```python
import torch

def _softmax(x, axis=-1):
    return torch.softmax(x, dim=axis)
def _gelu(x):
    return torch.nn.functional.gelu(x, approximate="tanh")
def _silu(x):
    return torch.nn.functional.silu(x)
def _sigmoid(x):
    return torch.sigmoid(x)
def _layernorm(x, axis=-1, eps=1e-5):
    m = x.mean(dim=axis, keepdim=True)
    v = x.var(dim=axis, keepdim=True, unbiased=False)
    return (x - m) / torch.sqrt(v + eps)
def _scatter_add(tgt, idx, src, axis=0):
    return tgt.clone().index_add_(axis, idx, src)
def _segment_sum(src, seg, n):
    out = torch.zeros((n,) + src.shape[1:], dtype=src.dtype)
    return out.index_add_(0, seg, src)
def _pad(x, pw):
    flat = tuple(v for pair in reversed(pw) for v in pair)
    return torch.nn.functional.pad(x, flat)

kernel_name = 'parallel_sum__sliding_local_dilated__dense_activation_gelu__prompt'

def setup_inputs():

    _w = (lambda a: (lambda t: t.to(torch.bfloat16) if t.is_floating_point() else t)(torch.as_tensor(a)))
    def _A_setup():
        B, S, D = 1, 2048, 1024
        return {
            "x": _w((lambda *s: torch.randn(*s, dtype=torch.bfloat16) * 0.05)(B, S, D)),
            "wqkv": _w((lambda *s: torch.randn(*s, dtype=torch.bfloat16) * 0.05)(D, 3 * D)),
            "wo": _w((lambda *s: torch.randn(*s, dtype=torch.bfloat16) * 0.05)(D, D)),
        }
    _A_in = _A_setup()

    def _B_setup():
        B, S, D, F = 1, 2048, 1024, 3584
        return {
            "x": _w((lambda *s: torch.randn(*s, dtype=torch.bfloat16) * 0.05)(B, S, D)),
            "w1": _w((lambda *s: torch.randn(*s, dtype=torch.bfloat16) * 3.2)(D, F) * (D ** -0.5)),
            "b1": _w((lambda *s: torch.randn(*s, dtype=torch.bfloat16) * 3.2)(F) * 0.01),
            "w2": _w((lambda *s: torch.randn(*s, dtype=torch.bfloat16) * 0.4)(F, D) * (F ** -0.5)),
            "b2": _w((lambda *s: torch.randn(*s, dtype=torch.bfloat16) * 0.4)(D) * 0.01),
        }
    _B_in = _B_setup()

    return {
        "A_x": _A_in["x"],
        "A_wqkv": _A_in["wqkv"],
        "A_wo": _A_in["wo"],
        "B_x": _B_in["x"],
        "B_w1": _B_in["w1"],
        "B_b1": _B_in["b1"],
        "B_w2": _B_in["w2"],
        "B_b2": _B_in["b2"],
    }

def reference(A_x, A_wqkv, A_wo, B_x, B_w1, B_b1, B_w2, B_b2):
    def _A_ref(x, wqkv, wo):
        B, S, D = x.shape
        H = 32; Dh = D // H
        W, dil = 8, 2
        qkv = (lambda x, *d: x.permute(*d))((x @ wqkv).reshape(B, S, 3, H, Dh), 2, 0, 3, 1, 4)
        q, k, v = qkv[0], qkv[1], qkv[2]
        scale = Dh ** -0.5
        pos = torch.arange(S)
        off = torch.arange(W) * dil
        idx = pos[:, None] - off[None, :]
        mask = idx >= 0
        idx_c = torch.where(mask, idx, 0).reshape(-1)
        kg = k[:, :, idx_c, :].reshape(B, H, S, W, Dh)
        vg = v[:, :, idx_c, :].reshape(B, H, S, W, Dh)
        logits = torch.einsum("bhsd,bhswd->bhsw", q, kg) * scale
        logits = torch.where(mask[None, None, :, :], logits, -1e9)
        attn = _softmax(logits, axis=-1)
        o = torch.einsum("bhsw,bhswd->bhsd", attn, vg)
        return (lambda x, *d: x.permute(*d))(o, 0, 2, 1, 3).reshape(B, S, D) @ wo

    def _B_ref(x, w1, b1, w2, b2):
        h = torch.einsum("bsd,df->bsf", x, w1) + b1
        h = _gelu(h)
        return torch.einsum("bsf,fd->bsd", h, w2) + b2

    x = A_x
    xn = _layernorm(x, axis=-1)
    return x + _A_ref(xn, A_wqkv, A_wo) + _B_ref(xn, B_w1, B_b1, B_w2, B_b2)
```

```asm
; @launch grid=(256,1,1) block=(256,1,1) lds=163840
.amdgcn_target "amdgcn-amd-amdhsa--gfx950"
.text
.globl parallel_sum__sliding_local_dilated__dense_activation_gelu__prompt_kernel
.p2align 8
.type parallel_sum__sliding_local_dilated__dense_activation_gelu__prompt_kernel,@function
parallel_sum__sliding_local_dilated__dense_activation_gelu__prompt_kernel:
  s_cmp_ge_u32 s2, 256
  s_cbranch_scc0 L_go
  s_endpgm
L_go:
  s_load_dwordx2 s[60:61], s[0:1], 0
  s_load_dwordx2 s[8:9], s[0:1], 8
  s_load_dwordx2 s[68:69], s[0:1], 32
  s_load_dwordx2 s[16:17], s[0:1], 80
  s_load_dwordx2 s[40:41], s[0:1], 16
  s_load_dwordx2 s[44:45], s[0:1], 48
  s_load_dwordx2 s[72:73], s[0:1], 40
  s_load_dwordx2 s[48:49], s[0:1], 72
  v_lshrrev_b32 v3, 6, v0
  v_and_b32 v2, 63, v0
  v_readfirstlane_b32 s20, v3
  v_and_b32 v4, 15, v2
  v_lshrrev_b32 v3, 4, v2
  s_lshr_b32 s29, s2, 3
  s_xor_b32 s29, s29, s2
  s_and_b32 s35, s29, 1
  s_cselect_b32 s30, 7, 11
  s_getpc_b64 s[76:77]
L_pc:
  s_mul_i32 s29, s35, Lg_base-La_base
  s_add_u32 s29, s29, La_base-L_pc
  s_add_u32 s76, s76, s29
  s_addc_u32 s77, s77, 0
  s_mov_b32 s78, Lg_end-Lg_base
  s_mov_b32 s79, 0x20000
  s_lshl_b32 s29, s20, 7
  v_lshl_add_u32 v24, v3, 9, s29
  buffer_load_dword a141, v24, s[76:79], 0 offen
  v_lshl_add_u32 v25, v4, 12, s29
  buffer_load_dword a141, v25, s[76:79], 0 offen
  v_lshrrev_b32 v24, 3, v2
  v_and_b32 v25, 7, v2
  s_bfe_u32 s23, s2, 0x20004
  s_bfe_u32 s3, s2, 65538
  s_lshl_b32 s29, s3, 2
  s_add_u32 s23, s23, s29
  v_and_b32 v26, 6, v24
  v_xor_b32 v26, v25, v26
  v_lshlrev_b32 v17, 12, v24
  v_lshl_add_u32 v17, v26, 4, v17
  s_lshl_b32 s29, s20, 17
  v_add_u32 v16, s29, v17
  s_lshr_b32 s38, s2, 6
  s_lshl_b32 s80, s38, 15
  s_and_b32 s39, s38, 2
  s_add_u32 s38, s38, s39
  s_lshl_b32 s39, s20, 3
  s_add_u32 s38, s38, s39
  s_lshl_b32 s84, s38, 10
  s_lshl_b32 s64, s23, 19
  s_lshl_b32 s39, s3, 10
  s_add_u32 s64, s64, s39
  s_add_u32 s64, s64, 0
  s_mov_b32 s6, 522368
  s_mov_b32 s7, 0x20000
  s_xor_b32 s81, s80, 32768
  s_xor_b32 s85, s84, 1024
  s_xor_b32 s82, s80, 65536
  s_xor_b32 s86, s84, 4096
  s_xor_b32 s83, s80, 98304
  s_xor_b32 s87, s84, 5120
  s_lshr_b32 s24, s2, 6
  s_and_b32 s29, s2, 3
  s_lshl_b32 s29, s29, 2
  s_add_u32 s24, s24, s29
  s_lshl_b32 s29, s35, 10
  s_add_u32 s36, s29, 6144
  s_lshl_b32 s29, s35, 8
  s_add_u32 s31, s29, 128
  v_and_b32 v26, 2, v24
  v_xor_b32 v25, v25, v26
  s_and_b32 s39, s23, 1
  s_lshl_b32 s29, s39, 2
  v_xor_b32 v25, s29, v25
  s_lshl_b32 s29, s20, 1
  s_add_u32 s29, s29, s39
  s_lshl_b32 s29, s29, 3
  v_add_u32 v26, s29, v24
  v_mul_u32_u24 v26, s36, v26
  v_lshl_add_u32 v18, v25, 4, v26
  s_xor_b32 s29, s29, 8
  v_add_u32 v26, s29, v24
  v_mul_u32_u24 v26, s36, v26
  v_xor_b32 v25, 4, v25
  v_lshl_add_u32 v19, v25, 4, v26
  s_lshl_b32 s65, s3, 9
  s_add_u32 s65, s65, 0
  s_mul_i32 s65, s65, s36
  s_mul_i32 s31, s31, s24
  s_add_u32 s65, s65, s31
  s_mul_i32 s10, s36, 63
  s_lshl_b32 s29, 2, s30
  s_add_u32 s10, s10, s29
  s_add_u32 s10, s10, 128
  s_mov_b32 s11, 0x20000
  s_mul_i32 s27, s20, 7168
  s_add_u32 s27, s27, 69632
  s_mul_i32 s39, s39, 3072
  s_and_b32 s38, s23, 2
  s_cmp_eq_u32 s38, 0
  s_cselect_b32 s29, 0, 2
  s_lshl_b32 s94, s29, s30
  s_lshl_b32 s29, s29, 10
  s_add_u32 s29, s29, s27
  s_add_u32 s88, s29, s39
  s_sub_u32 s29, s29, s39
  s_add_u32 s91, s29, 3072
  s_cmp_eq_u32 s38, 0
  s_cselect_b32 s29, 1, 0
  s_lshl_b32 s95, s29, s30
  s_lshl_b32 s29, s29, 10
  s_add_u32 s29, s29, s27
  s_add_u32 s89, s29, s39
  s_sub_u32 s29, s29, s39
  s_add_u32 s92, s29, 3072
  s_cmp_eq_u32 s38, 0
  s_cselect_b32 s29, 2, 1
  s_lshl_b32 s96, s29, s30
  s_lshl_b32 s29, s29, 10
  s_add_u32 s29, s29, s27
  s_add_u32 s90, s29, s39
  s_sub_u32 s29, s29, s39
  s_add_u32 s93, s29, 3072
  s_mov_b32 m0, s84
  s_waitcnt lgkmcnt(0)
  s_add_u32 s4, s60, s64
  s_addc_u32 s5, s61, 0
  buffer_load_dwordx4 v16, s[4:7], s80 offen lds
  buffer_load_dwordx4 v16, s[4:7], s80 offen offset:2048 lds
  s_mov_b32 m0, s88
  s_cmp_eq_u32 s35, 0
  s_cselect_b32 s8, s8, s68
  s_cselect_b32 s9, s9, s69
  s_add_u32 s8, s8, s65
  s_addc_u32 s9, s9, 0
  buffer_load_dwordx4 v18, s[8:11], s94 offen lds
  s_mov_b32 m0, s89
  s_nop 0
  buffer_load_dwordx4 v18, s[8:11], s95 offen lds
  s_mov_b32 m0, s90
  s_nop 0
  buffer_load_dwordx4 v18, s[8:11], s96 offen lds
  s_mov_b32 m0, s85
  s_nop 0
  buffer_load_dwordx4 v16, s[4:7], s81 offen lds
  buffer_load_dwordx4 v16, s[4:7], s81 offen offset:2048 lds
  s_lshr_b32 s21, s20, 1
  s_and_b32 s22, s20, 1
  s_mov_b32 s33, 0x3f803f80
  s_bfe_u32 s25, s2, 0x20003
  s_and_b32 s29, s2, 4
  s_add_u32 s25, s25, s29
  s_lshl_b32 s25, s25, 1
  s_bfe_u32 s29, s2, 0x10001
  s_add_u32 s25, s25, s29
  s_lshr_b32 s26, s2, 5
  s_cmp_eq_u32 s35, 0
  s_cbranch_scc0 Lg_base
  s_branch La_base
.p2align 12
La_base:
  s_load_dwordx2 s[52:53], s[0:1], 64
  v_lshrrev_b32 v5, 5, v2
  v_and_b32 v6, 3, v2
  v_accvgpr_write_b32 a136, s33
  v_accvgpr_write_b32 a137, s33
  v_accvgpr_write_b32 a138, s33
  v_accvgpr_write_b32 a139, s33
  v_lshrrev_b32 v24, 2, v2
  v_xor_b32 v25, v5, v6
  s_lshl_b32 s29, s20, 4
  v_add_u32 v24, s29, v24
  v_mul_u32_u24 v24, 7168, v24
  v_lshl_add_u32 v20, v25, 4, v24
  s_mul_i32 s39, s3, 3670016
  s_xor_b32 s38, s24, 0
  s_lshl_b32 s38, s38, 6
  s_add_u32 s39, s39, s38
  s_add_u32 s39, s39, 6144
  s_add_u32 s68, s68, s39
  s_addc_u32 s69, s69, 0
  s_mov_b32 s70, 451648
  s_mov_b32 s71, 0x20000
  s_mov_b32 s78, La_end-La_base
  s_lshr_b32 s29, s2, 4
  s_lshl_b32 s29, s29, 2
  s_add_u32 s29, s29, s20
  s_lshl_b32 s29, s29, 10
  v_and_b32 v24, 7, v2
  v_lshl_add_u32 v23, v24, 7, s29
  buffer_load_dword a141, v23, s[76:79], 0 offen
  s_lshl_b32 s64, s3, 11
  s_mul_i32 s65, s3, 6291456
  s_mul_i32 s97, s3, 7340032
  v_and_b32 v27, 6, v4
  s_add_u32 m0, s27, 6144
  s_nop 0
  buffer_load_dwordx4 v20, s[68:71], 0 offen  lds
  s_add_u32 s68, s68, 458752
  s_addc_u32 s69, s69, 0
  v_xor_b32 v27, v27, v3
  v_lshlrev_b32 v27, 4, v27
  v_lshl_add_u32 v28, v4, 7, v27
  s_lshl_b32 s29, s21, 14
  v_add_u32 v8, s29, v28
  v_xor_b32 v9, 64, v8
  v_bfe_u32 v27, v2, 2, 2
  s_add_u32 m0, s91, 0
  s_nop 0
  buffer_load_dwordx4 v19, s[8:11], s94 offen  lds
  v_and_b32 v28, 1, v3
  v_mul_u32_u24 v29, 7168, v5
  v_add_u32 v29, 69632, v29
  v_mul_u32_u24 v23, 3072, v28
  v_add_u32 v23, v29, v23
  v_lshl_add_u32 v23, v27, 7, v23
  v_lshl_add_u32 v23, v6, 3, v23
  v_lshrrev_b32 v24, 1, v27
  s_add_u32 m0, s92, 0
  s_nop 0
  buffer_load_dwordx4 v19, s[8:11], s95 offen  lds
  v_lshl_or_b32 v24, v28, 1, v24
  s_lshl_b32 s29, s22, 1
  v_xor_b32 v24, s29, v24
  v_lshl_add_u32 v10, v24, 5, v23
  v_xor_b32 v11, 32, v10
  v_add_u32 v13, 57344, v10
  v_add_u32 v14, 57344, v11
  s_and_b32 s38, s23, 3
  s_add_u32 m0, s93, 0
  s_nop 0
  buffer_load_dwordx4 v19, s[8:11], s96 offen  lds
  s_add_u32 s8, s8, 393216
  s_addc_u32 s9, s9, 0
  s_lshl_b32 s38, s38, 1
  s_add_u32 s38, s38, s21
  s_min_u32 s39, s38, 5
  s_and_b32 s29, s39, 1
  s_lshl_b32 s29, s29, 5
  v_xor_b32 v23, s29, v10
  s_lshr_b32 s29, s39, 1
  s_lshl_b32 s29, s29, 10
  s_add_u32 m0, s86, 0
  s_nop 0
  buffer_load_dwordx4 v16, s[4:7], s82 offen offset:0  lds
  v_add_u32 v23, s29, v23
  v_add_u32 v24, 512, v23
  s_and_b32 s29, s39, 6
  s_add_u32 s29, s29, s22
  s_lshl_b32 s29, s29, 1
  s_and_b32 s39, s39, 1
  s_add_u32 s29, s29, s39
  buffer_load_dwordx4 v16, s[4:7], s82 offen offset:2048  lds
  s_lshl_b32 s29, s29, 4
  v_add_u32_e64 v31, s29, v4
  v_lshl_add_u32 v25, v28, 3, v27
  v_lshl_add_u32 v25, v25, 6, v29
  v_add_u32 v25, 6144, v25
  v_and_b32 v26, 2, v6
  v_add_u32 v26, s22, v26
  v_xor_b32 v26, v26, v28
  s_add_u32 m0, s87, 0
  s_nop 0
  buffer_load_dwordx4 v16, s[4:7], s83 offen offset:0  lds
  v_lshl_add_u32 v25, v26, 4, v25
  v_and_b32 v26, 1, v6
  v_lshl_add_u32 v12, v26, 3, v25
  v_add_u32 v15, 57344, v12
  v_add_u32 v25, 256, v12
  v_and_b32 v26, 8, v4
  v_add_u32 v26, v26, v4
  s_lshl_b32 s29, s22, 3
  buffer_load_dwordx4 v16, s[4:7], s83 offen offset:2048  lds
  s_add_u32 s4, s4, 128
  s_addc_u32 s5, s5, 0
  s_add_u32 s29, s29, 192
  v_add_u32 v26, s29, v26
  s_cmp_ge_u32 s38, 6
  s_cselect_b64 vcc, -1, 0
  v_cndmask_b32 v23, v23, v12, vcc
  v_cndmask_b32 v24, v24, v25, vcc
  v_cndmask_b32 v31, v31, v26, vcc
  v_add_u32 v25, 57344, v23
  v_add_u32 v26, 57344, v24
  s_lshl_b32 s66, s24, 12
  s_add_u32 s66, s66, 16384
  s_lshr_b32 s29, s23, 2
  s_lshl_b32 s29, s29, 11
  s_add_u32 s29, s29, s66
  v_lshl_add_u32 v31, v31, 3, s29
  s_cmp_lt_u32 s38, 7
  s_cselect_b32 s38, 0xffff, 0
  s_lshl_b32 s29, s23, 2
  s_lshr_b32 s39, s24, 2
  s_add_u32 s29, s29, s39
  s_lshl_b32 s29, s29, 2
  s_and_b32 s39, s24, 3
  s_add_u32 s29, s29, s39
  s_lshl_b32 s29, s29, 2
  s_add_u32 s29, s29, s20
  s_lshl_b32 s29, s29, 4
  s_lshr_b32 s67, s2, 1
  s_lshl_b32 s67, s67, 2
  s_add_u32 s67, s67, s20
  s_lshl_b32 s67, s67, 4
  s_add_u32 s67, s67, 294912
  s_add_u32 s29, s29, 262144
  v_mov_b32 v29, s29
  s_lshl_b32 s99, s2, 2
  s_add_u32 s99, s99, s20
  s_lshl_b32 s99, s99, 5
  s_add_u32 s99, s99, 327680
  v_writelane_b32 v29, s99, 1
  s_lshl_b32 s29, s23, 1
  s_add_u32 s29, s29, s21
  s_lshl_b32 s29, s29, 4
  s_add_u32 s29, s29, s24
  s_lshl_b32 s29, s29, 1
  s_add_u32 s33, s29, s22
  s_lshl_b32 s32, s33, 12
  s_add_u32 s32, s32, 1048576
  v_mov_b32 v48, -1
  v_mov_b32 v49, -1
  v_mov_b32 v50, -1
  v_mov_b32 v51, -1
  s_mov_b32 s12, s16
  s_mov_b32 s13, s17
  s_mov_b32 s56, s16
  s_mov_b32 s57, s17
  s_mov_b32 s18, 4194304
  s_mov_b32 s19, 0x20000
  s_mov_b32 s42, 2097152
  s_add_u32 m0, s84, 34816
  s_nop 0
  buffer_load_dwordx4 v16, s[4:7], s80 offen offset:0  lds
  s_mov_b32 s43, 0x20000
  s_mov_b32 s46, 7340032
  s_mov_b32 s47, 0x20000
  s_mov_b32 s50, 256
  buffer_load_dwordx4 v16, s[4:7], s80 offen offset:2048  lds
  s_mov_b32 s51, 0x20000
  s_mov_b32 s54, 4194304
  s_mov_b32 s55, 0x20000
  s_mov_b32 s62, 4194304
  s_add_u32 m0, s85, 34816
  s_nop 0
  buffer_load_dwordx4 v16, s[4:7], s81 offen offset:0  lds
  s_mov_b32 s63, 0x20000
  s_mov_b32 s74, 7168
  s_mov_b32 s75, 0x20000
  s_mov_b32 s58, 16777216
  buffer_load_dwordx4 v16, s[4:7], s81 offen offset:2048  lds
  s_mov_b32 s59, 0x20000
  s_add_u32 s56, s56, 33554432
  s_addc_u32 s57, s57, 0
  s_lshl_b32 s29, s2, 2
  s_add_u32 s37, s29, s20
  s_lshl_b32 s29, s37, 1
  s_add_u32 m0, s86, 34816
  s_nop 0
  buffer_load_dwordx4 v16, s[4:7], s82 offen offset:0  lds
  v_lshrrev_b32 v30, 3, v4
  v_add_u32 v30, s29, v30
  v_and_b32 v27, 7, v2
  v_lshl_add_u32 v27, v3, 3, v27
  buffer_load_dwordx4 v16, s[4:7], s82 offen offset:2048  lds
  v_lshlrev_b32 v27, 4, v27
  v_lshl_add_u32 v27, v30, 11, v27
  v_lshlrev_b32 v7, 4, v2
  v_mov_b32 v35, 1
  s_add_u32 m0, s87, 34816
  s_nop 0
  buffer_load_dwordx4 v16, s[4:7], s83 offen offset:0  lds
  v_and_b32 v34, 0, v2
  v_lshlrev_b32 v34, 0, v34
  v_mov_b32 v32, 0
  v_mov_b32 v33, 0
  buffer_load_dwordx4 v16, s[4:7], s83 offen offset:2048  lds
  s_add_u32 s4, s4, 128
  s_addc_u32 s5, s5, 0
  v_lshlrev_b32 v30, 3, v30
  s_lshl_b32 s29, s20, 4
  v_add_lshl_u32 v6, s29, v4, 7
  s_lshr_b32 s29, s2, 1
  s_lshl_b32 s29, s29, 2
  s_add_u32 m0, s27, 34816
  s_nop 0
  buffer_load_dwordx4 v20, s[68:71], 0 offen  lds
  s_add_u32 s68, s68, 458752
  s_addc_u32 s69, s69, 0
  s_add_u32 s29, s29, s20
  s_lshl_b32 s35, s29, 10
  s_lshr_b32 s29, s29, 7
  s_mul_i32 s29, s29, 1441792
  s_add_u32 m0, s88, 28672
  s_nop 0
  buffer_load_dwordx4 v18, s[8:11], s94 offen  lds
  s_add_u32 s36, s35, s29
  s_lshr_b32 s29, s35, 15
  s_sub_u32 s29, s29, 11
  s_max_i32 s29, s29, 0
  s_add_u32 m0, s89, 28672
  s_nop 0
  buffer_load_dwordx4 v18, s[8:11], s95 offen  lds
  s_lshl_b32 s29, s29, 14
  s_sub_u32 s35, s35, s29
  s_and_b32 s29, s24, 7
  s_cmp_eq_u32 s29, 3
  s_cselect_b32 s35, 0x40000000, s35
  s_waitcnt lgkmcnt(0)
  s_mov_b64 exec, 0
  s_cmp_eq_u32 s20, 0
  s_cbranch_scc1 La_pad1
  s_cmp_eq_u32 s20, 1
  s_cbranch_scc1 La_pad2
  s_cmp_eq_u32 s20, 2
  s_cbranch_scc1 La_pad3
  s_branch La_pad4
La_ret0:
  s_mov_b64 exec, -1
  s_waitcnt vmcnt(11)
  s_barrier
  ds_read_b64_tr_b16 a[64:65], v10 offset:0
  ds_read_b64_tr_b16 a[66:67], v10 offset:512
  ds_read_b64_tr_b16 a[68:69], v10 offset:14336
  ds_read_b64_tr_b16 a[70:71], v10 offset:14848
  ds_read_b128 a[0:3], v8 offset:0
  ds_read_b128 a[4:7], v9 offset:0
  ds_read_b128 a[8:11], v8 offset:2048
  ds_read_b128 a[12:15], v9 offset:2048
  ds_read_b128 a[16:19], v8 offset:4096
  ds_read_b128 a[20:23], v9 offset:4096
  ds_read_b128 a[24:27], v8 offset:6144
  ds_read_b128 a[28:31], v9 offset:6144
  ds_read_b64_tr_b16 a[72:73], v11 offset:0
  ds_read_b64_tr_b16 a[74:75], v11 offset:512
  ds_read_b64_tr_b16 a[76:77], v11 offset:14336
  ds_read_b64_tr_b16 a[78:79], v11 offset:14848
  ds_read_b64_tr_b16 a[80:81], v10 offset:1024
  ds_read_b64_tr_b16 a[82:83], v10 offset:1536
  ds_read_b64_tr_b16 a[84:85], v10 offset:15360
  ds_read_b64_tr_b16 a[86:87], v10 offset:15872
  ds_read_b64_tr_b16 a[88:89], v11 offset:1024
  ds_read_b64_tr_b16 a[90:91], v11 offset:1536
  ds_read_b64_tr_b16 a[92:93], v11 offset:15360
  ds_read_b64_tr_b16 a[94:95], v11 offset:15872
  ds_read_b64_tr_b16 a[96:97], v10 offset:2048
  ds_read_b64_tr_b16 a[98:99], v10 offset:2560
  ds_read_b64_tr_b16 a[100:101], v10 offset:16384
  ds_read_b64_tr_b16 a[102:103], v10 offset:16896
  ds_read_b64_tr_b16 a[104:105], v11 offset:2048
  ds_read_b64_tr_b16 a[106:107], v11 offset:2560
  ds_read_b64_tr_b16 a[108:109], v11 offset:16384
  ds_read_b64_tr_b16 a[110:111], v11 offset:16896
  ds_read_b64_tr_b16 a[112:113], v12 offset:0
  ds_read_b64_tr_b16 a[114:115], v12 offset:256
  ds_read_b64_tr_b16 a[116:117], v12 offset:14336
  ds_read_b64_tr_b16 a[118:119], v12 offset:14592
  s_waitcnt lgkmcnt(14)
  v_mfma_f32_16x16x32_bf16 v[64:67], a[64:67], a[0:3], 0
  ds_read_b128 a[32:35], v8 offset:8192
  s_add_u32 m0, s90, 28672
  v_mfma_f32_16x16x32_bf16 v[64:67], a[68:71], a[4:7], v[64:67]
  buffer_load_dwordx4 v18, s[8:11], s96 offen  lds
  v_mfma_f32_16x16x32_bf16 v[88:91], a[68:71], a[12:15], 0
  ds_read_b128 a[36:39], v9 offset:8192
  v_mfma_f32_16x16x32_bf16 v[88:91], a[64:67], a[8:11], v[88:91]
  v_mfma_f32_16x16x32_bf16 v[112:115], a[64:67], a[16:19], 0
  ds_read_b128 a[40:43], v8 offset:10240
  v_mfma_f32_16x16x32_bf16 v[112:115], a[68:71], a[20:23], v[112:115]
  s_add_u32 m0, s91, 28672
  v_mfma_f32_16x16x32_bf16 v[136:139], a[68:71], a[28:31], 0
  ds_read_b128 a[44:47], v9 offset:10240
  buffer_load_dwordx4 v19, s[8:11], s94 offen  lds
  v_mfma_f32_16x16x32_bf16 v[136:139], a[64:67], a[24:27], v[136:139]
  v_mfma_f32_16x16x32_bf16 v[140:143], a[72:75], a[24:27], 0
  ds_read_b128 a[48:51], v8 offset:12288
  v_mfma_f32_16x16x32_bf16 v[140:143], a[76:79], a[28:31], v[140:143]
  v_mfma_f32_16x16x32_bf16 v[116:119], a[76:79], a[20:23], 0
  ds_read_b128 a[52:55], v9 offset:12288
  s_add_u32 m0, s92, 28672
  v_mfma_f32_16x16x32_bf16 v[116:119], a[72:75], a[16:19], v[116:119]
  buffer_load_dwordx4 v19, s[8:11], s95 offen  lds
  v_mfma_f32_16x16x32_bf16 v[92:95], a[72:75], a[8:11], 0
  ds_read_b128 a[56:59], v8 offset:14336
  v_mfma_f32_16x16x32_bf16 v[92:95], a[76:79], a[12:15], v[92:95]
  v_mfma_f32_16x16x32_bf16 v[68:71], a[76:79], a[4:7], 0
  ds_read_b128 a[60:63], v9 offset:14336
  v_mfma_f32_16x16x32_bf16 v[68:71], a[72:75], a[0:3], v[68:71]
  s_add_u32 m0, s93, 28672
  v_mfma_f32_16x16x32_bf16 v[72:75], a[80:83], a[0:3], 0
  ds_read_b64_tr_b16 a[128:129], v23 offset:0
  buffer_load_dwordx4 v19, s[8:11], s96 offen  lds
  v_mfma_f32_16x16x32_bf16 v[72:75], a[84:87], a[4:7], v[72:75]
  s_add_u32 s8, s8, 393216
  s_addc_u32 s9, s9, 0
  v_mfma_f32_16x16x32_bf16 v[96:99], a[84:87], a[12:15], 0
  ds_read_b64_tr_b16 a[130:131], v24 offset:0
  v_mfma_f32_16x16x32_bf16 v[96:99], a[80:83], a[8:11], v[96:99]
  v_mfma_f32_16x16x32_bf16 v[120:123], a[80:83], a[16:19], 0
  ds_read_b64_tr_b16 a[132:133], v23 offset:14336
  s_add_u32 m0, s27, 63488
  v_mfma_f32_16x16x32_bf16 v[120:123], a[84:87], a[20:23], v[120:123]
  buffer_load_dwordx4 v20, s[68:71], 0 offen  lds
  v_mfma_f32_16x16x32_bf16 v[144:147], a[84:87], a[28:31], 0
  ds_read_b64_tr_b16 a[134:135], v24 offset:14336
  s_add_u32 s68, s68, 458752
  s_addc_u32 s69, s69, 0
  v_mfma_f32_16x16x32_bf16 v[144:147], a[80:83], a[24:27], v[144:147]
  s_waitcnt lgkmcnt(14)
  v_mfma_f32_16x16x32_bf16 v[148:151], a[88:91], a[24:27], 0
  v_mfma_f32_16x16x32_bf16 v[148:151], a[92:95], a[28:31], v[148:151]
  s_add_u32 m0, s88, 57344
  v_mfma_f32_16x16x32_bf16 v[124:127], a[92:95], a[20:23], 0
  buffer_load_dwordx4 v18, s[8:11], s94 offen  lds
  v_mfma_f32_16x16x32_bf16 v[124:127], a[88:91], a[16:19], v[124:127]
  v_mfma_f32_16x16x32_bf16 v[100:103], a[88:91], a[8:11], 0
  v_mfma_f32_16x16x32_bf16 v[100:103], a[92:95], a[12:15], v[100:103]
  v_mfma_f32_16x16x32_bf16 v[76:79], a[92:95], a[4:7], 0
  s_add_u32 m0, s89, 57344
  v_mfma_f32_16x16x32_bf16 v[76:79], a[88:91], a[0:3], v[76:79]
  buffer_load_dwordx4 v18, s[8:11], s95 offen  lds
  v_mfma_f32_16x16x32_bf16 v[80:83], a[0:3], a[96:99], 0
  v_mfma_f32_16x16x32_bf16 v[80:83], a[4:7], a[100:103], v[80:83]
  v_mfma_f32_16x16x32_bf16 v[104:107], a[12:15], a[100:103], 0
  v_mfma_f32_16x16x32_bf16 v[104:107], a[8:11], a[96:99], v[104:107]
  v_mfma_f32_16x16x32_bf16 v[128:131], a[16:19], a[96:99], 0
  v_mfma_f32_16x16x32_bf16 v[128:131], a[20:23], a[100:103], v[128:131]
  v_mfma_f32_16x16x32_bf16 v[152:155], a[28:31], a[100:103], 0
  v_mfma_f32_16x16x32_bf16 v[152:155], a[24:27], a[96:99], v[152:155]
  v_mfma_f32_16x16x32_bf16 v[156:159], a[24:27], a[104:107], 0
  v_mfma_f32_16x16x32_bf16 v[156:159], a[28:31], a[108:111], v[156:159]
  v_mfma_f32_16x16x32_bf16 v[132:135], a[20:23], a[108:111], 0
  v_mfma_f32_16x16x32_bf16 v[132:135], a[16:19], a[104:107], v[132:135]
  v_mfma_f32_16x16x32_bf16 v[108:111], a[8:11], a[104:107], 0
  v_mfma_f32_16x16x32_bf16 v[108:111], a[12:15], a[108:111], v[108:111]
  v_mfma_f32_16x16x32_bf16 v[84:87], a[4:7], a[108:111], 0
  v_mfma_f32_16x16x32_bf16 v[84:87], a[0:3], a[104:107], v[84:87]
  s_waitcnt lgkmcnt(12)
  v_mfma_f32_16x16x32_bf16 a[176:179], a[112:115], a[0:3], 0
  v_mfma_f32_16x16x32_bf16 a[176:179], a[116:119], a[4:7], a[176:179]
  v_mfma_f32_16x16x32_bf16 a[180:183], a[116:119], a[12:15], 0
  v_mfma_f32_16x16x32_bf16 a[180:183], a[112:115], a[8:11], a[180:183]
  v_mfma_f32_16x16x32_bf16 a[184:187], a[112:115], a[16:19], 0
  v_mfma_f32_16x16x32_bf16 a[184:187], a[116:119], a[20:23], a[184:187]
  v_mfma_f32_16x16x32_bf16 a[188:191], a[116:119], a[28:31], 0
  v_mfma_f32_16x16x32_bf16 a[188:191], a[112:115], a[24:27], a[188:191]
  s_mov_b64 exec, 0
  s_cmp_eq_u32 s20, 0
  s_cbranch_scc1 La_pad5
  s_cmp_eq_u32 s20, 1
  s_cbranch_scc1 La_pad6
  s_cmp_eq_u32 s20, 2
  s_cbranch_scc1 La_pad7
  s_branch La_pad8
La_ret1:
  s_mov_b64 exec, -1
  s_waitcnt vmcnt(3) lgkmcnt(0)
  s_barrier
  v_mfma_f32_16x16x32_bf16 v[160:163], a[64:67], a[32:35], 0
  ds_read_b128 a[0:3], v8 offset:34816
  s_add_u32 m0, s84, 0
  v_mfma_f32_16x16x32_bf16 v[160:163], a[68:71], a[36:39], v[160:163]
  buffer_load_dwordx4 v16, s[4:7], s80 offen offset:0  lds
  v_mfma_f32_16x16x32_bf16 v[184:187], a[68:71], a[44:47], 0
  ds_read_b128 a[4:7], v9 offset:34816
  v_mfma_f32_16x16x32_bf16 v[184:187], a[64:67], a[40:43], v[184:187]
  ds_read_b128 a[16:19], v8 offset:38912
  v_mfma_f32_16x16x32_bf16 v[208:211], a[64:67], a[48:51], 0
  ds_read_b128 a[8:11], v8 offset:36864
  v_mfma_f32_16x16x32_bf16 v[208:211], a[68:71], a[52:55], v[208:211]
  buffer_load_dwordx4 v16, s[4:7], s80 offen offset:2048  lds
  v_mfma_f32_16x16x32_bf16 v[232:235], a[68:71], a[60:63], 0
  ds_read_b128 a[12:15], v9 offset:36864
  v_mfma_f32_16x16x32_bf16 v[232:235], a[64:67], a[56:59], v[232:235]
  ds_read_b128 a[20:23], v9 offset:38912
  v_mfma_f32_16x16x32_bf16 v[236:239], a[72:75], a[56:59], 0
  ds_read_b64_tr_b16 a[64:65], v10 offset:28672
  s_add_u32 m0, s85, 0
  v_mfma_f32_16x16x32_bf16 v[236:239], a[76:79], a[60:63], v[236:239]
  buffer_load_dwordx4 v16, s[4:7], s81 offen offset:0  lds
  v_mfma_f32_16x16x32_bf16 v[212:215], a[76:79], a[52:55], 0
  ds_read_b64_tr_b16 a[66:67], v10 offset:29184
  v_mfma_f32_16x16x32_bf16 v[212:215], a[72:75], a[48:51], v[212:215]
  ds_read_b128 a[24:27], v8 offset:40960
  v_mfma_f32_16x16x32_bf16 v[188:191], a[72:75], a[40:43], 0
  ds_read_b64_tr_b16 a[68:69], v10 offset:43008
  v_mfma_f32_16x16x32_bf16 v[188:191], a[76:79], a[44:47], v[188:191]
  buffer_load_dwordx4 v16, s[4:7], s81 offen offset:2048  lds
  v_mfma_f32_16x16x32_bf16 v[164:167], a[76:79], a[36:39], 0
  ds_read_b64_tr_b16 a[70:71], v10 offset:43520
  v_mfma_f32_16x16x32_bf16 v[164:167], a[72:75], a[32:35], v[164:167]
  ds_read_b128 a[28:31], v9 offset:40960
  v_mfma_f32_16x16x32_bf16 v[168:171], a[80:83], a[32:35], 0
  ds_read_b64_tr_b16 a[72:73], v11 offset:28672
  s_add_u32 m0, s86, 0
  v_mfma_f32_16x16x32_bf16 v[168:171], a[84:87], a[36:39], v[168:171]
  buffer_load_dwordx4 v16, s[4:7], s82 offen offset:0  lds
  v_mfma_f32_16x16x32_bf16 v[192:195], a[84:87], a[44:47], 0
  ds_read_b64_tr_b16 a[74:75], v11 offset:29184
  v_mfma_f32_16x16x32_bf16 v[192:195], a[80:83], a[40:43], v[192:195]
  v_mfma_f32_16x16x32_bf16 v[216:219], a[80:83], a[48:51], 0
  ds_read_b64_tr_b16 a[76:77], v11 offset:43008
  v_mfma_f32_16x16x32_bf16 v[216:219], a[84:87], a[52:55], v[216:219]
  buffer_load_dwordx4 v16, s[4:7], s82 offen offset:2048  lds
  v_mfma_f32_16x16x32_bf16 v[240:243], a[84:87], a[60:63], 0
  ds_read_b64_tr_b16 a[78:79], v11 offset:43520
  v_mfma_f32_16x16x32_bf16 v[240:243], a[80:83], a[56:59], v[240:243]
  v_mfma_f32_16x16x32_bf16 v[244:247], a[88:91], a[56:59], 0
  ds_read_b64_tr_b16 a[80:81], v10 offset:29696
  v_mfma_f32_16x16x32_bf16 v[244:247], a[92:95], a[60:63], v[244:247]
  v_mfma_f32_16x16x32_bf16 v[220:223], a[92:95], a[52:55], 0
  ds_read_b64_tr_b16 a[82:83], v10 offset:30208
  v_mfma_f32_16x16x32_bf16 v[220:223], a[88:91], a[48:51], v[220:223]
  v_mfma_f32_16x16x32_bf16 v[196:199], a[88:91], a[40:43], 0
  ds_read_b64_tr_b16 a[84:85], v10 offset:44032
  s_add_u32 m0, s87, 0
  v_mfma_f32_16x16x32_bf16 v[196:199], a[92:95], a[44:47], v[196:199]
  buffer_load_dwordx4 v16, s[4:7], s83 offen offset:0  lds
  v_mfma_f32_16x16x32_bf16 v[172:175], a[92:95], a[36:39], 0
  ds_read_b64_tr_b16 a[86:87], v10 offset:44544
  v_mfma_f32_16x16x32_bf16 v[172:175], a[88:91], a[32:35], v[172:175]
  v_mfma_f32_16x16x32_bf16 v[176:179], a[32:35], a[96:99], 0
  ds_read_b64_tr_b16 a[88:89], v11 offset:29696
  v_mfma_f32_16x16x32_bf16 v[176:179], a[36:39], a[100:103], v[176:179]
  buffer_load_dwordx4 v16, s[4:7], s83 offen offset:2048  lds
  v_mfma_f32_16x16x32_bf16 v[200:203], a[44:47], a[100:103], 0
  ds_read_b64_tr_b16 a[90:91], v11 offset:30208
  s_add_u32 s4, s4, 128
  s_addc_u32 s5, s5, 0
  v_mfma_f32_16x16x32_bf16 v[200:203], a[40:43], a[96:99], v[200:203]
  v_mfma_f32_16x16x32_bf16 v[224:227], a[48:51], a[96:99], 0
  ds_read_b64_tr_b16 a[92:93], v11 offset:44032
  s_add_u32 m0, s90, 57344
  v_mfma_f32_16x16x32_bf16 v[224:227], a[52:55], a[100:103], v[224:227]
  buffer_load_dwordx4 v18, s[8:11], s96 offen  lds
  v_mfma_f32_16x16x32_bf16 v[248:251], a[60:63], a[100:103], 0
  ds_read_b64_tr_b16 a[94:95], v11 offset:44544
  v_mfma_f32_16x16x32_bf16 v[248:251], a[56:59], a[96:99], v[248:251]
  v_mfma_f32_16x16x32_bf16 v[252:255], a[56:59], a[104:107], 0
  ds_read_b64_tr_b16 a[96:97], v10 offset:30720
  s_add_u32 m0, s91, 57344
  v_mfma_f32_16x16x32_bf16 v[252:255], a[60:63], a[108:111], v[252:255]
  buffer_load_dwordx4 v19, s[8:11], s94 offen  lds
  v_mfma_f32_16x16x32_bf16 v[228:231], a[52:55], a[108:111], 0
  ds_read_b64_tr_b16 a[98:99], v10 offset:31232
  v_mfma_f32_16x16x32_bf16 v[228:231], a[48:51], a[104:107], v[228:231]
  v_mfma_f32_16x16x32_bf16 v[204:207], a[40:43], a[104:107], 0
  ds_read_b64_tr_b16 a[100:101], v10 offset:45056
  s_add_u32 m0, s92, 57344
  v_mfma_f32_16x16x32_bf16 v[204:207], a[44:47], a[108:111], v[204:207]
  buffer_load_dwordx4 v19, s[8:11], s95 offen  lds
  v_mfma_f32_16x16x32_bf16 v[180:183], a[36:39], a[108:111], 0
  ds_read_b64_tr_b16 a[102:103], v10 offset:45568
  v_mfma_f32_16x16x32_bf16 v[180:183], a[32:35], a[104:107], v[180:183]
  v_mfma_f32_16x16x32_bf16 a[192:195], a[112:115], a[32:35], 0
  ds_read_b64_tr_b16 a[104:105], v11 offset:30720
  s_add_u32 m0, s93, 57344
  v_mfma_f32_16x16x32_bf16 a[192:195], a[116:119], a[36:39], a[192:195]
  buffer_load_dwordx4 v19, s[8:11], s96 offen  lds
  v_mfma_f32_16x16x32_bf16 a[196:199], a[116:119], a[44:47], 0
  ds_read_b64_tr_b16 a[106:107], v11 offset:31232
  s_add_u32 s8, s8, 393216
  s_addc_u32 s9, s9, 0
  v_mfma_f32_16x16x32_bf16 a[196:199], a[112:115], a[40:43], a[196:199]
  v_mfma_f32_16x16x32_bf16 a[200:203], a[112:115], a[48:51], 0
  ds_read_b64_tr_b16 a[108:109], v11 offset:45056
  v_mfma_f32_16x16x32_bf16 a[200:203], a[116:119], a[52:55], a[200:203]
  v_mfma_f32_16x16x32_bf16 a[204:207], a[116:119], a[60:63], 0
  ds_read_b64_tr_b16 a[110:111], v11 offset:45568
  v_mfma_f32_16x16x32_bf16 a[204:207], a[112:115], a[56:59], a[204:207]
  v_mfma_f32_16x16x32_bf16 v[36:39], a[136:139], a[128:131], 0
  v_mfma_f32_16x16x32_bf16 v[36:39], a[136:139], a[132:135], v[36:39]
  s_waitcnt lgkmcnt(14)
  v_mfma_f32_16x16x32_bf16 v[64:67], a[64:67], a[0:3], v[64:67]
  ds_read_b64_tr_b16 a[112:113], v12 offset:28672
  s_add_u32 m0, s27, 6144
  v_mfma_f32_16x16x32_bf16 v[64:67], a[68:71], a[4:7], v[64:67]
  buffer_load_dwordx4 v20, s[68:71], 0 offen  lds
  v_mfma_f32_16x16x32_bf16 v[88:91], a[68:71], a[12:15], v[88:91]
  ds_read_b64_tr_b16 a[114:115], v12 offset:28928
  s_add_u32 s68, s68, 458752
  s_addc_u32 s69, s69, 0
  v_mfma_f32_16x16x32_bf16 v[88:91], a[64:67], a[8:11], v[88:91]
  v_mfma_f32_16x16x32_bf16 v[112:115], a[64:67], a[16:19], v[112:115]
  ds_read_b64_tr_b16 a[116:117], v12 offset:43008
  v_mfma_f32_16x16x32_bf16 v[112:115], a[68:71], a[20:23], v[112:115]
  v_mfma_f32_16x16x32_bf16 v[136:139], a[68:71], a[28:31], v[136:139]
  ds_read_b64_tr_b16 a[118:119], v12 offset:43264
  v_mfma_f32_16x16x32_bf16 v[136:139], a[64:67], a[24:27], v[136:139]
  v_mfma_f32_16x16x32_bf16 v[140:143], a[72:75], a[24:27], v[140:143]
  ds_read_b128 a[32:35], v8 offset:43008
  s_add_u32 m0, s88, 0
  v_mfma_f32_16x16x32_bf16 v[140:143], a[76:79], a[28:31], v[140:143]
  buffer_load_dwordx4 v18, s[8:11], s94 offen  lds
  v_mfma_f32_16x16x32_bf16 v[116:119], a[76:79], a[20:23], v[116:119]
  ds_read_b128 a[36:39], v9 offset:43008
  v_mfma_f32_16x16x32_bf16 v[116:119], a[72:75], a[16:19], v[116:119]
  v_mfma_f32_16x16x32_bf16 v[92:95], a[72:75], a[8:11], v[92:95]
  ds_read_b128 a[40:43], v8 offset:45056
  v_mfma_f32_16x16x32_bf16 v[92:95], a[76:79], a[12:15], v[92:95]
  v_mfma_f32_16x16x32_bf16 v[68:71], a[76:79], a[4:7], v[68:71]
  ds_read_b128 a[44:47], v9 offset:45056
  v_mfma_f32_16x16x32_bf16 v[68:71], a[72:75], a[0:3], v[68:71]
  s_waitcnt lgkmcnt(14)
  v_mfma_f32_16x16x32_bf16 v[72:75], a[80:83], a[0:3], v[72:75]
  ds_read_b128 a[48:51], v8 offset:47104
  s_add_u32 m0, s89, 0
  v_mfma_f32_16x16x32_bf16 v[72:75], a[84:87], a[4:7], v[72:75]
  buffer_load_dwordx4 v18, s[8:11], s95 offen  lds
  v_mfma_f32_16x16x32_bf16 v[96:99], a[84:87], a[12:15], v[96:99]
  ds_read_b128 a[52:55], v9 offset:47104
  v_mfma_f32_16x16x32_bf16 v[96:99], a[80:83], a[8:11], v[96:99]
  v_mfma_f32_16x16x32_bf16 v[120:123], a[80:83], a[16:19], v[120:123]
  ds_read_b128 a[56:59], v8 offset:49152
  v_mfma_f32_16x16x32_bf16 v[120:123], a[84:87], a[20:23], v[120:123]
  v_mfma_f32_16x16x32_bf16 v[144:147], a[84:87], a[28:31], v[144:147]
  ds_read_b128 a[60:63], v9 offset:49152
  v_mfma_f32_16x16x32_bf16 v[144:147], a[80:83], a[24:27], v[144:147]
  v_mfma_f32_16x16x32_bf16 v[148:151], a[88:91], a[24:27], v[148:151]
  ds_read_b64_tr_b16 a[128:129], v23 offset:28672
  s_add_u32 m0, s90, 0
  v_mfma_f32_16x16x32_bf16 v[148:151], a[92:95], a[28:31], v[148:151]
  buffer_load_dwordx4 v18, s[8:11], s96 offen  lds
  v_mfma_f32_16x16x32_bf16 v[124:127], a[92:95], a[20:23], v[124:127]
  ds_read_b64_tr_b16 a[130:131], v24 offset:28672
  v_mfma_f32_16x16x32_bf16 v[124:127], a[88:91], a[16:19], v[124:127]
  v_mfma_f32_16x16x32_bf16 v[100:103], a[88:91], a[8:11], v[100:103]
  ds_read_b64_tr_b16 a[132:133], v23 offset:43008
  v_mfma_f32_16x16x32_bf16 v[100:103], a[92:95], a[12:15], v[100:103]
  v_mfma_f32_16x16x32_bf16 v[76:79], a[92:95], a[4:7], v[76:79]
  ds_read_b64_tr_b16 a[134:135], v24 offset:43008
  v_mfma_f32_16x16x32_bf16 v[76:79], a[88:91], a[0:3], v[76:79]
  s_waitcnt lgkmcnt(14)
  v_mfma_f32_16x16x32_bf16 v[80:83], a[0:3], a[96:99], v[80:83]
  s_add_u32 m0, s91, 0
  v_mfma_f32_16x16x32_bf16 v[80:83], a[4:7], a[100:103], v[80:83]
  buffer_load_dwordx4 v19, s[8:11], s94 offen  lds
  v_mfma_f32_16x16x32_bf16 v[104:107], a[12:15], a[100:103], v[104:107]
  v_mfma_f32_16x16x32_bf16 v[104:107], a[8:11], a[96:99], v[104:107]
  v_mfma_f32_16x16x32_bf16 v[128:131], a[16:19], a[96:99], v[128:131]
  v_mfma_f32_16x16x32_bf16 v[128:131], a[20:23], a[100:103], v[128:131]
  v_mfma_f32_16x16x32_bf16 v[152:155], a[28:31], a[100:103], v[152:155]
  v_mfma_f32_16x16x32_bf16 v[152:155], a[24:27], a[96:99], v[152:155]
  v_mfma_f32_16x16x32_bf16 v[156:159], a[24:27], a[104:107], v[156:159]
  s_add_u32 m0, s92, 0
  v_mfma_f32_16x16x32_bf16 v[156:159], a[28:31], a[108:111], v[156:159]
  buffer_load_dwordx4 v19, s[8:11], s95 offen  lds
  v_mfma_f32_16x16x32_bf16 v[132:135], a[20:23], a[108:111], v[132:135]
  v_mfma_f32_16x16x32_bf16 v[132:135], a[16:19], a[104:107], v[132:135]
  v_mfma_f32_16x16x32_bf16 v[108:111], a[8:11], a[104:107], v[108:111]
  v_mfma_f32_16x16x32_bf16 v[108:111], a[12:15], a[108:111], v[108:111]
  v_mfma_f32_16x16x32_bf16 v[84:87], a[4:7], a[108:111], v[84:87]
  v_mfma_f32_16x16x32_bf16 v[84:87], a[0:3], a[104:107], v[84:87]
  s_waitcnt lgkmcnt(12)
  v_mfma_f32_16x16x32_bf16 a[176:179], a[112:115], a[0:3], a[176:179]
  s_add_u32 m0, s93, 0
  v_mfma_f32_16x16x32_bf16 a[176:179], a[116:119], a[4:7], a[176:179]
  buffer_load_dwordx4 v19, s[8:11], s96 offen  lds
  v_mfma_f32_16x16x32_bf16 a[180:183], a[116:119], a[12:15], a[180:183]
  s_add_u32 s8, s8, 393216
  s_addc_u32 s9, s9, 0
  v_mfma_f32_16x16x32_bf16 a[180:183], a[112:115], a[8:11], a[180:183]
  v_mfma_f32_16x16x32_bf16 a[184:187], a[112:115], a[16:19], a[184:187]
  v_mfma_f32_16x16x32_bf16 a[184:187], a[116:119], a[20:23], a[184:187]
  v_mfma_f32_16x16x32_bf16 a[188:191], a[116:119], a[28:31], a[188:191]
  v_mfma_f32_16x16x32_bf16 a[188:191], a[112:115], a[24:27], a[188:191]
  s_mov_b64 exec, 0
  s_cmp_eq_u32 s20, 0
  s_cbranch_scc1 La_pad13
  s_cmp_eq_u32 s20, 1
  s_cbranch_scc1 La_ret2
  s_cmp_eq_u32 s20, 2
  s_cbranch_scc1 La_ret2
  s_branch La_ws
La_ret2:
  s_mov_b64 exec, -1
  s_waitcnt vmcnt(7) lgkmcnt(0)
La_pad1:
  s_cbranch_execz La_ret0
  s_nop 0
  s_barrier
  v_mfma_f32_16x16x32_bf16 v[160:163], a[64:67], a[32:35], v[160:163]
  ds_read_b128 a[0:3], v8 offset:0
  s_add_u32 m0, s84, 34816
  v_mfma_f32_16x16x32_bf16 v[160:163], a[68:71], a[36:39], v[160:163]
  buffer_load_dwordx4 v16, s[4:7], s80 offen offset:0  lds
  v_mfma_f32_16x16x32_bf16 v[184:187], a[68:71], a[44:47], v[184:187]
  ds_read_b128 a[4:7], v9 offset:0
  v_mfma_f32_16x16x32_bf16 v[184:187], a[64:67], a[40:43], v[184:187]
  ds_read_b128 a[16:19], v8 offset:4096
  v_mfma_f32_16x16x32_bf16 v[208:211], a[64:67], a[48:51], v[208:211]
  ds_read_b128 a[8:11], v8 offset:2048
  v_mfma_f32_16x16x32_bf16 v[208:211], a[68:71], a[52:55], v[208:211]
  buffer_load_dwordx4 v16, s[4:7], s80 offen offset:2048  lds
  v_mfma_f32_16x16x32_bf16 v[232:235], a[68:71], a[60:63], v[232:235]
  ds_read_b128 a[12:15], v9 offset:2048
  v_mfma_f32_16x16x32_bf16 v[232:235], a[64:67], a[56:59], v[232:235]
  ds_read_b128 a[20:23], v9 offset:4096
  v_mfma_f32_16x16x32_bf16 v[236:239], a[72:75], a[56:59], v[236:239]
  ds_read_b64_tr_b16 a[64:65], v13 offset:0
  v_mfma_f32_16x16x32_bf16 v[236:239], a[76:79], a[60:63], v[236:239]
  v_mfma_f32_16x16x32_bf16 v[212:215], a[76:79], a[52:55], v[212:215]
  ds_read_b64_tr_b16 a[66:67], v13 offset:512
  v_mfma_f32_16x16x32_bf16 v[212:215], a[72:75], a[48:51], v[212:215]
  ds_read_b128 a[24:27], v8 offset:6144
  v_mfma_f32_16x16x32_bf16 v[188:191], a[72:75], a[40:43], v[188:191]
  ds_read_b64_tr_b16 a[68:69], v13 offset:14336
  s_add_u32 m0, s85, 34816
  v_mfma_f32_16x16x32_bf16 v[188:191], a[76:79], a[44:47], v[188:191]
  buffer_load_dwordx4 v16, s[4:7], s81 offen offset:0  lds
  v_mfma_f32_16x16x32_bf16 v[164:167], a[76:79], a[36:39], v[164:167]
  ds_read_b64_tr_b16 a[70:71], v13 offset:14848
  v_mfma_f32_16x16x32_bf16 v[164:167], a[72:75], a[32:35], v[164:167]
  ds_read_b128 a[28:31], v9 offset:6144
  v_mfma_f32_16x16x32_bf16 v[168:171], a[80:83], a[32:35], v[168:171]
  ds_read_b64_tr_b16 a[72:73], v14 offset:0
  v_mfma_f32_16x16x32_bf16 v[168:171], a[84:87], a[36:39], v[168:171]
  v_mfma_f32_16x16x32_bf16 v[192:195], a[84:87], a[44:47], v[192:195]
  ds_read_b64_tr_b16 a[74:75], v14 offset:512
  v_mfma_f32_16x16x32_bf16 v[192:195], a[80:83], a[40:43], v[192:195]
  v_mfma_f32_16x16x32_bf16 v[216:219], a[80:83], a[48:51], v[216:219]
  ds_read_b64_tr_b16 a[76:77], v14 offset:14336
  v_mfma_f32_16x16x32_bf16 v[216:219], a[84:87], a[52:55], v[216:219]
  buffer_load_dwordx4 v16, s[4:7], s81 offen offset:2048  lds
  v_mfma_f32_16x16x32_bf16 v[240:243], a[84:87], a[60:63], v[240:243]
  ds_read_b64_tr_b16 a[78:79], v14 offset:14848
  v_mfma_f32_16x16x32_bf16 v[240:243], a[80:83], a[56:59], v[240:243]
  v_mfma_f32_16x16x32_bf16 v[244:247], a[88:91], a[56:59], v[244:247]
  ds_read_b64_tr_b16 a[80:81], v13 offset:1024
  v_mfma_f32_16x16x32_bf16 v[244:247], a[92:95], a[60:63], v[244:247]
  v_mfma_f32_16x16x32_bf16 v[220:223], a[92:95], a[52:55], v[220:223]
  ds_read_b64_tr_b16 a[82:83], v13 offset:1536
  v_mfma_f32_16x16x32_bf16 v[220:223], a[88:91], a[48:51], v[220:223]
  v_mfma_f32_16x16x32_bf16 v[196:199], a[88:91], a[40:43], v[196:199]
  ds_read_b64_tr_b16 a[84:85], v13 offset:15360
  s_add_u32 m0, s86, 34816
  v_mfma_f32_16x16x32_bf16 v[196:199], a[92:95], a[44:47], v[196:199]
  buffer_load_dwordx4 v16, s[4:7], s82 offen offset:0  lds
  v_mfma_f32_16x16x32_bf16 v[172:175], a[92:95], a[36:39], v[172:175]
  ds_read_b64_tr_b16 a[86:87], v13 offset:15872
  v_mfma_f32_16x16x32_bf16 v[172:175], a[88:91], a[32:35], v[172:175]
  v_mfma_f32_16x16x32_bf16 v[176:179], a[32:35], a[96:99], v[176:179]
  ds_read_b64_tr_b16 a[88:89], v14 offset:1024
  v_mfma_f32_16x16x32_bf16 v[176:179], a[36:39], a[100:103], v[176:179]
  buffer_load_dwordx4 v16, s[4:7], s82 offen offset:2048  lds
  v_mfma_f32_16x16x32_bf16 v[200:203], a[44:47], a[100:103], v[200:203]
  ds_read_b64_tr_b16 a[90:91], v14 offset:1536
  v_mfma_f32_16x16x32_bf16 v[200:203], a[40:43], a[96:99], v[200:203]
  v_mfma_f32_16x16x32_bf16 v[224:227], a[48:51], a[96:99], v[224:227]
  ds_read_b64_tr_b16 a[92:93], v14 offset:15360
  v_mfma_f32_16x16x32_bf16 v[224:227], a[52:55], a[100:103], v[224:227]
  v_mfma_f32_16x16x32_bf16 v[248:251], a[60:63], a[100:103], v[248:251]
  ds_read_b64_tr_b16 a[94:95], v14 offset:15872
  v_mfma_f32_16x16x32_bf16 v[248:251], a[56:59], a[96:99], v[248:251]
  v_mfma_f32_16x16x32_bf16 v[252:255], a[56:59], a[104:107], v[252:255]
  ds_read_b64_tr_b16 a[96:97], v13 offset:2048
  s_add_u32 m0, s87, 34816
  v_mfma_f32_16x16x32_bf16 v[252:255], a[60:63], a[108:111], v[252:255]
  buffer_load_dwordx4 v16, s[4:7], s83 offen offset:0  lds
  v_mfma_f32_16x16x32_bf16 v[228:231], a[52:55], a[108:111], v[228:231]
  ds_read_b64_tr_b16 a[98:99], v13 offset:2560
  v_mfma_f32_16x16x32_bf16 v[228:231], a[48:51], a[104:107], v[228:231]
  v_mfma_f32_16x16x32_bf16 v[204:207], a[40:43], a[104:107], v[204:207]
  ds_read_b64_tr_b16 a[100:101], v13 offset:16384
  v_mfma_f32_16x16x32_bf16 v[204:207], a[44:47], a[108:111], v[204:207]
  v_mfma_f32_16x16x32_bf16 v[180:183], a[36:39], a[108:111], v[180:183]
  ds_read_b64_tr_b16 a[102:103], v13 offset:16896
  v_mfma_f32_16x16x32_bf16 v[180:183], a[32:35], a[104:107], v[180:183]
  v_mfma_f32_16x16x32_bf16 a[192:195], a[112:115], a[32:35], a[192:195]
  ds_read_b64_tr_b16 a[104:105], v14 offset:2048
  v_mfma_f32_16x16x32_bf16 a[192:195], a[116:119], a[36:39], a[192:195]
  buffer_load_dwordx4 v16, s[4:7], s83 offen offset:2048  lds
  v_mfma_f32_16x16x32_bf16 a[196:199], a[116:119], a[44:47], a[196:199]
  ds_read_b64_tr_b16 a[106:107], v14 offset:2560
  s_add_u32 s4, s4, 128
  s_addc_u32 s5, s5, 0
  v_mfma_f32_16x16x32_bf16 a[196:199], a[112:115], a[40:43], a[196:199]
  v_mfma_f32_16x16x32_bf16 a[200:203], a[112:115], a[48:51], a[200:203]
  ds_read_b64_tr_b16 a[108:109], v14 offset:16384
  v_mfma_f32_16x16x32_bf16 a[200:203], a[116:119], a[52:55], a[200:203]
  v_mfma_f32_16x16x32_bf16 a[204:207], a[116:119], a[60:63], a[204:207]
  ds_read_b64_tr_b16 a[110:111], v14 offset:16896
  v_mfma_f32_16x16x32_bf16 a[204:207], a[112:115], a[56:59], a[204:207]
  v_mfma_f32_16x16x32_bf16 v[36:39], a[136:139], a[128:131], v[36:39]
  v_mfma_f32_16x16x32_bf16 v[36:39], a[136:139], a[132:135], v[36:39]
  s_waitcnt lgkmcnt(14)
  v_mfma_f32_16x16x32_bf16 v[64:67], a[64:67], a[0:3], v[64:67]
  ds_read_b64_tr_b16 a[112:113], v15 offset:0
  s_add_u32 m0, s88, 28672
  v_mfma_f32_16x16x32_bf16 v[64:67], a[68:71], a[4:7], v[64:67]
  buffer_load_dwordx4 v18, s[8:11], s94 offen  lds
  v_mfma_f32_16x16x32_bf16 v[88:91], a[68:71], a[12:15], v[88:91]
  ds_read_b64_tr_b16 a[114:115], v15 offset:256
  v_mfma_f32_16x16x32_bf16 v[88:91], a[64:67], a[8:11], v[88:91]
  v_mfma_f32_16x16x32_bf16 v[112:115], a[64:67], a[16:19], v[112:115]
  ds_read_b64_tr_b16 a[116:117], v15 offset:14336
  s_add_u32 m0, s89, 28672
  v_mfma_f32_16x16x32_bf16 v[112:115], a[68:71], a[20:23], v[112:115]
  buffer_load_dwordx4 v18, s[8:11], s95 offen  lds
  v_mfma_f32_16x16x32_bf16 v[136:139], a[68:71], a[28:31], v[136:139]
  ds_read_b64_tr_b16 a[118:119], v15 offset:14592
  v_mfma_f32_16x16x32_bf16 v[136:139], a[64:67], a[24:27], v[136:139]
  v_mfma_f32_16x16x32_bf16 v[140:143], a[72:75], a[24:27], v[140:143]
  ds_read_b128 a[32:35], v8 offset:8192
  s_add_u32 m0, s90, 28672
  v_mfma_f32_16x16x32_bf16 v[140:143], a[76:79], a[28:31], v[140:143]
  buffer_load_dwordx4 v18, s[8:11], s96 offen  lds
  v_mfma_f32_16x16x32_bf16 v[116:119], a[76:79], a[20:23], v[116:119]
  ds_read_b128 a[36:39], v9 offset:8192
  v_mfma_f32_16x16x32_bf16 v[116:119], a[72:75], a[16:19], v[116:119]
  v_mfma_f32_16x16x32_bf16 v[92:95], a[72:75], a[8:11], v[92:95]
  ds_read_b128 a[40:43], v8 offset:10240
  s_add_u32 m0, s91, 28672
  v_mfma_f32_16x16x32_bf16 v[92:95], a[76:79], a[12:15], v[92:95]
  buffer_load_dwordx4 v19, s[8:11], s94 offen  lds
  v_mfma_f32_16x16x32_bf16 v[68:71], a[76:79], a[4:7], v[68:71]
  ds_read_b128 a[44:47], v9 offset:10240
  v_mfma_f32_16x16x32_bf16 v[68:71], a[72:75], a[0:3], v[68:71]
  s_waitcnt lgkmcnt(14)
  v_mfma_f32_16x16x32_bf16 v[72:75], a[80:83], a[0:3], v[72:75]
  ds_read_b128 a[48:51], v8 offset:12288
  v_mfma_f32_16x16x32_bf16 v[72:75], a[84:87], a[4:7], v[72:75]
  v_mfma_f32_16x16x32_bf16 v[96:99], a[84:87], a[12:15], v[96:99]
  ds_read_b128 a[52:55], v9 offset:12288
  v_mfma_f32_16x16x32_bf16 v[96:99], a[80:83], a[8:11], v[96:99]
  v_mfma_f32_16x16x32_bf16 v[120:123], a[80:83], a[16:19], v[120:123]
  ds_read_b128 a[56:59], v8 offset:14336
  s_add_u32 m0, s92, 28672
  v_mfma_f32_16x16x32_bf16 v[120:123], a[84:87], a[20:23], v[120:123]
  buffer_load_dwordx4 v19, s[8:11], s95 offen  lds
  v_mfma_f32_16x16x32_bf16 v[144:147], a[84:87], a[28:31], v[144:147]
  ds_read_b128 a[60:63], v9 offset:14336
  v_mfma_f32_16x16x32_bf16 v[144:147], a[80:83], a[24:27], v[144:147]
  v_mfma_f32_16x16x32_bf16 v[148:151], a[88:91], a[24:27], v[148:151]
  ds_read_b64_tr_b16 a[128:129], v25 offset:0
  s_add_u32 m0, s93, 28672
  v_mfma_f32_16x16x32_bf16 v[148:151], a[92:95], a[28:31], v[148:151]
  buffer_load_dwordx4 v19, s[8:11], s96 offen  lds
  v_mfma_f32_16x16x32_bf16 v[124:127], a[92:95], a[20:23], v[124:127]
  ds_read_b64_tr_b16 a[130:131], v26 offset:0
  s_add_u32 s8, s8, 393216
  s_addc_u32 s9, s9, 0
  v_mfma_f32_16x16x32_bf16 v[124:127], a[88:91], a[16:19], v[124:127]
  v_mfma_f32_16x16x32_bf16 v[100:103], a[88:91], a[8:11], v[100:103]
  ds_read_b64_tr_b16 a[132:133], v25 offset:14336
  s_add_u32 m0, s27, 34816
  v_mfma_f32_16x16x32_bf16 v[100:103], a[92:95], a[12:15], v[100:103]
  buffer_load_dwordx4 v20, s[68:71], 0 offen  lds
  v_mfma_f32_16x16x32_bf16 v[76:79], a[92:95], a[4:7], v[76:79]
  ds_read_b64_tr_b16 a[134:135], v26 offset:14336
  s_add_u32 s68, s68, 458752
  s_addc_u32 s69, s69, 0
  v_mfma_f32_16x16x32_bf16 v[76:79], a[88:91], a[0:3], v[76:79]
  s_waitcnt lgkmcnt(14)
  v_mfma_f32_16x16x32_bf16 v[80:83], a[0:3], a[96:99], v[80:83]
  v_mfma_f32_16x16x32_bf16 v[80:83], a[4:7], a[100:103], v[80:83]
  buffer_load_dwordx4 a[144:147], v27, s[60:63], 0 offen offset:0
  v_mfma_f32_16x16x32_bf16 v[104:107], a[12:15], a[100:103], v[104:107]
  v_mfma_f32_16x16x32_bf16 v[104:107], a[8:11], a[96:99], v[104:107]
  v_mfma_f32_16x16x32_bf16 v[128:131], a[16:19], a[96:99], v[128:131]
  v_mfma_f32_16x16x32_bf16 v[128:131], a[20:23], a[100:103], v[128:131]
  v_mfma_f32_16x16x32_bf16 v[152:155], a[28:31], a[100:103], v[152:155]
  v_mfma_f32_16x16x32_bf16 v[152:155], a[24:27], a[96:99], v[152:155]
  v_mfma_f32_16x16x32_bf16 v[156:159], a[24:27], a[104:107], v[156:159]
  v_mfma_f32_16x16x32_bf16 v[156:159], a[28:31], a[108:111], v[156:159]
  buffer_load_dwordx4 a[148:151], v27, s[60:63], 0 offen offset:512
  v_mfma_f32_16x16x32_bf16 v[132:135], a[20:23], a[108:111], v[132:135]
  v_mfma_f32_16x16x32_bf16 v[132:135], a[16:19], a[104:107], v[132:135]
  v_mfma_f32_16x16x32_bf16 v[108:111], a[8:11], a[104:107], v[108:111]
  v_mfma_f32_16x16x32_bf16 v[108:111], a[12:15], a[108:111], v[108:111]
  buffer_load_dwordx4 a[152:155], v27, s[60:63], 0 offen offset:1024
  v_mfma_f32_16x16x32_bf16 v[84:87], a[4:7], a[108:111], v[84:87]
  v_mfma_f32_16x16x32_bf16 v[84:87], a[0:3], a[104:107], v[84:87]
  s_waitcnt lgkmcnt(12)
  v_mfma_f32_16x16x32_bf16 a[176:179], a[112:115], a[0:3], a[176:179]
  v_mfma_f32_16x16x32_bf16 a[176:179], a[116:119], a[4:7], a[176:179]
  buffer_load_dwordx4 a[156:159], v27, s[60:63], 0 offen offset:1536
  v_mfma_f32_16x16x32_bf16 a[180:183], a[116:119], a[12:15], a[180:183]
  v_mfma_f32_16x16x32_bf16 a[180:183], a[112:115], a[8:11], a[180:183]
  v_mfma_f32_16x16x32_bf16 a[184:187], a[112:115], a[16:19], a[184:187]
  v_mfma_f32_16x16x32_bf16 a[184:187], a[116:119], a[20:23], a[184:187]
  v_mfma_f32_16x16x32_bf16 a[188:191], a[116:119], a[28:31], a[188:191]
  v_mfma_f32_16x16x32_bf16 a[188:191], a[112:115], a[24:27], a[188:191]
  s_waitcnt vmcnt(11) lgkmcnt(0)
  s_barrier
  v_mfma_f32_16x16x32_bf16 v[160:163], a[64:67], a[32:35], v[160:163]
  ds_read_b128 a[0:3], v8 offset:34816
  s_add_u32 m0, s84, 0
  v_mfma_f32_16x16x32_bf16 v[160:163], a[68:71], a[36:39], v[160:163]
  buffer_load_dwordx4 v16, s[4:7], s80 offen offset:0  lds
  v_mfma_f32_16x16x32_bf16 v[184:187], a[68:71], a[44:47], v[184:187]
  ds_read_b128 a[4:7], v9 offset:34816
  v_mfma_f32_16x16x32_bf16 v[184:187], a[64:67], a[40:43], v[184:187]
  ds_read_b128 a[16:19], v8 offset:38912
  v_mfma_f32_16x16x32_bf16 v[208:211], a[64:67], a[48:51], v[208:211]
  ds_read_b128 a[8:11], v8 offset:36864
  v_mfma_f32_16x16x32_bf16 v[208:211], a[68:71], a[52:55], v[208:211]
  buffer_load_dwordx4 v16, s[4:7], s80 offen offset:2048  lds
  v_mfma_f32_16x16x32_bf16 v[232:235], a[68:71], a[60:63], v[232:235]
  ds_read_b128 a[12:15], v9 offset:36864
  v_mfma_f32_16x16x32_bf16 v[232:235], a[64:67], a[56:59], v[232:235]
  ds_read_b128 a[20:23], v9 offset:38912
  v_mfma_f32_16x16x32_bf16 v[236:239], a[72:75], a[56:59], v[236:239]
  ds_read_b64_tr_b16 a[64:65], v10 offset:0
  v_mfma_f32_16x16x32_bf16 v[236:239], a[76:79], a[60:63], v[236:239]
  v_mfma_f32_16x16x32_bf16 v[212:215], a[76:79], a[52:55], v[212:215]
  ds_read_b64_tr_b16 a[66:67], v10 offset:512
  v_mfma_f32_16x16x32_bf16 v[212:215], a[72:75], a[48:51], v[212:215]
  ds_read_b128 a[24:27], v8 offset:40960
  v_mfma_f32_16x16x32_bf16 v[188:191], a[72:75], a[40:43], v[188:191]
  ds_read_b64_tr_b16 a[68:69], v10 offset:14336
  s_add_u32 m0, s85, 0
  v_mfma_f32_16x16x32_bf16 v[188:191], a[76:79], a[44:47], v[188:191]
  buffer_load_dwordx4 v16, s[4:7], s81 offen offset:0  lds
  v_mfma_f32_16x16x32_bf16 v[164:167], a[76:79], a[36:39], v[164:167]
  ds_read_b64_tr_b16 a[70:71], v10 offset:14848
  v_mfma_f32_16x16x32_bf16 v[164:167], a[72:75], a[32:35], v[164:167]
  ds_read_b128 a[28:31], v9 offset:40960
  v_mfma_f32_16x16x32_bf16 v[168:171], a[80:83], a[32:35], v[168:171]
  ds_read_b64_tr_b16 a[72:73], v11 offset:0
  v_mfma_f32_16x16x32_bf16 v[168:171], a[84:87], a[36:39], v[168:171]
  v_mfma_f32_16x16x32_bf16 v[192:195], a[84:87], a[44:47], v[192:195]
  ds_read_b64_tr_b16 a[74:75], v11 offset:512
  v_mfma_f32_16x16x32_bf16 v[192:195], a[80:83], a[40:43], v[192:195]
  v_mfma_f32_16x16x32_bf16 v[216:219], a[80:83], a[48:51], v[216:219]
  ds_read_b64_tr_b16 a[76:77], v11 offset:14336
  v_mfma_f32_16x16x32_bf16 v[216:219], a[84:87], a[52:55], v[216:219]
  buffer_load_dwordx4 v16, s[4:7], s81 offen offset:2048  lds
  v_mfma_f32_16x16x32_bf16 v[240:243], a[84:87], a[60:63], v[240:243]
  ds_read_b64_tr_b16 a[78:79], v11 offset:14848
  v_mfma_f32_16x16x32_bf16 v[240:243], a[80:83], a[56:59], v[240:243]
  v_mfma_f32_16x16x32_bf16 v[244:247], a[88:91], a[56:59], v[244:247]
  ds_read_b64_tr_b16 a[80:81], v10 offset:1024
  v_mfma_f32_16x16x32_bf16 v[244:247], a[92:95], a[60:63], v[244:247]
  v_mfma_f32_16x16x32_bf16 v[220:223], a[92:95], a[52:55], v[220:223]
  ds_read_b64_tr_b16 a[82:83], v10 offset:1536
  v_mfma_f32_16x16x32_bf16 v[220:223], a[88:91], a[48:51], v[220:223]
  v_mfma_f32_16x16x32_bf16 v[196:199], a[88:91], a[40:43], v[196:199]
  ds_read_b64_tr_b16 a[84:85], v10 offset:15360
  s_add_u32 m0, s86, 0
  v_mfma_f32_16x16x32_bf16 v[196:199], a[92:95], a[44:47], v[196:199]
  buffer_load_dwordx4 v16, s[4:7], s82 offen offset:0  lds
  v_mfma_f32_16x16x32_bf16 v[172:175], a[92:95], a[36:39], v[172:175]
  ds_read_b64_tr_b16 a[86:87], v10 offset:15872
  v_mfma_f32_16x16x32_bf16 v[172:175], a[88:91], a[32:35], v[172:175]
  v_mfma_f32_16x16x32_bf16 v[176:179], a[32:35], a[96:99], v[176:179]
  ds_read_b64_tr_b16 a[88:89], v11 offset:1024
  v_mfma_f32_16x16x32_bf16 v[176:179], a[36:39], a[100:103], v[176:179]
  buffer_load_dwordx4 v16, s[4:7], s82 offen offset:2048  lds
  v_mfma_f32_16x16x32_bf16 v[200:203], a[44:47], a[100:103], v[200:203]
  ds_read_b64_tr_b16 a[90:91], v11 offset:1536
  v_mfma_f32_16x16x32_bf16 v[200:203], a[40:43], a[96:99], v[200:203]
  v_mfma_f32_16x16x32_bf16 v[224:227], a[48:51], a[96:99], v[224:227]
  ds_read_b64_tr_b16 a[92:93], v11 offset:15360
  v_mfma_f32_16x16x32_bf16 v[224:227], a[52:55], a[100:103], v[224:227]
  v_mfma_f32_16x16x32_bf16 v[248:251], a[60:63], a[100:103], v[248:251]
  ds_read_b64_tr_b16 a[94:95], v11 offset:15872
  v_mfma_f32_16x16x32_bf16 v[248:251], a[56:59], a[96:99], v[248:251]
  v_mfma_f32_16x16x32_bf16 v[252:255], a[56:59], a[104:107], v[252:255]
  ds_read_b64_tr_b16 a[96:97], v10 offset:2048
  s_add_u32 m0, s87, 0
  v_mfma_f32_16x16x32_bf16 v[252:255], a[60:63], a[108:111], v[252:255]
  buffer_load_dwordx4 v16, s[4:7], s83 offen offset:0  lds
  v_mfma_f32_16x16x32_bf16 v[228:231], a[52:55], a[108:111], v[228:231]
  ds_read_b64_tr_b16 a[98:99], v10 offset:2560
  v_mfma_f32_16x16x32_bf16 v[228:231], a[48:51], a[104:107], v[228:231]
  v_mfma_f32_16x16x32_bf16 v[204:207], a[40:43], a[104:107], v[204:207]
  ds_read_b64_tr_b16 a[100:101], v10 offset:16384
  v_mfma_f32_16x16x32_bf16 v[204:207], a[44:47], a[108:111], v[204:207]
  v_mfma_f32_16x16x32_bf16 v[180:183], a[36:39], a[108:111], v[180:183]
  ds_read_b64_tr_b16 a[102:103], v10 offset:16896
  v_mfma_f32_16x16x32_bf16 v[180:183], a[32:35], a[104:107], v[180:183]
  v_mfma_f32_16x16x32_bf16 a[192:195], a[112:115], a[32:35], a[192:195]
  ds_read_b64_tr_b16 a[104:105], v11 offset:2048
  v_mfma_f32_16x16x32_bf16 a[192:195], a[116:119], a[36:39], a[192:195]
  buffer_load_dwordx4 v16, s[4:7], s83 offen offset:2048  lds
  v_mfma_f32_16x16x32_bf16 a[196:199], a[116:119], a[44:47], a[196:199]
  ds_read_b64_tr_b16 a[106:107], v11 offset:2560
  s_add_u32 s4, s4, 128
  s_addc_u32 s5, s5, 0
  v_mfma_f32_16x16x32_bf16 a[196:199], a[112:115], a[40:43], a[196:199]
  v_mfma_f32_16x16x32_bf16 a[200:203], a[112:115], a[48:51], a[200:203]
  ds_read_b64_tr_b16 a[108:109], v11 offset:16384
  v_mfma_f32_16x16x32_bf16 a[200:203], a[116:119], a[52:55], a[200:203]
  v_mfma_f32_16x16x32_bf16 a[204:207], a[116:119], a[60:63], a[204:207]
  ds_read_b64_tr_b16 a[110:111], v11 offset:16896
  v_mfma_f32_16x16x32_bf16 a[204:207], a[112:115], a[56:59], a[204:207]
  v_mfma_f32_16x16x32_bf16 v[36:39], a[136:139], a[128:131], v[36:39]
  v_mfma_f32_16x16x32_bf16 v[36:39], a[136:139], a[132:135], v[36:39]
  s_waitcnt lgkmcnt(14)
  v_mfma_f32_16x16x32_bf16 v[64:67], a[64:67], a[0:3], v[64:67]
  ds_read_b64_tr_b16 a[112:113], v12 offset:0
  s_add_u32 m0, s88, 57344
  v_mfma_f32_16x16x32_bf16 v[64:67], a[68:71], a[4:7], v[64:67]
  buffer_load_dwordx4 v18, s[8:11], s94 offen  lds
  v_mfma_f32_16x16x32_bf16 v[88:91], a[68:71], a[12:15], v[88:91]
  ds_read_b64_tr_b16 a[114:115], v12 offset:256
  v_mfma_f32_16x16x32_bf16 v[88:91], a[64:67], a[8:11], v[88:91]
  v_mfma_f32_16x16x32_bf16 v[112:115], a[64:67], a[16:19], v[112:115]
  ds_read_b64_tr_b16 a[116:117], v12 offset:14336
  v_mfma_f32_16x16x32_bf16 v[112:115], a[68:71], a[20:23], v[112:115]
  v_mfma_f32_16x16x32_bf16 v[136:139], a[68:71], a[28:31], v[136:139]
  ds_read_b64_tr_b16 a[118:119], v12 offset:14592
  v_mfma_f32_16x16x32_bf16 v[136:139], a[64:67], a[24:27], v[136:139]
  v_mfma_f32_16x16x32_bf16 v[140:143], a[72:75], a[24:27], v[140:143]
  ds_read_b128 a[32:35], v8 offset:43008
  s_add_u32 m0, s89, 57344
  v_mfma_f32_16x16x32_bf16 v[140:143], a[76:79], a[28:31], v[140:143]
  buffer_load_dwordx4 v18, s[8:11], s95 offen  lds
  v_mfma_f32_16x16x32_bf16 v[116:119], a[76:79], a[20:23], v[116:119]
  ds_read_b128 a[36:39], v9 offset:43008
  v_mfma_f32_16x16x32_bf16 v[116:119], a[72:75], a[16:19], v[116:119]
  v_mfma_f32_16x16x32_bf16 v[92:95], a[72:75], a[8:11], v[92:95]
  ds_read_b128 a[40:43], v8 offset:45056
  v_mfma_f32_16x16x32_bf16 v[92:95], a[76:79], a[12:15], v[92:95]
  v_mfma_f32_16x16x32_bf16 v[68:71], a[76:79], a[4:7], v[68:71]
  ds_read_b128 a[44:47], v9 offset:45056
  v_mfma_f32_16x16x32_bf16 v[68:71], a[72:75], a[0:3], v[68:71]
  s_waitcnt lgkmcnt(14)
  v_mfma_f32_16x16x32_bf16 v[72:75], a[80:83], a[0:3], v[72:75]
  ds_read_b128 a[48:51], v8 offset:47104
  s_add_u32 m0, s90, 57344
  v_mfma_f32_16x16x32_bf16 v[72:75], a[84:87], a[4:7], v[72:75]
  buffer_load_dwordx4 v18, s[8:11], s96 offen  lds
  v_mfma_f32_16x16x32_bf16 v[96:99], a[84:87], a[12:15], v[96:99]
  ds_read_b128 a[52:55], v9 offset:47104
  v_mfma_f32_16x16x32_bf16 v[96:99], a[80:83], a[8:11], v[96:99]
  v_mfma_f32_16x16x32_bf16 v[120:123], a[80:83], a[16:19], v[120:123]
  ds_read_b128 a[56:59], v8 offset:49152
  v_mfma_f32_16x16x32_bf16 v[120:123], a[84:87], a[20:23], v[120:123]
  v_mfma_f32_16x16x32_bf16 v[144:147], a[84:87], a[28:31], v[144:147]
  ds_read_b128 a[60:63], v9 offset:49152
  v_mfma_f32_16x16x32_bf16 v[144:147], a[80:83], a[24:27], v[144:147]
  v_mfma_f32_16x16x32_bf16 v[148:151], a[88:91], a[24:27], v[148:151]
  ds_read_b64_tr_b16 a[128:129], v23 offset:0
  s_add_u32 m0, s91, 57344
  v_mfma_f32_16x16x32_bf16 v[148:151], a[92:95], a[28:31], v[148:151]
  buffer_load_dwordx4 v19, s[8:11], s94 offen  lds
  v_mfma_f32_16x16x32_bf16 v[124:127], a[92:95], a[20:23], v[124:127]
  ds_read_b64_tr_b16 a[130:131], v24 offset:0
  v_mfma_f32_16x16x32_bf16 v[124:127], a[88:91], a[16:19], v[124:127]
  v_mfma_f32_16x16x32_bf16 v[100:103], a[88:91], a[8:11], v[100:103]
  ds_read_b64_tr_b16 a[132:133], v23 offset:14336
  v_mfma_f32_16x16x32_bf16 v[100:103], a[92:95], a[12:15], v[100:103]
  v_mfma_f32_16x16x32_bf16 v[76:79], a[92:95], a[4:7], v[76:79]
  ds_read_b64_tr_b16 a[134:135], v24 offset:14336
  v_mfma_f32_16x16x32_bf16 v[76:79], a[88:91], a[0:3], v[76:79]
  s_waitcnt lgkmcnt(14)
  v_mfma_f32_16x16x32_bf16 v[80:83], a[0:3], a[96:99], v[80:83]
  s_add_u32 m0, s92, 57344
  v_mfma_f32_16x16x32_bf16 v[80:83], a[4:7], a[100:103], v[80:83]
  buffer_load_dwordx4 v19, s[8:11], s95 offen  lds
  v_mfma_f32_16x16x32_bf16 v[104:107], a[12:15], a[100:103], v[104:107]
  v_mfma_f32_16x16x32_bf16 v[104:107], a[8:11], a[96:99], v[104:107]
  v_mfma_f32_16x16x32_bf16 v[128:131], a[16:19], a[96:99], v[128:131]
  v_mfma_f32_16x16x32_bf16 v[128:131], a[20:23], a[100:103], v[128:131]
  v_mfma_f32_16x16x32_bf16 v[152:155], a[28:31], a[100:103], v[152:155]
  v_mfma_f32_16x16x32_bf16 v[152:155], a[24:27], a[96:99], v[152:155]
  v_mfma_f32_16x16x32_bf16 v[156:159], a[24:27], a[104:107], v[156:159]
  s_add_u32 m0, s93, 57344
  v_mfma_f32_16x16x32_bf16 v[156:159], a[28:31], a[108:111], v[156:159]
  buffer_load_dwordx4 v19, s[8:11], s96 offen  lds
  v_mfma_f32_16x16x32_bf16 v[132:135], a[20:23], a[108:111], v[132:135]
  s_add_u32 s8, s8, 393216
  s_addc_u32 s9, s9, 0
  v_mfma_f32_16x16x32_bf16 v[132:135], a[16:19], a[104:107], v[132:135]
  v_mfma_f32_16x16x32_bf16 v[108:111], a[8:11], a[104:107], v[108:111]
  v_mfma_f32_16x16x32_bf16 v[108:111], a[12:15], a[108:111], v[108:111]
  v_mfma_f32_16x16x32_bf16 v[84:87], a[4:7], a[108:111], v[84:87]
  v_mfma_f32_16x16x32_bf16 v[84:87], a[0:3], a[104:107], v[84:87]
  s_waitcnt lgkmcnt(12)
  v_mfma_f32_16x16x32_bf16 a[176:179], a[112:115], a[0:3], a[176:179]
  s_add_u32 m0, s27, 63488
  v_mfma_f32_16x16x32_bf16 a[176:179], a[116:119], a[4:7], a[176:179]
  buffer_load_dwordx4 v20, s[68:71], 0 offen  lds
  v_mfma_f32_16x16x32_bf16 a[180:183], a[116:119], a[12:15], a[180:183]
  s_add_u32 s68, s68, 458752
  s_addc_u32 s69, s69, 0
  v_mfma_f32_16x16x32_bf16 a[180:183], a[112:115], a[8:11], a[180:183]
  v_mfma_f32_16x16x32_bf16 a[184:187], a[112:115], a[16:19], a[184:187]
  v_mfma_f32_16x16x32_bf16 a[184:187], a[116:119], a[20:23], a[184:187]
  v_mfma_f32_16x16x32_bf16 a[188:191], a[116:119], a[28:31], a[188:191]
  v_mfma_f32_16x16x32_bf16 a[188:191], a[112:115], a[24:27], a[188:191]
  s_waitcnt vmcnt(7) lgkmcnt(0)
  s_barrier
  v_mfma_f32_16x16x32_bf16 v[160:163], a[64:67], a[32:35], v[160:163]
  ds_read_b128 a[0:3], v8 offset:0
  s_add_u32 m0, s84, 34816
  v_mfma_f32_16x16x32_bf16 v[160:163], a[68:71], a[36:39], v[160:163]
  buffer_load_dwordx4 v16, s[4:7], s80 offen offset:0  lds
  v_mfma_f32_16x16x32_bf16 v[184:187], a[68:71], a[44:47], v[184:187]
  ds_read_b128 a[4:7], v9 offset:0
  v_mfma_f32_16x16x32_bf16 v[184:187], a[64:67], a[40:43], v[184:187]
  ds_read_b128 a[16:19], v8 offset:4096
  v_mfma_f32_16x16x32_bf16 v[208:211], a[64:67], a[48:51], v[208:211]
  ds_read_b128 a[8:11], v8 offset:2048
  v_mfma_f32_16x16x32_bf16 v[208:211], a[68:71], a[52:55], v[208:211]
  buffer_load_dwordx4 v16, s[4:7], s80 offen offset:2048  lds
  v_mfma_f32_16x16x32_bf16 v[232:235], a[68:71], a[60:63], v[232:235]
  ds_read_b128 a[12:15], v9 offset:2048
  v_mfma_f32_16x16x32_bf16 v[232:235], a[64:67], a[56:59], v[232:235]
  ds_read_b128 a[20:23], v9 offset:4096
  v_mfma_f32_16x16x32_bf16 v[236:239], a[72:75], a[56:59], v[236:239]
  ds_read_b64_tr_b16 a[64:65], v10 offset:28672
  v_mfma_f32_16x16x32_bf16 v[236:239], a[76:79], a[60:63], v[236:239]
  v_mfma_f32_16x16x32_bf16 v[212:215], a[76:79], a[52:55], v[212:215]
  ds_read_b64_tr_b16 a[66:67], v10 offset:29184
  v_mfma_f32_16x16x32_bf16 v[212:215], a[72:75], a[48:51], v[212:215]
  ds_read_b128 a[24:27], v8 offset:6144
  v_mfma_f32_16x16x32_bf16 v[188:191], a[72:75], a[40:43], v[188:191]
  ds_read_b64_tr_b16 a[68:69], v10 offset:43008
  s_add_u32 m0, s85, 34816
  v_mfma_f32_16x16x32_bf16 v[188:191], a[76:79], a[44:47], v[188:191]
  buffer_load_dwordx4 v16, s[4:7], s81 offen offset:0  lds
  v_mfma_f32_16x16x32_bf16 v[164:167], a[76:79], a[36:39], v[164:167]
  ds_read_b64_tr_b16 a[70:71], v10 offset:43520
  v_mfma_f32_16x16x32_bf16 v[164:167], a[72:75], a[32:35], v[164:167]
  ds_read_b128 a[28:31], v9 offset:6144
  v_mfma_f32_16x16x32_bf16 v[168:171], a[80:83], a[32:35], v[168:171]
  ds_read_b64_tr_b16 a[72:73], v11 offset:28672
  v_mfma_f32_16x16x32_bf16 v[168:171], a[84:87], a[36:39], v[168:171]
  v_mfma_f32_16x16x32_bf16 v[192:195], a[84:87], a[44:47], v[192:195]
  ds_read_b64_tr_b16 a[74:75], v11 offset:29184
  v_mfma_f32_16x16x32_bf16 v[192:195], a[80:83], a[40:43], v[192:195]
  v_mfma_f32_16x16x32_bf16 v[216:219], a[80:83], a[48:51], v[216:219]
  ds_read_b64_tr_b16 a[76:77], v11 offset:43008
  v_mfma_f32_16x16x32_bf16 v[216:219], a[84:87], a[52:55], v[216:219]
  buffer_load_dwordx4 v16, s[4:7], s81 offen offset:2048  lds
  v_mfma_f32_16x16x32_bf16 v[240:243], a[84:87], a[60:63], v[240:243]
  ds_read_b64_tr_b16 a[78:79], v11 offset:43520
  v_mfma_f32_16x16x32_bf16 v[240:243], a[80:83], a[56:59], v[240:243]
  v_mfma_f32_16x16x32_bf16 v[244:247], a[88:91], a[56:59], v[244:247]
  ds_read_b64_tr_b16 a[80:81], v10 offset:29696
  v_mfma_f32_16x16x32_bf16 v[244:247], a[92:95], a[60:63], v[244:247]
  v_mfma_f32_16x16x32_bf16 v[220:223], a[92:95], a[52:55], v[220:223]
  ds_read_b64_tr_b16 a[82:83], v10 offset:30208
  v_mfma_f32_16x16x32_bf16 v[220:223], a[88:91], a[48:51], v[220:223]
  v_mfma_f32_16x16x32_bf16 v[196:199], a[88:91], a[40:43], v[196:199]
  ds_read_b64_tr_b16 a[84:85], v10 offset:44032
  s_add_u32 m0, s86, 34816
  v_mfma_f32_16x16x32_bf16 v[196:199], a[92:95], a[44:47], v[196:199]
  buffer_load_dwordx4 v16, s[4:7], s82 offen offset:0  lds
  v_mfma_f32_16x16x32_bf16 v[172:175], a[92:95], a[36:39], v[172:175]
  ds_read_b64_tr_b16 a[86:87], v10 offset:44544
  v_mfma_f32_16x16x32_bf16 v[172:175], a[88:91], a[32:35], v[172:175]
  v_mfma_f32_16x16x32_bf16 v[176:179], a[32:35], a[96:99], v[176:179]
  ds_read_b64_tr_b16 a[88:89], v11 offset:29696
  v_mfma_f32_16x16x32_bf16 v[176:179], a[36:39], a[100:103], v[176:179]
  buffer_load_dwordx4 v16, s[4:7], s82 offen offset:2048  lds
  v_mfma_f32_16x16x32_bf16 v[200:203], a[44:47], a[100:103], v[200:203]
  ds_read_b64_tr_b16 a[90:91], v11 offset:30208
  v_mfma_f32_16x16x32_bf16 v[200:203], a[40:43], a[96:99], v[200:203]
  v_mfma_f32_16x16x32_bf16 v[224:227], a[48:51], a[96:99], v[224:227]
  ds_read_b64_tr_b16 a[92:93], v11 offset:44032
  v_mfma_f32_16x16x32_bf16 v[224:227], a[52:55], a[100:103], v[224:227]
  v_mfma_f32_16x16x32_bf16 v[248:251], a[60:63], a[100:103], v[248:251]
  ds_read_b64_tr_b16 a[94:95], v11 offset:44544
  v_mfma_f32_16x16x32_bf16 v[248:251], a[56:59], a[96:99], v[248:251]
  v_mfma_f32_16x16x32_bf16 v[252:255], a[56:59], a[104:107], v[252:255]
  ds_read_b64_tr_b16 a[96:97], v10 offset:30720
  s_add_u32 m0, s87, 34816
  v_mfma_f32_16x16x32_bf16 v[252:255], a[60:63], a[108:111], v[252:255]
  buffer_load_dwordx4 v16, s[4:7], s83 offen offset:0  lds
  v_mfma_f32_16x16x32_bf16 v[228:231], a[52:55], a[108:111], v[228:231]
  ds_read_b64_tr_b16 a[98:99], v10 offset:31232
  v_mfma_f32_16x16x32_bf16 v[228:231], a[48:51], a[104:107], v[228:231]
  v_mfma_f32_16x16x32_bf16 v[204:207], a[40:43], a[104:107], v[204:207]
  ds_read_b64_tr_b16 a[100:101], v10 offset:45056
  v_mfma_f32_16x16x32_bf16 v[204:207], a[44:47], a[108:111], v[204:207]
  v_mfma_f32_16x16x32_bf16 v[180:183], a[36:39], a[108:111], v[180:183]
  ds_read_b64_tr_b16 a[102:103], v10 offset:45568
  v_mfma_f32_16x16x32_bf16 v[180:183], a[32:35], a[104:107], v[180:183]
  v_mfma_f32_16x16x32_bf16 a[192:195], a[112:115], a[32:35], a[192:195]
  ds_read_b64_tr_b16 a[104:105], v11 offset:30720
  v_mfma_f32_16x16x32_bf16 a[192:195], a[116:119], a[36:39], a[192:195]
  buffer_load_dwordx4 v16, s[4:7], s83 offen offset:2048  lds
  v_mfma_f32_16x16x32_bf16 a[196:199], a[116:119], a[44:47], a[196:199]
  ds_read_b64_tr_b16 a[106:107], v11 offset:31232
  s_add_u32 s4, s4, 128
  s_addc_u32 s5, s5, 0
  v_mfma_f32_16x16x32_bf16 a[196:199], a[112:115], a[40:43], a[196:199]
  v_mfma_f32_16x16x32_bf16 a[200:203], a[112:115], a[48:51], a[200:203]
  ds_read_b64_tr_b16 a[108:109], v11 offset:45056
  v_mfma_f32_16x16x32_bf16 a[200:203], a[116:119], a[52:55], a[200:203]
  v_mfma_f32_16x16x32_bf16 a[204:207], a[116:119], a[60:63], a[204:207]
  ds_read_b64_tr_b16 a[110:111], v11 offset:45568
  v_mfma_f32_16x16x32_bf16 a[204:207], a[112:115], a[56:59], a[204:207]
  v_mfma_f32_16x16x32_bf16 v[36:39], a[136:139], a[128:131], v[36:39]
  v_mfma_f32_16x16x32_bf16 v[36:39], a[136:139], a[132:135], v[36:39]
  v_mfma_f32_16x16x32_bf16 v[40:43], a[136:139], a[144:147], 0
  v_mfma_f32_16x16x32_bf16 v[40:43], a[136:139], a[148:151], v[40:43]
  v_mfma_f32_16x16x32_bf16 v[40:43], a[136:139], a[152:155], v[40:43]
  v_mfma_f32_16x16x32_bf16 v[40:43], a[136:139], a[156:159], v[40:43]
  v_mfma_f32_16x16x32_bf16 v[44:47], a[144:147], a[144:147], 0
  v_mfma_f32_16x16x32_bf16 v[44:47], a[148:151], a[148:151], v[44:47]
  v_mfma_f32_16x16x32_bf16 v[44:47], a[152:155], a[152:155], v[44:47]
  v_mfma_f32_16x16x32_bf16 v[44:47], a[156:159], a[156:159], v[44:47]
  s_waitcnt lgkmcnt(14)
  v_mfma_f32_16x16x32_bf16 v[64:67], a[64:67], a[0:3], v[64:67]
  ds_read_b64_tr_b16 a[112:113], v12 offset:28672
  s_add_u32 m0, s88, 0
  v_mfma_f32_16x16x32_bf16 v[64:67], a[68:71], a[4:7], v[64:67]
  buffer_load_dwordx4 v18, s[8:11], s94 offen  lds
  v_mfma_f32_16x16x32_bf16 v[88:91], a[68:71], a[12:15], v[88:91]
La_pad2:
  s_cbranch_execz La_ret0
  s_nop 0
  ds_read_b64_tr_b16 a[114:115], v12 offset:28928
  v_mfma_f32_16x16x32_bf16 v[88:91], a[64:67], a[8:11], v[88:91]
  v_mfma_f32_16x16x32_bf16 v[112:115], a[64:67], a[16:19], v[112:115]
  ds_read_b64_tr_b16 a[116:117], v12 offset:43008
  v_lshlrev_b32 v41, 2, v3
  v_mfma_f32_16x16x32_bf16 v[112:115], a[68:71], a[20:23], v[112:115]
  v_sub_u32 v41, v4, v41
  v_mfma_f32_16x16x32_bf16 v[136:139], a[68:71], a[28:31], v[136:139]
  ds_read_b64_tr_b16 a[118:119], v12 offset:43264
  v_mfma_f32_16x16x32_bf16 v[136:139], a[64:67], a[24:27], v[136:139]
  v_cmp_eq_u32 vcc, 0, v41
  v_mfma_f32_16x16x32_bf16 v[140:143], a[72:75], a[24:27], v[140:143]
  ds_read_b128 a[32:35], v8 offset:8192
  s_add_u32 m0, s89, 0
  v_mfma_f32_16x16x32_bf16 v[140:143], a[76:79], a[28:31], v[140:143]
  v_add_f32_dpp v40, v40, v40 quad_perm:[1,0,3,2] row_mask:0xf bank_mask:0xf
  buffer_load_dwordx4 v18, s[8:11], s95 offen  lds
  v_mfma_f32_16x16x32_bf16 v[116:119], a[76:79], a[20:23], v[116:119]
  ds_read_b128 a[36:39], v9 offset:8192
  v_mfma_f32_16x16x32_bf16 v[116:119], a[72:75], a[16:19], v[116:119]
  v_cndmask_b32_e64 v42, 0, v44, vcc
  v_mfma_f32_16x16x32_bf16 v[92:95], a[72:75], a[8:11], v[92:95]
  ds_read_b128 a[40:43], v8 offset:10240
  v_mfma_f32_16x16x32_bf16 v[92:95], a[76:79], a[12:15], v[92:95]
  v_cmp_eq_u32_e64 vcc, 1, v41
  v_mfma_f32_16x16x32_bf16 v[68:71], a[76:79], a[4:7], v[68:71]
  ds_read_b128 a[44:47], v9 offset:10240
  v_mfma_f32_16x16x32_bf16 v[68:71], a[72:75], a[0:3], v[68:71]
  s_waitcnt lgkmcnt(14)
  v_add_f32_dpp v40, v40, v40 quad_perm:[2,3,0,1] row_mask:0xf bank_mask:0xf
  v_mfma_f32_16x16x32_bf16 v[72:75], a[80:83], a[0:3], v[72:75]
  ds_read_b128 a[48:51], v8 offset:12288
  s_add_u32 m0, s90, 0
  v_mfma_f32_16x16x32_bf16 v[72:75], a[84:87], a[4:7], v[72:75]
  v_cndmask_b32_e64 v42, v42, v45, vcc
  buffer_load_dwordx4 v18, s[8:11], s96 offen  lds
  v_mfma_f32_16x16x32_bf16 v[96:99], a[84:87], a[12:15], v[96:99]
  ds_read_b128 a[52:55], v9 offset:12288
  v_mfma_f32_16x16x32_bf16 v[96:99], a[80:83], a[8:11], v[96:99]
  v_cmp_eq_u32_e64 vcc, 2, v41
  v_mfma_f32_16x16x32_bf16 v[120:123], a[80:83], a[16:19], v[120:123]
  ds_read_b128 a[56:59], v8 offset:14336
  v_mfma_f32_16x16x32_bf16 v[120:123], a[84:87], a[20:23], v[120:123]
  v_add_f32_dpp v40, v40, v40 row_half_mirror row_mask:0xf bank_mask:0xf
  v_mfma_f32_16x16x32_bf16 v[144:147], a[84:87], a[28:31], v[144:147]
  ds_read_b128 a[60:63], v9 offset:14336
  v_mfma_f32_16x16x32_bf16 v[144:147], a[80:83], a[24:27], v[144:147]
  v_cndmask_b32 v42, v42, v46, vcc
  v_mfma_f32_16x16x32_bf16 v[148:151], a[88:91], a[24:27], v[148:151]
  ds_read_b64_tr_b16 a[128:129], v23 offset:28672
  s_add_u32 m0, s91, 0
  v_mfma_f32_16x16x32_bf16 v[148:151], a[92:95], a[28:31], v[148:151]
  v_cmp_eq_u32_e64 vcc, 3, v41
  buffer_load_dwordx4 v19, s[8:11], s94 offen  lds
  v_mfma_f32_16x16x32_bf16 v[124:127], a[92:95], a[20:23], v[124:127]
  ds_read_b64_tr_b16 a[130:131], v24 offset:28672
  v_mfma_f32_16x16x32_bf16 v[124:127], a[88:91], a[16:19], v[124:127]
  v_mul_f32 v40, 0x3a800000, v40
  v_mfma_f32_16x16x32_bf16 v[100:103], a[88:91], a[8:11], v[100:103]
  ds_read_b64_tr_b16 a[132:133], v23 offset:43008
  v_mfma_f32_16x16x32_bf16 v[100:103], a[92:95], a[12:15], v[100:103]
  v_cndmask_b32_e64 v42, v42, v47, vcc
  v_mfma_f32_16x16x32_bf16 v[76:79], a[92:95], a[4:7], v[76:79]
  ds_read_b64_tr_b16 a[134:135], v24 offset:43008
  v_mfma_f32_16x16x32_bf16 v[76:79], a[88:91], a[0:3], v[76:79]
  s_waitcnt lgkmcnt(14)
  v_add_f32_dpp v42, v42, v42 quad_perm:[1,0,3,2] row_mask:0xf bank_mask:0xf
  v_mfma_f32_16x16x32_bf16 v[80:83], a[0:3], a[96:99], v[80:83]
  s_add_u32 m0, s92, 0
  v_mfma_f32_16x16x32_bf16 v[80:83], a[4:7], a[100:103], v[80:83]
  v_mul_f32_e64 v41, v40, v40
  buffer_load_dwordx4 v19, s[8:11], s95 offen  lds
  v_mfma_f32_16x16x32_bf16 v[104:107], a[12:15], a[100:103], v[104:107]
  v_mfma_f32_16x16x32_bf16 v[104:107], a[8:11], a[96:99], v[104:107]
  v_add_f32_dpp v42, v42, v42 quad_perm:[2,3,0,1] row_mask:0xf bank_mask:0xf
  v_mfma_f32_16x16x32_bf16 v[128:131], a[16:19], a[96:99], v[128:131]
  v_mfma_f32_16x16x32_bf16 v[128:131], a[20:23], a[100:103], v[128:131]
  v_cvt_pk_bf16_f32 v40, v40, v40
  v_mfma_f32_16x16x32_bf16 v[152:155], a[28:31], a[100:103], v[152:155]
  v_mfma_f32_16x16x32_bf16 v[152:155], a[24:27], a[96:99], v[152:155]
  v_add_f32_dpp v42, v42, v42 row_half_mirror row_mask:0xf bank_mask:0xf
  v_mfma_f32_16x16x32_bf16 v[156:159], a[24:27], a[104:107], v[156:159]
  s_add_u32 m0, s93, 0
  v_mfma_f32_16x16x32_bf16 v[156:159], a[28:31], a[108:111], v[156:159]
  v_and_b32 v40, 0xffff0000, v40
  buffer_load_dwordx4 v19, s[8:11], s96 offen  lds
  v_mfma_f32_16x16x32_bf16 v[132:135], a[20:23], a[108:111], v[132:135]
  s_add_u32 s8, s8, 393216
  s_addc_u32 s9, s9, 0
  v_mfma_f32_16x16x32_bf16 v[132:135], a[16:19], a[104:107], v[132:135]
  v_mov_b32 v43, v42
  v_mfma_f32_16x16x32_bf16 v[108:111], a[8:11], a[104:107], v[108:111]
  v_mfma_f32_16x16x32_bf16 v[108:111], a[12:15], a[108:111], v[108:111]
  v_permlane16_swap_b32 v42, v43
  v_mfma_f32_16x16x32_bf16 v[84:87], a[4:7], a[108:111], v[84:87]
  v_mfma_f32_16x16x32_bf16 v[84:87], a[0:3], a[104:107], v[84:87]
  s_waitcnt lgkmcnt(12)
  v_add_f32 v42, v42, v43
  v_mfma_f32_16x16x32_bf16 a[176:179], a[112:115], a[0:3], a[176:179]
  s_add_u32 m0, s27, 6144
  v_mfma_f32_16x16x32_bf16 a[176:179], a[116:119], a[4:7], a[176:179]
  v_mov_b32_e64 v43, v42
  buffer_load_dwordx4 v20, s[68:71], 0 offen  lds
  v_mfma_f32_16x16x32_bf16 a[180:183], a[116:119], a[12:15], a[180:183]
  s_add_u32 s68, s68, 458752
  s_addc_u32 s69, s69, 0
  v_mfma_f32_16x16x32_bf16 a[180:183], a[112:115], a[8:11], a[180:183]
  v_permlane32_swap_b32 v42, v43
  v_mfma_f32_16x16x32_bf16 a[184:187], a[112:115], a[16:19], a[184:187]
  v_mfma_f32_16x16x32_bf16 a[184:187], a[116:119], a[20:23], a[184:187]
  v_add_f32 v42, v42, v43
  v_mfma_f32_16x16x32_bf16 a[188:191], a[116:119], a[28:31], a[188:191]
  v_mfma_f32_16x16x32_bf16 a[188:191], a[112:115], a[24:27], a[188:191]
  s_waitcnt vmcnt(7) lgkmcnt(0)
  s_barrier
  v_mfma_f32_16x16x32_bf16 v[160:163], a[64:67], a[32:35], v[160:163]
  ds_read_b128 a[0:3], v8 offset:34816
  s_add_u32 m0, s84, 0
  v_mfma_f32_16x16x32_bf16 v[160:163], a[68:71], a[36:39], v[160:163]
  buffer_load_dwordx4 v16, s[4:7], s80 offen offset:0  lds
  v_mfma_f32_16x16x32_bf16 v[184:187], a[68:71], a[44:47], v[184:187]
  ds_read_b128 a[4:7], v9 offset:34816
  v_mov_b32 v43, 0x3a800000
  v_mfma_f32_16x16x32_bf16 v[184:187], a[64:67], a[40:43], v[184:187]
  ds_read_b128 a[16:19], v8 offset:38912
  v_mfma_f32_16x16x32_bf16 v[208:211], a[64:67], a[48:51], v[208:211]
  ds_read_b128 a[8:11], v8 offset:36864
  v_fma_f32 v44, v42, v43, -v41
  v_mfma_f32_16x16x32_bf16 v[208:211], a[68:71], a[52:55], v[208:211]
  buffer_load_dwordx4 v16, s[4:7], s80 offen offset:2048  lds
  v_mfma_f32_16x16x32_bf16 v[232:235], a[68:71], a[60:63], v[232:235]
  ds_read_b128 a[12:15], v9 offset:36864
  v_mfma_f32_16x16x32_bf16 v[232:235], a[64:67], a[56:59], v[232:235]
  ds_read_b128 a[20:23], v9 offset:38912
  v_max_f32_e64 v44, 0, v44
  v_mfma_f32_16x16x32_bf16 v[236:239], a[72:75], a[56:59], v[236:239]
  ds_read_b64_tr_b16 a[64:65], v13 offset:0
  v_mfma_f32_16x16x32_bf16 v[236:239], a[76:79], a[60:63], v[236:239]
  v_mfma_f32_16x16x32_bf16 v[212:215], a[76:79], a[52:55], v[212:215]
  ds_read_b64_tr_b16 a[66:67], v13 offset:512
  v_cvt_pk_bf16_f32 v44, v44, v44
  v_mfma_f32_16x16x32_bf16 v[212:215], a[72:75], a[48:51], v[212:215]
  ds_read_b128 a[24:27], v8 offset:40960
  v_mfma_f32_16x16x32_bf16 v[188:191], a[72:75], a[40:43], v[188:191]
  ds_read_b64_tr_b16 a[68:69], v13 offset:14336
  s_add_u32 m0, s85, 0
  v_mfma_f32_16x16x32_bf16 v[188:191], a[76:79], a[44:47], v[188:191]
  v_and_b32 v44, 0xffff0000, v44
  buffer_load_dwordx4 v16, s[4:7], s81 offen offset:0  lds
  v_mfma_f32_16x16x32_bf16 v[164:167], a[76:79], a[36:39], v[164:167]
  ds_read_b64_tr_b16 a[70:71], v13 offset:14848
  v_mfma_f32_16x16x32_bf16 v[164:167], a[72:75], a[32:35], v[164:167]
  ds_read_b128 a[28:31], v9 offset:40960
  v_mfma_f32_16x16x32_bf16 v[168:171], a[80:83], a[32:35], v[168:171]
  ds_read_b64_tr_b16 a[72:73], v14 offset:0
  v_add_f32 v44, 0x3727c5ac, v44
  v_mfma_f32_16x16x32_bf16 v[168:171], a[84:87], a[36:39], v[168:171]
  v_mfma_f32_16x16x32_bf16 v[192:195], a[84:87], a[44:47], v[192:195]
  ds_read_b64_tr_b16 a[74:75], v14 offset:512
  v_mfma_f32_16x16x32_bf16 v[192:195], a[80:83], a[40:43], v[192:195]
  v_cvt_pk_bf16_f32 v44, v44, v44
  v_mfma_f32_16x16x32_bf16 v[216:219], a[80:83], a[48:51], v[216:219]
  ds_read_b64_tr_b16 a[76:77], v14 offset:14336
  v_mfma_f32_16x16x32_bf16 v[216:219], a[84:87], a[52:55], v[216:219]
  buffer_load_dwordx4 v16, s[4:7], s81 offen offset:2048  lds
  v_mfma_f32_16x16x32_bf16 v[240:243], a[84:87], a[60:63], v[240:243]
  ds_read_b64_tr_b16 a[78:79], v14 offset:14848
  v_and_b32 v44, 0xffff0000, v44
  v_mfma_f32_16x16x32_bf16 v[240:243], a[80:83], a[56:59], v[240:243]
  v_mfma_f32_16x16x32_bf16 v[244:247], a[88:91], a[56:59], v[244:247]
  ds_read_b64_tr_b16 a[80:81], v13 offset:1024
  v_mfma_f32_16x16x32_bf16 v[244:247], a[92:95], a[60:63], v[244:247]
  v_sqrt_f32 v44, v44
  v_mfma_f32_16x16x32_bf16 v[220:223], a[92:95], a[52:55], v[220:223]
  ds_read_b64_tr_b16 a[82:83], v13 offset:1536
  v_mfma_f32_16x16x32_bf16 v[220:223], a[88:91], a[48:51], v[220:223]
  v_mfma_f32_16x16x32_bf16 v[196:199], a[88:91], a[40:43], v[196:199]
  ds_read_b64_tr_b16 a[84:85], v13 offset:15360
  v_cvt_pk_bf16_f32 v44, v44, v44
  s_add_u32 m0, s86, 0
  v_mfma_f32_16x16x32_bf16 v[196:199], a[92:95], a[44:47], v[196:199]
  buffer_load_dwordx4 v16, s[4:7], s82 offen offset:0  lds
  v_mfma_f32_16x16x32_bf16 v[172:175], a[92:95], a[36:39], v[172:175]
  ds_read_b64_tr_b16 a[86:87], v13 offset:15872
  v_mfma_f32_16x16x32_bf16 v[172:175], a[88:91], a[32:35], v[172:175]
  v_and_b32 v44, 0xffff0000, v44
  v_mfma_f32_16x16x32_bf16 v[176:179], a[32:35], a[96:99], v[176:179]
  ds_read_b64_tr_b16 a[88:89], v14 offset:1024
  v_mfma_f32_16x16x32_bf16 v[176:179], a[36:39], a[100:103], v[176:179]
  buffer_load_dwordx4 v16, s[4:7], s82 offen offset:2048  lds
  v_mfma_f32_16x16x32_bf16 v[200:203], a[44:47], a[100:103], v[200:203]
  ds_read_b64_tr_b16 a[90:91], v14 offset:1536
  v_rcp_f32 v44, v44
  v_mfma_f32_16x16x32_bf16 v[200:203], a[40:43], a[96:99], v[200:203]
  v_mfma_f32_16x16x32_bf16 v[224:227], a[48:51], a[96:99], v[224:227]
  ds_read_b64_tr_b16 a[92:93], v14 offset:15360
  v_mfma_f32_16x16x32_bf16 v[224:227], a[52:55], a[100:103], v[224:227]
  v_mul_f32_e64 v45, v44, v40
  v_mfma_f32_16x16x32_bf16 v[248:251], a[60:63], a[100:103], v[248:251]
  ds_read_b64_tr_b16 a[94:95], v14 offset:15872
  v_mfma_f32_16x16x32_bf16 v[248:251], a[56:59], a[96:99], v[248:251]
  v_mfma_f32_16x16x32_bf16 v[252:255], a[56:59], a[104:107], v[252:255]
  ds_read_b64_tr_b16 a[96:97], v13 offset:2048
  s_add_u32 m0, s87, 0
  v_mfma_f32_16x16x32_bf16 v[252:255], a[60:63], a[108:111], v[252:255]
  buffer_load_dwordx4 v16, s[4:7], s83 offen offset:0  lds
  v_mfma_f32_16x16x32_bf16 v[228:231], a[52:55], a[108:111], v[228:231]
  ds_read_b64_tr_b16 a[98:99], v13 offset:2560
  v_mfma_f32_16x16x32_bf16 v[228:231], a[48:51], a[104:107], v[228:231]
  v_mfma_f32_16x16x32_bf16 v[204:207], a[40:43], a[104:107], v[204:207]
  ds_read_b64_tr_b16 a[100:101], v13 offset:16384
  v_mfma_f32_16x16x32_bf16 v[204:207], a[44:47], a[108:111], v[204:207]
  v_mfma_f32_16x16x32_bf16 v[180:183], a[36:39], a[108:111], v[180:183]
  ds_read_b64_tr_b16 a[102:103], v13 offset:16896
  v_mfma_f32_16x16x32_bf16 v[180:183], a[32:35], a[104:107], v[180:183]
  v_mfma_f32_16x16x32_bf16 a[192:195], a[112:115], a[32:35], a[192:195]
  ds_read_b64_tr_b16 a[104:105], v14 offset:2048
  v_mfma_f32_16x16x32_bf16 a[192:195], a[116:119], a[36:39], a[192:195]
  buffer_load_dwordx4 v16, s[4:7], s83 offen offset:2048  lds
  v_mfma_f32_16x16x32_bf16 a[196:199], a[116:119], a[44:47], a[196:199]
  ds_read_b64_tr_b16 a[106:107], v14 offset:2560
  s_add_u32 s4, s4, 128
  s_addc_u32 s5, s5, 0
  v_mfma_f32_16x16x32_bf16 a[196:199], a[112:115], a[40:43], a[196:199]
  v_mfma_f32_16x16x32_bf16 a[200:203], a[112:115], a[48:51], a[200:203]
  ds_read_b64_tr_b16 a[108:109], v14 offset:16384
  v_mfma_f32_16x16x32_bf16 a[200:203], a[116:119], a[52:55], a[200:203]
  v_mfma_f32_16x16x32_bf16 a[204:207], a[116:119], a[60:63], a[204:207]
  ds_read_b64_tr_b16 a[110:111], v14 offset:16896
  v_mfma_f32_16x16x32_bf16 a[204:207], a[112:115], a[56:59], a[204:207]
  v_mfma_f32_16x16x32_bf16 v[36:39], a[136:139], a[128:131], v[36:39]
  v_mfma_f32_16x16x32_bf16 v[36:39], a[136:139], a[132:135], v[36:39]
  s_waitcnt lgkmcnt(14)
  v_mfma_f32_16x16x32_bf16 v[64:67], a[64:67], a[0:3], v[64:67]
  ds_read_b64_tr_b16 a[112:113], v15 offset:0
  s_mov_b32 exec_lo, s38
  s_mov_b32 exec_hi, 0
  s_cbranch_execz La_ncl
  buffer_store_dwordx2 v[32:33], v31, s[16:19], 0 offen sc1
La_ncl:
  s_mov_b64 exec, -1
  v_mfma_f32_16x16x32_bf16 v[64:67], a[68:71], a[4:7], v[64:67]
  v_mfma_f32_16x16x32_bf16 v[88:91], a[68:71], a[12:15], v[88:91]
  ds_read_b64_tr_b16 a[114:115], v15 offset:256
  v_mfma_f32_16x16x32_bf16 v[88:91], a[64:67], a[8:11], v[88:91]
  v_mfma_f32_16x16x32_bf16 v[112:115], a[64:67], a[16:19], v[112:115]
  ds_read_b64_tr_b16 a[116:117], v15 offset:14336
  s_mov_b64 exec, 3
  buffer_store_dword v32, v29, s[16:19], 0 offen sc1
  s_mov_b64 exec, -1
  v_mfma_f32_16x16x32_bf16 v[112:115], a[68:71], a[20:23], v[112:115]
  v_mfma_f32_16x16x32_bf16 v[136:139], a[68:71], a[28:31], v[136:139]
  ds_read_b64_tr_b16 a[118:119], v15 offset:14592
  v_mfma_f32_16x16x32_bf16 v[136:139], a[64:67], a[24:27], v[136:139]
  v_mfma_f32_16x16x32_bf16 v[140:143], a[72:75], a[24:27], v[140:143]
  ds_read_b128 a[32:35], v8 offset:43008
  s_mov_b64 exec, 0x101
  buffer_store_dwordx2 v[44:45], v30, s[16:19], 0 offen sc1
  s_mov_b64 exec, -1
  v_mfma_f32_16x16x32_bf16 v[140:143], a[76:79], a[28:31], v[140:143]
  v_mfma_f32_16x16x32_bf16 v[116:119], a[76:79], a[20:23], v[116:119]
  ds_read_b128 a[36:39], v9 offset:43008
  v_mfma_f32_16x16x32_bf16 v[116:119], a[72:75], a[16:19], v[116:119]
  v_mfma_f32_16x16x32_bf16 v[92:95], a[72:75], a[8:11], v[92:95]
  ds_read_b128 a[40:43], v8 offset:45056
  v_mfma_f32_16x16x32_bf16 v[92:95], a[76:79], a[12:15], v[92:95]
  v_mfma_f32_16x16x32_bf16 v[68:71], a[76:79], a[4:7], v[68:71]
  ds_read_b128 a[44:47], v9 offset:45056
  v_mfma_f32_16x16x32_bf16 v[68:71], a[72:75], a[0:3], v[68:71]
  s_waitcnt lgkmcnt(14)
  v_mfma_f32_16x16x32_bf16 v[72:75], a[80:83], a[0:3], v[72:75]
  ds_read_b128 a[48:51], v8 offset:47104
  s_add_u32 m0, s88, 28672
  v_mfma_f32_16x16x32_bf16 v[72:75], a[84:87], a[4:7], v[72:75]
  buffer_load_dwordx4 v18, s[8:11], s94 offen  lds
  v_mfma_f32_16x16x32_bf16 v[96:99], a[84:87], a[12:15], v[96:99]
  ds_read_b128 a[52:55], v9 offset:47104
  v_mfma_f32_16x16x32_bf16 v[96:99], a[80:83], a[8:11], v[96:99]
  v_mfma_f32_16x16x32_bf16 v[120:123], a[80:83], a[16:19], v[120:123]
  ds_read_b128 a[56:59], v8 offset:49152
  s_add_u32 m0, s89, 28672
  v_mfma_f32_16x16x32_bf16 v[120:123], a[84:87], a[20:23], v[120:123]
  buffer_load_dwordx4 v18, s[8:11], s95 offen  lds
  v_mfma_f32_16x16x32_bf16 v[144:147], a[84:87], a[28:31], v[144:147]
  ds_read_b128 a[60:63], v9 offset:49152
  v_mfma_f32_16x16x32_bf16 v[144:147], a[80:83], a[24:27], v[144:147]
  v_mfma_f32_16x16x32_bf16 v[148:151], a[88:91], a[24:27], v[148:151]
  ds_read_b64_tr_b16 a[128:129], v25 offset:0
  v_mfma_f32_16x16x32_bf16 v[148:151], a[92:95], a[28:31], v[148:151]
  v_mfma_f32_16x16x32_bf16 v[124:127], a[92:95], a[20:23], v[124:127]
  ds_read_b64_tr_b16 a[130:131], v26 offset:0
  v_mfma_f32_16x16x32_bf16 v[124:127], a[88:91], a[16:19], v[124:127]
  v_mfma_f32_16x16x32_bf16 v[100:103], a[88:91], a[8:11], v[100:103]
  ds_read_b64_tr_b16 a[132:133], v25 offset:14336
  s_add_u32 m0, s90, 28672
  v_mfma_f32_16x16x32_bf16 v[100:103], a[92:95], a[12:15], v[100:103]
  buffer_load_dwordx4 v18, s[8:11], s96 offen  lds
  v_mfma_f32_16x16x32_bf16 v[76:79], a[92:95], a[4:7], v[76:79]
  ds_read_b64_tr_b16 a[134:135], v26 offset:14336
  v_mfma_f32_16x16x32_bf16 v[76:79], a[88:91], a[0:3], v[76:79]
  s_waitcnt lgkmcnt(14)
  v_mfma_f32_16x16x32_bf16 v[80:83], a[0:3], a[96:99], v[80:83]
  s_add_u32 m0, s91, 28672
  v_mfma_f32_16x16x32_bf16 v[80:83], a[4:7], a[100:103], v[80:83]
  buffer_load_dwordx4 v19, s[8:11], s94 offen  lds
  v_mfma_f32_16x16x32_bf16 v[104:107], a[12:15], a[100:103], v[104:107]
  v_mfma_f32_16x16x32_bf16 v[104:107], a[8:11], a[96:99], v[104:107]
  v_mfma_f32_16x16x32_bf16 v[128:131], a[16:19], a[96:99], v[128:131]
  s_add_u32 m0, s92, 28672
  v_mfma_f32_16x16x32_bf16 v[128:131], a[20:23], a[100:103], v[128:131]
  buffer_load_dwordx4 v19, s[8:11], s95 offen  lds
  v_mfma_f32_16x16x32_bf16 v[152:155], a[28:31], a[100:103], v[152:155]
  v_mfma_f32_16x16x32_bf16 v[152:155], a[24:27], a[96:99], v[152:155]
  v_mfma_f32_16x16x32_bf16 v[156:159], a[24:27], a[104:107], v[156:159]
  v_mfma_f32_16x16x32_bf16 v[156:159], a[28:31], a[108:111], v[156:159]
  v_mfma_f32_16x16x32_bf16 v[132:135], a[20:23], a[108:111], v[132:135]
  v_mfma_f32_16x16x32_bf16 v[132:135], a[16:19], a[104:107], v[132:135]
  v_mfma_f32_16x16x32_bf16 v[108:111], a[8:11], a[104:107], v[108:111]
  s_add_u32 m0, s93, 28672
  v_mfma_f32_16x16x32_bf16 v[108:111], a[12:15], a[108:111], v[108:111]
  buffer_load_dwordx4 v19, s[8:11], s96 offen  lds
  v_mfma_f32_16x16x32_bf16 v[84:87], a[4:7], a[108:111], v[84:87]
  s_add_u32 s8, s8, 393216
  s_addc_u32 s9, s9, 0
  s_sub_u32 s8, s8, s65
  s_subb_u32 s9, s9, 0
  s_sub_u32 s65, 6291456, s65
  v_mfma_f32_16x16x32_bf16 v[84:87], a[0:3], a[104:107], v[84:87]
  s_waitcnt lgkmcnt(12)
  v_mfma_f32_16x16x32_bf16 a[176:179], a[112:115], a[0:3], a[176:179]
  s_add_u32 m0, s27, 34816
  v_mfma_f32_16x16x32_bf16 a[176:179], a[116:119], a[4:7], a[176:179]
  buffer_load_dwordx4 v20, s[68:71], 0 offen  lds
  v_mfma_f32_16x16x32_bf16 a[180:183], a[116:119], a[12:15], a[180:183]
  s_add_u32 s68, s68, 458752
  s_addc_u32 s69, s69, 0
  s_sub_u32 s68, s68, s97
  s_subb_u32 s69, s69, 0
  s_sub_u32 s97, 7340032, s97
  v_mfma_f32_16x16x32_bf16 a[180:183], a[112:115], a[8:11], a[180:183]
  v_mfma_f32_16x16x32_bf16 a[184:187], a[112:115], a[16:19], a[184:187]
  v_mfma_f32_16x16x32_bf16 a[184:187], a[116:119], a[20:23], a[184:187]
  v_mfma_f32_16x16x32_bf16 a[188:191], a[116:119], a[28:31], a[188:191]
  v_mfma_f32_16x16x32_bf16 a[188:191], a[112:115], a[24:27], a[188:191]
  s_waitcnt vmcnt(9) lgkmcnt(0)
  s_barrier
  v_mfma_f32_16x16x32_bf16 v[160:163], a[64:67], a[32:35], v[160:163]
  ds_read_b128 a[0:3], v8 offset:0
  s_add_u32 m0, s84, 34816
  v_mfma_f32_16x16x32_bf16 v[160:163], a[68:71], a[36:39], v[160:163]
  buffer_load_dwordx4 v16, s[4:7], s80 offen offset:0  lds
  v_mfma_f32_16x16x32_bf16 v[184:187], a[68:71], a[44:47], v[184:187]
  ds_read_b128 a[4:7], v9 offset:0
  v_mfma_f32_16x16x32_bf16 v[184:187], a[64:67], a[40:43], v[184:187]
  ds_read_b128 a[16:19], v8 offset:4096
  v_mfma_f32_16x16x32_bf16 v[208:211], a[64:67], a[48:51], v[208:211]
  ds_read_b128 a[8:11], v8 offset:2048
  v_mfma_f32_16x16x32_bf16 v[208:211], a[68:71], a[52:55], v[208:211]
  buffer_load_dwordx4 v16, s[4:7], s80 offen offset:2048  lds
  v_mfma_f32_16x16x32_bf16 v[232:235], a[68:71], a[60:63], v[232:235]
  ds_read_b128 a[12:15], v9 offset:2048
  v_mfma_f32_16x16x32_bf16 v[232:235], a[64:67], a[56:59], v[232:235]
  ds_read_b128 a[20:23], v9 offset:4096
  v_mfma_f32_16x16x32_bf16 v[236:239], a[72:75], a[56:59], v[236:239]
  ds_read_b64_tr_b16 a[64:65], v10 offset:0
  v_mfma_f32_16x16x32_bf16 v[236:239], a[76:79], a[60:63], v[236:239]
  v_mfma_f32_16x16x32_bf16 v[212:215], a[76:79], a[52:55], v[212:215]
  ds_read_b64_tr_b16 a[66:67], v10 offset:512
  v_mfma_f32_16x16x32_bf16 v[212:215], a[72:75], a[48:51], v[212:215]
  ds_read_b128 a[24:27], v8 offset:6144
  v_mfma_f32_16x16x32_bf16 v[188:191], a[72:75], a[40:43], v[188:191]
  ds_read_b64_tr_b16 a[68:69], v10 offset:14336
  s_add_u32 m0, s85, 34816
  v_mfma_f32_16x16x32_bf16 v[188:191], a[76:79], a[44:47], v[188:191]
  buffer_load_dwordx4 v16, s[4:7], s81 offen offset:0  lds
  v_mfma_f32_16x16x32_bf16 v[164:167], a[76:79], a[36:39], v[164:167]
  ds_read_b64_tr_b16 a[70:71], v10 offset:14848
  v_mfma_f32_16x16x32_bf16 v[164:167], a[72:75], a[32:35], v[164:167]
  ds_read_b128 a[28:31], v9 offset:6144
  v_mfma_f32_16x16x32_bf16 v[168:171], a[80:83], a[32:35], v[168:171]
  ds_read_b64_tr_b16 a[72:73], v11 offset:0
  v_mfma_f32_16x16x32_bf16 v[168:171], a[84:87], a[36:39], v[168:171]
  v_mfma_f32_16x16x32_bf16 v[192:195], a[84:87], a[44:47], v[192:195]
  ds_read_b64_tr_b16 a[74:75], v11 offset:512
  v_mfma_f32_16x16x32_bf16 v[192:195], a[80:83], a[40:43], v[192:195]
  v_mfma_f32_16x16x32_bf16 v[216:219], a[80:83], a[48:51], v[216:219]
  ds_read_b64_tr_b16 a[76:77], v11 offset:14336
  v_mfma_f32_16x16x32_bf16 v[216:219], a[84:87], a[52:55], v[216:219]
  buffer_load_dwordx4 v16, s[4:7], s81 offen offset:2048  lds
  v_mfma_f32_16x16x32_bf16 v[240:243], a[84:87], a[60:63], v[240:243]
  ds_read_b64_tr_b16 a[78:79], v11 offset:14848
  v_mfma_f32_16x16x32_bf16 v[240:243], a[80:83], a[56:59], v[240:243]
  v_mfma_f32_16x16x32_bf16 v[244:247], a[88:91], a[56:59], v[244:247]
  ds_read_b64_tr_b16 a[80:81], v10 offset:1024
  v_mfma_f32_16x16x32_bf16 v[244:247], a[92:95], a[60:63], v[244:247]
  v_mfma_f32_16x16x32_bf16 v[220:223], a[92:95], a[52:55], v[220:223]
  ds_read_b64_tr_b16 a[82:83], v10 offset:1536
  v_mfma_f32_16x16x32_bf16 v[220:223], a[88:91], a[48:51], v[220:223]
  v_mfma_f32_16x16x32_bf16 v[196:199], a[88:91], a[40:43], v[196:199]
  ds_read_b64_tr_b16 a[84:85], v10 offset:15360
  s_add_u32 m0, s86, 34816
  v_mfma_f32_16x16x32_bf16 v[196:199], a[92:95], a[44:47], v[196:199]
  buffer_load_dwordx4 v16, s[4:7], s82 offen offset:0  lds
  v_mfma_f32_16x16x32_bf16 v[172:175], a[92:95], a[36:39], v[172:175]
  ds_read_b64_tr_b16 a[86:87], v10 offset:15872
  v_mfma_f32_16x16x32_bf16 v[172:175], a[88:91], a[32:35], v[172:175]
  v_mfma_f32_16x16x32_bf16 v[176:179], a[32:35], a[96:99], v[176:179]
  ds_read_b64_tr_b16 a[88:89], v11 offset:1024
  v_mfma_f32_16x16x32_bf16 v[176:179], a[36:39], a[100:103], v[176:179]
  buffer_load_dwordx4 v16, s[4:7], s82 offen offset:2048  lds
  v_mfma_f32_16x16x32_bf16 v[200:203], a[44:47], a[100:103], v[200:203]
  ds_read_b64_tr_b16 a[90:91], v11 offset:1536
  v_mfma_f32_16x16x32_bf16 v[200:203], a[40:43], a[96:99], v[200:203]
  v_mfma_f32_16x16x32_bf16 v[224:227], a[48:51], a[96:99], v[224:227]
  ds_read_b64_tr_b16 a[92:93], v11 offset:15360
  v_mfma_f32_16x16x32_bf16 v[224:227], a[52:55], a[100:103], v[224:227]
  v_mfma_f32_16x16x32_bf16 v[248:251], a[60:63], a[100:103], v[248:251]
  ds_read_b64_tr_b16 a[94:95], v11 offset:15872
  v_mfma_f32_16x16x32_bf16 v[248:251], a[56:59], a[96:99], v[248:251]
  v_mfma_f32_16x16x32_bf16 v[252:255], a[56:59], a[104:107], v[252:255]
  ds_read_b64_tr_b16 a[96:97], v10 offset:2048
  s_add_u32 m0, s87, 34816
  v_mfma_f32_16x16x32_bf16 v[252:255], a[60:63], a[108:111], v[252:255]
  buffer_load_dwordx4 v16, s[4:7], s83 offen offset:0  lds
  v_mfma_f32_16x16x32_bf16 v[228:231], a[52:55], a[108:111], v[228:231]
  ds_read_b64_tr_b16 a[98:99], v10 offset:2560
  v_mfma_f32_16x16x32_bf16 v[228:231], a[48:51], a[104:107], v[228:231]
  v_mfma_f32_16x16x32_bf16 v[204:207], a[40:43], a[104:107], v[204:207]
  ds_read_b64_tr_b16 a[100:101], v10 offset:16384
  v_mfma_f32_16x16x32_bf16 v[204:207], a[44:47], a[108:111], v[204:207]
  v_mfma_f32_16x16x32_bf16 v[180:183], a[36:39], a[108:111], v[180:183]
  ds_read_b64_tr_b16 a[102:103], v10 offset:16896
  v_mfma_f32_16x16x32_bf16 v[180:183], a[32:35], a[104:107], v[180:183]
  v_mfma_f32_16x16x32_bf16 a[192:195], a[112:115], a[32:35], a[192:195]
  ds_read_b64_tr_b16 a[104:105], v11 offset:2048
  v_mfma_f32_16x16x32_bf16 a[192:195], a[116:119], a[36:39], a[192:195]
  buffer_load_dwordx4 v16, s[4:7], s83 offen offset:2048  lds
  v_mfma_f32_16x16x32_bf16 a[196:199], a[116:119], a[44:47], a[196:199]
  ds_read_b64_tr_b16 a[106:107], v11 offset:2560
  s_add_u32 s4, s4, 128
  s_addc_u32 s5, s5, 0
  s_sub_u32 s4, s4, s64
  s_subb_u32 s5, s5, 0
  s_sub_u32 s64, 2048, s64
  v_mfma_f32_16x16x32_bf16 a[196:199], a[112:115], a[40:43], a[196:199]
  v_mfma_f32_16x16x32_bf16 a[200:203], a[112:115], a[48:51], a[200:203]
  ds_read_b64_tr_b16 a[108:109], v11 offset:16384
  v_mfma_f32_16x16x32_bf16 a[200:203], a[116:119], a[52:55], a[200:203]
  v_mfma_f32_16x16x32_bf16 a[204:207], a[116:119], a[60:63], a[204:207]
  ds_read_b64_tr_b16 a[110:111], v11 offset:16896
  v_mfma_f32_16x16x32_bf16 a[204:207], a[112:115], a[56:59], a[204:207]
  v_mfma_f32_16x16x32_bf16 v[36:39], a[136:139], a[128:131], v[36:39]
  v_mfma_f32_16x16x32_bf16 v[36:39], a[136:139], a[132:135], v[36:39]
  s_waitcnt lgkmcnt(14)
  v_mfma_f32_16x16x32_bf16 v[64:67], a[64:67], a[0:3], v[64:67]
  ds_read_b64_tr_b16 a[112:113], v12 offset:0
  v_mfma_f32_16x16x32_bf16 v[64:67], a[68:71], a[4:7], v[64:67]
  buffer_store_dwordx4 v[48:51], v7, s[16:19], s32 offen offset:0 sc1
  v_mfma_f32_16x16x32_bf16 v[88:91], a[68:71], a[12:15], v[88:91]
  ds_read_b64_tr_b16 a[114:115], v12 offset:256
  v_mfma_f32_16x16x32_bf16 v[88:91], a[64:67], a[8:11], v[88:91]
  v_mfma_f32_16x16x32_bf16 v[112:115], a[64:67], a[16:19], v[112:115]
  ds_read_b64_tr_b16 a[116:117], v12 offset:14336
  v_mfma_f32_16x16x32_bf16 v[112:115], a[68:71], a[20:23], v[112:115]
  buffer_store_dwordx4 v[48:51], v7, s[16:19], s32 offen offset:1024 sc1
  v_mfma_f32_16x16x32_bf16 v[136:139], a[68:71], a[28:31], v[136:139]
  ds_read_b64_tr_b16 a[118:119], v12 offset:14592
  v_mfma_f32_16x16x32_bf16 v[136:139], a[64:67], a[24:27], v[136:139]
  v_mfma_f32_16x16x32_bf16 v[140:143], a[72:75], a[24:27], v[140:143]
  ds_read_b128 a[32:35], v8 offset:8192
  v_mfma_f32_16x16x32_bf16 v[140:143], a[76:79], a[28:31], v[140:143]
  buffer_store_dwordx4 v[48:51], v7, s[16:19], s32 offen offset:2048 sc1
  v_mfma_f32_16x16x32_bf16 v[116:119], a[76:79], a[20:23], v[116:119]
  ds_read_b128 a[36:39], v9 offset:8192
  v_mfma_f32_16x16x32_bf16 v[116:119], a[72:75], a[16:19], v[116:119]
  v_mfma_f32_16x16x32_bf16 v[92:95], a[72:75], a[8:11], v[92:95]
  ds_read_b128 a[40:43], v8 offset:10240
  v_mfma_f32_16x16x32_bf16 v[92:95], a[76:79], a[12:15], v[92:95]
  buffer_store_dwordx4 v[48:51], v7, s[16:19], s32 offen offset:3072 sc1
  v_mfma_f32_16x16x32_bf16 v[68:71], a[76:79], a[4:7], v[68:71]
  ds_read_b128 a[44:47], v9 offset:10240
  v_mfma_f32_16x16x32_bf16 v[68:71], a[72:75], a[0:3], v[68:71]
  s_waitcnt lgkmcnt(14)
  v_mfma_f32_16x16x32_bf16 v[72:75], a[80:83], a[0:3], v[72:75]
  ds_read_b128 a[48:51], v8 offset:12288
  v_mfma_f32_16x16x32_bf16 v[72:75], a[84:87], a[4:7], v[72:75]
  v_mfma_f32_16x16x32_bf16 v[96:99], a[84:87], a[12:15], v[96:99]
  ds_read_b128 a[52:55], v9 offset:12288
  v_mfma_f32_16x16x32_bf16 v[96:99], a[80:83], a[8:11], v[96:99]
  v_mfma_f32_16x16x32_bf16 v[120:123], a[80:83], a[16:19], v[120:123]
  ds_read_b128 a[56:59], v8 offset:14336
  s_add_u32 m0, s88, 57344
  v_mfma_f32_16x16x32_bf16 v[120:123], a[84:87], a[20:23], v[120:123]
  buffer_load_dwordx4 v18, s[8:11], s94 offen  lds
  v_mfma_f32_16x16x32_bf16 v[144:147], a[84:87], a[28:31], v[144:147]
  ds_read_b128 a[60:63], v9 offset:14336
  v_mfma_f32_16x16x32_bf16 v[144:147], a[80:83], a[24:27], v[144:147]
  v_mfma_f32_16x16x32_bf16 v[148:151], a[88:91], a[24:27], v[148:151]
  ds_read_b64_tr_b16 a[128:129], v23 offset:0
  s_add_u32 m0, s89, 57344
  v_mfma_f32_16x16x32_bf16 v[148:151], a[92:95], a[28:31], v[148:151]
  buffer_load_dwordx4 v18, s[8:11], s95 offen  lds
  v_mfma_f32_16x16x32_bf16 v[124:127], a[92:95], a[20:23], v[124:127]
  ds_read_b64_tr_b16 a[130:131], v24 offset:0
  v_mfma_f32_16x16x32_bf16 v[124:127], a[88:91], a[16:19], v[124:127]
  v_mfma_f32_16x16x32_bf16 v[100:103], a[88:91], a[8:11], v[100:103]
  ds_read_b64_tr_b16 a[132:133], v23 offset:14336
  s_add_u32 m0, s90, 57344
  v_mfma_f32_16x16x32_bf16 v[100:103], a[92:95], a[12:15], v[100:103]
  buffer_load_dwordx4 v18, s[8:11], s96 offen  lds
  v_mfma_f32_16x16x32_bf16 v[76:79], a[92:95], a[4:7], v[76:79]
  ds_read_b64_tr_b16 a[134:135], v24 offset:14336
  v_mfma_f32_16x16x32_bf16 v[76:79], a[88:91], a[0:3], v[76:79]
  s_waitcnt lgkmcnt(14)
  v_mfma_f32_16x16x32_bf16 v[80:83], a[0:3], a[96:99], v[80:83]
  s_add_u32 m0, s91, 57344
  v_mfma_f32_16x16x32_bf16 v[80:83], a[4:7], a[100:103], v[80:83]
  buffer_load_dwordx4 v19, s[8:11], s94 offen  lds
  v_mfma_f32_16x16x32_bf16 v[104:107], a[12:15], a[100:103], v[104:107]
  v_mfma_f32_16x16x32_bf16 v[104:107], a[8:11], a[96:99], v[104:107]
  v_mfma_f32_16x16x32_bf16 v[128:131], a[16:19], a[96:99], v[128:131]
  v_mfma_f32_16x16x32_bf16 v[128:131], a[20:23], a[100:103], v[128:131]
  v_mfma_f32_16x16x32_bf16 v[152:155], a[28:31], a[100:103], v[152:155]
  v_mfma_f32_16x16x32_bf16 v[152:155], a[24:27], a[96:99], v[152:155]
  v_mfma_f32_16x16x32_bf16 v[156:159], a[24:27], a[104:107], v[156:159]
  s_add_u32 m0, s92, 57344
  v_mfma_f32_16x16x32_bf16 v[156:159], a[28:31], a[108:111], v[156:159]
  buffer_load_dwordx4 v19, s[8:11], s95 offen  lds
  v_mfma_f32_16x16x32_bf16 v[132:135], a[20:23], a[108:111], v[132:135]
  v_mfma_f32_16x16x32_bf16 v[132:135], a[16:19], a[104:107], v[132:135]
  v_mfma_f32_16x16x32_bf16 v[108:111], a[8:11], a[104:107], v[108:111]
  s_add_u32 m0, s93, 57344
  v_mfma_f32_16x16x32_bf16 v[108:111], a[12:15], a[108:111], v[108:111]
  buffer_load_dwordx4 v19, s[8:11], s96 offen  lds
  v_mfma_f32_16x16x32_bf16 v[84:87], a[4:7], a[108:111], v[84:87]
  s_add_u32 s8, s8, 393216
  s_addc_u32 s9, s9, 0
  v_mfma_f32_16x16x32_bf16 v[84:87], a[0:3], a[104:107], v[84:87]
  s_waitcnt lgkmcnt(12)
  v_mfma_f32_16x16x32_bf16 a[176:179], a[112:115], a[0:3], a[176:179]
La_pad3:
  s_cbranch_execz La_ret0
  s_nop 0
  s_add_u32 m0, s27, 63488
  v_mfma_f32_16x16x32_bf16 a[176:179], a[116:119], a[4:7], a[176:179]
  buffer_load_dwordx4 v20, s[68:71], 0 offen  lds
  v_mfma_f32_16x16x32_bf16 a[180:183], a[116:119], a[12:15], a[180:183]
  s_add_u32 s68, s68, 458752
  s_addc_u32 s69, s69, 0
  v_mfma_f32_16x16x32_bf16 a[180:183], a[112:115], a[8:11], a[180:183]
  v_mfma_f32_16x16x32_bf16 a[184:187], a[112:115], a[16:19], a[184:187]
  v_mfma_f32_16x16x32_bf16 a[184:187], a[116:119], a[20:23], a[184:187]
  v_mfma_f32_16x16x32_bf16 a[188:191], a[116:119], a[28:31], a[188:191]
  v_mfma_f32_16x16x32_bf16 a[188:191], a[112:115], a[24:27], a[188:191]
  s_waitcnt vmcnt(11) lgkmcnt(0)
  s_barrier
  v_mfma_f32_16x16x32_bf16 v[160:163], a[64:67], a[32:35], v[160:163]
  ds_read_b128 a[0:3], v8 offset:34816
  s_add_u32 m0, s84, 0
  v_mfma_f32_16x16x32_bf16 v[160:163], a[68:71], a[36:39], v[160:163]
  buffer_load_dwordx4 v16, s[4:7], s80 offen offset:0  lds
  v_mfma_f32_16x16x32_bf16 v[184:187], a[68:71], a[44:47], v[184:187]
  ds_read_b128 a[4:7], v9 offset:34816
  v_mfma_f32_16x16x32_bf16 v[184:187], a[64:67], a[40:43], v[184:187]
  ds_read_b128 a[16:19], v8 offset:38912
  v_mfma_f32_16x16x32_bf16 v[208:211], a[64:67], a[48:51], v[208:211]
  ds_read_b128 a[8:11], v8 offset:36864
  v_mfma_f32_16x16x32_bf16 v[208:211], a[68:71], a[52:55], v[208:211]
  buffer_load_dwordx4 v16, s[4:7], s80 offen offset:2048  lds
  v_mfma_f32_16x16x32_bf16 v[232:235], a[68:71], a[60:63], v[232:235]
  ds_read_b128 a[12:15], v9 offset:36864
  v_mfma_f32_16x16x32_bf16 v[232:235], a[64:67], a[56:59], v[232:235]
  ds_read_b128 a[20:23], v9 offset:38912
  v_mfma_f32_16x16x32_bf16 v[236:239], a[72:75], a[56:59], v[236:239]
  ds_read_b64_tr_b16 a[64:65], v10 offset:28672
  v_mfma_f32_16x16x32_bf16 v[236:239], a[76:79], a[60:63], v[236:239]
  v_mfma_f32_16x16x32_bf16 v[212:215], a[76:79], a[52:55], v[212:215]
  ds_read_b64_tr_b16 a[66:67], v10 offset:29184
  v_mfma_f32_16x16x32_bf16 v[212:215], a[72:75], a[48:51], v[212:215]
  ds_read_b128 a[24:27], v8 offset:40960
  v_mfma_f32_16x16x32_bf16 v[188:191], a[72:75], a[40:43], v[188:191]
  ds_read_b64_tr_b16 a[68:69], v10 offset:43008
  s_add_u32 m0, s85, 0
  v_mfma_f32_16x16x32_bf16 v[188:191], a[76:79], a[44:47], v[188:191]
  buffer_load_dwordx4 v16, s[4:7], s81 offen offset:0  lds
  v_mfma_f32_16x16x32_bf16 v[164:167], a[76:79], a[36:39], v[164:167]
  ds_read_b64_tr_b16 a[70:71], v10 offset:43520
  v_mfma_f32_16x16x32_bf16 v[164:167], a[72:75], a[32:35], v[164:167]
  ds_read_b128 a[28:31], v9 offset:40960
  v_mfma_f32_16x16x32_bf16 v[168:171], a[80:83], a[32:35], v[168:171]
  ds_read_b64_tr_b16 a[72:73], v11 offset:28672
  v_mfma_f32_16x16x32_bf16 v[168:171], a[84:87], a[36:39], v[168:171]
  v_mfma_f32_16x16x32_bf16 v[192:195], a[84:87], a[44:47], v[192:195]
  ds_read_b64_tr_b16 a[74:75], v11 offset:29184
  v_mfma_f32_16x16x32_bf16 v[192:195], a[80:83], a[40:43], v[192:195]
  v_mfma_f32_16x16x32_bf16 v[216:219], a[80:83], a[48:51], v[216:219]
  ds_read_b64_tr_b16 a[76:77], v11 offset:43008
  v_mfma_f32_16x16x32_bf16 v[216:219], a[84:87], a[52:55], v[216:219]
  buffer_load_dwordx4 v16, s[4:7], s81 offen offset:2048  lds
  v_mfma_f32_16x16x32_bf16 v[240:243], a[84:87], a[60:63], v[240:243]
  ds_read_b64_tr_b16 a[78:79], v11 offset:43520
  v_mfma_f32_16x16x32_bf16 v[240:243], a[80:83], a[56:59], v[240:243]
  v_mfma_f32_16x16x32_bf16 v[244:247], a[88:91], a[56:59], v[244:247]
  ds_read_b64_tr_b16 a[80:81], v10 offset:29696
  v_mfma_f32_16x16x32_bf16 v[244:247], a[92:95], a[60:63], v[244:247]
  v_mfma_f32_16x16x32_bf16 v[220:223], a[92:95], a[52:55], v[220:223]
  ds_read_b64_tr_b16 a[82:83], v10 offset:30208
  v_mfma_f32_16x16x32_bf16 v[220:223], a[88:91], a[48:51], v[220:223]
  v_mfma_f32_16x16x32_bf16 v[196:199], a[88:91], a[40:43], v[196:199]
  ds_read_b64_tr_b16 a[84:85], v10 offset:44032
  s_add_u32 m0, s86, 0
  v_mfma_f32_16x16x32_bf16 v[196:199], a[92:95], a[44:47], v[196:199]
  buffer_load_dwordx4 v16, s[4:7], s82 offen offset:0  lds
  v_mfma_f32_16x16x32_bf16 v[172:175], a[92:95], a[36:39], v[172:175]
  ds_read_b64_tr_b16 a[86:87], v10 offset:44544
  v_mfma_f32_16x16x32_bf16 v[172:175], a[88:91], a[32:35], v[172:175]
  v_mfma_f32_16x16x32_bf16 v[176:179], a[32:35], a[96:99], v[176:179]
  ds_read_b64_tr_b16 a[88:89], v11 offset:29696
  v_mfma_f32_16x16x32_bf16 v[176:179], a[36:39], a[100:103], v[176:179]
  buffer_load_dwordx4 v16, s[4:7], s82 offen offset:2048  lds
  v_mfma_f32_16x16x32_bf16 v[200:203], a[44:47], a[100:103], v[200:203]
  ds_read_b64_tr_b16 a[90:91], v11 offset:30208
  v_mfma_f32_16x16x32_bf16 v[200:203], a[40:43], a[96:99], v[200:203]
  v_mfma_f32_16x16x32_bf16 v[224:227], a[48:51], a[96:99], v[224:227]
  ds_read_b64_tr_b16 a[92:93], v11 offset:44032
  v_mfma_f32_16x16x32_bf16 v[224:227], a[52:55], a[100:103], v[224:227]
  v_mfma_f32_16x16x32_bf16 v[248:251], a[60:63], a[100:103], v[248:251]
  ds_read_b64_tr_b16 a[94:95], v11 offset:44544
  v_mfma_f32_16x16x32_bf16 v[248:251], a[56:59], a[96:99], v[248:251]
  v_mfma_f32_16x16x32_bf16 v[252:255], a[56:59], a[104:107], v[252:255]
  ds_read_b64_tr_b16 a[96:97], v10 offset:30720
  s_add_u32 m0, s87, 0
  v_mfma_f32_16x16x32_bf16 v[252:255], a[60:63], a[108:111], v[252:255]
  buffer_load_dwordx4 v16, s[4:7], s83 offen offset:0  lds
  v_mfma_f32_16x16x32_bf16 v[228:231], a[52:55], a[108:111], v[228:231]
  ds_read_b64_tr_b16 a[98:99], v10 offset:31232
  v_mfma_f32_16x16x32_bf16 v[228:231], a[48:51], a[104:107], v[228:231]
  v_mfma_f32_16x16x32_bf16 v[204:207], a[40:43], a[104:107], v[204:207]
  ds_read_b64_tr_b16 a[100:101], v10 offset:45056
  v_mfma_f32_16x16x32_bf16 v[204:207], a[44:47], a[108:111], v[204:207]
  v_mfma_f32_16x16x32_bf16 v[180:183], a[36:39], a[108:111], v[180:183]
  ds_read_b64_tr_b16 a[102:103], v10 offset:45568
  v_mfma_f32_16x16x32_bf16 v[180:183], a[32:35], a[104:107], v[180:183]
  v_mfma_f32_16x16x32_bf16 a[192:195], a[112:115], a[32:35], a[192:195]
  ds_read_b64_tr_b16 a[104:105], v11 offset:30720
  v_mfma_f32_16x16x32_bf16 a[192:195], a[116:119], a[36:39], a[192:195]
  buffer_load_dwordx4 v16, s[4:7], s83 offen offset:2048  lds
  v_mfma_f32_16x16x32_bf16 a[196:199], a[116:119], a[44:47], a[196:199]
  ds_read_b64_tr_b16 a[106:107], v11 offset:31232
  s_add_u32 s4, s4, 128
  s_addc_u32 s5, s5, 0
  v_mfma_f32_16x16x32_bf16 a[196:199], a[112:115], a[40:43], a[196:199]
  v_mfma_f32_16x16x32_bf16 a[200:203], a[112:115], a[48:51], a[200:203]
  ds_read_b64_tr_b16 a[108:109], v11 offset:45056
  v_mfma_f32_16x16x32_bf16 a[200:203], a[116:119], a[52:55], a[200:203]
  v_mfma_f32_16x16x32_bf16 a[204:207], a[116:119], a[60:63], a[204:207]
  ds_read_b64_tr_b16 a[110:111], v11 offset:45568
  v_mfma_f32_16x16x32_bf16 a[204:207], a[112:115], a[56:59], a[204:207]
  v_mfma_f32_16x16x32_bf16 v[36:39], a[136:139], a[128:131], v[36:39]
  v_mfma_f32_16x16x32_bf16 v[36:39], a[136:139], a[132:135], v[36:39]
  s_waitcnt lgkmcnt(14)
  v_mfma_f32_16x16x32_bf16 v[64:67], a[64:67], a[0:3], v[64:67]
  ds_read_b64_tr_b16 a[112:113], v12 offset:28672
  s_add_u32 m0, s88, 0
  v_mfma_f32_16x16x32_bf16 v[64:67], a[68:71], a[4:7], v[64:67]
  buffer_load_dwordx4 v18, s[8:11], s94 offen  lds
  v_mfma_f32_16x16x32_bf16 v[88:91], a[68:71], a[12:15], v[88:91]
  ds_read_b64_tr_b16 a[114:115], v12 offset:28928
  v_mfma_f32_16x16x32_bf16 v[88:91], a[64:67], a[8:11], v[88:91]
  v_mfma_f32_16x16x32_bf16 v[112:115], a[64:67], a[16:19], v[112:115]
  ds_read_b64_tr_b16 a[116:117], v12 offset:43008
  s_add_u32 m0, s89, 0
  v_mfma_f32_16x16x32_bf16 v[112:115], a[68:71], a[20:23], v[112:115]
  buffer_load_dwordx4 v18, s[8:11], s95 offen  lds
  v_mfma_f32_16x16x32_bf16 v[136:139], a[68:71], a[28:31], v[136:139]
  ds_read_b64_tr_b16 a[118:119], v12 offset:43264
  v_mfma_f32_16x16x32_bf16 v[136:139], a[64:67], a[24:27], v[136:139]
  v_mfma_f32_16x16x32_bf16 v[140:143], a[72:75], a[24:27], v[140:143]
  ds_read_b128 a[32:35], v8 offset:43008
  s_add_u32 m0, s90, 0
  v_mfma_f32_16x16x32_bf16 v[140:143], a[76:79], a[28:31], v[140:143]
  buffer_load_dwordx4 v18, s[8:11], s96 offen  lds
  v_mfma_f32_16x16x32_bf16 v[116:119], a[76:79], a[20:23], v[116:119]
  ds_read_b128 a[36:39], v9 offset:43008
  v_mfma_f32_16x16x32_bf16 v[116:119], a[72:75], a[16:19], v[116:119]
  v_mfma_f32_16x16x32_bf16 v[92:95], a[72:75], a[8:11], v[92:95]
  ds_read_b128 a[40:43], v8 offset:45056
  s_add_u32 m0, s91, 0
  v_mfma_f32_16x16x32_bf16 v[92:95], a[76:79], a[12:15], v[92:95]
  buffer_load_dwordx4 v19, s[8:11], s94 offen  lds
  v_mfma_f32_16x16x32_bf16 v[68:71], a[76:79], a[4:7], v[68:71]
  ds_read_b128 a[44:47], v9 offset:45056
  v_mfma_f32_16x16x32_bf16 v[68:71], a[72:75], a[0:3], v[68:71]
  s_waitcnt lgkmcnt(14)
  v_mfma_f32_16x16x32_bf16 v[72:75], a[80:83], a[0:3], v[72:75]
  ds_read_b128 a[48:51], v8 offset:47104
  s_add_u32 m0, s92, 0
  v_mfma_f32_16x16x32_bf16 v[72:75], a[84:87], a[4:7], v[72:75]
  buffer_load_dwordx4 v19, s[8:11], s95 offen  lds
  v_mfma_f32_16x16x32_bf16 v[96:99], a[84:87], a[12:15], v[96:99]
  ds_read_b128 a[52:55], v9 offset:47104
  v_mfma_f32_16x16x32_bf16 v[96:99], a[80:83], a[8:11], v[96:99]
  v_mfma_f32_16x16x32_bf16 v[120:123], a[80:83], a[16:19], v[120:123]
  ds_read_b128 a[56:59], v8 offset:49152
  s_add_u32 m0, s93, 0
  v_mfma_f32_16x16x32_bf16 v[120:123], a[84:87], a[20:23], v[120:123]
  buffer_load_dwordx4 v19, s[8:11], s96 offen  lds
  v_mfma_f32_16x16x32_bf16 v[144:147], a[84:87], a[28:31], v[144:147]
  ds_read_b128 a[60:63], v9 offset:49152
  s_add_u32 s8, s8, 393216
  s_addc_u32 s9, s9, 0
  v_mfma_f32_16x16x32_bf16 v[144:147], a[80:83], a[24:27], v[144:147]
  v_mfma_f32_16x16x32_bf16 v[148:151], a[88:91], a[24:27], v[148:151]
  ds_read_b64_tr_b16 a[128:129], v23 offset:28672
  v_mfma_f32_16x16x32_bf16 v[148:151], a[92:95], a[28:31], v[148:151]
  v_mfma_f32_16x16x32_bf16 v[124:127], a[92:95], a[20:23], v[124:127]
  ds_read_b64_tr_b16 a[130:131], v24 offset:28672
  v_mfma_f32_16x16x32_bf16 v[124:127], a[88:91], a[16:19], v[124:127]
  v_mfma_f32_16x16x32_bf16 v[100:103], a[88:91], a[8:11], v[100:103]
  ds_read_b64_tr_b16 a[132:133], v23 offset:43008
  s_add_u32 m0, s27, 6144
  v_mfma_f32_16x16x32_bf16 v[100:103], a[92:95], a[12:15], v[100:103]
  buffer_load_dwordx4 v20, s[68:71], 0 offen  lds
  v_mfma_f32_16x16x32_bf16 v[76:79], a[92:95], a[4:7], v[76:79]
  ds_read_b64_tr_b16 a[134:135], v24 offset:43008
  s_add_u32 s68, s68, 458752
  s_addc_u32 s69, s69, 0
  v_mfma_f32_16x16x32_bf16 v[76:79], a[88:91], a[0:3], v[76:79]
  s_waitcnt lgkmcnt(14)
  v_mfma_f32_16x16x32_bf16 v[80:83], a[0:3], a[96:99], v[80:83]
  s_bfe_u32 s29, s2, 0x10004
  s_lshl_b32 s39, s20, 1
  s_add_u32 s29, s29, s39
  s_cmp_eq_u32 s29, 0
  s_cbranch_scc0 La_na6
  s_lshr_b32 s29, s2, 0
  s_and_b32 s29, s29, 0
  s_lshl_b64 exec, 1, s29
  buffer_atomic_add v35, v34, s[48:51], 0 offen sc1
  s_mov_b64 exec, -1
La_na6:
  v_mfma_f32_16x16x32_bf16 v[80:83], a[4:7], a[100:103], v[80:83]
  v_mfma_f32_16x16x32_bf16 v[104:107], a[12:15], a[100:103], v[104:107]
  v_mfma_f32_16x16x32_bf16 v[104:107], a[8:11], a[96:99], v[104:107]
  v_mfma_f32_16x16x32_bf16 v[128:131], a[16:19], a[96:99], v[128:131]
  s_add_u32 s29, s35, 0
  v_mfma_f32_16x16x32_bf16 v[128:131], a[20:23], a[100:103], v[128:131]
  buffer_load_dwordx4 a[140:143], v7, s[44:47], s29 offen
  v_mfma_f32_16x16x32_bf16 v[152:155], a[28:31], a[100:103], v[152:155]
  v_mfma_f32_16x16x32_bf16 v[152:155], a[24:27], a[96:99], v[152:155]
  v_mfma_f32_16x16x32_bf16 v[156:159], a[24:27], a[104:107], v[156:159]
  s_add_u32 s29, s35, 458752
  v_mfma_f32_16x16x32_bf16 v[156:159], a[28:31], a[108:111], v[156:159]
  buffer_load_dwordx4 a[140:143], v7, s[44:47], s29 offen
  v_mfma_f32_16x16x32_bf16 v[132:135], a[20:23], a[108:111], v[132:135]
  v_mfma_f32_16x16x32_bf16 v[132:135], a[16:19], a[104:107], v[132:135]
  v_mfma_f32_16x16x32_bf16 v[108:111], a[8:11], a[104:107], v[108:111]
  s_add_u32 s29, s35, 917504
  v_mfma_f32_16x16x32_bf16 v[108:111], a[12:15], a[108:111], v[108:111]
  buffer_load_dwordx4 a[140:143], v7, s[44:47], s29 offen
  v_mfma_f32_16x16x32_bf16 v[84:87], a[4:7], a[108:111], v[84:87]
  v_mfma_f32_16x16x32_bf16 v[84:87], a[0:3], a[104:107], v[84:87]
  s_waitcnt lgkmcnt(12)
  v_mfma_f32_16x16x32_bf16 a[176:179], a[112:115], a[0:3], a[176:179]
  s_add_u32 s29, s35, 1376256
  v_mfma_f32_16x16x32_bf16 a[176:179], a[116:119], a[4:7], a[176:179]
  buffer_load_dwordx4 a[140:143], v7, s[44:47], s29 offen
  v_mfma_f32_16x16x32_bf16 a[180:183], a[116:119], a[12:15], a[180:183]
  v_mfma_f32_16x16x32_bf16 a[180:183], a[112:115], a[8:11], a[180:183]
  v_mfma_f32_16x16x32_bf16 a[184:187], a[112:115], a[16:19], a[184:187]
  v_mfma_f32_16x16x32_bf16 a[184:187], a[116:119], a[20:23], a[184:187]
  v_mfma_f32_16x16x32_bf16 a[188:191], a[116:119], a[28:31], a[188:191]
  v_mfma_f32_16x16x32_bf16 a[188:191], a[112:115], a[24:27], a[188:191]
  s_waitcnt vmcnt(11) lgkmcnt(0)
  s_barrier
  v_mfma_f32_16x16x32_bf16 v[160:163], a[64:67], a[32:35], v[160:163]
  ds_read_b128 a[0:3], v8 offset:0
  s_add_u32 m0, s84, 34816
  v_mfma_f32_16x16x32_bf16 v[160:163], a[68:71], a[36:39], v[160:163]
  buffer_load_dwordx4 v16, s[4:7], s80 offen offset:0  lds
  v_mfma_f32_16x16x32_bf16 v[184:187], a[68:71], a[44:47], v[184:187]
  ds_read_b128 a[4:7], v9 offset:0
  v_mfma_f32_16x16x32_bf16 v[184:187], a[64:67], a[40:43], v[184:187]
  ds_read_b128 a[16:19], v8 offset:4096
  v_mfma_f32_16x16x32_bf16 v[208:211], a[64:67], a[48:51], v[208:211]
  ds_read_b128 a[8:11], v8 offset:2048
  v_mfma_f32_16x16x32_bf16 v[208:211], a[68:71], a[52:55], v[208:211]
  buffer_load_dwordx4 v16, s[4:7], s80 offen offset:2048  lds
  v_mfma_f32_16x16x32_bf16 v[232:235], a[68:71], a[60:63], v[232:235]
  ds_read_b128 a[12:15], v9 offset:2048
  v_mfma_f32_16x16x32_bf16 v[232:235], a[64:67], a[56:59], v[232:235]
  ds_read_b128 a[20:23], v9 offset:4096
  v_mfma_f32_16x16x32_bf16 v[236:239], a[72:75], a[56:59], v[236:239]
  ds_read_b64_tr_b16 a[64:65], v13 offset:0
  v_mfma_f32_16x16x32_bf16 v[236:239], a[76:79], a[60:63], v[236:239]
  v_mfma_f32_16x16x32_bf16 v[212:215], a[76:79], a[52:55], v[212:215]
  ds_read_b64_tr_b16 a[66:67], v13 offset:512
  v_mfma_f32_16x16x32_bf16 v[212:215], a[72:75], a[48:51], v[212:215]
  ds_read_b128 a[24:27], v8 offset:6144
  v_mfma_f32_16x16x32_bf16 v[188:191], a[72:75], a[40:43], v[188:191]
  ds_read_b64_tr_b16 a[68:69], v13 offset:14336
  s_add_u32 m0, s85, 34816
  v_mfma_f32_16x16x32_bf16 v[188:191], a[76:79], a[44:47], v[188:191]
  buffer_load_dwordx4 v16, s[4:7], s81 offen offset:0  lds
  v_mfma_f32_16x16x32_bf16 v[164:167], a[76:79], a[36:39], v[164:167]
  ds_read_b64_tr_b16 a[70:71], v13 offset:14848
  v_mfma_f32_16x16x32_bf16 v[164:167], a[72:75], a[32:35], v[164:167]
  ds_read_b128 a[28:31], v9 offset:6144
  v_mfma_f32_16x16x32_bf16 v[168:171], a[80:83], a[32:35], v[168:171]
  ds_read_b64_tr_b16 a[72:73], v14 offset:0
  v_mfma_f32_16x16x32_bf16 v[168:171], a[84:87], a[36:39], v[168:171]
  v_mfma_f32_16x16x32_bf16 v[192:195], a[84:87], a[44:47], v[192:195]
  ds_read_b64_tr_b16 a[74:75], v14 offset:512
  v_mfma_f32_16x16x32_bf16 v[192:195], a[80:83], a[40:43], v[192:195]
  v_mfma_f32_16x16x32_bf16 v[216:219], a[80:83], a[48:51], v[216:219]
  ds_read_b64_tr_b16 a[76:77], v14 offset:14336
  v_mfma_f32_16x16x32_bf16 v[216:219], a[84:87], a[52:55], v[216:219]
  buffer_load_dwordx4 v16, s[4:7], s81 offen offset:2048  lds
  v_mfma_f32_16x16x32_bf16 v[240:243], a[84:87], a[60:63], v[240:243]
  ds_read_b64_tr_b16 a[78:79], v14 offset:14848
  v_mfma_f32_16x16x32_bf16 v[240:243], a[80:83], a[56:59], v[240:243]
  v_mfma_f32_16x16x32_bf16 v[244:247], a[88:91], a[56:59], v[244:247]
  ds_read_b64_tr_b16 a[80:81], v13 offset:1024
  v_mfma_f32_16x16x32_bf16 v[244:247], a[92:95], a[60:63], v[244:247]
  v_mfma_f32_16x16x32_bf16 v[220:223], a[92:95], a[52:55], v[220:223]
  ds_read_b64_tr_b16 a[82:83], v13 offset:1536
  v_mfma_f32_16x16x32_bf16 v[220:223], a[88:91], a[48:51], v[220:223]
  v_mfma_f32_16x16x32_bf16 v[196:199], a[88:91], a[40:43], v[196:199]
  ds_read_b64_tr_b16 a[84:85], v13 offset:15360
  s_add_u32 m0, s86, 34816
  v_mfma_f32_16x16x32_bf16 v[196:199], a[92:95], a[44:47], v[196:199]
  buffer_load_dwordx4 v16, s[4:7], s82 offen offset:0  lds
  v_mfma_f32_16x16x32_bf16 v[172:175], a[92:95], a[36:39], v[172:175]
  ds_read_b64_tr_b16 a[86:87], v13 offset:15872
  v_mfma_f32_16x16x32_bf16 v[172:175], a[88:91], a[32:35], v[172:175]
  v_mfma_f32_16x16x32_bf16 v[176:179], a[32:35], a[96:99], v[176:179]
  ds_read_b64_tr_b16 a[88:89], v14 offset:1024
  v_mfma_f32_16x16x32_bf16 v[176:179], a[36:39], a[100:103], v[176:179]
  buffer_load_dwordx4 v16, s[4:7], s82 offen offset:2048  lds
  v_mfma_f32_16x16x32_bf16 v[200:203], a[44:47], a[100:103], v[200:203]
  ds_read_b64_tr_b16 a[90:91], v14 offset:1536
  v_mfma_f32_16x16x32_bf16 v[200:203], a[40:43], a[96:99], v[200:203]
  v_mfma_f32_16x16x32_bf16 v[224:227], a[48:51], a[96:99], v[224:227]
  ds_read_b64_tr_b16 a[92:93], v14 offset:15360
  v_mfma_f32_16x16x32_bf16 v[224:227], a[52:55], a[100:103], v[224:227]
  v_mfma_f32_16x16x32_bf16 v[248:251], a[60:63], a[100:103], v[248:251]
  ds_read_b64_tr_b16 a[94:95], v14 offset:15872
  v_mfma_f32_16x16x32_bf16 v[248:251], a[56:59], a[96:99], v[248:251]
  v_mfma_f32_16x16x32_bf16 v[252:255], a[56:59], a[104:107], v[252:255]
  ds_read_b64_tr_b16 a[96:97], v13 offset:2048
  s_add_u32 m0, s87, 34816
  v_mfma_f32_16x16x32_bf16 v[252:255], a[60:63], a[108:111], v[252:255]
  buffer_load_dwordx4 v16, s[4:7], s83 offen offset:0  lds
  v_mfma_f32_16x16x32_bf16 v[228:231], a[52:55], a[108:111], v[228:231]
  ds_read_b64_tr_b16 a[98:99], v13 offset:2560
  v_mfma_f32_16x16x32_bf16 v[228:231], a[48:51], a[104:107], v[228:231]
  v_mfma_f32_16x16x32_bf16 v[204:207], a[40:43], a[104:107], v[204:207]
  ds_read_b64_tr_b16 a[100:101], v13 offset:16384
  v_mfma_f32_16x16x32_bf16 v[204:207], a[44:47], a[108:111], v[204:207]
  v_mfma_f32_16x16x32_bf16 v[180:183], a[36:39], a[108:111], v[180:183]
  ds_read_b64_tr_b16 a[102:103], v13 offset:16896
  v_mfma_f32_16x16x32_bf16 v[180:183], a[32:35], a[104:107], v[180:183]
  v_mfma_f32_16x16x32_bf16 a[192:195], a[112:115], a[32:35], a[192:195]
  ds_read_b64_tr_b16 a[104:105], v14 offset:2048
  v_mfma_f32_16x16x32_bf16 a[192:195], a[116:119], a[36:39], a[192:195]
  buffer_load_dwordx4 v16, s[4:7], s83 offen offset:2048  lds
  v_mfma_f32_16x16x32_bf16 a[196:199], a[116:119], a[44:47], a[196:199]
  ds_read_b64_tr_b16 a[106:107], v14 offset:2560
  s_add_u32 s4, s4, 128
  s_addc_u32 s5, s5, 0
  v_mfma_f32_16x16x32_bf16 a[196:199], a[112:115], a[40:43], a[196:199]
  v_mfma_f32_16x16x32_bf16 a[200:203], a[112:115], a[48:51], a[200:203]
  ds_read_b64_tr_b16 a[108:109], v14 offset:16384
  v_mfma_f32_16x16x32_bf16 a[200:203], a[116:119], a[52:55], a[200:203]
  v_mfma_f32_16x16x32_bf16 a[204:207], a[116:119], a[60:63], a[204:207]
  ds_read_b64_tr_b16 a[110:111], v14 offset:16896
  v_mfma_f32_16x16x32_bf16 a[204:207], a[112:115], a[56:59], a[204:207]
  v_mfma_f32_16x16x32_bf16 v[36:39], a[136:139], a[128:131], v[36:39]
  v_mfma_f32_16x16x32_bf16 v[36:39], a[136:139], a[132:135], v[36:39]
  s_waitcnt lgkmcnt(14)
  v_mfma_f32_16x16x32_bf16 v[64:67], a[64:67], a[0:3], v[64:67]
  ds_read_b64_tr_b16 a[112:113], v15 offset:0
  s_add_u32 m0, s88, 28672
  v_mfma_f32_16x16x32_bf16 v[64:67], a[68:71], a[4:7], v[64:67]
  buffer_load_dwordx4 v18, s[8:11], s94 offen  lds
  v_mfma_f32_16x16x32_bf16 v[88:91], a[68:71], a[12:15], v[88:91]
  ds_read_b64_tr_b16 a[114:115], v15 offset:256
  v_mfma_f32_16x16x32_bf16 v[88:91], a[64:67], a[8:11], v[88:91]
  v_mfma_f32_16x16x32_bf16 v[112:115], a[64:67], a[16:19], v[112:115]
  ds_read_b64_tr_b16 a[116:117], v15 offset:14336
  s_add_u32 m0, s89, 28672
  v_mfma_f32_16x16x32_bf16 v[112:115], a[68:71], a[20:23], v[112:115]
  buffer_load_dwordx4 v18, s[8:11], s95 offen  lds
  v_mfma_f32_16x16x32_bf16 v[136:139], a[68:71], a[28:31], v[136:139]
  ds_read_b64_tr_b16 a[118:119], v15 offset:14592
  v_mfma_f32_16x16x32_bf16 v[136:139], a[64:67], a[24:27], v[136:139]
  v_mfma_f32_16x16x32_bf16 v[140:143], a[72:75], a[24:27], v[140:143]
  ds_read_b128 a[32:35], v8 offset:8192
  s_add_u32 m0, s90, 28672
  v_mfma_f32_16x16x32_bf16 v[140:143], a[76:79], a[28:31], v[140:143]
  buffer_load_dwordx4 v18, s[8:11], s96 offen  lds
  v_mfma_f32_16x16x32_bf16 v[116:119], a[76:79], a[20:23], v[116:119]
  ds_read_b128 a[36:39], v9 offset:8192
  v_mfma_f32_16x16x32_bf16 v[116:119], a[72:75], a[16:19], v[116:119]
  v_mfma_f32_16x16x32_bf16 v[92:95], a[72:75], a[8:11], v[92:95]
  ds_read_b128 a[40:43], v8 offset:10240
  s_add_u32 m0, s91, 28672
  v_mfma_f32_16x16x32_bf16 v[92:95], a[76:79], a[12:15], v[92:95]
  buffer_load_dwordx4 v19, s[8:11], s94 offen  lds
  v_mfma_f32_16x16x32_bf16 v[68:71], a[76:79], a[4:7], v[68:71]
  ds_read_b128 a[44:47], v9 offset:10240
  v_mfma_f32_16x16x32_bf16 v[68:71], a[72:75], a[0:3], v[68:71]
  s_waitcnt lgkmcnt(14)
  v_mfma_f32_16x16x32_bf16 v[72:75], a[80:83], a[0:3], v[72:75]
  ds_read_b128 a[48:51], v8 offset:12288
  s_add_u32 m0, s92, 28672
  v_mfma_f32_16x16x32_bf16 v[72:75], a[84:87], a[4:7], v[72:75]
  buffer_load_dwordx4 v19, s[8:11], s95 offen  lds
  v_mfma_f32_16x16x32_bf16 v[96:99], a[84:87], a[12:15], v[96:99]
  ds_read_b128 a[52:55], v9 offset:12288
  v_mfma_f32_16x16x32_bf16 v[96:99], a[80:83], a[8:11], v[96:99]
  v_mfma_f32_16x16x32_bf16 v[120:123], a[80:83], a[16:19], v[120:123]
  ds_read_b128 a[56:59], v8 offset:14336
  s_add_u32 m0, s93, 28672
  v_mfma_f32_16x16x32_bf16 v[120:123], a[84:87], a[20:23], v[120:123]
  buffer_load_dwordx4 v19, s[8:11], s96 offen  lds
  v_mfma_f32_16x16x32_bf16 v[144:147], a[84:87], a[28:31], v[144:147]
  ds_read_b128 a[60:63], v9 offset:14336
  s_add_u32 s8, s8, 393216
  s_addc_u32 s9, s9, 0
  v_mfma_f32_16x16x32_bf16 v[144:147], a[80:83], a[24:27], v[144:147]
  v_mfma_f32_16x16x32_bf16 v[148:151], a[88:91], a[24:27], v[148:151]
  s_add_u32 m0, s27, 34816
  v_mfma_f32_16x16x32_bf16 v[148:151], a[92:95], a[28:31], v[148:151]
  buffer_load_dwordx4 v20, s[68:71], 0 offen  lds
  v_mfma_f32_16x16x32_bf16 v[124:127], a[92:95], a[20:23], v[124:127]
  s_add_u32 s68, s68, 458752
  s_addc_u32 s69, s69, 0
  v_mfma_f32_16x16x32_bf16 v[124:127], a[88:91], a[16:19], v[124:127]
  v_mfma_f32_16x16x32_bf16 v[100:103], a[88:91], a[8:11], v[100:103]
  s_bfe_u32 s29, s2, 0x10004
  s_lshl_b32 s39, s20, 1
  s_add_u32 s29, s29, s39
  s_cmp_eq_u32 s29, 1
  s_cbranch_scc0 La_na7
  s_lshr_b32 s29, s2, 0
  s_and_b32 s29, s29, 0
  s_lshl_b64 exec, 1, s29
  buffer_atomic_add v35, v34, s[48:51], 0 offen sc1
  s_mov_b64 exec, -1
La_na7:
  v_mfma_f32_16x16x32_bf16 v[100:103], a[92:95], a[12:15], v[100:103]
  v_mfma_f32_16x16x32_bf16 v[76:79], a[92:95], a[4:7], v[76:79]
  v_mfma_f32_16x16x32_bf16 v[76:79], a[88:91], a[0:3], v[76:79]
  s_waitcnt lgkmcnt(14)
  v_mfma_f32_16x16x32_bf16 v[80:83], a[0:3], a[96:99], v[80:83]
  s_add_u32 s29, s35, 1835008
  v_mfma_f32_16x16x32_bf16 v[80:83], a[4:7], a[100:103], v[80:83]
  buffer_load_dwordx4 a[140:143], v7, s[44:47], s29 offen
  v_mfma_f32_16x16x32_bf16 v[104:107], a[12:15], a[100:103], v[104:107]
  v_mfma_f32_16x16x32_bf16 v[104:107], a[8:11], a[96:99], v[104:107]
  v_mfma_f32_16x16x32_bf16 v[128:131], a[16:19], a[96:99], v[128:131]
  s_add_u32 s29, s35, 2293760
  v_mfma_f32_16x16x32_bf16 v[128:131], a[20:23], a[100:103], v[128:131]
  buffer_load_dwordx4 a[140:143], v7, s[44:47], s29 offen
  v_mfma_f32_16x16x32_bf16 v[152:155], a[28:31], a[100:103], v[152:155]
  v_mfma_f32_16x16x32_bf16 v[152:155], a[24:27], a[96:99], v[152:155]
  s_waitcnt lgkmcnt(12)
  v_mfma_f32_16x16x32_bf16 v[156:159], a[24:27], a[104:107], v[156:159]
  s_add_u32 s29, s35, 2752512
  v_mfma_f32_16x16x32_bf16 v[156:159], a[28:31], a[108:111], v[156:159]
  buffer_load_dwordx4 a[140:143], v7, s[44:47], s29 offen
  v_mfma_f32_16x16x32_bf16 v[132:135], a[20:23], a[108:111], v[132:135]
  v_mfma_f32_16x16x32_bf16 v[132:135], a[16:19], a[104:107], v[132:135]
  v_mfma_f32_16x16x32_bf16 v[108:111], a[8:11], a[104:107], v[108:111]
  s_add_u32 s29, s35, 3211264
  v_mfma_f32_16x16x32_bf16 v[108:111], a[12:15], a[108:111], v[108:111]
  buffer_load_dwordx4 a[140:143], v7, s[44:47], s29 offen
  v_mfma_f32_16x16x32_bf16 v[84:87], a[4:7], a[108:111], v[84:87]
  v_mfma_f32_16x16x32_bf16 v[84:87], a[0:3], a[104:107], v[84:87]
  s_waitcnt lgkmcnt(8)
  v_mfma_f32_16x16x32_bf16 a[176:179], a[112:115], a[0:3], a[176:179]
  v_mov_b32 v37, 1
  s_mov_b32 exec_lo, s38
  s_mov_b32 exec_hi, 0
  s_cbranch_execz La_ncs
  buffer_store_dwordx2 v[36:37], v31, s[16:19], 0 offen sc1
La_ncs:
  s_mov_b64 exec, -1
  v_mfma_f32_16x16x32_bf16 a[176:179], a[116:119], a[4:7], a[176:179]
  v_mfma_f32_16x16x32_bf16 a[180:183], a[116:119], a[12:15], a[180:183]
  v_mfma_f32_16x16x32_bf16 a[180:183], a[112:115], a[8:11], a[180:183]
  v_mfma_f32_16x16x32_bf16 a[184:187], a[112:115], a[16:19], a[184:187]
  v_mfma_f32_16x16x32_bf16 a[184:187], a[116:119], a[20:23], a[184:187]
  v_mfma_f32_16x16x32_bf16 a[188:191], a[116:119], a[28:31], a[188:191]
  v_mfma_f32_16x16x32_bf16 a[188:191], a[112:115], a[24:27], a[188:191]
  s_waitcnt vmcnt(11) lgkmcnt(0)
  s_barrier
  v_mfma_f32_16x16x32_bf16 v[160:163], a[64:67], a[32:35], v[160:163]
  ds_read_b128 a[0:3], v8 offset:34816
  s_add_u32 m0, s84, 0
  v_mfma_f32_16x16x32_bf16 v[160:163], a[68:71], a[36:39], v[160:163]
  buffer_load_dwordx4 v16, s[4:7], s80 offen offset:0  lds
  v_mfma_f32_16x16x32_bf16 v[184:187], a[68:71], a[44:47], v[184:187]
  ds_read_b128 a[4:7], v9 offset:34816
  v_mfma_f32_16x16x32_bf16 v[184:187], a[64:67], a[40:43], v[184:187]
  ds_read_b128 a[16:19], v8 offset:38912
  v_mfma_f32_16x16x32_bf16 v[208:211], a[64:67], a[48:51], v[208:211]
  ds_read_b128 a[8:11], v8 offset:36864
  v_mfma_f32_16x16x32_bf16 v[208:211], a[68:71], a[52:55], v[208:211]
  buffer_load_dwordx4 v16, s[4:7], s80 offen offset:2048  lds
  v_mfma_f32_16x16x32_bf16 v[232:235], a[68:71], a[60:63], v[232:235]
  ds_read_b128 a[12:15], v9 offset:36864
  v_mfma_f32_16x16x32_bf16 v[232:235], a[64:67], a[56:59], v[232:235]
  ds_read_b128 a[20:23], v9 offset:38912
  v_mfma_f32_16x16x32_bf16 v[236:239], a[72:75], a[56:59], v[236:239]
  ds_read_b64_tr_b16 a[64:65], v10 offset:0
  v_mfma_f32_16x16x32_bf16 v[236:239], a[76:79], a[60:63], v[236:239]
  v_mfma_f32_16x16x32_bf16 v[212:215], a[76:79], a[52:55], v[212:215]
  ds_read_b64_tr_b16 a[66:67], v10 offset:512
  v_mfma_f32_16x16x32_bf16 v[212:215], a[72:75], a[48:51], v[212:215]
  ds_read_b128 a[24:27], v8 offset:40960
  v_mfma_f32_16x16x32_bf16 v[188:191], a[72:75], a[40:43], v[188:191]
  ds_read_b64_tr_b16 a[68:69], v10 offset:14336
  s_add_u32 m0, s85, 0
  v_mfma_f32_16x16x32_bf16 v[188:191], a[76:79], a[44:47], v[188:191]
  buffer_load_dwordx4 v16, s[4:7], s81 offen offset:0  lds
  v_mfma_f32_16x16x32_bf16 v[164:167], a[76:79], a[36:39], v[164:167]
  ds_read_b64_tr_b16 a[70:71], v10 offset:14848
  v_mfma_f32_16x16x32_bf16 v[164:167], a[72:75], a[32:35], v[164:167]
  ds_read_b128 a[28:31], v9 offset:40960
  v_mfma_f32_16x16x32_bf16 v[168:171], a[80:83], a[32:35], v[168:171]
  ds_read_b64_tr_b16 a[72:73], v11 offset:0
  v_mfma_f32_16x16x32_bf16 v[168:171], a[84:87], a[36:39], v[168:171]
  v_mfma_f32_16x16x32_bf16 v[192:195], a[84:87], a[44:47], v[192:195]
  ds_read_b64_tr_b16 a[74:75], v11 offset:512
  v_mfma_f32_16x16x32_bf16 v[192:195], a[80:83], a[40:43], v[192:195]
  v_mfma_f32_16x16x32_bf16 v[216:219], a[80:83], a[48:51], v[216:219]
  ds_read_b64_tr_b16 a[76:77], v11 offset:14336
  v_mfma_f32_16x16x32_bf16 v[216:219], a[84:87], a[52:55], v[216:219]
  buffer_load_dwordx4 v16, s[4:7], s81 offen offset:2048  lds
  v_mfma_f32_16x16x32_bf16 v[240:243], a[84:87], a[60:63], v[240:243]
  ds_read_b64_tr_b16 a[78:79], v11 offset:14848
  v_mfma_f32_16x16x32_bf16 v[240:243], a[80:83], a[56:59], v[240:243]
  v_mfma_f32_16x16x32_bf16 v[244:247], a[88:91], a[56:59], v[244:247]
  ds_read_b64_tr_b16 a[80:81], v10 offset:1024
  v_mfma_f32_16x16x32_bf16 v[244:247], a[92:95], a[60:63], v[244:247]
  v_mfma_f32_16x16x32_bf16 v[220:223], a[92:95], a[52:55], v[220:223]
  ds_read_b64_tr_b16 a[82:83], v10 offset:1536
  v_mfma_f32_16x16x32_bf16 v[220:223], a[88:91], a[48:51], v[220:223]
  v_mfma_f32_16x16x32_bf16 v[196:199], a[88:91], a[40:43], v[196:199]
  ds_read_b64_tr_b16 a[84:85], v10 offset:15360
  s_add_u32 m0, s86, 0
  v_mfma_f32_16x16x32_bf16 v[196:199], a[92:95], a[44:47], v[196:199]
  buffer_load_dwordx4 v16, s[4:7], s82 offen offset:0  lds
  v_mfma_f32_16x16x32_bf16 v[172:175], a[92:95], a[36:39], v[172:175]
  ds_read_b64_tr_b16 a[86:87], v10 offset:15872
  v_mfma_f32_16x16x32_bf16 v[172:175], a[88:91], a[32:35], v[172:175]
  v_mfma_f32_16x16x32_bf16 v[176:179], a[32:35], a[96:99], v[176:179]
  ds_read_b64_tr_b16 a[88:89], v11 offset:1024
  v_mfma_f32_16x16x32_bf16 v[176:179], a[36:39], a[100:103], v[176:179]
  buffer_load_dwordx4 v16, s[4:7], s82 offen offset:2048  lds
  v_mfma_f32_16x16x32_bf16 v[200:203], a[44:47], a[100:103], v[200:203]
  ds_read_b64_tr_b16 a[90:91], v11 offset:1536
  v_mfma_f32_16x16x32_bf16 v[200:203], a[40:43], a[96:99], v[200:203]
  v_mfma_f32_16x16x32_bf16 v[224:227], a[48:51], a[96:99], v[224:227]
  ds_read_b64_tr_b16 a[92:93], v11 offset:15360
  v_mfma_f32_16x16x32_bf16 v[224:227], a[52:55], a[100:103], v[224:227]
  v_mfma_f32_16x16x32_bf16 v[248:251], a[60:63], a[100:103], v[248:251]
  ds_read_b64_tr_b16 a[94:95], v11 offset:15872
  v_mfma_f32_16x16x32_bf16 v[248:251], a[56:59], a[96:99], v[248:251]
  v_mfma_f32_16x16x32_bf16 v[252:255], a[56:59], a[104:107], v[252:255]
  ds_read_b64_tr_b16 a[96:97], v10 offset:2048
  s_add_u32 m0, s87, 0
  v_mfma_f32_16x16x32_bf16 v[252:255], a[60:63], a[108:111], v[252:255]
  buffer_load_dwordx4 v16, s[4:7], s83 offen offset:0  lds
  v_mfma_f32_16x16x32_bf16 v[228:231], a[52:55], a[108:111], v[228:231]
  ds_read_b64_tr_b16 a[98:99], v10 offset:2560
  v_mfma_f32_16x16x32_bf16 v[228:231], a[48:51], a[104:107], v[228:231]
  v_mfma_f32_16x16x32_bf16 v[204:207], a[40:43], a[104:107], v[204:207]
  ds_read_b64_tr_b16 a[100:101], v10 offset:16384
  v_mfma_f32_16x16x32_bf16 v[204:207], a[44:47], a[108:111], v[204:207]
  v_mfma_f32_16x16x32_bf16 v[180:183], a[36:39], a[108:111], v[180:183]
  ds_read_b64_tr_b16 a[102:103], v10 offset:16896
  v_mfma_f32_16x16x32_bf16 v[180:183], a[32:35], a[104:107], v[180:183]
  v_mfma_f32_16x16x32_bf16 a[192:195], a[112:115], a[32:35], a[192:195]
La_pad4:
  s_cbranch_execz La_ret0
  s_nop 0
  ds_read_b64_tr_b16 a[104:105], v11 offset:2048
  v_mfma_f32_16x16x32_bf16 a[192:195], a[116:119], a[36:39], a[192:195]
  buffer_load_dwordx4 v16, s[4:7], s83 offen offset:2048  lds
  v_mfma_f32_16x16x32_bf16 a[196:199], a[116:119], a[44:47], a[196:199]
  ds_read_b64_tr_b16 a[106:107], v11 offset:2560
  s_add_u32 s4, s4, 128
  s_addc_u32 s5, s5, 0
  v_mfma_f32_16x16x32_bf16 a[196:199], a[112:115], a[40:43], a[196:199]
  v_mfma_f32_16x16x32_bf16 a[200:203], a[112:115], a[48:51], a[200:203]
  ds_read_b64_tr_b16 a[108:109], v11 offset:16384
  v_mfma_f32_16x16x32_bf16 a[200:203], a[116:119], a[52:55], a[200:203]
  v_mfma_f32_16x16x32_bf16 a[204:207], a[116:119], a[60:63], a[204:207]
  ds_read_b64_tr_b16 a[110:111], v11 offset:16896
  v_mfma_f32_16x16x32_bf16 a[204:207], a[112:115], a[56:59], a[204:207]
  s_waitcnt lgkmcnt(14)
  v_mfma_f32_16x16x32_bf16 v[64:67], a[64:67], a[0:3], v[64:67]
  ds_read_b64_tr_b16 a[112:113], v12 offset:0
  s_add_u32 m0, s88, 57344
  v_mfma_f32_16x16x32_bf16 v[64:67], a[68:71], a[4:7], v[64:67]
  buffer_load_dwordx4 v18, s[8:11], s94 offen  lds
  v_mfma_f32_16x16x32_bf16 v[88:91], a[68:71], a[12:15], v[88:91]
  ds_read_b64_tr_b16 a[114:115], v12 offset:256
  v_mfma_f32_16x16x32_bf16 v[88:91], a[64:67], a[8:11], v[88:91]
  v_mfma_f32_16x16x32_bf16 v[112:115], a[64:67], a[16:19], v[112:115]
  ds_read_b64_tr_b16 a[116:117], v12 offset:14336
  s_add_u32 m0, s89, 57344
  v_mfma_f32_16x16x32_bf16 v[112:115], a[68:71], a[20:23], v[112:115]
  buffer_load_dwordx4 v18, s[8:11], s95 offen  lds
  v_mfma_f32_16x16x32_bf16 v[136:139], a[68:71], a[28:31], v[136:139]
  ds_read_b64_tr_b16 a[118:119], v12 offset:14592
  v_mfma_f32_16x16x32_bf16 v[136:139], a[64:67], a[24:27], v[136:139]
  v_mfma_f32_16x16x32_bf16 v[140:143], a[72:75], a[24:27], v[140:143]
  ds_read_b128 a[32:35], v8 offset:43008
  s_add_u32 m0, s90, 57344
  v_mfma_f32_16x16x32_bf16 v[140:143], a[76:79], a[28:31], v[140:143]
  buffer_load_dwordx4 v18, s[8:11], s96 offen  lds
  v_mfma_f32_16x16x32_bf16 v[116:119], a[76:79], a[20:23], v[116:119]
  ds_read_b128 a[36:39], v9 offset:43008
  v_mfma_f32_16x16x32_bf16 v[116:119], a[72:75], a[16:19], v[116:119]
  v_mfma_f32_16x16x32_bf16 v[92:95], a[72:75], a[8:11], v[92:95]
  ds_read_b128 a[40:43], v8 offset:45056
  s_add_u32 m0, s91, 57344
  v_mfma_f32_16x16x32_bf16 v[92:95], a[76:79], a[12:15], v[92:95]
  buffer_load_dwordx4 v19, s[8:11], s94 offen  lds
  v_mfma_f32_16x16x32_bf16 v[68:71], a[76:79], a[4:7], v[68:71]
  ds_read_b128 a[44:47], v9 offset:45056
  v_mfma_f32_16x16x32_bf16 v[68:71], a[72:75], a[0:3], v[68:71]
  s_waitcnt lgkmcnt(14)
  v_mfma_f32_16x16x32_bf16 v[72:75], a[80:83], a[0:3], v[72:75]
  ds_read_b128 a[48:51], v8 offset:47104
  v_mfma_f32_16x16x32_bf16 v[72:75], a[84:87], a[4:7], v[72:75]
  v_mfma_f32_16x16x32_bf16 v[96:99], a[84:87], a[12:15], v[96:99]
  ds_read_b128 a[52:55], v9 offset:47104
  v_mfma_f32_16x16x32_bf16 v[96:99], a[80:83], a[8:11], v[96:99]
  v_mfma_f32_16x16x32_bf16 v[120:123], a[80:83], a[16:19], v[120:123]
  ds_read_b128 a[56:59], v8 offset:49152
  s_add_u32 m0, s92, 57344
  v_mfma_f32_16x16x32_bf16 v[120:123], a[84:87], a[20:23], v[120:123]
  buffer_load_dwordx4 v19, s[8:11], s95 offen  lds
  v_mfma_f32_16x16x32_bf16 v[144:147], a[84:87], a[28:31], v[144:147]
  ds_read_b128 a[60:63], v9 offset:49152
  v_mfma_f32_16x16x32_bf16 v[144:147], a[80:83], a[24:27], v[144:147]
  v_mfma_f32_16x16x32_bf16 v[148:151], a[88:91], a[24:27], v[148:151]
  s_add_u32 m0, s93, 57344
  v_mfma_f32_16x16x32_bf16 v[148:151], a[92:95], a[28:31], v[148:151]
  buffer_load_dwordx4 v19, s[8:11], s96 offen  lds
  v_mfma_f32_16x16x32_bf16 v[124:127], a[92:95], a[20:23], v[124:127]
  s_add_u32 s8, s8, 393216
  s_addc_u32 s9, s9, 0
  v_mfma_f32_16x16x32_bf16 v[124:127], a[88:91], a[16:19], v[124:127]
  v_mfma_f32_16x16x32_bf16 v[100:103], a[88:91], a[8:11], v[100:103]
  s_add_u32 m0, s27, 63488
  v_mfma_f32_16x16x32_bf16 v[100:103], a[92:95], a[12:15], v[100:103]
  buffer_load_dwordx4 v20, s[68:71], 0 offen  lds
  v_mfma_f32_16x16x32_bf16 v[76:79], a[92:95], a[4:7], v[76:79]
  s_add_u32 s68, s68, 458752
  s_addc_u32 s69, s69, 0
  v_mfma_f32_16x16x32_bf16 v[76:79], a[88:91], a[0:3], v[76:79]
  s_waitcnt lgkmcnt(14)
  v_mfma_f32_16x16x32_bf16 v[80:83], a[0:3], a[96:99], v[80:83]
  s_add_u32 s29, s35, 3670016
  v_mfma_f32_16x16x32_bf16 v[80:83], a[4:7], a[100:103], v[80:83]
  buffer_load_dwordx4 a[140:143], v7, s[44:47], s29 offen
  v_mfma_f32_16x16x32_bf16 v[104:107], a[12:15], a[100:103], v[104:107]
  v_mfma_f32_16x16x32_bf16 v[104:107], a[8:11], a[96:99], v[104:107]
  v_mfma_f32_16x16x32_bf16 v[128:131], a[16:19], a[96:99], v[128:131]
  v_mfma_f32_16x16x32_bf16 v[128:131], a[20:23], a[100:103], v[128:131]
  v_mfma_f32_16x16x32_bf16 v[152:155], a[28:31], a[100:103], v[152:155]
  v_mfma_f32_16x16x32_bf16 v[152:155], a[24:27], a[96:99], v[152:155]
  s_waitcnt lgkmcnt(12)
  v_mfma_f32_16x16x32_bf16 v[156:159], a[24:27], a[104:107], v[156:159]
  s_add_u32 s29, s35, 4128768
  v_mfma_f32_16x16x32_bf16 v[156:159], a[28:31], a[108:111], v[156:159]
  buffer_load_dwordx4 a[140:143], v7, s[44:47], s29 offen
  v_mfma_f32_16x16x32_bf16 v[132:135], a[20:23], a[108:111], v[132:135]
  v_mfma_f32_16x16x32_bf16 v[132:135], a[16:19], a[104:107], v[132:135]
  v_mfma_f32_16x16x32_bf16 v[108:111], a[8:11], a[104:107], v[108:111]
  s_add_u32 s29, s35, 4587520
  v_mfma_f32_16x16x32_bf16 v[108:111], a[12:15], a[108:111], v[108:111]
  buffer_load_dwordx4 a[140:143], v7, s[44:47], s29 offen
  v_mfma_f32_16x16x32_bf16 v[84:87], a[4:7], a[108:111], v[84:87]
  v_mfma_f32_16x16x32_bf16 v[84:87], a[0:3], a[104:107], v[84:87]
  s_waitcnt lgkmcnt(8)
  v_mfma_f32_16x16x32_bf16 a[176:179], a[112:115], a[0:3], a[176:179]
  s_add_u32 s29, s35, 5046272
  v_mfma_f32_16x16x32_bf16 a[176:179], a[116:119], a[4:7], a[176:179]
  buffer_load_dwordx4 a[140:143], v7, s[44:47], s29 offen
  v_mfma_f32_16x16x32_bf16 a[180:183], a[116:119], a[12:15], a[180:183]
  v_mfma_f32_16x16x32_bf16 a[180:183], a[112:115], a[8:11], a[180:183]
  v_mfma_f32_16x16x32_bf16 a[184:187], a[112:115], a[16:19], a[184:187]
  v_mfma_f32_16x16x32_bf16 a[184:187], a[116:119], a[20:23], a[184:187]
  v_mfma_f32_16x16x32_bf16 a[188:191], a[116:119], a[28:31], a[188:191]
  v_mfma_f32_16x16x32_bf16 a[188:191], a[112:115], a[24:27], a[188:191]
  s_waitcnt vmcnt(11) lgkmcnt(0)
  s_barrier
  v_mfma_f32_16x16x32_bf16 v[160:163], a[64:67], a[32:35], v[160:163]
  ds_read_b128 a[0:3], v8 offset:0
  s_add_u32 m0, s84, 34816
  v_mfma_f32_16x16x32_bf16 v[160:163], a[68:71], a[36:39], v[160:163]
  buffer_load_dwordx4 v16, s[4:7], s80 offen offset:0  lds
  v_mfma_f32_16x16x32_bf16 v[184:187], a[68:71], a[44:47], v[184:187]
  ds_read_b128 a[4:7], v9 offset:0
  v_mov_b32 v27, 0xf149f2ca
  v_mfma_f32_16x16x32_bf16 v[184:187], a[64:67], a[40:43], v[184:187]
  ds_read_b128 a[16:19], v8 offset:4096
  v_mfma_f32_16x16x32_bf16 v[208:211], a[64:67], a[48:51], v[208:211]
  ds_read_b128 a[8:11], v8 offset:2048
  v_lshlrev_b32 v28, 2, v3
  v_mfma_f32_16x16x32_bf16 v[208:211], a[68:71], a[52:55], v[208:211]
  buffer_load_dwordx4 v16, s[4:7], s80 offen offset:2048  lds
  v_mfma_f32_16x16x32_bf16 v[232:235], a[68:71], a[60:63], v[232:235]
  ds_read_b128 a[12:15], v9 offset:2048
  v_sub_u32_e64 v28, v28, v4
  v_mfma_f32_16x16x32_bf16 v[232:235], a[64:67], a[56:59], v[232:235]
  ds_read_b128 a[20:23], v9 offset:4096
  v_mfma_f32_16x16x32_bf16 v[236:239], a[72:75], a[56:59], v[236:239]
  ds_read_b64_tr_b16 a[64:65], v10 offset:28672
  s_or_b32 s29, s23, s21
  s_cmp_lg_u32 s29, 0
  s_cselect_b64 s[30:31], -1, 0
  v_mfma_f32_16x16x32_bf16 v[236:239], a[76:79], a[60:63], v[236:239]
  v_mfma_f32_16x16x32_bf16 v[212:215], a[76:79], a[52:55], v[212:215]
  ds_read_b64_tr_b16 a[66:67], v10 offset:29184
  v_add_u32 v32, 7, v28
  v_mfma_f32_16x16x32_bf16 v[212:215], a[72:75], a[48:51], v[212:215]
  ds_read_b128 a[24:27], v8 offset:6144
  v_mfma_f32_16x16x32_bf16 v[188:191], a[72:75], a[40:43], v[188:191]
  ds_read_b64_tr_b16 a[68:69], v10 offset:43008
  v_cmp_gt_u32_e64 vcc, 8, v32
  s_add_u32 m0, s85, 34816
  v_mfma_f32_16x16x32_bf16 v[188:191], a[76:79], a[44:47], v[188:191]
  buffer_load_dwordx4 v16, s[4:7], s81 offen offset:0  lds
  v_mfma_f32_16x16x32_bf16 v[164:167], a[76:79], a[36:39], v[164:167]
  ds_read_b64_tr_b16 a[70:71], v10 offset:43520
  v_cndmask_b32 v33, v27, 0, vcc
  v_mfma_f32_16x16x32_bf16 v[164:167], a[72:75], a[32:35], v[164:167]
  ds_read_b128 a[28:31], v9 offset:6144
  v_mfma_f32_16x16x32_bf16 v[168:171], a[80:83], a[32:35], v[168:171]
  ds_read_b64_tr_b16 a[72:73], v11 offset:28672
  v_accvgpr_write_b32 a160, v33
  v_mfma_f32_16x16x32_bf16 v[168:171], a[84:87], a[36:39], v[168:171]
  v_mfma_f32_16x16x32_bf16 v[192:195], a[84:87], a[44:47], v[192:195]
  ds_read_b64_tr_b16 a[74:75], v11 offset:29184
  v_cmp_lt_i32_e64 vcc, 15, v32
  v_mfma_f32_16x16x32_bf16 v[192:195], a[80:83], a[40:43], v[192:195]
  v_mfma_f32_16x16x32_bf16 v[216:219], a[80:83], a[48:51], v[216:219]
  ds_read_b64_tr_b16 a[76:77], v11 offset:43008
  v_cndmask_b32 v33, v27, 0, vcc
  v_mfma_f32_16x16x32_bf16 v[216:219], a[84:87], a[52:55], v[216:219]
  buffer_load_dwordx4 v16, s[4:7], s81 offen offset:2048  lds
  v_mfma_f32_16x16x32_bf16 v[240:243], a[84:87], a[60:63], v[240:243]
  ds_read_b64_tr_b16 a[78:79], v11 offset:43520
  v_accvgpr_write_b32 a164, v33
  v_mfma_f32_16x16x32_bf16 v[240:243], a[80:83], a[56:59], v[240:243]
  v_mfma_f32_16x16x32_bf16 v[244:247], a[88:91], a[56:59], v[244:247]
  ds_read_b64_tr_b16 a[80:81], v10 offset:29696
  s_and_b64 vcc, vcc, s[30:31]
  v_mfma_f32_16x16x32_bf16 v[244:247], a[92:95], a[60:63], v[244:247]
  v_mfma_f32_16x16x32_bf16 v[220:223], a[92:95], a[52:55], v[220:223]
  ds_read_b64_tr_b16 a[82:83], v10 offset:30208
  v_mfma_f32_16x16x32_bf16 v[220:223], a[88:91], a[48:51], v[220:223]
  v_cndmask_b32 v33, v27, 0, vcc
  v_mfma_f32_16x16x32_bf16 v[196:199], a[88:91], a[40:43], v[196:199]
  ds_read_b64_tr_b16 a[84:85], v10 offset:44032
  s_add_u32 m0, s86, 34816
  v_mfma_f32_16x16x32_bf16 v[196:199], a[92:95], a[44:47], v[196:199]
  v_accvgpr_write_b32 a168, v33
  buffer_load_dwordx4 v16, s[4:7], s82 offen offset:0  lds
  v_mfma_f32_16x16x32_bf16 v[172:175], a[92:95], a[36:39], v[172:175]
  ds_read_b64_tr_b16 a[86:87], v10 offset:44544
  v_mfma_f32_16x16x32_bf16 v[172:175], a[88:91], a[32:35], v[172:175]
  v_add_u32 v32, 8, v28
  v_mfma_f32_16x16x32_bf16 v[176:179], a[32:35], a[96:99], v[176:179]
  ds_read_b64_tr_b16 a[88:89], v11 offset:29696
  v_mfma_f32_16x16x32_bf16 v[176:179], a[36:39], a[100:103], v[176:179]
  v_cmp_gt_u32_e64 vcc, 8, v32
  buffer_load_dwordx4 v16, s[4:7], s82 offen offset:2048  lds
  v_mfma_f32_16x16x32_bf16 v[200:203], a[44:47], a[100:103], v[200:203]
  ds_read_b64_tr_b16 a[90:91], v11 offset:30208
  v_mfma_f32_16x16x32_bf16 v[200:203], a[40:43], a[96:99], v[200:203]
  v_cndmask_b32 v33, v27, 0, vcc
  v_mfma_f32_16x16x32_bf16 v[224:227], a[48:51], a[96:99], v[224:227]
  ds_read_b64_tr_b16 a[92:93], v11 offset:44032
  v_mfma_f32_16x16x32_bf16 v[224:227], a[52:55], a[100:103], v[224:227]
  v_accvgpr_write_b32 a161, v33
  v_mfma_f32_16x16x32_bf16 v[248:251], a[60:63], a[100:103], v[248:251]
  ds_read_b64_tr_b16 a[94:95], v11 offset:44544
  v_mfma_f32_16x16x32_bf16 v[248:251], a[56:59], a[96:99], v[248:251]
  v_cmp_lt_i32_e64 vcc, 15, v32
  v_mfma_f32_16x16x32_bf16 v[252:255], a[56:59], a[104:107], v[252:255]
  ds_read_b64_tr_b16 a[96:97], v10 offset:30720
  s_add_u32 m0, s87, 34816
  v_mfma_f32_16x16x32_bf16 v[252:255], a[60:63], a[108:111], v[252:255]
  v_cndmask_b32 v33, v27, 0, vcc
  buffer_load_dwordx4 v16, s[4:7], s83 offen offset:0  lds
  v_mfma_f32_16x16x32_bf16 v[228:231], a[52:55], a[108:111], v[228:231]
  ds_read_b64_tr_b16 a[98:99], v10 offset:31232
  v_mfma_f32_16x16x32_bf16 v[228:231], a[48:51], a[104:107], v[228:231]
  v_accvgpr_write_b32 a165, v33
  v_mfma_f32_16x16x32_bf16 v[204:207], a[40:43], a[104:107], v[204:207]
  ds_read_b64_tr_b16 a[100:101], v10 offset:45056
  v_mfma_f32_16x16x32_bf16 v[204:207], a[44:47], a[108:111], v[204:207]
  s_and_b64 vcc, vcc, s[30:31]
  v_mfma_f32_16x16x32_bf16 v[180:183], a[36:39], a[108:111], v[180:183]
  ds_read_b64_tr_b16 a[102:103], v10 offset:45568
  v_mfma_f32_16x16x32_bf16 v[180:183], a[32:35], a[104:107], v[180:183]
  v_cndmask_b32 v33, v27, 0, vcc
  v_mfma_f32_16x16x32_bf16 a[192:195], a[112:115], a[32:35], a[192:195]
  ds_read_b64_tr_b16 a[104:105], v11 offset:30720
  v_mfma_f32_16x16x32_bf16 a[192:195], a[116:119], a[36:39], a[192:195]
  v_accvgpr_write_b32 a169, v33
  buffer_load_dwordx4 v16, s[4:7], s83 offen offset:2048  lds
  v_mfma_f32_16x16x32_bf16 a[196:199], a[116:119], a[44:47], a[196:199]
  ds_read_b64_tr_b16 a[106:107], v11 offset:31232
  s_add_u32 s4, s4, 128
  s_addc_u32 s5, s5, 0
  v_mfma_f32_16x16x32_bf16 a[196:199], a[112:115], a[40:43], a[196:199]
  v_mfma_f32_16x16x32_bf16 a[200:203], a[112:115], a[48:51], a[200:203]
  ds_read_b64_tr_b16 a[108:109], v11 offset:45056
  v_mfma_f32_16x16x32_bf16 a[200:203], a[116:119], a[52:55], a[200:203]
  v_mfma_f32_16x16x32_bf16 a[204:207], a[116:119], a[60:63], a[204:207]
  ds_read_b64_tr_b16 a[110:111], v11 offset:45568
  v_mfma_f32_16x16x32_bf16 a[204:207], a[112:115], a[56:59], a[204:207]
  s_waitcnt lgkmcnt(14)
  v_mfma_f32_16x16x32_bf16 v[64:67], a[64:67], a[0:3], v[64:67]
  ds_read_b64_tr_b16 a[112:113], v12 offset:28672
  s_add_u32 m0, s88, 0
  v_mfma_f32_16x16x32_bf16 v[64:67], a[68:71], a[4:7], v[64:67]
  buffer_load_dwordx4 v18, s[8:11], s94 offen  lds
  v_mfma_f32_16x16x32_bf16 v[88:91], a[68:71], a[12:15], v[88:91]
  ds_read_b64_tr_b16 a[114:115], v12 offset:28928
  v_mfma_f32_16x16x32_bf16 v[88:91], a[64:67], a[8:11], v[88:91]
  v_mfma_f32_16x16x32_bf16 v[112:115], a[64:67], a[16:19], v[112:115]
  ds_read_b64_tr_b16 a[116:117], v12 offset:43008
  s_add_u32 m0, s89, 0
  v_mfma_f32_16x16x32_bf16 v[112:115], a[68:71], a[20:23], v[112:115]
  buffer_load_dwordx4 v18, s[8:11], s95 offen  lds
  v_mfma_f32_16x16x32_bf16 v[136:139], a[68:71], a[28:31], v[136:139]
  ds_read_b64_tr_b16 a[118:119], v12 offset:43264
  v_mfma_f32_16x16x32_bf16 v[136:139], a[64:67], a[24:27], v[136:139]
  v_mfma_f32_16x16x32_bf16 v[140:143], a[72:75], a[24:27], v[140:143]
  ds_read_b128 a[32:35], v8 offset:8192
  s_add_u32 m0, s90, 0
  v_mfma_f32_16x16x32_bf16 v[140:143], a[76:79], a[28:31], v[140:143]
  buffer_load_dwordx4 v18, s[8:11], s96 offen  lds
  v_mfma_f32_16x16x32_bf16 v[116:119], a[76:79], a[20:23], v[116:119]
  ds_read_b128 a[36:39], v9 offset:8192
  v_mfma_f32_16x16x32_bf16 v[116:119], a[72:75], a[16:19], v[116:119]
  v_mfma_f32_16x16x32_bf16 v[92:95], a[72:75], a[8:11], v[92:95]
  ds_read_b128 a[40:43], v8 offset:10240
  s_add_u32 m0, s91, 0
  v_mfma_f32_16x16x32_bf16 v[92:95], a[76:79], a[12:15], v[92:95]
  buffer_load_dwordx4 v19, s[8:11], s94 offen  lds
  v_mfma_f32_16x16x32_bf16 v[68:71], a[76:79], a[4:7], v[68:71]
  ds_read_b128 a[44:47], v9 offset:10240
  v_mfma_f32_16x16x32_bf16 v[68:71], a[72:75], a[0:3], v[68:71]
  s_waitcnt lgkmcnt(14)
  v_mfma_f32_16x16x32_bf16 v[72:75], a[80:83], a[0:3], v[72:75]
  ds_read_b128 a[48:51], v8 offset:12288
  v_mfma_f32_16x16x32_bf16 v[72:75], a[84:87], a[4:7], v[72:75]
  v_mfma_f32_16x16x32_bf16 v[96:99], a[84:87], a[12:15], v[96:99]
  ds_read_b128 a[52:55], v9 offset:12288
  v_mfma_f32_16x16x32_bf16 v[96:99], a[80:83], a[8:11], v[96:99]
  v_mfma_f32_16x16x32_bf16 v[120:123], a[80:83], a[16:19], v[120:123]
  ds_read_b128 a[56:59], v8 offset:14336
  s_add_u32 m0, s92, 0
  v_mfma_f32_16x16x32_bf16 v[120:123], a[84:87], a[20:23], v[120:123]
  buffer_load_dwordx4 v19, s[8:11], s95 offen  lds
  v_mfma_f32_16x16x32_bf16 v[144:147], a[84:87], a[28:31], v[144:147]
  ds_read_b128 a[60:63], v9 offset:14336
  v_mfma_f32_16x16x32_bf16 v[144:147], a[80:83], a[24:27], v[144:147]
  v_mfma_f32_16x16x32_bf16 v[148:151], a[88:91], a[24:27], v[148:151]
  s_add_u32 m0, s93, 0
  v_mfma_f32_16x16x32_bf16 v[148:151], a[92:95], a[28:31], v[148:151]
  buffer_load_dwordx4 v19, s[8:11], s96 offen  lds
  v_mfma_f32_16x16x32_bf16 v[124:127], a[92:95], a[20:23], v[124:127]
  s_add_u32 s8, s8, 393216
  s_addc_u32 s9, s9, 0
  v_mfma_f32_16x16x32_bf16 v[124:127], a[88:91], a[16:19], v[124:127]
  v_mfma_f32_16x16x32_bf16 v[100:103], a[88:91], a[8:11], v[100:103]
  s_add_u32 m0, s27, 6144
  v_mfma_f32_16x16x32_bf16 v[100:103], a[92:95], a[12:15], v[100:103]
  buffer_load_dwordx4 v20, s[68:71], 0 offen  lds
  v_mfma_f32_16x16x32_bf16 v[76:79], a[92:95], a[4:7], v[76:79]
  s_add_u32 s68, s68, 458752
  s_addc_u32 s69, s69, 0
  v_mfma_f32_16x16x32_bf16 v[76:79], a[88:91], a[0:3], v[76:79]
  s_waitcnt lgkmcnt(14)
  v_mfma_f32_16x16x32_bf16 v[80:83], a[0:3], a[96:99], v[80:83]
  s_add_u32 s29, s35, 5505024
  v_mfma_f32_16x16x32_bf16 v[80:83], a[4:7], a[100:103], v[80:83]
  buffer_load_dwordx4 a[140:143], v7, s[44:47], s29 offen
  v_mfma_f32_16x16x32_bf16 v[104:107], a[12:15], a[100:103], v[104:107]
  v_mfma_f32_16x16x32_bf16 v[104:107], a[8:11], a[96:99], v[104:107]
  v_mfma_f32_16x16x32_bf16 v[128:131], a[16:19], a[96:99], v[128:131]
  v_mfma_f32_16x16x32_bf16 v[128:131], a[20:23], a[100:103], v[128:131]
  v_mfma_f32_16x16x32_bf16 v[152:155], a[28:31], a[100:103], v[152:155]
  v_mfma_f32_16x16x32_bf16 v[152:155], a[24:27], a[96:99], v[152:155]
  s_waitcnt lgkmcnt(12)
  v_mfma_f32_16x16x32_bf16 v[156:159], a[24:27], a[104:107], v[156:159]
  s_add_u32 s29, s35, 5963776
  v_mfma_f32_16x16x32_bf16 v[156:159], a[28:31], a[108:111], v[156:159]
  buffer_load_dwordx4 a[140:143], v7, s[44:47], s29 offen
  v_mfma_f32_16x16x32_bf16 v[132:135], a[20:23], a[108:111], v[132:135]
  v_mfma_f32_16x16x32_bf16 v[132:135], a[16:19], a[104:107], v[132:135]
  v_mfma_f32_16x16x32_bf16 v[108:111], a[8:11], a[104:107], v[108:111]
  s_add_u32 s29, s35, 6422528
  v_mfma_f32_16x16x32_bf16 v[108:111], a[12:15], a[108:111], v[108:111]
  buffer_load_dwordx4 a[140:143], v7, s[44:47], s29 offen
  v_mfma_f32_16x16x32_bf16 v[84:87], a[4:7], a[108:111], v[84:87]
  v_mfma_f32_16x16x32_bf16 v[84:87], a[0:3], a[104:107], v[84:87]
  s_waitcnt lgkmcnt(8)
  v_mfma_f32_16x16x32_bf16 a[176:179], a[112:115], a[0:3], a[176:179]
  s_add_u32 s29, s35, 6881280
  v_mfma_f32_16x16x32_bf16 a[176:179], a[116:119], a[4:7], a[176:179]
  buffer_load_dwordx4 a[140:143], v7, s[44:47], s29 offen
  v_mfma_f32_16x16x32_bf16 a[180:183], a[116:119], a[12:15], a[180:183]
  v_mfma_f32_16x16x32_bf16 a[180:183], a[112:115], a[8:11], a[180:183]
  v_mfma_f32_16x16x32_bf16 a[184:187], a[112:115], a[16:19], a[184:187]
  v_mfma_f32_16x16x32_bf16 a[184:187], a[116:119], a[20:23], a[184:187]
  v_mfma_f32_16x16x32_bf16 a[188:191], a[116:119], a[28:31], a[188:191]
  v_mfma_f32_16x16x32_bf16 a[188:191], a[112:115], a[24:27], a[188:191]
  s_waitcnt vmcnt(11) lgkmcnt(0)
  s_barrier
  v_mfma_f32_16x16x32_bf16 v[160:163], a[64:67], a[32:35], v[160:163]
  ds_read_b128 a[0:3], v8 offset:34816
  s_add_u32 m0, s84, 0
  v_mfma_f32_16x16x32_bf16 v[160:163], a[68:71], a[36:39], v[160:163]
  buffer_load_dwordx4 v16, s[4:7], s80 offen offset:0  lds
  v_mfma_f32_16x16x32_bf16 v[184:187], a[68:71], a[44:47], v[184:187]
  ds_read_b128 a[4:7], v9 offset:34816
  v_mov_b32 v27, 0xf149f2ca
  v_mfma_f32_16x16x32_bf16 v[184:187], a[64:67], a[40:43], v[184:187]
  ds_read_b128 a[16:19], v8 offset:38912
  v_mfma_f32_16x16x32_bf16 v[208:211], a[64:67], a[48:51], v[208:211]
  ds_read_b128 a[8:11], v8 offset:36864
  v_lshlrev_b32_e64 v28, 2, v3
  v_mfma_f32_16x16x32_bf16 v[208:211], a[68:71], a[52:55], v[208:211]
  buffer_load_dwordx4 v16, s[4:7], s80 offen offset:2048  lds
  v_mfma_f32_16x16x32_bf16 v[232:235], a[68:71], a[60:63], v[232:235]
  ds_read_b128 a[12:15], v9 offset:36864
  v_sub_u32_e64 v28, v28, v4
  v_mfma_f32_16x16x32_bf16 v[232:235], a[64:67], a[56:59], v[232:235]
  ds_read_b128 a[20:23], v9 offset:38912
  v_mfma_f32_16x16x32_bf16 v[236:239], a[72:75], a[56:59], v[236:239]
  ds_read_b64_tr_b16 a[64:65], v13 offset:0
  s_or_b32 s29, s23, s21
  s_cmp_lg_u32 s29, 0
  s_cselect_b64 s[30:31], -1, 0
  v_mfma_f32_16x16x32_bf16 v[236:239], a[76:79], a[60:63], v[236:239]
  v_mfma_f32_16x16x32_bf16 v[212:215], a[76:79], a[52:55], v[212:215]
  ds_read_b64_tr_b16 a[66:67], v13 offset:512
  v_add_u32 v32, 9, v28
  v_mfma_f32_16x16x32_bf16 v[212:215], a[72:75], a[48:51], v[212:215]
  ds_read_b128 a[24:27], v8 offset:40960
  v_mfma_f32_16x16x32_bf16 v[188:191], a[72:75], a[40:43], v[188:191]
  ds_read_b64_tr_b16 a[68:69], v13 offset:14336
  v_cmp_gt_u32 vcc, 8, v32
  s_add_u32 m0, s85, 0
  v_mfma_f32_16x16x32_bf16 v[188:191], a[76:79], a[44:47], v[188:191]
  buffer_load_dwordx4 v16, s[4:7], s81 offen offset:0  lds
  v_mfma_f32_16x16x32_bf16 v[164:167], a[76:79], a[36:39], v[164:167]
  ds_read_b64_tr_b16 a[70:71], v13 offset:14848
  v_cndmask_b32 v33, v27, 0, vcc
  v_mfma_f32_16x16x32_bf16 v[164:167], a[72:75], a[32:35], v[164:167]
  ds_read_b128 a[28:31], v9 offset:40960
  v_mfma_f32_16x16x32_bf16 v[168:171], a[80:83], a[32:35], v[168:171]
  ds_read_b64_tr_b16 a[72:73], v14 offset:0
  v_accvgpr_write_b32 a162, v33
  v_mfma_f32_16x16x32_bf16 v[168:171], a[84:87], a[36:39], v[168:171]
  v_mfma_f32_16x16x32_bf16 v[192:195], a[84:87], a[44:47], v[192:195]
  ds_read_b64_tr_b16 a[74:75], v14 offset:512
  v_cmp_lt_i32_e64 vcc, 15, v32
  v_mfma_f32_16x16x32_bf16 v[192:195], a[80:83], a[40:43], v[192:195]
  v_mfma_f32_16x16x32_bf16 v[216:219], a[80:83], a[48:51], v[216:219]
  ds_read_b64_tr_b16 a[76:77], v14 offset:14336
  v_cndmask_b32 v33, v27, 0, vcc
  v_mfma_f32_16x16x32_bf16 v[216:219], a[84:87], a[52:55], v[216:219]
  buffer_load_dwordx4 v16, s[4:7], s81 offen offset:2048  lds
  v_mfma_f32_16x16x32_bf16 v[240:243], a[84:87], a[60:63], v[240:243]
  ds_read_b64_tr_b16 a[78:79], v14 offset:14848
  v_accvgpr_write_b32 a166, v33
  v_mfma_f32_16x16x32_bf16 v[240:243], a[80:83], a[56:59], v[240:243]
  v_mfma_f32_16x16x32_bf16 v[244:247], a[88:91], a[56:59], v[244:247]
  ds_read_b64_tr_b16 a[80:81], v13 offset:1024
  s_and_b64 vcc, vcc, s[30:31]
  v_mfma_f32_16x16x32_bf16 v[244:247], a[92:95], a[60:63], v[244:247]
  v_mfma_f32_16x16x32_bf16 v[220:223], a[92:95], a[52:55], v[220:223]
  ds_read_b64_tr_b16 a[82:83], v13 offset:1536
  v_mfma_f32_16x16x32_bf16 v[220:223], a[88:91], a[48:51], v[220:223]
  v_cndmask_b32 v33, v27, 0, vcc
  v_mfma_f32_16x16x32_bf16 v[196:199], a[88:91], a[40:43], v[196:199]
  ds_read_b64_tr_b16 a[84:85], v13 offset:15360
  s_add_u32 m0, s86, 0
  v_mfma_f32_16x16x32_bf16 v[196:199], a[92:95], a[44:47], v[196:199]
  v_accvgpr_write_b32 a170, v33
  buffer_load_dwordx4 v16, s[4:7], s82 offen offset:0  lds
  v_mfma_f32_16x16x32_bf16 v[172:175], a[92:95], a[36:39], v[172:175]
  ds_read_b64_tr_b16 a[86:87], v13 offset:15872
  v_mfma_f32_16x16x32_bf16 v[172:175], a[88:91], a[32:35], v[172:175]
  v_add_u32_e64 v32, 10, v28
  v_mfma_f32_16x16x32_bf16 v[176:179], a[32:35], a[96:99], v[176:179]
  ds_read_b64_tr_b16 a[88:89], v14 offset:1024
  v_mfma_f32_16x16x32_bf16 v[176:179], a[36:39], a[100:103], v[176:179]
  v_cmp_gt_u32_e64 vcc, 8, v32
  buffer_load_dwordx4 v16, s[4:7], s82 offen offset:2048  lds
  v_mfma_f32_16x16x32_bf16 v[200:203], a[44:47], a[100:103], v[200:203]
  ds_read_b64_tr_b16 a[90:91], v14 offset:1536
  v_mfma_f32_16x16x32_bf16 v[200:203], a[40:43], a[96:99], v[200:203]
  v_cndmask_b32 v33, v27, 0, vcc
  v_mfma_f32_16x16x32_bf16 v[224:227], a[48:51], a[96:99], v[224:227]
  ds_read_b64_tr_b16 a[92:93], v14 offset:15360
  v_mfma_f32_16x16x32_bf16 v[224:227], a[52:55], a[100:103], v[224:227]
  v_accvgpr_write_b32 a163, v33
  v_mfma_f32_16x16x32_bf16 v[248:251], a[60:63], a[100:103], v[248:251]
  ds_read_b64_tr_b16 a[94:95], v14 offset:15872
  v_mfma_f32_16x16x32_bf16 v[248:251], a[56:59], a[96:99], v[248:251]
  v_cmp_lt_i32 vcc, 15, v32
  v_mfma_f32_16x16x32_bf16 v[252:255], a[56:59], a[104:107], v[252:255]
  ds_read_b64_tr_b16 a[96:97], v13 offset:2048
  s_add_u32 m0, s87, 0
  v_mfma_f32_16x16x32_bf16 v[252:255], a[60:63], a[108:111], v[252:255]
  v_cndmask_b32 v33, v27, 0, vcc
  buffer_load_dwordx4 v16, s[4:7], s83 offen offset:0  lds
  v_mfma_f32_16x16x32_bf16 v[228:231], a[52:55], a[108:111], v[228:231]
  ds_read_b64_tr_b16 a[98:99], v13 offset:2560
  v_mfma_f32_16x16x32_bf16 v[228:231], a[48:51], a[104:107], v[228:231]
  v_accvgpr_write_b32 a167, v33
  v_mfma_f32_16x16x32_bf16 v[204:207], a[40:43], a[104:107], v[204:207]
  ds_read_b64_tr_b16 a[100:101], v13 offset:16384
  v_mfma_f32_16x16x32_bf16 v[204:207], a[44:47], a[108:111], v[204:207]
  s_and_b64 vcc, vcc, s[30:31]
  v_mfma_f32_16x16x32_bf16 v[180:183], a[36:39], a[108:111], v[180:183]
  ds_read_b64_tr_b16 a[102:103], v13 offset:16896
  v_mfma_f32_16x16x32_bf16 v[180:183], a[32:35], a[104:107], v[180:183]
  v_cndmask_b32 v33, v27, 0, vcc
  v_mfma_f32_16x16x32_bf16 a[192:195], a[112:115], a[32:35], a[192:195]
  ds_read_b64_tr_b16 a[104:105], v14 offset:2048
  v_mfma_f32_16x16x32_bf16 a[192:195], a[116:119], a[36:39], a[192:195]
  v_accvgpr_write_b32 a171, v33
  buffer_load_dwordx4 v16, s[4:7], s83 offen offset:2048  lds
  v_mfma_f32_16x16x32_bf16 a[196:199], a[116:119], a[44:47], a[196:199]
  ds_read_b64_tr_b16 a[106:107], v14 offset:2560
  s_add_u32 s4, s4, 128
  s_addc_u32 s5, s5, 0
  v_mfma_f32_16x16x32_bf16 a[196:199], a[112:115], a[40:43], a[196:199]
  v_mfma_f32_16x16x32_bf16 a[200:203], a[112:115], a[48:51], a[200:203]
  ds_read_b64_tr_b16 a[108:109], v14 offset:16384
  v_mfma_f32_16x16x32_bf16 a[200:203], a[116:119], a[52:55], a[200:203]
  v_mfma_f32_16x16x32_bf16 a[204:207], a[116:119], a[60:63], a[204:207]
  ds_read_b64_tr_b16 a[110:111], v14 offset:16896
  v_mfma_f32_16x16x32_bf16 a[204:207], a[112:115], a[56:59], a[204:207]
  s_waitcnt lgkmcnt(14)
  v_mfma_f32_16x16x32_bf16 v[64:67], a[64:67], a[0:3], v[64:67]
  ds_read_b64_tr_b16 a[112:113], v15 offset:0
  s_add_u32 m0, s88, 28672
  v_mfma_f32_16x16x32_bf16 v[64:67], a[68:71], a[4:7], v[64:67]
  buffer_load_dwordx4 v18, s[8:11], s94 offen  lds
  v_mfma_f32_16x16x32_bf16 v[88:91], a[68:71], a[12:15], v[88:91]
  ds_read_b64_tr_b16 a[114:115], v15 offset:256
  v_mfma_f32_16x16x32_bf16 v[88:91], a[64:67], a[8:11], v[88:91]
  v_mfma_f32_16x16x32_bf16 v[112:115], a[64:67], a[16:19], v[112:115]
  ds_read_b64_tr_b16 a[116:117], v15 offset:14336
  s_add_u32 m0, s89, 28672
  v_mfma_f32_16x16x32_bf16 v[112:115], a[68:71], a[20:23], v[112:115]
  buffer_load_dwordx4 v18, s[8:11], s95 offen  lds
  v_mfma_f32_16x16x32_bf16 v[136:139], a[68:71], a[28:31], v[136:139]
  ds_read_b64_tr_b16 a[118:119], v15 offset:14592
  v_mfma_f32_16x16x32_bf16 v[136:139], a[64:67], a[24:27], v[136:139]
  v_mfma_f32_16x16x32_bf16 v[140:143], a[72:75], a[24:27], v[140:143]
  ds_read_b128 a[32:35], v8 offset:43008
  s_add_u32 m0, s90, 28672
  v_mfma_f32_16x16x32_bf16 v[140:143], a[76:79], a[28:31], v[140:143]
  buffer_load_dwordx4 v18, s[8:11], s96 offen  lds
  v_mfma_f32_16x16x32_bf16 v[116:119], a[76:79], a[20:23], v[116:119]
  ds_read_b128 a[36:39], v9 offset:43008
  v_mfma_f32_16x16x32_bf16 v[116:119], a[72:75], a[16:19], v[116:119]
  v_mfma_f32_16x16x32_bf16 v[92:95], a[72:75], a[8:11], v[92:95]
  ds_read_b128 a[40:43], v8 offset:45056
  s_add_u32 m0, s91, 28672
  v_mfma_f32_16x16x32_bf16 v[92:95], a[76:79], a[12:15], v[92:95]
  buffer_load_dwordx4 v19, s[8:11], s94 offen  lds
  v_mfma_f32_16x16x32_bf16 v[68:71], a[76:79], a[4:7], v[68:71]
  ds_read_b128 a[44:47], v9 offset:45056
  v_mfma_f32_16x16x32_bf16 v[68:71], a[72:75], a[0:3], v[68:71]
  s_waitcnt lgkmcnt(14)
  v_mfma_f32_16x16x32_bf16 v[72:75], a[80:83], a[0:3], v[72:75]
  ds_read_b128 a[48:51], v8 offset:47104
  v_mfma_f32_16x16x32_bf16 v[72:75], a[84:87], a[4:7], v[72:75]
  v_mfma_f32_16x16x32_bf16 v[96:99], a[84:87], a[12:15], v[96:99]
  ds_read_b128 a[52:55], v9 offset:47104
  v_mfma_f32_16x16x32_bf16 v[96:99], a[80:83], a[8:11], v[96:99]
  v_mfma_f32_16x16x32_bf16 v[120:123], a[80:83], a[16:19], v[120:123]
  ds_read_b128 a[56:59], v8 offset:49152
  s_add_u32 m0, s92, 28672
  v_mfma_f32_16x16x32_bf16 v[120:123], a[84:87], a[20:23], v[120:123]
  buffer_load_dwordx4 v19, s[8:11], s95 offen  lds
  v_mfma_f32_16x16x32_bf16 v[144:147], a[84:87], a[28:31], v[144:147]
  ds_read_b128 a[60:63], v9 offset:49152
  v_mfma_f32_16x16x32_bf16 v[144:147], a[80:83], a[24:27], v[144:147]
  v_mfma_f32_16x16x32_bf16 v[148:151], a[88:91], a[24:27], v[148:151]
  s_add_u32 m0, s93, 28672
  v_mfma_f32_16x16x32_bf16 v[148:151], a[92:95], a[28:31], v[148:151]
  buffer_load_dwordx4 v19, s[8:11], s96 offen  lds
  v_mfma_f32_16x16x32_bf16 v[124:127], a[92:95], a[20:23], v[124:127]
  s_add_u32 s8, s8, 393216
  s_addc_u32 s9, s9, 0
  v_mfma_f32_16x16x32_bf16 v[124:127], a[88:91], a[16:19], v[124:127]
  v_mfma_f32_16x16x32_bf16 v[100:103], a[88:91], a[8:11], v[100:103]
  s_add_u32 m0, s27, 34816
  v_mfma_f32_16x16x32_bf16 v[100:103], a[92:95], a[12:15], v[100:103]
  buffer_load_dwordx4 v20, s[68:71], 0 offen  lds
  v_mfma_f32_16x16x32_bf16 v[76:79], a[92:95], a[4:7], v[76:79]
  s_add_u32 s68, s68, 458752
  s_addc_u32 s69, s69, 0
  v_mfma_f32_16x16x32_bf16 v[76:79], a[88:91], a[0:3], v[76:79]
La_pad5:
  s_cbranch_execz La_pad9
  s_nop 0
  s_waitcnt lgkmcnt(14)
  v_mfma_f32_16x16x32_bf16 v[80:83], a[0:3], a[96:99], v[80:83]
  s_add_u32 s29, s35, 0
  v_mfma_f32_16x16x32_bf16 v[80:83], a[4:7], a[100:103], v[80:83]
  buffer_load_dwordx4 a[140:143], v7, s[40:43], s29 offen
  v_mfma_f32_16x16x32_bf16 v[104:107], a[12:15], a[100:103], v[104:107]
  v_mfma_f32_16x16x32_bf16 v[104:107], a[8:11], a[96:99], v[104:107]
  v_mfma_f32_16x16x32_bf16 v[128:131], a[16:19], a[96:99], v[128:131]
  v_mfma_f32_16x16x32_bf16 v[128:131], a[20:23], a[100:103], v[128:131]
  v_mfma_f32_16x16x32_bf16 v[152:155], a[28:31], a[100:103], v[152:155]
  v_mfma_f32_16x16x32_bf16 v[152:155], a[24:27], a[96:99], v[152:155]
  s_waitcnt lgkmcnt(12)
  v_mfma_f32_16x16x32_bf16 v[156:159], a[24:27], a[104:107], v[156:159]
  s_add_u32 s29, s35, 458752
  v_mfma_f32_16x16x32_bf16 v[156:159], a[28:31], a[108:111], v[156:159]
  buffer_load_dwordx4 a[140:143], v7, s[40:43], s29 offen
  v_mfma_f32_16x16x32_bf16 v[132:135], a[20:23], a[108:111], v[132:135]
  v_mfma_f32_16x16x32_bf16 v[132:135], a[16:19], a[104:107], v[132:135]
  v_mfma_f32_16x16x32_bf16 v[108:111], a[8:11], a[104:107], v[108:111]
  s_add_u32 s29, s35, 917504
  v_mfma_f32_16x16x32_bf16 v[108:111], a[12:15], a[108:111], v[108:111]
  buffer_load_dwordx4 a[140:143], v7, s[40:43], s29 offen
  v_mfma_f32_16x16x32_bf16 v[84:87], a[4:7], a[108:111], v[84:87]
  v_mfma_f32_16x16x32_bf16 v[84:87], a[0:3], a[104:107], v[84:87]
  s_waitcnt lgkmcnt(8)
  v_mfma_f32_16x16x32_bf16 a[176:179], a[112:115], a[0:3], a[176:179]
  s_add_u32 s29, s35, 1376256
  v_mfma_f32_16x16x32_bf16 a[176:179], a[116:119], a[4:7], a[176:179]
  buffer_load_dwordx4 a[140:143], v7, s[40:43], s29 offen
  v_mfma_f32_16x16x32_bf16 a[180:183], a[116:119], a[12:15], a[180:183]
  v_mfma_f32_16x16x32_bf16 a[180:183], a[112:115], a[8:11], a[180:183]
  v_mfma_f32_16x16x32_bf16 a[184:187], a[112:115], a[16:19], a[184:187]
  v_mfma_f32_16x16x32_bf16 a[184:187], a[116:119], a[20:23], a[184:187]
  v_mfma_f32_16x16x32_bf16 a[188:191], a[116:119], a[28:31], a[188:191]
  v_mfma_f32_16x16x32_bf16 a[188:191], a[112:115], a[24:27], a[188:191]
  s_waitcnt vmcnt(11) lgkmcnt(0)
  s_barrier
  v_mfma_f32_16x16x32_bf16 v[160:163], a[64:67], a[32:35], v[160:163]
  ds_read_b128 a[0:3], v8 offset:0
  v_mfma_f32_16x16x32_bf16 v[160:163], a[68:71], a[36:39], v[160:163]
  buffer_load_dword v33, v34, s[48:51], 0 offen sc1
  v_mfma_f32_16x16x32_bf16 v[184:187], a[68:71], a[44:47], v[184:187]
  ds_read_b128 a[4:7], v9 offset:0
  v_mfma_f32_16x16x32_bf16 v[184:187], a[64:67], a[40:43], v[184:187]
  ds_read_b128 a[16:19], v8 offset:4096
  v_mfma_f32_16x16x32_bf16 v[208:211], a[64:67], a[48:51], v[208:211]
  ds_read_b128 a[8:11], v8 offset:2048
  v_min_u32 v30, 223, v0
  s_add_u32 m0, s84, 34816
  v_mfma_f32_16x16x32_bf16 v[208:211], a[68:71], a[52:55], v[208:211]
  buffer_load_dwordx4 v16, s[4:7], s80 offen offset:0  lds
  v_mfma_f32_16x16x32_bf16 v[232:235], a[68:71], a[60:63], v[232:235]
  ds_read_b128 a[12:15], v9 offset:2048
  v_mfma_f32_16x16x32_bf16 v[232:235], a[64:67], a[56:59], v[232:235]
  ds_read_b128 a[20:23], v9 offset:4096
  v_and_b32 v27, 0xe0, v0
  v_mfma_f32_16x16x32_bf16 v[236:239], a[72:75], a[56:59], v[236:239]
  ds_read_b64_tr_b16 a[64:65], v10 offset:0
  v_mfma_f32_16x16x32_bf16 v[236:239], a[76:79], a[60:63], v[236:239]
  v_mfma_f32_16x16x32_bf16 v[212:215], a[76:79], a[52:55], v[212:215]
  ds_read_b64_tr_b16 a[66:67], v10 offset:512
  v_mfma_f32_16x16x32_bf16 v[212:215], a[72:75], a[48:51], v[212:215]
  ds_read_b128 a[24:27], v8 offset:6144
  v_lshl_add_u32 v27, v4, 1, v27
  v_mfma_f32_16x16x32_bf16 v[188:191], a[72:75], a[40:43], v[188:191]
  ds_read_b64_tr_b16 a[68:69], v10 offset:14336
  v_mfma_f32_16x16x32_bf16 v[188:191], a[76:79], a[44:47], v[188:191]
  buffer_load_dwordx4 v16, s[4:7], s80 offen offset:2048  lds
  v_mfma_f32_16x16x32_bf16 v[164:167], a[76:79], a[36:39], v[164:167]
  ds_read_b64_tr_b16 a[70:71], v10 offset:14848
  v_and_b32_e64 v28, 1, v3
  v_mfma_f32_16x16x32_bf16 v[164:167], a[72:75], a[32:35], v[164:167]
  ds_read_b128 a[28:31], v9 offset:6144
  v_mfma_f32_16x16x32_bf16 v[168:171], a[80:83], a[32:35], v[168:171]
  ds_read_b64_tr_b16 a[72:73], v11 offset:0
  s_add_u32 m0, s85, 34816
  v_mfma_f32_16x16x32_bf16 v[168:171], a[84:87], a[36:39], v[168:171]
  buffer_load_dwordx4 v16, s[4:7], s81 offen offset:0  lds
  v_mfma_f32_16x16x32_bf16 v[192:195], a[84:87], a[44:47], v[192:195]
  ds_read_b64_tr_b16 a[74:75], v11 offset:512
  v_add_u32_e64 v27, v27, v28
  v_mfma_f32_16x16x32_bf16 v[192:195], a[80:83], a[40:43], v[192:195]
  v_mfma_f32_16x16x32_bf16 v[216:219], a[80:83], a[48:51], v[216:219]
  ds_read_b64_tr_b16 a[76:77], v11 offset:14336
  v_mfma_f32_16x16x32_bf16 v[216:219], a[84:87], a[52:55], v[216:219]
  v_mfma_f32_16x16x32_bf16 v[240:243], a[84:87], a[60:63], v[240:243]
  ds_read_b64_tr_b16 a[78:79], v11 offset:14848
  s_lshl_b32 s29, s23, 8
  v_add_lshl_u32 v27, v27, s29, 3
  v_mfma_f32_16x16x32_bf16 v[240:243], a[80:83], a[56:59], v[240:243]
  v_mfma_f32_16x16x32_bf16 v[244:247], a[88:91], a[56:59], v[244:247]
  ds_read_b64_tr_b16 a[80:81], v10 offset:1024
  v_mfma_f32_16x16x32_bf16 v[244:247], a[92:95], a[60:63], v[244:247]
  v_and_b32 v31, 31, v0
  buffer_load_dwordx4 v16, s[4:7], s81 offen offset:2048  lds
  v_mfma_f32_16x16x32_bf16 v[220:223], a[92:95], a[52:55], v[220:223]
  ds_read_b64_tr_b16 a[82:83], v10 offset:1536
  v_mfma_f32_16x16x32_bf16 v[220:223], a[88:91], a[48:51], v[220:223]
  v_mfma_f32_16x16x32_bf16 v[196:199], a[88:91], a[40:43], v[196:199]
  ds_read_b64_tr_b16 a[84:85], v10 offset:15360
  s_add_u32 m0, s86, 34816
  v_mfma_f32_16x16x32_bf16 v[196:199], a[92:95], a[44:47], v[196:199]
  s_lshl_b32 s29, s24, 5
  s_add_u32 s29, s29, 3072
  v_add_lshl_u32 v31, v31, s29, 1
  buffer_load_dwordx4 v16, s[4:7], s82 offen offset:0  lds
  v_mfma_f32_16x16x32_bf16 v[172:175], a[92:95], a[36:39], v[172:175]
  ds_read_b64_tr_b16 a[86:87], v10 offset:15872
  v_mfma_f32_16x16x32_bf16 v[172:175], a[88:91], a[32:35], v[172:175]
  v_mfma_f32_16x16x32_bf16 v[176:179], a[32:35], a[96:99], v[176:179]
  ds_read_b64_tr_b16 a[88:89], v11 offset:1024
  v_lshlrev_b32 v30, 3, v30
  v_mfma_f32_16x16x32_bf16 v[176:179], a[36:39], a[100:103], v[176:179]
  v_mfma_f32_16x16x32_bf16 v[200:203], a[44:47], a[100:103], v[200:203]
  ds_read_b64_tr_b16 a[90:91], v11 offset:1536
  v_mfma_f32_16x16x32_bf16 v[200:203], a[40:43], a[96:99], v[200:203]
  v_mfma_f32_16x16x32_bf16 v[224:227], a[48:51], a[96:99], v[224:227]
  ds_read_b64_tr_b16 a[92:93], v11 offset:15360
  v_lshlrev_b32_e64 v32, 2, v0
  v_mfma_f32_16x16x32_bf16 v[224:227], a[52:55], a[100:103], v[224:227]
  buffer_load_dwordx4 v16, s[4:7], s82 offen offset:2048  lds
  v_mfma_f32_16x16x32_bf16 v[248:251], a[60:63], a[100:103], v[248:251]
  ds_read_b64_tr_b16 a[94:95], v11 offset:15872
  v_mfma_f32_16x16x32_bf16 v[248:251], a[56:59], a[96:99], v[248:251]
  v_mfma_f32_16x16x32_bf16 v[252:255], a[56:59], a[104:107], v[252:255]
  ds_read_b64_tr_b16 a[96:97], v10 offset:2048
  s_add_u32 m0, s87, 34816
  v_mfma_f32_16x16x32_bf16 v[252:255], a[60:63], a[108:111], v[252:255]
  buffer_load_dwordx4 v16, s[4:7], s83 offen offset:0  lds
  v_mfma_f32_16x16x32_bf16 v[228:231], a[52:55], a[108:111], v[228:231]
  ds_read_b64_tr_b16 a[98:99], v10 offset:2560
  v_mfma_f32_16x16x32_bf16 v[228:231], a[48:51], a[104:107], v[228:231]
  v_mfma_f32_16x16x32_bf16 v[204:207], a[40:43], a[104:107], v[204:207]
  ds_read_b64_tr_b16 a[100:101], v10 offset:16384
  v_mfma_f32_16x16x32_bf16 v[204:207], a[44:47], a[108:111], v[204:207]
  v_mfma_f32_16x16x32_bf16 v[180:183], a[36:39], a[108:111], v[180:183]
  ds_read_b64_tr_b16 a[102:103], v10 offset:16896
  v_mfma_f32_16x16x32_bf16 v[180:183], a[32:35], a[104:107], v[180:183]
  v_mfma_f32_16x16x32_bf16 a[192:195], a[112:115], a[32:35], a[192:195]
  ds_read_b64_tr_b16 a[104:105], v11 offset:2048
  v_mfma_f32_16x16x32_bf16 a[192:195], a[116:119], a[36:39], a[192:195]
  buffer_load_dwordx4 v16, s[4:7], s83 offen offset:2048  lds
  v_mfma_f32_16x16x32_bf16 a[196:199], a[116:119], a[44:47], a[196:199]
  ds_read_b64_tr_b16 a[106:107], v11 offset:2560
  s_add_u32 s4, s4, 128
  s_addc_u32 s5, s5, 0
  v_mfma_f32_16x16x32_bf16 a[196:199], a[112:115], a[40:43], a[196:199]
  v_mfma_f32_16x16x32_bf16 a[200:203], a[112:115], a[48:51], a[200:203]
  ds_read_b64_tr_b16 a[108:109], v11 offset:16384
  v_mfma_f32_16x16x32_bf16 a[200:203], a[116:119], a[52:55], a[200:203]
  v_mfma_f32_16x16x32_bf16 a[204:207], a[116:119], a[60:63], a[204:207]
  ds_read_b64_tr_b16 a[110:111], v11 offset:16896
  v_mfma_f32_16x16x32_bf16 a[204:207], a[112:115], a[56:59], a[204:207]
  s_waitcnt lgkmcnt(14)
  v_mfma_f32_16x16x32_bf16 v[64:67], a[64:67], a[0:3], v[64:67]
  ds_read_b64_tr_b16 a[112:113], v12 offset:0
  s_add_u32 m0, s88, 57344
  v_mfma_f32_16x16x32_bf16 v[64:67], a[68:71], a[4:7], v[64:67]
  buffer_load_dwordx4 v18, s[8:11], s94 offen  lds
  v_mfma_f32_16x16x32_bf16 v[88:91], a[68:71], a[12:15], v[88:91]
  ds_read_b64_tr_b16 a[114:115], v12 offset:256
  v_mfma_f32_16x16x32_bf16 v[88:91], a[64:67], a[8:11], v[88:91]
  v_mfma_f32_16x16x32_bf16 v[112:115], a[64:67], a[16:19], v[112:115]
  ds_read_b64_tr_b16 a[116:117], v12 offset:14336
  s_add_u32 m0, s89, 57344
  v_mfma_f32_16x16x32_bf16 v[112:115], a[68:71], a[20:23], v[112:115]
  buffer_load_dwordx4 v18, s[8:11], s95 offen  lds
  v_mfma_f32_16x16x32_bf16 v[136:139], a[68:71], a[28:31], v[136:139]
  ds_read_b64_tr_b16 a[118:119], v12 offset:14592
  v_mfma_f32_16x16x32_bf16 v[136:139], a[64:67], a[24:27], v[136:139]
  v_mfma_f32_16x16x32_bf16 v[140:143], a[72:75], a[24:27], v[140:143]
  ds_read_b128 a[32:35], v8 offset:8192
  v_mfma_f32_16x16x32_bf16 v[140:143], a[76:79], a[28:31], v[140:143]
  v_mfma_f32_16x16x32_bf16 v[116:119], a[76:79], a[20:23], v[116:119]
  ds_read_b128 a[36:39], v9 offset:8192
  v_mfma_f32_16x16x32_bf16 v[116:119], a[72:75], a[16:19], v[116:119]
  v_mfma_f32_16x16x32_bf16 v[92:95], a[72:75], a[8:11], v[92:95]
  ds_read_b128 a[40:43], v8 offset:10240
  s_add_u32 m0, s90, 57344
  v_mfma_f32_16x16x32_bf16 v[92:95], a[76:79], a[12:15], v[92:95]
  buffer_load_dwordx4 v18, s[8:11], s96 offen  lds
  v_mfma_f32_16x16x32_bf16 v[68:71], a[76:79], a[4:7], v[68:71]
  ds_read_b128 a[44:47], v9 offset:10240
  v_mfma_f32_16x16x32_bf16 v[68:71], a[72:75], a[0:3], v[68:71]
  s_waitcnt lgkmcnt(14)
  v_mfma_f32_16x16x32_bf16 v[72:75], a[80:83], a[0:3], v[72:75]
  ds_read_b128 a[48:51], v8 offset:12288
  v_mfma_f32_16x16x32_bf16 v[72:75], a[84:87], a[4:7], v[72:75]
  v_mfma_f32_16x16x32_bf16 v[96:99], a[84:87], a[12:15], v[96:99]
  ds_read_b128 a[52:55], v9 offset:12288
  v_mfma_f32_16x16x32_bf16 v[96:99], a[80:83], a[8:11], v[96:99]
  v_mfma_f32_16x16x32_bf16 v[120:123], a[80:83], a[16:19], v[120:123]
  ds_read_b128 a[56:59], v8 offset:14336
  s_add_u32 m0, s91, 57344
  v_mfma_f32_16x16x32_bf16 v[120:123], a[84:87], a[20:23], v[120:123]
  buffer_load_dwordx4 v19, s[8:11], s94 offen  lds
  v_mfma_f32_16x16x32_bf16 v[144:147], a[84:87], a[28:31], v[144:147]
  ds_read_b128 a[60:63], v9 offset:14336
  v_mfma_f32_16x16x32_bf16 v[144:147], a[80:83], a[24:27], v[144:147]
  v_mfma_f32_16x16x32_bf16 v[148:151], a[88:91], a[24:27], v[148:151]
  v_mfma_f32_16x16x32_bf16 v[148:151], a[92:95], a[28:31], v[148:151]
  v_mfma_f32_16x16x32_bf16 v[124:127], a[92:95], a[20:23], v[124:127]
  v_mfma_f32_16x16x32_bf16 v[124:127], a[88:91], a[16:19], v[124:127]
  v_mfma_f32_16x16x32_bf16 v[100:103], a[88:91], a[8:11], v[100:103]
  s_add_u32 m0, s92, 57344
  v_mfma_f32_16x16x32_bf16 v[100:103], a[92:95], a[12:15], v[100:103]
  buffer_load_dwordx4 v19, s[8:11], s95 offen  lds
  v_mfma_f32_16x16x32_bf16 v[76:79], a[92:95], a[4:7], v[76:79]
  v_mfma_f32_16x16x32_bf16 v[76:79], a[88:91], a[0:3], v[76:79]
  s_waitcnt lgkmcnt(14)
  v_mfma_f32_16x16x32_bf16 v[80:83], a[0:3], a[96:99], v[80:83]
  s_add_u32 m0, s93, 57344
  v_mfma_f32_16x16x32_bf16 v[80:83], a[4:7], a[100:103], v[80:83]
  buffer_load_dwordx4 v19, s[8:11], s96 offen  lds
  v_mfma_f32_16x16x32_bf16 v[104:107], a[12:15], a[100:103], v[104:107]
  s_add_u32 s8, s8, 393216
  s_addc_u32 s9, s9, 0
  v_mfma_f32_16x16x32_bf16 v[104:107], a[8:11], a[96:99], v[104:107]
  v_mfma_f32_16x16x32_bf16 v[128:131], a[16:19], a[96:99], v[128:131]
  v_mfma_f32_16x16x32_bf16 v[128:131], a[20:23], a[100:103], v[128:131]
  v_mfma_f32_16x16x32_bf16 v[152:155], a[28:31], a[100:103], v[152:155]
  v_mfma_f32_16x16x32_bf16 v[152:155], a[24:27], a[96:99], v[152:155]
  s_waitcnt lgkmcnt(12)
  v_mfma_f32_16x16x32_bf16 v[156:159], a[24:27], a[104:107], v[156:159]
  s_add_u32 m0, s27, 63488
  v_mfma_f32_16x16x32_bf16 v[156:159], a[28:31], a[108:111], v[156:159]
  buffer_load_dwordx4 v20, s[68:71], 0 offen  lds
  v_mfma_f32_16x16x32_bf16 v[132:135], a[20:23], a[108:111], v[132:135]
  s_add_u32 s68, s68, 458752
  s_addc_u32 s69, s69, 0
  v_mfma_f32_16x16x32_bf16 v[132:135], a[16:19], a[104:107], v[132:135]
  v_mfma_f32_16x16x32_bf16 v[108:111], a[8:11], a[104:107], v[108:111]
  v_mfma_f32_16x16x32_bf16 v[108:111], a[12:15], a[108:111], v[108:111]
  v_mfma_f32_16x16x32_bf16 v[84:87], a[4:7], a[108:111], v[84:87]
  v_mfma_f32_16x16x32_bf16 v[84:87], a[0:3], a[104:107], v[84:87]
  s_waitcnt lgkmcnt(8)
  v_mfma_f32_16x16x32_bf16 a[176:179], a[112:115], a[0:3], a[176:179]
  s_add_u32 s29, s35, 1835008
  v_mfma_f32_16x16x32_bf16 a[176:179], a[116:119], a[4:7], a[176:179]
  buffer_load_dwordx4 a[140:143], v7, s[40:43], s29 offen
  v_mfma_f32_16x16x32_bf16 a[180:183], a[116:119], a[12:15], a[180:183]
  v_mfma_f32_16x16x32_bf16 a[180:183], a[112:115], a[8:11], a[180:183]
  v_mfma_f32_16x16x32_bf16 a[184:187], a[112:115], a[16:19], a[184:187]
  v_mfma_f32_16x16x32_bf16 a[184:187], a[116:119], a[20:23], a[184:187]
  v_mfma_f32_16x16x32_bf16 a[188:191], a[116:119], a[28:31], a[188:191]
  v_mfma_f32_16x16x32_bf16 a[188:191], a[112:115], a[24:27], a[188:191]
  s_waitcnt vmcnt(8) lgkmcnt(0)
  s_barrier
  v_mfma_f32_16x16x32_bf16 v[160:163], a[64:67], a[32:35], v[160:163]
  ds_read_b128 a[0:3], v8 offset:34816
  v_cmp_gt_u32 vcc, 256, v33
  s_cbranch_vccnz La_c0_slow
La_c0_back:
  v_mfma_f32_16x16x32_bf16 v[160:163], a[68:71], a[36:39], v[160:163]
  v_mfma_f32_16x16x32_bf16 v[184:187], a[68:71], a[44:47], v[184:187]
  ds_read_b128 a[4:7], v9 offset:34816
  buffer_load_dwordx2 v[40:41], v30, s[16:19], s66 offen sc1
  v_mfma_f32_16x16x32_bf16 v[184:187], a[64:67], a[40:43], v[184:187]
  ds_read_b128 a[16:19], v8 offset:38912
  v_mfma_f32_16x16x32_bf16 v[208:211], a[64:67], a[48:51], v[208:211]
  ds_read_b128 a[8:11], v8 offset:36864
  v_mfma_f32_16x16x32_bf16 v[208:211], a[68:71], a[52:55], v[208:211]
  v_mfma_f32_16x16x32_bf16 v[232:235], a[68:71], a[60:63], v[232:235]
  ds_read_b128 a[12:15], v9 offset:36864
  buffer_load_dwordx2 v[42:43], v30, s[16:19], s66 offen offset:2048 sc1
  v_mfma_f32_16x16x32_bf16 v[232:235], a[64:67], a[56:59], v[232:235]
  ds_read_b128 a[20:23], v9 offset:38912
  v_mfma_f32_16x16x32_bf16 v[236:239], a[72:75], a[56:59], v[236:239]
  ds_read_b64_tr_b16 a[64:65], v10 offset:28672
  v_mfma_f32_16x16x32_bf16 v[236:239], a[76:79], a[60:63], v[236:239]
  v_mfma_f32_16x16x32_bf16 v[212:215], a[76:79], a[52:55], v[212:215]
  ds_read_b64_tr_b16 a[66:67], v10 offset:29184
  buffer_load_dwordx2 v[44:45], v27, s[16:19], 0 offen sc1
  v_mfma_f32_16x16x32_bf16 v[212:215], a[72:75], a[48:51], v[212:215]
  ds_read_b128 a[24:27], v8 offset:40960
  v_mfma_f32_16x16x32_bf16 v[188:191], a[72:75], a[40:43], v[188:191]
  ds_read_b64_tr_b16 a[68:69], v10 offset:43008
  v_mfma_f32_16x16x32_bf16 v[188:191], a[76:79], a[44:47], v[188:191]
  v_mfma_f32_16x16x32_bf16 v[164:167], a[76:79], a[36:39], v[164:167]
  ds_read_b64_tr_b16 a[70:71], v10 offset:43520
  buffer_load_ushort v36, v31, s[72:75], 0 offen
  v_mfma_f32_16x16x32_bf16 v[164:167], a[72:75], a[32:35], v[164:167]
  ds_read_b128 a[28:31], v9 offset:40960
  v_mfma_f32_16x16x32_bf16 v[168:171], a[80:83], a[32:35], v[168:171]
  ds_read_b64_tr_b16 a[72:73], v11 offset:28672
  v_mfma_f32_16x16x32_bf16 v[168:171], a[84:87], a[36:39], v[168:171]
  s_add_u32 m0, s84, 0
  v_mfma_f32_16x16x32_bf16 v[192:195], a[84:87], a[44:47], v[192:195]
  ds_read_b64_tr_b16 a[74:75], v11 offset:29184
  buffer_load_dwordx4 v16, s[4:7], s80 offen offset:0  lds
  v_mfma_f32_16x16x32_bf16 v[192:195], a[80:83], a[40:43], v[192:195]
  v_mfma_f32_16x16x32_bf16 v[216:219], a[80:83], a[48:51], v[216:219]
  ds_read_b64_tr_b16 a[76:77], v11 offset:43008
  v_mfma_f32_16x16x32_bf16 v[216:219], a[84:87], a[52:55], v[216:219]
  v_mfma_f32_16x16x32_bf16 v[240:243], a[84:87], a[60:63], v[240:243]
  ds_read_b64_tr_b16 a[78:79], v11 offset:43520
  buffer_load_dwordx4 v16, s[4:7], s80 offen offset:2048  lds
  v_mfma_f32_16x16x32_bf16 v[240:243], a[80:83], a[56:59], v[240:243]
  v_mfma_f32_16x16x32_bf16 v[244:247], a[88:91], a[56:59], v[244:247]
  ds_read_b64_tr_b16 a[80:81], v10 offset:29696
  v_mfma_f32_16x16x32_bf16 v[244:247], a[92:95], a[60:63], v[244:247]
  s_add_u32 m0, s85, 0
  v_mfma_f32_16x16x32_bf16 v[220:223], a[92:95], a[52:55], v[220:223]
  ds_read_b64_tr_b16 a[82:83], v10 offset:30208
  buffer_load_dwordx4 v16, s[4:7], s81 offen offset:0  lds
  v_mfma_f32_16x16x32_bf16 v[220:223], a[88:91], a[48:51], v[220:223]
  v_mfma_f32_16x16x32_bf16 v[196:199], a[88:91], a[40:43], v[196:199]
  ds_read_b64_tr_b16 a[84:85], v10 offset:44032
  v_mfma_f32_16x16x32_bf16 v[196:199], a[92:95], a[44:47], v[196:199]
  v_mfma_f32_16x16x32_bf16 v[172:175], a[92:95], a[36:39], v[172:175]
  ds_read_b64_tr_b16 a[86:87], v10 offset:44544
  buffer_load_dwordx4 v16, s[4:7], s81 offen offset:2048  lds
  v_mfma_f32_16x16x32_bf16 v[172:175], a[88:91], a[32:35], v[172:175]
  v_mfma_f32_16x16x32_bf16 v[176:179], a[32:35], a[96:99], v[176:179]
  ds_read_b64_tr_b16 a[88:89], v11 offset:29696
  v_mfma_f32_16x16x32_bf16 v[176:179], a[36:39], a[100:103], v[176:179]
  s_add_u32 m0, s86, 0
  v_mfma_f32_16x16x32_bf16 v[200:203], a[44:47], a[100:103], v[200:203]
  ds_read_b64_tr_b16 a[90:91], v11 offset:30208
  buffer_load_dwordx4 v16, s[4:7], s82 offen offset:0  lds
  v_mfma_f32_16x16x32_bf16 v[200:203], a[40:43], a[96:99], v[200:203]
  v_mfma_f32_16x16x32_bf16 v[224:227], a[48:51], a[96:99], v[224:227]
  ds_read_b64_tr_b16 a[92:93], v11 offset:44032
  v_mfma_f32_16x16x32_bf16 v[224:227], a[52:55], a[100:103], v[224:227]
  v_mfma_f32_16x16x32_bf16 v[248:251], a[60:63], a[100:103], v[248:251]
  ds_read_b64_tr_b16 a[94:95], v11 offset:44544
  buffer_load_dwordx4 v16, s[4:7], s82 offen offset:2048  lds
  v_mfma_f32_16x16x32_bf16 v[248:251], a[56:59], a[96:99], v[248:251]
  v_mfma_f32_16x16x32_bf16 v[252:255], a[56:59], a[104:107], v[252:255]
  ds_read_b64_tr_b16 a[96:97], v10 offset:30720
  v_mfma_f32_16x16x32_bf16 v[252:255], a[60:63], a[108:111], v[252:255]
  s_add_u32 m0, s87, 0
  v_mfma_f32_16x16x32_bf16 v[228:231], a[52:55], a[108:111], v[228:231]
  ds_read_b64_tr_b16 a[98:99], v10 offset:31232
  buffer_load_dwordx4 v16, s[4:7], s83 offen offset:0  lds
  v_mfma_f32_16x16x32_bf16 v[228:231], a[48:51], a[104:107], v[228:231]
  v_mfma_f32_16x16x32_bf16 v[204:207], a[40:43], a[104:107], v[204:207]
  ds_read_b64_tr_b16 a[100:101], v10 offset:45056
  v_mfma_f32_16x16x32_bf16 v[204:207], a[44:47], a[108:111], v[204:207]
  v_mfma_f32_16x16x32_bf16 v[180:183], a[36:39], a[108:111], v[180:183]
  ds_read_b64_tr_b16 a[102:103], v10 offset:45568
  buffer_load_dwordx4 v16, s[4:7], s83 offen offset:2048  lds
  v_mfma_f32_16x16x32_bf16 v[180:183], a[32:35], a[104:107], v[180:183]
  s_add_u32 s4, s4, 128
  s_addc_u32 s5, s5, 0
  v_mfma_f32_16x16x32_bf16 a[192:195], a[112:115], a[32:35], a[192:195]
  ds_read_b64_tr_b16 a[104:105], v11 offset:30720
  v_mfma_f32_16x16x32_bf16 a[192:195], a[116:119], a[36:39], a[192:195]
  v_mfma_f32_16x16x32_bf16 a[196:199], a[116:119], a[44:47], a[196:199]
  ds_read_b64_tr_b16 a[106:107], v11 offset:31232
  v_mfma_f32_16x16x32_bf16 a[196:199], a[112:115], a[40:43], a[196:199]
  v_mfma_f32_16x16x32_bf16 a[200:203], a[112:115], a[48:51], a[200:203]
  ds_read_b64_tr_b16 a[108:109], v11 offset:45056
  v_mfma_f32_16x16x32_bf16 a[200:203], a[116:119], a[52:55], a[200:203]
  v_mfma_f32_16x16x32_bf16 a[204:207], a[116:119], a[60:63], a[204:207]
  ds_read_b64_tr_b16 a[110:111], v11 offset:45568
  v_mfma_f32_16x16x32_bf16 a[204:207], a[112:115], a[56:59], a[204:207]
  s_waitcnt lgkmcnt(14)
  v_mfma_f32_16x16x32_bf16 v[64:67], a[64:67], a[0:3], v[64:67]
  ds_read_b64_tr_b16 a[112:113], v12 offset:28672
  s_add_u32 m0, s88, 0
  v_mfma_f32_16x16x32_bf16 v[64:67], a[68:71], a[4:7], v[64:67]
  buffer_load_dwordx4 v18, s[8:11], s94 offen  lds
  v_mfma_f32_16x16x32_bf16 v[88:91], a[68:71], a[12:15], v[88:91]
  ds_read_b64_tr_b16 a[114:115], v12 offset:28928
  v_mfma_f32_16x16x32_bf16 v[88:91], a[64:67], a[8:11], v[88:91]
  v_mfma_f32_16x16x32_bf16 v[112:115], a[64:67], a[16:19], v[112:115]
  ds_read_b64_tr_b16 a[116:117], v12 offset:43008
  s_add_u32 m0, s89, 0
  v_mfma_f32_16x16x32_bf16 v[112:115], a[68:71], a[20:23], v[112:115]
  buffer_load_dwordx4 v18, s[8:11], s95 offen  lds
  v_mfma_f32_16x16x32_bf16 v[136:139], a[68:71], a[28:31], v[136:139]
  ds_read_b64_tr_b16 a[118:119], v12 offset:43264
  v_mfma_f32_16x16x32_bf16 v[136:139], a[64:67], a[24:27], v[136:139]
  v_mfma_f32_16x16x32_bf16 v[140:143], a[72:75], a[24:27], v[140:143]
  ds_read_b128 a[32:35], v8 offset:43008
  v_mfma_f32_16x16x32_bf16 v[140:143], a[76:79], a[28:31], v[140:143]
  v_mfma_f32_16x16x32_bf16 v[116:119], a[76:79], a[20:23], v[116:119]
  ds_read_b128 a[36:39], v9 offset:43008
  v_mfma_f32_16x16x32_bf16 v[116:119], a[72:75], a[16:19], v[116:119]
  v_mfma_f32_16x16x32_bf16 v[92:95], a[72:75], a[8:11], v[92:95]
  ds_read_b128 a[40:43], v8 offset:45056
  s_add_u32 m0, s90, 0
  v_mfma_f32_16x16x32_bf16 v[92:95], a[76:79], a[12:15], v[92:95]
  buffer_load_dwordx4 v18, s[8:11], s96 offen  lds
  v_mfma_f32_16x16x32_bf16 v[68:71], a[76:79], a[4:7], v[68:71]
  ds_read_b128 a[44:47], v9 offset:45056
  v_mfma_f32_16x16x32_bf16 v[68:71], a[72:75], a[0:3], v[68:71]
  s_waitcnt lgkmcnt(14)
  v_mfma_f32_16x16x32_bf16 v[72:75], a[80:83], a[0:3], v[72:75]
  ds_read_b128 a[48:51], v8 offset:47104
  s_add_u32 m0, s91, 0
  v_mfma_f32_16x16x32_bf16 v[72:75], a[84:87], a[4:7], v[72:75]
  buffer_load_dwordx4 v19, s[8:11], s94 offen  lds
  v_mfma_f32_16x16x32_bf16 v[96:99], a[84:87], a[12:15], v[96:99]
  ds_read_b128 a[52:55], v9 offset:47104
  v_mfma_f32_16x16x32_bf16 v[96:99], a[80:83], a[8:11], v[96:99]
  v_mfma_f32_16x16x32_bf16 v[120:123], a[80:83], a[16:19], v[120:123]
  ds_read_b128 a[56:59], v8 offset:49152
  v_mfma_f32_16x16x32_bf16 v[120:123], a[84:87], a[20:23], v[120:123]
  v_mfma_f32_16x16x32_bf16 v[144:147], a[84:87], a[28:31], v[144:147]
  ds_read_b128 a[60:63], v9 offset:49152
  v_mfma_f32_16x16x32_bf16 v[144:147], a[80:83], a[24:27], v[144:147]
  v_mfma_f32_16x16x32_bf16 v[148:151], a[88:91], a[24:27], v[148:151]
  s_add_u32 m0, s92, 0
  v_mfma_f32_16x16x32_bf16 v[148:151], a[92:95], a[28:31], v[148:151]
  buffer_load_dwordx4 v19, s[8:11], s95 offen  lds
  v_mfma_f32_16x16x32_bf16 v[124:127], a[92:95], a[20:23], v[124:127]
  v_mfma_f32_16x16x32_bf16 v[124:127], a[88:91], a[16:19], v[124:127]
  v_mfma_f32_16x16x32_bf16 v[100:103], a[88:91], a[8:11], v[100:103]
  s_add_u32 m0, s93, 0
  v_mfma_f32_16x16x32_bf16 v[100:103], a[92:95], a[12:15], v[100:103]
  buffer_load_dwordx4 v19, s[8:11], s96 offen  lds
  v_mfma_f32_16x16x32_bf16 v[76:79], a[92:95], a[4:7], v[76:79]
  s_add_u32 s8, s8, 393216
  s_addc_u32 s9, s9, 0
  v_mfma_f32_16x16x32_bf16 v[76:79], a[88:91], a[0:3], v[76:79]
  s_waitcnt lgkmcnt(14)
  v_mfma_f32_16x16x32_bf16 v[80:83], a[0:3], a[96:99], v[80:83]
  v_mfma_f32_16x16x32_bf16 v[80:83], a[4:7], a[100:103], v[80:83]
  v_mfma_f32_16x16x32_bf16 v[104:107], a[12:15], a[100:103], v[104:107]
  v_mfma_f32_16x16x32_bf16 v[104:107], a[8:11], a[96:99], v[104:107]
  v_mfma_f32_16x16x32_bf16 v[128:131], a[16:19], a[96:99], v[128:131]
  s_add_u32 m0, s27, 6144
  v_mfma_f32_16x16x32_bf16 v[128:131], a[20:23], a[100:103], v[128:131]
  buffer_load_dwordx4 v20, s[68:71], 0 offen  lds
  v_mfma_f32_16x16x32_bf16 v[152:155], a[28:31], a[100:103], v[152:155]
  s_add_u32 s68, s68, 458752
  s_addc_u32 s69, s69, 0
  v_mfma_f32_16x16x32_bf16 v[152:155], a[24:27], a[96:99], v[152:155]
  s_waitcnt lgkmcnt(12)
  v_mfma_f32_16x16x32_bf16 v[156:159], a[24:27], a[104:107], v[156:159]
  s_mov_b32 s29, La_epi-La_base+0
  v_mfma_f32_16x16x32_bf16 v[156:159], a[28:31], a[108:111], v[156:159]
  buffer_load_dword a141, v6, s[76:79], s29 offen
  v_mfma_f32_16x16x32_bf16 v[132:135], a[20:23], a[108:111], v[132:135]
  v_mfma_f32_16x16x32_bf16 v[132:135], a[16:19], a[104:107], v[132:135]
  v_mfma_f32_16x16x32_bf16 v[108:111], a[8:11], a[104:107], v[108:111]
  v_mfma_f32_16x16x32_bf16 v[108:111], a[12:15], a[108:111], v[108:111]
  v_mfma_f32_16x16x32_bf16 v[84:87], a[4:7], a[108:111], v[84:87]
  v_mfma_f32_16x16x32_bf16 v[84:87], a[0:3], a[104:107], v[84:87]
  s_waitcnt lgkmcnt(8)
  v_mfma_f32_16x16x32_bf16 a[176:179], a[112:115], a[0:3], a[176:179]
  s_mov_b32 s29, La_epi-La_base+8192
  v_mfma_f32_16x16x32_bf16 a[176:179], a[116:119], a[4:7], a[176:179]
  buffer_load_dword a141, v6, s[76:79], s29 offen
  v_mfma_f32_16x16x32_bf16 a[180:183], a[116:119], a[12:15], a[180:183]
  v_mfma_f32_16x16x32_bf16 a[180:183], a[112:115], a[8:11], a[180:183]
  v_mfma_f32_16x16x32_bf16 a[184:187], a[112:115], a[16:19], a[184:187]
  v_mfma_f32_16x16x32_bf16 a[184:187], a[116:119], a[20:23], a[184:187]
  v_mfma_f32_16x16x32_bf16 a[188:191], a[116:119], a[28:31], a[188:191]
  v_mfma_f32_16x16x32_bf16 a[188:191], a[112:115], a[24:27], a[188:191]
  s_waitcnt vmcnt(9) lgkmcnt(0)
  s_barrier
  v_mfma_f32_16x16x32_bf16 v[160:163], a[64:67], a[32:35], v[160:163]
  ds_read_b128 a[0:3], v8 offset:0
  s_add_u32 m0, s84, 34816
  v_mfma_f32_16x16x32_bf16 v[160:163], a[68:71], a[36:39], v[160:163]
  v_and_b32 v33, v41, v43
  v_cmp_ne_u32 vcc, 1, v33
  s_cbranch_vccnz La_cs_slow
La_cs_back:
  buffer_load_dwordx4 v16, s[4:7], s80 offen offset:0  lds
  v_mfma_f32_16x16x32_bf16 v[184:187], a[68:71], a[44:47], v[184:187]
  ds_read_b128 a[4:7], v9 offset:0
  v_mfma_f32_16x16x32_bf16 v[184:187], a[64:67], a[40:43], v[184:187]
  ds_read_b128 a[16:19], v8 offset:4096
  v_add_f32_e64 v40, v40, v42
  v_mfma_f32_16x16x32_bf16 v[208:211], a[64:67], a[48:51], v[208:211]
  ds_read_b128 a[8:11], v8 offset:2048
  v_mfma_f32_16x16x32_bf16 v[208:211], a[68:71], a[52:55], v[208:211]
  buffer_load_dwordx4 v16, s[4:7], s80 offen offset:2048  lds
  v_mfma_f32_16x16x32_bf16 v[232:235], a[68:71], a[60:63], v[232:235]
  ds_read_b128 a[12:15], v9 offset:2048
  v_add_u32 v32, 155648, v32
  v_mfma_f32_16x16x32_bf16 v[232:235], a[64:67], a[56:59], v[232:235]
  ds_read_b128 a[20:23], v9 offset:4096
  v_mfma_f32_16x16x32_bf16 v[236:239], a[72:75], a[56:59], v[236:239]
  ds_read_b64_tr_b16 a[64:65], v13 offset:0
  v_mul_f32 v42, 0x3eeff558, v44
  v_mfma_f32_16x16x32_bf16 v[236:239], a[76:79], a[60:63], v[236:239]
  v_mfma_f32_16x16x32_bf16 v[212:215], a[76:79], a[52:55], v[212:215]
  ds_read_b64_tr_b16 a[66:67], v13 offset:512
  v_mfma_f32_16x16x32_bf16 v[212:215], a[72:75], a[48:51], v[212:215]
  ds_read_b128 a[24:27], v8 offset:6144
  v_mul_f32 v43, 0x3eeff558, v45
  v_mfma_f32_16x16x32_bf16 v[188:191], a[72:75], a[40:43], v[188:191]
  ds_read_b64_tr_b16 a[68:69], v13 offset:14336
  s_add_u32 m0, s85, 34816
  v_mfma_f32_16x16x32_bf16 v[188:191], a[76:79], a[44:47], v[188:191]
  ds_write2st64_b32 v32, v42, v43 offset0:18 offset1:23
  buffer_load_dwordx4 v16, s[4:7], s81 offen offset:0  lds
  v_mfma_f32_16x16x32_bf16 v[164:167], a[76:79], a[36:39], v[164:167]
  ds_read_b64_tr_b16 a[70:71], v13 offset:14848
  v_mfma_f32_16x16x32_bf16 v[164:167], a[72:75], a[32:35], v[164:167]
  ds_read_b128 a[28:31], v9 offset:6144
  v_mfma_f32_16x16x32_bf16 v[168:171], a[80:83], a[32:35], v[168:171]
  ds_read_b64_tr_b16 a[72:73], v14 offset:0
  v_lshlrev_b32_e64 v36, 16, v36
  v_mfma_f32_16x16x32_bf16 v[168:171], a[84:87], a[36:39], v[168:171]
  v_mfma_f32_16x16x32_bf16 v[192:195], a[84:87], a[44:47], v[192:195]
  ds_read_b64_tr_b16 a[74:75], v14 offset:512
  v_mul_f32 v36, 0x3eeff558, v36
  v_mfma_f32_16x16x32_bf16 v[192:195], a[80:83], a[40:43], v[192:195]
  v_mfma_f32_16x16x32_bf16 v[216:219], a[80:83], a[48:51], v[216:219]
  ds_read_b64_tr_b16 a[76:77], v14 offset:14336
  v_mfma_f32_16x16x32_bf16 v[216:219], a[84:87], a[52:55], v[216:219]
  ds_write2st64_b32 v32, v40, v36 offset0:10 offset1:14
  buffer_load_dwordx4 v16, s[4:7], s81 offen offset:2048  lds
  v_mfma_f32_16x16x32_bf16 v[240:243], a[84:87], a[60:63], v[240:243]
  ds_read_b64_tr_b16 a[78:79], v14 offset:14848
  v_mfma_f32_16x16x32_bf16 v[240:243], a[80:83], a[56:59], v[240:243]
  ds_write2st64_b32 v32, v44, v45 offset0:0 offset1:5
  v_mfma_f32_16x16x32_bf16 v[244:247], a[88:91], a[56:59], v[244:247]
  ds_read_b64_tr_b16 a[80:81], v13 offset:1024
  v_mfma_f32_16x16x32_bf16 v[244:247], a[92:95], a[60:63], v[244:247]
  v_mfma_f32_16x16x32_bf16 v[220:223], a[92:95], a[52:55], v[220:223]
  ds_read_b64_tr_b16 a[82:83], v13 offset:1536
  s_lshl_b32 s98, s20, 12
  v_mfma_f32_16x16x32_bf16 v[220:223], a[88:91], a[48:51], v[220:223]
  v_mfma_f32_16x16x32_bf16 v[196:199], a[88:91], a[40:43], v[196:199]
  ds_read_b64_tr_b16 a[84:85], v13 offset:15360
  v_lshrrev_b32 v18, 3, v2
  s_add_u32 m0, s86, 34816
  v_mfma_f32_16x16x32_bf16 v[196:199], a[92:95], a[44:47], v[196:199]
  buffer_load_dwordx4 v16, s[4:7], s82 offen offset:0  lds
  v_mfma_f32_16x16x32_bf16 v[172:175], a[92:95], a[36:39], v[172:175]
  ds_read_b64_tr_b16 a[86:87], v13 offset:15872
  v_mfma_f32_16x16x32_bf16 v[172:175], a[88:91], a[32:35], v[172:175]
  v_and_b32_e64 v19, 7, v2
  v_mfma_f32_16x16x32_bf16 v[176:179], a[32:35], a[96:99], v[176:179]
  ds_read_b64_tr_b16 a[88:89], v14 offset:1024
  v_mfma_f32_16x16x32_bf16 v[176:179], a[36:39], a[100:103], v[176:179]
  v_and_b32_e64 v20, 6, v18
  buffer_load_dwordx4 v16, s[4:7], s82 offen offset:2048  lds
  v_mfma_f32_16x16x32_bf16 v[200:203], a[44:47], a[100:103], v[200:203]
La_pad6:
  s_cbranch_execz La_pad10
  s_nop 0
  ds_read_b64_tr_b16 a[90:91], v14 offset:1536
  v_mfma_f32_16x16x32_bf16 v[200:203], a[40:43], a[96:99], v[200:203]
  v_mfma_f32_16x16x32_bf16 v[224:227], a[48:51], a[96:99], v[224:227]
  ds_read_b64_tr_b16 a[92:93], v14 offset:15360
  v_xor_b32_e64 v19, v19, v20
  v_mfma_f32_16x16x32_bf16 v[224:227], a[52:55], a[100:103], v[224:227]
  v_mfma_f32_16x16x32_bf16 v[248:251], a[60:63], a[100:103], v[248:251]
  ds_read_b64_tr_b16 a[94:95], v14 offset:15872
  s_lshl_b32 s29, s20, 4
  v_add_u32 v18, s29, v18
  v_mfma_f32_16x16x32_bf16 v[248:251], a[56:59], a[96:99], v[248:251]
  v_mfma_f32_16x16x32_bf16 v[252:255], a[56:59], a[104:107], v[252:255]
  ds_read_b64_tr_b16 a[96:97], v13 offset:2048
  s_add_u32 m0, s87, 34816
  v_mfma_f32_16x16x32_bf16 v[252:255], a[60:63], a[108:111], v[252:255]
  s_lshl_b32 s29, s26, 8
  v_lshl_add_u32 v18, v18, 11, s29
  buffer_load_dwordx4 v16, s[4:7], s83 offen offset:0  lds
  v_mfma_f32_16x16x32_bf16 v[228:231], a[52:55], a[108:111], v[228:231]
  ds_read_b64_tr_b16 a[98:99], v13 offset:2560
  v_mfma_f32_16x16x32_bf16 v[228:231], a[48:51], a[104:107], v[228:231]
  v_lshl_add_u32 v19, v19, 4, v18
  v_mfma_f32_16x16x32_bf16 v[204:207], a[40:43], a[104:107], v[204:207]
  ds_read_b64_tr_b16 a[100:101], v13 offset:16384
  v_mfma_f32_16x16x32_bf16 v[204:207], a[44:47], a[108:111], v[204:207]
  v_mfma_f32_16x16x32_bf16 v[180:183], a[36:39], a[108:111], v[180:183]
  ds_read_b64_tr_b16 a[102:103], v13 offset:16896
  s_and_b32 s29, s25, 14
  s_lshl_b32 s29, s29, 9
  s_add_u32 s29, s29, 262144
  v_mfma_f32_16x16x32_bf16 v[180:183], a[32:35], a[104:107], v[180:183]
  v_mfma_f32_16x16x32_bf16 a[192:195], a[112:115], a[32:35], a[192:195]
  ds_read_b64_tr_b16 a[104:105], v14 offset:2048
  v_lshl_add_u32 v20, v4, 4, s29
  v_mfma_f32_16x16x32_bf16 a[192:195], a[116:119], a[36:39], a[192:195]
  buffer_load_dwordx4 v16, s[4:7], s83 offen offset:2048  lds
  v_mfma_f32_16x16x32_bf16 a[196:199], a[116:119], a[44:47], a[196:199]
  ds_read_b64_tr_b16 a[106:107], v14 offset:2560
  s_add_u32 s4, s4, 128
  s_addc_u32 s5, s5, 0
  v_mfma_f32_16x16x32_bf16 a[196:199], a[112:115], a[40:43], a[196:199]
  s_and_b32 s29, s2, 3
  s_lshl_b32 s29, s29, 8
  v_add_u32_e64 v20, s29, v20
  v_mfma_f32_16x16x32_bf16 a[200:203], a[112:115], a[48:51], a[200:203]
  ds_read_b64_tr_b16 a[108:109], v14 offset:16384
  v_mfma_f32_16x16x32_bf16 a[200:203], a[116:119], a[52:55], a[200:203]
  v_mfma_f32_16x16x32_bf16 a[204:207], a[116:119], a[60:63], a[204:207]
  ds_read_b64_tr_b16 a[110:111], v14 offset:16896
  v_mfma_f32_16x16x32_bf16 a[204:207], a[112:115], a[56:59], a[204:207]
  s_waitcnt lgkmcnt(14)
  v_mfma_f32_16x16x32_bf16 v[64:67], a[64:67], a[0:3], v[64:67]
  ds_read_b64_tr_b16 a[112:113], v15 offset:0
  s_and_b32 s92, s2, 1
  s_bfe_u32 s29, s2, 0x10004
  s_xor_b32 s29, s29, s26
  v_mfma_f32_16x16x32_bf16 v[64:67], a[68:71], a[4:7], v[64:67]
  s_and_b32 s88, s29, 1
  s_sub_u32 s89, 0, s88
  s_and_b32 s93, s2, 3
  v_mfma_f32_16x16x32_bf16 v[88:91], a[68:71], a[12:15], v[88:91]
  ds_read_b64_tr_b16 a[114:115], v15 offset:256
  v_mfma_f32_16x16x32_bf16 v[88:91], a[64:67], a[8:11], v[88:91]
  v_mfma_f32_16x16x32_bf16 v[112:115], a[64:67], a[16:19], v[112:115]
  ds_read_b64_tr_b16 a[116:117], v15 offset:14336
  v_mfma_f32_16x16x32_bf16 v[112:115], a[68:71], a[20:23], v[112:115]
  v_mfma_f32_16x16x32_bf16 v[136:139], a[68:71], a[28:31], v[136:139]
  ds_read_b64_tr_b16 a[118:119], v15 offset:14592
  v_mfma_f32_16x16x32_bf16 v[136:139], a[64:67], a[24:27], v[136:139]
  v_mfma_f32_16x16x32_bf16 v[140:143], a[72:75], a[24:27], v[140:143]
  ds_read_b128 a[32:35], v8 offset:8192
  s_add_u32 m0, s98, 98304
  s_mul_i32 s68, s88, 393216
  s_mul_i32 s31, s93, 1572864
  s_add_u32 s68, s68, s31
  s_add_u32 s31, s68, 0
  v_mfma_f32_16x16x32_bf16 v[140:143], a[76:79], a[28:31], v[140:143]
  buffer_load_dwordx4 v19, s[44:47], s31 offen offset:0 lds
  v_mfma_f32_16x16x32_bf16 v[116:119], a[76:79], a[20:23], v[116:119]
  ds_read_b128 a[36:39], v9 offset:8192
  v_mfma_f32_16x16x32_bf16 v[116:119], a[72:75], a[16:19], v[116:119]
  v_mfma_f32_16x16x32_bf16 v[92:95], a[72:75], a[8:11], v[92:95]
  ds_read_b128 a[40:43], v8 offset:10240
  v_mfma_f32_16x16x32_bf16 v[92:95], a[76:79], a[12:15], v[92:95]
  v_mfma_f32_16x16x32_bf16 v[68:71], a[76:79], a[4:7], v[68:71]
  ds_read_b128 a[44:47], v9 offset:10240
  v_mfma_f32_16x16x32_bf16 v[68:71], a[72:75], a[0:3], v[68:71]
  s_waitcnt lgkmcnt(14)
  v_mfma_f32_16x16x32_bf16 v[72:75], a[80:83], a[0:3], v[72:75]
  ds_read_b128 a[48:51], v8 offset:12288
  s_add_u32 m0, s98, 99200
  v_mfma_f32_16x16x32_bf16 v[72:75], a[84:87], a[4:7], v[72:75]
  buffer_load_dwordx4 v19, s[44:47], s31 offen offset:128 lds
  v_mfma_f32_16x16x32_bf16 v[96:99], a[84:87], a[12:15], v[96:99]
  ds_read_b128 a[52:55], v9 offset:12288
  v_mfma_f32_16x16x32_bf16 v[96:99], a[80:83], a[8:11], v[96:99]
  v_mfma_f32_16x16x32_bf16 v[120:123], a[80:83], a[16:19], v[120:123]
  ds_read_b128 a[56:59], v8 offset:14336
  v_mfma_f32_16x16x32_bf16 v[120:123], a[84:87], a[20:23], v[120:123]
  v_mfma_f32_16x16x32_bf16 v[144:147], a[84:87], a[28:31], v[144:147]
  ds_read_b128 a[60:63], v9 offset:14336
  v_mfma_f32_16x16x32_bf16 v[144:147], a[80:83], a[24:27], v[144:147]
  v_mfma_f32_16x16x32_bf16 v[148:151], a[88:91], a[24:27], v[148:151]
  v_mfma_f32_16x16x32_bf16 v[148:151], a[92:95], a[28:31], v[148:151]
  v_mfma_f32_16x16x32_bf16 v[124:127], a[92:95], a[20:23], v[124:127]
  v_mfma_f32_16x16x32_bf16 v[124:127], a[88:91], a[16:19], v[124:127]
  v_mfma_f32_16x16x32_bf16 v[100:103], a[88:91], a[8:11], v[100:103]
  s_add_u32 m0, s98, 100352
  s_add_u32 s31, s68, 16384
  v_mfma_f32_16x16x32_bf16 v[100:103], a[92:95], a[12:15], v[100:103]
  buffer_load_dwordx4 v19, s[44:47], s31 offen offset:0 lds
  v_mfma_f32_16x16x32_bf16 v[76:79], a[92:95], a[4:7], v[76:79]
  v_mfma_f32_16x16x32_bf16 v[76:79], a[88:91], a[0:3], v[76:79]
  s_waitcnt lgkmcnt(14)
  v_mfma_f32_16x16x32_bf16 v[80:83], a[0:3], a[96:99], v[80:83]
  v_mfma_f32_16x16x32_bf16 v[80:83], a[4:7], a[100:103], v[80:83]
  v_mfma_f32_16x16x32_bf16 v[104:107], a[12:15], a[100:103], v[104:107]
  v_mfma_f32_16x16x32_bf16 v[104:107], a[8:11], a[96:99], v[104:107]
  v_mfma_f32_16x16x32_bf16 v[128:131], a[16:19], a[96:99], v[128:131]
  s_add_u32 m0, s98, 101248
  v_mfma_f32_16x16x32_bf16 v[128:131], a[20:23], a[100:103], v[128:131]
  buffer_load_dwordx4 v19, s[44:47], s31 offen offset:128 lds
  v_mfma_f32_16x16x32_bf16 v[152:155], a[28:31], a[100:103], v[152:155]
  v_mfma_f32_16x16x32_bf16 v[152:155], a[24:27], a[96:99], v[152:155]
  s_waitcnt lgkmcnt(12)
  v_mfma_f32_16x16x32_bf16 v[156:159], a[24:27], a[104:107], v[156:159]
  v_mfma_f32_16x16x32_bf16 v[156:159], a[28:31], a[108:111], v[156:159]
  v_mfma_f32_16x16x32_bf16 v[132:135], a[20:23], a[108:111], v[132:135]
  v_mfma_f32_16x16x32_bf16 v[132:135], a[16:19], a[104:107], v[132:135]
  v_mfma_f32_16x16x32_bf16 v[108:111], a[8:11], a[104:107], v[108:111]
  s_mov_b32 s29, La_epi-La_base+16384
  v_mfma_f32_16x16x32_bf16 v[108:111], a[12:15], a[108:111], v[108:111]
  buffer_load_dword a141, v6, s[76:79], s29 offen
  v_mfma_f32_16x16x32_bf16 v[84:87], a[4:7], a[108:111], v[84:87]
  v_mfma_f32_16x16x32_bf16 v[84:87], a[0:3], a[104:107], v[84:87]
  s_waitcnt lgkmcnt(8)
  v_mfma_f32_16x16x32_bf16 a[176:179], a[112:115], a[0:3], a[176:179]
  v_mfma_f32_16x16x32_bf16 a[176:179], a[116:119], a[4:7], a[176:179]
  v_mfma_f32_16x16x32_bf16 a[180:183], a[116:119], a[12:15], a[180:183]
  v_mfma_f32_16x16x32_bf16 a[180:183], a[112:115], a[8:11], a[180:183]
  v_mfma_f32_16x16x32_bf16 a[184:187], a[112:115], a[16:19], a[184:187]
  v_mfma_f32_16x16x32_bf16 a[184:187], a[116:119], a[20:23], a[184:187]
  v_mfma_f32_16x16x32_bf16 a[188:191], a[116:119], a[28:31], a[188:191]
  v_mfma_f32_16x16x32_bf16 a[188:191], a[112:115], a[24:27], a[188:191]
  s_waitcnt vmcnt(5) lgkmcnt(0)
  s_barrier
  v_mfma_f32_16x16x32_bf16 v[160:163], a[64:67], a[32:35], v[160:163]
  ds_read_b128 a[0:3], v8 offset:34816
  s_add_u32 m0, s98, 114688
  s_mul_i32 s69, s89, 393216
  s_mul_i32 s31, s93, 1572864
  s_add_u32 s69, s69, s31
  s_add_u32 s31, s69, 393216
  v_mfma_f32_16x16x32_bf16 v[160:163], a[68:71], a[36:39], v[160:163]
  buffer_load_dwordx4 v19, s[44:47], s31 offen offset:0 lds
  v_mfma_f32_16x16x32_bf16 v[184:187], a[68:71], a[44:47], v[184:187]
  ds_read_b128 a[4:7], v9 offset:34816
  s_and_b32 s29, s25, 1
  s_lshl_b32 s29, s29, 2
  s_add_u32 s29, s29, s20
  v_mfma_f32_16x16x32_bf16 v[184:187], a[64:67], a[40:43], v[184:187]
  ds_read_b128 a[16:19], v8 offset:38912
  v_mfma_f32_16x16x32_bf16 v[208:211], a[64:67], a[48:51], v[208:211]
  ds_read_b128 a[8:11], v8 offset:36864
  s_add_u32 m0, s98, 115584
  v_mfma_f32_16x16x32_bf16 v[208:211], a[68:71], a[52:55], v[208:211]
  buffer_load_dwordx4 v19, s[44:47], s31 offen offset:128 lds
  v_mfma_f32_16x16x32_bf16 v[232:235], a[68:71], a[60:63], v[232:235]
  ds_read_b128 a[12:15], v9 offset:36864
  v_mfma_f32_16x16x32_bf16 v[232:235], a[64:67], a[56:59], v[232:235]
  ds_read_b128 a[20:23], v9 offset:38912
  s_mul_i32 s39, s29, 295936
  v_lshl_add_u32 v16, v2, 4, s39
  v_mfma_f32_16x16x32_bf16 v[236:239], a[72:75], a[56:59], v[236:239]
  ds_read_b64_tr_b16 a[64:65], v10 offset:0
  v_mfma_f32_16x16x32_bf16 v[236:239], a[76:79], a[60:63], v[236:239]
  v_mfma_f32_16x16x32_bf16 v[212:215], a[76:79], a[52:55], v[212:215]
  ds_read_b64_tr_b16 a[66:67], v10 offset:512
  v_mfma_f32_16x16x32_bf16 v[212:215], a[72:75], a[48:51], v[212:215]
  ds_read_b128 a[24:27], v8 offset:40960
  v_mfma_f32_16x16x32_bf16 v[188:191], a[72:75], a[40:43], v[188:191]
  ds_read_b64_tr_b16 a[68:69], v10 offset:14336
  s_xor_b32 s29, s29, 4
  s_mul_i32 s39, s29, 295936
  v_lshl_add_u32 v7, v2, 4, s39
  s_add_u32 m0, s98, 116736
  s_add_u32 s31, s69, 409600
  v_mfma_f32_16x16x32_bf16 v[188:191], a[76:79], a[44:47], v[188:191]
  buffer_load_dwordx4 v19, s[44:47], s31 offen offset:0 lds
  v_mfma_f32_16x16x32_bf16 v[164:167], a[76:79], a[36:39], v[164:167]
  ds_read_b64_tr_b16 a[70:71], v10 offset:14848
  v_mfma_f32_16x16x32_bf16 v[164:167], a[72:75], a[32:35], v[164:167]
  ds_read_b128 a[28:31], v9 offset:40960
  v_mfma_f32_16x16x32_bf16 v[168:171], a[80:83], a[32:35], v[168:171]
  ds_read_b64_tr_b16 a[72:73], v11 offset:0
  v_mfma_f32_16x16x32_bf16 v[168:171], a[84:87], a[36:39], v[168:171]
  s_lshr_b32 s29, s25, 1
  s_mul_i32 s29, s29, 2367488
  s_add_u32 s29, s29, 8388608
  v_mfma_f32_16x16x32_bf16 v[192:195], a[84:87], a[44:47], v[192:195]
  ds_read_b64_tr_b16 a[74:75], v11 offset:512
  v_mfma_f32_16x16x32_bf16 v[192:195], a[80:83], a[40:43], v[192:195]
  v_mfma_f32_16x16x32_bf16 v[216:219], a[80:83], a[48:51], v[216:219]
  ds_read_b64_tr_b16 a[76:77], v11 offset:14336
  s_add_u32 m0, s98, 117632
  v_mfma_f32_16x16x32_bf16 v[216:219], a[84:87], a[52:55], v[216:219]
  buffer_load_dwordx4 v19, s[44:47], s31 offen offset:128 lds
  v_mfma_f32_16x16x32_bf16 v[240:243], a[84:87], a[60:63], v[240:243]
  ds_read_b64_tr_b16 a[78:79], v11 offset:14848
  s_add_u32 s4, s12, s29
  s_addc_u32 s5, s13, 0
  s_mov_b32 s6, 2367488
  v_mfma_f32_16x16x32_bf16 v[240:243], a[80:83], a[56:59], v[240:243]
  v_mfma_f32_16x16x32_bf16 v[244:247], a[88:91], a[56:59], v[244:247]
  ds_read_b64_tr_b16 a[80:81], v10 offset:1024
  v_mfma_f32_16x16x32_bf16 v[244:247], a[92:95], a[60:63], v[244:247]
  v_mfma_f32_16x16x32_bf16 v[220:223], a[92:95], a[52:55], v[220:223]
  ds_read_b64_tr_b16 a[82:83], v10 offset:1536
  v_mfma_f32_16x16x32_bf16 v[220:223], a[88:91], a[48:51], v[220:223]
  s_lshl_b32 s29, s23, 1
  s_add_u32 s29, s29, s21
  s_mul_i32 s29, s29, 1183744
  v_mfma_f32_16x16x32_bf16 v[196:199], a[88:91], a[40:43], v[196:199]
  ds_read_b64_tr_b16 a[84:85], v10 offset:15360
  s_add_u32 m0, s98, 131072
  s_add_u32 s31, s68, 786432
  v_mfma_f32_16x16x32_bf16 v[196:199], a[92:95], a[44:47], v[196:199]
  buffer_load_dwordx4 v19, s[44:47], s31 offen offset:0 lds
  v_mfma_f32_16x16x32_bf16 v[172:175], a[92:95], a[36:39], v[172:175]
  ds_read_b64_tr_b16 a[86:87], v10 offset:15872
  v_mfma_f32_16x16x32_bf16 v[172:175], a[88:91], a[32:35], v[172:175]
  v_mfma_f32_16x16x32_bf16 v[176:179], a[32:35], a[96:99], v[176:179]
  ds_read_b64_tr_b16 a[88:89], v11 offset:1024
  s_add_u32 s29, s29, 8388608
  s_add_u32 s12, s12, s29
  s_addc_u32 s13, s13, 0
  s_add_u32 m0, s98, 131968
  v_mfma_f32_16x16x32_bf16 v[176:179], a[36:39], a[100:103], v[176:179]
  buffer_load_dwordx4 v19, s[44:47], s31 offen offset:128 lds
  v_mfma_f32_16x16x32_bf16 v[200:203], a[44:47], a[100:103], v[200:203]
  ds_read_b64_tr_b16 a[90:91], v11 offset:1536
  v_mfma_f32_16x16x32_bf16 v[200:203], a[40:43], a[96:99], v[200:203]
  v_mfma_f32_16x16x32_bf16 v[224:227], a[48:51], a[96:99], v[224:227]
  ds_read_b64_tr_b16 a[92:93], v11 offset:15360
  v_mfma_f32_16x16x32_bf16 v[224:227], a[52:55], a[100:103], v[224:227]
  s_mov_b32 s14, 1183744
  s_mov_b32 s15, 0x20000
  v_mfma_f32_16x16x32_bf16 v[248:251], a[60:63], a[100:103], v[248:251]
  ds_read_b64_tr_b16 a[94:95], v11 offset:15872
  v_mfma_f32_16x16x32_bf16 v[248:251], a[56:59], a[96:99], v[248:251]
  v_mfma_f32_16x16x32_bf16 v[252:255], a[56:59], a[104:107], v[252:255]
  ds_read_b64_tr_b16 a[96:97], v10 offset:2048
  s_add_u32 m0, s98, 133120
  s_add_u32 s31, s68, 802816
  v_mfma_f32_16x16x32_bf16 v[252:255], a[60:63], a[108:111], v[252:255]
  buffer_load_dwordx4 v19, s[44:47], s31 offen offset:0 lds
  v_mfma_f32_16x16x32_bf16 v[228:231], a[52:55], a[108:111], v[228:231]
  ds_read_b64_tr_b16 a[98:99], v10 offset:2560
  s_movk_i32 s34, 0x1000
  s_mov_b32 s94, 8192
  v_mfma_f32_16x16x32_bf16 v[228:231], a[48:51], a[104:107], v[228:231]
  v_mfma_f32_16x16x32_bf16 v[204:207], a[40:43], a[104:107], v[204:207]
  ds_read_b64_tr_b16 a[100:101], v10 offset:16384
  v_mfma_f32_16x16x32_bf16 v[204:207], a[44:47], a[108:111], v[204:207]
  v_mfma_f32_16x16x32_bf16 v[180:183], a[36:39], a[108:111], v[180:183]
  ds_read_b64_tr_b16 a[102:103], v10 offset:16896
  v_mfma_f32_16x16x32_bf16 v[180:183], a[32:35], a[104:107], v[180:183]
  s_mov_b32 s32, 16384
  s_mov_b32 s28, 24576
  v_mfma_f32_16x16x32_bf16 a[192:195], a[112:115], a[32:35], a[192:195]
  ds_read_b64_tr_b16 a[104:105], v11 offset:2048
  s_add_u32 m0, s98, 134016
  v_mfma_f32_16x16x32_bf16 a[192:195], a[116:119], a[36:39], a[192:195]
  buffer_load_dwordx4 v19, s[44:47], s31 offen offset:128 lds
  v_mfma_f32_16x16x32_bf16 a[196:199], a[116:119], a[44:47], a[196:199]
  ds_read_b64_tr_b16 a[106:107], v11 offset:2560
  v_mfma_f32_16x16x32_bf16 a[196:199], a[112:115], a[40:43], a[196:199]
  v_mfma_f32_16x16x32_bf16 a[200:203], a[112:115], a[48:51], a[200:203]
  ds_read_b64_tr_b16 a[108:109], v11 offset:16384
  v_mfma_f32_16x16x32_bf16 a[200:203], a[116:119], a[52:55], a[200:203]
  v_mfma_f32_16x16x32_bf16 a[204:207], a[116:119], a[60:63], a[204:207]
  ds_read_b64_tr_b16 a[110:111], v11 offset:16896
  v_mfma_f32_16x16x32_bf16 a[204:207], a[112:115], a[56:59], a[204:207]
  s_waitcnt lgkmcnt(14)
  v_mfma_f32_16x16x32_bf16 v[64:67], a[64:67], a[0:3], v[64:67]
  ds_read_b64_tr_b16 a[112:113], v12 offset:0
  s_add_u32 m0, s98, 0
  s_add_u32 s31, s69, 1179648
  v_mfma_f32_16x16x32_bf16 v[64:67], a[68:71], a[4:7], v[64:67]
  buffer_load_dwordx4 v19, s[44:47], s31 offen offset:0 lds
  v_mfma_f32_16x16x32_bf16 v[88:91], a[68:71], a[12:15], v[88:91]
  ds_read_b64_tr_b16 a[114:115], v12 offset:256
  v_mfma_f32_16x16x32_bf16 v[88:91], a[64:67], a[8:11], v[88:91]
  v_mfma_f32_16x16x32_bf16 v[112:115], a[64:67], a[16:19], v[112:115]
  ds_read_b64_tr_b16 a[116:117], v12 offset:14336
  s_add_u32 m0, s98, 896
  v_mfma_f32_16x16x32_bf16 v[112:115], a[68:71], a[20:23], v[112:115]
  buffer_load_dwordx4 v19, s[44:47], s31 offen offset:128 lds
  v_mfma_f32_16x16x32_bf16 v[136:139], a[68:71], a[28:31], v[136:139]
  ds_read_b64_tr_b16 a[118:119], v12 offset:14592
  v_mfma_f32_16x16x32_bf16 v[136:139], a[64:67], a[24:27], v[136:139]
  v_mfma_f32_16x16x32_bf16 v[140:143], a[72:75], a[24:27], v[140:143]
  ds_read_b128 a[32:35], v8 offset:43008
  v_mfma_f32_16x16x32_bf16 v[140:143], a[76:79], a[28:31], v[140:143]
  v_mfma_f32_16x16x32_bf16 v[116:119], a[76:79], a[20:23], v[116:119]
  ds_read_b128 a[36:39], v9 offset:43008
  v_mfma_f32_16x16x32_bf16 v[116:119], a[72:75], a[16:19], v[116:119]
  v_mfma_f32_16x16x32_bf16 v[92:95], a[72:75], a[8:11], v[92:95]
  ds_read_b128 a[40:43], v8 offset:45056
  s_add_u32 m0, s98, 2048
  s_add_u32 s31, s69, 1196032
  v_mfma_f32_16x16x32_bf16 v[92:95], a[76:79], a[12:15], v[92:95]
  buffer_load_dwordx4 v19, s[44:47], s31 offen offset:0 lds
  v_mfma_f32_16x16x32_bf16 v[68:71], a[76:79], a[4:7], v[68:71]
  ds_read_b128 a[44:47], v9 offset:45056
  v_mfma_f32_16x16x32_bf16 v[68:71], a[72:75], a[0:3], v[68:71]
  s_waitcnt lgkmcnt(14)
  v_mfma_f32_16x16x32_bf16 v[72:75], a[80:83], a[0:3], v[72:75]
  ds_read_b128 a[48:51], v8 offset:47104
  v_mfma_f32_16x16x32_bf16 v[72:75], a[84:87], a[4:7], v[72:75]
  v_mfma_f32_16x16x32_bf16 v[96:99], a[84:87], a[12:15], v[96:99]
  ds_read_b128 a[52:55], v9 offset:47104
  v_mfma_f32_16x16x32_bf16 v[96:99], a[80:83], a[8:11], v[96:99]
  v_mfma_f32_16x16x32_bf16 v[120:123], a[80:83], a[16:19], v[120:123]
  ds_read_b128 a[56:59], v8 offset:49152
  s_add_u32 m0, s98, 2944
  v_mfma_f32_16x16x32_bf16 v[120:123], a[84:87], a[20:23], v[120:123]
  buffer_load_dwordx4 v19, s[44:47], s31 offen offset:128 lds
  v_mfma_f32_16x16x32_bf16 v[144:147], a[84:87], a[28:31], v[144:147]
  ds_read_b128 a[60:63], v9 offset:49152
  v_mfma_f32_16x16x32_bf16 v[144:147], a[80:83], a[24:27], v[144:147]
  v_mfma_f32_16x16x32_bf16 v[148:151], a[88:91], a[24:27], v[148:151]
  v_mfma_f32_16x16x32_bf16 v[148:151], a[92:95], a[28:31], v[148:151]
  v_mfma_f32_16x16x32_bf16 v[124:127], a[92:95], a[20:23], v[124:127]
  v_mfma_f32_16x16x32_bf16 v[124:127], a[88:91], a[16:19], v[124:127]
  v_mfma_f32_16x16x32_bf16 v[100:103], a[88:91], a[8:11], v[100:103]
  s_add_u32 m0, s98, 16384
  s_add_u32 s31, s68, 131072
  v_mfma_f32_16x16x32_bf16 v[100:103], a[92:95], a[12:15], v[100:103]
  buffer_load_dwordx4 v19, s[44:47], s31 offen offset:0 lds
  v_mfma_f32_16x16x32_bf16 v[76:79], a[92:95], a[4:7], v[76:79]
  v_mfma_f32_16x16x32_bf16 v[76:79], a[88:91], a[0:3], v[76:79]
  s_waitcnt lgkmcnt(14)
  v_mfma_f32_16x16x32_bf16 v[80:83], a[0:3], a[96:99], v[80:83]
  s_add_u32 m0, s98, 17280
  v_mfma_f32_16x16x32_bf16 v[80:83], a[4:7], a[100:103], v[80:83]
  buffer_load_dwordx4 v19, s[44:47], s31 offen offset:128 lds
  v_mfma_f32_16x16x32_bf16 v[104:107], a[12:15], a[100:103], v[104:107]
  v_mfma_f32_16x16x32_bf16 v[104:107], a[8:11], a[96:99], v[104:107]
  v_mfma_f32_16x16x32_bf16 v[128:131], a[16:19], a[96:99], v[128:131]
  v_mfma_f32_16x16x32_bf16 v[128:131], a[20:23], a[100:103], v[128:131]
  v_mfma_f32_16x16x32_bf16 v[152:155], a[28:31], a[100:103], v[152:155]
  v_mfma_f32_16x16x32_bf16 v[152:155], a[24:27], a[96:99], v[152:155]
  s_waitcnt lgkmcnt(12)
  v_mfma_f32_16x16x32_bf16 v[156:159], a[24:27], a[104:107], v[156:159]
  s_add_u32 m0, s98, 18432
  s_add_u32 s31, s68, 147456
  v_mfma_f32_16x16x32_bf16 v[156:159], a[28:31], a[108:111], v[156:159]
  buffer_load_dwordx4 v19, s[44:47], s31 offen offset:0 lds
  v_mfma_f32_16x16x32_bf16 v[132:135], a[20:23], a[108:111], v[132:135]
  v_mfma_f32_16x16x32_bf16 v[132:135], a[16:19], a[104:107], v[132:135]
  v_mfma_f32_16x16x32_bf16 v[108:111], a[8:11], a[104:107], v[108:111]
  v_mfma_f32_16x16x32_bf16 v[108:111], a[12:15], a[108:111], v[108:111]
  v_mfma_f32_16x16x32_bf16 v[84:87], a[4:7], a[108:111], v[84:87]
  v_mfma_f32_16x16x32_bf16 v[84:87], a[0:3], a[104:107], v[84:87]
  s_waitcnt lgkmcnt(8)
  v_mfma_f32_16x16x32_bf16 a[176:179], a[112:115], a[0:3], a[176:179]
  s_add_u32 m0, s98, 19328
  v_mfma_f32_16x16x32_bf16 a[176:179], a[116:119], a[4:7], a[176:179]
  buffer_load_dwordx4 v19, s[44:47], s31 offen offset:128 lds
  v_mfma_f32_16x16x32_bf16 a[180:183], a[116:119], a[12:15], a[180:183]
  v_mfma_f32_16x16x32_bf16 a[180:183], a[112:115], a[8:11], a[180:183]
  v_mfma_f32_16x16x32_bf16 a[184:187], a[112:115], a[16:19], a[184:187]
  v_mfma_f32_16x16x32_bf16 a[184:187], a[116:119], a[20:23], a[184:187]
  v_mfma_f32_16x16x32_bf16 a[188:191], a[116:119], a[28:31], a[188:191]
  v_mfma_f32_16x16x32_bf16 a[188:191], a[112:115], a[24:27], a[188:191]
  s_waitcnt lgkmcnt(0)
  s_barrier
  v_mfma_f32_16x16x32_bf16 v[160:163], a[64:67], a[32:35], v[160:163]
  s_lshl_b32 s29, s21, 9
  s_add_u32 s29, s29, 155648
  v_lshl_add_u32 v30, v4, 2, s29
  s_add_u32 m0, s98, 32768
  s_add_u32 s31, s69, 524288
  v_mfma_f32_16x16x32_bf16 v[160:163], a[68:71], a[36:39], v[160:163]
  s_mov_b32 s64, 0x409d30fc
  s_mov_b32 s65, 0x3eeff558
  buffer_load_dwordx4 v19, s[44:47], s31 offen offset:0 lds
  v_mfma_f32_16x16x32_bf16 v[184:187], a[68:71], a[44:47], v[184:187]
  v_mfma_f32_16x16x32_bf16 v[184:187], a[64:67], a[40:43], v[184:187]
  v_lshl_add_u32 v31, v3, 4, s29
  v_mfma_f32_16x16x32_bf16 v[208:211], a[64:67], a[48:51], v[208:211]
  s_add_u32 m0, s98, 33664
  v_mfma_f32_16x16x32_bf16 v[208:211], a[68:71], a[52:55], v[208:211]
  s_lshl_b32 s29, s22, 7
  s_add_u32 s29, s29, 158208
  v_lshl_add_u32 v26, v3, 4, s29
  buffer_load_dwordx4 v19, s[44:47], s31 offen offset:128 lds
  v_mfma_f32_16x16x32_bf16 v[232:235], a[68:71], a[60:63], v[232:235]
  v_mfma_f32_16x16x32_bf16 v[232:235], a[64:67], a[56:59], v[232:235]
  v_lshl_add_u32 v27, v4, 2, s29
  v_mfma_f32_16x16x32_bf16 v[236:239], a[72:75], a[56:59], v[236:239]
  ds_read_b128 v[8:11], v26 offset:0
  v_mfma_f32_16x16x32_bf16 v[236:239], a[76:79], a[60:63], v[236:239]
  v_mfma_f32_16x16x32_bf16 v[212:215], a[76:79], a[52:55], v[212:215]
  ds_read_b128 v[12:15], v26 offset:64
  v_mfma_f32_16x16x32_bf16 v[212:215], a[72:75], a[48:51], v[212:215]
  v_mfma_f32_16x16x32_bf16 v[188:191], a[72:75], a[40:43], v[188:191]
  ds_read_b128 v[40:43], v26 offset:256
  s_add_u32 m0, s98, 34816
  s_add_u32 s31, s69, 540672
  v_mfma_f32_16x16x32_bf16 v[188:191], a[76:79], a[44:47], v[188:191]
  buffer_load_dwordx4 v19, s[44:47], s31 offen offset:0 lds
  v_mfma_f32_16x16x32_bf16 v[164:167], a[76:79], a[36:39], v[164:167]
  ds_read_b128 v[44:47], v26 offset:320
  v_mfma_f32_16x16x32_bf16 v[164:167], a[72:75], a[32:35], v[164:167]
  v_mfma_f32_16x16x32_bf16 v[168:171], a[80:83], a[32:35], v[168:171]
  ds_read_b32 v36, v27 offset:512
  ds_read_b32 v37, v27 offset:576
  v_mfma_f32_16x16x32_bf16 v[168:171], a[84:87], a[36:39], v[168:171]
  ds_read_b32 v24, v30 offset:448
  ds_read_b32 v25, v30 offset:1728
  v_mfma_f32_16x16x32_bf16 v[192:195], a[84:87], a[44:47], v[192:195]
  v_mfma_f32_16x16x32_bf16 v[192:195], a[80:83], a[40:43], v[192:195]
  ds_read_b128 v[56:59], v31 offset:448
  ds_read_b128 v[60:63], v31 offset:1728
  v_mfma_f32_16x16x32_bf16 v[216:219], a[80:83], a[48:51], v[216:219]
  s_add_u32 m0, s98, 35712
  v_mfma_f32_16x16x32_bf16 v[216:219], a[84:87], a[52:55], v[216:219]
  v_and_b32 v32, 1, v3
  buffer_load_dwordx4 v19, s[44:47], s31 offen offset:128 lds
  v_mfma_f32_16x16x32_bf16 v[240:243], a[84:87], a[60:63], v[240:243]
  v_mfma_f32_16x16x32_bf16 v[240:243], a[80:83], a[56:59], v[240:243]
  v_lshlrev_b32 v21, 4, v32
  v_mfma_f32_16x16x32_bf16 v[244:247], a[88:91], a[56:59], v[244:247]
  v_mfma_f32_16x16x32_bf16 v[244:247], a[92:95], a[60:63], v[244:247]
  v_lshlrev_b32 v28, 4, v2
  v_mfma_f32_16x16x32_bf16 v[220:223], a[92:95], a[52:55], v[220:223]
  v_lshlrev_b32 v32, 3, v2
  v_mfma_f32_16x16x32_bf16 v[220:223], a[88:91], a[48:51], v[220:223]
  v_mfma_f32_16x16x32_bf16 v[196:199], a[88:91], a[40:43], v[196:199]
  s_lshl_b32 s90, s33, 12
  s_add_u32 s90, s90, 1048576
  s_sub_u32 s91, s90, 131072
  s_add_u32 m0, s98, 49152
  s_add_u32 s31, s68, 917504
  v_mfma_f32_16x16x32_bf16 v[196:199], a[92:95], a[44:47], v[196:199]
  buffer_load_dwordx4 v19, s[44:47], s31 offen offset:0 lds
  v_mfma_f32_16x16x32_bf16 v[172:175], a[92:95], a[36:39], v[172:175]
  s_cmp_lt_u32 s33, 32
  s_cselect_b32 s91, 0x40000000, s91
  v_mfma_f32_16x16x32_bf16 v[172:175], a[88:91], a[32:35], v[172:175]
  v_mfma_f32_16x16x32_bf16 v[176:179], a[32:35], a[96:99], v[176:179]
  v_lshl_add_u32 v21, v5, 6, v21
  s_add_u32 m0, s98, 50048
  v_mfma_f32_16x16x32_bf16 v[176:179], a[36:39], a[100:103], v[176:179]
  s_lshl_b32 s29, s22, 5
  s_add_u32 s29, s29, 158976
  v_add_u32 v21, s29, v21
  buffer_load_dwordx4 v19, s[44:47], s31 offen offset:128 lds
  v_mfma_f32_16x16x32_bf16 v[200:203], a[44:47], a[100:103], v[200:203]
  v_mfma_f32_16x16x32_bf16 v[200:203], a[40:43], a[96:99], v[200:203]
  s_lshl_b32 s29, s24, 1
  s_add_u32 s29, s29, s22
  s_lshl_b32 s29, s29, 10
  v_mfma_f32_16x16x32_bf16 v[224:227], a[48:51], a[96:99], v[224:227]
  v_mfma_f32_16x16x32_bf16 v[224:227], a[52:55], a[100:103], v[224:227]
  v_lshl_add_u32 v18, v2, 4, s29
  v_mfma_f32_16x16x32_bf16 v[248:251], a[60:63], a[100:103], v[248:251]
  v_mfma_f32_16x16x32_bf16 v[248:251], a[56:59], a[96:99], v[248:251]
  v_mul_u32_u24 v17, 147968, v5
  v_mfma_f32_16x16x32_bf16 v[252:255], a[56:59], a[104:107], v[252:255]
  s_add_u32 m0, s98, 51200
  s_add_u32 s31, s68, 933888
  v_mfma_f32_16x16x32_bf16 v[252:255], a[60:63], a[108:111], v[252:255]
  v_and_b32 v34, 31, v2
  buffer_load_dwordx4 v19, s[44:47], s31 offen offset:0 lds
  v_mfma_f32_16x16x32_bf16 v[228:231], a[52:55], a[108:111], v[228:231]
  v_lshl_add_u32 v17, v34, 4, v17
  v_mfma_f32_16x16x32_bf16 v[228:231], a[48:51], a[104:107], v[228:231]
  v_mfma_f32_16x16x32_bf16 v[204:207], a[40:43], a[104:107], v[204:207]
  s_lshl_b32 s29, s24, 1
  s_add_u32 s29, s29, s22
  s_add_u32 s29, s29, 256
  v_mfma_f32_16x16x32_bf16 v[204:207], a[44:47], a[108:111], v[204:207]
  v_mfma_f32_16x16x32_bf16 v[180:183], a[36:39], a[108:111], v[180:183]
  s_lshl_b32 s29, s29, 9
  v_add_u32 v17, s29, v17
  v_mfma_f32_16x16x32_bf16 v[180:183], a[32:35], a[104:107], v[180:183]
  v_mfma_f32_16x16x32_bf16 a[192:195], a[112:115], a[32:35], a[192:195]
  s_mov_b32 s86, 0x3e8293ee
  s_mov_b32 s87, 0x3e8293ee
  s_add_u32 m0, s98, 52096
  v_mfma_f32_16x16x32_bf16 a[192:195], a[116:119], a[36:39], a[192:195]
  buffer_load_dwordx4 v19, s[44:47], s31 offen offset:128 lds
  v_mfma_f32_16x16x32_bf16 a[196:199], a[116:119], a[44:47], a[196:199]
  v_mfma_f32_16x16x32_bf16 a[196:199], a[112:115], a[40:43], a[196:199]
  v_mfma_f32_16x16x32_bf16 a[200:203], a[112:115], a[48:51], a[200:203]
  v_mfma_f32_16x16x32_bf16 a[200:203], a[116:119], a[52:55], a[200:203]
  v_mfma_f32_16x16x32_bf16 a[204:207], a[116:119], a[60:63], a[204:207]
  v_mfma_f32_16x16x32_bf16 a[204:207], a[112:115], a[56:59], a[204:207]
La_epi:
  s_waitcnt lgkmcnt(0)
  s_nop 0
  ds_read_b32 v22, v30 offset:384
  ds_read_b32 v23, v30 offset:1664
  ds_read_b128 v[48:51], v31 offset:384
  ds_read_b128 v[52:55], v31 offset:1664
  v_pk_mul_f32 v[232:233], v[232:233], v[24:25] op_sel_hi:[1,0]
  v_pk_mul_f32 v[234:235], v[234:235], v[24:25] op_sel_hi:[1,0]
  v_pk_mul_f32 v[236:237], v[236:237], v[24:25] op_sel_hi:[1,0]
  v_pk_mul_f32 v[238:239], v[238:239], v[24:25] op_sel_hi:[1,0]
  v_pk_fma_f32 v[232:233], v[8:9], v[24:25], v[232:233] op_sel:[0,1,0] op_sel_hi:[1,1,1] neg_lo:[0,1,0] neg_hi:[0,1,0]
  v_pk_fma_f32 v[234:235], v[10:11], v[24:25], v[234:235] op_sel:[0,1,0] op_sel_hi:[1,1,1] neg_lo:[0,1,0] neg_hi:[0,1,0]
  v_pk_fma_f32 v[236:237], v[12:13], v[24:25], v[236:237] op_sel:[0,1,0] op_sel_hi:[1,1,1] neg_lo:[0,1,0] neg_hi:[0,1,0]
  v_pk_fma_f32 v[238:239], v[14:15], v[24:25], v[238:239] op_sel:[0,1,0] op_sel_hi:[1,1,1] neg_lo:[0,1,0] neg_hi:[0,1,0]
  v_cvt_pk_bf16_f32 v232, v232, v233
  v_cvt_pk_bf16_f32 v233, v234, v235
  v_cvt_pk_bf16_f32 v234, v236, v237
  v_cvt_pk_bf16_f32 v235, v238, v239
  v_pk_mul_f32 v[240:241], v[240:241], v[24:25] op_sel_hi:[1,0]
  v_pk_mul_f32 v[242:243], v[242:243], v[24:25] op_sel_hi:[1,0]
  v_pk_mul_f32 v[244:245], v[244:245], v[24:25] op_sel_hi:[1,0]
  v_pk_mul_f32 v[246:247], v[246:247], v[24:25] op_sel_hi:[1,0]
  v_pk_fma_f32 v[240:241], v[40:41], v[24:25], v[240:241] op_sel:[0,1,0] op_sel_hi:[1,1,1] neg_lo:[0,1,0] neg_hi:[0,1,0]
  v_pk_fma_f32 v[242:243], v[42:43], v[24:25], v[242:243] op_sel:[0,1,0] op_sel_hi:[1,1,1] neg_lo:[0,1,0] neg_hi:[0,1,0]
  v_pk_fma_f32 v[244:245], v[44:45], v[24:25], v[244:245] op_sel:[0,1,0] op_sel_hi:[1,1,1] neg_lo:[0,1,0] neg_hi:[0,1,0]
  v_pk_fma_f32 v[246:247], v[46:47], v[24:25], v[246:247] op_sel:[0,1,0] op_sel_hi:[1,1,1] neg_lo:[0,1,0] neg_hi:[0,1,0]
  v_cvt_pk_bf16_f32 v236, v240, v241
  v_cvt_pk_bf16_f32 v237, v242, v243
  v_cvt_pk_bf16_f32 v238, v244, v245
  v_cvt_pk_bf16_f32 v239, v246, v247
  v_pk_mul_f32 v[248:249], v[248:249], v[56:57]
  v_pk_mul_f32 v[250:251], v[250:251], v[58:59]
  v_pk_mul_f32 v[252:253], v[252:253], v[56:57]
  v_pk_mul_f32 v[254:255], v[254:255], v[58:59]
  v_pk_fma_f32 v[248:249], v[60:61], v[36:37], v[248:249] op_sel:[0,0,0] op_sel_hi:[1,0,1] neg_lo:[0,1,0] neg_hi:[0,1,0]
  v_pk_fma_f32 v[250:251], v[62:63], v[36:37], v[250:251] op_sel:[0,0,0] op_sel_hi:[1,0,1] neg_lo:[0,1,0] neg_hi:[0,1,0]
  v_pk_fma_f32 v[252:253], v[60:61], v[36:37], v[252:253] op_sel:[0,1,0] op_sel_hi:[1,1,1] neg_lo:[0,1,0] neg_hi:[0,1,0]
  v_pk_fma_f32 v[254:255], v[62:63], v[36:37], v[254:255] op_sel:[0,1,0] op_sel_hi:[1,1,1] neg_lo:[0,1,0] neg_hi:[0,1,0]
  v_cvt_pk_bf16_f32 v242, v248, v249
  v_cvt_pk_bf16_f32 v243, v250, v251
  v_cvt_pk_bf16_f32 v246, v252, v253
  v_cvt_pk_bf16_f32 v247, v254, v255
La_pad7:
  s_cbranch_execz La_pad11
  s_nop 0
  s_waitcnt lgkmcnt(0)
  s_nop 0
  ds_read_b32 v24, v30 offset:320
  ds_read_b32 v25, v30 offset:1600
  ds_read_b128 v[56:59], v31 offset:320
  ds_read_b128 v[60:63], v31 offset:1600
  v_pk_mul_f32 v[208:209], v[208:209], v[22:23] op_sel_hi:[1,0]
  v_pk_mul_f32 v[210:211], v[210:211], v[22:23] op_sel_hi:[1,0]
  buffer_store_dwordx4 v[236:239], v28, s[16:19], s90 offen offset:1024 sc1
  v_pk_mul_f32 v[212:213], v[212:213], v[22:23] op_sel_hi:[1,0]
  v_pk_mul_f32 v[214:215], v[214:215], v[22:23] op_sel_hi:[1,0]
  v_pk_fma_f32 v[208:209], v[8:9], v[22:23], v[208:209] op_sel:[0,1,0] op_sel_hi:[1,1,1] neg_lo:[0,1,0] neg_hi:[0,1,0]
  v_pk_fma_f32 v[210:211], v[10:11], v[22:23], v[210:211] op_sel:[0,1,0] op_sel_hi:[1,1,1] neg_lo:[0,1,0] neg_hi:[0,1,0]
  v_pk_fma_f32 v[212:213], v[12:13], v[22:23], v[212:213] op_sel:[0,1,0] op_sel_hi:[1,1,1] neg_lo:[0,1,0] neg_hi:[0,1,0]
  v_pk_fma_f32 v[214:215], v[14:15], v[22:23], v[214:215] op_sel:[0,1,0] op_sel_hi:[1,1,1] neg_lo:[0,1,0] neg_hi:[0,1,0]
  v_cvt_pk_bf16_f32 v208, v208, v209
  v_cvt_pk_bf16_f32 v209, v210, v211
  v_cvt_pk_bf16_f32 v210, v212, v213
  v_cvt_pk_bf16_f32 v211, v214, v215
  v_pk_mul_f32 v[216:217], v[216:217], v[22:23] op_sel_hi:[1,0]
  buffer_store_dwordx2 v[242:243], v32, s[16:19], s90 offen offset:3072 sc1
  v_pk_mul_f32 v[218:219], v[218:219], v[22:23] op_sel_hi:[1,0]
  v_pk_mul_f32 v[220:221], v[220:221], v[22:23] op_sel_hi:[1,0]
  v_pk_mul_f32 v[222:223], v[222:223], v[22:23] op_sel_hi:[1,0]
  v_pk_fma_f32 v[216:217], v[40:41], v[22:23], v[216:217] op_sel:[0,1,0] op_sel_hi:[1,1,1] neg_lo:[0,1,0] neg_hi:[0,1,0]
  v_pk_fma_f32 v[218:219], v[42:43], v[22:23], v[218:219] op_sel:[0,1,0] op_sel_hi:[1,1,1] neg_lo:[0,1,0] neg_hi:[0,1,0]
  v_pk_fma_f32 v[220:221], v[44:45], v[22:23], v[220:221] op_sel:[0,1,0] op_sel_hi:[1,1,1] neg_lo:[0,1,0] neg_hi:[0,1,0]
  v_pk_fma_f32 v[222:223], v[46:47], v[22:23], v[222:223] op_sel:[0,1,0] op_sel_hi:[1,1,1] neg_lo:[0,1,0] neg_hi:[0,1,0]
  v_cvt_pk_bf16_f32 v212, v216, v217
  v_cvt_pk_bf16_f32 v213, v218, v219
  v_cvt_pk_bf16_f32 v214, v220, v221
  v_cvt_pk_bf16_f32 v215, v222, v223
  v_pk_mul_f32 v[224:225], v[224:225], v[48:49]
  buffer_store_dwordx2 v[246:247], v32, s[16:19], s90 offen offset:3584 sc1
  v_pk_mul_f32 v[226:227], v[226:227], v[50:51]
  v_pk_mul_f32 v[228:229], v[228:229], v[48:49]
  v_pk_mul_f32 v[230:231], v[230:231], v[50:51]
  v_pk_fma_f32 v[224:225], v[52:53], v[36:37], v[224:225] op_sel:[0,0,0] op_sel_hi:[1,0,1] neg_lo:[0,1,0] neg_hi:[0,1,0]
  v_pk_fma_f32 v[226:227], v[54:55], v[36:37], v[226:227] op_sel:[0,0,0] op_sel_hi:[1,0,1] neg_lo:[0,1,0] neg_hi:[0,1,0]
  v_pk_fma_f32 v[228:229], v[52:53], v[36:37], v[228:229] op_sel:[0,1,0] op_sel_hi:[1,1,1] neg_lo:[0,1,0] neg_hi:[0,1,0]
  v_pk_fma_f32 v[230:231], v[54:55], v[36:37], v[230:231] op_sel:[0,1,0] op_sel_hi:[1,1,1] neg_lo:[0,1,0] neg_hi:[0,1,0]
  v_cvt_pk_bf16_f32 v218, v224, v225
  v_cvt_pk_bf16_f32 v219, v226, v227
  v_cvt_pk_bf16_f32 v222, v228, v229
  v_cvt_pk_bf16_f32 v223, v230, v231
  s_waitcnt lgkmcnt(0)
  s_nop 0
  ds_read_b32 v22, v30 offset:256
  ds_read_b32 v23, v30 offset:1536
  ds_read_b128 v[48:51], v31 offset:256
  ds_read_b128 v[52:55], v31 offset:1536
  v_pk_mul_f32 v[184:185], v[184:185], v[24:25] op_sel_hi:[1,0]
  v_pk_mul_f32 v[186:187], v[186:187], v[24:25] op_sel_hi:[1,0]
  buffer_store_dwordx4 v[212:215], v28, s[16:19], s90 offen offset:0 sc1
  v_pk_mul_f32 v[188:189], v[188:189], v[24:25] op_sel_hi:[1,0]
  v_pk_mul_f32 v[190:191], v[190:191], v[24:25] op_sel_hi:[1,0]
  v_pk_fma_f32 v[184:185], v[8:9], v[24:25], v[184:185] op_sel:[0,1,0] op_sel_hi:[1,1,1] neg_lo:[0,1,0] neg_hi:[0,1,0]
  v_pk_fma_f32 v[186:187], v[10:11], v[24:25], v[186:187] op_sel:[0,1,0] op_sel_hi:[1,1,1] neg_lo:[0,1,0] neg_hi:[0,1,0]
  v_pk_fma_f32 v[188:189], v[12:13], v[24:25], v[188:189] op_sel:[0,1,0] op_sel_hi:[1,1,1] neg_lo:[0,1,0] neg_hi:[0,1,0]
  v_pk_fma_f32 v[190:191], v[14:15], v[24:25], v[190:191] op_sel:[0,1,0] op_sel_hi:[1,1,1] neg_lo:[0,1,0] neg_hi:[0,1,0]
  v_cvt_pk_bf16_f32 v184, v184, v185
  v_cvt_pk_bf16_f32 v185, v186, v187
  v_cvt_pk_bf16_f32 v186, v188, v189
  v_cvt_pk_bf16_f32 v187, v190, v191
  v_pk_mul_f32 v[192:193], v[192:193], v[24:25] op_sel_hi:[1,0]
  buffer_store_dwordx2 v[218:219], v32, s[16:19], s90 offen offset:2048 sc1
  v_pk_mul_f32 v[194:195], v[194:195], v[24:25] op_sel_hi:[1,0]
  v_pk_mul_f32 v[196:197], v[196:197], v[24:25] op_sel_hi:[1,0]
  v_pk_mul_f32 v[198:199], v[198:199], v[24:25] op_sel_hi:[1,0]
  v_pk_fma_f32 v[192:193], v[40:41], v[24:25], v[192:193] op_sel:[0,1,0] op_sel_hi:[1,1,1] neg_lo:[0,1,0] neg_hi:[0,1,0]
  v_pk_fma_f32 v[194:195], v[42:43], v[24:25], v[194:195] op_sel:[0,1,0] op_sel_hi:[1,1,1] neg_lo:[0,1,0] neg_hi:[0,1,0]
  v_pk_fma_f32 v[196:197], v[44:45], v[24:25], v[196:197] op_sel:[0,1,0] op_sel_hi:[1,1,1] neg_lo:[0,1,0] neg_hi:[0,1,0]
  v_pk_fma_f32 v[198:199], v[46:47], v[24:25], v[198:199] op_sel:[0,1,0] op_sel_hi:[1,1,1] neg_lo:[0,1,0] neg_hi:[0,1,0]
  v_cvt_pk_bf16_f32 v188, v192, v193
  v_cvt_pk_bf16_f32 v189, v194, v195
  v_cvt_pk_bf16_f32 v190, v196, v197
  v_cvt_pk_bf16_f32 v191, v198, v199
  v_pk_mul_f32 v[200:201], v[200:201], v[56:57]
  buffer_store_dwordx2 v[222:223], v32, s[16:19], s90 offen offset:2560 sc1
  v_pk_mul_f32 v[202:203], v[202:203], v[58:59]
  v_pk_mul_f32 v[204:205], v[204:205], v[56:57]
  v_pk_mul_f32 v[206:207], v[206:207], v[58:59]
  v_pk_fma_f32 v[200:201], v[60:61], v[36:37], v[200:201] op_sel:[0,0,0] op_sel_hi:[1,0,1] neg_lo:[0,1,0] neg_hi:[0,1,0]
  v_pk_fma_f32 v[202:203], v[62:63], v[36:37], v[202:203] op_sel:[0,0,0] op_sel_hi:[1,0,1] neg_lo:[0,1,0] neg_hi:[0,1,0]
  v_pk_fma_f32 v[204:205], v[60:61], v[36:37], v[204:205] op_sel:[0,1,0] op_sel_hi:[1,1,1] neg_lo:[0,1,0] neg_hi:[0,1,0]
  v_pk_fma_f32 v[206:207], v[62:63], v[36:37], v[206:207] op_sel:[0,1,0] op_sel_hi:[1,1,1] neg_lo:[0,1,0] neg_hi:[0,1,0]
  v_cvt_pk_bf16_f32 v194, v200, v201
  v_cvt_pk_bf16_f32 v240, v200, v201
  v_cvt_pk_bf16_f32 v195, v202, v203
  v_cvt_pk_bf16_f32 v241, v202, v203
  v_cvt_pk_bf16_f32 v198, v204, v205
  v_cvt_pk_bf16_f32 v244, v204, v205
  v_cvt_pk_bf16_f32 v199, v206, v207
  v_cvt_pk_bf16_f32 v245, v206, v207
  s_waitcnt lgkmcnt(0)
  s_nop 0
  ds_read_b32 v24, v30 offset:192
  ds_read_b32 v25, v30 offset:1472
  ds_read_b128 v[56:59], v31 offset:192
  ds_read_b128 v[60:63], v31 offset:1472
  v_pk_mul_f32 v[160:161], v[160:161], v[22:23] op_sel_hi:[1,0]
  v_pk_mul_f32 v[162:163], v[162:163], v[22:23] op_sel_hi:[1,0]
  v_pk_mul_f32 v[164:165], v[164:165], v[22:23] op_sel_hi:[1,0]
  v_pk_mul_f32 v[166:167], v[166:167], v[22:23] op_sel_hi:[1,0]
  v_pk_fma_f32 v[160:161], v[8:9], v[22:23], v[160:161] op_sel:[0,1,0] op_sel_hi:[1,1,1] neg_lo:[0,1,0] neg_hi:[0,1,0]
  v_pk_fma_f32 v[162:163], v[10:11], v[22:23], v[162:163] op_sel:[0,1,0] op_sel_hi:[1,1,1] neg_lo:[0,1,0] neg_hi:[0,1,0]
  v_pk_fma_f32 v[164:165], v[12:13], v[22:23], v[164:165] op_sel:[0,1,0] op_sel_hi:[1,1,1] neg_lo:[0,1,0] neg_hi:[0,1,0]
  v_pk_fma_f32 v[166:167], v[14:15], v[22:23], v[166:167] op_sel:[0,1,0] op_sel_hi:[1,1,1] neg_lo:[0,1,0] neg_hi:[0,1,0]
  v_cvt_pk_bf16_f32 v160, v160, v161
  v_cvt_pk_bf16_f32 v161, v162, v163
  v_cvt_pk_bf16_f32 v162, v164, v165
  v_cvt_pk_bf16_f32 v163, v166, v167
  v_pk_mul_f32 v[168:169], v[168:169], v[22:23] op_sel_hi:[1,0]
  v_pk_mul_f32 v[170:171], v[170:171], v[22:23] op_sel_hi:[1,0]
  v_pk_mul_f32 v[172:173], v[172:173], v[22:23] op_sel_hi:[1,0]
  v_pk_mul_f32 v[174:175], v[174:175], v[22:23] op_sel_hi:[1,0]
  v_pk_fma_f32 v[168:169], v[40:41], v[22:23], v[168:169] op_sel:[0,1,0] op_sel_hi:[1,1,1] neg_lo:[0,1,0] neg_hi:[0,1,0]
  v_pk_fma_f32 v[170:171], v[42:43], v[22:23], v[170:171] op_sel:[0,1,0] op_sel_hi:[1,1,1] neg_lo:[0,1,0] neg_hi:[0,1,0]
  v_pk_fma_f32 v[172:173], v[44:45], v[22:23], v[172:173] op_sel:[0,1,0] op_sel_hi:[1,1,1] neg_lo:[0,1,0] neg_hi:[0,1,0]
  v_pk_fma_f32 v[174:175], v[46:47], v[22:23], v[174:175] op_sel:[0,1,0] op_sel_hi:[1,1,1] neg_lo:[0,1,0] neg_hi:[0,1,0]
  v_cvt_pk_bf16_f32 v164, v168, v169
  v_cvt_pk_bf16_f32 v165, v170, v171
  v_cvt_pk_bf16_f32 v166, v172, v173
  v_cvt_pk_bf16_f32 v167, v174, v175
  v_pk_mul_f32 v[176:177], v[176:177], v[48:49]
  v_pk_mul_f32 v[178:179], v[178:179], v[50:51]
  v_pk_mul_f32 v[180:181], v[180:181], v[48:49]
  v_pk_mul_f32 v[182:183], v[182:183], v[50:51]
  v_pk_fma_f32 v[176:177], v[52:53], v[36:37], v[176:177] op_sel:[0,0,0] op_sel_hi:[1,0,1] neg_lo:[0,1,0] neg_hi:[0,1,0]
  v_pk_fma_f32 v[178:179], v[54:55], v[36:37], v[178:179] op_sel:[0,0,0] op_sel_hi:[1,0,1] neg_lo:[0,1,0] neg_hi:[0,1,0]
  v_pk_fma_f32 v[180:181], v[52:53], v[36:37], v[180:181] op_sel:[0,1,0] op_sel_hi:[1,1,1] neg_lo:[0,1,0] neg_hi:[0,1,0]
  v_pk_fma_f32 v[182:183], v[54:55], v[36:37], v[182:183] op_sel:[0,1,0] op_sel_hi:[1,1,1] neg_lo:[0,1,0] neg_hi:[0,1,0]
  v_cvt_pk_bf16_f32 v170, v176, v177
  v_cvt_pk_bf16_f32 v216, v176, v177
  v_cvt_pk_bf16_f32 v171, v178, v179
  v_cvt_pk_bf16_f32 v217, v178, v179
  v_cvt_pk_bf16_f32 v174, v180, v181
  v_cvt_pk_bf16_f32 v220, v180, v181
  v_cvt_pk_bf16_f32 v175, v182, v183
  v_cvt_pk_bf16_f32 v221, v182, v183
  s_waitcnt lgkmcnt(0)
  s_nop 0
  ds_read_b32 v22, v30 offset:128
  ds_read_b32 v23, v30 offset:1408
  ds_read_b128 v[48:51], v31 offset:128
  ds_read_b128 v[52:55], v31 offset:1408
  v_pk_mul_f32 v[136:137], v[136:137], v[24:25] op_sel_hi:[1,0]
  v_pk_mul_f32 v[138:139], v[138:139], v[24:25] op_sel_hi:[1,0]
  v_pk_mul_f32 v[140:141], v[140:141], v[24:25] op_sel_hi:[1,0]
  v_pk_mul_f32 v[142:143], v[142:143], v[24:25] op_sel_hi:[1,0]
  v_pk_fma_f32 v[136:137], v[8:9], v[24:25], v[136:137] op_sel:[0,1,0] op_sel_hi:[1,1,1] neg_lo:[0,1,0] neg_hi:[0,1,0]
  v_pk_fma_f32 v[138:139], v[10:11], v[24:25], v[138:139] op_sel:[0,1,0] op_sel_hi:[1,1,1] neg_lo:[0,1,0] neg_hi:[0,1,0]
  v_pk_fma_f32 v[140:141], v[12:13], v[24:25], v[140:141] op_sel:[0,1,0] op_sel_hi:[1,1,1] neg_lo:[0,1,0] neg_hi:[0,1,0]
  v_pk_fma_f32 v[142:143], v[14:15], v[24:25], v[142:143] op_sel:[0,1,0] op_sel_hi:[1,1,1] neg_lo:[0,1,0] neg_hi:[0,1,0]
  v_cvt_pk_bf16_f32 v136, v136, v137
  v_cvt_pk_bf16_f32 v137, v138, v139
  v_cvt_pk_bf16_f32 v138, v140, v141
  v_cvt_pk_bf16_f32 v139, v142, v143
  v_pk_mul_f32 v[144:145], v[144:145], v[24:25] op_sel_hi:[1,0]
  v_pk_mul_f32 v[146:147], v[146:147], v[24:25] op_sel_hi:[1,0]
  v_pk_mul_f32 v[148:149], v[148:149], v[24:25] op_sel_hi:[1,0]
  v_pk_mul_f32 v[150:151], v[150:151], v[24:25] op_sel_hi:[1,0]
  v_pk_fma_f32 v[144:145], v[40:41], v[24:25], v[144:145] op_sel:[0,1,0] op_sel_hi:[1,1,1] neg_lo:[0,1,0] neg_hi:[0,1,0]
  v_pk_fma_f32 v[146:147], v[42:43], v[24:25], v[146:147] op_sel:[0,1,0] op_sel_hi:[1,1,1] neg_lo:[0,1,0] neg_hi:[0,1,0]
  v_pk_fma_f32 v[148:149], v[44:45], v[24:25], v[148:149] op_sel:[0,1,0] op_sel_hi:[1,1,1] neg_lo:[0,1,0] neg_hi:[0,1,0]
  v_pk_fma_f32 v[150:151], v[46:47], v[24:25], v[150:151] op_sel:[0,1,0] op_sel_hi:[1,1,1] neg_lo:[0,1,0] neg_hi:[0,1,0]
  v_cvt_pk_bf16_f32 v140, v144, v145
  v_cvt_pk_bf16_f32 v141, v146, v147
  v_cvt_pk_bf16_f32 v142, v148, v149
  v_cvt_pk_bf16_f32 v143, v150, v151
  v_pk_mul_f32 v[152:153], v[152:153], v[56:57]
  v_pk_mul_f32 v[154:155], v[154:155], v[58:59]
  v_pk_mul_f32 v[156:157], v[156:157], v[56:57]
  v_pk_mul_f32 v[158:159], v[158:159], v[58:59]
  v_pk_fma_f32 v[152:153], v[60:61], v[36:37], v[152:153] op_sel:[0,0,0] op_sel_hi:[1,0,1] neg_lo:[0,1,0] neg_hi:[0,1,0]
  v_pk_fma_f32 v[154:155], v[62:63], v[36:37], v[154:155] op_sel:[0,0,0] op_sel_hi:[1,0,1] neg_lo:[0,1,0] neg_hi:[0,1,0]
  v_pk_fma_f32 v[156:157], v[60:61], v[36:37], v[156:157] op_sel:[0,1,0] op_sel_hi:[1,1,1] neg_lo:[0,1,0] neg_hi:[0,1,0]
  v_pk_fma_f32 v[158:159], v[62:63], v[36:37], v[158:159] op_sel:[0,1,0] op_sel_hi:[1,1,1] neg_lo:[0,1,0] neg_hi:[0,1,0]
  v_cvt_pk_bf16_f32 v146, v152, v153
  v_cvt_pk_bf16_f32 v192, v152, v153
  v_cvt_pk_bf16_f32 v147, v154, v155
  v_cvt_pk_bf16_f32 v193, v154, v155
  v_cvt_pk_bf16_f32 v150, v156, v157
  v_cvt_pk_bf16_f32 v196, v156, v157
  v_cvt_pk_bf16_f32 v151, v158, v159
  v_cvt_pk_bf16_f32 v197, v158, v159
  s_waitcnt lgkmcnt(0)
  s_nop 0
  ds_read_b32 v24, v30 offset:64
  ds_read_b32 v25, v30 offset:1344
  ds_read_b128 v[56:59], v31 offset:64
  ds_read_b128 v[60:63], v31 offset:1344
  v_pk_mul_f32 v[112:113], v[112:113], v[22:23] op_sel_hi:[1,0]
  v_pk_mul_f32 v[114:115], v[114:115], v[22:23] op_sel_hi:[1,0]
  v_pk_mul_f32 v[116:117], v[116:117], v[22:23] op_sel_hi:[1,0]
  v_pk_mul_f32 v[118:119], v[118:119], v[22:23] op_sel_hi:[1,0]
  v_pk_fma_f32 v[112:113], v[8:9], v[22:23], v[112:113] op_sel:[0,1,0] op_sel_hi:[1,1,1] neg_lo:[0,1,0] neg_hi:[0,1,0]
  v_pk_fma_f32 v[114:115], v[10:11], v[22:23], v[114:115] op_sel:[0,1,0] op_sel_hi:[1,1,1] neg_lo:[0,1,0] neg_hi:[0,1,0]
  v_pk_fma_f32 v[116:117], v[12:13], v[22:23], v[116:117] op_sel:[0,1,0] op_sel_hi:[1,1,1] neg_lo:[0,1,0] neg_hi:[0,1,0]
  v_pk_fma_f32 v[118:119], v[14:15], v[22:23], v[118:119] op_sel:[0,1,0] op_sel_hi:[1,1,1] neg_lo:[0,1,0] neg_hi:[0,1,0]
  v_cvt_pk_bf16_f32 v112, v112, v113
  v_cvt_pk_bf16_f32 v113, v114, v115
  v_cvt_pk_bf16_f32 v114, v116, v117
  v_cvt_pk_bf16_f32 v115, v118, v119
  v_pk_mul_f32 v[120:121], v[120:121], v[22:23] op_sel_hi:[1,0]
  v_pk_mul_f32 v[122:123], v[122:123], v[22:23] op_sel_hi:[1,0]
  v_pk_mul_f32 v[124:125], v[124:125], v[22:23] op_sel_hi:[1,0]
  v_pk_mul_f32 v[126:127], v[126:127], v[22:23] op_sel_hi:[1,0]
  v_pk_fma_f32 v[120:121], v[40:41], v[22:23], v[120:121] op_sel:[0,1,0] op_sel_hi:[1,1,1] neg_lo:[0,1,0] neg_hi:[0,1,0]
  v_pk_fma_f32 v[122:123], v[42:43], v[22:23], v[122:123] op_sel:[0,1,0] op_sel_hi:[1,1,1] neg_lo:[0,1,0] neg_hi:[0,1,0]
  v_pk_fma_f32 v[124:125], v[44:45], v[22:23], v[124:125] op_sel:[0,1,0] op_sel_hi:[1,1,1] neg_lo:[0,1,0] neg_hi:[0,1,0]
  v_pk_fma_f32 v[126:127], v[46:47], v[22:23], v[126:127] op_sel:[0,1,0] op_sel_hi:[1,1,1] neg_lo:[0,1,0] neg_hi:[0,1,0]
  v_cvt_pk_bf16_f32 v116, v120, v121
  v_cvt_pk_bf16_f32 v117, v122, v123
  v_cvt_pk_bf16_f32 v118, v124, v125
  v_cvt_pk_bf16_f32 v119, v126, v127
  v_pk_mul_f32 v[128:129], v[128:129], v[48:49]
  v_pk_mul_f32 v[130:131], v[130:131], v[50:51]
  v_pk_mul_f32 v[132:133], v[132:133], v[48:49]
  v_pk_mul_f32 v[134:135], v[134:135], v[50:51]
  v_pk_fma_f32 v[128:129], v[52:53], v[36:37], v[128:129] op_sel:[0,0,0] op_sel_hi:[1,0,1] neg_lo:[0,1,0] neg_hi:[0,1,0]
  v_pk_fma_f32 v[130:131], v[54:55], v[36:37], v[130:131] op_sel:[0,0,0] op_sel_hi:[1,0,1] neg_lo:[0,1,0] neg_hi:[0,1,0]
  v_pk_fma_f32 v[132:133], v[52:53], v[36:37], v[132:133] op_sel:[0,1,0] op_sel_hi:[1,1,1] neg_lo:[0,1,0] neg_hi:[0,1,0]
  v_pk_fma_f32 v[134:135], v[54:55], v[36:37], v[134:135] op_sel:[0,1,0] op_sel_hi:[1,1,1] neg_lo:[0,1,0] neg_hi:[0,1,0]
  v_cvt_pk_bf16_f32 v122, v128, v129
  v_cvt_pk_bf16_f32 v168, v128, v129
  v_cvt_pk_bf16_f32 v123, v130, v131
  v_cvt_pk_bf16_f32 v169, v130, v131
  v_cvt_pk_bf16_f32 v126, v132, v133
  v_cvt_pk_bf16_f32 v172, v132, v133
  v_cvt_pk_bf16_f32 v127, v134, v135
  v_cvt_pk_bf16_f32 v173, v134, v135
  s_waitcnt lgkmcnt(0)
  s_nop 0
  ds_read_b32 v22, v30 offset:0
  ds_read_b32 v23, v30 offset:1280
  ds_read_b128 v[48:51], v31 offset:0
  ds_read_b128 v[52:55], v31 offset:1280
  v_pk_mul_f32 v[88:89], v[88:89], v[24:25] op_sel_hi:[1,0]
  v_pk_mul_f32 v[90:91], v[90:91], v[24:25] op_sel_hi:[1,0]
  v_pk_mul_f32 v[92:93], v[92:93], v[24:25] op_sel_hi:[1,0]
  v_pk_mul_f32 v[94:95], v[94:95], v[24:25] op_sel_hi:[1,0]
  v_pk_fma_f32 v[88:89], v[8:9], v[24:25], v[88:89] op_sel:[0,1,0] op_sel_hi:[1,1,1] neg_lo:[0,1,0] neg_hi:[0,1,0]
  v_pk_fma_f32 v[90:91], v[10:11], v[24:25], v[90:91] op_sel:[0,1,0] op_sel_hi:[1,1,1] neg_lo:[0,1,0] neg_hi:[0,1,0]
  v_pk_fma_f32 v[92:93], v[12:13], v[24:25], v[92:93] op_sel:[0,1,0] op_sel_hi:[1,1,1] neg_lo:[0,1,0] neg_hi:[0,1,0]
  v_pk_fma_f32 v[94:95], v[14:15], v[24:25], v[94:95] op_sel:[0,1,0] op_sel_hi:[1,1,1] neg_lo:[0,1,0] neg_hi:[0,1,0]
  v_cvt_pk_bf16_f32 v88, v88, v89
  v_cvt_pk_bf16_f32 v89, v90, v91
  v_cvt_pk_bf16_f32 v90, v92, v93
  v_cvt_pk_bf16_f32 v91, v94, v95
  v_pk_mul_f32 v[96:97], v[96:97], v[24:25] op_sel_hi:[1,0]
  v_pk_mul_f32 v[98:99], v[98:99], v[24:25] op_sel_hi:[1,0]
  v_pk_mul_f32 v[100:101], v[100:101], v[24:25] op_sel_hi:[1,0]
  v_pk_mul_f32 v[102:103], v[102:103], v[24:25] op_sel_hi:[1,0]
  v_pk_fma_f32 v[96:97], v[40:41], v[24:25], v[96:97] op_sel:[0,1,0] op_sel_hi:[1,1,1] neg_lo:[0,1,0] neg_hi:[0,1,0]
  v_pk_fma_f32 v[98:99], v[42:43], v[24:25], v[98:99] op_sel:[0,1,0] op_sel_hi:[1,1,1] neg_lo:[0,1,0] neg_hi:[0,1,0]
  v_pk_fma_f32 v[100:101], v[44:45], v[24:25], v[100:101] op_sel:[0,1,0] op_sel_hi:[1,1,1] neg_lo:[0,1,0] neg_hi:[0,1,0]
  v_pk_fma_f32 v[102:103], v[46:47], v[24:25], v[102:103] op_sel:[0,1,0] op_sel_hi:[1,1,1] neg_lo:[0,1,0] neg_hi:[0,1,0]
  v_cvt_pk_bf16_f32 v92, v96, v97
  v_cvt_pk_bf16_f32 v93, v98, v99
  v_cvt_pk_bf16_f32 v94, v100, v101
  v_cvt_pk_bf16_f32 v95, v102, v103
  v_pk_mul_f32 v[104:105], v[104:105], v[56:57]
  v_pk_mul_f32 v[106:107], v[106:107], v[58:59]
  v_pk_mul_f32 v[108:109], v[108:109], v[56:57]
  v_pk_mul_f32 v[110:111], v[110:111], v[58:59]
  v_pk_fma_f32 v[104:105], v[60:61], v[36:37], v[104:105] op_sel:[0,0,0] op_sel_hi:[1,0,1] neg_lo:[0,1,0] neg_hi:[0,1,0]
  v_pk_fma_f32 v[106:107], v[62:63], v[36:37], v[106:107] op_sel:[0,0,0] op_sel_hi:[1,0,1] neg_lo:[0,1,0] neg_hi:[0,1,0]
  v_pk_fma_f32 v[108:109], v[60:61], v[36:37], v[108:109] op_sel:[0,1,0] op_sel_hi:[1,1,1] neg_lo:[0,1,0] neg_hi:[0,1,0]
  v_pk_fma_f32 v[110:111], v[62:63], v[36:37], v[110:111] op_sel:[0,1,0] op_sel_hi:[1,1,1] neg_lo:[0,1,0] neg_hi:[0,1,0]
  v_cvt_pk_bf16_f32 v98, v104, v105
  v_cvt_pk_bf16_f32 v144, v104, v105
  v_cvt_pk_bf16_f32 v99, v106, v107
  v_cvt_pk_bf16_f32 v145, v106, v107
  v_cvt_pk_bf16_f32 v102, v108, v109
  v_cvt_pk_bf16_f32 v148, v108, v109
  v_cvt_pk_bf16_f32 v103, v110, v111
  v_cvt_pk_bf16_f32 v149, v110, v111
  s_waitcnt lgkmcnt(0)
  s_nop 0
  v_pk_mul_f32 v[64:65], v[64:65], v[22:23] op_sel_hi:[1,0]
  v_pk_mul_f32 v[66:67], v[66:67], v[22:23] op_sel_hi:[1,0]
  v_pk_mul_f32 v[68:69], v[68:69], v[22:23] op_sel_hi:[1,0]
  v_pk_mul_f32 v[70:71], v[70:71], v[22:23] op_sel_hi:[1,0]
  v_pk_fma_f32 v[64:65], v[8:9], v[22:23], v[64:65] op_sel:[0,1,0] op_sel_hi:[1,1,1] neg_lo:[0,1,0] neg_hi:[0,1,0]
  v_pk_fma_f32 v[66:67], v[10:11], v[22:23], v[66:67] op_sel:[0,1,0] op_sel_hi:[1,1,1] neg_lo:[0,1,0] neg_hi:[0,1,0]
  v_pk_fma_f32 v[68:69], v[12:13], v[22:23], v[68:69] op_sel:[0,1,0] op_sel_hi:[1,1,1] neg_lo:[0,1,0] neg_hi:[0,1,0]
  v_pk_fma_f32 v[70:71], v[14:15], v[22:23], v[70:71] op_sel:[0,1,0] op_sel_hi:[1,1,1] neg_lo:[0,1,0] neg_hi:[0,1,0]
  v_cvt_pk_bf16_f32 v64, v64, v65
  v_cvt_pk_bf16_f32 v65, v66, v67
  v_cvt_pk_bf16_f32 v66, v68, v69
  v_cvt_pk_bf16_f32 v67, v70, v71
  v_pk_mul_f32 v[72:73], v[72:73], v[22:23] op_sel_hi:[1,0]
  v_pk_mul_f32 v[74:75], v[74:75], v[22:23] op_sel_hi:[1,0]
  v_pk_mul_f32 v[76:77], v[76:77], v[22:23] op_sel_hi:[1,0]
  v_pk_mul_f32 v[78:79], v[78:79], v[22:23] op_sel_hi:[1,0]
  v_pk_fma_f32 v[72:73], v[40:41], v[22:23], v[72:73] op_sel:[0,1,0] op_sel_hi:[1,1,1] neg_lo:[0,1,0] neg_hi:[0,1,0]
  v_pk_fma_f32 v[74:75], v[42:43], v[22:23], v[74:75] op_sel:[0,1,0] op_sel_hi:[1,1,1] neg_lo:[0,1,0] neg_hi:[0,1,0]
  v_pk_fma_f32 v[76:77], v[44:45], v[22:23], v[76:77] op_sel:[0,1,0] op_sel_hi:[1,1,1] neg_lo:[0,1,0] neg_hi:[0,1,0]
  v_pk_fma_f32 v[78:79], v[46:47], v[22:23], v[78:79] op_sel:[0,1,0] op_sel_hi:[1,1,1] neg_lo:[0,1,0] neg_hi:[0,1,0]
  v_cvt_pk_bf16_f32 v68, v72, v73
  v_cvt_pk_bf16_f32 v69, v74, v75
  v_cvt_pk_bf16_f32 v70, v76, v77
  v_cvt_pk_bf16_f32 v71, v78, v79
  v_pk_mul_f32 v[80:81], v[80:81], v[48:49]
  v_pk_mul_f32 v[82:83], v[82:83], v[50:51]
  v_pk_mul_f32 v[84:85], v[84:85], v[48:49]
  v_pk_mul_f32 v[86:87], v[86:87], v[50:51]
  v_pk_fma_f32 v[80:81], v[52:53], v[36:37], v[80:81] op_sel:[0,0,0] op_sel_hi:[1,0,1] neg_lo:[0,1,0] neg_hi:[0,1,0]
  v_pk_fma_f32 v[82:83], v[54:55], v[36:37], v[82:83] op_sel:[0,0,0] op_sel_hi:[1,0,1] neg_lo:[0,1,0] neg_hi:[0,1,0]
  v_pk_fma_f32 v[84:85], v[52:53], v[36:37], v[84:85] op_sel:[0,1,0] op_sel_hi:[1,1,1] neg_lo:[0,1,0] neg_hi:[0,1,0]
  v_pk_fma_f32 v[86:87], v[54:55], v[36:37], v[86:87] op_sel:[0,1,0] op_sel_hi:[1,1,1] neg_lo:[0,1,0] neg_hi:[0,1,0]
  v_cvt_pk_bf16_f32 v74, v80, v81
  v_cvt_pk_bf16_f32 v120, v80, v81
  v_cvt_pk_bf16_f32 v75, v82, v83
  v_cvt_pk_bf16_f32 v121, v82, v83
  v_cvt_pk_bf16_f32 v78, v84, v85
  v_cvt_pk_bf16_f32 v124, v84, v85
  v_cvt_pk_bf16_f32 v79, v86, v87
  v_cvt_pk_bf16_f32 v125, v86, v87
  v_accvgpr_read_b32 v8, a160
  v_accvgpr_read_b32 v9, a161
  v_accvgpr_read_b32 v10, a162
  v_accvgpr_read_b32 v11, a163
  v_accvgpr_read_b32 v12, a164
  v_accvgpr_read_b32 v13, a165
  v_accvgpr_read_b32 v14, a166
  v_accvgpr_read_b32 v15, a167
  s_nop 1
  s_nop 0
  v_mfma_f32_16x16x32_bf16 v[224:227], v[164:167], v[208:211], v[12:15]
  v_mfma_f32_16x16x32_bf16 v[228:231], v[212:215], v[208:211], v[8:11]
  v_mfma_f32_16x16x32_bf16 v[248:251], v[188:191], v[232:235], v[12:15]
  v_mfma_f32_16x16x32_bf16 v[252:255], v[236:239], v[232:235], v[8:11]
  v_accvgpr_read_b32 v40, a168
  v_accvgpr_read_b32 v41, a169
  v_accvgpr_read_b32 v42, a170
  v_accvgpr_read_b32 v43, a171
  v_cvt_pk_bf16_f32 v44, v8, v9
  v_cvt_pk_bf16_f32 v45, v10, v11
  v_pk_ashrrev_i16 v44, 15, v44 op_sel_hi:[0,1]
  v_pk_ashrrev_i16 v45, 15, v45 op_sel_hi:[0,1]
  v_max_f32 v224, v224, v228
  v_max_f32 v248, v248, v252
  v_max_f32 v225, v225, v229
  v_max_f32 v249, v249, v253
  v_max_f32 v226, v226, v230
  v_max_f32 v250, v250, v254
  v_max_f32 v227, v227, v231
  v_max_f32 v251, v251, v255
  v_max3_f32 v22, v224, v225, v226
  v_max3_f32 v24, v248, v249, v250
  v_max_f32 v22, v22, v227
  v_max_f32 v24, v24, v251
  v_mfma_f32_16x16x32_bf16 v[176:179], v[116:119], v[160:163], v[12:15]
  v_mfma_f32_16x16x32_bf16 v[180:183], v[164:167], v[160:163], v[8:11]
  v_permlane16_swap_b32 v22, v24
  v_max_f32 v22, v22, v24
  v_mov_b32 v24, v22
  v_mfma_f32_16x16x32_bf16 v[200:203], v[140:143], v[184:187], v[12:15]
  v_mfma_f32_16x16x32_bf16 v[204:207], v[188:191], v[184:187], v[8:11]
  v_permlane32_swap_b32 v22, v24
  v_max_f32 v22, v22, v24
  v_mul_f32 v22, s86, v22
  v_mov_b32 v24, v22
  s_nop 1
  v_permlane16_swap_b32 v22, v24
  s_nop 0
  v_pk_fma_f32 v[224:225], v[224:225], s[86:87], v[22:23] op_sel_hi:[1,1,0] neg_lo:[0,0,1] neg_hi:[0,0,1]
  v_pk_fma_f32 v[248:249], v[248:249], s[86:87], v[24:25] op_sel_hi:[1,1,0] neg_lo:[0,0,1] neg_hi:[0,0,1]
  v_pk_fma_f32 v[226:227], v[226:227], s[86:87], v[22:23] op_sel_hi:[1,1,0] neg_lo:[0,0,1] neg_hi:[0,0,1]
  v_pk_fma_f32 v[250:251], v[250:251], s[86:87], v[24:25] op_sel_hi:[1,1,0] neg_lo:[0,0,1] neg_hi:[0,0,1]
  v_exp_f32 v224, v224
  v_exp_f32 v248, v248
  v_exp_f32 v225, v225
  v_exp_f32 v249, v249
  v_exp_f32 v226, v226
  v_exp_f32 v250, v250
  v_exp_f32 v227, v227
  v_exp_f32 v251, v251
  v_cvt_pk_bf16_f32 v228, v224, v225
  v_cvt_pk_bf16_f32 v252, v248, v249
  v_cvt_pk_bf16_f32 v229, v226, v227
  v_cvt_pk_bf16_f32 v253, v250, v251
  v_and_b32 v208, v44, v228
  v_and_b32 v232, v44, v252
  v_and_b32 v209, v45, v229
  v_and_b32 v233, v45, v253
  v_bfi_b32 v210, v44, 0, v228
  v_bfi_b32 v234, v44, 0, v252
  v_bfi_b32 v211, v45, 0, v229
  v_bfi_b32 v235, v45, 0, v253
  v_max_f32 v176, v176, v180
  v_max_f32 v200, v200, v204
  v_max_f32 v177, v177, v181
  v_max_f32 v201, v201, v205
  v_max_f32 v178, v178, v182
  v_max_f32 v202, v202, v206
  v_max_f32 v179, v179, v183
  v_max_f32 v203, v203, v207
  v_max3_f32 v22, v176, v177, v178
  v_max3_f32 v24, v200, v201, v202
  v_max_f32 v22, v22, v179
  v_max_f32 v24, v24, v203
  v_mfma_f32_16x16x32_bf16 v[224:227], v[216:219], v[208:211], 0
  v_mfma_f32_16x16x32_bf16 v[228:231], v[220:223], v[208:211], 0
  v_permlane16_swap_b32 v22, v24
  v_max_f32 v22, v22, v24
  v_mov_b32 v24, v22
  v_mfma_f32_16x16x32_bf16 v[216:219], a[136:139], v[208:211], 0
  v_mfma_f32_16x16x32_bf16 v[248:251], v[240:243], v[232:235], 0
  v_permlane32_swap_b32 v22, v24
  v_max_f32 v22, v22, v24
  v_mul_f32 v22, s86, v22
  v_mov_b32 v24, v22
  v_mfma_f32_16x16x32_bf16 v[252:255], v[244:247], v[232:235], 0
  v_mfma_f32_16x16x32_bf16 v[240:243], a[136:139], v[232:235], 0
  v_permlane16_swap_b32 v22, v24
  v_pk_fma_f32 v[176:177], v[176:177], s[86:87], v[22:23] op_sel_hi:[1,1,0] neg_lo:[0,0,1] neg_hi:[0,0,1]
  v_pk_fma_f32 v[200:201], v[200:201], s[86:87], v[24:25] op_sel_hi:[1,1,0] neg_lo:[0,0,1] neg_hi:[0,0,1]
  v_pk_fma_f32 v[178:179], v[178:179], s[86:87], v[22:23] op_sel_hi:[1,1,0] neg_lo:[0,0,1] neg_hi:[0,0,1]
  v_pk_fma_f32 v[202:203], v[202:203], s[86:87], v[24:25] op_sel_hi:[1,1,0] neg_lo:[0,0,1] neg_hi:[0,0,1]
  v_exp_f32 v176, v176
  v_mfma_f32_16x16x32_bf16 v[128:131], v[68:71], v[112:115], v[12:15]
  v_exp_f32 v200, v200
  v_exp_f32 v177, v177
  v_mfma_f32_16x16x32_bf16 v[132:135], v[116:119], v[112:115], v[8:11]
  v_exp_f32 v201, v201
  v_exp_f32 v178, v178
  v_mfma_f32_16x16x32_bf16 v[152:155], v[92:95], v[136:139], v[12:15]
  v_exp_f32 v202, v202
  v_exp_f32 v179, v179
  v_mfma_f32_16x16x32_bf16 v[156:159], v[140:143], v[136:139], v[8:11]
  v_exp_f32 v203, v203
  v_cvt_pk_bf16_f32 v180, v176, v177
  v_cvt_pk_bf16_f32 v204, v200, v201
  v_cvt_pk_bf16_f32 v181, v178, v179
  v_cvt_pk_bf16_f32 v205, v202, v203
  v_and_b32 v160, v44, v180
  v_and_b32 v184, v44, v204
  v_and_b32 v161, v45, v181
  v_and_b32 v185, v45, v205
  v_bfi_b32 v162, v44, 0, v180
  v_bfi_b32 v186, v44, 0, v204
  v_bfi_b32 v163, v45, 0, v181
  v_bfi_b32 v187, v45, 0, v205
  v_rcp_f32 v216, v216
  v_rcp_f32 v240, v240
  v_pk_mul_f32 v[224:225], v[224:225], v[216:217] op_sel_hi:[1,0]
  v_pk_mul_f32 v[248:249], v[248:249], v[240:241] op_sel_hi:[1,0]
  v_pk_mul_f32 v[226:227], v[226:227], v[216:217] op_sel_hi:[1,0]
  v_pk_mul_f32 v[250:251], v[250:251], v[240:241] op_sel_hi:[1,0]
  v_pk_mul_f32 v[228:229], v[228:229], v[216:217] op_sel_hi:[1,0]
  v_pk_mul_f32 v[252:253], v[252:253], v[240:241] op_sel_hi:[1,0]
  v_pk_mul_f32 v[230:231], v[230:231], v[216:217] op_sel_hi:[1,0]
  v_pk_mul_f32 v[254:255], v[254:255], v[240:241] op_sel_hi:[1,0]
  v_cvt_pk_bf16_f32 v208, v224, v225
  v_cvt_pk_bf16_f32 v232, v248, v249
  v_cvt_pk_bf16_f32 v209, v226, v227
  v_cvt_pk_bf16_f32 v233, v250, v251
  v_cvt_pk_bf16_f32 v210, v228, v229
  v_cvt_pk_bf16_f32 v234, v252, v253
  v_cvt_pk_bf16_f32 v211, v230, v231
  v_cvt_pk_bf16_f32 v235, v254, v255
  v_max_f32 v128, v128, v132
  v_max_f32 v152, v152, v156
  v_max_f32 v129, v129, v133
  v_max_f32 v153, v153, v157
  v_max_f32 v130, v130, v134
  v_max_f32 v154, v154, v158
  v_max_f32 v131, v131, v135
  v_max_f32 v155, v155, v159
  v_max3_f32 v22, v128, v129, v130
  buffer_load_dword v33, v20, s[16:19], s94 offen sc1
  v_max3_f32 v24, v152, v153, v154
  v_max_f32 v22, v22, v131
  v_max_f32 v24, v24, v155
  v_mfma_f32_16x16x32_bf16 v[176:179], v[168:171], v[160:163], 0
  v_mfma_f32_16x16x32_bf16 v[180:183], v[172:175], v[160:163], 0
  v_permlane16_swap_b32 v22, v24
  v_max_f32 v22, v22, v24
  v_mov_b32 v24, v22
  v_mfma_f32_16x16x32_bf16 v[168:171], a[136:139], v[160:163], 0
  v_mfma_f32_16x16x32_bf16 v[200:203], v[192:195], v[184:187], 0
  v_permlane32_swap_b32 v22, v24
  v_max_f32 v22, v22, v24
  v_mul_f32 v22, s86, v22
  buffer_load_dwordx4 v[48:51], v28, s[16:19], s91 offen offset:0 sc1
  v_mov_b32 v24, v22
  v_mfma_f32_16x16x32_bf16 v[204:207], v[196:199], v[184:187], 0
  v_mfma_f32_16x16x32_bf16 v[192:195], a[136:139], v[184:187], 0
  v_permlane16_swap_b32 v22, v24
  v_pk_fma_f32 v[128:129], v[128:129], s[86:87], v[22:23] op_sel_hi:[1,1,0] neg_lo:[0,0,1] neg_hi:[0,0,1]
  v_pk_fma_f32 v[152:153], v[152:153], s[86:87], v[24:25] op_sel_hi:[1,1,0] neg_lo:[0,0,1] neg_hi:[0,0,1]
  v_pk_fma_f32 v[130:131], v[130:131], s[86:87], v[22:23] op_sel_hi:[1,1,0] neg_lo:[0,0,1] neg_hi:[0,0,1]
  ds_read_b32 v212, v30 offset:4608
  ds_read_b32 v213, v30 offset:5888
  v_pk_fma_f32 v[154:155], v[154:155], s[86:87], v[24:25] op_sel_hi:[1,1,0] neg_lo:[0,0,1] neg_hi:[0,0,1]
  v_exp_f32 v128, v128
  ds_read_b32 v214, v30 offset:4672
  ds_read_b32 v215, v30 offset:5952
  v_exp_f32 v152, v152
  v_exp_f32_e64 v129, v129
  ds_read_b32 v216, v30 offset:4736
  ds_read_b32 v217, v30 offset:6016
  buffer_load_dwordx4 v[52:55], v28, s[16:19], s91 offen offset:1024 sc1
  v_exp_f32 v153, v153
  v_exp_f32 v130, v130
  v_exp_f32 v154, v154
  ds_read_b32 v218, v30 offset:4800
  ds_read_b32 v219, v30 offset:6080
  v_exp_f32 v131, v131
  v_exp_f32_e64 v155, v155
  ds_read_b32 v220, v30 offset:4864
  ds_read_b32 v221, v30 offset:6144
  v_cvt_pk_bf16_f32 v132, v128, v129
  v_cvt_pk_bf16_f32 v156, v152, v153
  v_cvt_pk_bf16_f32 v133, v130, v131
  ds_read_b32 v222, v30 offset:4928
  ds_read_b32 v223, v30 offset:6208
  v_cvt_pk_bf16_f32 v157, v154, v155
  buffer_load_dwordx2 v[72:73], v32, s[16:19], s91 offen offset:2048 sc1
  v_and_b32 v112, v44, v132
  ds_read_b32 v224, v30 offset:4992
  ds_read_b32 v225, v30 offset:6272
  v_and_b32 v136, v44, v156
  v_and_b32 v113, v45, v133
  v_and_b32 v137, v45, v157
  ds_read_b32 v226, v30 offset:5056
  ds_read_b32 v227, v30 offset:6336
  v_bfi_b32 v114, v44, 0, v132
  v_bfi_b32 v138, v44, 0, v156
  ds_read_b128 v[228:231], v21
  ds_read_b128 v[248:251], v21 offset:1024
  v_bfi_b32 v115, v45, 0, v133
  v_bfi_b32 v139, v45, 0, v157
  v_rcp_f32 v168, v168
  buffer_load_dwordx2 v[76:77], v32, s[16:19], s91 offen offset:2560 sc1
  v_rcp_f32 v192, v192
  v_pk_mul_f32 v[176:177], v[176:177], v[168:169] op_sel_hi:[1,0]
  v_pk_mul_f32 v[200:201], v[200:201], v[192:193] op_sel_hi:[1,0]
  v_pk_mul_f32 v[178:179], v[178:179], v[168:169] op_sel_hi:[1,0]
  v_pk_mul_f32 v[202:203], v[202:203], v[192:193] op_sel_hi:[1,0]
  v_pk_mul_f32 v[180:181], v[180:181], v[168:169] op_sel_hi:[1,0]
  v_pk_mul_f32 v[204:205], v[204:205], v[192:193] op_sel_hi:[1,0]
  v_pk_mul_f32 v[182:183], v[182:183], v[168:169] op_sel_hi:[1,0]
  v_pk_mul_f32 v[206:207], v[206:207], v[192:193] op_sel_hi:[1,0]
  buffer_load_dwordx2 v[96:97], v32, s[16:19], s91 offen offset:3072 sc1
  v_cvt_pk_bf16_f32 v160, v176, v177
  v_cvt_pk_bf16_f32 v184, v200, v201
  v_cvt_pk_bf16_f32 v161, v178, v179
  v_cvt_pk_bf16_f32 v185, v202, v203
  v_cvt_pk_bf16_f32 v162, v180, v181
  v_cvt_pk_bf16_f32 v186, v204, v205
  v_cvt_pk_bf16_f32 v163, v182, v183
  v_cvt_pk_bf16_f32 v187, v206, v207
  v_bfe_u32 v252, v2, 2, 3
  buffer_load_dwordx2 v[100:101], v32, s[16:19], s91 offen offset:3584 sc1
  v_and_b32 v253, 3, v2
  v_lshlrev_b32 v254, 11, v5
  v_lshl_add_u32 v254, v252, 7, v254
  v_lshl_add_u32 v254, v253, 3, v254
  v_lshrrev_b32 v252, 1, v252
  v_lshl_add_u32 v236, v252, 5, v254
  v_add_u32 v240, 0x10000, v236
  v_xor_b32 v241, 32, v240
  v_xor_b32 v242, 64, v240
  v_xor_b32 v243, 96, v240
  s_waitcnt lgkmcnt(0)
La_pad8:
  s_cbranch_execz La_pad12
  s_nop 0
  v_accvgpr_read_b32 v164, a176
  v_accvgpr_read_b32 v165, a177
  v_accvgpr_read_b32 v166, a178
  s_mov_b32 s29, 887808
  buffer_store_dwordx4 v[208:211], v18, s[12:15], s29 offen sc1
  v_accvgpr_read_b32 v167, a179
  v_accvgpr_read_b32 v168, a180
  v_accvgpr_read_b32 v169, a181
  v_accvgpr_read_b32 v170, a182
  v_accvgpr_read_b32 v171, a183
  v_pk_fma_f32 v[22:23], v[228:229], v[212:213], v[248:249] op_sel:[0,1,0] op_sel_hi:[1,1,1] neg_lo:[0,1,0] neg_hi:[0,1,0]
  v_pk_fma_f32 v[24:25], v[230:231], v[212:213], v[250:251] op_sel:[0,1,0] op_sel_hi:[1,1,1] neg_lo:[0,1,0] neg_hi:[0,1,0]
  v_mfma_f32_16x16x32_bf16 v[128:131], v[120:123], v[112:115], 0
  v_pk_fma_f32 v[26:27], v[228:229], v[214:215], v[248:249] op_sel:[0,1,0] op_sel_hi:[1,1,1] neg_lo:[0,1,0] neg_hi:[0,1,0]
  v_pk_fma_f32 v[38:39], v[230:231], v[214:215], v[250:251] op_sel:[0,1,0] op_sel_hi:[1,1,1] neg_lo:[0,1,0] neg_hi:[0,1,0]
  v_pk_fma_f32 v[164:165], v[164:165], v[212:213], v[22:23] op_sel_hi:[1,0,1]
  v_mfma_f32_16x16x32_bf16 v[132:135], v[124:127], v[112:115], 0
  v_pk_fma_f32 v[166:167], v[166:167], v[212:213], v[24:25] op_sel_hi:[1,0,1]
  v_pk_fma_f32 v[168:169], v[168:169], v[214:215], v[26:27] op_sel_hi:[1,0,1]
  v_pk_fma_f32 v[170:171], v[170:171], v[214:215], v[38:39] op_sel_hi:[1,0,1]
  v_mfma_f32_16x16x32_bf16 v[120:123], a[136:139], v[112:115], 0
  v_pk_fma_f32 v[22:23], v[164:165], v[164:165], s[64:65] op_sel_hi:[1,1,0]
  s_mov_b32 s29, 1035776
  buffer_store_dwordx4 v[232:235], v18, s[12:15], s29 offen sc1
  v_pk_fma_f32 v[24:25], v[166:167], v[166:167], s[64:65] op_sel_hi:[1,1,0]
  v_pk_fma_f32 v[26:27], v[168:169], v[168:169], s[64:65] op_sel_hi:[1,1,0]
  v_mfma_f32_16x16x32_bf16 v[152:155], v[144:147], v[136:139], 0
  v_pk_fma_f32 v[38:39], v[170:171], v[170:171], s[64:65] op_sel_hi:[1,1,0]
  v_pk_mul_f32 v[22:23], v[22:23], v[164:165] neg_lo:[0,1] neg_hi:[0,1]
  v_pk_mul_f32 v[24:25], v[24:25], v[166:167] neg_lo:[0,1] neg_hi:[0,1]
  v_mfma_f32_16x16x32_bf16 v[156:159], v[148:151], v[136:139], 0
  v_pk_mul_f32 v[26:27], v[26:27], v[168:169] neg_lo:[0,1] neg_hi:[0,1]
  v_pk_mul_f32 v[38:39], v[38:39], v[170:171] neg_lo:[0,1] neg_hi:[0,1]
  v_exp_f32 v22, v22
  v_mfma_f32_16x16x32_bf16 v[144:147], a[136:139], v[136:139], 0
  v_exp_f32 v23, v23
  v_exp_f32 v24, v24
  v_exp_f32 v25, v25
  v_exp_f32 v26, v26
  v_exp_f32 v27, v27
  v_exp_f32 v38, v38
  v_exp_f32 v39, v39
  s_mov_b32 s29, 591872
  buffer_store_dwordx4 v[160:163], v18, s[12:15], s29 offen sc1
  v_pk_fma_f32 v[22:23], v[22:23], s[64:65], s[64:65] op_sel:[0,1,1] op_sel_hi:[1,1,1]
  v_pk_fma_f32 v[24:25], v[24:25], s[64:65], s[64:65] op_sel:[0,1,1] op_sel_hi:[1,1,1]
  v_pk_fma_f32 v[26:27], v[26:27], s[64:65], s[64:65] op_sel:[0,1,1] op_sel_hi:[1,1,1]
  v_pk_fma_f32 v[38:39], v[38:39], s[64:65], s[64:65] op_sel:[0,1,1] op_sel_hi:[1,1,1]
  v_rcp_f32 v22, v22
  v_rcp_f32 v23, v23
  v_rcp_f32 v24, v24
  v_rcp_f32 v25, v25
  v_rcp_f32 v26, v26
  v_rcp_f32 v27, v27
  v_rcp_f32 v38, v38
  v_rcp_f32 v39, v39
  v_pk_mul_f32 v[22:23], v[22:23], v[164:165]
  v_pk_mul_f32 v[24:25], v[24:25], v[166:167]
  v_pk_mul_f32 v[26:27], v[26:27], v[168:169]
  v_pk_mul_f32 v[38:39], v[38:39], v[170:171]
  v_cvt_pk_bf16_f32 v164, v22, v23
  v_cvt_pk_bf16_f32 v165, v24, v25
  v_cvt_pk_bf16_f32 v166, v26, v27
  v_cvt_pk_bf16_f32 v167, v38, v39
  s_nop 0
  v_permlane32_swap_b32 v164, v166
  v_permlane32_swap_b32 v165, v167
  s_mov_b32 s29, 0
  buffer_store_dwordx4 v[164:167], v17, s[12:15], s29 offen sc1
  v_rcp_f32 v120, v120
  v_rcp_f32 v144, v144
  v_pk_mul_f32 v[128:129], v[128:129], v[120:121] op_sel_hi:[1,0]
  v_pk_mul_f32 v[152:153], v[152:153], v[144:145] op_sel_hi:[1,0]
  v_pk_mul_f32 v[130:131], v[130:131], v[120:121] op_sel_hi:[1,0]
  v_pk_mul_f32 v[154:155], v[154:155], v[144:145] op_sel_hi:[1,0]
  v_pk_mul_f32 v[132:133], v[132:133], v[120:121] op_sel_hi:[1,0]
  v_pk_mul_f32 v[156:157], v[156:157], v[144:145] op_sel_hi:[1,0]
  v_pk_mul_f32 v[134:135], v[134:135], v[120:121] op_sel_hi:[1,0]
  v_pk_mul_f32 v[158:159], v[158:159], v[144:145] op_sel_hi:[1,0]
  v_cvt_pk_bf16_f32 v112, v128, v129
  v_cvt_pk_bf16_f32 v136, v152, v153
  v_cvt_pk_bf16_f32 v113, v130, v131
  v_cvt_pk_bf16_f32 v137, v154, v155
  v_cvt_pk_bf16_f32 v114, v132, v133
  v_cvt_pk_bf16_f32 v138, v156, v157
  v_cvt_pk_bf16_f32 v115, v134, v135
  v_cvt_pk_bf16_f32 v139, v158, v159
  v_accvgpr_read_b32 v172, a184
  s_waitcnt vmcnt(10)
  v_cmp_eq_u32 vcc, 0, v33
  s_cbranch_vccnz La_f1_slow
  s_nop 0
La_f1_back:
  v_accvgpr_read_b32 v173, a185
  v_accvgpr_read_b32 v174, a186
  v_accvgpr_read_b32 v175, a187
  v_accvgpr_read_b32 v176, a188
  v_accvgpr_read_b32 v177, a189
  v_accvgpr_read_b32 v178, a190
  v_accvgpr_read_b32 v179, a191
  v_pk_fma_f32 v[22:23], v[228:229], v[216:217], v[248:249] op_sel:[0,1,0] op_sel_hi:[1,1,1] neg_lo:[0,1,0] neg_hi:[0,1,0]
  v_pk_fma_f32 v[24:25], v[230:231], v[216:217], v[250:251] op_sel:[0,1,0] op_sel_hi:[1,1,1] neg_lo:[0,1,0] neg_hi:[0,1,0]
  v_pk_fma_f32 v[26:27], v[228:229], v[218:219], v[248:249] op_sel:[0,1,0] op_sel_hi:[1,1,1] neg_lo:[0,1,0] neg_hi:[0,1,0]
  s_mul_i32 s80, s88, 6144
  s_mul_i32 s30, s93, 24576
  s_add_u32 s80, s80, s30
  s_nop 0
  s_add_u32 s30, s80, 32768
  v_pk_fma_f32 v[38:39], v[230:231], v[218:219], v[250:251] op_sel:[0,1,0] op_sel_hi:[1,1,1] neg_lo:[0,1,0] neg_hi:[0,1,0]
  buffer_load_dwordx4 a[64:67], v16, s[4:7], s30 offen offset:0 sc1
  v_pk_fma_f32 v[172:173], v[172:173], v[216:217], v[22:23] op_sel_hi:[1,0,1]
  v_pk_fma_f32 v[174:175], v[174:175], v[216:217], v[24:25] op_sel_hi:[1,0,1]
  v_pk_fma_f32 v[176:177], v[176:177], v[218:219], v[26:27] op_sel_hi:[1,0,1]
  v_pk_fma_f32 v[178:179], v[178:179], v[218:219], v[38:39] op_sel_hi:[1,0,1]
  v_pk_fma_f32 v[22:23], v[172:173], v[172:173], s[64:65] op_sel_hi:[1,1,0]
  v_pk_fma_f32 v[24:25], v[174:175], v[174:175], s[64:65] op_sel_hi:[1,1,0]
  v_pk_fma_f32 v[26:27], v[176:177], v[176:177], s[64:65] op_sel_hi:[1,1,0]
  v_pk_fma_f32 v[38:39], v[178:179], v[178:179], s[64:65] op_sel_hi:[1,1,0]
  v_pk_mul_f32 v[22:23], v[22:23], v[172:173] neg_lo:[0,1] neg_hi:[0,1]
  v_pk_mul_f32 v[24:25], v[24:25], v[174:175] neg_lo:[0,1] neg_hi:[0,1]
  buffer_load_dwordx4 a[80:83], v16, s[4:7], s30 offen offset:1024 sc1
  v_pk_mul_f32 v[26:27], v[26:27], v[176:177] neg_lo:[0,1] neg_hi:[0,1]
  v_pk_mul_f32 v[38:39], v[38:39], v[178:179] neg_lo:[0,1] neg_hi:[0,1]
  v_exp_f32 v22, v22
  v_exp_f32 v23, v23
  v_exp_f32 v24, v24
  v_exp_f32 v25, v25
  v_exp_f32 v26, v26
  v_exp_f32 v27, v27
  v_exp_f32 v38, v38
  v_exp_f32 v39, v39
  buffer_load_dwordx4 a[72:75], v7, s[4:7], s30 offen offset:0 sc1
  v_pk_fma_f32 v[22:23], v[22:23], s[64:65], s[64:65] op_sel:[0,1,1] op_sel_hi:[1,1,1]
  v_pk_fma_f32 v[24:25], v[24:25], s[64:65], s[64:65] op_sel:[0,1,1] op_sel_hi:[1,1,1]
  v_pk_fma_f32 v[26:27], v[26:27], s[64:65], s[64:65] op_sel:[0,1,1] op_sel_hi:[1,1,1]
  v_pk_fma_f32 v[38:39], v[38:39], s[64:65], s[64:65] op_sel:[0,1,1] op_sel_hi:[1,1,1]
  v_rcp_f32 v22, v22
  v_rcp_f32 v23, v23
  v_rcp_f32 v24, v24
  v_rcp_f32 v25, v25
  v_rcp_f32 v26, v26
  v_rcp_f32 v27, v27
  buffer_load_dwordx4 a[88:91], v7, s[4:7], s30 offen offset:1024 sc1
  v_rcp_f32 v38, v38
  v_rcp_f32 v39, v39
  v_pk_mul_f32 v[22:23], v[22:23], v[172:173]
  v_pk_mul_f32 v[24:25], v[24:25], v[174:175]
  v_pk_mul_f32 v[26:27], v[26:27], v[176:177]
  v_pk_mul_f32 v[38:39], v[38:39], v[178:179]
  v_cvt_pk_bf16_f32 v172, v22, v23
  v_cvt_pk_bf16_f32 v173, v24, v25
  v_cvt_pk_bf16_f32 v174, v26, v27
  v_cvt_pk_bf16_f32 v175, v38, v39
  s_nop 0
  v_permlane32_swap_b32 v172, v174
  v_permlane32_swap_b32 v173, v175
  s_nop 0
  s_mov_b32 s29, 295936
  buffer_store_dwordx4 v[172:175], v17, s[12:15], s29 offen sc1
  v_accvgpr_read_b32 v188, a192
  v_accvgpr_read_b32 v189, a193
  v_accvgpr_read_b32 v190, a194
  v_accvgpr_read_b32 v191, a195
  v_accvgpr_read_b32 v192, a196
  v_accvgpr_read_b32 v193, a197
  v_accvgpr_read_b32 v194, a198
  s_add_u32 s30, s80, 180736
  v_accvgpr_read_b32 v195, a199
  buffer_load_dwordx4 a[68:71], v16, s[4:7], s30 offen offset:0 sc1
  v_pk_fma_f32 v[22:23], v[228:229], v[220:221], v[248:249] op_sel:[0,1,0] op_sel_hi:[1,1,1] neg_lo:[0,1,0] neg_hi:[0,1,0]
  v_pk_fma_f32 v[24:25], v[230:231], v[220:221], v[250:251] op_sel:[0,1,0] op_sel_hi:[1,1,1] neg_lo:[0,1,0] neg_hi:[0,1,0]
  v_pk_fma_f32 v[26:27], v[228:229], v[222:223], v[248:249] op_sel:[0,1,0] op_sel_hi:[1,1,1] neg_lo:[0,1,0] neg_hi:[0,1,0]
  v_pk_fma_f32 v[38:39], v[230:231], v[222:223], v[250:251] op_sel:[0,1,0] op_sel_hi:[1,1,1] neg_lo:[0,1,0] neg_hi:[0,1,0]
  v_pk_fma_f32 v[188:189], v[188:189], v[220:221], v[22:23] op_sel_hi:[1,0,1]
  v_pk_fma_f32 v[190:191], v[190:191], v[220:221], v[24:25] op_sel_hi:[1,0,1]
  v_pk_fma_f32 v[192:193], v[192:193], v[222:223], v[26:27] op_sel_hi:[1,0,1]
  v_pk_fma_f32 v[194:195], v[194:195], v[222:223], v[38:39] op_sel_hi:[1,0,1]
  v_pk_fma_f32 v[22:23], v[188:189], v[188:189], s[64:65] op_sel_hi:[1,1,0]
  v_pk_fma_f32 v[24:25], v[190:191], v[190:191], s[64:65] op_sel_hi:[1,1,0]
  v_pk_fma_f32 v[26:27], v[192:193], v[192:193], s[64:65] op_sel_hi:[1,1,0]
  buffer_load_dwordx4 a[84:87], v16, s[4:7], s30 offen offset:1024 sc1
  v_pk_fma_f32 v[38:39], v[194:195], v[194:195], s[64:65] op_sel_hi:[1,1,0]
  v_pk_mul_f32 v[22:23], v[22:23], v[188:189] neg_lo:[0,1] neg_hi:[0,1]
  v_pk_mul_f32 v[24:25], v[24:25], v[190:191] neg_lo:[0,1] neg_hi:[0,1]
  v_pk_mul_f32 v[26:27], v[26:27], v[192:193] neg_lo:[0,1] neg_hi:[0,1]
  v_pk_mul_f32 v[38:39], v[38:39], v[194:195] neg_lo:[0,1] neg_hi:[0,1]
  v_exp_f32 v22, v22
  v_exp_f32 v23, v23
  v_exp_f32 v24, v24
  v_exp_f32 v25, v25
  v_exp_f32 v26, v26
  v_exp_f32 v27, v27
  buffer_load_dwordx4 a[76:79], v7, s[4:7], s30 offen offset:0 sc1
  v_exp_f32 v38, v38
  v_exp_f32 v39, v39
  v_pk_fma_f32 v[22:23], v[22:23], s[64:65], s[64:65] op_sel:[0,1,1] op_sel_hi:[1,1,1]
  s_waitcnt vmcnt(12)
  s_nop 0
  v_max3_u32 v6, v48, v49, v50
  v_max3_u32 v34, v51, v52, v53
  v_max3_u32 v6, v6, v54, v55
  v_max3_u32 v34, v34, v72, v73
  v_max3_u32 v6, v6, v76, v77
  v_max3_u32 v34, v34, v96, v97
  v_max3_u32 v6, v6, v100, v101
  v_max_u32 v6, v6, v34
  v_cmp_eq_u32 vcc, -1, v6
  s_cbranch_vccnz La_hx_slow
  s_nop 0
La_hx_back:
  v_pk_fma_f32 v[24:25], v[24:25], s[64:65], s[64:65] op_sel:[0,1,1] op_sel_hi:[1,1,1]
  v_pk_fma_f32 v[26:27], v[26:27], s[64:65], s[64:65] op_sel:[0,1,1] op_sel_hi:[1,1,1]
  v_mfma_f32_16x16x32_bf16 v[80:83], v[48:51], v[64:67], v[40:43]
  v_pk_fma_f32 v[38:39], v[38:39], s[64:65], s[64:65] op_sel:[0,1,1] op_sel_hi:[1,1,1]
  v_rcp_f32 v22, v22
  v_mfma_f32_16x16x32_bf16 v[84:87], v[68:71], v[64:67], v[8:11]
  v_rcp_f32 v23, v23
  v_rcp_f32 v24, v24
  v_rcp_f32 v25, v25
  v_mfma_f32_16x16x32_bf16 v[104:107], v[52:55], v[88:91], v[40:43]
  v_rcp_f32 v26, v26
  buffer_load_dwordx4 a[92:95], v7, s[4:7], s30 offen offset:1024 sc1
  v_rcp_f32 v27, v27
  v_mfma_f32_16x16x32_bf16 v[108:111], v[92:95], v[88:91], v[8:11]
  v_rcp_f32 v38, v38
  v_rcp_f32 v39, v39
  v_pk_mul_f32 v[22:23], v[22:23], v[188:189]
  v_pk_mul_f32 v[24:25], v[24:25], v[190:191]
  v_pk_mul_f32 v[26:27], v[26:27], v[192:193]
  v_pk_mul_f32 v[38:39], v[38:39], v[194:195]
  v_cvt_pk_bf16_f32 v188, v22, v23
  v_cvt_pk_bf16_f32 v189, v24, v25
  v_cvt_pk_bf16_f32 v190, v26, v27
  v_cvt_pk_bf16_f32 v191, v38, v39
  s_nop 0
  v_permlane32_swap_b32 v188, v190
  v_permlane32_swap_b32 v189, v191
  s_mov_b32 s29, 591872
  buffer_store_dwordx4 v[188:191], v17, s[12:15], s29 offen sc1
  v_max_f32 v80, v80, v84
  v_max_f32 v104, v104, v108
  v_max_f32 v81, v81, v85
  v_max_f32 v105, v105, v109
  v_max_f32 v82, v82, v86
  v_max_f32 v106, v106, v110
  v_max_f32 v83, v83, v87
  v_max_f32 v107, v107, v111
  v_max3_f32 v22, v80, v81, v82
  v_max3_f32 v24, v104, v105, v106
  v_max_f32 v22, v22, v83
  v_max_f32 v24, v24, v107
  s_mov_b32 s29, 739840
  buffer_store_dwordx4 v[184:187], v18, s[12:15], s29 offen sc1
  v_permlane16_swap_b32 v22, v24
  v_max_f32 v22, v22, v24
  v_mov_b32 v24, v22
  s_nop 1
  v_permlane32_swap_b32 v22, v24
  v_max_f32 v22, v22, v24
  v_mul_f32 v22, s86, v22
  v_mov_b32 v24, v22
  s_nop 1
  v_permlane16_swap_b32 v22, v24
  s_nop 0
  v_pk_fma_f32 v[80:81], v[80:81], s[86:87], v[22:23] op_sel_hi:[1,1,0] neg_lo:[0,0,1] neg_hi:[0,0,1]
  v_pk_fma_f32 v[104:105], v[104:105], s[86:87], v[24:25] op_sel_hi:[1,1,0] neg_lo:[0,0,1] neg_hi:[0,0,1]
  v_pk_fma_f32 v[82:83], v[82:83], s[86:87], v[22:23] op_sel_hi:[1,1,0] neg_lo:[0,0,1] neg_hi:[0,0,1]
  v_pk_fma_f32 v[106:107], v[106:107], s[86:87], v[24:25] op_sel_hi:[1,1,0] neg_lo:[0,0,1] neg_hi:[0,0,1]
  v_exp_f32 v80, v80
  v_exp_f32 v104, v104
  v_exp_f32 v81, v81
  s_mov_b32 s29, 295936
  buffer_store_dwordx4 v[112:115], v18, s[12:15], s29 offen sc1
  v_exp_f32 v105, v105
  v_exp_f32 v82, v82
  v_exp_f32 v106, v106
  v_exp_f32 v83, v83
  v_exp_f32 v107, v107
  v_cvt_pk_bf16_f32 v84, v80, v81
  v_cvt_pk_bf16_f32 v108, v104, v105
  v_cvt_pk_bf16_f32 v85, v82, v83
  v_cvt_pk_bf16_f32 v109, v106, v107
  s_mov_b32 s29, 443904
  buffer_store_dwordx4 v[136:139], v18, s[12:15], s29 offen sc1
  v_and_b32 v64, v44, v84
  v_and_b32 v88, v44, v108
  v_and_b32 v65, v45, v85
  v_and_b32 v89, v45, v109
  v_bfi_b32 v66, v44, 0, v84
  v_bfi_b32 v90, v44, 0, v108
  v_bfi_b32 v67, v45, 0, v85
  v_bfi_b32 v91, v45, 0, v109
  v_accvgpr_read_b32 v196, a200
  v_accvgpr_read_b32 v197, a201
  v_accvgpr_read_b32 v198, a202
  v_accvgpr_read_b32 v199, a203
  v_accvgpr_read_b32 v200, a204
  v_accvgpr_read_b32 v201, a205
  v_accvgpr_read_b32 v202, a206
  v_accvgpr_read_b32 v203, a207
  v_pk_fma_f32 v[22:23], v[228:229], v[224:225], v[248:249] op_sel:[0,1,0] op_sel_hi:[1,1,1] neg_lo:[0,1,0] neg_hi:[0,1,0]
  v_pk_fma_f32 v[24:25], v[230:231], v[224:225], v[250:251] op_sel:[0,1,0] op_sel_hi:[1,1,1] neg_lo:[0,1,0] neg_hi:[0,1,0]
  v_mfma_f32_16x16x32_bf16 v[80:83], v[72:75], v[64:67], 0
  v_pk_fma_f32 v[26:27], v[228:229], v[226:227], v[248:249] op_sel:[0,1,0] op_sel_hi:[1,1,1] neg_lo:[0,1,0] neg_hi:[0,1,0]
  v_pk_fma_f32 v[38:39], v[230:231], v[226:227], v[250:251] op_sel:[0,1,0] op_sel_hi:[1,1,1] neg_lo:[0,1,0] neg_hi:[0,1,0]
  v_pk_fma_f32 v[196:197], v[196:197], v[224:225], v[22:23] op_sel_hi:[1,0,1]
  v_mfma_f32_16x16x32_bf16 v[84:87], v[76:79], v[64:67], 0
  s_barrier
  s_nop 0
  v_pk_fma_f32 v[198:199], v[198:199], v[224:225], v[24:25] op_sel_hi:[1,0,1]
  v_pk_fma_f32 v[200:201], v[200:201], v[226:227], v[26:27] op_sel_hi:[1,0,1]
  ds_read_b64_tr_b16 a[0:1], v240 offset:32768
  v_pk_fma_f32 v[202:203], v[202:203], v[226:227], v[38:39] op_sel_hi:[1,0,1]
  v_mfma_f32_16x16x32_bf16 v[72:75], a[136:139], v[64:67], 0
  v_pk_fma_f32 v[22:23], v[196:197], v[196:197], s[64:65] op_sel_hi:[1,1,0]
  ds_read_b64_tr_b16 a[2:3], v240 offset:36864
  v_pk_fma_f32 v[24:25], v[198:199], v[198:199], s[64:65] op_sel_hi:[1,1,0]
  v_pk_fma_f32 v[26:27], v[200:201], v[200:201], s[64:65] op_sel_hi:[1,1,0]
  v_mfma_f32_16x16x32_bf16 v[104:107], v[96:99], v[88:91], 0
  ds_read_b64_tr_b16 a[4:5], v240 offset:40960
  v_pk_fma_f32 v[38:39], v[202:203], v[202:203], s[64:65] op_sel_hi:[1,1,0]
  v_pk_mul_f32 v[22:23], v[22:23], v[196:197] neg_lo:[0,1] neg_hi:[0,1]
  ds_read_b64_tr_b16 a[6:7], v240 offset:45056
  v_pk_mul_f32 v[24:25], v[24:25], v[198:199] neg_lo:[0,1] neg_hi:[0,1]
  v_mfma_f32_16x16x32_bf16 v[108:111], v[100:103], v[88:91], 0
  v_pk_mul_f32 v[26:27], v[26:27], v[200:201] neg_lo:[0,1] neg_hi:[0,1]
  v_pk_mul_f32 v[38:39], v[38:39], v[202:203] neg_lo:[0,1] neg_hi:[0,1]
  ds_read_b64_tr_b16 a[8:9], v241 offset:32768
  v_exp_f32 v22, v22
  v_mfma_f32_16x16x32_bf16 v[96:99], a[136:139], v[88:91], 0
  v_exp_f32 v23, v23
  ds_read_b64_tr_b16 a[10:11], v241 offset:36864
  v_exp_f32 v24, v24
  v_exp_f32 v25, v25
  ds_read_b64_tr_b16 a[12:13], v241 offset:40960
  v_exp_f32 v26, v26
  v_exp_f32 v27, v27
  ds_read_b64_tr_b16 a[14:15], v241 offset:45056
  v_exp_f32 v38, v38
  v_exp_f32 v39, v39
  v_pk_fma_f32 v[22:23], v[22:23], s[64:65], s[64:65] op_sel:[0,1,1] op_sel_hi:[1,1,1]
  ds_read_b64_tr_b16 a[16:17], v242 offset:32768
  v_pk_fma_f32 v[24:25], v[24:25], s[64:65], s[64:65] op_sel:[0,1,1] op_sel_hi:[1,1,1]
  v_pk_fma_f32 v[26:27], v[26:27], s[64:65], s[64:65] op_sel:[0,1,1] op_sel_hi:[1,1,1]
  ds_read_b64_tr_b16 a[18:19], v242 offset:36864
  v_pk_fma_f32 v[38:39], v[38:39], s[64:65], s[64:65] op_sel:[0,1,1] op_sel_hi:[1,1,1]
  v_rcp_f32 v22, v22
  ds_read_b64_tr_b16 a[20:21], v242 offset:40960
  v_rcp_f32 v23, v23
  v_rcp_f32 v24, v24
  ds_read_b64_tr_b16 a[22:23], v242 offset:45056
  v_rcp_f32 v25, v25
  v_rcp_f32 v26, v26
  v_rcp_f32 v27, v27
  ds_read_b64_tr_b16 a[24:25], v243 offset:32768
  v_rcp_f32 v38, v38
  v_rcp_f32 v39, v39
  ds_read_b64_tr_b16 a[26:27], v243 offset:36864
  v_pk_mul_f32 v[22:23], v[22:23], v[196:197]
  v_pk_mul_f32 v[24:25], v[24:25], v[198:199]
  ds_read_b64_tr_b16 a[28:29], v243 offset:40960
  v_pk_mul_f32 v[26:27], v[26:27], v[200:201]
  v_pk_mul_f32 v[38:39], v[38:39], v[202:203]
  ds_read_b64_tr_b16 a[30:31], v243 offset:45056
  v_cvt_pk_bf16_f32 v196, v22, v23
  v_cvt_pk_bf16_f32 v197, v24, v25
  v_cvt_pk_bf16_f32 v198, v26, v27
  v_cvt_pk_bf16_f32 v199, v38, v39
  s_nop 0
  v_permlane32_swap_b32 v196, v198
  v_permlane32_swap_b32 v197, v199
  s_mov_b32 s29, 887808
  buffer_store_dwordx4 v[196:199], v17, s[12:15], s29 offen sc1
  v_rcp_f32 v72, v72
  v_rcp_f32_e64 v96, v96
  v_pk_mul_f32 v[80:81], v[80:81], v[72:73] op_sel_hi:[1,0]
  v_pk_mul_f32 v[104:105], v[104:105], v[96:97] op_sel_hi:[1,0]
  v_pk_mul_f32 v[82:83], v[82:83], v[72:73] op_sel_hi:[1,0]
  v_pk_mul_f32 v[106:107], v[106:107], v[96:97] op_sel_hi:[1,0]
  v_pk_mul_f32 v[84:85], v[84:85], v[72:73] op_sel_hi:[1,0]
  v_pk_mul_f32 v[108:109], v[108:109], v[96:97] op_sel_hi:[1,0]
  v_pk_mul_f32 v[86:87], v[86:87], v[72:73] op_sel_hi:[1,0]
  v_pk_mul_f32 v[110:111], v[110:111], v[96:97] op_sel_hi:[1,0]
  v_cvt_pk_bf16_f32 v64, v80, v81
  v_cvt_pk_bf16_f32 v88, v104, v105
  v_cvt_pk_bf16_f32 v65, v82, v83
  v_cvt_pk_bf16_f32 v89, v106, v107
  v_cvt_pk_bf16_f32 v66, v84, v85
  v_cvt_pk_bf16_f32 v90, v108, v109
  v_cvt_pk_bf16_f32 v67, v86, v87
  v_cvt_pk_bf16_f32 v91, v110, v111
  s_mov_b32 s29, 0
  s_nop 0
  buffer_store_dwordx4 v[64:67], v18, s[12:15], s29 offen sc1
  s_mov_b32 s29, 147968
  buffer_store_dwordx4 v[88:91], v18, s[12:15], s29 offen sc1
  s_waitcnt vmcnt(7) lgkmcnt(0)
La_g2:
  v_mfma_f32_16x16x32_bf16 v[64:67], a[0:3], a[64:67], 0
  ds_read_b64_tr_b16 a[32:33], v240 offset:33792
  s_mul_i32 s81, s89, 6144
  s_mul_i32 s30, s93, 24576
  s_add_u32 s81, s81, s30
  s_add_u32 s30, s81, 38912
  v_mfma_f32_16x16x32_bf16 v[64:67], a[4:7], a[80:83], v[64:67]
  buffer_load_dwordx4 a[96:99], v16, s[4:7], s30 offen offset:0 sc1
  v_mfma_f32_16x16x32_bf16 v[96:99], a[4:7], a[84:87], 0
  ds_read_b64_tr_b16 a[34:35], v240 offset:37888
  v_mfma_f32_16x16x32_bf16 v[96:99], a[0:3], a[68:71], v[96:99]
  v_add_u32 v244, 0x10000, v240
  v_mfma_f32_16x16x32_bf16 v[128:131], a[0:3], a[72:75], 0
  ds_read_b64_tr_b16 a[36:37], v240 offset:41984
  v_mfma_f32_16x16x32_bf16 v[128:131], a[4:7], a[88:91], v[128:131]
  buffer_load_dwordx4 a[112:115], v16, s[4:7], s30 offen offset:1024 sc1
  v_mfma_f32_16x16x32_bf16 v[160:163], a[4:7], a[92:95], 0
  ds_read_b64_tr_b16 a[38:39], v240 offset:46080
  v_add_u32 v245, 0x10000, v241
  v_mfma_f32_16x16x32_bf16 v[160:163], a[0:3], a[76:79], v[160:163]
  v_mfma_f32_16x16x32_bf16 v[68:71], a[8:11], a[64:67], 0
  ds_read_b64_tr_b16 a[40:41], v241 offset:33792
  v_mfma_f32_16x16x32_bf16 v[68:71], a[12:15], a[80:83], v[68:71]
  buffer_load_dwordx4 a[104:107], v7, s[4:7], s30 offen offset:0 sc1
  v_mfma_f32_16x16x32_bf16 v[100:103], a[12:15], a[84:87], 0
  ds_read_b64_tr_b16 a[42:43], v241 offset:37888
  v_add_u32 v246, 0x10000, v242
  v_mfma_f32_16x16x32_bf16 v[100:103], a[8:11], a[68:71], v[100:103]
  v_mfma_f32_16x16x32_bf16 v[132:135], a[8:11], a[72:75], 0
  ds_read_b64_tr_b16 a[44:45], v241 offset:41984
  v_mfma_f32_16x16x32_bf16 v[132:135], a[12:15], a[88:91], v[132:135]
  v_add_u32 v247, 0x10000, v243
  buffer_load_dwordx4 a[120:123], v7, s[4:7], s30 offen offset:1024 sc1
  v_mfma_f32_16x16x32_bf16 v[164:167], a[12:15], a[92:95], 0
  ds_read_b64_tr_b16 a[46:47], v241 offset:46080
  v_mfma_f32_16x16x32_bf16 v[164:167], a[8:11], a[76:79], v[164:167]
  s_waitcnt lgkmcnt(8)
  v_mfma_f32_16x16x32_bf16 v[72:75], a[16:19], a[64:67], 0
  ds_read_b64_tr_b16 a[48:49], v242 offset:33792
  s_add_u32 s30, s81, 186880
  v_mfma_f32_16x16x32_bf16 v[72:75], a[20:23], a[80:83], v[72:75]
  v_xor_b32 v237, 32, v236
  buffer_load_dwordx4 a[100:103], v16, s[4:7], s30 offen offset:0 sc1
  v_mfma_f32_16x16x32_bf16 v[104:107], a[20:23], a[84:87], 0
  ds_read_b64_tr_b16 a[50:51], v242 offset:37888
  v_mfma_f32_16x16x32_bf16 v[104:107], a[16:19], a[68:71], v[104:107]
  v_mfma_f32_16x16x32_bf16 v[136:139], a[16:19], a[72:75], 0
  ds_read_b64_tr_b16 a[52:53], v242 offset:41984
  v_xor_b32_e64 v238, 64, v236
  v_mfma_f32_16x16x32_bf16 v[136:139], a[20:23], a[88:91], v[136:139]
  buffer_load_dwordx4 a[116:119], v16, s[4:7], s30 offen offset:1024 sc1
  v_mfma_f32_16x16x32_bf16 v[168:171], a[20:23], a[92:95], 0
  ds_read_b64_tr_b16 a[54:55], v242 offset:46080
  v_mfma_f32_16x16x32_bf16 v[168:171], a[16:19], a[76:79], v[168:171]
  v_mfma_f32_16x16x32_bf16 v[76:79], a[24:27], a[64:67], 0
  ds_read_b64_tr_b16 a[56:57], v243 offset:33792
  v_xor_b32 v239, 96, v236
  v_mfma_f32_16x16x32_bf16 v[76:79], a[28:31], a[80:83], v[76:79]
  buffer_load_dwordx4 a[108:111], v7, s[4:7], s30 offen offset:0 sc1
  v_mfma_f32_16x16x32_bf16 v[108:111], a[28:31], a[84:87], 0
  ds_read_b64_tr_b16 a[58:59], v243 offset:37888
  v_mfma_f32_16x16x32_bf16 v[108:111], a[24:27], a[68:71], v[108:111]
  v_mfma_f32_16x16x32_bf16 v[140:143], a[24:27], a[72:75], 0
  ds_read_b64_tr_b16 a[60:61], v243 offset:41984
  v_mfma_f32_16x16x32_bf16 v[140:143], a[28:31], a[88:91], v[140:143]
  buffer_load_dwordx4 a[124:127], v7, s[4:7], s30 offen offset:1024 sc1
  v_mfma_f32_16x16x32_bf16 v[172:175], a[28:31], a[92:95], 0
  ds_read_b64_tr_b16 a[62:63], v243 offset:46080
  v_mfma_f32_16x16x32_bf16 v[172:175], a[24:27], a[76:79], v[172:175]
  s_waitcnt lgkmcnt(8)
  s_barrier
  v_mfma_f32_16x16x32_bf16 v[80:83], a[32:35], a[64:67], 0
  ds_read_b64_tr_b16 a[0:1], v240 offset:49152
  buffer_load_dword v33, v20, s[16:19], s32 offen sc1
  s_add_u32 s30, s80, 45056
  v_mfma_f32_16x16x32_bf16 v[80:83], a[36:39], a[80:83], v[80:83]
  buffer_load_dwordx4 a[128:131], v16, s[4:7], s30 offen offset:0 sc1
  v_mfma_f32_16x16x32_bf16 v[112:115], a[36:39], a[84:87], 0
  ds_read_b64_tr_b16 a[2:3], v240 offset:53248
  v_mfma_f32_16x16x32_bf16 v[112:115], a[32:35], a[68:71], v[112:115]
  v_mfma_f32_16x16x32_bf16 v[144:147], a[32:35], a[72:75], 0
  ds_read_b64_tr_b16 a[4:5], v240 offset:57344
  v_mfma_f32_16x16x32_bf16 v[144:147], a[36:39], a[88:91], v[144:147]
  buffer_load_dwordx4 a[144:147], v16, s[4:7], s30 offen offset:1024 sc1
  v_mfma_f32_16x16x32_bf16 v[176:179], a[36:39], a[92:95], 0
  ds_read_b64_tr_b16 a[6:7], v240 offset:61440
  v_mfma_f32_16x16x32_bf16 v[176:179], a[32:35], a[76:79], v[176:179]
  v_mfma_f32_16x16x32_bf16 v[84:87], a[40:43], a[64:67], 0
  ds_read_b64_tr_b16 a[8:9], v241 offset:49152
  v_mfma_f32_16x16x32_bf16 v[84:87], a[44:47], a[80:83], v[84:87]
  buffer_load_dwordx4 a[136:139], v7, s[4:7], s30 offen offset:0 sc1
  v_mfma_f32_16x16x32_bf16 v[116:119], a[44:47], a[84:87], 0
  ds_read_b64_tr_b16 a[10:11], v241 offset:53248
  v_mfma_f32_16x16x32_bf16 v[116:119], a[40:43], a[68:71], v[116:119]
  v_mfma_f32_16x16x32_bf16 v[148:151], a[40:43], a[72:75], 0
  ds_read_b64_tr_b16 a[12:13], v241 offset:57344
  v_mfma_f32_16x16x32_bf16 v[148:151], a[44:47], a[88:91], v[148:151]
  v_mfma_f32_16x16x32_bf16 v[180:183], a[44:47], a[92:95], 0
  ds_read_b64_tr_b16 a[14:15], v241 offset:61440
  v_mfma_f32_16x16x32_bf16 v[180:183], a[40:43], a[76:79], v[180:183]
  s_waitcnt lgkmcnt(8)
  v_mfma_f32_16x16x32_bf16 v[88:91], a[48:51], a[64:67], 0
  ds_read_b64_tr_b16 a[16:17], v242 offset:49152
  v_mfma_f32_16x16x32_bf16 v[88:91], a[52:55], a[80:83], v[88:91]
  buffer_load_dwordx4 a[152:155], v7, s[4:7], s30 offen offset:1024 sc1
  v_mfma_f32_16x16x32_bf16 v[120:123], a[52:55], a[84:87], 0
  ds_read_b64_tr_b16 a[18:19], v242 offset:53248
  v_mfma_f32_16x16x32_bf16 v[120:123], a[48:51], a[68:71], v[120:123]
  v_mfma_f32_16x16x32_bf16 v[152:155], a[48:51], a[72:75], 0
  ds_read_b64_tr_b16 a[20:21], v242 offset:57344
  s_add_u32 s30, s80, 193024
  v_mfma_f32_16x16x32_bf16 v[152:155], a[52:55], a[88:91], v[152:155]
  buffer_load_dwordx4 a[132:135], v16, s[4:7], s30 offen offset:0 sc1
  v_mfma_f32_16x16x32_bf16 v[184:187], a[52:55], a[92:95], 0
  ds_read_b64_tr_b16 a[22:23], v242 offset:61440
  v_mfma_f32_16x16x32_bf16 v[184:187], a[48:51], a[76:79], v[184:187]
  v_mfma_f32_16x16x32_bf16 v[92:95], a[56:59], a[64:67], 0
  ds_read_b64_tr_b16 a[24:25], v243 offset:49152
  v_mfma_f32_16x16x32_bf16 v[92:95], a[60:63], a[80:83], v[92:95]
  buffer_load_dwordx4 a[148:151], v16, s[4:7], s30 offen offset:1024 sc1
  v_mfma_f32_16x16x32_bf16 v[124:127], a[60:63], a[84:87], 0
  ds_read_b64_tr_b16 a[26:27], v243 offset:53248
  v_mfma_f32_16x16x32_bf16 v[124:127], a[56:59], a[68:71], v[124:127]
  v_mfma_f32_16x16x32_bf16 v[156:159], a[56:59], a[72:75], 0
  ds_read_b64_tr_b16 a[28:29], v243 offset:57344
  v_mfma_f32_16x16x32_bf16 v[156:159], a[60:63], a[88:91], v[156:159]
  v_mfma_f32_16x16x32_bf16 v[188:191], a[60:63], a[92:95], 0
  ds_read_b64_tr_b16 a[30:31], v243 offset:61440
  v_mfma_f32_16x16x32_bf16 v[188:191], a[56:59], a[76:79], v[188:191]
  s_waitcnt vmcnt(7) lgkmcnt(8)
  v_mfma_f32_16x16x32_bf16 v[64:67], a[0:3], a[96:99], v[64:67]
  ds_read_b64_tr_b16 a[32:33], v240 offset:50176
  v_mfma_f32_16x16x32_bf16 v[64:67], a[4:7], a[112:115], v[64:67]
  buffer_load_dwordx4 a[140:143], v7, s[4:7], s30 offen offset:0 sc1
  v_mfma_f32_16x16x32_bf16 v[96:99], a[4:7], a[116:119], v[96:99]
  ds_read_b64_tr_b16 a[34:35], v240 offset:54272
  v_mfma_f32_16x16x32_bf16 v[96:99], a[0:3], a[100:103], v[96:99]
  v_mfma_f32_16x16x32_bf16 v[128:131], a[0:3], a[104:107], v[128:131]
  ds_read_b64_tr_b16 a[36:37], v240 offset:58368
  v_mfma_f32_16x16x32_bf16 v[128:131], a[4:7], a[120:123], v[128:131]
  buffer_load_dwordx4 a[156:159], v7, s[4:7], s30 offen offset:1024 sc1
  v_mfma_f32_16x16x32_bf16 v[160:163], a[4:7], a[124:127], v[160:163]
  ds_read_b64_tr_b16 a[38:39], v240 offset:62464
  v_mfma_f32_16x16x32_bf16 v[160:163], a[0:3], a[108:111], v[160:163]
  v_mfma_f32_16x16x32_bf16 v[164:167], a[8:11], a[108:111], v[164:167]
  ds_read_b64_tr_b16 a[40:41], v241 offset:50176
  s_add_u32 s30, s81, 51200
  v_mfma_f32_16x16x32_bf16 v[164:167], a[12:15], a[124:127], v[164:167]
  buffer_load_dwordx4 a[160:163], v16, s[4:7], s30 offen offset:0 sc1
  v_mfma_f32_16x16x32_bf16 v[132:135], a[12:15], a[120:123], v[132:135]
  ds_read_b64_tr_b16 a[42:43], v241 offset:54272
  v_mfma_f32_16x16x32_bf16 v[132:135], a[8:11], a[104:107], v[132:135]
  v_mfma_f32_16x16x32_bf16 v[100:103], a[8:11], a[100:103], v[100:103]
  ds_read_b64_tr_b16 a[44:45], v241 offset:58368
  v_mfma_f32_16x16x32_bf16 v[100:103], a[12:15], a[116:119], v[100:103]
  v_mfma_f32_16x16x32_bf16 v[68:71], a[12:15], a[112:115], v[68:71]
  ds_read_b64_tr_b16 a[46:47], v241 offset:62464
  v_mfma_f32_16x16x32_bf16 v[68:71], a[8:11], a[96:99], v[68:71]
  s_waitcnt lgkmcnt(8)
  v_mfma_f32_16x16x32_bf16 v[72:75], a[16:19], a[96:99], v[72:75]
  ds_read_b64_tr_b16 a[48:49], v242 offset:50176
  v_mfma_f32_16x16x32_bf16 v[72:75], a[20:23], a[112:115], v[72:75]
  buffer_load_dwordx4 a[176:179], v16, s[4:7], s30 offen offset:1024 sc1
  v_mfma_f32_16x16x32_bf16 v[104:107], a[20:23], a[116:119], v[104:107]
  ds_read_b64_tr_b16 a[50:51], v242 offset:54272
  v_mfma_f32_16x16x32_bf16 v[104:107], a[16:19], a[100:103], v[104:107]
  v_mfma_f32_16x16x32_bf16 v[136:139], a[16:19], a[104:107], v[136:139]
  ds_read_b64_tr_b16 a[52:53], v242 offset:58368
  v_mfma_f32_16x16x32_bf16 v[136:139], a[20:23], a[120:123], v[136:139]
  buffer_load_dwordx4 a[168:171], v7, s[4:7], s30 offen offset:0 sc1
  v_mfma_f32_16x16x32_bf16 v[168:171], a[20:23], a[124:127], v[168:171]
  ds_read_b64_tr_b16 a[54:55], v242 offset:62464
  v_mfma_f32_16x16x32_bf16 v[168:171], a[16:19], a[108:111], v[168:171]
  v_mfma_f32_16x16x32_bf16 v[172:175], a[24:27], a[108:111], v[172:175]
  ds_read_b64_tr_b16 a[56:57], v243 offset:50176
  v_mfma_f32_16x16x32_bf16 v[172:175], a[28:31], a[124:127], v[172:175]
  buffer_load_dwordx4 a[184:187], v7, s[4:7], s30 offen offset:1024 sc1
  v_mfma_f32_16x16x32_bf16 v[140:143], a[28:31], a[120:123], v[140:143]
  ds_read_b64_tr_b16 a[58:59], v243 offset:54272
  v_mfma_f32_16x16x32_bf16 v[140:143], a[24:27], a[104:107], v[140:143]
  v_mfma_f32_16x16x32_bf16 v[108:111], a[24:27], a[100:103], v[108:111]
  ds_read_b64_tr_b16 a[60:61], v243 offset:58368
  v_mfma_f32_16x16x32_bf16 v[108:111], a[28:31], a[116:119], v[108:111]
  v_mfma_f32_16x16x32_bf16 v[76:79], a[28:31], a[112:115], v[76:79]
  ds_read_b64_tr_b16 a[62:63], v243 offset:62464
  v_mfma_f32_16x16x32_bf16 v[76:79], a[24:27], a[96:99], v[76:79]
La_pad9:
  s_cbranch_execz La_ret1
  s_nop 0
  s_waitcnt vmcnt(12) lgkmcnt(8)
  v_mfma_f32_16x16x32_bf16 v[80:83], a[32:35], a[96:99], v[80:83]
  ds_read_b64_tr_b16 a[0:1], v244 offset:0
  v_cmp_eq_u32 vcc, 0, v33
  s_cbranch_vccnz La_g2_slow
La_g2_back:
  s_mov_b64 exec, 1
  buffer_store_dword v35, v29, s[16:19], 0 offen sc1
  s_mov_b64 exec, -1
  s_add_u32 s30, s81, 199168
  v_mfma_f32_16x16x32_bf16 v[80:83], a[36:39], a[112:115], v[80:83]
  buffer_load_dwordx4 a[164:167], v16, s[4:7], s30 offen offset:0 sc1
  v_mfma_f32_16x16x32_bf16 v[112:115], a[36:39], a[116:119], v[112:115]
  ds_read_b64_tr_b16 a[2:3], v244 offset:4096
  v_mfma_f32_16x16x32_bf16 v[112:115], a[32:35], a[100:103], v[112:115]
  v_mfma_f32_16x16x32_bf16 v[144:147], a[32:35], a[104:107], v[144:147]
  ds_read_b64_tr_b16 a[4:5], v244 offset:8192
  v_mfma_f32_16x16x32_bf16 v[144:147], a[36:39], a[120:123], v[144:147]
  buffer_load_dwordx4 a[180:183], v16, s[4:7], s30 offen offset:1024 sc1
  v_mfma_f32_16x16x32_bf16 v[176:179], a[36:39], a[124:127], v[176:179]
  ds_read_b64_tr_b16 a[6:7], v244 offset:12288
  v_mfma_f32_16x16x32_bf16 v[176:179], a[32:35], a[108:111], v[176:179]
  v_mfma_f32_16x16x32_bf16 v[180:183], a[40:43], a[108:111], v[180:183]
  ds_read_b64_tr_b16 a[8:9], v245 offset:0
  v_mfma_f32_16x16x32_bf16 v[180:183], a[44:47], a[124:127], v[180:183]
  buffer_load_dwordx4 a[172:175], v7, s[4:7], s30 offen offset:0 sc1
  v_mfma_f32_16x16x32_bf16 v[148:151], a[44:47], a[120:123], v[148:151]
  ds_read_b64_tr_b16 a[10:11], v245 offset:4096
  v_mfma_f32_16x16x32_bf16 v[148:151], a[40:43], a[104:107], v[148:151]
  v_mfma_f32_16x16x32_bf16 v[116:119], a[40:43], a[100:103], v[116:119]
  ds_read_b64_tr_b16 a[12:13], v245 offset:8192
  v_mfma_f32_16x16x32_bf16 v[116:119], a[44:47], a[116:119], v[116:119]
  v_mfma_f32_16x16x32_bf16 v[84:87], a[44:47], a[112:115], v[84:87]
  ds_read_b64_tr_b16 a[14:15], v245 offset:12288
  v_mfma_f32_16x16x32_bf16 v[84:87], a[40:43], a[96:99], v[84:87]
  s_waitcnt lgkmcnt(8)
  v_mfma_f32_16x16x32_bf16 v[88:91], a[48:51], a[96:99], v[88:91]
  ds_read_b64_tr_b16 a[16:17], v246 offset:0
  v_mfma_f32_16x16x32_bf16 v[88:91], a[52:55], a[112:115], v[88:91]
  buffer_load_dwordx4 a[188:191], v7, s[4:7], s30 offen offset:1024 sc1
  v_mfma_f32_16x16x32_bf16 v[120:123], a[52:55], a[116:119], v[120:123]
  ds_read_b64_tr_b16 a[18:19], v246 offset:4096
  v_mfma_f32_16x16x32_bf16 v[120:123], a[48:51], a[100:103], v[120:123]
  v_mfma_f32_16x16x32_bf16 v[152:155], a[48:51], a[104:107], v[152:155]
  ds_read_b64_tr_b16 a[20:21], v246 offset:8192
  s_add_u32 s30, s80, 34816
  v_mfma_f32_16x16x32_bf16 v[152:155], a[52:55], a[120:123], v[152:155]
  buffer_load_dwordx4 a[64:67], v16, s[4:7], s30 offen offset:0 sc1
  v_mfma_f32_16x16x32_bf16 v[184:187], a[52:55], a[124:127], v[184:187]
  ds_read_b64_tr_b16 a[22:23], v246 offset:12288
  v_mfma_f32_16x16x32_bf16 v[184:187], a[48:51], a[108:111], v[184:187]
  v_mfma_f32_16x16x32_bf16 v[188:191], a[56:59], a[108:111], v[188:191]
  ds_read_b64_tr_b16 a[24:25], v247 offset:0
  v_mfma_f32_16x16x32_bf16 v[188:191], a[60:63], a[124:127], v[188:191]
  buffer_load_dwordx4 a[80:83], v16, s[4:7], s30 offen offset:1024 sc1
  v_mfma_f32_16x16x32_bf16 v[156:159], a[60:63], a[120:123], v[156:159]
  ds_read_b64_tr_b16 a[26:27], v247 offset:4096
  v_mfma_f32_16x16x32_bf16 v[156:159], a[56:59], a[104:107], v[156:159]
  v_mfma_f32_16x16x32_bf16 v[124:127], a[56:59], a[100:103], v[124:127]
  ds_read_b64_tr_b16 a[28:29], v247 offset:8192
  v_mfma_f32_16x16x32_bf16 v[124:127], a[60:63], a[116:119], v[124:127]
  v_mfma_f32_16x16x32_bf16 v[92:95], a[60:63], a[112:115], v[92:95]
  ds_read_b64_tr_b16 a[30:31], v247 offset:12288
  v_mfma_f32_16x16x32_bf16 v[92:95], a[56:59], a[96:99], v[92:95]
  s_waitcnt vmcnt(11) lgkmcnt(8)
  v_mfma_f32_16x16x32_bf16 v[64:67], a[0:3], a[128:131], v[64:67]
  ds_read_b64_tr_b16 a[32:33], v244 offset:1024
  v_mfma_f32_16x16x32_bf16 v[64:67], a[4:7], a[144:147], v[64:67]
  buffer_load_dwordx4 a[72:75], v7, s[4:7], s30 offen offset:0 sc1
  v_mfma_f32_16x16x32_bf16 v[96:99], a[4:7], a[148:151], v[96:99]
  ds_read_b64_tr_b16 a[34:35], v244 offset:5120
  v_mfma_f32_16x16x32_bf16 v[96:99], a[0:3], a[132:135], v[96:99]
  v_mfma_f32_16x16x32_bf16 v[128:131], a[0:3], a[136:139], v[128:131]
  ds_read_b64_tr_b16 a[36:37], v244 offset:9216
  v_mfma_f32_16x16x32_bf16 v[128:131], a[4:7], a[152:155], v[128:131]
  buffer_load_dwordx4 a[88:91], v7, s[4:7], s30 offen offset:1024 sc1
  v_mfma_f32_16x16x32_bf16 v[160:163], a[4:7], a[156:159], v[160:163]
  ds_read_b64_tr_b16 a[38:39], v244 offset:13312
  v_mfma_f32_16x16x32_bf16 v[160:163], a[0:3], a[140:143], v[160:163]
  v_mfma_f32_16x16x32_bf16 v[164:167], a[8:11], a[140:143], v[164:167]
  ds_read_b64_tr_b16 a[40:41], v245 offset:1024
  s_add_u32 s30, s80, 182784
  v_mfma_f32_16x16x32_bf16 v[164:167], a[12:15], a[156:159], v[164:167]
  buffer_load_dwordx4 a[68:71], v16, s[4:7], s30 offen offset:0 sc1
  v_mfma_f32_16x16x32_bf16 v[132:135], a[12:15], a[152:155], v[132:135]
  ds_read_b64_tr_b16 a[42:43], v245 offset:5120
  v_mfma_f32_16x16x32_bf16 v[132:135], a[8:11], a[136:139], v[132:135]
  v_mfma_f32_16x16x32_bf16 v[100:103], a[8:11], a[132:135], v[100:103]
  ds_read_b64_tr_b16 a[44:45], v245 offset:9216
  v_mfma_f32_16x16x32_bf16 v[100:103], a[12:15], a[148:151], v[100:103]
  v_mfma_f32_16x16x32_bf16 v[68:71], a[12:15], a[144:147], v[68:71]
  ds_read_b64_tr_b16 a[46:47], v245 offset:13312
  v_mfma_f32_16x16x32_bf16 v[68:71], a[8:11], a[128:131], v[68:71]
  s_waitcnt lgkmcnt(8)
  v_mfma_f32_16x16x32_bf16 v[72:75], a[16:19], a[128:131], v[72:75]
  ds_read_b64_tr_b16 a[48:49], v246 offset:1024
  v_mfma_f32_16x16x32_bf16 v[72:75], a[20:23], a[144:147], v[72:75]
  buffer_load_dwordx4 a[84:87], v16, s[4:7], s30 offen offset:1024 sc1
  v_mfma_f32_16x16x32_bf16 v[104:107], a[20:23], a[148:151], v[104:107]
  ds_read_b64_tr_b16 a[50:51], v246 offset:5120
  v_mfma_f32_16x16x32_bf16 v[104:107], a[16:19], a[132:135], v[104:107]
  v_mfma_f32_16x16x32_bf16 v[136:139], a[16:19], a[136:139], v[136:139]
  ds_read_b64_tr_b16 a[52:53], v246 offset:9216
  v_mfma_f32_16x16x32_bf16 v[136:139], a[20:23], a[152:155], v[136:139]
  buffer_load_dwordx4 a[76:79], v7, s[4:7], s30 offen offset:0 sc1
  v_mfma_f32_16x16x32_bf16 v[168:171], a[20:23], a[156:159], v[168:171]
  ds_read_b64_tr_b16 a[54:55], v246 offset:13312
  v_mfma_f32_16x16x32_bf16 v[168:171], a[16:19], a[140:143], v[168:171]
  v_mfma_f32_16x16x32_bf16 v[172:175], a[24:27], a[140:143], v[172:175]
  ds_read_b64_tr_b16 a[56:57], v247 offset:1024
  v_mfma_f32_16x16x32_bf16 v[172:175], a[28:31], a[156:159], v[172:175]
  buffer_load_dwordx4 a[92:95], v7, s[4:7], s30 offen offset:1024 sc1
  v_mfma_f32_16x16x32_bf16 v[140:143], a[28:31], a[152:155], v[140:143]
  ds_read_b64_tr_b16 a[58:59], v247 offset:5120
  v_mfma_f32_16x16x32_bf16 v[140:143], a[24:27], a[136:139], v[140:143]
  v_mfma_f32_16x16x32_bf16 v[108:111], a[24:27], a[132:135], v[108:111]
  ds_read_b64_tr_b16 a[60:61], v247 offset:9216
  v_mfma_f32_16x16x32_bf16 v[108:111], a[28:31], a[148:151], v[108:111]
  v_mfma_f32_16x16x32_bf16 v[76:79], a[28:31], a[144:147], v[76:79]
  ds_read_b64_tr_b16 a[62:63], v247 offset:13312
  v_mfma_f32_16x16x32_bf16 v[76:79], a[24:27], a[128:131], v[76:79]
  s_waitcnt lgkmcnt(8)
  s_barrier
  v_mfma_f32_16x16x32_bf16 v[80:83], a[32:35], a[128:131], v[80:83]
  ds_read_b64_tr_b16 a[0:1], v236 offset:0
  s_add_u32 s30, s81, 40960
  v_mfma_f32_16x16x32_bf16 v[80:83], a[36:39], a[144:147], v[80:83]
  buffer_load_dwordx4 a[96:99], v16, s[4:7], s30 offen offset:0 sc1
  v_mfma_f32_16x16x32_bf16 v[112:115], a[36:39], a[148:151], v[112:115]
  ds_read_b64_tr_b16 a[2:3], v236 offset:4096
  s_mul_i32 s29, s37, 9216
  s_add_u32 s29, s29, 5242880
  v_lshl_add_u32 v12, v2, 4, s29
  v_mfma_f32_16x16x32_bf16 v[112:115], a[32:35], a[132:135], v[112:115]
  s_xor_b32 s29, s37, 8
  s_mul_i32 s29, s29, 9216
  v_mfma_f32_16x16x32_bf16 v[144:147], a[32:35], a[136:139], v[144:147]
  ds_read_b64_tr_b16 a[4:5], v236 offset:8192
  v_mfma_f32_16x16x32_bf16 v[144:147], a[36:39], a[152:155], v[144:147]
  s_add_u32 s29, s29, 5242880
  v_lshl_add_u32 v13, v2, 4, s29
  buffer_load_dwordx4 a[112:115], v16, s[4:7], s30 offen offset:1024 sc1
  v_mfma_f32_16x16x32_bf16 v[176:179], a[36:39], a[156:159], v[176:179]
  ds_read_b64_tr_b16 a[6:7], v236 offset:12288
  v_mfma_f32_16x16x32_bf16 v[176:179], a[32:35], a[140:143], v[176:179]
  s_lshr_b32 s29, s2, 1
  s_lshl_b32 s29, s29, 2
  s_add_u32 s29, s29, s20
  v_mfma_f32_16x16x32_bf16 v[180:183], a[40:43], a[140:143], v[180:183]
  ds_read_b64_tr_b16 a[8:9], v237 offset:0
  v_mfma_f32_16x16x32_bf16 v[180:183], a[44:47], a[156:159], v[180:183]
  s_mul_i32 s29, s29, 9216
  v_lshl_add_u32 v18, v2, 4, s29
  buffer_load_dwordx4 a[104:107], v7, s[4:7], s30 offen offset:0 sc1
  v_mfma_f32_16x16x32_bf16 v[148:151], a[44:47], a[152:155], v[148:151]
  ds_read_b64_tr_b16 a[10:11], v237 offset:4096
  s_xor_b32 s29, s99, 256
  v_mov_b32 v26, s29
  v_mfma_f32_16x16x32_bf16 v[148:151], a[40:43], a[136:139], v[148:151]
  v_mfma_f32_16x16x32_bf16 v[116:119], a[40:43], a[132:135], v[116:119]
  ds_read_b64_tr_b16 a[12:13], v237 offset:8192
  v_mov_b32_e64 v34, s67
  v_mfma_f32_16x16x32_bf16 v[116:119], a[44:47], a[148:151], v[116:119]
  v_mfma_f32_16x16x32_bf16 v[84:87], a[44:47], a[144:147], v[84:87]
  ds_read_b64_tr_b16 a[14:15], v237 offset:12288
  s_lshl_b32 s29, s25, 2
  v_mfma_f32_16x16x32_bf16 v[84:87], a[40:43], a[128:131], v[84:87]
  s_waitcnt lgkmcnt(8)
  v_mfma_f32_16x16x32_bf16 v[88:91], a[48:51], a[128:131], v[88:91]
  ds_read_b64_tr_b16 a[16:17], v238 offset:0
  s_add_u32 s29, s29, s20
  v_mfma_f32_16x16x32_bf16 v[88:91], a[52:55], a[144:147], v[88:91]
  s_lshl_b32 s29, s29, 16
  buffer_load_dwordx4 a[120:123], v7, s[4:7], s30 offen offset:1024 sc1
  v_mfma_f32_16x16x32_bf16 v[120:123], a[52:55], a[148:151], v[120:123]
  ds_read_b64_tr_b16 a[18:19], v238 offset:4096
  v_mfma_f32_16x16x32_bf16 v[120:123], a[48:51], a[132:135], v[120:123]
  s_lshl_b32 s39, s26, 8
  v_mfma_f32_16x16x32_bf16 v[152:155], a[48:51], a[136:139], v[152:155]
  ds_read_b64_tr_b16 a[20:21], v238 offset:8192
  s_add_u32 s30, s81, 188928
  v_mfma_f32_16x16x32_bf16 v[152:155], a[52:55], a[152:155], v[152:155]
  s_add_u32 s29, s29, s39
  buffer_load_dwordx4 a[100:103], v16, s[4:7], s30 offen offset:0 sc1
  v_mfma_f32_16x16x32_bf16 v[184:187], a[52:55], a[156:159], v[184:187]
  ds_read_b64_tr_b16 a[22:23], v238 offset:12288
  v_mfma_f32_16x16x32_bf16 v[184:187], a[48:51], a[140:143], v[184:187]
  v_lshrrev_b32 v10, 3, v2
  v_mfma_f32_16x16x32_bf16 v[188:191], a[56:59], a[140:143], v[188:191]
  ds_read_b64_tr_b16 a[24:25], v239 offset:0
  v_and_b32 v11, 7, v2
  v_mfma_f32_16x16x32_bf16 v[188:191], a[60:63], a[156:159], v[188:191]
  buffer_load_dwordx4 a[116:119], v16, s[4:7], s30 offen offset:1024 sc1
  v_mfma_f32_16x16x32_bf16 v[156:159], a[60:63], a[152:155], v[156:159]
  ds_read_b64_tr_b16 a[26:27], v239 offset:4096
  v_lshl_add_u32 v21, v10, 11, s29
  v_mfma_f32_16x16x32_bf16 v[156:159], a[56:59], a[136:139], v[156:159]
  v_mfma_f32_16x16x32_bf16 v[124:127], a[56:59], a[132:135], v[124:127]
  ds_read_b64_tr_b16 a[28:29], v239 offset:8192
  v_lshl_add_u32 v21, v11, 4, v21
  v_mfma_f32_16x16x32_bf16 v[124:127], a[60:63], a[148:151], v[124:127]
  v_mfma_f32_16x16x32_bf16 v[92:95], a[60:63], a[144:147], v[92:95]
  ds_read_b64_tr_b16 a[30:31], v239 offset:12288
  v_mfma_f32_16x16x32_bf16 v[92:95], a[56:59], a[128:131], v[92:95]
  s_waitcnt vmcnt(14) lgkmcnt(8)
  v_mfma_f32_16x16x32_bf16 v[64:67], a[0:3], a[160:163], v[64:67]
  ds_read_b64_tr_b16 a[32:33], v236 offset:1024
  v_mfma_f32_16x16x32_bf16 v[64:67], a[4:7], a[176:179], v[64:67]
  buffer_load_dwordx4 a[108:111], v7, s[4:7], s30 offen offset:0 sc1
  v_mfma_f32_16x16x32_bf16 v[96:99], a[4:7], a[180:183], v[96:99]
  ds_read_b64_tr_b16 a[34:35], v236 offset:5120
  v_mfma_f32_16x16x32_bf16 v[96:99], a[0:3], a[164:167], v[96:99]
  v_mfma_f32_16x16x32_bf16 v[128:131], a[0:3], a[168:171], v[128:131]
  ds_read_b64_tr_b16 a[36:37], v236 offset:9216
  v_mfma_f32_16x16x32_bf16 v[128:131], a[4:7], a[184:187], v[128:131]
  buffer_load_dwordx4 a[124:127], v7, s[4:7], s30 offen offset:1024 sc1
  v_mfma_f32_16x16x32_bf16 v[160:163], a[4:7], a[188:191], v[160:163]
  ds_read_b64_tr_b16 a[38:39], v236 offset:13312
  v_mfma_f32_16x16x32_bf16 v[160:163], a[0:3], a[172:175], v[160:163]
  v_mfma_f32_16x16x32_bf16 v[164:167], a[8:11], a[172:175], v[164:167]
  ds_read_b64_tr_b16 a[40:41], v237 offset:1024
  s_add_u32 s30, s80, 47104
  v_mfma_f32_16x16x32_bf16 v[164:167], a[12:15], a[188:191], v[164:167]
  buffer_load_dwordx4 a[128:131], v16, s[4:7], s30 offen offset:0 sc1
  v_mfma_f32_16x16x32_bf16 v[132:135], a[12:15], a[184:187], v[132:135]
  ds_read_b64_tr_b16 a[42:43], v237 offset:5120
  v_mfma_f32_16x16x32_bf16 v[132:135], a[8:11], a[168:171], v[132:135]
  v_mfma_f32_16x16x32_bf16 v[100:103], a[8:11], a[164:167], v[100:103]
  ds_read_b64_tr_b16 a[44:45], v237 offset:9216
  v_mfma_f32_16x16x32_bf16 v[100:103], a[12:15], a[180:183], v[100:103]
  v_mfma_f32_16x16x32_bf16 v[68:71], a[12:15], a[176:179], v[68:71]
  ds_read_b64_tr_b16 a[46:47], v237 offset:13312
  v_mfma_f32_16x16x32_bf16 v[68:71], a[8:11], a[160:163], v[68:71]
  s_waitcnt lgkmcnt(8)
  v_mfma_f32_16x16x32_bf16 v[72:75], a[16:19], a[160:163], v[72:75]
  ds_read_b64_tr_b16 a[48:49], v238 offset:1024
  v_mfma_f32_16x16x32_bf16 v[72:75], a[20:23], a[176:179], v[72:75]
  buffer_load_dwordx4 a[144:147], v16, s[4:7], s30 offen offset:1024 sc1
  v_mfma_f32_16x16x32_bf16 v[104:107], a[20:23], a[180:183], v[104:107]
  ds_read_b64_tr_b16 a[50:51], v238 offset:5120
  v_mfma_f32_16x16x32_bf16 v[104:107], a[16:19], a[164:167], v[104:107]
  v_mfma_f32_16x16x32_bf16 v[136:139], a[16:19], a[168:171], v[136:139]
  ds_read_b64_tr_b16 a[52:53], v238 offset:9216
  v_mfma_f32_16x16x32_bf16 v[136:139], a[20:23], a[184:187], v[136:139]
  buffer_load_dwordx4 a[136:139], v7, s[4:7], s30 offen offset:0 sc1
  v_mfma_f32_16x16x32_bf16 v[168:171], a[20:23], a[188:191], v[168:171]
  ds_read_b64_tr_b16 a[54:55], v238 offset:13312
  v_mfma_f32_16x16x32_bf16 v[168:171], a[16:19], a[172:175], v[168:171]
  v_mfma_f32_16x16x32_bf16 v[172:175], a[24:27], a[172:175], v[172:175]
  ds_read_b64_tr_b16 a[56:57], v239 offset:1024
  v_mfma_f32_16x16x32_bf16 v[172:175], a[28:31], a[188:191], v[172:175]
  buffer_load_dwordx4 a[152:155], v7, s[4:7], s30 offen offset:1024 sc1
  v_mfma_f32_16x16x32_bf16 v[140:143], a[28:31], a[184:187], v[140:143]
  ds_read_b64_tr_b16 a[58:59], v239 offset:5120
  v_mfma_f32_16x16x32_bf16 v[140:143], a[24:27], a[168:171], v[140:143]
  v_mfma_f32_16x16x32_bf16 v[108:111], a[24:27], a[164:167], v[108:111]
  ds_read_b64_tr_b16 a[60:61], v239 offset:9216
  v_mfma_f32_16x16x32_bf16 v[108:111], a[28:31], a[180:183], v[108:111]
  v_mfma_f32_16x16x32_bf16 v[76:79], a[28:31], a[176:179], v[76:79]
  ds_read_b64_tr_b16 a[62:63], v239 offset:13312
  v_mfma_f32_16x16x32_bf16 v[76:79], a[24:27], a[160:163], v[76:79]
  s_waitcnt lgkmcnt(8)
  v_mfma_f32_16x16x32_bf16 v[80:83], a[32:35], a[160:163], v[80:83]
  ds_read_b64_tr_b16 a[0:1], v236 offset:16384
  s_add_u32 s30, s80, 195072
  v_mfma_f32_16x16x32_bf16 v[80:83], a[36:39], a[176:179], v[80:83]
  buffer_load_dwordx4 a[132:135], v16, s[4:7], s30 offen offset:0 sc1
  v_mfma_f32_16x16x32_bf16 v[112:115], a[36:39], a[180:183], v[112:115]
  ds_read_b64_tr_b16 a[2:3], v236 offset:20480
  v_mfma_f32_16x16x32_bf16 v[112:115], a[32:35], a[164:167], v[112:115]
  v_mfma_f32_16x16x32_bf16 v[144:147], a[32:35], a[168:171], v[144:147]
  ds_read_b64_tr_b16 a[4:5], v236 offset:24576
  v_and_b32 v27, 4294966527, v20
  v_mfma_f32_16x16x32_bf16 v[144:147], a[36:39], a[184:187], v[144:147]
  buffer_load_dwordx4 a[148:151], v16, s[4:7], s30 offen offset:1024 sc1
  v_mfma_f32_16x16x32_bf16 v[176:179], a[36:39], a[188:191], v[176:179]
  ds_read_b64_tr_b16 a[6:7], v236 offset:28672
  v_mfma_f32_16x16x32_bf16 v[176:179], a[32:35], a[172:175], v[176:179]
  v_lshl_add_u32 v27, v3, 8, v27
  v_mfma_f32_16x16x32_bf16 v[180:183], a[40:43], a[172:175], v[180:183]
  ds_read_b64_tr_b16 a[8:9], v237 offset:16384
  v_mfma_f32_16x16x32_bf16 v[180:183], a[44:47], a[188:191], v[180:183]
  buffer_load_dwordx4 a[140:143], v7, s[4:7], s30 offen offset:0 sc1
  v_mfma_f32_16x16x32_bf16 v[148:151], a[44:47], a[184:187], v[148:151]
  ds_read_b64_tr_b16 a[10:11], v237 offset:20480
  v_mfma_f32_16x16x32_bf16 v[148:151], a[40:43], a[168:171], v[148:151]
  v_mfma_f32_16x16x32_bf16 v[116:119], a[40:43], a[164:167], v[116:119]
  ds_read_b64_tr_b16 a[12:13], v237 offset:24576
  v_mfma_f32_16x16x32_bf16 v[116:119], a[44:47], a[180:183], v[116:119]
  v_mfma_f32_16x16x32_bf16 v[84:87], a[44:47], a[176:179], v[84:87]
  ds_read_b64_tr_b16 a[14:15], v237 offset:28672
  v_mfma_f32_16x16x32_bf16 v[84:87], a[40:43], a[160:163], v[84:87]
  s_waitcnt lgkmcnt(8)
  v_mfma_f32_16x16x32_bf16 v[88:91], a[48:51], a[160:163], v[88:91]
  ds_read_b64_tr_b16 a[16:17], v238 offset:16384
  v_mfma_f32_16x16x32_bf16 v[88:91], a[52:55], a[176:179], v[88:91]
  buffer_load_dwordx4 a[156:159], v7, s[4:7], s30 offen offset:1024 sc1
  v_mfma_f32_16x16x32_bf16 v[120:123], a[52:55], a[180:183], v[120:123]
  ds_read_b64_tr_b16 a[18:19], v238 offset:20480
  v_mfma_f32_16x16x32_bf16 v[120:123], a[48:51], a[164:167], v[120:123]
  v_mfma_f32_16x16x32_bf16 v[152:155], a[48:51], a[168:171], v[152:155]
  ds_read_b64_tr_b16 a[20:21], v238 offset:24576
  s_add_u32 m0, s98, 65536
  s_add_u32 s31, s69, 1310720
  v_mfma_f32_16x16x32_bf16 v[152:155], a[52:55], a[184:187], v[152:155]
  buffer_load_dwordx4 v19, s[44:47], s31 offen offset:0 lds
  v_mfma_f32_16x16x32_bf16 v[184:187], a[52:55], a[188:191], v[184:187]
  ds_read_b64_tr_b16 a[22:23], v238 offset:28672
  v_mfma_f32_16x16x32_bf16 v[184:187], a[48:51], a[172:175], v[184:187]
  v_mfma_f32_16x16x32_bf16 v[188:191], a[56:59], a[172:175], v[188:191]
  ds_read_b64_tr_b16 a[24:25], v239 offset:16384
  s_add_u32 m0, s98, 66432
  v_mfma_f32_16x16x32_bf16 v[188:191], a[60:63], a[188:191], v[188:191]
  buffer_load_dwordx4 v19, s[44:47], s31 offen offset:128 lds
  v_mfma_f32_16x16x32_bf16 v[156:159], a[60:63], a[184:187], v[156:159]
  ds_read_b64_tr_b16 a[26:27], v239 offset:20480
  v_mfma_f32_16x16x32_bf16 v[156:159], a[56:59], a[168:171], v[156:159]
  v_mfma_f32_16x16x32_bf16 v[124:127], a[56:59], a[164:167], v[124:127]
  ds_read_b64_tr_b16 a[28:29], v239 offset:24576
  v_mfma_f32_16x16x32_bf16 v[124:127], a[60:63], a[180:183], v[124:127]
  v_mfma_f32_16x16x32_bf16 v[92:95], a[60:63], a[176:179], v[92:95]
  ds_read_b64_tr_b16 a[30:31], v239 offset:28672
  v_mfma_f32_16x16x32_bf16 v[92:95], a[56:59], a[160:163], v[92:95]
  s_waitcnt vmcnt(18) lgkmcnt(8)
  v_mfma_f32_16x16x32_bf16 v[64:67], a[0:3], a[64:67], v[64:67]
  ds_read_b64_tr_b16 a[32:33], v236 offset:17408
  s_add_u32 m0, s98, 67584
  s_add_u32 s31, s69, 1327104
  v_mfma_f32_16x16x32_bf16 v[64:67], a[4:7], a[80:83], v[64:67]
  buffer_load_dwordx4 v19, s[44:47], s31 offen offset:0 lds
  v_mfma_f32_16x16x32_bf16 v[96:99], a[4:7], a[84:87], v[96:99]
  ds_read_b64_tr_b16 a[34:35], v236 offset:21504
  v_mfma_f32_16x16x32_bf16 v[96:99], a[0:3], a[68:71], v[96:99]
  v_mfma_f32_16x16x32_bf16 v[128:131], a[0:3], a[72:75], v[128:131]
  ds_read_b64_tr_b16 a[36:37], v236 offset:25600
  s_add_u32 m0, s98, 68480
  v_mfma_f32_16x16x32_bf16 v[128:131], a[4:7], a[88:91], v[128:131]
  buffer_load_dwordx4 v19, s[44:47], s31 offen offset:128 lds
  v_mfma_f32_16x16x32_bf16 v[160:163], a[4:7], a[92:95], v[160:163]
  ds_read_b64_tr_b16 a[38:39], v236 offset:29696
  v_mfma_f32_16x16x32_bf16 v[160:163], a[0:3], a[76:79], v[160:163]
  v_mfma_f32_16x16x32_bf16 v[164:167], a[8:11], a[76:79], v[164:167]
  ds_read_b64_tr_b16 a[40:41], v237 offset:17408
  s_add_u32 m0, s98, 81920
  s_add_u32 s31, s68, 262144
  v_mfma_f32_16x16x32_bf16 v[164:167], a[12:15], a[92:95], v[164:167]
  buffer_load_dwordx4 v19, s[44:47], s31 offen offset:0 lds
  v_mfma_f32_16x16x32_bf16 v[132:135], a[12:15], a[88:91], v[132:135]
  ds_read_b64_tr_b16 a[42:43], v237 offset:21504
  v_mfma_f32_16x16x32_bf16 v[132:135], a[8:11], a[72:75], v[132:135]
  v_mfma_f32_16x16x32_bf16 v[100:103], a[8:11], a[68:71], v[100:103]
  ds_read_b64_tr_b16 a[44:45], v237 offset:25600
  v_mfma_f32_16x16x32_bf16 v[100:103], a[12:15], a[84:87], v[100:103]
  v_mfma_f32_16x16x32_bf16 v[68:71], a[12:15], a[80:83], v[68:71]
  ds_read_b64_tr_b16 a[46:47], v237 offset:29696
  v_mfma_f32_16x16x32_bf16 v[68:71], a[8:11], a[64:67], v[68:71]
  s_waitcnt lgkmcnt(8)
  v_mfma_f32_16x16x32_bf16 v[72:75], a[16:19], a[64:67], v[72:75]
  ds_read_b64_tr_b16 a[48:49], v238 offset:17408
  s_add_u32 m0, s98, 82816
  v_mfma_f32_16x16x32_bf16 v[72:75], a[20:23], a[80:83], v[72:75]
  buffer_load_dwordx4 v19, s[44:47], s31 offen offset:128 lds
  v_mfma_f32_16x16x32_bf16 v[104:107], a[20:23], a[84:87], v[104:107]
  ds_read_b64_tr_b16 a[50:51], v238 offset:21504
  v_mfma_f32_16x16x32_bf16 v[104:107], a[16:19], a[68:71], v[104:107]
  v_mfma_f32_16x16x32_bf16 v[136:139], a[16:19], a[72:75], v[136:139]
  ds_read_b64_tr_b16 a[52:53], v238 offset:25600
  s_add_u32 m0, s98, 83968
  s_add_u32 s31, s68, 278528
  v_mfma_f32_16x16x32_bf16 v[136:139], a[20:23], a[88:91], v[136:139]
  buffer_load_dwordx4 v19, s[44:47], s31 offen offset:0 lds
  v_mfma_f32_16x16x32_bf16 v[168:171], a[20:23], a[92:95], v[168:171]
  ds_read_b64_tr_b16 a[54:55], v238 offset:29696
  v_mfma_f32_16x16x32_bf16 v[168:171], a[16:19], a[76:79], v[168:171]
  v_mfma_f32_16x16x32_bf16 v[172:175], a[24:27], a[76:79], v[172:175]
  ds_read_b64_tr_b16 a[56:57], v239 offset:17408
  s_add_u32 m0, s98, 84864
  v_mfma_f32_16x16x32_bf16 v[172:175], a[28:31], a[92:95], v[172:175]
  buffer_load_dwordx4 v19, s[44:47], s31 offen offset:128 lds
  v_mfma_f32_16x16x32_bf16 v[140:143], a[28:31], a[88:91], v[140:143]
  ds_read_b64_tr_b16 a[58:59], v239 offset:21504
  v_mfma_f32_16x16x32_bf16 v[140:143], a[24:27], a[72:75], v[140:143]
  v_mfma_f32_16x16x32_bf16 v[108:111], a[24:27], a[68:71], v[108:111]
  ds_read_b64_tr_b16 a[60:61], v239 offset:25600
  v_mfma_f32_16x16x32_bf16 v[108:111], a[28:31], a[84:87], v[108:111]
  v_mfma_f32_16x16x32_bf16 v[76:79], a[28:31], a[80:83], v[76:79]
  ds_read_b64_tr_b16 a[62:63], v239 offset:29696
  v_mfma_f32_16x16x32_bf16 v[76:79], a[24:27], a[64:67], v[76:79]
  s_waitcnt lgkmcnt(8)
  s_barrier
  v_mfma_f32_16x16x32_bf16 v[80:83], a[32:35], a[64:67], v[80:83]
  ds_read_b64_tr_b16 a[0:1], v236 offset:32768
  buffer_load_dword v33, v20, s[16:19], s28 offen sc1
  s_add_u32 s30, s81, 53248
  v_mfma_f32_16x16x32_bf16 v[80:83], a[36:39], a[80:83], v[80:83]
  buffer_load_dwordx4 a[160:163], v16, s[4:7], s30 offen offset:0 sc1
  v_mfma_f32_16x16x32_bf16 v[112:115], a[36:39], a[84:87], v[112:115]
  ds_read_b64_tr_b16 a[2:3], v236 offset:36864
  v_mfma_f32_16x16x32_bf16 v[112:115], a[32:35], a[68:71], v[112:115]
  v_mfma_f32_16x16x32_bf16 v[144:147], a[32:35], a[72:75], v[144:147]
  ds_read_b64_tr_b16 a[4:5], v236 offset:40960
  v_mfma_f32_16x16x32_bf16 v[144:147], a[36:39], a[88:91], v[144:147]
  buffer_load_dwordx4 a[176:179], v16, s[4:7], s30 offen offset:1024 sc1
  v_mfma_f32_16x16x32_bf16 v[176:179], a[36:39], a[92:95], v[176:179]
  ds_read_b64_tr_b16 a[6:7], v236 offset:45056
  v_mfma_f32_16x16x32_bf16 v[176:179], a[32:35], a[76:79], v[176:179]
  v_mfma_f32_16x16x32_bf16 v[180:183], a[40:43], a[76:79], v[180:183]
  ds_read_b64_tr_b16 a[8:9], v237 offset:32768
  v_mfma_f32_16x16x32_bf16 v[180:183], a[44:47], a[92:95], v[180:183]
  buffer_load_dwordx4 a[168:171], v7, s[4:7], s30 offen offset:0 sc1
  v_mfma_f32_16x16x32_bf16 v[148:151], a[44:47], a[88:91], v[148:151]
  ds_read_b64_tr_b16 a[10:11], v237 offset:36864
  v_mfma_f32_16x16x32_bf16 v[148:151], a[40:43], a[72:75], v[148:151]
  v_mfma_f32_16x16x32_bf16 v[116:119], a[40:43], a[68:71], v[116:119]
  ds_read_b64_tr_b16 a[12:13], v237 offset:40960
  v_mfma_f32_16x16x32_bf16 v[116:119], a[44:47], a[84:87], v[116:119]
  v_mfma_f32_16x16x32_bf16 v[84:87], a[44:47], a[80:83], v[84:87]
  ds_read_b64_tr_b16 a[14:15], v237 offset:45056
  v_mfma_f32_16x16x32_bf16 v[84:87], a[40:43], a[64:67], v[84:87]
  s_waitcnt lgkmcnt(8)
  v_mfma_f32_16x16x32_bf16 v[88:91], a[48:51], a[64:67], v[88:91]
  ds_read_b64_tr_b16 a[16:17], v238 offset:32768
  v_mfma_f32_16x16x32_bf16 v[88:91], a[52:55], a[80:83], v[88:91]
  buffer_load_dwordx4 a[184:187], v7, s[4:7], s30 offen offset:1024 sc1
  v_mfma_f32_16x16x32_bf16 v[120:123], a[52:55], a[84:87], v[120:123]
  ds_read_b64_tr_b16 a[18:19], v238 offset:36864
  v_mfma_f32_16x16x32_bf16 v[120:123], a[48:51], a[68:71], v[120:123]
  v_mfma_f32_16x16x32_bf16 v[152:155], a[48:51], a[72:75], v[152:155]
  ds_read_b64_tr_b16 a[20:21], v238 offset:40960
  s_add_u32 s30, s81, 201216
  v_mfma_f32_16x16x32_bf16 v[152:155], a[52:55], a[88:91], v[152:155]
  buffer_load_dwordx4 a[164:167], v16, s[4:7], s30 offen offset:0 sc1
  v_mfma_f32_16x16x32_bf16 v[184:187], a[52:55], a[92:95], v[184:187]
  ds_read_b64_tr_b16 a[22:23], v238 offset:45056
  v_mfma_f32_16x16x32_bf16 v[184:187], a[48:51], a[76:79], v[184:187]
  v_mfma_f32_16x16x32_bf16 v[188:191], a[56:59], a[76:79], v[188:191]
  ds_read_b64_tr_b16 a[24:25], v239 offset:32768
  v_mfma_f32_16x16x32_bf16 v[188:191], a[60:63], a[92:95], v[188:191]
  buffer_load_dwordx4 a[180:183], v16, s[4:7], s30 offen offset:1024 sc1
  v_mfma_f32_16x16x32_bf16 v[156:159], a[60:63], a[88:91], v[156:159]
  ds_read_b64_tr_b16 a[26:27], v239 offset:36864
  v_mfma_f32_16x16x32_bf16 v[156:159], a[56:59], a[72:75], v[156:159]
  v_mfma_f32_16x16x32_bf16 v[124:127], a[56:59], a[68:71], v[124:127]
  ds_read_b64_tr_b16 a[28:29], v239 offset:40960
  v_mfma_f32_16x16x32_bf16 v[124:127], a[60:63], a[84:87], v[124:127]
  v_mfma_f32_16x16x32_bf16 v[92:95], a[60:63], a[80:83], v[92:95]
  ds_read_b64_tr_b16 a[30:31], v239 offset:45056
  v_mfma_f32_16x16x32_bf16 v[92:95], a[56:59], a[64:67], v[92:95]
  s_waitcnt vmcnt(23) lgkmcnt(8)
  v_mfma_f32_16x16x32_bf16 v[64:67], a[0:3], a[96:99], v[64:67]
  ds_read_b64_tr_b16 a[32:33], v236 offset:33792
  v_mfma_f32_16x16x32_bf16 v[64:67], a[4:7], a[112:115], v[64:67]
  buffer_load_dwordx4 a[172:175], v7, s[4:7], s30 offen offset:0 sc1
  v_mfma_f32_16x16x32_bf16 v[96:99], a[4:7], a[116:119], v[96:99]
  ds_read_b64_tr_b16 a[34:35], v236 offset:37888
  v_mfma_f32_16x16x32_bf16 v[96:99], a[0:3], a[100:103], v[96:99]
  v_mfma_f32_16x16x32_bf16 v[128:131], a[0:3], a[104:107], v[128:131]
  ds_read_b64_tr_b16 a[36:37], v236 offset:41984
  v_mfma_f32_16x16x32_bf16 v[128:131], a[4:7], a[120:123], v[128:131]
  buffer_load_dwordx4 a[188:191], v7, s[4:7], s30 offen offset:1024 sc1
  v_mfma_f32_16x16x32_bf16 v[160:163], a[4:7], a[124:127], v[160:163]
  ds_read_b64_tr_b16 a[38:39], v236 offset:46080
  v_mfma_f32_16x16x32_bf16 v[160:163], a[0:3], a[108:111], v[160:163]
  v_mfma_f32_16x16x32_bf16 v[164:167], a[8:11], a[108:111], v[164:167]
  ds_read_b64_tr_b16 a[40:41], v237 offset:33792
  s_add_u32 m0, s98, 98304
  s_add_u32 s31, s69, 655360
  v_mfma_f32_16x16x32_bf16 v[164:167], a[12:15], a[124:127], v[164:167]
  buffer_load_dwordx4 v19, s[44:47], s31 offen offset:0 lds
  v_mfma_f32_16x16x32_bf16 v[132:135], a[12:15], a[120:123], v[132:135]
  ds_read_b64_tr_b16 a[42:43], v237 offset:37888
  v_mfma_f32_16x16x32_bf16 v[132:135], a[8:11], a[104:107], v[132:135]
  v_mfma_f32_16x16x32_bf16 v[100:103], a[8:11], a[100:103], v[100:103]
  ds_read_b64_tr_b16 a[44:45], v237 offset:41984
  v_mfma_f32_16x16x32_bf16 v[100:103], a[12:15], a[116:119], v[100:103]
  v_mfma_f32_16x16x32_bf16 v[68:71], a[12:15], a[112:115], v[68:71]
  ds_read_b64_tr_b16 a[46:47], v237 offset:46080
  v_mfma_f32_16x16x32_bf16 v[68:71], a[8:11], a[96:99], v[68:71]
  s_waitcnt lgkmcnt(8)
  v_mfma_f32_16x16x32_bf16 v[72:75], a[16:19], a[96:99], v[72:75]
  ds_read_b64_tr_b16 a[48:49], v238 offset:33792
  s_add_u32 m0, s98, 99200
  v_mfma_f32_16x16x32_bf16 v[72:75], a[20:23], a[112:115], v[72:75]
  buffer_load_dwordx4 v19, s[44:47], s31 offen offset:128 lds
  v_mfma_f32_16x16x32_bf16 v[104:107], a[20:23], a[116:119], v[104:107]
  ds_read_b64_tr_b16 a[50:51], v238 offset:37888
  v_mfma_f32_16x16x32_bf16 v[104:107], a[16:19], a[100:103], v[104:107]
  v_mfma_f32_16x16x32_bf16 v[136:139], a[16:19], a[104:107], v[136:139]
  ds_read_b64_tr_b16 a[52:53], v238 offset:41984
  s_add_u32 m0, s98, 100352
  s_add_u32 s31, s69, 671744
  v_mfma_f32_16x16x32_bf16 v[136:139], a[20:23], a[120:123], v[136:139]
  buffer_load_dwordx4 v19, s[44:47], s31 offen offset:0 lds
  v_mfma_f32_16x16x32_bf16 v[168:171], a[20:23], a[124:127], v[168:171]
  ds_read_b64_tr_b16 a[54:55], v238 offset:46080
  v_mfma_f32_16x16x32_bf16 v[168:171], a[16:19], a[108:111], v[168:171]
  v_mfma_f32_16x16x32_bf16 v[172:175], a[24:27], a[108:111], v[172:175]
  ds_read_b64_tr_b16 a[56:57], v239 offset:33792
  s_add_u32 m0, s98, 101248
  v_mfma_f32_16x16x32_bf16 v[172:175], a[28:31], a[124:127], v[172:175]
  buffer_load_dwordx4 v19, s[44:47], s31 offen offset:128 lds
  v_mfma_f32_16x16x32_bf16 v[140:143], a[28:31], a[120:123], v[140:143]
  ds_read_b64_tr_b16 a[58:59], v239 offset:37888
  v_mfma_f32_16x16x32_bf16 v[140:143], a[24:27], a[104:107], v[140:143]
  v_mfma_f32_16x16x32_bf16 v[108:111], a[24:27], a[100:103], v[108:111]
  ds_read_b64_tr_b16 a[60:61], v239 offset:41984
  v_mfma_f32_16x16x32_bf16 v[108:111], a[28:31], a[116:119], v[108:111]
  v_mfma_f32_16x16x32_bf16 v[76:79], a[28:31], a[112:115], v[76:79]
  ds_read_b64_tr_b16 a[62:63], v239 offset:46080
  v_mfma_f32_16x16x32_bf16 v[76:79], a[24:27], a[96:99], v[76:79]
  s_waitcnt vmcnt(12) lgkmcnt(8)
  v_mfma_f32_16x16x32_bf16 v[80:83], a[32:35], a[96:99], v[80:83]
  ds_read_b64_tr_b16 a[0:1], v236 offset:49152
  v_cmp_eq_u32 vcc, 0, v33
  s_cbranch_vccnz La_g3_slow
La_g3_back:
  s_add_u32 s30, s80, 36864
  v_mfma_f32_16x16x32_bf16 v[80:83], a[36:39], a[112:115], v[80:83]
  buffer_load_dwordx4 a[64:67], v16, s[4:7], s30 offen offset:0 sc1
  v_mfma_f32_16x16x32_bf16 v[112:115], a[36:39], a[116:119], v[112:115]
  ds_read_b64_tr_b16 a[2:3], v236 offset:53248
  v_and_b32_e64 v22, 1, v4
  v_mfma_f32_16x16x32_bf16 v[112:115], a[32:35], a[100:103], v[112:115]
  v_mfma_f32_16x16x32_bf16 v[144:147], a[32:35], a[104:107], v[144:147]
  ds_read_b64_tr_b16 a[4:5], v236 offset:57344
  v_lshlrev_b32_e64 v22, 4, v22
  v_mfma_f32_16x16x32_bf16 v[144:147], a[36:39], a[120:123], v[144:147]
  buffer_load_dwordx4 a[80:83], v16, s[4:7], s30 offen offset:1024 sc1
  v_mfma_f32_16x16x32_bf16 v[176:179], a[36:39], a[124:127], v[176:179]
  ds_read_b64_tr_b16 a[6:7], v236 offset:61440
  v_mov_b32 v23, 0x3f80
La_pad10:
  s_cbranch_execz La_ret1
  s_nop 0
  v_mfma_f32_16x16x32_bf16 v[176:179], a[32:35], a[108:111], v[176:179]
  v_mfma_f32_16x16x32_bf16 v[180:183], a[40:43], a[108:111], v[180:183]
  ds_read_b64_tr_b16 a[8:9], v237 offset:49152
  v_lshlrev_b32_e64 v22, v22, v23
  v_mfma_f32_16x16x32_bf16 v[180:183], a[44:47], a[124:127], v[180:183]
  buffer_load_dwordx4 a[72:75], v7, s[4:7], s30 offen offset:0 sc1
  v_mfma_f32_16x16x32_bf16 v[148:151], a[44:47], a[120:123], v[148:151]
  ds_read_b64_tr_b16 a[10:11], v237 offset:53248
  v_lshrrev_b32_e64 v23, 1, v4
  v_mfma_f32_16x16x32_bf16 v[148:151], a[40:43], a[104:107], v[148:151]
  v_mfma_f32_16x16x32_bf16 v[116:119], a[40:43], a[100:103], v[116:119]
  ds_read_b64_tr_b16 a[12:13], v237 offset:57344
  v_lshlrev_b32_e64 v24, 1, v3
  v_mfma_f32_16x16x32_bf16 v[116:119], a[44:47], a[116:119], v[116:119]
  v_mfma_f32_16x16x32_bf16 v[84:87], a[44:47], a[112:115], v[84:87]
  ds_read_b64_tr_b16 a[14:15], v237 offset:61440
  v_sub_u32 v23, v23, v24
  v_mfma_f32_16x16x32_bf16 v[84:87], a[40:43], a[96:99], v[84:87]
  s_waitcnt lgkmcnt(8)
  v_mfma_f32_16x16x32_bf16 v[88:91], a[48:51], a[96:99], v[88:91]
  ds_read_b64_tr_b16 a[16:17], v238 offset:49152
  v_cmp_eq_u32_e64 vcc, 0, v23
  v_mfma_f32_16x16x32_bf16 v[88:91], a[52:55], a[112:115], v[88:91]
  buffer_load_dwordx4 a[88:91], v7, s[4:7], s30 offen offset:1024 sc1
  v_mfma_f32_16x16x32_bf16 v[120:123], a[52:55], a[116:119], v[120:123]
  ds_read_b64_tr_b16 a[18:19], v238 offset:53248
  v_mov_b32_e64 v192, 0
  v_mfma_f32_16x16x32_bf16 v[120:123], a[48:51], a[100:103], v[120:123]
  v_mfma_f32_16x16x32_bf16 v[152:155], a[48:51], a[104:107], v[152:155]
  ds_read_b64_tr_b16 a[20:21], v238 offset:57344
  v_cndmask_b32_e64 v194, 0, v22, vcc
  s_add_u32 s30, s80, 184832
  v_mfma_f32_16x16x32_bf16 v[152:155], a[52:55], a[120:123], v[152:155]
  buffer_load_dwordx4 a[68:71], v16, s[4:7], s30 offen offset:0 sc1
  v_mfma_f32_16x16x32_bf16 v[184:187], a[52:55], a[124:127], v[184:187]
  ds_read_b64_tr_b16 a[22:23], v238 offset:61440
  v_cmp_eq_u32_e64 vcc, 1, v23
  v_mfma_f32_16x16x32_bf16 v[184:187], a[48:51], a[108:111], v[184:187]
  v_mfma_f32_16x16x32_bf16 v[188:191], a[56:59], a[108:111], v[188:191]
  ds_read_b64_tr_b16 a[24:25], v239 offset:49152
  v_mov_b32_e64 v193, 0
  v_mfma_f32_16x16x32_bf16 v[188:191], a[60:63], a[124:127], v[188:191]
  buffer_load_dwordx4 a[84:87], v16, s[4:7], s30 offen offset:1024 sc1
  v_mfma_f32_16x16x32_bf16 v[156:159], a[60:63], a[120:123], v[156:159]
  ds_read_b64_tr_b16 a[26:27], v239 offset:53248
  v_cndmask_b32_e64 v195, 0, v22, vcc
  v_mfma_f32_16x16x32_bf16 v[156:159], a[56:59], a[104:107], v[156:159]
  v_mfma_f32_16x16x32_bf16 v[124:127], a[56:59], a[100:103], v[124:127]
  ds_read_b64_tr_b16 a[28:29], v239 offset:57344
  v_mov_b32_e64 v196, 0
  v_mfma_f32_16x16x32_bf16 v[124:127], a[60:63], a[116:119], v[124:127]
  v_mfma_f32_16x16x32_bf16 v[92:95], a[60:63], a[112:115], v[92:95]
  ds_read_b64_tr_b16 a[30:31], v239 offset:61440
  v_mov_b32 v197, 0
  v_mfma_f32_16x16x32_bf16 v[92:95], a[56:59], a[96:99], v[92:95]
  s_waitcnt lgkmcnt(8)
  v_mfma_f32_16x16x32_bf16 v[64:67], a[0:3], a[128:131], v[64:67]
  ds_read_b64_tr_b16 a[32:33], v236 offset:50176
  v_mfma_f32_16x16x32_bf16 v[64:67], a[4:7], a[144:147], v[64:67]
  buffer_load_dwordx4 a[76:79], v7, s[4:7], s30 offen offset:0 sc1
  v_mfma_f32_16x16x32_bf16 v[96:99], a[4:7], a[148:151], v[96:99]
  ds_read_b64_tr_b16 a[34:35], v236 offset:54272
  v_mfma_f32_16x16x32_bf16 v[96:99], a[0:3], a[132:135], v[96:99]
  v_mfma_f32_16x16x32_bf16 v[128:131], a[0:3], a[136:139], v[128:131]
  ds_read_b64_tr_b16 a[36:37], v236 offset:58368
  v_mfma_f32_16x16x32_bf16 v[128:131], a[4:7], a[152:155], v[128:131]
  buffer_load_dwordx4 a[92:95], v7, s[4:7], s30 offen offset:1024 sc1
  v_mfma_f32_16x16x32_bf16 v[160:163], a[4:7], a[156:159], v[160:163]
  ds_read_b64_tr_b16 a[38:39], v236 offset:62464
  v_mfma_f32_16x16x32_bf16 v[160:163], a[0:3], a[140:143], v[160:163]
  v_mfma_f32_16x16x32_bf16 v[164:167], a[8:11], a[140:143], v[164:167]
  ds_read_b64_tr_b16 a[40:41], v237 offset:50176
  s_add_u32 m0, s98, 114688
  s_add_u32 s31, s68, 1048576
  v_mfma_f32_16x16x32_bf16 v[164:167], a[12:15], a[156:159], v[164:167]
  buffer_load_dwordx4 v19, s[44:47], s31 offen offset:0 lds
  v_mfma_f32_16x16x32_bf16 v[132:135], a[12:15], a[152:155], v[132:135]
  ds_read_b64_tr_b16 a[42:43], v237 offset:54272
  v_mfma_f32_16x16x32_bf16 v[132:135], a[8:11], a[136:139], v[132:135]
  v_mfma_f32_16x16x32_bf16 v[100:103], a[8:11], a[132:135], v[100:103]
  ds_read_b64_tr_b16 a[44:45], v237 offset:58368
  v_mfma_f32_16x16x32_bf16 v[100:103], a[12:15], a[148:151], v[100:103]
  v_mfma_f32_16x16x32_bf16 v[68:71], a[12:15], a[144:147], v[68:71]
  ds_read_b64_tr_b16 a[46:47], v237 offset:62464
  v_mfma_f32_16x16x32_bf16 v[68:71], a[8:11], a[128:131], v[68:71]
  s_waitcnt lgkmcnt(8)
  v_mfma_f32_16x16x32_bf16 v[72:75], a[16:19], a[128:131], v[72:75]
  ds_read_b64_tr_b16 a[48:49], v238 offset:50176
  s_add_u32 m0, s98, 115584
  v_mfma_f32_16x16x32_bf16 v[72:75], a[20:23], a[144:147], v[72:75]
  buffer_load_dwordx4 v19, s[44:47], s31 offen offset:128 lds
  v_mfma_f32_16x16x32_bf16 v[104:107], a[20:23], a[148:151], v[104:107]
  ds_read_b64_tr_b16 a[50:51], v238 offset:54272
  v_mfma_f32_16x16x32_bf16 v[104:107], a[16:19], a[132:135], v[104:107]
  v_mfma_f32_16x16x32_bf16 v[136:139], a[16:19], a[136:139], v[136:139]
  ds_read_b64_tr_b16 a[52:53], v238 offset:58368
  s_add_u32 m0, s98, 116736
  s_add_u32 s31, s68, 1064960
  v_mfma_f32_16x16x32_bf16 v[136:139], a[20:23], a[152:155], v[136:139]
  buffer_load_dwordx4 v19, s[44:47], s31 offen offset:0 lds
  v_mfma_f32_16x16x32_bf16 v[168:171], a[20:23], a[156:159], v[168:171]
  ds_read_b64_tr_b16 a[54:55], v238 offset:62464
  v_mfma_f32_16x16x32_bf16 v[168:171], a[16:19], a[140:143], v[168:171]
  v_mfma_f32_16x16x32_bf16 v[172:175], a[24:27], a[140:143], v[172:175]
  ds_read_b64_tr_b16 a[56:57], v239 offset:50176
  s_add_u32 m0, s98, 117632
  v_mfma_f32_16x16x32_bf16 v[172:175], a[28:31], a[156:159], v[172:175]
  buffer_load_dwordx4 v19, s[44:47], s31 offen offset:128 lds
  v_mfma_f32_16x16x32_bf16 v[140:143], a[28:31], a[152:155], v[140:143]
  ds_read_b64_tr_b16 a[58:59], v239 offset:54272
  v_mfma_f32_16x16x32_bf16 v[140:143], a[24:27], a[136:139], v[140:143]
  v_mfma_f32_16x16x32_bf16 v[108:111], a[24:27], a[132:135], v[108:111]
  ds_read_b64_tr_b16 a[60:61], v239 offset:58368
  v_mfma_f32_16x16x32_bf16 v[108:111], a[28:31], a[148:151], v[108:111]
  v_mfma_f32_16x16x32_bf16 v[76:79], a[28:31], a[144:147], v[76:79]
  ds_read_b64_tr_b16 a[62:63], v239 offset:62464
  v_mfma_f32_16x16x32_bf16 v[76:79], a[24:27], a[128:131], v[76:79]
  s_waitcnt lgkmcnt(8)
  s_barrier
  v_mfma_f32_16x16x32_bf16 v[80:83], a[32:35], a[128:131], v[80:83]
  ds_read_b64_tr_b16 a[0:1], v240 offset:0
  s_add_u32 s30, s81, 43008
  v_mfma_f32_16x16x32_bf16 v[80:83], a[36:39], a[144:147], v[80:83]
  buffer_load_dwordx4 a[96:99], v16, s[4:7], s30 offen offset:0 sc1
  v_mfma_f32_16x16x32_bf16 v[112:115], a[36:39], a[148:151], v[112:115]
  ds_read_b64_tr_b16 a[2:3], v240 offset:4096
  v_mul_u32_u24 v8, 272, v4
  v_mfma_f32_16x16x32_bf16 v[112:115], a[32:35], a[132:135], v[112:115]
  v_mfma_f32_16x16x32_bf16 v[144:147], a[32:35], a[136:139], v[144:147]
  ds_read_b64_tr_b16 a[4:5], v240 offset:8192
  v_mfma_f32_16x16x32_bf16 v[144:147], a[36:39], a[152:155], v[144:147]
  v_lshl_add_u32 v8, v3, 3, v8
  buffer_load_dwordx4 a[112:115], v16, s[4:7], s30 offen offset:1024 sc1
  v_mfma_f32_16x16x32_bf16 v[176:179], a[36:39], a[156:159], v[176:179]
  ds_read_b64_tr_b16 a[6:7], v240 offset:12288
  v_mfma_f32_16x16x32_bf16 v[176:179], a[32:35], a[140:143], v[176:179]
  v_mfma_f32_16x16x32_bf16 v[180:183], a[40:43], a[140:143], v[180:183]
  ds_read_b64_tr_b16 a[8:9], v241 offset:0
  v_mfma_f32_16x16x32_bf16 v[180:183], a[44:47], a[156:159], v[180:183]
  s_mul_i32 s29, s20, 8704
  s_add_u32 s29, s29, 16384
  v_add_u32 v8, s29, v8
  buffer_load_dwordx4 a[104:107], v7, s[4:7], s30 offen offset:0 sc1
  v_mfma_f32_16x16x32_bf16 v[148:151], a[44:47], a[152:155], v[148:151]
  ds_read_b64_tr_b16 a[10:11], v241 offset:4096
  v_mfma_f32_16x16x32_bf16 v[148:151], a[40:43], a[136:139], v[148:151]
  v_mfma_f32_16x16x32_bf16 v[116:119], a[40:43], a[132:135], v[116:119]
  ds_read_b64_tr_b16 a[12:13], v241 offset:8192
  v_mfma_f32_16x16x32_bf16 v[116:119], a[44:47], a[148:151], v[116:119]
  v_and_b32_e64 v9, 1, v10
  v_mfma_f32_16x16x32_bf16 v[84:87], a[44:47], a[144:147], v[84:87]
  ds_read_b64_tr_b16 a[14:15], v241 offset:12288
  v_mfma_f32_16x16x32_bf16 v[84:87], a[40:43], a[128:131], v[84:87]
  s_waitcnt lgkmcnt(8)
  v_mfma_f32_16x16x32_bf16 v[88:91], a[48:51], a[128:131], v[88:91]
  ds_read_b64_tr_b16 a[16:17], v242 offset:0
  v_mfma_f32_16x16x32_bf16 v[88:91], a[52:55], a[144:147], v[88:91]
  v_lshl_add_u32 v10, v9, 4, v3
  buffer_load_dwordx4 a[120:123], v7, s[4:7], s30 offen offset:1024 sc1
  v_mfma_f32_16x16x32_bf16 v[120:123], a[52:55], a[148:151], v[120:123]
  ds_read_b64_tr_b16 a[18:19], v242 offset:4096
  v_mfma_f32_16x16x32_bf16 v[120:123], a[48:51], a[132:135], v[120:123]
  v_mfma_f32_16x16x32_bf16 v[152:155], a[48:51], a[136:139], v[152:155]
  ds_read_b64_tr_b16 a[20:21], v242 offset:8192
  v_mul_u32_u24 v9, 272, v10
  s_add_u32 s30, s81, 190976
  v_mfma_f32_16x16x32_bf16 v[152:155], a[52:55], a[152:155], v[152:155]
  buffer_load_dwordx4 a[100:103], v16, s[4:7], s30 offen offset:0 sc1
  v_mfma_f32_16x16x32_bf16 v[184:187], a[52:55], a[156:159], v[184:187]
  ds_read_b64_tr_b16 a[22:23], v242 offset:12288
  v_mfma_f32_16x16x32_bf16 v[184:187], a[48:51], a[140:143], v[184:187]
  v_mfma_f32_16x16x32_bf16 v[188:191], a[56:59], a[140:143], v[188:191]
  ds_read_b64_tr_b16 a[24:25], v243 offset:0
  v_lshl_add_u32 v9, v11, 4, v9
  v_mfma_f32_16x16x32_bf16 v[188:191], a[60:63], a[156:159], v[188:191]
  buffer_load_dwordx4 a[116:119], v16, s[4:7], s30 offen offset:1024 sc1
  v_mfma_f32_16x16x32_bf16 v[156:159], a[60:63], a[152:155], v[156:159]
  ds_read_b64_tr_b16 a[26:27], v243 offset:4096
  v_mfma_f32_16x16x32_bf16 v[156:159], a[56:59], a[136:139], v[156:159]
  v_mfma_f32_16x16x32_bf16 v[124:127], a[56:59], a[132:135], v[124:127]
  ds_read_b64_tr_b16 a[28:29], v243 offset:8192
  v_add_u32 v9, s29, v9
  v_mfma_f32_16x16x32_bf16 v[124:127], a[60:63], a[148:151], v[124:127]
  v_mfma_f32_16x16x32_bf16 v[92:95], a[60:63], a[144:147], v[92:95]
  ds_read_b64_tr_b16 a[30:31], v243 offset:12288
  v_mfma_f32_16x16x32_bf16 v[92:95], a[56:59], a[128:131], v[92:95]
  s_waitcnt vmcnt(22) lgkmcnt(8)
  v_mfma_f32_16x16x32_bf16 v[64:67], a[0:3], a[160:163], v[64:67]
  ds_read_b64_tr_b16 a[32:33], v240 offset:1024
  v_mfma_f32_16x16x32_bf16 v[64:67], a[4:7], a[176:179], v[64:67]
  buffer_load_dwordx4 a[108:111], v7, s[4:7], s30 offen offset:0 sc1
  v_mfma_f32_16x16x32_bf16 v[96:99], a[4:7], a[180:183], v[96:99]
  ds_read_b64_tr_b16 a[34:35], v240 offset:5120
  v_mfma_f32_16x16x32_bf16 v[96:99], a[0:3], a[164:167], v[96:99]
  v_mfma_f32_16x16x32_bf16 v[128:131], a[0:3], a[168:171], v[128:131]
  ds_read_b64_tr_b16 a[36:37], v240 offset:9216
  v_mfma_f32_16x16x32_bf16 v[128:131], a[4:7], a[184:187], v[128:131]
  buffer_load_dwordx4 a[124:127], v7, s[4:7], s30 offen offset:1024 sc1
  v_mfma_f32_16x16x32_bf16 v[160:163], a[4:7], a[188:191], v[160:163]
  ds_read_b64_tr_b16 a[38:39], v240 offset:13312
  v_mfma_f32_16x16x32_bf16 v[160:163], a[0:3], a[172:175], v[160:163]
  v_mfma_f32_16x16x32_bf16 v[164:167], a[8:11], a[172:175], v[164:167]
  ds_read_b64_tr_b16 a[40:41], v241 offset:1024
  s_add_u32 s30, s80, 49152
  v_mfma_f32_16x16x32_bf16 v[164:167], a[12:15], a[188:191], v[164:167]
  buffer_load_dwordx4 a[128:131], v16, s[4:7], s30 offen offset:0 sc1
  v_mfma_f32_16x16x32_bf16 v[132:135], a[12:15], a[184:187], v[132:135]
  ds_read_b64_tr_b16 a[42:43], v241 offset:5120
  v_mfma_f32_16x16x32_bf16 v[132:135], a[8:11], a[168:171], v[132:135]
  v_mfma_f32_16x16x32_bf16 v[100:103], a[8:11], a[164:167], v[100:103]
  ds_read_b64_tr_b16 a[44:45], v241 offset:9216
  v_mfma_f32_16x16x32_bf16 v[100:103], a[12:15], a[180:183], v[100:103]
  buffer_load_dwordx4 a[144:147], v16, s[4:7], s30 offen offset:1024 sc1
  v_mfma_f32_16x16x32_bf16 v[68:71], a[12:15], a[176:179], v[68:71]
  ds_read_b64_tr_b16 a[46:47], v241 offset:13312
  v_mfma_f32_16x16x32_bf16 v[68:71], a[8:11], a[160:163], v[68:71]
  s_waitcnt lgkmcnt(8)
  v_mfma_f32_16x16x32_bf16 v[72:75], a[16:19], a[160:163], v[72:75]
  ds_read_b64_tr_b16 a[48:49], v242 offset:1024
  v_mfma_f32_16x16x32_bf16 v[72:75], a[20:23], a[176:179], v[72:75]
  buffer_load_dwordx4 a[136:139], v7, s[4:7], s30 offen offset:0 sc1
  v_mfma_f32_16x16x32_bf16 v[104:107], a[20:23], a[180:183], v[104:107]
  ds_read_b64_tr_b16 a[50:51], v242 offset:5120
  v_mfma_f32_16x16x32_bf16 v[104:107], a[16:19], a[164:167], v[104:107]
  v_mfma_f32_16x16x32_bf16 v[136:139], a[16:19], a[168:171], v[136:139]
  ds_read_b64_tr_b16 a[52:53], v242 offset:9216
  v_mfma_f32_16x16x32_bf16 v[136:139], a[20:23], a[184:187], v[136:139]
  buffer_load_dwordx4 a[152:155], v7, s[4:7], s30 offen offset:1024 sc1
  v_mfma_f32_16x16x32_bf16 v[168:171], a[20:23], a[188:191], v[168:171]
  ds_read_b64_tr_b16 a[54:55], v242 offset:13312
  v_mfma_f32_16x16x32_bf16 v[168:171], a[16:19], a[172:175], v[168:171]
  v_mfma_f32_16x16x32_bf16 v[172:175], a[24:27], a[172:175], v[172:175]
  ds_read_b64_tr_b16 a[56:57], v243 offset:1024
  s_add_u32 s30, s80, 197120
  v_mfma_f32_16x16x32_bf16 v[172:175], a[28:31], a[188:191], v[172:175]
  buffer_load_dwordx4 a[132:135], v16, s[4:7], s30 offen offset:0 sc1
  v_mfma_f32_16x16x32_bf16 v[140:143], a[28:31], a[184:187], v[140:143]
  ds_read_b64_tr_b16 a[58:59], v243 offset:5120
  v_mfma_f32_16x16x32_bf16 v[140:143], a[24:27], a[168:171], v[140:143]
  v_mfma_f32_16x16x32_bf16 v[108:111], a[24:27], a[164:167], v[108:111]
  ds_read_b64_tr_b16 a[60:61], v243 offset:9216
  v_mfma_f32_16x16x32_bf16 v[108:111], a[28:31], a[180:183], v[108:111]
  v_mfma_f32_16x16x32_bf16 v[76:79], a[28:31], a[176:179], v[76:79]
  ds_read_b64_tr_b16 a[62:63], v243 offset:13312
  v_mfma_f32_16x16x32_bf16 v[76:79], a[24:27], a[160:163], v[76:79]
  s_waitcnt lgkmcnt(8)
  v_mfma_f32_16x16x32_bf16 v[80:83], a[32:35], a[160:163], v[80:83]
  ds_read_b64_tr_b16 a[0:1], v240 offset:16384
  v_mfma_f32_16x16x32_bf16 v[80:83], a[36:39], a[176:179], v[80:83]
  buffer_load_dwordx4 a[148:151], v16, s[4:7], s30 offen offset:1024 sc1
  v_mfma_f32_16x16x32_bf16 v[112:115], a[36:39], a[180:183], v[112:115]
  ds_read_b64_tr_b16 a[2:3], v240 offset:20480
  v_mfma_f32_16x16x32_bf16 v[112:115], a[32:35], a[164:167], v[112:115]
  v_mfma_f32_16x16x32_bf16 v[144:147], a[32:35], a[168:171], v[144:147]
  ds_read_b64_tr_b16 a[4:5], v240 offset:24576
  v_mfma_f32_16x16x32_bf16 v[144:147], a[36:39], a[184:187], v[144:147]
  buffer_load_dwordx4 a[140:143], v7, s[4:7], s30 offen offset:0 sc1
  v_mfma_f32_16x16x32_bf16 v[176:179], a[36:39], a[188:191], v[176:179]
  ds_read_b64_tr_b16 a[6:7], v240 offset:28672
  v_mfma_f32_16x16x32_bf16 v[176:179], a[32:35], a[172:175], v[176:179]
  v_mfma_f32_16x16x32_bf16 v[180:183], a[40:43], a[172:175], v[180:183]
  ds_read_b64_tr_b16 a[8:9], v241 offset:16384
  v_mfma_f32_16x16x32_bf16 v[180:183], a[44:47], a[188:191], v[180:183]
  buffer_load_dwordx4 a[156:159], v7, s[4:7], s30 offen offset:1024 sc1
  v_mfma_f32_16x16x32_bf16 v[148:151], a[44:47], a[184:187], v[148:151]
  ds_read_b64_tr_b16 a[10:11], v241 offset:20480
  v_mfma_f32_16x16x32_bf16 v[148:151], a[40:43], a[168:171], v[148:151]
  v_mfma_f32_16x16x32_bf16 v[116:119], a[40:43], a[164:167], v[116:119]
  ds_read_b64_tr_b16 a[12:13], v241 offset:24576
  s_add_u32 m0, s98, 131072
  s_add_u32 s31, s69, 1441792
  v_mfma_f32_16x16x32_bf16 v[116:119], a[44:47], a[180:183], v[116:119]
  buffer_load_dwordx4 v19, s[44:47], s31 offen offset:0 lds
  v_mfma_f32_16x16x32_bf16 v[84:87], a[44:47], a[176:179], v[84:87]
  ds_read_b64_tr_b16 a[14:15], v241 offset:28672
  v_mfma_f32_16x16x32_bf16 v[84:87], a[40:43], a[160:163], v[84:87]
  s_waitcnt lgkmcnt(8)
  v_mfma_f32_16x16x32_bf16 v[88:91], a[48:51], a[160:163], v[88:91]
  ds_read_b64_tr_b16 a[16:17], v242 offset:16384
  s_add_u32 m0, s98, 131968
  v_mfma_f32_16x16x32_bf16 v[88:91], a[52:55], a[176:179], v[88:91]
  buffer_load_dwordx4 v19, s[44:47], s31 offen offset:128 lds
  v_mfma_f32_16x16x32_bf16 v[120:123], a[52:55], a[180:183], v[120:123]
  ds_read_b64_tr_b16 a[18:19], v242 offset:20480
  v_mfma_f32_16x16x32_bf16 v[120:123], a[48:51], a[164:167], v[120:123]
  v_mfma_f32_16x16x32_bf16 v[152:155], a[48:51], a[168:171], v[152:155]
  ds_read_b64_tr_b16 a[20:21], v242 offset:24576
  s_add_u32 m0, s98, 133120
  s_add_u32 s31, s69, 1458176
  v_mfma_f32_16x16x32_bf16 v[152:155], a[52:55], a[184:187], v[152:155]
  buffer_load_dwordx4 v19, s[44:47], s31 offen offset:0 lds
  v_mfma_f32_16x16x32_bf16 v[184:187], a[52:55], a[188:191], v[184:187]
  ds_read_b64_tr_b16 a[22:23], v242 offset:28672
  v_mfma_f32_16x16x32_bf16 v[184:187], a[48:51], a[172:175], v[184:187]
  v_mfma_f32_16x16x32_bf16 v[188:191], a[56:59], a[172:175], v[188:191]
  ds_read_b64_tr_b16 a[24:25], v243 offset:16384
  s_add_u32 m0, s98, 134016
  v_mfma_f32_16x16x32_bf16 v[188:191], a[60:63], a[188:191], v[188:191]
  buffer_load_dwordx4 v19, s[44:47], s31 offen offset:128 lds
  v_mfma_f32_16x16x32_bf16 v[156:159], a[60:63], a[184:187], v[156:159]
  ds_read_b64_tr_b16 a[26:27], v243 offset:20480
  v_mfma_f32_16x16x32_bf16 v[156:159], a[56:59], a[168:171], v[156:159]
  v_mfma_f32_16x16x32_bf16 v[124:127], a[56:59], a[164:167], v[124:127]
  ds_read_b64_tr_b16 a[28:29], v243 offset:24576
  v_mfma_f32_16x16x32_bf16 v[124:127], a[60:63], a[180:183], v[124:127]
  v_mfma_f32_16x16x32_bf16 v[92:95], a[60:63], a[176:179], v[92:95]
  ds_read_b64_tr_b16 a[30:31], v243 offset:28672
  v_mfma_f32_16x16x32_bf16 v[92:95], a[56:59], a[160:163], v[92:95]
  s_waitcnt vmcnt(24) lgkmcnt(8)
  v_mfma_f32_16x16x32_bf16 v[64:67], a[0:3], a[64:67], v[64:67]
  ds_read_b64_tr_b16 a[32:33], v240 offset:17408
  s_add_u32 m0, s98, 0
  s_mul_i32 s68, s88, 131072
  s_mul_i32 s31, s93, 524288
  s_add_u32 s68, s68, s31
  s_add_u32 s31, s68, 0
  v_mfma_f32_16x16x32_bf16 v[64:67], a[4:7], a[80:83], v[64:67]
  buffer_load_dwordx4 v19, s[40:43], s31 offen offset:0 lds
  v_mfma_f32_16x16x32_bf16 v[96:99], a[4:7], a[84:87], v[96:99]
  ds_read_b64_tr_b16 a[34:35], v240 offset:21504
  v_mfma_f32_16x16x32_bf16 v[96:99], a[0:3], a[68:71], v[96:99]
  v_mfma_f32_16x16x32_bf16 v[128:131], a[0:3], a[72:75], v[128:131]
  ds_read_b64_tr_b16 a[36:37], v240 offset:25600
  s_add_u32 m0, s98, 896
  v_mfma_f32_16x16x32_bf16 v[128:131], a[4:7], a[88:91], v[128:131]
  buffer_load_dwordx4 v19, s[40:43], s31 offen offset:128 lds
  v_mfma_f32_16x16x32_bf16 v[160:163], a[4:7], a[92:95], v[160:163]
  ds_read_b64_tr_b16 a[38:39], v240 offset:29696
  v_mfma_f32_16x16x32_bf16 v[160:163], a[0:3], a[76:79], v[160:163]
  v_mfma_f32_16x16x32_bf16 v[164:167], a[8:11], a[76:79], v[164:167]
  ds_read_b64_tr_b16 a[40:41], v241 offset:17408
  s_add_u32 m0, s98, 2048
  s_add_u32 s31, s68, 16384
  v_mfma_f32_16x16x32_bf16 v[164:167], a[12:15], a[92:95], v[164:167]
  buffer_load_dwordx4 v19, s[40:43], s31 offen offset:0 lds
  v_mfma_f32_16x16x32_bf16 v[132:135], a[12:15], a[88:91], v[132:135]
  ds_read_b64_tr_b16 a[42:43], v241 offset:21504
  v_mfma_f32_16x16x32_bf16 v[132:135], a[8:11], a[72:75], v[132:135]
  v_mfma_f32_16x16x32_bf16 v[100:103], a[8:11], a[68:71], v[100:103]
  ds_read_b64_tr_b16 a[44:45], v241 offset:25600
  s_add_u32 m0, s98, 2944
  v_mfma_f32_16x16x32_bf16 v[100:103], a[12:15], a[84:87], v[100:103]
  buffer_load_dwordx4 v19, s[40:43], s31 offen offset:128 lds
  v_mfma_f32_16x16x32_bf16 v[68:71], a[12:15], a[80:83], v[68:71]
  ds_read_b64_tr_b16 a[46:47], v241 offset:29696
  v_mfma_f32_16x16x32_bf16 v[68:71], a[8:11], a[64:67], v[68:71]
  s_waitcnt lgkmcnt(8)
  v_mfma_f32_16x16x32_bf16 v[72:75], a[16:19], a[64:67], v[72:75]
  ds_read_b64_tr_b16 a[48:49], v242 offset:17408
  s_add_u32 s30, s81, 55296
  v_mfma_f32_16x16x32_bf16 v[72:75], a[20:23], a[80:83], v[72:75]
  buffer_load_dwordx4 a[160:163], v16, s[4:7], s30 offen offset:0 sc1
  v_mfma_f32_16x16x32_bf16 v[104:107], a[20:23], a[84:87], v[104:107]
  ds_read_b64_tr_b16 a[50:51], v242 offset:21504
  v_mfma_f32_16x16x32_bf16 v[104:107], a[16:19], a[68:71], v[104:107]
  v_mfma_f32_16x16x32_bf16 v[136:139], a[16:19], a[72:75], v[136:139]
  ds_read_b64_tr_b16 a[52:53], v242 offset:25600
  v_mfma_f32_16x16x32_bf16 v[136:139], a[20:23], a[88:91], v[136:139]
  buffer_load_dwordx4 a[176:179], v16, s[4:7], s30 offen offset:1024 sc1
  v_mfma_f32_16x16x32_bf16 v[168:171], a[20:23], a[92:95], v[168:171]
  ds_read_b64_tr_b16 a[54:55], v242 offset:29696
  v_mfma_f32_16x16x32_bf16 v[168:171], a[16:19], a[76:79], v[168:171]
  v_mfma_f32_16x16x32_bf16 v[172:175], a[24:27], a[76:79], v[172:175]
  ds_read_b64_tr_b16 a[56:57], v243 offset:17408
  v_mfma_f32_16x16x32_bf16 v[172:175], a[28:31], a[92:95], v[172:175]
  buffer_load_dwordx4 a[168:171], v7, s[4:7], s30 offen offset:0 sc1
  v_mfma_f32_16x16x32_bf16 v[140:143], a[28:31], a[88:91], v[140:143]
  ds_read_b64_tr_b16 a[58:59], v243 offset:21504
  v_mfma_f32_16x16x32_bf16 v[140:143], a[24:27], a[72:75], v[140:143]
  v_mfma_f32_16x16x32_bf16 v[108:111], a[24:27], a[68:71], v[108:111]
  ds_read_b64_tr_b16 a[60:61], v243 offset:25600
  v_mfma_f32_16x16x32_bf16 v[108:111], a[28:31], a[84:87], v[108:111]
  v_mfma_f32_16x16x32_bf16 v[76:79], a[28:31], a[80:83], v[76:79]
  ds_read_b64_tr_b16 a[62:63], v243 offset:29696
  v_mfma_f32_16x16x32_bf16 v[76:79], a[24:27], a[64:67], v[76:79]
  s_waitcnt vmcnt(27) lgkmcnt(8)
  s_barrier
  v_mfma_f32_16x16x32_bf16 v[80:83], a[32:35], a[64:67], v[80:83]
  ds_read_b64_tr_b16 a[0:1], v240 offset:32768
  buffer_load_dword v33, v27, s[16:19], 0 offen sc1
  v_mfma_f32_16x16x32_bf16 v[80:83], a[36:39], a[80:83], v[80:83]
  buffer_load_dwordx4 a[184:187], v7, s[4:7], s30 offen offset:1024 sc1
  v_mfma_f32_16x16x32_bf16 v[112:115], a[36:39], a[84:87], v[112:115]
  ds_read_b64_tr_b16 a[2:3], v240 offset:36864
  v_mfma_f32_16x16x32_bf16 v[112:115], a[32:35], a[68:71], v[112:115]
  v_mfma_f32_16x16x32_bf16 v[144:147], a[32:35], a[72:75], v[144:147]
  ds_read_b64_tr_b16 a[4:5], v240 offset:40960
  s_add_u32 s30, s81, 203264
  v_mfma_f32_16x16x32_bf16 v[144:147], a[36:39], a[88:91], v[144:147]
  buffer_load_dwordx4 a[164:167], v16, s[4:7], s30 offen offset:0 sc1
  v_mfma_f32_16x16x32_bf16 v[176:179], a[36:39], a[92:95], v[176:179]
  ds_read_b64_tr_b16 a[6:7], v240 offset:45056
  v_mfma_f32_16x16x32_bf16 v[176:179], a[32:35], a[76:79], v[176:179]
  v_mfma_f32_16x16x32_bf16 v[180:183], a[40:43], a[76:79], v[180:183]
  ds_read_b64_tr_b16 a[8:9], v241 offset:32768
  v_mfma_f32_16x16x32_bf16 v[180:183], a[44:47], a[92:95], v[180:183]
  buffer_load_dwordx4 a[180:183], v16, s[4:7], s30 offen offset:1024 sc1
  v_mfma_f32_16x16x32_bf16 v[148:151], a[44:47], a[88:91], v[148:151]
  ds_read_b64_tr_b16 a[10:11], v241 offset:36864
  v_mfma_f32_16x16x32_bf16 v[148:151], a[40:43], a[72:75], v[148:151]
  v_mfma_f32_16x16x32_bf16 v[116:119], a[40:43], a[68:71], v[116:119]
  ds_read_b64_tr_b16 a[12:13], v241 offset:40960
  v_mfma_f32_16x16x32_bf16 v[116:119], a[44:47], a[84:87], v[116:119]
  buffer_load_dwordx4 a[172:175], v7, s[4:7], s30 offen offset:0 sc1
  v_mfma_f32_16x16x32_bf16 v[84:87], a[44:47], a[80:83], v[84:87]
  ds_read_b64_tr_b16 a[14:15], v241 offset:45056
  v_mfma_f32_16x16x32_bf16 v[84:87], a[40:43], a[64:67], v[84:87]
  s_waitcnt lgkmcnt(8)
  v_mfma_f32_16x16x32_bf16 v[88:91], a[48:51], a[64:67], v[88:91]
  ds_read_b64_tr_b16 a[16:17], v242 offset:32768
  v_mfma_f32_16x16x32_bf16 v[88:91], a[52:55], a[80:83], v[88:91]
  buffer_load_dwordx4 a[188:191], v7, s[4:7], s30 offen offset:1024 sc1
  v_mfma_f32_16x16x32_bf16 v[120:123], a[52:55], a[84:87], v[120:123]
  ds_read_b64_tr_b16 a[18:19], v242 offset:36864
  v_mfma_f32_16x16x32_bf16 v[120:123], a[48:51], a[68:71], v[120:123]
  v_mfma_f32_16x16x32_bf16 v[152:155], a[48:51], a[72:75], v[152:155]
  ds_read_b64_tr_b16 a[20:21], v242 offset:40960
  s_add_u32 m0, s98, 16384
  s_mul_i32 s69, s89, 131072
  s_mul_i32 s31, s93, 524288
  s_add_u32 s69, s69, s31
  s_add_u32 s31, s69, 131072
  v_mfma_f32_16x16x32_bf16 v[152:155], a[52:55], a[88:91], v[152:155]
  buffer_load_dwordx4 v19, s[40:43], s31 offen offset:0 lds
  v_mfma_f32_16x16x32_bf16 v[184:187], a[52:55], a[92:95], v[184:187]
  ds_read_b64_tr_b16 a[22:23], v242 offset:45056
  v_mfma_f32_16x16x32_bf16 v[184:187], a[48:51], a[76:79], v[184:187]
  v_mfma_f32_16x16x32_bf16 v[188:191], a[56:59], a[76:79], v[188:191]
  ds_read_b64_tr_b16 a[24:25], v243 offset:32768
  s_add_u32 m0, s98, 17280
  v_mfma_f32_16x16x32_bf16 v[188:191], a[60:63], a[92:95], v[188:191]
  buffer_load_dwordx4 v19, s[40:43], s31 offen offset:128 lds
  v_mfma_f32_16x16x32_bf16 v[156:159], a[60:63], a[88:91], v[156:159]
  ds_read_b64_tr_b16 a[26:27], v243 offset:36864
  v_mfma_f32_16x16x32_bf16 v[156:159], a[56:59], a[72:75], v[156:159]
  v_mfma_f32_16x16x32_bf16 v[124:127], a[56:59], a[68:71], v[124:127]
  ds_read_b64_tr_b16 a[28:29], v243 offset:40960
  v_mfma_f32_16x16x32_bf16 v[124:127], a[60:63], a[84:87], v[124:127]
  v_mfma_f32_16x16x32_bf16 v[92:95], a[60:63], a[80:83], v[92:95]
  ds_read_b64_tr_b16 a[30:31], v243 offset:45056
  v_mfma_f32_16x16x32_bf16 v[92:95], a[56:59], a[64:67], v[92:95]
  s_waitcnt vmcnt(27) lgkmcnt(8)
  v_mfma_f32_16x16x32_bf16 v[64:67], a[0:3], a[96:99], v[64:67]
  ds_read_b64_tr_b16 a[32:33], v240 offset:33792
  s_add_u32 m0, s98, 18432
  s_add_u32 s31, s69, 147456
  v_mfma_f32_16x16x32_bf16 v[64:67], a[4:7], a[112:115], v[64:67]
  buffer_load_dwordx4 v19, s[40:43], s31 offen offset:0 lds
  v_mfma_f32_16x16x32_bf16 v[96:99], a[4:7], a[116:119], v[96:99]
  ds_read_b64_tr_b16 a[34:35], v240 offset:37888
  v_mfma_f32_16x16x32_bf16 v[96:99], a[0:3], a[100:103], v[96:99]
  v_mfma_f32_16x16x32_bf16 v[128:131], a[0:3], a[104:107], v[128:131]
  ds_read_b64_tr_b16 a[36:37], v240 offset:41984
  s_add_u32 m0, s98, 19328
  v_mfma_f32_16x16x32_bf16 v[128:131], a[4:7], a[120:123], v[128:131]
  buffer_load_dwordx4 v19, s[40:43], s31 offen offset:128 lds
  v_mfma_f32_16x16x32_bf16 v[160:163], a[4:7], a[124:127], v[160:163]
  ds_read_b64_tr_b16 a[38:39], v240 offset:46080
  v_mfma_f32_16x16x32_bf16 v[160:163], a[0:3], a[108:111], v[160:163]
  v_mfma_f32_16x16x32_bf16 v[164:167], a[8:11], a[108:111], v[164:167]
  ds_read_b64_tr_b16 a[40:41], v241 offset:33792
  s_add_u32 m0, s98, 32768
  s_mul_i32 s68, s88, 131072
  s_mul_i32 s31, s92, 524288
  s_add_u32 s68, s68, s31
  s_add_u32 s31, s68, 262144
  v_mfma_f32_16x16x32_bf16 v[164:167], a[12:15], a[124:127], v[164:167]
  buffer_load_dwordx4 v19, s[40:43], s31 offen offset:0 lds
  v_mfma_f32_16x16x32_bf16 v[132:135], a[12:15], a[120:123], v[132:135]
  ds_read_b64_tr_b16 a[42:43], v241 offset:37888
  v_mfma_f32_16x16x32_bf16 v[132:135], a[8:11], a[104:107], v[132:135]
  v_mfma_f32_16x16x32_bf16 v[100:103], a[8:11], a[100:103], v[100:103]
  ds_read_b64_tr_b16 a[44:45], v241 offset:41984
  s_add_u32 m0, s98, 33664
  v_mfma_f32_16x16x32_bf16 v[100:103], a[12:15], a[116:119], v[100:103]
  buffer_load_dwordx4 v19, s[40:43], s31 offen offset:128 lds
  v_mfma_f32_16x16x32_bf16 v[68:71], a[12:15], a[112:115], v[68:71]
  ds_read_b64_tr_b16 a[46:47], v241 offset:46080
  v_mfma_f32_16x16x32_bf16 v[68:71], a[8:11], a[96:99], v[68:71]
  s_waitcnt lgkmcnt(8)
  v_mfma_f32_16x16x32_bf16 v[72:75], a[16:19], a[96:99], v[72:75]
  ds_read_b64_tr_b16 a[48:49], v242 offset:33792
  s_add_u32 m0, s98, 34816
  s_add_u32 s31, s68, 278528
  v_mfma_f32_16x16x32_bf16 v[72:75], a[20:23], a[112:115], v[72:75]
  buffer_load_dwordx4 v19, s[40:43], s31 offen offset:0 lds
  v_mfma_f32_16x16x32_bf16 v[104:107], a[20:23], a[116:119], v[104:107]
  ds_read_b64_tr_b16 a[50:51], v242 offset:37888
  v_mfma_f32_16x16x32_bf16 v[104:107], a[16:19], a[100:103], v[104:107]
  v_mfma_f32_16x16x32_bf16 v[136:139], a[16:19], a[104:107], v[136:139]
  ds_read_b64_tr_b16 a[52:53], v242 offset:41984
  s_add_u32 m0, s98, 35712
  v_mfma_f32_16x16x32_bf16 v[136:139], a[20:23], a[120:123], v[136:139]
  buffer_load_dwordx4 v19, s[40:43], s31 offen offset:128 lds
  v_mfma_f32_16x16x32_bf16 v[168:171], a[20:23], a[124:127], v[168:171]
  ds_read_b64_tr_b16 a[54:55], v242 offset:46080
  v_mfma_f32_16x16x32_bf16 v[168:171], a[16:19], a[108:111], v[168:171]
  v_mfma_f32_16x16x32_bf16 v[172:175], a[24:27], a[108:111], v[172:175]
  ds_read_b64_tr_b16 a[56:57], v243 offset:33792
  s_add_u32 m0, s98, 49152
  s_mul_i32 s69, s89, 131072
  s_mul_i32 s31, s92, 524288
  s_add_u32 s69, s69, s31
  s_add_u32 s31, s69, 393216
  v_mfma_f32_16x16x32_bf16 v[172:175], a[28:31], a[124:127], v[172:175]
  buffer_load_dwordx4 v19, s[40:43], s31 offen offset:0 lds
  v_mfma_f32_16x16x32_bf16 v[140:143], a[28:31], a[120:123], v[140:143]
  ds_read_b64_tr_b16 a[58:59], v243 offset:37888
  v_mfma_f32_16x16x32_bf16 v[140:143], a[24:27], a[104:107], v[140:143]
  v_mfma_f32_16x16x32_bf16 v[108:111], a[24:27], a[100:103], v[108:111]
  ds_read_b64_tr_b16 a[60:61], v243 offset:41984
  v_mfma_f32_16x16x32_bf16 v[108:111], a[28:31], a[116:119], v[108:111]
  v_mfma_f32_16x16x32_bf16 v[76:79], a[28:31], a[112:115], v[76:79]
  ds_read_b64_tr_b16 a[62:63], v243 offset:46080
  v_mfma_f32_16x16x32_bf16 v[76:79], a[24:27], a[96:99], v[76:79]
  s_waitcnt vmcnt(14) lgkmcnt(8)
  v_mfma_f32_16x16x32_bf16 v[80:83], a[32:35], a[96:99], v[80:83]
  ds_read_b64_tr_b16 a[0:1], v240 offset:49152
  v_cmp_eq_u32 vcc, 0, v33
  s_cbranch_vccnz La_g0_slow
La_g0_back:
  s_mul_i32 s80, s88, 2048
  s_mul_i32 s30, s93, 8192
  s_add_u32 s80, s80, s30
  s_add_u32 s30, s80, 0
  v_mfma_f32_16x16x32_bf16 v[80:83], a[36:39], a[112:115], v[80:83]
  buffer_load_dwordx4 a[64:67], v16, s[4:7], s30 offen offset:0 sc1
  v_mfma_f32_16x16x32_bf16 v[112:115], a[36:39], a[116:119], v[112:115]
La_pad11:
  s_cbranch_execz La_ret1
  s_nop 0
  ds_read_b64_tr_b16 a[2:3], v240 offset:53248
  v_mfma_f32_16x16x32_bf16 v[112:115], a[32:35], a[100:103], v[112:115]
  v_mfma_f32_16x16x32_bf16 v[144:147], a[32:35], a[104:107], v[144:147]
  ds_read_b64_tr_b16 a[4:5], v240 offset:57344
  v_mfma_f32_16x16x32_bf16 v[144:147], a[36:39], a[120:123], v[144:147]
  buffer_load_dwordx4 a[80:83], v16, s[4:7], s30 offen offset:1024 sc1
  v_mfma_f32_16x16x32_bf16 v[176:179], a[36:39], a[124:127], v[176:179]
  ds_read_b64_tr_b16 a[6:7], v240 offset:61440
  v_mfma_f32_16x16x32_bf16 v[176:179], a[32:35], a[108:111], v[176:179]
  v_mfma_f32_16x16x32_bf16 v[180:183], a[40:43], a[108:111], v[180:183]
  ds_read_b64_tr_b16 a[8:9], v241 offset:49152
  v_mfma_f32_16x16x32_bf16 v[180:183], a[44:47], a[124:127], v[180:183]
  buffer_load_dwordx4 a[72:75], v7, s[4:7], s30 offen offset:0 sc1
  v_mfma_f32_16x16x32_bf16 v[148:151], a[44:47], a[120:123], v[148:151]
  ds_read_b64_tr_b16 a[10:11], v241 offset:53248
  v_mfma_f32_16x16x32_bf16 v[148:151], a[40:43], a[104:107], v[148:151]
  v_mfma_f32_16x16x32_bf16 v[116:119], a[40:43], a[100:103], v[116:119]
  ds_read_b64_tr_b16 a[12:13], v241 offset:57344
  v_mfma_f32_16x16x32_bf16 v[116:119], a[44:47], a[116:119], v[116:119]
  buffer_load_dwordx4 a[88:91], v7, s[4:7], s30 offen offset:1024 sc1
  v_mfma_f32_16x16x32_bf16 v[84:87], a[44:47], a[112:115], v[84:87]
  ds_read_b64_tr_b16 a[14:15], v241 offset:61440
  v_mfma_f32_16x16x32_bf16 v[84:87], a[40:43], a[96:99], v[84:87]
  s_waitcnt lgkmcnt(8)
  v_mfma_f32_16x16x32_bf16 v[88:91], a[48:51], a[96:99], v[88:91]
  ds_read_b64_tr_b16 a[16:17], v242 offset:49152
  s_add_u32 s30, s80, 147968
  v_mfma_f32_16x16x32_bf16 v[88:91], a[52:55], a[112:115], v[88:91]
  buffer_load_dwordx4 a[68:71], v16, s[4:7], s30 offen offset:0 sc1
  v_mfma_f32_16x16x32_bf16 v[120:123], a[52:55], a[116:119], v[120:123]
  ds_read_b64_tr_b16 a[18:19], v242 offset:53248
  v_mfma_f32_16x16x32_bf16 v[120:123], a[48:51], a[100:103], v[120:123]
  v_mfma_f32_16x16x32_bf16 v[152:155], a[48:51], a[104:107], v[152:155]
  ds_read_b64_tr_b16 a[20:21], v242 offset:57344
  v_mfma_f32_16x16x32_bf16 v[152:155], a[52:55], a[120:123], v[152:155]
  buffer_load_dwordx4 a[84:87], v16, s[4:7], s30 offen offset:1024 sc1
  v_mfma_f32_16x16x32_bf16 v[184:187], a[52:55], a[124:127], v[184:187]
  ds_read_b64_tr_b16 a[22:23], v242 offset:61440
  v_mfma_f32_16x16x32_bf16 v[184:187], a[48:51], a[108:111], v[184:187]
  v_mfma_f32_16x16x32_bf16 v[188:191], a[56:59], a[108:111], v[188:191]
  ds_read_b64_tr_b16 a[24:25], v243 offset:49152
  v_mfma_f32_16x16x32_bf16 v[188:191], a[60:63], a[124:127], v[188:191]
  buffer_load_dwordx4 a[76:79], v7, s[4:7], s30 offen offset:0 sc1
  v_mfma_f32_16x16x32_bf16 v[156:159], a[60:63], a[120:123], v[156:159]
  ds_read_b64_tr_b16 a[26:27], v243 offset:53248
  v_mfma_f32_16x16x32_bf16 v[156:159], a[56:59], a[104:107], v[156:159]
  v_mfma_f32_16x16x32_bf16 v[124:127], a[56:59], a[100:103], v[124:127]
  ds_read_b64_tr_b16 a[28:29], v243 offset:57344
  v_mfma_f32_16x16x32_bf16 v[124:127], a[60:63], a[116:119], v[124:127]
  v_mfma_f32_16x16x32_bf16 v[92:95], a[60:63], a[112:115], v[92:95]
  ds_read_b64_tr_b16 a[30:31], v243 offset:61440
  v_mfma_f32_16x16x32_bf16 v[92:95], a[56:59], a[96:99], v[92:95]
  s_waitcnt lgkmcnt(8)
  v_mfma_f32_16x16x32_bf16 v[64:67], a[0:3], a[128:131], v[64:67]
  ds_read_b64_tr_b16 a[32:33], v240 offset:50176
  v_mfma_f32_16x16x32_bf16 v[64:67], a[4:7], a[144:147], v[64:67]
  buffer_load_dwordx4 a[92:95], v7, s[4:7], s30 offen offset:1024 sc1
  v_mfma_f32_16x16x32_bf16 v[96:99], a[4:7], a[148:151], v[96:99]
  ds_read_b64_tr_b16 a[34:35], v240 offset:54272
  v_mfma_f32_16x16x32_bf16 v[96:99], a[0:3], a[132:135], v[96:99]
  v_mfma_f32_16x16x32_bf16 v[128:131], a[0:3], a[136:139], v[128:131]
  ds_read_b64_tr_b16 a[36:37], v240 offset:58368
  s_mul_i32 s81, s89, 2048
  s_mul_i32 s30, s93, 8192
  s_add_u32 s81, s81, s30
  s_add_u32 s30, s81, 2048
  v_mfma_f32_16x16x32_bf16 v[128:131], a[4:7], a[152:155], v[128:131]
  buffer_load_dwordx4 a[96:99], v16, s[4:7], s30 offen offset:0 sc1
  v_mfma_f32_16x16x32_bf16 v[160:163], a[4:7], a[156:159], v[160:163]
  ds_read_b64_tr_b16 a[38:39], v240 offset:62464
  v_mfma_f32_16x16x32_bf16 v[160:163], a[0:3], a[140:143], v[160:163]
  v_mfma_f32_16x16x32_bf16 v[164:167], a[8:11], a[140:143], v[164:167]
  ds_read_b64_tr_b16 a[40:41], v241 offset:50176
  v_mfma_f32_16x16x32_bf16 v[164:167], a[12:15], a[156:159], v[164:167]
  buffer_load_dwordx4 a[112:115], v16, s[4:7], s30 offen offset:1024 sc1
  v_mfma_f32_16x16x32_bf16 v[132:135], a[12:15], a[152:155], v[132:135]
  ds_read_b64_tr_b16 a[42:43], v241 offset:54272
  v_mfma_f32_16x16x32_bf16 v[132:135], a[8:11], a[136:139], v[132:135]
  v_mfma_f32_16x16x32_bf16 v[100:103], a[8:11], a[132:135], v[100:103]
  ds_read_b64_tr_b16 a[44:45], v241 offset:58368
  v_mfma_f32_16x16x32_bf16 v[100:103], a[12:15], a[148:151], v[100:103]
  buffer_load_dwordx4 a[104:107], v7, s[4:7], s30 offen offset:0 sc1
  v_mfma_f32_16x16x32_bf16 v[68:71], a[12:15], a[144:147], v[68:71]
  ds_read_b64_tr_b16 a[46:47], v241 offset:62464
  v_mfma_f32_16x16x32_bf16 v[68:71], a[8:11], a[128:131], v[68:71]
  s_waitcnt lgkmcnt(8)
  v_mfma_f32_16x16x32_bf16 v[72:75], a[16:19], a[128:131], v[72:75]
  ds_read_b64_tr_b16 a[48:49], v242 offset:50176
  v_mfma_f32_16x16x32_bf16 v[72:75], a[20:23], a[144:147], v[72:75]
  buffer_load_dwordx4 a[120:123], v7, s[4:7], s30 offen offset:1024 sc1
  v_mfma_f32_16x16x32_bf16 v[104:107], a[20:23], a[148:151], v[104:107]
  ds_read_b64_tr_b16 a[50:51], v242 offset:54272
  v_mfma_f32_16x16x32_bf16 v[104:107], a[16:19], a[132:135], v[104:107]
  v_mfma_f32_16x16x32_bf16 v[136:139], a[16:19], a[136:139], v[136:139]
  ds_read_b64_tr_b16 a[52:53], v242 offset:58368
  s_add_u32 s30, s81, 150016
  v_mfma_f32_16x16x32_bf16 v[136:139], a[20:23], a[152:155], v[136:139]
  buffer_load_dwordx4 a[100:103], v16, s[4:7], s30 offen offset:0 sc1
  v_mfma_f32_16x16x32_bf16 v[168:171], a[20:23], a[156:159], v[168:171]
  ds_read_b64_tr_b16 a[54:55], v242 offset:62464
  v_mfma_f32_16x16x32_bf16 v[168:171], a[16:19], a[140:143], v[168:171]
  v_mfma_f32_16x16x32_bf16 v[172:175], a[24:27], a[140:143], v[172:175]
  ds_read_b64_tr_b16 a[56:57], v243 offset:50176
  v_mfma_f32_16x16x32_bf16 v[172:175], a[28:31], a[156:159], v[172:175]
  buffer_load_dwordx4 a[116:119], v16, s[4:7], s30 offen offset:1024 sc1
  v_mfma_f32_16x16x32_bf16 v[140:143], a[28:31], a[152:155], v[140:143]
  ds_read_b64_tr_b16 a[58:59], v243 offset:54272
  v_mfma_f32_16x16x32_bf16 v[140:143], a[24:27], a[136:139], v[140:143]
  v_mfma_f32_16x16x32_bf16 v[108:111], a[24:27], a[132:135], v[108:111]
  ds_read_b64_tr_b16 a[60:61], v243 offset:58368
  v_mfma_f32_16x16x32_bf16 v[108:111], a[28:31], a[148:151], v[108:111]
  v_mfma_f32_16x16x32_bf16 v[76:79], a[28:31], a[144:147], v[76:79]
  ds_read_b64_tr_b16 a[62:63], v243 offset:62464
  v_mfma_f32_16x16x32_bf16 v[76:79], a[24:27], a[128:131], v[76:79]
  s_waitcnt lgkmcnt(8)
  s_barrier
  v_mfma_f32_16x16x32_bf16 v[80:83], a[32:35], a[128:131], v[80:83]
  ds_read_b64_tr_b16 a[0:1], v244 offset:0
  v_mfma_f32_16x16x32_bf16 v[80:83], a[36:39], a[144:147], v[80:83]
  buffer_load_dwordx4 a[108:111], v7, s[4:7], s30 offen offset:0 sc1
  v_mfma_f32_16x16x32_bf16 v[112:115], a[36:39], a[148:151], v[112:115]
  ds_read_b64_tr_b16 a[2:3], v244 offset:4096
  v_mfma_f32_16x16x32_bf16 v[112:115], a[32:35], a[132:135], v[112:115]
  v_mfma_f32_16x16x32_bf16 v[144:147], a[32:35], a[136:139], v[144:147]
  ds_read_b64_tr_b16 a[4:5], v244 offset:8192
  v_mfma_f32_16x16x32_bf16 v[144:147], a[36:39], a[152:155], v[144:147]
  buffer_load_dwordx4 a[124:127], v7, s[4:7], s30 offen offset:1024 sc1
  v_mfma_f32_16x16x32_bf16 v[176:179], a[36:39], a[156:159], v[176:179]
  ds_read_b64_tr_b16 a[6:7], v244 offset:12288
  v_mfma_f32_16x16x32_bf16 v[176:179], a[32:35], a[140:143], v[176:179]
  v_mfma_f32_16x16x32_bf16 v[180:183], a[40:43], a[140:143], v[180:183]
  ds_read_b64_tr_b16 a[8:9], v245 offset:0
  s_add_u32 m0, s98, 50048
  v_mfma_f32_16x16x32_bf16 v[180:183], a[44:47], a[156:159], v[180:183]
  buffer_load_dwordx4 v19, s[40:43], s31 offen offset:128 lds
  v_mfma_f32_16x16x32_bf16 v[148:151], a[44:47], a[152:155], v[148:151]
  ds_read_b64_tr_b16 a[10:11], v245 offset:4096
  v_mfma_f32_16x16x32_bf16 v[148:151], a[40:43], a[136:139], v[148:151]
  v_mfma_f32_16x16x32_bf16 v[116:119], a[40:43], a[132:135], v[116:119]
  ds_read_b64_tr_b16 a[12:13], v245 offset:8192
  s_add_u32 m0, s98, 51200
  s_add_u32 s31, s69, 409600
  v_mfma_f32_16x16x32_bf16 v[116:119], a[44:47], a[148:151], v[116:119]
  buffer_load_dwordx4 v19, s[40:43], s31 offen offset:0 lds
  v_mfma_f32_16x16x32_bf16 v[84:87], a[44:47], a[144:147], v[84:87]
  ds_read_b64_tr_b16 a[14:15], v245 offset:12288
  v_mfma_f32_16x16x32_bf16 v[84:87], a[40:43], a[128:131], v[84:87]
  s_waitcnt lgkmcnt(8)
  v_mfma_f32_16x16x32_bf16 v[88:91], a[48:51], a[128:131], v[88:91]
  ds_read_b64_tr_b16 a[16:17], v246 offset:0
  s_add_u32 m0, s98, 52096
  v_mfma_f32_16x16x32_bf16 v[88:91], a[52:55], a[144:147], v[88:91]
  buffer_load_dwordx4 v19, s[40:43], s31 offen offset:128 lds
  v_mfma_f32_16x16x32_bf16 v[120:123], a[52:55], a[148:151], v[120:123]
  ds_read_b64_tr_b16 a[18:19], v246 offset:4096
  v_mfma_f32_16x16x32_bf16 v[120:123], a[48:51], a[132:135], v[120:123]
  v_mfma_f32_16x16x32_bf16 v[152:155], a[48:51], a[136:139], v[152:155]
  ds_read_b64_tr_b16 a[20:21], v246 offset:8192
  s_add_u32 m0, s98, 65536
  s_add_u32 s31, s68, 1310720
  v_mfma_f32_16x16x32_bf16 v[152:155], a[52:55], a[152:155], v[152:155]
  buffer_load_dwordx4 v19, s[40:43], s31 offen offset:0 lds
  v_mfma_f32_16x16x32_bf16 v[184:187], a[52:55], a[156:159], v[184:187]
  ds_read_b64_tr_b16 a[22:23], v246 offset:12288
  v_mfma_f32_16x16x32_bf16 v[184:187], a[48:51], a[140:143], v[184:187]
  v_mfma_f32_16x16x32_bf16 v[188:191], a[56:59], a[140:143], v[188:191]
  ds_read_b64_tr_b16 a[24:25], v247 offset:0
  s_add_u32 m0, s98, 66432
  v_mfma_f32_16x16x32_bf16 v[188:191], a[60:63], a[156:159], v[188:191]
  buffer_load_dwordx4 v19, s[40:43], s31 offen offset:128 lds
  v_mfma_f32_16x16x32_bf16 v[156:159], a[60:63], a[152:155], v[156:159]
  ds_read_b64_tr_b16 a[26:27], v247 offset:4096
  v_mfma_f32_16x16x32_bf16 v[156:159], a[56:59], a[136:139], v[156:159]
  v_mfma_f32_16x16x32_bf16 v[124:127], a[56:59], a[132:135], v[124:127]
  ds_read_b64_tr_b16 a[28:29], v247 offset:8192
  v_mfma_f32_16x16x32_bf16 v[124:127], a[60:63], a[148:151], v[124:127]
  v_mfma_f32_16x16x32_bf16 v[92:95], a[60:63], a[144:147], v[92:95]
  ds_read_b64_tr_b16 a[30:31], v247 offset:12288
  v_mfma_f32_16x16x32_bf16 v[92:95], a[56:59], a[128:131], v[92:95]
  s_waitcnt vmcnt(30) lgkmcnt(8)
  v_mfma_f32_16x16x32_bf16 v[64:67], a[0:3], a[160:163], v[64:67]
  ds_read_b64_tr_b16 a[32:33], v244 offset:1024
  s_mul_i32 s80, s88, 2048
  s_mul_i32 s30, s92, 8192
  s_add_u32 s80, s80, s30
  s_add_u32 s30, s80, 4096
  v_mfma_f32_16x16x32_bf16 v[64:67], a[4:7], a[176:179], v[64:67]
  buffer_load_dwordx4 a[128:131], v16, s[4:7], s30 offen offset:0 sc1
  v_mfma_f32_16x16x32_bf16 v[96:99], a[4:7], a[180:183], v[96:99]
  ds_read_b64_tr_b16 a[34:35], v244 offset:5120
  v_mfma_f32_16x16x32_bf16 v[96:99], a[0:3], a[164:167], v[96:99]
  v_mfma_f32_16x16x32_bf16 v[128:131], a[0:3], a[168:171], v[128:131]
  ds_read_b64_tr_b16 a[36:37], v244 offset:9216
  v_mfma_f32_16x16x32_bf16 v[128:131], a[4:7], a[184:187], v[128:131]
  buffer_load_dwordx4 a[136:139], v16, s[4:7], s30 offen offset:1024 sc1
  v_mfma_f32_16x16x32_bf16 v[160:163], a[4:7], a[188:191], v[160:163]
  ds_read_b64_tr_b16 a[38:39], v244 offset:13312
  v_mfma_f32_16x16x32_bf16 v[160:163], a[0:3], a[172:175], v[160:163]
  v_mfma_f32_16x16x32_bf16 v[164:167], a[8:11], a[172:175], v[164:167]
  ds_read_b64_tr_b16 a[40:41], v245 offset:1024
  s_add_u32 s30, s80, 152064
  v_mfma_f32_16x16x32_bf16 v[164:167], a[12:15], a[188:191], v[164:167]
  buffer_load_dwordx4 a[132:135], v16, s[4:7], s30 offen offset:0 sc1
  v_mfma_f32_16x16x32_bf16 v[132:135], a[12:15], a[184:187], v[132:135]
  ds_read_b64_tr_b16 a[42:43], v245 offset:5120
  v_mfma_f32_16x16x32_bf16 v[132:135], a[8:11], a[168:171], v[132:135]
  v_mfma_f32_16x16x32_bf16 v[100:103], a[8:11], a[164:167], v[100:103]
  ds_read_b64_tr_b16 a[44:45], v245 offset:9216
  v_mfma_f32_16x16x32_bf16 v[100:103], a[12:15], a[180:183], v[100:103]
  buffer_load_dwordx4 a[140:143], v16, s[4:7], s30 offen offset:1024 sc1
  v_mfma_f32_16x16x32_bf16 v[68:71], a[12:15], a[176:179], v[68:71]
  ds_read_b64_tr_b16 a[46:47], v245 offset:13312
  v_mfma_f32_16x16x32_bf16 v[68:71], a[8:11], a[160:163], v[68:71]
  s_waitcnt lgkmcnt(8)
  v_mfma_f32_16x16x32_bf16 v[72:75], a[16:19], a[160:163], v[72:75]
  ds_read_b64_tr_b16 a[48:49], v246 offset:1024
  s_add_u32 m0, s98, 67584
  s_add_u32 s31, s68, 1327104
  v_mfma_f32_16x16x32_bf16 v[72:75], a[20:23], a[176:179], v[72:75]
  buffer_load_dwordx4 v19, s[40:43], s31 offen offset:0 lds
  v_mfma_f32_16x16x32_bf16 v[104:107], a[20:23], a[180:183], v[104:107]
  ds_read_b64_tr_b16 a[50:51], v246 offset:5120
  v_mfma_f32_16x16x32_bf16 v[104:107], a[16:19], a[164:167], v[104:107]
  v_mfma_f32_16x16x32_bf16 v[136:139], a[16:19], a[168:171], v[136:139]
  ds_read_b64_tr_b16 a[52:53], v246 offset:9216
  s_add_u32 m0, s98, 68480
  v_mfma_f32_16x16x32_bf16 v[136:139], a[20:23], a[184:187], v[136:139]
  buffer_load_dwordx4 v19, s[40:43], s31 offen offset:128 lds
  v_mfma_f32_16x16x32_bf16 v[168:171], a[20:23], a[188:191], v[168:171]
  ds_read_b64_tr_b16 a[54:55], v246 offset:13312
  v_mfma_f32_16x16x32_bf16 v[168:171], a[16:19], a[172:175], v[168:171]
  v_mfma_f32_16x16x32_bf16 v[172:175], a[24:27], a[172:175], v[172:175]
  ds_read_b64_tr_b16 a[56:57], v247 offset:1024
  s_mul_i32 s81, s89, 2048
  s_mul_i32 s30, s92, 8192
  s_add_u32 s81, s81, s30
  s_add_u32 s30, s81, 6144
  v_mfma_f32_16x16x32_bf16 v[172:175], a[28:31], a[188:191], v[172:175]
  buffer_load_dwordx4 a[144:147], v16, s[4:7], s30 offen offset:0 sc1
  v_mfma_f32_16x16x32_bf16 v[140:143], a[28:31], a[184:187], v[140:143]
  ds_read_b64_tr_b16 a[58:59], v247 offset:5120
  v_mfma_f32_16x16x32_bf16 v[140:143], a[24:27], a[168:171], v[140:143]
  v_mfma_f32_16x16x32_bf16 v[108:111], a[24:27], a[164:167], v[108:111]
  ds_read_b64_tr_b16 a[60:61], v247 offset:9216
  v_mfma_f32_16x16x32_bf16 v[108:111], a[28:31], a[180:183], v[108:111]
  v_mfma_f32_16x16x32_bf16 v[76:79], a[28:31], a[176:179], v[76:79]
  ds_read_b64_tr_b16 a[62:63], v247 offset:13312
  v_mfma_f32_16x16x32_bf16 v[76:79], a[24:27], a[160:163], v[76:79]
  s_waitcnt lgkmcnt(8)
  v_mfma_f32_16x16x32_bf16 v[80:83], a[32:35], a[160:163], v[80:83]
  ds_read_b64_tr_b16 a[0:1], v236 offset:0
  v_mfma_f32_16x16x32_bf16 v[80:83], a[36:39], a[176:179], v[80:83]
  buffer_load_dwordx4 a[152:155], v16, s[4:7], s30 offen offset:1024 sc1
  v_mfma_f32_16x16x32_bf16 v[112:115], a[36:39], a[180:183], v[112:115]
  ds_read_b64_tr_b16 a[2:3], v236 offset:4096
  v_mfma_f32_16x16x32_bf16 v[112:115], a[32:35], a[164:167], v[112:115]
  v_mfma_f32_16x16x32_bf16 v[144:147], a[32:35], a[168:171], v[144:147]
  ds_read_b64_tr_b16 a[4:5], v236 offset:8192
  s_add_u32 s30, s81, 154112
  v_mfma_f32_16x16x32_bf16 v[144:147], a[36:39], a[184:187], v[144:147]
  buffer_load_dwordx4 a[148:151], v16, s[4:7], s30 offen offset:0 sc1
  v_mfma_f32_16x16x32_bf16 v[176:179], a[36:39], a[188:191], v[176:179]
  ds_read_b64_tr_b16 a[6:7], v236 offset:12288
  v_mfma_f32_16x16x32_bf16 v[176:179], a[32:35], a[172:175], v[176:179]
  v_mfma_f32_16x16x32_bf16 v[180:183], a[40:43], a[172:175], v[180:183]
  ds_read_b64_tr_b16 a[8:9], v237 offset:0
  v_mfma_f32_16x16x32_bf16 v[180:183], a[44:47], a[188:191], v[180:183]
  buffer_load_dwordx4 a[156:159], v16, s[4:7], s30 offen offset:1024 sc1
  v_mfma_f32_16x16x32_bf16 v[148:151], a[44:47], a[184:187], v[148:151]
  ds_read_b64_tr_b16 a[10:11], v237 offset:4096
  v_mfma_f32_16x16x32_bf16 v[148:151], a[40:43], a[168:171], v[148:151]
  v_mfma_f32_16x16x32_bf16 v[116:119], a[40:43], a[164:167], v[116:119]
  ds_read_b64_tr_b16 a[12:13], v237 offset:8192
  s_add_u32 m0, s98, 81920
  s_add_u32 s31, s69, 1441792
  v_mfma_f32_16x16x32_bf16 v[116:119], a[44:47], a[180:183], v[116:119]
  buffer_load_dwordx4 v19, s[40:43], s31 offen offset:0 lds
  v_mfma_f32_16x16x32_bf16 v[84:87], a[44:47], a[176:179], v[84:87]
  ds_read_b64_tr_b16 a[14:15], v237 offset:12288
  v_mfma_f32_16x16x32_bf16 v[84:87], a[40:43], a[160:163], v[84:87]
  s_waitcnt lgkmcnt(8)
  v_mfma_f32_16x16x32_bf16 v[88:91], a[48:51], a[160:163], v[88:91]
  ds_read_b64_tr_b16 a[16:17], v238 offset:0
  s_add_u32 m0, s98, 82816
  v_mfma_f32_16x16x32_bf16 v[88:91], a[52:55], a[176:179], v[88:91]
  buffer_load_dwordx4 v19, s[40:43], s31 offen offset:128 lds
  v_mfma_f32_16x16x32_bf16 v[120:123], a[52:55], a[180:183], v[120:123]
  ds_read_b64_tr_b16 a[18:19], v238 offset:4096
  v_mfma_f32_16x16x32_bf16 v[120:123], a[48:51], a[164:167], v[120:123]
  v_mfma_f32_16x16x32_bf16 v[152:155], a[48:51], a[168:171], v[152:155]
  ds_read_b64_tr_b16 a[20:21], v238 offset:8192
  s_add_u32 m0, s98, 83968
  s_add_u32 s31, s69, 1458176
  v_mfma_f32_16x16x32_bf16 v[152:155], a[52:55], a[184:187], v[152:155]
  buffer_load_dwordx4 v19, s[40:43], s31 offen offset:0 lds
  v_mfma_f32_16x16x32_bf16 v[184:187], a[52:55], a[188:191], v[184:187]
  ds_read_b64_tr_b16 a[22:23], v238 offset:12288
  v_mfma_f32_16x16x32_bf16 v[184:187], a[48:51], a[172:175], v[184:187]
  v_mfma_f32_16x16x32_bf16 v[188:191], a[56:59], a[172:175], v[188:191]
  ds_read_b64_tr_b16 a[24:25], v239 offset:0
  s_add_u32 m0, s98, 84864
  v_mfma_f32_16x16x32_bf16 v[188:191], a[60:63], a[188:191], v[188:191]
  buffer_load_dwordx4 v19, s[40:43], s31 offen offset:128 lds
  v_mfma_f32_16x16x32_bf16 v[156:159], a[60:63], a[184:187], v[156:159]
  ds_read_b64_tr_b16 a[26:27], v239 offset:4096
  v_mfma_f32_16x16x32_bf16 v[156:159], a[56:59], a[168:171], v[156:159]
  v_mfma_f32_16x16x32_bf16 v[124:127], a[56:59], a[164:167], v[124:127]
  ds_read_b64_tr_b16 a[28:29], v239 offset:8192
  v_mfma_f32_16x16x32_bf16 v[124:127], a[60:63], a[180:183], v[124:127]
  v_mfma_f32_16x16x32_bf16 v[92:95], a[60:63], a[176:179], v[92:95]
  ds_read_b64_tr_b16 a[30:31], v239 offset:12288
  v_mfma_f32_16x16x32_bf16 v[92:95], a[56:59], a[160:163], v[92:95]
  s_waitcnt vmcnt(27) lgkmcnt(8)
  v_mfma_f32_16x16x32_bf16 v[64:67], a[0:3], a[64:67], v[64:67]
  ds_read_b64_tr_b16 a[32:33], v236 offset:1024
  s_add_u32 s30, s80, 20480
  v_mfma_f32_16x16x32_bf16 v[64:67], a[4:7], a[80:83], v[64:67]
  buffer_load_dwordx4 a[160:163], v16, s[4:7], s30 offen offset:0 sc1
  v_mfma_f32_16x16x32_bf16 v[96:99], a[4:7], a[84:87], v[96:99]
  ds_read_b64_tr_b16 a[34:35], v236 offset:5120
  v_mfma_f32_16x16x32_bf16 v[96:99], a[0:3], a[68:71], v[96:99]
  v_mfma_f32_16x16x32_bf16 v[128:131], a[0:3], a[72:75], v[128:131]
  ds_read_b64_tr_b16 a[36:37], v236 offset:9216
  v_mfma_f32_16x16x32_bf16 v[128:131], a[4:7], a[88:91], v[128:131]
  buffer_load_dwordx4 a[168:171], v16, s[4:7], s30 offen offset:1024 sc1
  v_mfma_f32_16x16x32_bf16 v[160:163], a[4:7], a[92:95], v[160:163]
  ds_read_b64_tr_b16 a[38:39], v236 offset:13312
  v_mfma_f32_16x16x32_bf16 v[160:163], a[0:3], a[76:79], v[160:163]
  v_mfma_f32_16x16x32_bf16 v[164:167], a[8:11], a[76:79], v[164:167]
  ds_read_b64_tr_b16 a[40:41], v237 offset:1024
  s_add_u32 s30, s80, 168448
  v_mfma_f32_16x16x32_bf16 v[164:167], a[12:15], a[92:95], v[164:167]
  buffer_load_dwordx4 a[164:167], v16, s[4:7], s30 offen offset:0 sc1
  v_mfma_f32_16x16x32_bf16 v[132:135], a[12:15], a[88:91], v[132:135]
  ds_read_b64_tr_b16 a[42:43], v237 offset:5120
  v_mfma_f32_16x16x32_bf16 v[132:135], a[8:11], a[72:75], v[132:135]
  v_mfma_f32_16x16x32_bf16 v[100:103], a[8:11], a[68:71], v[100:103]
  ds_read_b64_tr_b16 a[44:45], v237 offset:9216
  v_mfma_f32_16x16x32_bf16 v[100:103], a[12:15], a[84:87], v[100:103]
  buffer_load_dwordx4 a[172:175], v16, s[4:7], s30 offen offset:1024 sc1
  v_mfma_f32_16x16x32_bf16 v[68:71], a[12:15], a[80:83], v[68:71]
  ds_read_b64_tr_b16 a[46:47], v237 offset:13312
  v_mfma_f32_16x16x32_bf16 v[68:71], a[8:11], a[64:67], v[68:71]
  s_waitcnt lgkmcnt(8)
  v_mfma_f32_16x16x32_bf16 v[72:75], a[16:19], a[64:67], v[72:75]
  ds_read_b64_tr_b16 a[48:49], v238 offset:1024
  s_add_u32 m0, s98, 98304
  s_add_u32 s31, s68, 6291456
  v_mfma_f32_16x16x32_bf16 v[72:75], a[20:23], a[80:83], v[72:75]
  buffer_load_dwordx4 v19, s[44:47], s31 offen offset:0 lds
  v_mfma_f32_16x16x32_bf16 v[104:107], a[20:23], a[84:87], v[104:107]
  ds_read_b64_tr_b16 a[50:51], v238 offset:5120
  v_mfma_f32_16x16x32_bf16 v[104:107], a[16:19], a[68:71], v[104:107]
  v_mfma_f32_16x16x32_bf16 v[136:139], a[16:19], a[72:75], v[136:139]
  ds_read_b64_tr_b16 a[52:53], v238 offset:9216
  s_add_u32 m0, s98, 99200
  v_mfma_f32_16x16x32_bf16 v[136:139], a[20:23], a[88:91], v[136:139]
  buffer_load_dwordx4 v19, s[44:47], s31 offen offset:128 lds
  v_mfma_f32_16x16x32_bf16 v[168:171], a[20:23], a[92:95], v[168:171]
  ds_read_b64_tr_b16 a[54:55], v238 offset:13312
  v_mfma_f32_16x16x32_bf16 v[168:171], a[16:19], a[76:79], v[168:171]
  v_mfma_f32_16x16x32_bf16 v[172:175], a[24:27], a[76:79], v[172:175]
  ds_read_b64_tr_b16 a[56:57], v239 offset:1024
  s_add_u32 m0, s98, 100352
  s_add_u32 s31, s68, 6307840
  v_mfma_f32_16x16x32_bf16 v[172:175], a[28:31], a[92:95], v[172:175]
  buffer_load_dwordx4 v19, s[44:47], s31 offen offset:0 lds
  v_mfma_f32_16x16x32_bf16 v[140:143], a[28:31], a[88:91], v[140:143]
  ds_read_b64_tr_b16 a[58:59], v239 offset:5120
  v_mfma_f32_16x16x32_bf16 v[140:143], a[24:27], a[72:75], v[140:143]
  v_mfma_f32_16x16x32_bf16 v[108:111], a[24:27], a[68:71], v[108:111]
  ds_read_b64_tr_b16 a[60:61], v239 offset:9216
  v_mfma_f32_16x16x32_bf16 v[108:111], a[28:31], a[84:87], v[108:111]
  v_mfma_f32_16x16x32_bf16 v[76:79], a[28:31], a[80:83], v[76:79]
  ds_read_b64_tr_b16 a[62:63], v239 offset:13312
  v_mfma_f32_16x16x32_bf16 v[76:79], a[24:27], a[64:67], v[76:79]
  s_waitcnt lgkmcnt(8)
  s_barrier
  v_mfma_f32_16x16x32_bf16 v[80:83], a[32:35], a[64:67], v[80:83]
  ds_read_b64_tr_b16 a[0:1], v236 offset:16384
  s_add_u32 m0, s98, 101248
  v_mfma_f32_16x16x32_bf16 v[80:83], a[36:39], a[80:83], v[80:83]
  buffer_load_dwordx4 v19, s[44:47], s31 offen offset:128 lds
  v_mfma_f32_16x16x32_bf16 v[112:115], a[36:39], a[84:87], v[112:115]
  ds_read_b64_tr_b16 a[2:3], v236 offset:20480
  v_mfma_f32_16x16x32_bf16 v[112:115], a[32:35], a[68:71], v[112:115]
  v_mfma_f32_16x16x32_bf16 v[144:147], a[32:35], a[72:75], v[144:147]
  ds_read_b64_tr_b16 a[4:5], v236 offset:24576
  s_add_u32 s30, s81, 22528
  v_mfma_f32_16x16x32_bf16 v[144:147], a[36:39], a[88:91], v[144:147]
  buffer_load_dwordx4 a[176:179], v16, s[4:7], s30 offen offset:0 sc1
  v_mfma_f32_16x16x32_bf16 v[176:179], a[36:39], a[92:95], v[176:179]
  ds_read_b64_tr_b16 a[6:7], v236 offset:28672
  v_mfma_f32_16x16x32_bf16 v[176:179], a[32:35], a[76:79], v[176:179]
  v_mfma_f32_16x16x32_bf16 v[180:183], a[40:43], a[76:79], v[180:183]
  ds_read_b64_tr_b16 a[8:9], v237 offset:16384
  v_mfma_f32_16x16x32_bf16 v[180:183], a[44:47], a[92:95], v[180:183]
  buffer_load_dwordx4 a[184:187], v16, s[4:7], s30 offen offset:1024 sc1
  v_mfma_f32_16x16x32_bf16 v[148:151], a[44:47], a[88:91], v[148:151]
  ds_read_b64_tr_b16 a[10:11], v237 offset:20480
  v_mfma_f32_16x16x32_bf16 v[148:151], a[40:43], a[72:75], v[148:151]
  v_mfma_f32_16x16x32_bf16 v[116:119], a[40:43], a[68:71], v[116:119]
  ds_read_b64_tr_b16 a[12:13], v237 offset:24576
  s_add_u32 s30, s81, 170496
  v_mfma_f32_16x16x32_bf16 v[116:119], a[44:47], a[84:87], v[116:119]
  buffer_load_dwordx4 a[180:183], v16, s[4:7], s30 offen offset:0 sc1
  v_mfma_f32_16x16x32_bf16 v[84:87], a[44:47], a[80:83], v[84:87]
  ds_read_b64_tr_b16 a[14:15], v237 offset:28672
  v_mfma_f32_16x16x32_bf16 v[84:87], a[40:43], a[64:67], v[84:87]
  s_waitcnt lgkmcnt(8)
  v_mfma_f32_16x16x32_bf16 v[88:91], a[48:51], a[64:67], v[88:91]
  ds_read_b64_tr_b16 a[16:17], v238 offset:16384
  v_mfma_f32_16x16x32_bf16 v[88:91], a[52:55], a[80:83], v[88:91]
  buffer_load_dwordx4 a[188:191], v16, s[4:7], s30 offen offset:1024 sc1
  v_mfma_f32_16x16x32_bf16 v[120:123], a[52:55], a[84:87], v[120:123]
  ds_read_b64_tr_b16 a[18:19], v238 offset:20480
  v_mfma_f32_16x16x32_bf16 v[120:123], a[48:51], a[68:71], v[120:123]
  v_mfma_f32_16x16x32_bf16 v[152:155], a[48:51], a[72:75], v[152:155]
  ds_read_b64_tr_b16 a[20:21], v238 offset:24576
  s_add_u32 m0, s98, 114688
  s_add_u32 s31, s69, 6422528
  v_mfma_f32_16x16x32_bf16 v[152:155], a[52:55], a[88:91], v[152:155]
  buffer_load_dwordx4 v19, s[44:47], s31 offen offset:0 lds
  v_mfma_f32_16x16x32_bf16 v[184:187], a[52:55], a[92:95], v[184:187]
  ds_read_b64_tr_b16 a[22:23], v238 offset:28672
  v_mfma_f32_16x16x32_bf16 v[184:187], a[48:51], a[76:79], v[184:187]
  v_mfma_f32_16x16x32_bf16 v[188:191], a[56:59], a[76:79], v[188:191]
  ds_read_b64_tr_b16 a[24:25], v239 offset:16384
  s_add_u32 m0, s98, 115584
  v_mfma_f32_16x16x32_bf16 v[188:191], a[60:63], a[92:95], v[188:191]
  buffer_load_dwordx4 v19, s[44:47], s31 offen offset:128 lds
  v_mfma_f32_16x16x32_bf16 v[156:159], a[60:63], a[88:91], v[156:159]
  ds_read_b64_tr_b16 a[26:27], v239 offset:20480
  v_mfma_f32_16x16x32_bf16 v[156:159], a[56:59], a[72:75], v[156:159]
  v_mfma_f32_16x16x32_bf16 v[124:127], a[56:59], a[68:71], v[124:127]
  ds_read_b64_tr_b16 a[28:29], v239 offset:24576
  v_mfma_f32_16x16x32_bf16 v[124:127], a[60:63], a[84:87], v[124:127]
  v_mfma_f32_16x16x32_bf16 v[92:95], a[60:63], a[80:83], v[92:95]
  ds_read_b64_tr_b16 a[30:31], v239 offset:28672
  v_mfma_f32_16x16x32_bf16 v[92:95], a[56:59], a[64:67], v[92:95]
  s_waitcnt vmcnt(33) lgkmcnt(8)
  v_mfma_f32_16x16x32_bf16 v[64:67], a[0:3], a[96:99], v[64:67]
  ds_read_b64_tr_b16 a[32:33], v236 offset:17408
  s_add_u32 s30, s80, 131072
  v_mfma_f32_16x16x32_bf16 v[64:67], a[4:7], a[112:115], v[64:67]
  buffer_load_dwordx4 a[64:67], v16, s[4:7], s30 offen offset:0 sc1
  v_mfma_f32_16x16x32_bf16 v[96:99], a[4:7], a[116:119], v[96:99]
  ds_read_b64_tr_b16 a[34:35], v236 offset:21504
  v_mfma_f32_16x16x32_bf16 v[96:99], a[0:3], a[100:103], v[96:99]
  v_mfma_f32_16x16x32_bf16 v[128:131], a[0:3], a[104:107], v[128:131]
  ds_read_b64_tr_b16 a[36:37], v236 offset:25600
  v_mfma_f32_16x16x32_bf16 v[128:131], a[4:7], a[120:123], v[128:131]
  buffer_load_dwordx4 a[72:75], v16, s[4:7], s30 offen offset:1024 sc1
  v_mfma_f32_16x16x32_bf16 v[160:163], a[4:7], a[124:127], v[160:163]
  ds_read_b64_tr_b16 a[38:39], v236 offset:29696
  v_mfma_f32_16x16x32_bf16 v[160:163], a[0:3], a[108:111], v[160:163]
  v_mfma_f32_16x16x32_bf16 v[164:167], a[8:11], a[108:111], v[164:167]
  ds_read_b64_tr_b16 a[40:41], v237 offset:17408
  s_add_u32 s30, s80, 279040
  v_mfma_f32_16x16x32_bf16 v[164:167], a[12:15], a[124:127], v[164:167]
  buffer_load_dwordx4 a[68:71], v16, s[4:7], s30 offen offset:0 sc1
  v_mfma_f32_16x16x32_bf16 v[132:135], a[12:15], a[120:123], v[132:135]
  ds_read_b64_tr_b16 a[42:43], v237 offset:21504
  v_mfma_f32_16x16x32_bf16 v[132:135], a[8:11], a[104:107], v[132:135]
  v_mfma_f32_16x16x32_bf16 v[100:103], a[8:11], a[100:103], v[100:103]
  ds_read_b64_tr_b16 a[44:45], v237 offset:25600
  v_mfma_f32_16x16x32_bf16 v[100:103], a[12:15], a[116:119], v[100:103]
  buffer_load_dwordx4 a[76:79], v16, s[4:7], s30 offen offset:1024 sc1
  v_mfma_f32_16x16x32_bf16 v[68:71], a[12:15], a[112:115], v[68:71]
  ds_read_b64_tr_b16 a[46:47], v237 offset:29696
  v_mfma_f32_16x16x32_bf16 v[68:71], a[8:11], a[96:99], v[68:71]
  s_waitcnt lgkmcnt(8)
  v_mfma_f32_16x16x32_bf16 v[72:75], a[16:19], a[96:99], v[72:75]
  ds_read_b64_tr_b16 a[48:49], v238 offset:17408
  s_add_u32 m0, s98, 116736
  s_add_u32 s31, s69, 6438912
  v_mfma_f32_16x16x32_bf16 v[72:75], a[20:23], a[112:115], v[72:75]
  buffer_load_dwordx4 v19, s[44:47], s31 offen offset:0 lds
  v_mfma_f32_16x16x32_bf16 v[104:107], a[20:23], a[116:119], v[104:107]
  ds_read_b64_tr_b16 a[50:51], v238 offset:21504
  v_mfma_f32_16x16x32_bf16 v[104:107], a[16:19], a[100:103], v[104:107]
  v_mfma_f32_16x16x32_bf16 v[136:139], a[16:19], a[104:107], v[136:139]
  ds_read_b64_tr_b16 a[52:53], v238 offset:25600
  s_add_u32 m0, s98, 117632
  v_mfma_f32_16x16x32_bf16 v[136:139], a[20:23], a[120:123], v[136:139]
  buffer_load_dwordx4 v19, s[44:47], s31 offen offset:128 lds
  v_mfma_f32_16x16x32_bf16 v[168:171], a[20:23], a[124:127], v[168:171]
  ds_read_b64_tr_b16 a[54:55], v238 offset:29696
  v_mfma_f32_16x16x32_bf16 v[168:171], a[16:19], a[108:111], v[168:171]
  v_mfma_f32_16x16x32_bf16 v[172:175], a[24:27], a[108:111], v[172:175]
  ds_read_b64_tr_b16 a[56:57], v239 offset:17408
  s_add_u32 m0, s98, 131072
  s_add_u32 s31, s68, 6553600
  v_mfma_f32_16x16x32_bf16 v[172:175], a[28:31], a[124:127], v[172:175]
  buffer_load_dwordx4 v19, s[44:47], s31 offen offset:0 lds
  v_mfma_f32_16x16x32_bf16 v[140:143], a[28:31], a[120:123], v[140:143]
  ds_read_b64_tr_b16 a[58:59], v239 offset:21504
  v_mfma_f32_16x16x32_bf16 v[140:143], a[24:27], a[104:107], v[140:143]
  v_mfma_f32_16x16x32_bf16 v[108:111], a[24:27], a[100:103], v[108:111]
  ds_read_b64_tr_b16 a[60:61], v239 offset:25600
  v_mfma_f32_16x16x32_bf16 v[108:111], a[28:31], a[116:119], v[108:111]
  v_mfma_f32_16x16x32_bf16 v[76:79], a[28:31], a[112:115], v[76:79]
  ds_read_b64_tr_b16 a[62:63], v239 offset:29696
  v_mfma_f32_16x16x32_bf16 v[76:79], a[24:27], a[96:99], v[76:79]
  s_waitcnt lgkmcnt(8)
  v_mfma_f32_16x16x32_bf16 v[80:83], a[32:35], a[96:99], v[80:83]
  ds_read_b64_tr_b16 a[0:1], v236 offset:32768
  v_cvt_pk_bf16_f32 v128, v128, v129
  v_mfma_f32_16x16x32_bf16 v[80:83], a[36:39], a[112:115], v[80:83]
  v_cvt_pk_bf16_f32 v129, v130, v131
  v_mfma_f32_16x16x32_bf16 v[112:115], a[36:39], a[116:119], v[112:115]
  ds_read_b64_tr_b16 a[2:3], v236 offset:36864
  v_cvt_pk_bf16_f32 v130, v132, v133
  v_mfma_f32_16x16x32_bf16 v[112:115], a[32:35], a[100:103], v[112:115]
  v_cvt_pk_bf16_f32 v131, v134, v135
  v_mfma_f32_16x16x32_bf16 v[144:147], a[32:35], a[104:107], v[144:147]
  ds_read_b64_tr_b16 a[4:5], v236 offset:40960
  buffer_store_dwordx4 v[128:131], v12, s[56:59], 0 offen offset:0 sc1
  v_mfma_f32_16x16x32_bf16 v[144:147], a[36:39], a[120:123], v[144:147]
  v_cvt_pk_bf16_f32 v160, v160, v161
  v_mfma_f32_16x16x32_bf16 v[176:179], a[36:39], a[124:127], v[176:179]
  ds_read_b64_tr_b16 a[6:7], v236 offset:45056
La_pad12:
  s_cbranch_execz La_ret1
  s_nop 0
  v_cvt_pk_bf16_f32 v161, v162, v163
  v_mfma_f32_16x16x32_bf16 v[176:179], a[32:35], a[108:111], v[176:179]
  v_cvt_pk_bf16_f32 v162, v164, v165
  v_mfma_f32_16x16x32_bf16 v[180:183], a[40:43], a[108:111], v[180:183]
  ds_read_b64_tr_b16 a[8:9], v237 offset:32768
  v_cvt_pk_bf16_f32 v163, v166, v167
  v_mfma_f32_16x16x32_bf16 v[180:183], a[44:47], a[124:127], v[180:183]
  buffer_store_dwordx4 v[160:163], v12, s[56:59], s34 offen offset:0 sc1
  v_mfma_f32_16x16x32_bf16 v[148:151], a[44:47], a[120:123], v[148:151]
  ds_read_b64_tr_b16 a[10:11], v237 offset:36864
  v_cvt_pk_bf16_f32 v136, v136, v137
  v_mfma_f32_16x16x32_bf16 v[148:151], a[40:43], a[104:107], v[148:151]
  v_cvt_pk_bf16_f32 v137, v138, v139
  v_mfma_f32_16x16x32_bf16 v[116:119], a[40:43], a[100:103], v[116:119]
  ds_read_b64_tr_b16 a[12:13], v237 offset:40960
  v_cvt_pk_bf16_f32 v138, v140, v141
  v_mfma_f32_16x16x32_bf16 v[116:119], a[44:47], a[116:119], v[116:119]
  v_cvt_pk_bf16_f32 v139, v142, v143
  v_mfma_f32_16x16x32_bf16 v[84:87], a[44:47], a[112:115], v[84:87]
  ds_read_b64_tr_b16 a[14:15], v237 offset:45056
  buffer_store_dwordx4 v[136:139], v12, s[56:59], 0 offen offset:1024 sc1
  v_mfma_f32_16x16x32_bf16 v[84:87], a[40:43], a[96:99], v[84:87]
  v_cvt_pk_bf16_f32 v168, v168, v169
  s_waitcnt lgkmcnt(8)
  v_mfma_f32_16x16x32_bf16 v[88:91], a[48:51], a[96:99], v[88:91]
  ds_read_b64_tr_b16 a[16:17], v238 offset:32768
  v_cvt_pk_bf16_f32 v169, v170, v171
  v_mfma_f32_16x16x32_bf16 v[88:91], a[52:55], a[112:115], v[88:91]
  v_cvt_pk_bf16_f32 v170, v172, v173
  v_mfma_f32_16x16x32_bf16 v[120:123], a[52:55], a[116:119], v[120:123]
  ds_read_b64_tr_b16 a[18:19], v238 offset:36864
  v_cvt_pk_bf16_f32 v171, v174, v175
  v_mfma_f32_16x16x32_bf16 v[120:123], a[48:51], a[100:103], v[120:123]
  buffer_store_dwordx4 v[168:171], v12, s[56:59], s34 offen offset:1024 sc1
  v_mfma_f32_16x16x32_bf16 v[152:155], a[48:51], a[104:107], v[152:155]
  ds_read_b64_tr_b16 a[20:21], v238 offset:40960
  v_cvt_pk_bf16_f32 v144, v144, v145
  v_mfma_f32_16x16x32_bf16 v[152:155], a[52:55], a[120:123], v[152:155]
  v_cvt_pk_bf16_f32 v145, v146, v147
  v_mfma_f32_16x16x32_bf16 v[184:187], a[52:55], a[124:127], v[184:187]
  ds_read_b64_tr_b16 a[22:23], v238 offset:45056
  v_cvt_pk_bf16_f32 v146, v148, v149
  v_mfma_f32_16x16x32_bf16 v[184:187], a[48:51], a[108:111], v[184:187]
  v_cvt_pk_bf16_f32 v147, v150, v151
  v_mfma_f32_16x16x32_bf16 v[188:191], a[56:59], a[108:111], v[188:191]
  ds_read_b64_tr_b16 a[24:25], v239 offset:32768
  buffer_store_dwordx4 v[144:147], v12, s[56:59], 0 offen offset:2048 sc1
  v_mfma_f32_16x16x32_bf16 v[188:191], a[60:63], a[124:127], v[188:191]
  v_mfma_f32_16x16x32_bf16 v[156:159], a[60:63], a[120:123], v[156:159]
  ds_read_b64_tr_b16 a[26:27], v239 offset:36864
  v_cvt_pk_bf16_f32 v176, v176, v177
  v_mfma_f32_16x16x32_bf16 v[156:159], a[56:59], a[104:107], v[156:159]
  v_cvt_pk_bf16_f32 v177, v178, v179
  v_mfma_f32_16x16x32_bf16 v[124:127], a[56:59], a[100:103], v[124:127]
  ds_read_b64_tr_b16 a[28:29], v239 offset:40960
  v_cvt_pk_bf16_f32 v178, v180, v181
  v_mfma_f32_16x16x32_bf16 v[124:127], a[60:63], a[116:119], v[124:127]
  v_cvt_pk_bf16_f32 v179, v182, v183
  v_mfma_f32_16x16x32_bf16 v[92:95], a[60:63], a[112:115], v[92:95]
  ds_read_b64_tr_b16 a[30:31], v239 offset:45056
  buffer_store_dwordx4 v[176:179], v12, s[56:59], s34 offen offset:2048 sc1
  v_mfma_f32_16x16x32_bf16 v[92:95], a[56:59], a[96:99], v[92:95]
  s_waitcnt vmcnt(37) lgkmcnt(8)
  v_mfma_f32_16x16x32_bf16 v[64:67], a[0:3], a[128:131], v[64:67]
  ds_read_b64_tr_b16 a[32:33], v236 offset:33792
  v_mfma_f32_16x16x32_bf16 v[64:67], a[4:7], a[136:139], v[64:67]
  ds_read_b64_tr_b16 a[34:35], v236 offset:37888
  v_mfma_f32_16x16x32_bf16 v[96:99], a[4:7], a[140:143], v[96:99]
  ds_read_b64_tr_b16 a[36:37], v236 offset:41984
  v_mfma_f32_16x16x32_bf16 v[96:99], a[0:3], a[132:135], v[96:99]
  ds_read_b64_tr_b16 a[38:39], v236 offset:46080
  v_mfma_f32_16x16x32_bf16 v[100:103], a[8:11], a[132:135], v[100:103]
  ds_read_b64_tr_b16 a[40:41], v237 offset:33792
  v_cvt_pk_bf16_f32 v152, v152, v153
  v_mfma_f32_16x16x32_bf16 v[100:103], a[12:15], a[140:143], v[100:103]
  ds_read_b64_tr_b16 a[42:43], v237 offset:37888
  v_cvt_pk_bf16_f32 v153, v154, v155
  v_mfma_f32_16x16x32_bf16 v[68:71], a[12:15], a[136:139], v[68:71]
  ds_read_b64_tr_b16 a[44:45], v237 offset:41984
  v_cvt_pk_bf16_f32 v154, v156, v157
  v_mfma_f32_16x16x32_bf16 v[68:71], a[8:11], a[128:131], v[68:71]
  ds_read_b64_tr_b16 a[46:47], v237 offset:46080
  v_cvt_pk_bf16_f32 v155, v158, v159
  s_waitcnt lgkmcnt(8)
  v_mfma_f32_16x16x32_bf16 v[72:75], a[16:19], a[128:131], v[72:75]
  ds_read_b64_tr_b16 a[48:49], v238 offset:33792
  buffer_store_dwordx4 v[152:155], v12, s[56:59], 0 offen offset:3072 sc1
  v_mfma_f32_16x16x32_bf16 v[72:75], a[20:23], a[136:139], v[72:75]
  ds_read_b64_tr_b16 a[50:51], v238 offset:37888
  v_mfma_f32_16x16x32_bf16 v[104:107], a[20:23], a[140:143], v[104:107]
  ds_read_b64_tr_b16 a[52:53], v238 offset:41984
  v_cvt_pk_bf16_f32 v184, v184, v185
  v_mfma_f32_16x16x32_bf16 v[104:107], a[16:19], a[132:135], v[104:107]
  ds_read_b64_tr_b16 a[54:55], v238 offset:46080
  v_cvt_pk_bf16_f32 v185, v186, v187
  v_mfma_f32_16x16x32_bf16 v[108:111], a[24:27], a[132:135], v[108:111]
  ds_read_b64_tr_b16 a[56:57], v239 offset:33792
  v_cvt_pk_bf16_f32 v186, v188, v189
  v_mfma_f32_16x16x32_bf16 v[108:111], a[28:31], a[140:143], v[108:111]
  ds_read_b64_tr_b16 a[58:59], v239 offset:37888
  v_cvt_pk_bf16_f32 v187, v190, v191
  v_mfma_f32_16x16x32_bf16 v[76:79], a[28:31], a[136:139], v[76:79]
  ds_read_b64_tr_b16 a[60:61], v239 offset:41984
  buffer_store_dwordx4 v[184:187], v12, s[56:59], s34 offen offset:3072 sc1
  v_mfma_f32_16x16x32_bf16 v[76:79], a[24:27], a[128:131], v[76:79]
  ds_read_b64_tr_b16 a[62:63], v239 offset:46080
  s_waitcnt vmcnt(37) lgkmcnt(8)
  s_barrier
  v_mfma_f32_16x16x32_bf16 v[80:83], a[32:35], a[128:131], v[80:83]
  ds_read_b64_tr_b16 a[0:1], v236 offset:49152
  v_mfma_f32_16x16x32_bf16 v[80:83], a[36:39], a[136:139], v[80:83]
  ds_read_b64_tr_b16 a[2:3], v236 offset:53248
  v_mfma_f32_16x16x32_bf16 v[112:115], a[36:39], a[140:143], v[112:115]
  ds_read_b64_tr_b16 a[4:5], v236 offset:57344
  v_mfma_f32_16x16x32_bf16 v[112:115], a[32:35], a[132:135], v[112:115]
  ds_read_b64_tr_b16 a[6:7], v236 offset:61440
  v_mfma_f32_16x16x32_bf16 v[116:119], a[40:43], a[132:135], v[116:119]
  ds_read_b64_tr_b16 a[8:9], v237 offset:49152
  v_mfma_f32_16x16x32_bf16 v[116:119], a[44:47], a[140:143], v[116:119]
  ds_read_b64_tr_b16 a[10:11], v237 offset:53248
  v_mfma_f32_16x16x32_bf16 v[84:87], a[44:47], a[136:139], v[84:87]
  ds_read_b64_tr_b16 a[12:13], v237 offset:57344
  v_mfma_f32_16x16x32_bf16 v[84:87], a[40:43], a[128:131], v[84:87]
  ds_read_b64_tr_b16 a[14:15], v237 offset:61440
  s_waitcnt lgkmcnt(8)
  v_mfma_f32_16x16x32_bf16 v[88:91], a[48:51], a[128:131], v[88:91]
  ds_read_b64_tr_b16 a[16:17], v238 offset:49152
  v_mfma_f32_16x16x32_bf16 v[88:91], a[52:55], a[136:139], v[88:91]
  ds_read_b64_tr_b16 a[18:19], v238 offset:53248
  v_mfma_f32_16x16x32_bf16 v[120:123], a[52:55], a[140:143], v[120:123]
  ds_read_b64_tr_b16 a[20:21], v238 offset:57344
  v_mfma_f32_16x16x32_bf16 v[120:123], a[48:51], a[132:135], v[120:123]
  ds_read_b64_tr_b16 a[22:23], v238 offset:61440
  v_mfma_f32_16x16x32_bf16 v[124:127], a[56:59], a[132:135], v[124:127]
  ds_read_b64_tr_b16 a[24:25], v239 offset:49152
  v_mfma_f32_16x16x32_bf16 v[124:127], a[60:63], a[140:143], v[124:127]
  ds_read_b64_tr_b16 a[26:27], v239 offset:53248
  v_mfma_f32_16x16x32_bf16 v[92:95], a[60:63], a[136:139], v[92:95]
  ds_read_b64_tr_b16 a[28:29], v239 offset:57344
  v_mfma_f32_16x16x32_bf16 v[92:95], a[56:59], a[128:131], v[92:95]
  ds_read_b64_tr_b16 a[30:31], v239 offset:61440
  s_waitcnt vmcnt(33) lgkmcnt(8)
  v_mfma_f32_16x16x32_bf16 v[64:67], a[0:3], a[144:147], v[64:67]
  ds_read_b64_tr_b16 a[32:33], v236 offset:50176
  s_add_u32 m0, s98, 131968
  v_mfma_f32_16x16x32_bf16 v[64:67], a[4:7], a[152:155], v[64:67]
  ds_read_b64_tr_b16 a[34:35], v236 offset:54272
  buffer_load_dwordx4 v19, s[44:47], s31 offen offset:128 lds
  v_mfma_f32_16x16x32_bf16 v[96:99], a[4:7], a[156:159], v[96:99]
  ds_read_b64_tr_b16 a[36:37], v236 offset:58368
  v_mfma_f32_16x16x32_bf16 v[96:99], a[0:3], a[148:151], v[96:99]
  ds_read_b64_tr_b16 a[38:39], v236 offset:62464
  v_mfma_f32_16x16x32_bf16 v[100:103], a[8:11], a[148:151], v[100:103]
  ds_read_b64_tr_b16 a[40:41], v237 offset:50176
  s_add_u32 m0, s98, 133120
  s_add_u32 s31, s68, 6569984
  v_mfma_f32_16x16x32_bf16 v[100:103], a[12:15], a[156:159], v[100:103]
  ds_read_b64_tr_b16 a[42:43], v237 offset:54272
  buffer_load_dwordx4 v19, s[44:47], s31 offen offset:0 lds
  v_mfma_f32_16x16x32_bf16 v[68:71], a[12:15], a[152:155], v[68:71]
  ds_read_b64_tr_b16 a[44:45], v237 offset:58368
  v_mfma_f32_16x16x32_bf16 v[68:71], a[8:11], a[144:147], v[68:71]
  ds_read_b64_tr_b16 a[46:47], v237 offset:62464
  s_waitcnt lgkmcnt(8)
  v_mfma_f32_16x16x32_bf16 v[72:75], a[16:19], a[144:147], v[72:75]
  ds_read_b64_tr_b16 a[48:49], v238 offset:50176
  s_add_u32 m0, s98, 134016
  v_mfma_f32_16x16x32_bf16 v[72:75], a[20:23], a[152:155], v[72:75]
  ds_read_b64_tr_b16 a[50:51], v238 offset:54272
  buffer_load_dwordx4 v19, s[44:47], s31 offen offset:128 lds
  v_mfma_f32_16x16x32_bf16 v[104:107], a[20:23], a[156:159], v[104:107]
  ds_read_b64_tr_b16 a[52:53], v238 offset:58368
  v_mfma_f32_16x16x32_bf16 v[104:107], a[16:19], a[148:151], v[104:107]
  ds_read_b64_tr_b16 a[54:55], v238 offset:62464
  v_mfma_f32_16x16x32_bf16 v[108:111], a[24:27], a[148:151], v[108:111]
  ds_read_b64_tr_b16 a[56:57], v239 offset:50176
  v_mfma_f32_16x16x32_bf16 v[108:111], a[28:31], a[156:159], v[108:111]
  ds_read_b64_tr_b16 a[58:59], v239 offset:54272
  v_mfma_f32_16x16x32_bf16 v[76:79], a[28:31], a[152:155], v[76:79]
  ds_read_b64_tr_b16 a[60:61], v239 offset:58368
  v_mfma_f32_16x16x32_bf16 v[76:79], a[24:27], a[144:147], v[76:79]
  ds_read_b64_tr_b16 a[62:63], v239 offset:62464
  s_waitcnt lgkmcnt(8)
  v_mfma_f32_16x16x32_bf16 v[80:83], a[32:35], a[144:147], v[80:83]
  ds_read_b64_tr_b16 a[0:1], v240 offset:0
  s_add_u32 s30, s81, 133120
  v_mfma_f32_16x16x32_bf16 v[80:83], a[36:39], a[152:155], v[80:83]
  ds_read_b64_tr_b16 a[2:3], v240 offset:4096
  buffer_load_dwordx4 a[80:83], v16, s[4:7], s30 offen offset:0 sc1
  v_mfma_f32_16x16x32_bf16 v[112:115], a[36:39], a[156:159], v[112:115]
  ds_read_b64_tr_b16 a[4:5], v240 offset:8192
  v_mfma_f32_16x16x32_bf16 v[112:115], a[32:35], a[148:151], v[112:115]
  ds_read_b64_tr_b16 a[6:7], v240 offset:12288
  v_mfma_f32_16x16x32_bf16 v[116:119], a[40:43], a[148:151], v[116:119]
  ds_read_b64_tr_b16 a[8:9], v241 offset:0
  v_mfma_f32_16x16x32_bf16 v[116:119], a[44:47], a[156:159], v[116:119]
  ds_read_b64_tr_b16 a[10:11], v241 offset:4096
  buffer_load_dwordx4 a[88:91], v16, s[4:7], s30 offen offset:1024 sc1
  v_mfma_f32_16x16x32_bf16 v[84:87], a[44:47], a[152:155], v[84:87]
  ds_read_b64_tr_b16 a[12:13], v241 offset:8192
  v_mfma_f32_16x16x32_bf16 v[84:87], a[40:43], a[144:147], v[84:87]
  ds_read_b64_tr_b16 a[14:15], v241 offset:12288
  s_waitcnt lgkmcnt(8)
  v_mfma_f32_16x16x32_bf16 v[88:91], a[48:51], a[144:147], v[88:91]
  ds_read_b64_tr_b16 a[16:17], v242 offset:0
  s_add_u32 s30, s81, 281088
  v_mfma_f32_16x16x32_bf16 v[88:91], a[52:55], a[152:155], v[88:91]
  ds_read_b64_tr_b16 a[18:19], v242 offset:4096
  buffer_load_dwordx4 a[84:87], v16, s[4:7], s30 offen offset:0 sc1
  v_mfma_f32_16x16x32_bf16 v[120:123], a[52:55], a[156:159], v[120:123]
  ds_read_b64_tr_b16 a[20:21], v242 offset:8192
  v_mfma_f32_16x16x32_bf16 v[120:123], a[48:51], a[148:151], v[120:123]
  ds_read_b64_tr_b16 a[22:23], v242 offset:12288
  v_mfma_f32_16x16x32_bf16 v[124:127], a[56:59], a[148:151], v[124:127]
  ds_read_b64_tr_b16 a[24:25], v243 offset:0
  v_mfma_f32_16x16x32_bf16 v[124:127], a[60:63], a[156:159], v[124:127]
  ds_read_b64_tr_b16 a[26:27], v243 offset:4096
  v_mfma_f32_16x16x32_bf16 v[92:95], a[60:63], a[152:155], v[92:95]
  ds_read_b64_tr_b16 a[28:29], v243 offset:8192
  v_mfma_f32_16x16x32_bf16 v[92:95], a[56:59], a[144:147], v[92:95]
  ds_read_b64_tr_b16 a[30:31], v243 offset:12288
  s_waitcnt vmcnt(6) lgkmcnt(8)
  v_mfma_f32_16x16x32_bf16 v[64:67], a[0:3], a[160:163], v[64:67]
  ds_read_b64_tr_b16 a[32:33], v240 offset:1024
  s_mov_b64 exec, 2
  buffer_store_dword v35, v29, s[16:19], 0 offen sc1
  s_mov_b64 exec, -1
  v_mfma_f32_16x16x32_bf16 v[64:67], a[4:7], a[168:171], v[64:67]
  ds_read_b64_tr_b16 a[34:35], v240 offset:5120
  buffer_load_dwordx4 a[92:95], v16, s[4:7], s30 offen offset:1024 sc1
  v_mfma_f32_16x16x32_bf16 v[96:99], a[4:7], a[172:175], v[96:99]
  ds_read_b64_tr_b16 a[36:37], v240 offset:9216
  v_mfma_f32_16x16x32_bf16 v[96:99], a[0:3], a[164:167], v[96:99]
  ds_read_b64_tr_b16 a[38:39], v240 offset:13312
  v_mfma_f32_16x16x32_bf16 v[100:103], a[8:11], a[164:167], v[100:103]
  ds_read_b64_tr_b16 a[40:41], v241 offset:1024
  s_add_u32 s30, s80, 135168
  v_mfma_f32_16x16x32_bf16 v[100:103], a[12:15], a[172:175], v[100:103]
  ds_read_b64_tr_b16 a[42:43], v241 offset:5120
  buffer_load_dwordx4 a[96:99], v16, s[4:7], s30 offen offset:0 sc1
  v_mfma_f32_16x16x32_bf16 v[68:71], a[12:15], a[168:171], v[68:71]
  ds_read_b64_tr_b16 a[44:45], v241 offset:9216
  v_mfma_f32_16x16x32_bf16 v[68:71], a[8:11], a[160:163], v[68:71]
  ds_read_b64_tr_b16 a[46:47], v241 offset:13312
  s_waitcnt lgkmcnt(8)
  v_mfma_f32_16x16x32_bf16 v[72:75], a[16:19], a[160:163], v[72:75]
  ds_read_b64_tr_b16 a[48:49], v242 offset:1024
  v_mfma_f32_16x16x32_bf16 v[72:75], a[20:23], a[168:171], v[72:75]
  ds_read_b64_tr_b16 a[50:51], v242 offset:5120
  buffer_load_dwordx4 a[104:107], v16, s[4:7], s30 offen offset:1024 sc1
  v_mfma_f32_16x16x32_bf16 v[104:107], a[20:23], a[172:175], v[104:107]
  ds_read_b64_tr_b16 a[52:53], v242 offset:9216
  v_mfma_f32_16x16x32_bf16 v[104:107], a[16:19], a[164:167], v[104:107]
  ds_read_b64_tr_b16 a[54:55], v242 offset:13312
  v_mfma_f32_16x16x32_bf16 v[108:111], a[24:27], a[164:167], v[108:111]
  ds_read_b64_tr_b16 a[56:57], v243 offset:1024
  v_mfma_f32_16x16x32_bf16 v[108:111], a[28:31], a[172:175], v[108:111]
  ds_read_b64_tr_b16 a[58:59], v243 offset:5120
  v_mfma_f32_16x16x32_bf16 v[76:79], a[28:31], a[168:171], v[76:79]
  ds_read_b64_tr_b16 a[60:61], v243 offset:9216
  v_mfma_f32_16x16x32_bf16 v[76:79], a[24:27], a[160:163], v[76:79]
  ds_read_b64_tr_b16 a[62:63], v243 offset:13312
  s_waitcnt lgkmcnt(8)
  s_barrier
  v_mfma_f32_16x16x32_bf16 v[80:83], a[32:35], a[160:163], v[80:83]
  ds_read_b64_tr_b16 a[0:1], v240 offset:16384
  s_add_u32 s30, s80, 283136
  v_mfma_f32_16x16x32_bf16 v[80:83], a[36:39], a[168:171], v[80:83]
  ds_read_b64_tr_b16 a[2:3], v240 offset:20480
  buffer_load_dwordx4 a[100:103], v16, s[4:7], s30 offen offset:0 sc1
  v_mfma_f32_16x16x32_bf16 v[112:115], a[36:39], a[172:175], v[112:115]
  ds_read_b64_tr_b16 a[4:5], v240 offset:24576
  v_mfma_f32_16x16x32_bf16 v[112:115], a[32:35], a[164:167], v[112:115]
  ds_read_b64_tr_b16 a[6:7], v240 offset:28672
  v_mfma_f32_16x16x32_bf16 v[116:119], a[40:43], a[164:167], v[116:119]
  ds_read_b64_tr_b16 a[8:9], v241 offset:16384
  v_mfma_f32_16x16x32_bf16 v[116:119], a[44:47], a[172:175], v[116:119]
  ds_read_b64_tr_b16 a[10:11], v241 offset:20480
  buffer_load_dwordx4 a[108:111], v16, s[4:7], s30 offen offset:1024 sc1
  v_mfma_f32_16x16x32_bf16 v[84:87], a[44:47], a[168:171], v[84:87]
  ds_read_b64_tr_b16 a[12:13], v241 offset:24576
  v_mfma_f32_16x16x32_bf16 v[84:87], a[40:43], a[160:163], v[84:87]
  ds_read_b64_tr_b16 a[14:15], v241 offset:28672
  s_waitcnt lgkmcnt(8)
  v_mfma_f32_16x16x32_bf16 v[88:91], a[48:51], a[160:163], v[88:91]
  ds_read_b64_tr_b16 a[16:17], v242 offset:16384
  s_add_u32 m0, s98, 0
  s_add_u32 s31, s69, 6684672
  v_mfma_f32_16x16x32_bf16 v[88:91], a[52:55], a[168:171], v[88:91]
  ds_read_b64_tr_b16 a[18:19], v242 offset:20480
  buffer_load_dwordx4 v19, s[44:47], s31 offen offset:0 lds
  v_mfma_f32_16x16x32_bf16 v[120:123], a[52:55], a[172:175], v[120:123]
  ds_read_b64_tr_b16 a[20:21], v242 offset:24576
  v_mfma_f32_16x16x32_bf16 v[120:123], a[48:51], a[164:167], v[120:123]
  ds_read_b64_tr_b16 a[22:23], v242 offset:28672
  v_mfma_f32_16x16x32_bf16 v[124:127], a[56:59], a[164:167], v[124:127]
  ds_read_b64_tr_b16 a[24:25], v243 offset:16384
  v_mfma_f32_16x16x32_bf16 v[124:127], a[60:63], a[172:175], v[124:127]
  ds_read_b64_tr_b16 a[26:27], v243 offset:20480
  v_mfma_f32_16x16x32_bf16 v[92:95], a[60:63], a[168:171], v[92:95]
  ds_read_b64_tr_b16 a[28:29], v243 offset:24576
  v_mfma_f32_16x16x32_bf16 v[92:95], a[56:59], a[160:163], v[92:95]
  ds_read_b64_tr_b16 a[30:31], v243 offset:28672
  s_waitcnt lgkmcnt(8)
  v_mfma_f32_16x16x32_bf16 v[64:67], a[0:3], a[176:179], v[64:67]
  ds_read_b64_tr_b16 a[32:33], v240 offset:17408
  s_add_u32 m0, s98, 896
  v_mfma_f32_16x16x32_bf16 v[64:67], a[4:7], a[184:187], v[64:67]
  ds_read_b64_tr_b16 a[34:35], v240 offset:21504
  buffer_load_dwordx4 v19, s[44:47], s31 offen offset:128 lds
  v_mfma_f32_16x16x32_bf16 v[96:99], a[4:7], a[188:191], v[96:99]
  ds_read_b64_tr_b16 a[36:37], v240 offset:25600
  v_mfma_f32_16x16x32_bf16 v[96:99], a[0:3], a[180:183], v[96:99]
  ds_read_b64_tr_b16 a[38:39], v240 offset:29696
  v_mfma_f32_16x16x32_bf16 v[100:103], a[8:11], a[180:183], v[100:103]
  ds_read_b64_tr_b16 a[40:41], v241 offset:17408
  s_add_u32 m0, s98, 2048
  s_add_u32 s31, s69, 6701056
  v_mfma_f32_16x16x32_bf16 v[100:103], a[12:15], a[188:191], v[100:103]
  ds_read_b64_tr_b16 a[42:43], v241 offset:21504
  buffer_load_dwordx4 v19, s[44:47], s31 offen offset:0 lds
  v_mfma_f32_16x16x32_bf16 v[68:71], a[12:15], a[184:187], v[68:71]
  ds_read_b64_tr_b16 a[44:45], v241 offset:25600
  v_mfma_f32_16x16x32_bf16 v[68:71], a[8:11], a[176:179], v[68:71]
  ds_read_b64_tr_b16 a[46:47], v241 offset:29696
  s_waitcnt lgkmcnt(8)
  v_mfma_f32_16x16x32_bf16 v[72:75], a[16:19], a[176:179], v[72:75]
  ds_read_b64_tr_b16 a[48:49], v242 offset:17408
  s_add_u32 m0, s98, 2944
  v_mfma_f32_16x16x32_bf16 v[72:75], a[20:23], a[184:187], v[72:75]
  ds_read_b64_tr_b16 a[50:51], v242 offset:21504
  buffer_load_dwordx4 v19, s[44:47], s31 offen offset:128 lds
  v_mfma_f32_16x16x32_bf16 v[104:107], a[20:23], a[188:191], v[104:107]
  ds_read_b64_tr_b16 a[52:53], v242 offset:25600
  v_mfma_f32_16x16x32_bf16 v[104:107], a[16:19], a[180:183], v[104:107]
  ds_read_b64_tr_b16 a[54:55], v242 offset:29696
  v_mfma_f32_16x16x32_bf16 v[108:111], a[24:27], a[180:183], v[108:111]
  ds_read_b64_tr_b16 a[56:57], v243 offset:17408
  v_mfma_f32_16x16x32_bf16 v[108:111], a[28:31], a[188:191], v[108:111]
  ds_read_b64_tr_b16 a[58:59], v243 offset:21504
  v_mfma_f32_16x16x32_bf16 v[76:79], a[28:31], a[184:187], v[76:79]
  ds_read_b64_tr_b16 a[60:61], v243 offset:25600
  v_mfma_f32_16x16x32_bf16 v[76:79], a[24:27], a[176:179], v[76:79]
  ds_read_b64_tr_b16 a[62:63], v243 offset:29696
  s_waitcnt lgkmcnt(8)
  v_mfma_f32_16x16x32_bf16 v[80:83], a[32:35], a[176:179], v[80:83]
  ds_read_b64_tr_b16 a[0:1], v240 offset:32768
  buffer_load_dword v25, v26, s[16:19], 0 offen sc1
  s_add_u32 s30, s81, 137216
  v_mfma_f32_16x16x32_bf16 v[80:83], a[36:39], a[184:187], v[80:83]
  ds_read_b64_tr_b16 a[2:3], v240 offset:36864
  buffer_load_dwordx4 a[112:115], v16, s[4:7], s30 offen offset:0 sc1
  v_mfma_f32_16x16x32_bf16 v[112:115], a[36:39], a[188:191], v[112:115]
  ds_read_b64_tr_b16 a[4:5], v240 offset:40960
  v_mfma_f32_16x16x32_bf16 v[112:115], a[32:35], a[180:183], v[112:115]
  ds_read_b64_tr_b16 a[6:7], v240 offset:45056
  v_mfma_f32_16x16x32_bf16 v[116:119], a[40:43], a[180:183], v[116:119]
  ds_read_b64_tr_b16 a[8:9], v241 offset:32768
  v_mfma_f32_16x16x32_bf16 v[116:119], a[44:47], a[188:191], v[116:119]
  ds_read_b64_tr_b16 a[10:11], v241 offset:36864
  buffer_load_dwordx4 a[120:123], v16, s[4:7], s30 offen offset:1024 sc1
  v_mfma_f32_16x16x32_bf16 v[84:87], a[44:47], a[184:187], v[84:87]
  ds_read_b64_tr_b16 a[12:13], v241 offset:40960
  v_mfma_f32_16x16x32_bf16 v[84:87], a[40:43], a[176:179], v[84:87]
  ds_read_b64_tr_b16 a[14:15], v241 offset:45056
  s_waitcnt lgkmcnt(8)
  v_mfma_f32_16x16x32_bf16 v[88:91], a[48:51], a[176:179], v[88:91]
  ds_read_b64_tr_b16 a[16:17], v242 offset:32768
  s_add_u32 s30, s81, 285184
  v_mfma_f32_16x16x32_bf16 v[88:91], a[52:55], a[184:187], v[88:91]
  ds_read_b64_tr_b16 a[18:19], v242 offset:36864
  buffer_load_dwordx4 a[116:119], v16, s[4:7], s30 offen offset:0 sc1
  v_mfma_f32_16x16x32_bf16 v[120:123], a[52:55], a[188:191], v[120:123]
  ds_read_b64_tr_b16 a[20:21], v242 offset:40960
  v_mfma_f32_16x16x32_bf16 v[120:123], a[48:51], a[180:183], v[120:123]
  ds_read_b64_tr_b16 a[22:23], v242 offset:45056
  v_mfma_f32_16x16x32_bf16 v[124:127], a[56:59], a[180:183], v[124:127]
  ds_read_b64_tr_b16 a[24:25], v243 offset:32768
  v_mfma_f32_16x16x32_bf16 v[124:127], a[60:63], a[188:191], v[124:127]
  ds_read_b64_tr_b16 a[26:27], v243 offset:36864
  v_mfma_f32_16x16x32_bf16 v[92:95], a[60:63], a[184:187], v[92:95]
  ds_read_b64_tr_b16 a[28:29], v243 offset:40960
  v_mfma_f32_16x16x32_bf16 v[92:95], a[56:59], a[176:179], v[92:95]
  ds_read_b64_tr_b16 a[30:31], v243 offset:45056
  s_waitcnt lgkmcnt(8)
  v_mfma_f32_16x16x32_bf16 v[64:67], a[0:3], a[64:67], v[64:67]
  ds_read_b64_tr_b16 a[32:33], v240 offset:33792
  v_mfma_f32_16x16x32_bf16 v[64:67], a[4:7], a[72:75], v[64:67]
  ds_read_b64_tr_b16 a[34:35], v240 offset:37888
  buffer_load_dwordx4 a[124:127], v16, s[4:7], s30 offen offset:1024 sc1
  v_mfma_f32_16x16x32_bf16 v[96:99], a[4:7], a[76:79], v[96:99]
  ds_read_b64_tr_b16 a[36:37], v240 offset:41984
  v_mfma_f32_16x16x32_bf16 v[96:99], a[0:3], a[68:71], v[96:99]
  ds_read_b64_tr_b16 a[38:39], v240 offset:46080
  v_mfma_f32_16x16x32_bf16 v[100:103], a[8:11], a[68:71], v[100:103]
  ds_read_b64_tr_b16 a[40:41], v241 offset:33792
  v_mfma_f32_16x16x32_bf16 v[100:103], a[12:15], a[76:79], v[100:103]
  ds_read_b64_tr_b16 a[42:43], v241 offset:37888
  v_mfma_f32_16x16x32_bf16 v[68:71], a[12:15], a[72:75], v[68:71]
  ds_read_b64_tr_b16 a[44:45], v241 offset:41984
  v_mfma_f32_16x16x32_bf16 v[68:71], a[8:11], a[64:67], v[68:71]
  ds_read_b64_tr_b16 a[46:47], v241 offset:46080
  s_waitcnt lgkmcnt(8)
  v_mfma_f32_16x16x32_bf16 v[72:75], a[16:19], a[64:67], v[72:75]
  ds_read_b64_tr_b16 a[48:49], v242 offset:33792
  v_mfma_f32_16x16x32_bf16 v[72:75], a[20:23], a[72:75], v[72:75]
  ds_read_b64_tr_b16 a[50:51], v242 offset:37888
  v_mfma_f32_16x16x32_bf16 v[104:107], a[20:23], a[76:79], v[104:107]
  ds_read_b64_tr_b16 a[52:53], v242 offset:41984
  v_mfma_f32_16x16x32_bf16 v[104:107], a[16:19], a[68:71], v[104:107]
  ds_read_b64_tr_b16 a[54:55], v242 offset:46080
  v_mfma_f32_16x16x32_bf16 v[108:111], a[24:27], a[68:71], v[108:111]
  ds_read_b64_tr_b16 a[56:57], v243 offset:33792
  v_mfma_f32_16x16x32_bf16 v[108:111], a[28:31], a[76:79], v[108:111]
  ds_read_b64_tr_b16 a[58:59], v243 offset:37888
  v_mfma_f32_16x16x32_bf16 v[76:79], a[28:31], a[72:75], v[76:79]
  ds_read_b64_tr_b16 a[60:61], v243 offset:41984
  v_mfma_f32_16x16x32_bf16 v[76:79], a[24:27], a[64:67], v[76:79]
  ds_read_b64_tr_b16 a[62:63], v243 offset:46080
  s_waitcnt vmcnt(18) lgkmcnt(8)
  s_barrier
  v_mfma_f32_16x16x32_bf16 v[80:83], a[32:35], a[64:67], v[80:83]
  ds_read_b64_tr_b16 a[0:1], v240 offset:49152
  buffer_load_dword v33, v34, s[16:19], 0 offen sc1
  v_mfma_f32_16x16x32_bf16 v[80:83], a[36:39], a[72:75], v[80:83]
  ds_read_b64_tr_b16 a[2:3], v240 offset:53248
  v_mfma_f32_16x16x32_bf16 v[112:115], a[36:39], a[76:79], v[112:115]
  ds_read_b64_tr_b16 a[4:5], v240 offset:57344
  v_mfma_f32_16x16x32_bf16 v[112:115], a[32:35], a[68:71], v[112:115]
  ds_read_b64_tr_b16 a[6:7], v240 offset:61440
  v_mfma_f32_16x16x32_bf16 v[116:119], a[40:43], a[68:71], v[116:119]
  ds_read_b64_tr_b16 a[8:9], v241 offset:49152
  v_mfma_f32_16x16x32_bf16 v[116:119], a[44:47], a[76:79], v[116:119]
  ds_read_b64_tr_b16 a[10:11], v241 offset:53248
  v_mfma_f32_16x16x32_bf16 v[84:87], a[44:47], a[72:75], v[84:87]
  ds_read_b64_tr_b16 a[12:13], v241 offset:57344
  v_mfma_f32_16x16x32_bf16 v[84:87], a[40:43], a[64:67], v[84:87]
  ds_read_b64_tr_b16 a[14:15], v241 offset:61440
  s_waitcnt lgkmcnt(8)
  v_mfma_f32_16x16x32_bf16 v[88:91], a[48:51], a[64:67], v[88:91]
  ds_read_b64_tr_b16 a[16:17], v242 offset:49152
  v_mfma_f32_16x16x32_bf16 v[88:91], a[52:55], a[72:75], v[88:91]
  ds_read_b64_tr_b16 a[18:19], v242 offset:53248
  v_mfma_f32_16x16x32_bf16 v[120:123], a[52:55], a[76:79], v[120:123]
  ds_read_b64_tr_b16 a[20:21], v242 offset:57344
  v_mfma_f32_16x16x32_bf16 v[120:123], a[48:51], a[68:71], v[120:123]
  ds_read_b64_tr_b16 a[22:23], v242 offset:61440
  v_mfma_f32_16x16x32_bf16 v[124:127], a[56:59], a[68:71], v[124:127]
  ds_read_b64_tr_b16 a[24:25], v243 offset:49152
  v_mfma_f32_16x16x32_bf16 v[124:127], a[60:63], a[76:79], v[124:127]
  ds_read_b64_tr_b16 a[26:27], v243 offset:53248
  v_mfma_f32_16x16x32_bf16 v[92:95], a[60:63], a[72:75], v[92:95]
  ds_read_b64_tr_b16 a[28:29], v243 offset:57344
  v_mfma_f32_16x16x32_bf16 v[92:95], a[56:59], a[64:67], v[92:95]
  ds_read_b64_tr_b16 a[30:31], v243 offset:61440
  s_waitcnt vmcnt(5) lgkmcnt(8)
  v_mfma_f32_16x16x32_bf16 v[64:67], a[0:3], a[80:83], v[64:67]
  ds_read_b64_tr_b16 a[32:33], v240 offset:50176
  v_cmp_eq_u32 vcc, 0, v25
  s_nop 1
  s_cmp_eq_u64 vcc, 0
  s_cselect_b32 s58, 16777216, 0
  s_mov_b32 s65, s58
  v_mfma_f32_16x16x32_bf16 v[64:67], a[4:7], a[88:91], v[64:67]
  ds_read_b64_tr_b16 a[34:35], v240 offset:54272
  buffer_load_dwordx4 v[160:163], v13, s[56:59], 0 offen offset:0 sc1
  v_mfma_f32_16x16x32_bf16 v[96:99], a[4:7], a[92:95], v[96:99]
  ds_read_b64_tr_b16 a[36:37], v240 offset:58368
  v_mfma_f32_16x16x32_bf16 v[96:99], a[0:3], a[84:87], v[96:99]
  ds_read_b64_tr_b16 a[38:39], v240 offset:62464
  v_mfma_f32_16x16x32_bf16 v[100:103], a[8:11], a[84:87], v[100:103]
  ds_read_b64_tr_b16 a[40:41], v241 offset:50176
  v_mfma_f32_16x16x32_bf16 v[100:103], a[12:15], a[92:95], v[100:103]
  ds_read_b64_tr_b16 a[42:43], v241 offset:54272
  buffer_load_dwordx4 v[176:179], v13, s[56:59], s34 offen offset:0 sc1
  v_mfma_f32_16x16x32_bf16 v[68:71], a[12:15], a[88:91], v[68:71]
  ds_read_b64_tr_b16 a[44:45], v241 offset:58368
  v_mfma_f32_16x16x32_bf16 v[68:71], a[8:11], a[80:83], v[68:71]
  ds_read_b64_tr_b16 a[46:47], v241 offset:62464
  s_waitcnt lgkmcnt(8)
  v_mfma_f32_16x16x32_bf16 v[72:75], a[16:19], a[80:83], v[72:75]
  ds_read_b64_tr_b16 a[48:49], v242 offset:50176
  v_mfma_f32_16x16x32_bf16 v[72:75], a[20:23], a[88:91], v[72:75]
  ds_read_b64_tr_b16 a[50:51], v242 offset:54272
  buffer_load_dwordx4 v[164:167], v13, s[56:59], 0 offen offset:1024 sc1
  v_mfma_f32_16x16x32_bf16 v[104:107], a[20:23], a[92:95], v[104:107]
  ds_read_b64_tr_b16 a[52:53], v242 offset:58368
  v_mfma_f32_16x16x32_bf16 v[104:107], a[16:19], a[84:87], v[104:107]
  ds_read_b64_tr_b16 a[54:55], v242 offset:62464
  v_mfma_f32_16x16x32_bf16 v[108:111], a[24:27], a[84:87], v[108:111]
  ds_read_b64_tr_b16 a[56:57], v243 offset:50176
  v_mfma_f32_16x16x32_bf16 v[108:111], a[28:31], a[92:95], v[108:111]
  ds_read_b64_tr_b16 a[58:59], v243 offset:54272
  buffer_load_dwordx4 v[180:183], v13, s[56:59], s34 offen offset:1024 sc1
  v_mfma_f32_16x16x32_bf16 v[76:79], a[28:31], a[88:91], v[76:79]
  ds_read_b64_tr_b16 a[60:61], v243 offset:58368
  v_mfma_f32_16x16x32_bf16 v[76:79], a[24:27], a[80:83], v[76:79]
  ds_read_b64_tr_b16 a[62:63], v243 offset:62464
  s_waitcnt lgkmcnt(8)
  v_mfma_f32_16x16x32_bf16 v[80:83], a[32:35], a[80:83], v[80:83]
  ds_read_b64_tr_b16 a[0:1], v244 offset:0
  v_mfma_f32_16x16x32_bf16 v[80:83], a[36:39], a[88:91], v[80:83]
  ds_read_b64_tr_b16 a[2:3], v244 offset:4096
  buffer_load_dwordx4 v[168:171], v13, s[56:59], 0 offen offset:2048 sc1
  v_mfma_f32_16x16x32_bf16 v[112:115], a[36:39], a[92:95], v[112:115]
  ds_read_b64_tr_b16 a[4:5], v244 offset:8192
  v_mfma_f32_16x16x32_bf16 v[112:115], a[32:35], a[84:87], v[112:115]
  ds_read_b64_tr_b16 a[6:7], v244 offset:12288
  v_mfma_f32_16x16x32_bf16 v[116:119], a[40:43], a[84:87], v[116:119]
  ds_read_b64_tr_b16 a[8:9], v245 offset:0
  v_mfma_f32_16x16x32_bf16 v[116:119], a[44:47], a[92:95], v[116:119]
  ds_read_b64_tr_b16 a[10:11], v245 offset:4096
  buffer_load_dwordx4 v[184:187], v13, s[56:59], s34 offen offset:2048 sc1
  v_mfma_f32_16x16x32_bf16 v[84:87], a[44:47], a[88:91], v[84:87]
  ds_read_b64_tr_b16 a[12:13], v245 offset:8192
  v_mfma_f32_16x16x32_bf16 v[84:87], a[40:43], a[80:83], v[84:87]
  ds_read_b64_tr_b16 a[14:15], v245 offset:12288
  s_waitcnt lgkmcnt(8)
  v_mfma_f32_16x16x32_bf16 v[88:91], a[48:51], a[80:83], v[88:91]
  ds_read_b64_tr_b16 a[16:17], v246 offset:0
  v_mfma_f32_16x16x32_bf16 v[88:91], a[52:55], a[88:91], v[88:91]
  ds_read_b64_tr_b16 a[18:19], v246 offset:4096
  buffer_load_dwordx4 v[172:175], v13, s[56:59], 0 offen offset:3072 sc1
  v_mfma_f32_16x16x32_bf16 v[120:123], a[52:55], a[92:95], v[120:123]
  ds_read_b64_tr_b16 a[20:21], v246 offset:8192
  v_mfma_f32_16x16x32_bf16 v[120:123], a[48:51], a[84:87], v[120:123]
  ds_read_b64_tr_b16 a[22:23], v246 offset:12288
  v_mfma_f32_16x16x32_bf16 v[124:127], a[56:59], a[84:87], v[124:127]
La_pad13:
  s_cbranch_execz La_ret2
  s_nop 0
  ds_read_b64_tr_b16 a[24:25], v247 offset:0
  v_mfma_f32_16x16x32_bf16 v[124:127], a[60:63], a[92:95], v[124:127]
  ds_read_b64_tr_b16 a[26:27], v247 offset:4096
  buffer_load_dwordx4 v[188:191], v13, s[56:59], s34 offen offset:3072 sc1
  v_mfma_f32_16x16x32_bf16 v[92:95], a[60:63], a[88:91], v[92:95]
  ds_read_b64_tr_b16 a[28:29], v247 offset:8192
  v_mfma_f32_16x16x32_bf16 v[92:95], a[56:59], a[80:83], v[92:95]
  ds_read_b64_tr_b16 a[30:31], v247 offset:12288
  s_waitcnt vmcnt(8) lgkmcnt(8)
  v_mfma_f32_16x16x32_bf16 v[64:67], a[0:3], a[96:99], v[64:67]
  ds_read_b64_tr_b16 a[32:33], v244 offset:1024
  v_cmp_eq_u32 vcc, 0, v33
  s_nop 1
  s_cmp_eq_u64 vcc, 0
  s_cselect_b32 s58, 16777216, 0
  s_mov_b32 s64, s58
  v_mfma_f32_16x16x32_bf16 v[64:67], a[4:7], a[104:107], v[64:67]
  ds_read_b64_tr_b16 a[34:35], v244 offset:5120
  buffer_load_dwordx4 v[128:131], v18, s[56:59], 0 offen offset:0 sc1
  v_mfma_f32_16x16x32_bf16 v[96:99], a[4:7], a[108:111], v[96:99]
  ds_read_b64_tr_b16 a[36:37], v244 offset:9216
  v_mfma_f32_16x16x32_bf16 v[96:99], a[0:3], a[100:103], v[96:99]
  ds_read_b64_tr_b16 a[38:39], v244 offset:13312
  v_mfma_f32_16x16x32_bf16 v[100:103], a[8:11], a[100:103], v[100:103]
  ds_read_b64_tr_b16 a[40:41], v245 offset:1024
  v_mfma_f32_16x16x32_bf16 v[100:103], a[12:15], a[108:111], v[100:103]
  ds_read_b64_tr_b16 a[42:43], v245 offset:5120
  buffer_load_dwordx4 v[144:147], v18, s[56:59], s34 offen offset:0 sc1
  v_mfma_f32_16x16x32_bf16 v[68:71], a[12:15], a[104:107], v[68:71]
  ds_read_b64_tr_b16 a[44:45], v245 offset:9216
  v_mfma_f32_16x16x32_bf16 v[68:71], a[8:11], a[96:99], v[68:71]
  ds_read_b64_tr_b16 a[46:47], v245 offset:13312
  s_waitcnt lgkmcnt(8)
  v_mfma_f32_16x16x32_bf16 v[72:75], a[16:19], a[96:99], v[72:75]
  ds_read_b64_tr_b16 a[48:49], v246 offset:1024
  v_mfma_f32_16x16x32_bf16 v[72:75], a[20:23], a[104:107], v[72:75]
  ds_read_b64_tr_b16 a[50:51], v246 offset:5120
  buffer_load_dwordx4 v[132:135], v18, s[56:59], 0 offen offset:1024 sc1
  v_mfma_f32_16x16x32_bf16 v[104:107], a[20:23], a[108:111], v[104:107]
  ds_read_b64_tr_b16 a[52:53], v246 offset:9216
  v_mfma_f32_16x16x32_bf16 v[104:107], a[16:19], a[100:103], v[104:107]
  ds_read_b64_tr_b16 a[54:55], v246 offset:13312
  v_mfma_f32_16x16x32_bf16 v[108:111], a[24:27], a[100:103], v[108:111]
  ds_read_b64_tr_b16 a[56:57], v247 offset:1024
  v_mfma_f32_16x16x32_bf16 v[108:111], a[28:31], a[108:111], v[108:111]
  ds_read_b64_tr_b16 a[58:59], v247 offset:5120
  buffer_load_dwordx4 v[148:151], v18, s[56:59], s34 offen offset:1024 sc1
  v_mfma_f32_16x16x32_bf16 v[76:79], a[28:31], a[104:107], v[76:79]
  ds_read_b64_tr_b16 a[60:61], v247 offset:9216
  v_mfma_f32_16x16x32_bf16 v[76:79], a[24:27], a[96:99], v[76:79]
  ds_read_b64_tr_b16 a[62:63], v247 offset:13312
  s_waitcnt lgkmcnt(8)
  s_barrier
  v_mfma_f32_16x16x32_bf16 v[80:83], a[32:35], a[96:99], v[80:83]
  ds_read_b64_tr_b16 a[0:1], v236 offset:0
  v_mfma_f32_16x16x32_bf16 v[80:83], a[36:39], a[104:107], v[80:83]
  ds_read_b64_tr_b16 a[2:3], v236 offset:4096
  buffer_load_dwordx4 v[136:139], v18, s[56:59], 0 offen offset:2048 sc1
  v_mfma_f32_16x16x32_bf16 v[112:115], a[36:39], a[108:111], v[112:115]
  ds_read_b64_tr_b16 a[4:5], v237 offset:0
  v_mfma_f32_16x16x32_bf16 v[112:115], a[32:35], a[100:103], v[112:115]
  ds_read_b64_tr_b16 a[6:7], v237 offset:4096
  v_mfma_f32_16x16x32_bf16 v[116:119], a[40:43], a[100:103], v[116:119]
  ds_read_b64_tr_b16 a[8:9], v238 offset:0
  v_mfma_f32_16x16x32_bf16 v[116:119], a[44:47], a[108:111], v[116:119]
  ds_read_b64_tr_b16 a[10:11], v238 offset:4096
  buffer_load_dwordx4 v[152:155], v18, s[56:59], s34 offen offset:2048 sc1
  v_mfma_f32_16x16x32_bf16 v[84:87], a[44:47], a[104:107], v[84:87]
  ds_read_b64_tr_b16 a[12:13], v239 offset:0
  v_mfma_f32_16x16x32_bf16 v[84:87], a[40:43], a[96:99], v[84:87]
  ds_read_b64_tr_b16 a[14:15], v239 offset:4096
  s_waitcnt lgkmcnt(8)
  v_mfma_f32_16x16x32_bf16 v[88:91], a[48:51], a[96:99], v[88:91]
  ds_read_b64_tr_b16 a[16:17], v236 offset:1024
  v_mfma_f32_16x16x32_bf16 v[88:91], a[52:55], a[104:107], v[88:91]
  ds_read_b64_tr_b16 a[18:19], v236 offset:5120
  buffer_load_dwordx4 v[140:143], v18, s[56:59], 0 offen offset:3072 sc1
  v_mfma_f32_16x16x32_bf16 v[120:123], a[52:55], a[108:111], v[120:123]
  ds_read_b64_tr_b16 a[20:21], v237 offset:1024
  v_mfma_f32_16x16x32_bf16 v[120:123], a[48:51], a[100:103], v[120:123]
  ds_read_b64_tr_b16 a[22:23], v237 offset:5120
  v_mfma_f32_16x16x32_bf16 v[124:127], a[56:59], a[100:103], v[124:127]
  ds_read_b64_tr_b16 a[24:25], v238 offset:1024
  v_mfma_f32_16x16x32_bf16 v[124:127], a[60:63], a[108:111], v[124:127]
  ds_read_b64_tr_b16 a[26:27], v238 offset:5120
  buffer_load_dwordx4 v[156:159], v18, s[56:59], s34 offen offset:3072 sc1
  v_mfma_f32_16x16x32_bf16 v[92:95], a[60:63], a[104:107], v[92:95]
  ds_read_b64_tr_b16 a[28:29], v239 offset:1024
  v_mfma_f32_16x16x32_bf16 v[92:95], a[56:59], a[96:99], v[92:95]
  ds_read_b64_tr_b16 a[30:31], v239 offset:5120
  s_waitcnt lgkmcnt(8)
  v_mfma_f32_16x16x32_bf16 v[64:67], a[0:3], a[112:115], v[64:67]
  ds_read_b64_tr_b16 a[32:33], v236 offset:8192
  v_mfma_f32_16x16x32_bf16 v[96:99], a[0:3], a[116:119], v[96:99]
  ds_read_b64_tr_b16 a[34:35], v236 offset:12288
  v_mfma_f32_16x16x32_bf16 v[100:103], a[4:7], a[116:119], v[100:103]
  ds_read_b64_tr_b16 a[36:37], v237 offset:8192
  v_mfma_f32_16x16x32_bf16 v[68:71], a[4:7], a[112:115], v[68:71]
  ds_read_b64_tr_b16 a[38:39], v237 offset:12288
  v_mfma_f32_16x16x32_bf16 v[72:75], a[8:11], a[112:115], v[72:75]
  ds_read_b64_tr_b16 a[40:41], v238 offset:8192
  v_mfma_f32_16x16x32_bf16 v[104:107], a[8:11], a[116:119], v[104:107]
  ds_read_b64_tr_b16 a[42:43], v238 offset:12288
  v_mfma_f32_16x16x32_bf16 v[108:111], a[12:15], a[116:119], v[108:111]
  ds_read_b64_tr_b16 a[44:45], v239 offset:8192
  v_mfma_f32_16x16x32_bf16 v[76:79], a[12:15], a[112:115], v[76:79]
  ds_read_b64_tr_b16 a[46:47], v239 offset:12288
  s_waitcnt lgkmcnt(8)
  v_mfma_f32_16x16x32_bf16 v[80:83], a[16:19], a[112:115], v[80:83]
  ds_read_b64_tr_b16 a[48:49], v236 offset:9216
  v_mfma_f32_16x16x32_bf16 v[112:115], a[16:19], a[116:119], v[112:115]
  ds_read_b64_tr_b16 a[50:51], v236 offset:13312
  v_mfma_f32_16x16x32_bf16 v[116:119], a[20:23], a[116:119], v[116:119]
  ds_read_b64_tr_b16 a[52:53], v237 offset:9216
  v_mfma_f32_16x16x32_bf16 v[84:87], a[20:23], a[112:115], v[84:87]
  ds_read_b64_tr_b16 a[54:55], v237 offset:13312
  v_mfma_f32_16x16x32_bf16 v[88:91], a[24:27], a[112:115], v[88:91]
  ds_read_b64_tr_b16 a[56:57], v238 offset:9216
  v_mfma_f32_16x16x32_bf16 v[120:123], a[24:27], a[116:119], v[120:123]
  ds_read_b64_tr_b16 a[58:59], v238 offset:13312
  v_mfma_f32_16x16x32_bf16 v[124:127], a[28:31], a[116:119], v[124:127]
  ds_read_b64_tr_b16 a[60:61], v239 offset:9216
  v_mfma_f32_16x16x32_bf16 v[92:95], a[28:31], a[112:115], v[92:95]
  ds_read_b64_tr_b16 a[62:63], v239 offset:13312
  s_cmp_eq_u32 s65, 0
  s_cbranch_scc1 La_y_slow
La_ydone:
  s_cmp_eq_u32 s64, 0
  s_cbranch_scc1 La_x_slow
La_xdone:
  s_mov_b32 s29, 0x8000
  s_movk_i32 s30, 0x4000
  s_mov_b32 s31, 0xc000
  s_waitcnt vmcnt(8)
  s_nop 0
  v_mfma_f32_16x16x32_bf16 v[64:67], v[194:197], v[160:163], v[64:67]
  v_mfma_f32_16x16x32_bf16 v[96:99], v[194:197], v[176:179], v[96:99]
  v_mfma_f32_16x16x32_bf16 v[100:103], v[192:195], v[176:179], v[100:103]
  v_mfma_f32_16x16x32_bf16 v[68:71], v[192:195], v[160:163], v[68:71]
  v_mfma_f32_16x16x32_bf16 v[72:75], v[194:197], v[164:167], v[72:75]
  v_mfma_f32_16x16x32_bf16 v[104:107], v[194:197], v[180:183], v[104:107]
  v_mfma_f32_16x16x32_bf16 v[108:111], v[192:195], v[180:183], v[108:111]
  v_mfma_f32_16x16x32_bf16 v[76:79], v[192:195], v[164:167], v[76:79]
  v_mfma_f32_16x16x32_bf16 v[80:83], v[194:197], v[168:171], v[80:83]
  v_mfma_f32_16x16x32_bf16 v[112:115], v[194:197], v[184:187], v[112:115]
  v_mfma_f32_16x16x32_bf16 v[116:119], v[192:195], v[184:187], v[116:119]
  v_mfma_f32_16x16x32_bf16 v[84:87], v[192:195], v[168:171], v[84:87]
  v_mfma_f32_16x16x32_bf16 v[88:91], v[194:197], v[172:175], v[88:91]
  v_mfma_f32_16x16x32_bf16 v[120:123], v[194:197], v[188:191], v[120:123]
  v_mfma_f32_16x16x32_bf16 v[124:127], v[192:195], v[188:191], v[124:127]
  v_mfma_f32_16x16x32_bf16 v[92:95], v[192:195], v[172:175], v[92:95]
  s_waitcnt lgkmcnt(8)
  s_nop 0
  v_mfma_f32_16x16x32_bf16 v[64:67], a[32:35], a[120:123], v[64:67]
  v_mfma_f32_16x16x32_bf16 v[96:99], a[32:35], a[124:127], v[96:99]
  v_mfma_f32_16x16x32_bf16 v[100:103], a[36:39], a[124:127], v[100:103]
  v_mfma_f32_16x16x32_bf16 v[68:71], a[36:39], a[120:123], v[68:71]
  s_waitcnt vmcnt(6)
  s_nop 0
  v_mfma_f32_16x16x32_bf16 v[64:67], v[194:197], v[128:131], v[64:67]
  v_mfma_f32_16x16x32_bf16 v[96:99], v[194:197], v[144:147], v[96:99]
  v_mfma_f32_16x16x32_bf16 v[100:103], v[192:195], v[144:147], v[100:103]
  v_mfma_f32_16x16x32_bf16 v[68:71], v[192:195], v[128:131], v[68:71]
  s_waitcnt lgkmcnt(0)
  s_nop 0
  v_mfma_f32_16x16x32_bf16 v[72:75], a[40:43], a[120:123], v[72:75]
  v_mfma_f32_16x16x32_bf16 v[104:107], a[40:43], a[124:127], v[104:107]
  v_mfma_f32_16x16x32_bf16 v[108:111], a[44:47], a[124:127], v[108:111]
  s_nop 0
  s_nop 0
  v_cvt_pk_bf16_f32 v64, v64, v65
  v_cvt_pk_bf16_f32 v65, v66, v67
  v_mfma_f32_16x16x32_bf16 v[76:79], a[44:47], a[120:123], v[76:79]
  s_waitcnt vmcnt(4)
  s_nop 0
  ds_write_b64 v8, v[64:65] offset:0
  v_cvt_pk_bf16_f32 v96, v96, v97
  v_mfma_f32_16x16x32_bf16 v[72:75], v[194:197], v[132:135], v[72:75]
  v_cvt_pk_bf16_f32 v97, v98, v99
  ds_write_b64 v8, v[96:97] offset:4352
  v_mfma_f32_16x16x32_bf16 v[104:107], v[194:197], v[148:151], v[104:107]
  v_cvt_pk_bf16_f32 v100, v100, v101
  v_cvt_pk_bf16_f32 v101, v102, v103
  v_mfma_f32_16x16x32_bf16 v[108:111], v[192:195], v[148:151], v[108:111]
  ds_write_b64 v8, v[100:101] offset:4384
  v_cvt_pk_bf16_f32 v68, v68, v69
  v_mfma_f32_16x16x32_bf16 v[76:79], v[192:195], v[132:135], v[76:79]
  v_cvt_pk_bf16_f32 v69, v70, v71
  ds_write_b64 v8, v[68:69] offset:32
  v_mfma_f32_16x16x32_bf16 v[80:83], a[48:51], a[120:123], v[80:83]
  v_mfma_f32_16x16x32_bf16 v[112:115], a[48:51], a[124:127], v[112:115]
  v_mfma_f32_16x16x32_bf16 v[116:119], a[52:55], a[124:127], v[116:119]
  v_cvt_pk_bf16_f32 v72, v72, v73
  v_cvt_pk_bf16_f32 v73, v74, v75
  v_mfma_f32_16x16x32_bf16 v[84:87], a[52:55], a[120:123], v[84:87]
  s_waitcnt vmcnt(2)
  s_nop 0
  ds_write_b64 v8, v[72:73] offset:64
  v_cvt_pk_bf16_f32 v104, v104, v105
  v_mfma_f32_16x16x32_bf16 v[80:83], v[194:197], v[136:139], v[80:83]
  v_cvt_pk_bf16_f32 v105, v106, v107
  ds_write_b64 v8, v[104:105] offset:4416
  v_mfma_f32_16x16x32_bf16 v[112:115], v[194:197], v[152:155], v[112:115]
  v_cvt_pk_bf16_f32 v108, v108, v109
  v_cvt_pk_bf16_f32 v109, v110, v111
  v_mfma_f32_16x16x32_bf16 v[116:119], v[192:195], v[152:155], v[116:119]
  ds_write_b64 v8, v[108:109] offset:4448
  v_cvt_pk_bf16_f32 v76, v76, v77
  v_mfma_f32_16x16x32_bf16 v[84:87], v[192:195], v[136:139], v[84:87]
  v_cvt_pk_bf16_f32 v77, v78, v79
  ds_write_b64 v8, v[76:77] offset:96
  v_mfma_f32_16x16x32_bf16 v[88:91], a[56:59], a[120:123], v[88:91]
  ds_read_b128 v[160:163], v9 offset:0
  ds_read_b128 v[164:167], v9 offset:1088
  v_mfma_f32_16x16x32_bf16 v[120:123], a[56:59], a[124:127], v[120:123]
  ds_read_b128 v[168:171], v9 offset:2176
  ds_read_b128 v[172:175], v9 offset:3264
  v_mfma_f32_16x16x32_bf16 v[124:127], a[60:63], a[124:127], v[124:127]
  v_cvt_pk_bf16_f32 v80, v80, v81
  v_cvt_pk_bf16_f32 v81, v82, v83
  v_mfma_f32_16x16x32_bf16 v[92:95], a[60:63], a[120:123], v[92:95]
  s_waitcnt vmcnt(0)
  s_nop 0
  ds_write_b64 v8, v[80:81] offset:128
  v_cvt_pk_bf16_f32 v112, v112, v113
  v_mfma_f32_16x16x32_bf16 v[88:91], v[194:197], v[140:143], v[88:91]
  v_cvt_pk_bf16_f32 v113, v114, v115
  ds_write_b64 v8, v[112:113] offset:4480
  v_mfma_f32_16x16x32_bf16 v[120:123], v[194:197], v[156:159], v[120:123]
  v_cvt_pk_bf16_f32 v116, v116, v117
  v_cvt_pk_bf16_f32 v117, v118, v119
  v_mfma_f32_16x16x32_bf16 v[124:127], v[192:195], v[156:159], v[124:127]
  ds_write_b64 v8, v[116:117] offset:4512
  v_cvt_pk_bf16_f32 v84, v84, v85
  v_mfma_f32_16x16x32_bf16 v[92:95], v[192:195], v[140:143], v[92:95]
  v_cvt_pk_bf16_f32 v85, v86, v87
  ds_write_b64 v8, v[84:85] offset:160
  s_waitcnt lgkmcnt(4)
  s_nop 0
  buffer_store_dwordx4 v[160:163], v21, s[52:55], 0 offen offset:0 sc1
  buffer_store_dwordx4 v[164:167], v21, s[52:55], s30 offen offset:0 sc1
  v_cvt_pk_bf16_f32 v88, v88, v89
  v_cvt_pk_bf16_f32 v89, v90, v91
  ds_write_b64 v8, v[88:89] offset:192
  v_cvt_pk_bf16_f32 v120, v120, v121
  v_cvt_pk_bf16_f32 v121, v122, v123
  ds_write_b64 v8, v[120:121] offset:4544
  v_cvt_pk_bf16_f32 v124, v124, v125
  v_cvt_pk_bf16_f32 v125, v126, v127
  ds_write_b64 v8, v[124:125] offset:4576
  v_cvt_pk_bf16_f32 v92, v92, v93
  v_cvt_pk_bf16_f32 v93, v94, v95
  ds_write_b64 v8, v[92:93] offset:224
  ds_read_b128 v[176:179], v9 offset:128
  ds_read_b128 v[180:183], v9 offset:1216
  ds_read_b128 v[184:187], v9 offset:2304
  ds_read_b128 v[188:191], v9 offset:3392
  buffer_store_dwordx4 v[168:171], v21, s[52:55], s29 offen offset:0 sc1
  buffer_store_dwordx4 v[172:175], v21, s[52:55], s31 offen offset:0 sc1
  s_waitcnt lgkmcnt(3)
  buffer_store_dwordx4 v[176:179], v21, s[52:55], 0 offen offset:128 sc1
  s_waitcnt lgkmcnt(2)
  buffer_store_dwordx4 v[180:183], v21, s[52:55], s30 offen offset:128 sc1
  s_waitcnt lgkmcnt(1)
  buffer_store_dwordx4 v[184:187], v21, s[52:55], s29 offen offset:128 sc1
  s_waitcnt lgkmcnt(0)
  buffer_store_dwordx4 v[188:191], v21, s[52:55], s31 offen offset:128 sc1
La_fin:
  s_endpgm
.p2align 6
La_ws:
  s_branch La_ret2
  s_nop 7
La_x_slow:
  s_mov_b32 s39, 65536
  s_mov_b32 s58, 16777216
La_x_spin:
  buffer_load_dword v33, v34, s[16:19], 0 offen sc1
  s_waitcnt vmcnt(0)
  v_cmp_eq_u32 vcc, 0, v33
  s_cbranch_vccz La_x_ok
  s_sleep 1
  s_sub_u32 s39, s39, 1
  s_cmp_lg_u32 s39, 0
  s_cbranch_scc1 La_x_spin
La_x_ok:
  buffer_load_dwordx4 v[128:131], v18, s[56:59], 0 offen offset:0 sc1
  buffer_load_dwordx4 v[144:147], v18, s[56:59], s34 offen offset:0 sc1
  buffer_load_dwordx4 v[132:135], v18, s[56:59], 0 offen offset:1024 sc1
  buffer_load_dwordx4 v[148:151], v18, s[56:59], s34 offen offset:1024 sc1
  buffer_load_dwordx4 v[136:139], v18, s[56:59], 0 offen offset:2048 sc1
  buffer_load_dwordx4 v[152:155], v18, s[56:59], s34 offen offset:2048 sc1
  buffer_load_dwordx4 v[140:143], v18, s[56:59], 0 offen offset:3072 sc1
  buffer_load_dwordx4 v[156:159], v18, s[56:59], s34 offen offset:3072 sc1
  s_branch La_xdone
  s_nop 7
La_y_slow:
  s_mov_b32 s39, 65536
  s_mov_b32 s58, 16777216
La_y_spin:
  buffer_load_dword v25, v26, s[16:19], 0 offen sc1
  s_waitcnt vmcnt(0)
  v_cmp_eq_u32 vcc, 0, v25
  s_cbranch_vccz La_y_ok
  s_sleep 1
  s_sub_u32 s39, s39, 1
  s_cmp_lg_u32 s39, 0
  s_cbranch_scc1 La_y_spin
La_y_ok:
  buffer_load_dwordx4 v[160:163], v13, s[56:59], 0 offen offset:0 sc1
  buffer_load_dwordx4 v[176:179], v13, s[56:59], s34 offen offset:0 sc1
  buffer_load_dwordx4 v[164:167], v13, s[56:59], 0 offen offset:1024 sc1
  buffer_load_dwordx4 v[180:183], v13, s[56:59], s34 offen offset:1024 sc1
  buffer_load_dwordx4 v[168:171], v13, s[56:59], 0 offen offset:2048 sc1
  buffer_load_dwordx4 v[184:187], v13, s[56:59], s34 offen offset:2048 sc1
  buffer_load_dwordx4 v[172:175], v13, s[56:59], 0 offen offset:3072 sc1
  buffer_load_dwordx4 v[188:191], v13, s[56:59], s34 offen offset:3072 sc1
  s_cmp_eq_u32 s64, 0
  s_cbranch_scc1 La_ydone
  s_waitcnt vmcnt(0)
  s_branch La_ydone
  s_nop 7
La_c0_slow:
  s_mov_b32 s39, 65536
La_c0_spin:
  s_sleep 8
  buffer_load_dword v33, v34, s[48:51], 0 offen sc1
  s_waitcnt vmcnt(0)
  v_cmp_gt_u32 vcc, 256, v33
  s_cbranch_vccz La_c0_back
  s_sub_u32 s39, s39, 1
  s_cmp_lg_u32 s39, 0
  s_cbranch_scc1 La_c0_spin
  s_branch La_c0_back
  s_nop 7
La_cs_slow:
  s_mov_b32 s39, 65536
La_cs_spin:
  s_sleep 8
  buffer_load_dwordx2 v[40:41], v30, s[16:19], s66 offen sc1
  buffer_load_dwordx2 v[42:43], v30, s[16:19], s66 offen offset:2048 sc1
  s_waitcnt vmcnt(0)
  v_and_b32 v33, v41, v43
  v_cmp_ne_u32 vcc, 1, v33
  s_cbranch_vccz La_cs_back
  s_sub_u32 s39, s39, 1
  s_cmp_lg_u32 s39, 0
  s_cbranch_scc1 La_cs_spin
  s_branch La_cs_back
  s_nop 7
La_f1_slow:
  s_mov_b32 s39, 65536
La_f1_spin:
  s_sleep 8
  buffer_load_dword v33, v20, s[16:19], s94 offen sc1
  s_waitcnt vmcnt(0)
  v_cmp_eq_u32 vcc, 0, v33
  s_cbranch_vccz La_f1_back
  s_sub_u32 s39, s39, 1
  s_cmp_lg_u32 s39, 0
  s_cbranch_scc1 La_f1_spin
  s_branch La_f1_back
  s_nop 7
La_hx_slow:
  s_mov_b32 s39, 65536
La_hx_spin:
  s_sleep 8
  buffer_load_dwordx4 v[48:51], v28, s[16:19], s91 offen offset:0 sc1
  buffer_load_dwordx4 v[52:55], v28, s[16:19], s91 offen offset:1024 sc1
  buffer_load_dwordx2 v[72:73], v32, s[16:19], s91 offen offset:2048 sc1
  buffer_load_dwordx2 v[76:77], v32, s[16:19], s91 offen offset:2560 sc1
  buffer_load_dwordx2 v[96:97], v32, s[16:19], s91 offen offset:3072 sc1
  buffer_load_dwordx2 v[100:101], v32, s[16:19], s91 offen offset:3584 sc1
  s_waitcnt vmcnt(0)
  v_max3_u32 v6, v48, v49, v50
  v_max3_u32 v34, v51, v52, v53
  v_max3_u32 v6, v6, v54, v55
  v_max3_u32 v34, v34, v72, v73
  v_max3_u32 v6, v6, v76, v77
  v_max3_u32 v34, v34, v96, v97
  v_max3_u32 v6, v6, v100, v101
  v_max_u32 v6, v6, v34
  v_cmp_eq_u32 vcc, -1, v6
  s_cbranch_vccz La_hx_back
  s_sub_u32 s39, s39, 1
  s_cmp_lg_u32 s39, 0
  s_cbranch_scc1 La_hx_spin
  s_branch La_hx_back
  s_nop 7
La_g2_slow:
  s_mov_b32 s39, 65536
La_g2_spin:
  s_sleep 8
  buffer_load_dword v33, v20, s[16:19], s32 offen sc1
  s_waitcnt vmcnt(0)
  v_cmp_eq_u32 vcc, 0, v33
  s_cbranch_vccz La_g2_back
  s_sub_u32 s39, s39, 1
  s_cmp_lg_u32 s39, 0
  s_cbranch_scc1 La_g2_spin
  s_branch La_g2_back
  s_nop 7
La_g3_slow:
  s_mov_b32 s39, 65536
La_g3_spin:
  s_sleep 8
  buffer_load_dword v33, v20, s[16:19], s28 offen sc1
  s_waitcnt vmcnt(0)
  v_cmp_eq_u32 vcc, 0, v33
  s_cbranch_vccz La_g3_back
  s_sub_u32 s39, s39, 1
  s_cmp_lg_u32 s39, 0
  s_cbranch_scc1 La_g3_spin
  s_branch La_g3_back
  s_nop 7
La_g0_slow:
  s_mov_b32 s39, 65536
La_g0_spin:
  s_sleep 8
  buffer_load_dword v33, v27, s[16:19], 0 offen sc1
  s_waitcnt vmcnt(0)
  v_cmp_eq_u32 vcc, 0, v33
  s_cbranch_vccz La_g0_back
  s_sub_u32 s39, s39, 1
  s_cmp_lg_u32 s39, 0
  s_cbranch_scc1 La_g0_spin
  s_branch La_g0_back
La_end:
.p2align 12
Lg_base:
  s_load_dwordx2 s[52:53], s[0:1], 56
  v_lshrrev_b32 v5, 5, v2
  v_and_b32 v6, 3, v2
  v_accvgpr_write_b32 a136, s33
  v_accvgpr_write_b32 a137, s33
  v_accvgpr_write_b32 a138, s33
  v_accvgpr_write_b32 a139, s33
  s_mov_b32 s78, Lg_end-Lg_base
  s_lshr_b32 s29, s2, 4
  s_lshl_b32 s29, s29, 2
  s_add_u32 s29, s29, s20
  s_lshl_b32 s29, s29, 10
  v_and_b32 v24, 7, v2
  v_lshl_add_u32 v23, v24, 7, s29
  buffer_load_dword a141, v23, s[76:79], 0 offen
  s_lshl_b32 s64, s3, 11
  s_mul_i32 s65, s3, 7340032
  s_mul_i32 s97, s3, 7340032
  v_and_b32 v27, 6, v4
  s_add_u32 m0, s91, 0
  s_nop 0
  buffer_load_dwordx4 v19, s[8:11], s94 offen  lds
  v_xor_b32 v27, v27, v3
  v_lshlrev_b32 v27, 4, v27
  v_lshl_add_u32 v28, v4, 7, v27
  s_lshl_b32 s29, s21, 14
  v_add_u32 v8, s29, v28
  v_xor_b32 v9, 64, v8
  s_lshl_b32 s29, s25, 2
  s_add_u32 m0, s92, 0
  s_nop 0
  buffer_load_dwordx4 v19, s[8:11], s95 offen  lds
  s_add_u32 s29, s29, s20
  s_lshl_b32 s29, s29, 16
  s_lshl_b32 s39, s26, 8
  s_add_u32 s29, s29, s39
  v_lshl_add_u32 v21, v4, 12, s29
  v_lshl_add_u32 v21, v3, 4, v21
  v_bfe_u32 v27, v2, 2, 2
  s_add_u32 m0, s93, 0
  s_nop 0
  buffer_load_dwordx4 v19, s[8:11], s96 offen  lds
  s_add_u32 s8, s8, 458752
  s_addc_u32 s9, s9, 0
  v_and_b32_e64 v28, 1, v3
  v_mul_u32_u24 v29, 7168, v5
  v_add_u32 v29, 69632, v29
  v_mul_u32_u24 v23, 3072, v28
  v_add_u32 v23, v29, v23
  v_lshl_add_u32 v23, v27, 7, v23
  v_lshl_add_u32 v23, v6, 3, v23
  s_add_u32 m0, s86, 0
  s_nop 0
  buffer_load_dwordx4 v16, s[4:7], s82 offen offset:0  lds
  v_lshrrev_b32 v24, 1, v27
  v_lshl_or_b32 v24, v28, 1, v24
  s_lshl_b32 s29, s22, 1
  v_xor_b32 v24, s29, v24
  v_lshl_add_u32 v10, v24, 5, v23
  v_xor_b32_e64 v11, 32, v10
  v_add_u32 v13, 57344, v10
  buffer_load_dwordx4 v16, s[4:7], s82 offen offset:2048  lds
  v_add_u32 v14, 57344, v11
  s_and_b32 s38, s23, 3
  s_lshl_b32 s38, s38, 1
  s_add_u32 s38, s38, s21
  s_min_u32 s39, s38, 5
  s_and_b32 s29, s39, 1
  s_lshl_b32 s29, s29, 5
  s_add_u32 m0, s87, 0
  s_nop 0
  buffer_load_dwordx4 v16, s[4:7], s83 offen offset:0  lds
  v_xor_b32 v23, s29, v10
  s_lshr_b32 s29, s39, 1
  s_lshl_b32 s29, s29, 10
  v_add_u32 v23, s29, v23
  v_add_u32 v24, 512, v23
  s_and_b32 s29, s39, 6
  s_add_u32 s29, s29, s22
  buffer_load_dwordx4 v16, s[4:7], s83 offen offset:2048  lds
  s_add_u32 s4, s4, 128
  s_addc_u32 s5, s5, 0
  s_lshl_b32 s29, s29, 1
  s_and_b32 s39, s39, 1
  s_add_u32 s29, s29, s39
  s_lshl_b32 s29, s29, 4
  v_add_u32 v31, s29, v4
  v_add_u32 v25, 57344, v23
  v_add_u32 v26, 57344, v24
  s_lshl_b32 s66, s24, 12
  s_add_u32 s66, s66, 81920
  s_lshr_b32 s29, s23, 2
  s_lshl_b32 s29, s29, 11
  s_add_u32 s29, s29, s66
  v_lshl_add_u32 v31, v31, 3, s29
  s_cmp_lt_u32 s38, 6
  s_cselect_b32 s38, 0xffff, 0
  s_lshl_b32 s29, s23, 2
  s_lshr_b32 s39, s24, 2
  s_add_u32 s29, s29, s39
  s_lshl_b32 s29, s29, 2
  s_and_b32 s39, s24, 3
  s_add_u32 s29, s29, s39
  s_lshl_b32 s29, s29, 2
  s_add_u32 s29, s29, s20
  s_lshl_b32 s29, s29, 4
  s_lshr_b32 s67, s2, 1
  s_lshl_b32 s67, s67, 2
  s_add_u32 s67, s67, s20
  s_lshl_b32 s67, s67, 4
  s_add_u32 s67, s67, 294912
  s_add_u32 s29, s29, 270336
  v_lshl_add_u32 v29, v6, 13, s29
  v_writelane_b32 v29, s67, 3
  s_lshl_b32 s99, s2, 2
  s_add_u32 s99, s99, s20
  s_lshl_b32 s99, s99, 5
  s_add_u32 s99, s99, 327680
  v_writelane_b32 v29, s99, 4
  s_mov_b32 s12, s16
  s_mov_b32 s13, s17
  s_mov_b32 s56, s16
  s_mov_b32 s57, s17
  s_mov_b32 s18, 4194304
  s_mov_b32 s19, 0x20000
  s_mov_b32 s42, 2097152
  s_mov_b32 s43, 0x20000
  s_mov_b32 s46, 7340032
  s_add_u32 m0, s88, 28672
  s_nop 0
  buffer_load_dwordx4 v18, s[8:11], s94 offen  lds
  s_mov_b32 s47, 0x20000
  s_mov_b32 s50, 256
  s_mov_b32 s51, 0x20000
  s_add_u32 m0, s89, 28672
  s_nop 0
  buffer_load_dwordx4 v18, s[8:11], s95 offen  lds
  s_mov_b32 s54, 2048
  s_mov_b32 s55, 0x20000
  s_mov_b32 s62, 4194304
  s_mov_b32 s63, 0x20000
  s_add_u32 m0, s84, 34816
  s_nop 0
  buffer_load_dwordx4 v16, s[4:7], s80 offen offset:0  lds
  s_mov_b32 s74, 7168
  s_mov_b32 s75, 0x20000
  s_mov_b32 s58, 16777216
  s_mov_b32 s59, 0x20000
  buffer_load_dwordx4 v16, s[4:7], s80 offen offset:2048  lds
  s_add_u32 s56, s56, 33554432
  s_addc_u32 s57, s57, 0
  s_lshl_b32 s29, s2, 2
  s_add_u32 s37, s29, s20
  s_lshl_b32 s29, s37, 1
  s_add_u32 m0, s85, 34816
  s_nop 0
  buffer_load_dwordx4 v16, s[4:7], s81 offen offset:0  lds
  v_lshrrev_b32 v30, 3, v4
  v_add_u32 v30, s29, v30
  v_and_b32 v27, 7, v2
  v_lshl_add_u32 v27, v3, 3, v27
  buffer_load_dwordx4 v16, s[4:7], s81 offen offset:2048  lds
  v_lshlrev_b32 v27, 4, v27
  v_lshl_add_u32 v27, v30, 11, v27
  v_lshlrev_b32 v7, 4, v2
  s_add_u32 m0, s86, 34816
  s_nop 0
  buffer_load_dwordx4 v16, s[4:7], s82 offen offset:0  lds
  v_mov_b32 v35, 1
  v_and_b32 v34, 0, v2
  v_lshlrev_b32 v34, 0, v34
  v_mov_b32 v32, 0
  buffer_load_dwordx4 v16, s[4:7], s82 offen offset:2048  lds
  v_mov_b32 v33, 0
  v_lshlrev_b32 v30, 3, v30
  s_lshl_b32 s29, s20, 4
  v_add_lshl_u32 v6, s29, v4, 7
  s_add_u32 m0, s87, 34816
  s_nop 0
  buffer_load_dwordx4 v16, s[4:7], s83 offen offset:0  lds
  s_lshr_b32 s29, s2, 1
  s_lshl_b32 s29, s29, 2
  s_add_u32 s29, s29, s20
  s_lshl_b32 s35, s29, 10
  buffer_load_dwordx4 v16, s[4:7], s83 offen offset:2048  lds
  s_add_u32 s4, s4, 128
  s_addc_u32 s5, s5, 0
  s_lshr_b32 s29, s29, 7
  s_mul_i32 s29, s29, 1441792
  s_add_u32 s36, s35, s29
  s_waitcnt lgkmcnt(0)
  s_mov_b64 exec, 0
  s_cmp_eq_u32 s20, 0
  s_cbranch_scc1 Lg_pad1
  s_cmp_eq_u32 s20, 1
  s_cbranch_scc1 Lg_pad2
  s_cmp_eq_u32 s20, 2
  s_cbranch_scc1 Lg_pad3
  s_branch Lg_pad4
Lg_ret0:
  s_mov_b64 exec, -1
  s_waitcnt vmcnt(10)
  s_barrier
  ds_read_b64_tr_b16 a[64:65], v10 offset:0
  ds_read_b64_tr_b16 a[66:67], v10 offset:512
  ds_read_b64_tr_b16 a[68:69], v10 offset:14336
  ds_read_b64_tr_b16 a[70:71], v10 offset:14848
  ds_read_b128 a[0:3], v8 offset:0
  ds_read_b128 a[4:7], v9 offset:0
  ds_read_b128 a[8:11], v8 offset:2048
  ds_read_b128 a[12:15], v9 offset:2048
  ds_read_b128 a[16:19], v8 offset:4096
  ds_read_b128 a[20:23], v9 offset:4096
  ds_read_b128 a[24:27], v8 offset:6144
  ds_read_b128 a[28:31], v9 offset:6144
  ds_read_b64_tr_b16 a[72:73], v11 offset:0
  ds_read_b64_tr_b16 a[74:75], v11 offset:512
  ds_read_b64_tr_b16 a[76:77], v11 offset:14336
  ds_read_b64_tr_b16 a[78:79], v11 offset:14848
  ds_read_b64_tr_b16 a[80:81], v10 offset:1024
  ds_read_b64_tr_b16 a[82:83], v10 offset:1536
  ds_read_b64_tr_b16 a[84:85], v10 offset:15360
  ds_read_b64_tr_b16 a[86:87], v10 offset:15872
  ds_read_b64_tr_b16 a[88:89], v11 offset:1024
  ds_read_b64_tr_b16 a[90:91], v11 offset:1536
  ds_read_b64_tr_b16 a[92:93], v11 offset:15360
  ds_read_b64_tr_b16 a[94:95], v11 offset:15872
  ds_read_b64_tr_b16 a[96:97], v10 offset:2048
  ds_read_b64_tr_b16 a[98:99], v10 offset:2560
  ds_read_b64_tr_b16 a[100:101], v10 offset:16384
  ds_read_b64_tr_b16 a[102:103], v10 offset:16896
  ds_read_b64_tr_b16 a[104:105], v11 offset:2048
  ds_read_b64_tr_b16 a[106:107], v11 offset:2560
  ds_read_b64_tr_b16 a[108:109], v11 offset:16384
  ds_read_b64_tr_b16 a[110:111], v11 offset:16896
  s_waitcnt lgkmcnt(14)
  v_mfma_f32_16x16x32_bf16 v[64:67], a[64:67], a[0:3], 0
  ds_read_b128 a[32:35], v8 offset:8192
  s_add_u32 m0, s90, 28672
  v_mfma_f32_16x16x32_bf16 v[64:67], a[68:71], a[4:7], v[64:67]
  buffer_load_dwordx4 v18, s[8:11], s96 offen  lds
  v_mfma_f32_16x16x32_bf16 v[88:91], a[68:71], a[12:15], 0
  ds_read_b128 a[36:39], v9 offset:8192
  v_mfma_f32_16x16x32_bf16 v[88:91], a[64:67], a[8:11], v[88:91]
  v_mfma_f32_16x16x32_bf16 v[112:115], a[64:67], a[16:19], 0
  ds_read_b128 a[40:43], v8 offset:10240
  s_add_u32 m0, s91, 28672
  v_mfma_f32_16x16x32_bf16 v[112:115], a[68:71], a[20:23], v[112:115]
  buffer_load_dwordx4 v19, s[8:11], s94 offen  lds
  v_mfma_f32_16x16x32_bf16 v[136:139], a[68:71], a[28:31], 0
  ds_read_b128 a[44:47], v9 offset:10240
  v_mfma_f32_16x16x32_bf16 v[136:139], a[64:67], a[24:27], v[136:139]
  v_mfma_f32_16x16x32_bf16 v[140:143], a[72:75], a[24:27], 0
  ds_read_b128 a[48:51], v8 offset:12288
  s_add_u32 m0, s92, 28672
  v_mfma_f32_16x16x32_bf16 v[140:143], a[76:79], a[28:31], v[140:143]
  buffer_load_dwordx4 v19, s[8:11], s95 offen  lds
  v_mfma_f32_16x16x32_bf16 v[116:119], a[76:79], a[20:23], 0
  ds_read_b128 a[52:55], v9 offset:12288
  v_mfma_f32_16x16x32_bf16 v[116:119], a[72:75], a[16:19], v[116:119]
  v_mfma_f32_16x16x32_bf16 v[92:95], a[72:75], a[8:11], 0
  ds_read_b128 a[56:59], v8 offset:14336
  s_add_u32 m0, s93, 28672
  v_mfma_f32_16x16x32_bf16 v[92:95], a[76:79], a[12:15], v[92:95]
  buffer_load_dwordx4 v19, s[8:11], s96 offen  lds
  v_mfma_f32_16x16x32_bf16 v[68:71], a[76:79], a[4:7], 0
  ds_read_b128 a[60:63], v9 offset:14336
  s_add_u32 s8, s8, 458752
  s_addc_u32 s9, s9, 0
  v_mfma_f32_16x16x32_bf16 v[68:71], a[72:75], a[0:3], v[68:71]
  s_waitcnt lgkmcnt(14)
  v_mfma_f32_16x16x32_bf16 v[72:75], a[80:83], a[0:3], 0
  ds_read_b64_tr_b16 a[128:129], v23 offset:0
  s_add_u32 m0, s88, 57344
  v_mfma_f32_16x16x32_bf16 v[72:75], a[84:87], a[4:7], v[72:75]
  buffer_load_dwordx4 v18, s[8:11], s94 offen  lds
  v_mfma_f32_16x16x32_bf16 v[96:99], a[84:87], a[12:15], 0
  ds_read_b64_tr_b16 a[130:131], v24 offset:0
  v_mfma_f32_16x16x32_bf16 v[96:99], a[80:83], a[8:11], v[96:99]
  v_mfma_f32_16x16x32_bf16 v[120:123], a[80:83], a[16:19], 0
  ds_read_b64_tr_b16 a[132:133], v23 offset:14336
  s_add_u32 m0, s89, 57344
  v_mfma_f32_16x16x32_bf16 v[120:123], a[84:87], a[20:23], v[120:123]
  buffer_load_dwordx4 v18, s[8:11], s95 offen  lds
  v_mfma_f32_16x16x32_bf16 v[144:147], a[84:87], a[28:31], 0
  ds_read_b64_tr_b16 a[134:135], v24 offset:14336
  v_mfma_f32_16x16x32_bf16 v[144:147], a[80:83], a[24:27], v[144:147]
  v_mfma_f32_16x16x32_bf16 v[148:151], a[88:91], a[24:27], 0
  s_add_u32 m0, s90, 57344
  v_mfma_f32_16x16x32_bf16 v[148:151], a[92:95], a[28:31], v[148:151]
  buffer_load_dwordx4 v18, s[8:11], s96 offen  lds
  v_mfma_f32_16x16x32_bf16 v[124:127], a[92:95], a[20:23], 0
  v_mfma_f32_16x16x32_bf16 v[124:127], a[88:91], a[16:19], v[124:127]
  v_mfma_f32_16x16x32_bf16 v[100:103], a[88:91], a[8:11], 0
  s_add_u32 m0, s91, 57344
  v_mfma_f32_16x16x32_bf16 v[100:103], a[92:95], a[12:15], v[100:103]
  buffer_load_dwordx4 v19, s[8:11], s94 offen  lds
  v_mfma_f32_16x16x32_bf16 v[76:79], a[92:95], a[4:7], 0
  v_mfma_f32_16x16x32_bf16 v[76:79], a[88:91], a[0:3], v[76:79]
  s_waitcnt lgkmcnt(14)
  v_mfma_f32_16x16x32_bf16 v[80:83], a[96:99], a[0:3], 0
  s_add_u32 m0, s92, 57344
  v_mfma_f32_16x16x32_bf16 v[80:83], a[100:103], a[4:7], v[80:83]
  buffer_load_dwordx4 v19, s[8:11], s95 offen  lds
  v_mfma_f32_16x16x32_bf16 v[104:107], a[100:103], a[12:15], 0
  v_mfma_f32_16x16x32_bf16 v[104:107], a[96:99], a[8:11], v[104:107]
  v_mfma_f32_16x16x32_bf16 v[128:131], a[96:99], a[16:19], 0
  s_add_u32 m0, s93, 57344
  v_mfma_f32_16x16x32_bf16 v[128:131], a[100:103], a[20:23], v[128:131]
  buffer_load_dwordx4 v19, s[8:11], s96 offen  lds
  v_mfma_f32_16x16x32_bf16 v[152:155], a[100:103], a[28:31], 0
  s_add_u32 s8, s8, 458752
  s_addc_u32 s9, s9, 0
  v_mfma_f32_16x16x32_bf16 v[152:155], a[96:99], a[24:27], v[152:155]
  s_waitcnt lgkmcnt(12)
  v_mfma_f32_16x16x32_bf16 v[156:159], a[104:107], a[24:27], 0
  v_mfma_f32_16x16x32_bf16 v[156:159], a[108:111], a[28:31], v[156:159]
  v_mfma_f32_16x16x32_bf16 v[132:135], a[108:111], a[20:23], 0
  v_mfma_f32_16x16x32_bf16 v[132:135], a[104:107], a[16:19], v[132:135]
  v_mfma_f32_16x16x32_bf16 v[108:111], a[104:107], a[8:11], 0
  v_mfma_f32_16x16x32_bf16 v[108:111], a[108:111], a[12:15], v[108:111]
  v_mfma_f32_16x16x32_bf16 v[84:87], a[108:111], a[4:7], 0
  v_mfma_f32_16x16x32_bf16 v[84:87], a[104:107], a[0:3], v[84:87]
  s_mov_b64 exec, 0
  s_cmp_eq_u32 s20, 0
  s_cbranch_scc1 Lg_pad5
  s_cmp_eq_u32 s20, 1
  s_cbranch_scc1 Lg_pad6
  s_cmp_eq_u32 s20, 2
  s_cbranch_scc1 Lg_pad7
  s_branch Lg_pad8
Lg_ret1:
  s_mov_b64 exec, -1
  s_waitcnt vmcnt(6) lgkmcnt(0)
  s_barrier
  v_mfma_f32_16x16x32_bf16 v[160:163], a[64:67], a[32:35], 0
  ds_read_b128 a[0:3], v8 offset:34816
  s_add_u32 m0, s84, 0
  v_mfma_f32_16x16x32_bf16 v[160:163], a[68:71], a[36:39], v[160:163]
  buffer_load_dwordx4 v16, s[4:7], s80 offen offset:0  lds
  v_mfma_f32_16x16x32_bf16 v[184:187], a[68:71], a[44:47], 0
  ds_read_b128 a[4:7], v9 offset:34816
  v_mfma_f32_16x16x32_bf16 v[184:187], a[64:67], a[40:43], v[184:187]
  ds_read_b128 a[16:19], v8 offset:38912
  v_mfma_f32_16x16x32_bf16 v[208:211], a[64:67], a[48:51], 0
  ds_read_b128 a[8:11], v8 offset:36864
  v_mfma_f32_16x16x32_bf16 v[208:211], a[68:71], a[52:55], v[208:211]
  buffer_load_dwordx4 v16, s[4:7], s80 offen offset:2048  lds
  v_mfma_f32_16x16x32_bf16 v[232:235], a[68:71], a[60:63], 0
  ds_read_b128 a[12:15], v9 offset:36864
  v_mfma_f32_16x16x32_bf16 v[232:235], a[64:67], a[56:59], v[232:235]
  ds_read_b128 a[20:23], v9 offset:38912
  v_mfma_f32_16x16x32_bf16 v[236:239], a[72:75], a[56:59], 0
  ds_read_b64_tr_b16 a[64:65], v10 offset:28672
  v_mfma_f32_16x16x32_bf16 v[236:239], a[76:79], a[60:63], v[236:239]
  v_mfma_f32_16x16x32_bf16 v[212:215], a[76:79], a[52:55], 0
  ds_read_b64_tr_b16 a[66:67], v10 offset:29184
  v_mfma_f32_16x16x32_bf16 v[212:215], a[72:75], a[48:51], v[212:215]
  ds_read_b128 a[24:27], v8 offset:40960
  v_mfma_f32_16x16x32_bf16 v[188:191], a[72:75], a[40:43], 0
  ds_read_b64_tr_b16 a[68:69], v10 offset:43008
  s_add_u32 m0, s85, 0
  v_mfma_f32_16x16x32_bf16 v[188:191], a[76:79], a[44:47], v[188:191]
  buffer_load_dwordx4 v16, s[4:7], s81 offen offset:0  lds
  v_mfma_f32_16x16x32_bf16 v[164:167], a[76:79], a[36:39], 0
  ds_read_b64_tr_b16 a[70:71], v10 offset:43520
  v_mfma_f32_16x16x32_bf16 v[164:167], a[72:75], a[32:35], v[164:167]
  ds_read_b128 a[28:31], v9 offset:40960
  v_mfma_f32_16x16x32_bf16 v[168:171], a[80:83], a[32:35], 0
  ds_read_b64_tr_b16 a[72:73], v11 offset:28672
  v_mfma_f32_16x16x32_bf16 v[168:171], a[84:87], a[36:39], v[168:171]
  buffer_load_dwordx4 v16, s[4:7], s81 offen offset:2048  lds
  v_mfma_f32_16x16x32_bf16 v[192:195], a[84:87], a[44:47], 0
  ds_read_b64_tr_b16 a[74:75], v11 offset:29184
  v_mfma_f32_16x16x32_bf16 v[192:195], a[80:83], a[40:43], v[192:195]
  v_mfma_f32_16x16x32_bf16 v[216:219], a[80:83], a[48:51], 0
  ds_read_b64_tr_b16 a[76:77], v11 offset:43008
  v_mfma_f32_16x16x32_bf16 v[216:219], a[84:87], a[52:55], v[216:219]
  v_mfma_f32_16x16x32_bf16 v[240:243], a[84:87], a[60:63], 0
  ds_read_b64_tr_b16 a[78:79], v11 offset:43520
  v_mfma_f32_16x16x32_bf16 v[240:243], a[80:83], a[56:59], v[240:243]
  v_mfma_f32_16x16x32_bf16 v[244:247], a[88:91], a[56:59], 0
  ds_read_b64_tr_b16 a[80:81], v10 offset:29696
  s_add_u32 m0, s86, 0
  v_mfma_f32_16x16x32_bf16 v[244:247], a[92:95], a[60:63], v[244:247]
  buffer_load_dwordx4 v16, s[4:7], s82 offen offset:0  lds
  v_mfma_f32_16x16x32_bf16 v[220:223], a[92:95], a[52:55], 0
  ds_read_b64_tr_b16 a[82:83], v10 offset:30208
  v_mfma_f32_16x16x32_bf16 v[220:223], a[88:91], a[48:51], v[220:223]
  v_mfma_f32_16x16x32_bf16 v[196:199], a[88:91], a[40:43], 0
  ds_read_b64_tr_b16 a[84:85], v10 offset:44032
  v_mfma_f32_16x16x32_bf16 v[196:199], a[92:95], a[44:47], v[196:199]
  buffer_load_dwordx4 v16, s[4:7], s82 offen offset:2048  lds
  v_mfma_f32_16x16x32_bf16 v[172:175], a[92:95], a[36:39], 0
  ds_read_b64_tr_b16 a[86:87], v10 offset:44544
  v_mfma_f32_16x16x32_bf16 v[172:175], a[88:91], a[32:35], v[172:175]
  v_mfma_f32_16x16x32_bf16 v[176:179], a[96:99], a[32:35], 0
  ds_read_b64_tr_b16 a[88:89], v11 offset:29696
  v_mfma_f32_16x16x32_bf16 v[176:179], a[100:103], a[36:39], v[176:179]
  v_mfma_f32_16x16x32_bf16 v[200:203], a[100:103], a[44:47], 0
  ds_read_b64_tr_b16 a[90:91], v11 offset:30208
  v_mfma_f32_16x16x32_bf16 v[200:203], a[96:99], a[40:43], v[200:203]
  v_mfma_f32_16x16x32_bf16 v[224:227], a[96:99], a[48:51], 0
  ds_read_b64_tr_b16 a[92:93], v11 offset:44032
  s_add_u32 m0, s87, 0
  v_mfma_f32_16x16x32_bf16 v[224:227], a[100:103], a[52:55], v[224:227]
  buffer_load_dwordx4 v16, s[4:7], s83 offen offset:0  lds
  v_mfma_f32_16x16x32_bf16 v[248:251], a[100:103], a[60:63], 0
  ds_read_b64_tr_b16 a[94:95], v11 offset:44544
  v_mfma_f32_16x16x32_bf16 v[248:251], a[96:99], a[56:59], v[248:251]
  v_mfma_f32_16x16x32_bf16 v[252:255], a[104:107], a[56:59], 0
  ds_read_b64_tr_b16 a[96:97], v10 offset:30720
  v_mfma_f32_16x16x32_bf16 v[252:255], a[108:111], a[60:63], v[252:255]
  buffer_load_dwordx4 v16, s[4:7], s83 offen offset:2048  lds
  v_mfma_f32_16x16x32_bf16 v[228:231], a[108:111], a[52:55], 0
  ds_read_b64_tr_b16 a[98:99], v10 offset:31232
  s_add_u32 s4, s4, 128
  s_addc_u32 s5, s5, 0
  v_mfma_f32_16x16x32_bf16 v[228:231], a[104:107], a[48:51], v[228:231]
  v_mfma_f32_16x16x32_bf16 v[204:207], a[104:107], a[40:43], 0
  ds_read_b64_tr_b16 a[100:101], v10 offset:45056
  v_mfma_f32_16x16x32_bf16 v[204:207], a[108:111], a[44:47], v[204:207]
  v_mfma_f32_16x16x32_bf16 v[180:183], a[108:111], a[36:39], 0
  ds_read_b64_tr_b16 a[102:103], v10 offset:45568
  v_mfma_f32_16x16x32_bf16 v[180:183], a[104:107], a[32:35], v[180:183]
  v_mfma_f32_16x16x32_bf16 v[36:39], a[136:139], a[128:131], 0
  v_mfma_f32_16x16x32_bf16 v[36:39], a[136:139], a[132:135], v[36:39]
  s_waitcnt lgkmcnt(14)
  v_mfma_f32_16x16x32_bf16 v[64:67], a[64:67], a[0:3], v[64:67]
  ds_read_b64_tr_b16 a[104:105], v11 offset:30720
  s_add_u32 m0, s88, 0
  v_mfma_f32_16x16x32_bf16 v[64:67], a[68:71], a[4:7], v[64:67]
  buffer_load_dwordx4 v18, s[8:11], s94 offen  lds
  v_mfma_f32_16x16x32_bf16 v[88:91], a[68:71], a[12:15], v[88:91]
  ds_read_b64_tr_b16 a[106:107], v11 offset:31232
  v_mfma_f32_16x16x32_bf16 v[88:91], a[64:67], a[8:11], v[88:91]
  v_mfma_f32_16x16x32_bf16 v[112:115], a[64:67], a[16:19], v[112:115]
  ds_read_b64_tr_b16 a[108:109], v11 offset:45056
  v_mfma_f32_16x16x32_bf16 v[112:115], a[68:71], a[20:23], v[112:115]
  v_mfma_f32_16x16x32_bf16 v[136:139], a[68:71], a[28:31], v[136:139]
  ds_read_b64_tr_b16 a[110:111], v11 offset:45568
  v_mfma_f32_16x16x32_bf16 v[136:139], a[64:67], a[24:27], v[136:139]
  s_waitcnt lgkmcnt(14)
  v_mfma_f32_16x16x32_bf16 v[140:143], a[72:75], a[24:27], v[140:143]
  ds_read_b128 a[32:35], v8 offset:43008
  s_add_u32 m0, s89, 0
  v_mfma_f32_16x16x32_bf16 v[140:143], a[76:79], a[28:31], v[140:143]
  buffer_load_dwordx4 v18, s[8:11], s95 offen  lds
  v_mfma_f32_16x16x32_bf16 v[116:119], a[76:79], a[20:23], v[116:119]
  ds_read_b128 a[36:39], v9 offset:43008
  v_mfma_f32_16x16x32_bf16 v[116:119], a[72:75], a[16:19], v[116:119]
  v_mfma_f32_16x16x32_bf16 v[92:95], a[72:75], a[8:11], v[92:95]
  ds_read_b128 a[40:43], v8 offset:45056
  v_mfma_f32_16x16x32_bf16 v[92:95], a[76:79], a[12:15], v[92:95]
  v_mfma_f32_16x16x32_bf16 v[68:71], a[76:79], a[4:7], v[68:71]
  ds_read_b128 a[44:47], v9 offset:45056
  v_mfma_f32_16x16x32_bf16 v[68:71], a[72:75], a[0:3], v[68:71]
  s_waitcnt lgkmcnt(14)
  v_mfma_f32_16x16x32_bf16 v[72:75], a[80:83], a[0:3], v[72:75]
  ds_read_b128 a[48:51], v8 offset:47104
  s_add_u32 m0, s90, 0
  v_mfma_f32_16x16x32_bf16 v[72:75], a[84:87], a[4:7], v[72:75]
  buffer_load_dwordx4 v18, s[8:11], s96 offen  lds
  v_mfma_f32_16x16x32_bf16 v[96:99], a[84:87], a[12:15], v[96:99]
  ds_read_b128 a[52:55], v9 offset:47104
  v_mfma_f32_16x16x32_bf16 v[96:99], a[80:83], a[8:11], v[96:99]
  v_mfma_f32_16x16x32_bf16 v[120:123], a[80:83], a[16:19], v[120:123]
  ds_read_b128 a[56:59], v8 offset:49152
  v_mfma_f32_16x16x32_bf16 v[120:123], a[84:87], a[20:23], v[120:123]
  v_mfma_f32_16x16x32_bf16 v[144:147], a[84:87], a[28:31], v[144:147]
  ds_read_b128 a[60:63], v9 offset:49152
  v_mfma_f32_16x16x32_bf16 v[144:147], a[80:83], a[24:27], v[144:147]
  s_waitcnt lgkmcnt(14)
  v_mfma_f32_16x16x32_bf16 v[148:151], a[88:91], a[24:27], v[148:151]
  ds_read_b64_tr_b16 a[128:129], v23 offset:28672
  s_add_u32 m0, s91, 0
  v_mfma_f32_16x16x32_bf16 v[148:151], a[92:95], a[28:31], v[148:151]
  buffer_load_dwordx4 v19, s[8:11], s94 offen  lds
  v_mfma_f32_16x16x32_bf16 v[124:127], a[92:95], a[20:23], v[124:127]
  ds_read_b64_tr_b16 a[130:131], v24 offset:28672
  v_mfma_f32_16x16x32_bf16 v[124:127], a[88:91], a[16:19], v[124:127]
  v_mfma_f32_16x16x32_bf16 v[100:103], a[88:91], a[8:11], v[100:103]
  ds_read_b64_tr_b16 a[132:133], v23 offset:43008
  v_mfma_f32_16x16x32_bf16 v[100:103], a[92:95], a[12:15], v[100:103]
  v_mfma_f32_16x16x32_bf16 v[76:79], a[92:95], a[4:7], v[76:79]
  ds_read_b64_tr_b16 a[134:135], v24 offset:43008
  v_mfma_f32_16x16x32_bf16 v[76:79], a[88:91], a[0:3], v[76:79]
  s_waitcnt lgkmcnt(14)
  v_mfma_f32_16x16x32_bf16 v[80:83], a[96:99], a[0:3], v[80:83]
  s_add_u32 m0, s92, 0
  v_mfma_f32_16x16x32_bf16 v[80:83], a[100:103], a[4:7], v[80:83]
  buffer_load_dwordx4 v19, s[8:11], s95 offen  lds
  v_mfma_f32_16x16x32_bf16 v[104:107], a[100:103], a[12:15], v[104:107]
  v_mfma_f32_16x16x32_bf16 v[104:107], a[96:99], a[8:11], v[104:107]
  v_mfma_f32_16x16x32_bf16 v[128:131], a[96:99], a[16:19], v[128:131]
  v_mfma_f32_16x16x32_bf16 v[128:131], a[100:103], a[20:23], v[128:131]
  v_mfma_f32_16x16x32_bf16 v[152:155], a[100:103], a[28:31], v[152:155]
  v_mfma_f32_16x16x32_bf16 v[152:155], a[96:99], a[24:27], v[152:155]
  s_waitcnt lgkmcnt(12)
  v_mfma_f32_16x16x32_bf16 v[156:159], a[104:107], a[24:27], v[156:159]
  s_add_u32 m0, s93, 0
  v_mfma_f32_16x16x32_bf16 v[156:159], a[108:111], a[28:31], v[156:159]
  buffer_load_dwordx4 v19, s[8:11], s96 offen  lds
  v_mfma_f32_16x16x32_bf16 v[132:135], a[108:111], a[20:23], v[132:135]
  s_add_u32 s8, s8, 458752
  s_addc_u32 s9, s9, 0
  v_mfma_f32_16x16x32_bf16 v[132:135], a[104:107], a[16:19], v[132:135]
  v_mfma_f32_16x16x32_bf16 v[108:111], a[104:107], a[8:11], v[108:111]
  v_mfma_f32_16x16x32_bf16 v[108:111], a[108:111], a[12:15], v[108:111]
  v_mfma_f32_16x16x32_bf16 v[84:87], a[108:111], a[4:7], v[84:87]
  v_mfma_f32_16x16x32_bf16 v[84:87], a[104:107], a[0:3], v[84:87]
  s_mov_b64 exec, 0
  s_cmp_eq_u32 s20, 0
  s_cbranch_scc1 Lg_ret2
  s_cmp_eq_u32 s20, 1
  s_cbranch_scc1 Lg_ret2
  s_cmp_eq_u32 s20, 2
  s_cbranch_scc1 Lg_ret2
  s_branch Lg_ws
Lg_ret2:
  s_mov_b64 exec, -1
  s_waitcnt vmcnt(6) lgkmcnt(0)
  s_barrier
  v_mfma_f32_16x16x32_bf16 v[160:163], a[64:67], a[32:35], v[160:163]
  ds_read_b128 a[0:3], v8 offset:0
  s_add_u32 m0, s84, 34816
  v_mfma_f32_16x16x32_bf16 v[160:163], a[68:71], a[36:39], v[160:163]
  buffer_load_dwordx4 v16, s[4:7], s80 offen offset:0  lds
  v_mfma_f32_16x16x32_bf16 v[184:187], a[68:71], a[44:47], v[184:187]
  ds_read_b128 a[4:7], v9 offset:0
  v_mfma_f32_16x16x32_bf16 v[184:187], a[64:67], a[40:43], v[184:187]
  ds_read_b128 a[16:19], v8 offset:4096
  v_mfma_f32_16x16x32_bf16 v[208:211], a[64:67], a[48:51], v[208:211]
  ds_read_b128 a[8:11], v8 offset:2048
  v_mfma_f32_16x16x32_bf16 v[208:211], a[68:71], a[52:55], v[208:211]
  buffer_load_dwordx4 v16, s[4:7], s80 offen offset:2048  lds
  v_mfma_f32_16x16x32_bf16 v[232:235], a[68:71], a[60:63], v[232:235]
  ds_read_b128 a[12:15], v9 offset:2048
  v_mfma_f32_16x16x32_bf16 v[232:235], a[64:67], a[56:59], v[232:235]
  ds_read_b128 a[20:23], v9 offset:4096
  v_mfma_f32_16x16x32_bf16 v[236:239], a[72:75], a[56:59], v[236:239]
  ds_read_b64_tr_b16 a[64:65], v13 offset:0
  v_mfma_f32_16x16x32_bf16 v[236:239], a[76:79], a[60:63], v[236:239]
  v_mfma_f32_16x16x32_bf16 v[212:215], a[76:79], a[52:55], v[212:215]
  ds_read_b64_tr_b16 a[66:67], v13 offset:512
  v_mfma_f32_16x16x32_bf16 v[212:215], a[72:75], a[48:51], v[212:215]
  ds_read_b128 a[24:27], v8 offset:6144
  v_mfma_f32_16x16x32_bf16 v[188:191], a[72:75], a[40:43], v[188:191]
  ds_read_b64_tr_b16 a[68:69], v13 offset:14336
  s_add_u32 m0, s85, 34816
  v_mfma_f32_16x16x32_bf16 v[188:191], a[76:79], a[44:47], v[188:191]
  buffer_load_dwordx4 v16, s[4:7], s81 offen offset:0  lds
  v_mfma_f32_16x16x32_bf16 v[164:167], a[76:79], a[36:39], v[164:167]
  ds_read_b64_tr_b16 a[70:71], v13 offset:14848
  v_mfma_f32_16x16x32_bf16 v[164:167], a[72:75], a[32:35], v[164:167]
  ds_read_b128 a[28:31], v9 offset:6144
  v_mfma_f32_16x16x32_bf16 v[168:171], a[80:83], a[32:35], v[168:171]
  ds_read_b64_tr_b16 a[72:73], v14 offset:0
  v_mfma_f32_16x16x32_bf16 v[168:171], a[84:87], a[36:39], v[168:171]
  buffer_load_dwordx4 v16, s[4:7], s81 offen offset:2048  lds
  v_mfma_f32_16x16x32_bf16 v[192:195], a[84:87], a[44:47], v[192:195]
  ds_read_b64_tr_b16 a[74:75], v14 offset:512
  v_mfma_f32_16x16x32_bf16 v[192:195], a[80:83], a[40:43], v[192:195]
  v_mfma_f32_16x16x32_bf16 v[216:219], a[80:83], a[48:51], v[216:219]
  ds_read_b64_tr_b16 a[76:77], v14 offset:14336
  v_mfma_f32_16x16x32_bf16 v[216:219], a[84:87], a[52:55], v[216:219]
  v_mfma_f32_16x16x32_bf16 v[240:243], a[84:87], a[60:63], v[240:243]
  ds_read_b64_tr_b16 a[78:79], v14 offset:14848
  v_mfma_f32_16x16x32_bf16 v[240:243], a[80:83], a[56:59], v[240:243]
  v_mfma_f32_16x16x32_bf16 v[244:247], a[88:91], a[56:59], v[244:247]
  ds_read_b64_tr_b16 a[80:81], v13 offset:1024
  s_add_u32 m0, s86, 34816
  v_mfma_f32_16x16x32_bf16 v[244:247], a[92:95], a[60:63], v[244:247]
  buffer_load_dwordx4 v16, s[4:7], s82 offen offset:0  lds
  v_mfma_f32_16x16x32_bf16 v[220:223], a[92:95], a[52:55], v[220:223]
  ds_read_b64_tr_b16 a[82:83], v13 offset:1536
  v_mfma_f32_16x16x32_bf16 v[220:223], a[88:91], a[48:51], v[220:223]
  v_mfma_f32_16x16x32_bf16 v[196:199], a[88:91], a[40:43], v[196:199]
  ds_read_b64_tr_b16 a[84:85], v13 offset:15360
  v_mfma_f32_16x16x32_bf16 v[196:199], a[92:95], a[44:47], v[196:199]
  buffer_load_dwordx4 v16, s[4:7], s82 offen offset:2048  lds
  v_mfma_f32_16x16x32_bf16 v[172:175], a[92:95], a[36:39], v[172:175]
  ds_read_b64_tr_b16 a[86:87], v13 offset:15872
  v_mfma_f32_16x16x32_bf16 v[172:175], a[88:91], a[32:35], v[172:175]
  v_mfma_f32_16x16x32_bf16 v[176:179], a[96:99], a[32:35], v[176:179]
  ds_read_b64_tr_b16 a[88:89], v14 offset:1024
  v_mfma_f32_16x16x32_bf16 v[176:179], a[100:103], a[36:39], v[176:179]
  v_mfma_f32_16x16x32_bf16 v[200:203], a[100:103], a[44:47], v[200:203]
  ds_read_b64_tr_b16 a[90:91], v14 offset:1536
  v_mfma_f32_16x16x32_bf16 v[200:203], a[96:99], a[40:43], v[200:203]
  v_mfma_f32_16x16x32_bf16 v[224:227], a[96:99], a[48:51], v[224:227]
  ds_read_b64_tr_b16 a[92:93], v14 offset:15360
  s_add_u32 m0, s87, 34816
  v_mfma_f32_16x16x32_bf16 v[224:227], a[100:103], a[52:55], v[224:227]
  buffer_load_dwordx4 v16, s[4:7], s83 offen offset:0  lds
  v_mfma_f32_16x16x32_bf16 v[248:251], a[100:103], a[60:63], v[248:251]
  ds_read_b64_tr_b16 a[94:95], v14 offset:15872
Lg_pad1:
  s_cbranch_execz Lg_ret0
  s_nop 0
  v_mfma_f32_16x16x32_bf16 v[248:251], a[96:99], a[56:59], v[248:251]
  v_mfma_f32_16x16x32_bf16 v[252:255], a[104:107], a[56:59], v[252:255]
  ds_read_b64_tr_b16 a[96:97], v13 offset:2048
  v_mfma_f32_16x16x32_bf16 v[252:255], a[108:111], a[60:63], v[252:255]
  buffer_load_dwordx4 v16, s[4:7], s83 offen offset:2048  lds
  v_mfma_f32_16x16x32_bf16 v[228:231], a[108:111], a[52:55], v[228:231]
  ds_read_b64_tr_b16 a[98:99], v13 offset:2560
  s_add_u32 s4, s4, 128
  s_addc_u32 s5, s5, 0
  v_mfma_f32_16x16x32_bf16 v[228:231], a[104:107], a[48:51], v[228:231]
  v_mfma_f32_16x16x32_bf16 v[204:207], a[104:107], a[40:43], v[204:207]
  ds_read_b64_tr_b16 a[100:101], v13 offset:16384
  v_mfma_f32_16x16x32_bf16 v[204:207], a[108:111], a[44:47], v[204:207]
  v_mfma_f32_16x16x32_bf16 v[180:183], a[108:111], a[36:39], v[180:183]
  ds_read_b64_tr_b16 a[102:103], v13 offset:16896
  v_mfma_f32_16x16x32_bf16 v[180:183], a[104:107], a[32:35], v[180:183]
  v_mfma_f32_16x16x32_bf16 v[36:39], a[136:139], a[128:131], v[36:39]
  v_mfma_f32_16x16x32_bf16 v[36:39], a[136:139], a[132:135], v[36:39]
  s_waitcnt lgkmcnt(14)
  v_mfma_f32_16x16x32_bf16 v[64:67], a[64:67], a[0:3], v[64:67]
  ds_read_b64_tr_b16 a[104:105], v14 offset:2048
  s_add_u32 m0, s88, 28672
  v_mfma_f32_16x16x32_bf16 v[64:67], a[68:71], a[4:7], v[64:67]
  buffer_load_dwordx4 v18, s[8:11], s94 offen  lds
  v_mfma_f32_16x16x32_bf16 v[88:91], a[68:71], a[12:15], v[88:91]
  ds_read_b64_tr_b16 a[106:107], v14 offset:2560
  v_mfma_f32_16x16x32_bf16 v[88:91], a[64:67], a[8:11], v[88:91]
  v_mfma_f32_16x16x32_bf16 v[112:115], a[64:67], a[16:19], v[112:115]
  ds_read_b64_tr_b16 a[108:109], v14 offset:16384
  s_add_u32 m0, s89, 28672
  v_mfma_f32_16x16x32_bf16 v[112:115], a[68:71], a[20:23], v[112:115]
  buffer_load_dwordx4 v18, s[8:11], s95 offen  lds
  v_mfma_f32_16x16x32_bf16 v[136:139], a[68:71], a[28:31], v[136:139]
  ds_read_b64_tr_b16 a[110:111], v14 offset:16896
  v_mfma_f32_16x16x32_bf16 v[136:139], a[64:67], a[24:27], v[136:139]
  s_waitcnt lgkmcnt(14)
  v_mfma_f32_16x16x32_bf16 v[140:143], a[72:75], a[24:27], v[140:143]
  ds_read_b128 a[32:35], v8 offset:8192
  s_add_u32 m0, s90, 28672
  v_mfma_f32_16x16x32_bf16 v[140:143], a[76:79], a[28:31], v[140:143]
  buffer_load_dwordx4 v18, s[8:11], s96 offen  lds
  v_mfma_f32_16x16x32_bf16 v[116:119], a[76:79], a[20:23], v[116:119]
  ds_read_b128 a[36:39], v9 offset:8192
  v_mfma_f32_16x16x32_bf16 v[116:119], a[72:75], a[16:19], v[116:119]
  v_mfma_f32_16x16x32_bf16 v[92:95], a[72:75], a[8:11], v[92:95]
  ds_read_b128 a[40:43], v8 offset:10240
  s_add_u32 m0, s91, 28672
  v_mfma_f32_16x16x32_bf16 v[92:95], a[76:79], a[12:15], v[92:95]
  buffer_load_dwordx4 v19, s[8:11], s94 offen  lds
  v_mfma_f32_16x16x32_bf16 v[68:71], a[76:79], a[4:7], v[68:71]
  ds_read_b128 a[44:47], v9 offset:10240
  v_mfma_f32_16x16x32_bf16 v[68:71], a[72:75], a[0:3], v[68:71]
  s_waitcnt lgkmcnt(14)
  v_mfma_f32_16x16x32_bf16 v[72:75], a[80:83], a[0:3], v[72:75]
  ds_read_b128 a[48:51], v8 offset:12288
  s_add_u32 m0, s92, 28672
  v_mfma_f32_16x16x32_bf16 v[72:75], a[84:87], a[4:7], v[72:75]
  buffer_load_dwordx4 v19, s[8:11], s95 offen  lds
  v_mfma_f32_16x16x32_bf16 v[96:99], a[84:87], a[12:15], v[96:99]
  ds_read_b128 a[52:55], v9 offset:12288
  v_mfma_f32_16x16x32_bf16 v[96:99], a[80:83], a[8:11], v[96:99]
  v_mfma_f32_16x16x32_bf16 v[120:123], a[80:83], a[16:19], v[120:123]
  ds_read_b128 a[56:59], v8 offset:14336
  v_mfma_f32_16x16x32_bf16 v[120:123], a[84:87], a[20:23], v[120:123]
  v_mfma_f32_16x16x32_bf16 v[144:147], a[84:87], a[28:31], v[144:147]
  ds_read_b128 a[60:63], v9 offset:14336
  v_mfma_f32_16x16x32_bf16 v[144:147], a[80:83], a[24:27], v[144:147]
  s_waitcnt lgkmcnt(14)
  v_mfma_f32_16x16x32_bf16 v[148:151], a[88:91], a[24:27], v[148:151]
  ds_read_b64_tr_b16 a[128:129], v25 offset:0
  s_add_u32 m0, s93, 28672
  v_mfma_f32_16x16x32_bf16 v[148:151], a[92:95], a[28:31], v[148:151]
  buffer_load_dwordx4 v19, s[8:11], s96 offen  lds
  v_mfma_f32_16x16x32_bf16 v[124:127], a[92:95], a[20:23], v[124:127]
  ds_read_b64_tr_b16 a[130:131], v26 offset:0
  s_add_u32 s8, s8, 458752
  s_addc_u32 s9, s9, 0
  v_mfma_f32_16x16x32_bf16 v[124:127], a[88:91], a[16:19], v[124:127]
  v_mfma_f32_16x16x32_bf16 v[100:103], a[88:91], a[8:11], v[100:103]
  ds_read_b64_tr_b16 a[132:133], v25 offset:14336
  v_mfma_f32_16x16x32_bf16 v[100:103], a[92:95], a[12:15], v[100:103]
  buffer_load_dwordx4 a[144:147], v27, s[60:63], 0 offen offset:0
  v_mfma_f32_16x16x32_bf16 v[76:79], a[92:95], a[4:7], v[76:79]
  ds_read_b64_tr_b16 a[134:135], v26 offset:14336
  v_mfma_f32_16x16x32_bf16 v[76:79], a[88:91], a[0:3], v[76:79]
  s_waitcnt lgkmcnt(14)
  v_mfma_f32_16x16x32_bf16 v[80:83], a[96:99], a[0:3], v[80:83]
  v_mfma_f32_16x16x32_bf16 v[80:83], a[100:103], a[4:7], v[80:83]
  buffer_load_dwordx4 a[148:151], v27, s[60:63], 0 offen offset:512
  v_mfma_f32_16x16x32_bf16 v[104:107], a[100:103], a[12:15], v[104:107]
  v_mfma_f32_16x16x32_bf16 v[104:107], a[96:99], a[8:11], v[104:107]
  v_mfma_f32_16x16x32_bf16 v[128:131], a[96:99], a[16:19], v[128:131]
  v_mfma_f32_16x16x32_bf16 v[128:131], a[100:103], a[20:23], v[128:131]
  buffer_load_dwordx4 a[152:155], v27, s[60:63], 0 offen offset:1024
  v_mfma_f32_16x16x32_bf16 v[152:155], a[100:103], a[28:31], v[152:155]
  v_mfma_f32_16x16x32_bf16 v[152:155], a[96:99], a[24:27], v[152:155]
  s_waitcnt lgkmcnt(12)
  v_mfma_f32_16x16x32_bf16 v[156:159], a[104:107], a[24:27], v[156:159]
  v_mfma_f32_16x16x32_bf16 v[156:159], a[108:111], a[28:31], v[156:159]
  buffer_load_dwordx4 a[156:159], v27, s[60:63], 0 offen offset:1536
  v_mfma_f32_16x16x32_bf16 v[132:135], a[108:111], a[20:23], v[132:135]
  v_mfma_f32_16x16x32_bf16 v[132:135], a[104:107], a[16:19], v[132:135]
  v_mfma_f32_16x16x32_bf16 v[108:111], a[104:107], a[8:11], v[108:111]
  v_mfma_f32_16x16x32_bf16 v[108:111], a[108:111], a[12:15], v[108:111]
  v_mfma_f32_16x16x32_bf16 v[84:87], a[108:111], a[4:7], v[84:87]
  v_mfma_f32_16x16x32_bf16 v[84:87], a[104:107], a[0:3], v[84:87]
  s_waitcnt vmcnt(10) lgkmcnt(0)
  s_barrier
  v_mfma_f32_16x16x32_bf16 v[160:163], a[64:67], a[32:35], v[160:163]
  ds_read_b128 a[0:3], v8 offset:34816
  s_add_u32 m0, s84, 0
  v_mfma_f32_16x16x32_bf16 v[160:163], a[68:71], a[36:39], v[160:163]
  buffer_load_dwordx4 v16, s[4:7], s80 offen offset:0  lds
  v_mfma_f32_16x16x32_bf16 v[184:187], a[68:71], a[44:47], v[184:187]
  ds_read_b128 a[4:7], v9 offset:34816
  v_mfma_f32_16x16x32_bf16 v[184:187], a[64:67], a[40:43], v[184:187]
  ds_read_b128 a[16:19], v8 offset:38912
  v_mfma_f32_16x16x32_bf16 v[208:211], a[64:67], a[48:51], v[208:211]
  ds_read_b128 a[8:11], v8 offset:36864
  v_mfma_f32_16x16x32_bf16 v[208:211], a[68:71], a[52:55], v[208:211]
  buffer_load_dwordx4 v16, s[4:7], s80 offen offset:2048  lds
  v_mfma_f32_16x16x32_bf16 v[232:235], a[68:71], a[60:63], v[232:235]
  ds_read_b128 a[12:15], v9 offset:36864
  v_mfma_f32_16x16x32_bf16 v[232:235], a[64:67], a[56:59], v[232:235]
  ds_read_b128 a[20:23], v9 offset:38912
  v_mfma_f32_16x16x32_bf16 v[236:239], a[72:75], a[56:59], v[236:239]
  ds_read_b64_tr_b16 a[64:65], v10 offset:0
  v_mfma_f32_16x16x32_bf16 v[236:239], a[76:79], a[60:63], v[236:239]
  v_mfma_f32_16x16x32_bf16 v[212:215], a[76:79], a[52:55], v[212:215]
  ds_read_b64_tr_b16 a[66:67], v10 offset:512
  v_mfma_f32_16x16x32_bf16 v[212:215], a[72:75], a[48:51], v[212:215]
  ds_read_b128 a[24:27], v8 offset:40960
  v_mfma_f32_16x16x32_bf16 v[188:191], a[72:75], a[40:43], v[188:191]
  ds_read_b64_tr_b16 a[68:69], v10 offset:14336
  s_add_u32 m0, s85, 0
  v_mfma_f32_16x16x32_bf16 v[188:191], a[76:79], a[44:47], v[188:191]
  buffer_load_dwordx4 v16, s[4:7], s81 offen offset:0  lds
  v_mfma_f32_16x16x32_bf16 v[164:167], a[76:79], a[36:39], v[164:167]
  ds_read_b64_tr_b16 a[70:71], v10 offset:14848
  v_mfma_f32_16x16x32_bf16 v[164:167], a[72:75], a[32:35], v[164:167]
  ds_read_b128 a[28:31], v9 offset:40960
  v_mfma_f32_16x16x32_bf16 v[168:171], a[80:83], a[32:35], v[168:171]
  ds_read_b64_tr_b16 a[72:73], v11 offset:0
  v_mfma_f32_16x16x32_bf16 v[168:171], a[84:87], a[36:39], v[168:171]
  buffer_load_dwordx4 v16, s[4:7], s81 offen offset:2048  lds
  v_mfma_f32_16x16x32_bf16 v[192:195], a[84:87], a[44:47], v[192:195]
  ds_read_b64_tr_b16 a[74:75], v11 offset:512
  v_mfma_f32_16x16x32_bf16 v[192:195], a[80:83], a[40:43], v[192:195]
  v_mfma_f32_16x16x32_bf16 v[216:219], a[80:83], a[48:51], v[216:219]
  ds_read_b64_tr_b16 a[76:77], v11 offset:14336
  v_mfma_f32_16x16x32_bf16 v[216:219], a[84:87], a[52:55], v[216:219]
  v_mfma_f32_16x16x32_bf16 v[240:243], a[84:87], a[60:63], v[240:243]
  ds_read_b64_tr_b16 a[78:79], v11 offset:14848
  v_mfma_f32_16x16x32_bf16 v[240:243], a[80:83], a[56:59], v[240:243]
  v_mfma_f32_16x16x32_bf16 v[244:247], a[88:91], a[56:59], v[244:247]
  ds_read_b64_tr_b16 a[80:81], v10 offset:1024
  s_add_u32 m0, s86, 0
  v_mfma_f32_16x16x32_bf16 v[244:247], a[92:95], a[60:63], v[244:247]
  buffer_load_dwordx4 v16, s[4:7], s82 offen offset:0  lds
  v_mfma_f32_16x16x32_bf16 v[220:223], a[92:95], a[52:55], v[220:223]
  ds_read_b64_tr_b16 a[82:83], v10 offset:1536
  v_mfma_f32_16x16x32_bf16 v[220:223], a[88:91], a[48:51], v[220:223]
  v_mfma_f32_16x16x32_bf16 v[196:199], a[88:91], a[40:43], v[196:199]
  ds_read_b64_tr_b16 a[84:85], v10 offset:15360
  v_mfma_f32_16x16x32_bf16 v[196:199], a[92:95], a[44:47], v[196:199]
  buffer_load_dwordx4 v16, s[4:7], s82 offen offset:2048  lds
  v_mfma_f32_16x16x32_bf16 v[172:175], a[92:95], a[36:39], v[172:175]
  ds_read_b64_tr_b16 a[86:87], v10 offset:15872
  v_mfma_f32_16x16x32_bf16 v[172:175], a[88:91], a[32:35], v[172:175]
  v_mfma_f32_16x16x32_bf16 v[176:179], a[96:99], a[32:35], v[176:179]
  ds_read_b64_tr_b16 a[88:89], v11 offset:1024
  v_mfma_f32_16x16x32_bf16 v[176:179], a[100:103], a[36:39], v[176:179]
  v_mfma_f32_16x16x32_bf16 v[200:203], a[100:103], a[44:47], v[200:203]
  ds_read_b64_tr_b16 a[90:91], v11 offset:1536
  v_mfma_f32_16x16x32_bf16 v[200:203], a[96:99], a[40:43], v[200:203]
  v_mfma_f32_16x16x32_bf16 v[224:227], a[96:99], a[48:51], v[224:227]
  ds_read_b64_tr_b16 a[92:93], v11 offset:15360
  s_add_u32 m0, s87, 0
  v_mfma_f32_16x16x32_bf16 v[224:227], a[100:103], a[52:55], v[224:227]
  buffer_load_dwordx4 v16, s[4:7], s83 offen offset:0  lds
  v_mfma_f32_16x16x32_bf16 v[248:251], a[100:103], a[60:63], v[248:251]
  ds_read_b64_tr_b16 a[94:95], v11 offset:15872
  v_mfma_f32_16x16x32_bf16 v[248:251], a[96:99], a[56:59], v[248:251]
  v_mfma_f32_16x16x32_bf16 v[252:255], a[104:107], a[56:59], v[252:255]
  ds_read_b64_tr_b16 a[96:97], v10 offset:2048
  v_mfma_f32_16x16x32_bf16 v[252:255], a[108:111], a[60:63], v[252:255]
  buffer_load_dwordx4 v16, s[4:7], s83 offen offset:2048  lds
  v_mfma_f32_16x16x32_bf16 v[228:231], a[108:111], a[52:55], v[228:231]
  ds_read_b64_tr_b16 a[98:99], v10 offset:2560
  s_add_u32 s4, s4, 128
  s_addc_u32 s5, s5, 0
  v_mfma_f32_16x16x32_bf16 v[228:231], a[104:107], a[48:51], v[228:231]
  v_mfma_f32_16x16x32_bf16 v[204:207], a[104:107], a[40:43], v[204:207]
  ds_read_b64_tr_b16 a[100:101], v10 offset:16384
  v_mfma_f32_16x16x32_bf16 v[204:207], a[108:111], a[44:47], v[204:207]
  v_mfma_f32_16x16x32_bf16 v[180:183], a[108:111], a[36:39], v[180:183]
  ds_read_b64_tr_b16 a[102:103], v10 offset:16896
  v_mfma_f32_16x16x32_bf16 v[180:183], a[104:107], a[32:35], v[180:183]
  v_mfma_f32_16x16x32_bf16 v[36:39], a[136:139], a[128:131], v[36:39]
  v_mfma_f32_16x16x32_bf16 v[36:39], a[136:139], a[132:135], v[36:39]
  s_waitcnt lgkmcnt(14)
  v_mfma_f32_16x16x32_bf16 v[64:67], a[64:67], a[0:3], v[64:67]
  ds_read_b64_tr_b16 a[104:105], v11 offset:2048
  s_add_u32 m0, s88, 57344
  v_mfma_f32_16x16x32_bf16 v[64:67], a[68:71], a[4:7], v[64:67]
  buffer_load_dwordx4 v18, s[8:11], s94 offen  lds
  v_mfma_f32_16x16x32_bf16 v[88:91], a[68:71], a[12:15], v[88:91]
  ds_read_b64_tr_b16 a[106:107], v11 offset:2560
  v_mfma_f32_16x16x32_bf16 v[88:91], a[64:67], a[8:11], v[88:91]
  v_mfma_f32_16x16x32_bf16 v[112:115], a[64:67], a[16:19], v[112:115]
  ds_read_b64_tr_b16 a[108:109], v11 offset:16384
  v_mfma_f32_16x16x32_bf16 v[112:115], a[68:71], a[20:23], v[112:115]
  v_mfma_f32_16x16x32_bf16 v[136:139], a[68:71], a[28:31], v[136:139]
  ds_read_b64_tr_b16 a[110:111], v11 offset:16896
  v_mfma_f32_16x16x32_bf16 v[136:139], a[64:67], a[24:27], v[136:139]
  s_waitcnt lgkmcnt(14)
  v_mfma_f32_16x16x32_bf16 v[140:143], a[72:75], a[24:27], v[140:143]
  ds_read_b128 a[32:35], v8 offset:43008
  s_add_u32 m0, s89, 57344
  v_mfma_f32_16x16x32_bf16 v[140:143], a[76:79], a[28:31], v[140:143]
  buffer_load_dwordx4 v18, s[8:11], s95 offen  lds
  v_mfma_f32_16x16x32_bf16 v[116:119], a[76:79], a[20:23], v[116:119]
  ds_read_b128 a[36:39], v9 offset:43008
  v_mfma_f32_16x16x32_bf16 v[116:119], a[72:75], a[16:19], v[116:119]
  v_mfma_f32_16x16x32_bf16 v[92:95], a[72:75], a[8:11], v[92:95]
  ds_read_b128 a[40:43], v8 offset:45056
  v_mfma_f32_16x16x32_bf16 v[92:95], a[76:79], a[12:15], v[92:95]
  v_mfma_f32_16x16x32_bf16 v[68:71], a[76:79], a[4:7], v[68:71]
  ds_read_b128 a[44:47], v9 offset:45056
  v_mfma_f32_16x16x32_bf16 v[68:71], a[72:75], a[0:3], v[68:71]
  s_waitcnt lgkmcnt(14)
  v_mfma_f32_16x16x32_bf16 v[72:75], a[80:83], a[0:3], v[72:75]
  ds_read_b128 a[48:51], v8 offset:47104
  s_add_u32 m0, s90, 57344
  v_mfma_f32_16x16x32_bf16 v[72:75], a[84:87], a[4:7], v[72:75]
  buffer_load_dwordx4 v18, s[8:11], s96 offen  lds
  v_mfma_f32_16x16x32_bf16 v[96:99], a[84:87], a[12:15], v[96:99]
  ds_read_b128 a[52:55], v9 offset:47104
  v_mfma_f32_16x16x32_bf16 v[96:99], a[80:83], a[8:11], v[96:99]
  v_mfma_f32_16x16x32_bf16 v[120:123], a[80:83], a[16:19], v[120:123]
  ds_read_b128 a[56:59], v8 offset:49152
  v_mfma_f32_16x16x32_bf16 v[120:123], a[84:87], a[20:23], v[120:123]
  v_mfma_f32_16x16x32_bf16 v[144:147], a[84:87], a[28:31], v[144:147]
  ds_read_b128 a[60:63], v9 offset:49152
  v_mfma_f32_16x16x32_bf16 v[144:147], a[80:83], a[24:27], v[144:147]
  s_waitcnt lgkmcnt(14)
  v_mfma_f32_16x16x32_bf16 v[148:151], a[88:91], a[24:27], v[148:151]
  ds_read_b64_tr_b16 a[128:129], v23 offset:0
  s_add_u32 m0, s91, 57344
  v_mfma_f32_16x16x32_bf16 v[148:151], a[92:95], a[28:31], v[148:151]
  buffer_load_dwordx4 v19, s[8:11], s94 offen  lds
  v_mfma_f32_16x16x32_bf16 v[124:127], a[92:95], a[20:23], v[124:127]
  ds_read_b64_tr_b16 a[130:131], v24 offset:0
  v_mfma_f32_16x16x32_bf16 v[124:127], a[88:91], a[16:19], v[124:127]
  v_mfma_f32_16x16x32_bf16 v[100:103], a[88:91], a[8:11], v[100:103]
  ds_read_b64_tr_b16 a[132:133], v23 offset:14336
  v_mfma_f32_16x16x32_bf16 v[100:103], a[92:95], a[12:15], v[100:103]
  v_mfma_f32_16x16x32_bf16 v[76:79], a[92:95], a[4:7], v[76:79]
  ds_read_b64_tr_b16 a[134:135], v24 offset:14336
  v_mfma_f32_16x16x32_bf16 v[76:79], a[88:91], a[0:3], v[76:79]
  s_waitcnt lgkmcnt(14)
  v_mfma_f32_16x16x32_bf16 v[80:83], a[96:99], a[0:3], v[80:83]
  s_add_u32 m0, s92, 57344
  v_mfma_f32_16x16x32_bf16 v[80:83], a[100:103], a[4:7], v[80:83]
  buffer_load_dwordx4 v19, s[8:11], s95 offen  lds
  v_mfma_f32_16x16x32_bf16 v[104:107], a[100:103], a[12:15], v[104:107]
  v_mfma_f32_16x16x32_bf16 v[104:107], a[96:99], a[8:11], v[104:107]
  v_mfma_f32_16x16x32_bf16 v[128:131], a[96:99], a[16:19], v[128:131]
  v_mfma_f32_16x16x32_bf16 v[128:131], a[100:103], a[20:23], v[128:131]
  v_mfma_f32_16x16x32_bf16 v[152:155], a[100:103], a[28:31], v[152:155]
  v_mfma_f32_16x16x32_bf16 v[152:155], a[96:99], a[24:27], v[152:155]
  s_waitcnt lgkmcnt(12)
  v_mfma_f32_16x16x32_bf16 v[156:159], a[104:107], a[24:27], v[156:159]
  s_add_u32 m0, s93, 57344
  v_mfma_f32_16x16x32_bf16 v[156:159], a[108:111], a[28:31], v[156:159]
  buffer_load_dwordx4 v19, s[8:11], s96 offen  lds
  v_mfma_f32_16x16x32_bf16 v[132:135], a[108:111], a[20:23], v[132:135]
  s_add_u32 s8, s8, 458752
  s_addc_u32 s9, s9, 0
  v_mfma_f32_16x16x32_bf16 v[132:135], a[104:107], a[16:19], v[132:135]
  v_mfma_f32_16x16x32_bf16 v[108:111], a[104:107], a[8:11], v[108:111]
  v_mfma_f32_16x16x32_bf16 v[108:111], a[108:111], a[12:15], v[108:111]
  v_mfma_f32_16x16x32_bf16 v[84:87], a[108:111], a[4:7], v[84:87]
  v_mfma_f32_16x16x32_bf16 v[84:87], a[104:107], a[0:3], v[84:87]
  s_waitcnt vmcnt(6) lgkmcnt(0)
  s_barrier
  v_mfma_f32_16x16x32_bf16 v[160:163], a[64:67], a[32:35], v[160:163]
  ds_read_b128 a[0:3], v8 offset:0
  s_add_u32 m0, s84, 34816
  v_mfma_f32_16x16x32_bf16 v[160:163], a[68:71], a[36:39], v[160:163]
  buffer_load_dwordx4 v16, s[4:7], s80 offen offset:0  lds
  v_mfma_f32_16x16x32_bf16 v[184:187], a[68:71], a[44:47], v[184:187]
  ds_read_b128 a[4:7], v9 offset:0
  v_mfma_f32_16x16x32_bf16 v[184:187], a[64:67], a[40:43], v[184:187]
  ds_read_b128 a[16:19], v8 offset:4096
  v_mfma_f32_16x16x32_bf16 v[208:211], a[64:67], a[48:51], v[208:211]
  ds_read_b128 a[8:11], v8 offset:2048
  v_mfma_f32_16x16x32_bf16 v[208:211], a[68:71], a[52:55], v[208:211]
  buffer_load_dwordx4 v16, s[4:7], s80 offen offset:2048  lds
  v_mfma_f32_16x16x32_bf16 v[232:235], a[68:71], a[60:63], v[232:235]
  ds_read_b128 a[12:15], v9 offset:2048
  v_mfma_f32_16x16x32_bf16 v[232:235], a[64:67], a[56:59], v[232:235]
  ds_read_b128 a[20:23], v9 offset:4096
  v_mfma_f32_16x16x32_bf16 v[236:239], a[72:75], a[56:59], v[236:239]
  ds_read_b64_tr_b16 a[64:65], v10 offset:28672
  v_mfma_f32_16x16x32_bf16 v[236:239], a[76:79], a[60:63], v[236:239]
  v_mfma_f32_16x16x32_bf16 v[212:215], a[76:79], a[52:55], v[212:215]
  ds_read_b64_tr_b16 a[66:67], v10 offset:29184
  v_mfma_f32_16x16x32_bf16 v[212:215], a[72:75], a[48:51], v[212:215]
  ds_read_b128 a[24:27], v8 offset:6144
  v_mfma_f32_16x16x32_bf16 v[188:191], a[72:75], a[40:43], v[188:191]
  ds_read_b64_tr_b16 a[68:69], v10 offset:43008
  s_add_u32 m0, s85, 34816
  v_mfma_f32_16x16x32_bf16 v[188:191], a[76:79], a[44:47], v[188:191]
  buffer_load_dwordx4 v16, s[4:7], s81 offen offset:0  lds
  v_mfma_f32_16x16x32_bf16 v[164:167], a[76:79], a[36:39], v[164:167]
  ds_read_b64_tr_b16 a[70:71], v10 offset:43520
  v_mfma_f32_16x16x32_bf16 v[164:167], a[72:75], a[32:35], v[164:167]
  ds_read_b128 a[28:31], v9 offset:6144
  v_mfma_f32_16x16x32_bf16 v[168:171], a[80:83], a[32:35], v[168:171]
  ds_read_b64_tr_b16 a[72:73], v11 offset:28672
  v_mfma_f32_16x16x32_bf16 v[168:171], a[84:87], a[36:39], v[168:171]
  buffer_load_dwordx4 v16, s[4:7], s81 offen offset:2048  lds
  v_mfma_f32_16x16x32_bf16 v[192:195], a[84:87], a[44:47], v[192:195]
  ds_read_b64_tr_b16 a[74:75], v11 offset:29184
  v_mfma_f32_16x16x32_bf16 v[192:195], a[80:83], a[40:43], v[192:195]
  v_mfma_f32_16x16x32_bf16 v[216:219], a[80:83], a[48:51], v[216:219]
  ds_read_b64_tr_b16 a[76:77], v11 offset:43008
  v_mfma_f32_16x16x32_bf16 v[216:219], a[84:87], a[52:55], v[216:219]
  v_mfma_f32_16x16x32_bf16 v[240:243], a[84:87], a[60:63], v[240:243]
  ds_read_b64_tr_b16 a[78:79], v11 offset:43520
  v_mfma_f32_16x16x32_bf16 v[240:243], a[80:83], a[56:59], v[240:243]
  v_mfma_f32_16x16x32_bf16 v[244:247], a[88:91], a[56:59], v[244:247]
  ds_read_b64_tr_b16 a[80:81], v10 offset:29696
  s_add_u32 m0, s86, 34816
  v_mfma_f32_16x16x32_bf16 v[244:247], a[92:95], a[60:63], v[244:247]
  buffer_load_dwordx4 v16, s[4:7], s82 offen offset:0  lds
  v_mfma_f32_16x16x32_bf16 v[220:223], a[92:95], a[52:55], v[220:223]
  ds_read_b64_tr_b16 a[82:83], v10 offset:30208
  v_mfma_f32_16x16x32_bf16 v[220:223], a[88:91], a[48:51], v[220:223]
  v_mfma_f32_16x16x32_bf16 v[196:199], a[88:91], a[40:43], v[196:199]
  ds_read_b64_tr_b16 a[84:85], v10 offset:44032
  v_mfma_f32_16x16x32_bf16 v[196:199], a[92:95], a[44:47], v[196:199]
  buffer_load_dwordx4 v16, s[4:7], s82 offen offset:2048  lds
  v_mfma_f32_16x16x32_bf16 v[172:175], a[92:95], a[36:39], v[172:175]
  ds_read_b64_tr_b16 a[86:87], v10 offset:44544
  v_mfma_f32_16x16x32_bf16 v[172:175], a[88:91], a[32:35], v[172:175]
  v_mfma_f32_16x16x32_bf16 v[176:179], a[96:99], a[32:35], v[176:179]
  ds_read_b64_tr_b16 a[88:89], v11 offset:29696
  v_mfma_f32_16x16x32_bf16 v[176:179], a[100:103], a[36:39], v[176:179]
  v_mfma_f32_16x16x32_bf16 v[200:203], a[100:103], a[44:47], v[200:203]
  ds_read_b64_tr_b16 a[90:91], v11 offset:30208
  v_mfma_f32_16x16x32_bf16 v[200:203], a[96:99], a[40:43], v[200:203]
  v_mfma_f32_16x16x32_bf16 v[224:227], a[96:99], a[48:51], v[224:227]
  ds_read_b64_tr_b16 a[92:93], v11 offset:44032
  s_add_u32 m0, s87, 34816
  v_mfma_f32_16x16x32_bf16 v[224:227], a[100:103], a[52:55], v[224:227]
  buffer_load_dwordx4 v16, s[4:7], s83 offen offset:0  lds
  v_mfma_f32_16x16x32_bf16 v[248:251], a[100:103], a[60:63], v[248:251]
  ds_read_b64_tr_b16 a[94:95], v11 offset:44544
  v_mfma_f32_16x16x32_bf16 v[248:251], a[96:99], a[56:59], v[248:251]
  v_mfma_f32_16x16x32_bf16 v[252:255], a[104:107], a[56:59], v[252:255]
  ds_read_b64_tr_b16 a[96:97], v10 offset:30720
  v_mfma_f32_16x16x32_bf16 v[252:255], a[108:111], a[60:63], v[252:255]
  buffer_load_dwordx4 v16, s[4:7], s83 offen offset:2048  lds
  v_mfma_f32_16x16x32_bf16 v[228:231], a[108:111], a[52:55], v[228:231]
  ds_read_b64_tr_b16 a[98:99], v10 offset:31232
  s_add_u32 s4, s4, 128
  s_addc_u32 s5, s5, 0
  v_mfma_f32_16x16x32_bf16 v[228:231], a[104:107], a[48:51], v[228:231]
  v_mfma_f32_16x16x32_bf16 v[204:207], a[104:107], a[40:43], v[204:207]
  ds_read_b64_tr_b16 a[100:101], v10 offset:45056
  v_mfma_f32_16x16x32_bf16 v[204:207], a[108:111], a[44:47], v[204:207]
  v_mfma_f32_16x16x32_bf16 v[180:183], a[108:111], a[36:39], v[180:183]
  ds_read_b64_tr_b16 a[102:103], v10 offset:45568
  v_mfma_f32_16x16x32_bf16 v[180:183], a[104:107], a[32:35], v[180:183]
  v_mfma_f32_16x16x32_bf16 v[36:39], a[136:139], a[128:131], v[36:39]
  v_mfma_f32_16x16x32_bf16 v[36:39], a[136:139], a[132:135], v[36:39]
  v_mfma_f32_16x16x32_bf16 v[40:43], a[136:139], a[144:147], 0
  v_mfma_f32_16x16x32_bf16 v[40:43], a[136:139], a[148:151], v[40:43]
  v_mfma_f32_16x16x32_bf16 v[40:43], a[136:139], a[152:155], v[40:43]
  v_mfma_f32_16x16x32_bf16 v[40:43], a[136:139], a[156:159], v[40:43]
  v_mfma_f32_16x16x32_bf16 v[44:47], a[144:147], a[144:147], 0
  v_mfma_f32_16x16x32_bf16 v[44:47], a[148:151], a[148:151], v[44:47]
  v_mfma_f32_16x16x32_bf16 v[44:47], a[152:155], a[152:155], v[44:47]
  v_mfma_f32_16x16x32_bf16 v[44:47], a[156:159], a[156:159], v[44:47]
  s_waitcnt lgkmcnt(14)
  v_mfma_f32_16x16x32_bf16 v[64:67], a[64:67], a[0:3], v[64:67]
  ds_read_b64_tr_b16 a[104:105], v11 offset:30720
  s_add_u32 m0, s88, 0
  v_mfma_f32_16x16x32_bf16 v[64:67], a[68:71], a[4:7], v[64:67]
  buffer_load_dwordx4 v18, s[8:11], s94 offen  lds
  v_mfma_f32_16x16x32_bf16 v[88:91], a[68:71], a[12:15], v[88:91]
  ds_read_b64_tr_b16 a[106:107], v11 offset:31232
  v_mfma_f32_16x16x32_bf16 v[88:91], a[64:67], a[8:11], v[88:91]
  v_mfma_f32_16x16x32_bf16 v[112:115], a[64:67], a[16:19], v[112:115]
  ds_read_b64_tr_b16 a[108:109], v11 offset:45056
  v_lshlrev_b32 v41, 2, v3
  v_mfma_f32_16x16x32_bf16 v[112:115], a[68:71], a[20:23], v[112:115]
  v_sub_u32_e64 v41, v4, v41
  v_mfma_f32_16x16x32_bf16 v[136:139], a[68:71], a[28:31], v[136:139]
  ds_read_b64_tr_b16 a[110:111], v11 offset:45568
  v_mfma_f32_16x16x32_bf16 v[136:139], a[64:67], a[24:27], v[136:139]
  s_waitcnt lgkmcnt(14)
  v_cmp_eq_u32 vcc, 0, v41
  v_mfma_f32_16x16x32_bf16 v[140:143], a[72:75], a[24:27], v[140:143]
  ds_read_b128 a[32:35], v8 offset:8192
  v_add_f32_dpp v40, v40, v40 quad_perm:[1,0,3,2] row_mask:0xf bank_mask:0xf
  s_add_u32 m0, s89, 0
  v_mfma_f32_16x16x32_bf16 v[140:143], a[76:79], a[28:31], v[140:143]
  buffer_load_dwordx4 v18, s[8:11], s95 offen  lds
  v_mfma_f32_16x16x32_bf16 v[116:119], a[76:79], a[20:23], v[116:119]
  ds_read_b128 a[36:39], v9 offset:8192
  v_cndmask_b32 v42, 0, v44, vcc
  v_mfma_f32_16x16x32_bf16 v[116:119], a[72:75], a[16:19], v[116:119]
  v_mfma_f32_16x16x32_bf16 v[92:95], a[72:75], a[8:11], v[92:95]
  ds_read_b128 a[40:43], v8 offset:10240
  v_cmp_eq_u32_e64 vcc, 1, v41
  v_mfma_f32_16x16x32_bf16 v[92:95], a[76:79], a[12:15], v[92:95]
  v_add_f32_dpp v40, v40, v40 quad_perm:[2,3,0,1] row_mask:0xf bank_mask:0xf
  v_mfma_f32_16x16x32_bf16 v[68:71], a[76:79], a[4:7], v[68:71]
  ds_read_b128 a[44:47], v9 offset:10240
  v_mfma_f32_16x16x32_bf16 v[68:71], a[72:75], a[0:3], v[68:71]
  s_waitcnt lgkmcnt(14)
  v_cndmask_b32 v42, v42, v45, vcc
  v_mfma_f32_16x16x32_bf16 v[72:75], a[80:83], a[0:3], v[72:75]
  ds_read_b128 a[48:51], v8 offset:12288
  s_add_u32 m0, s90, 0
  v_mfma_f32_16x16x32_bf16 v[72:75], a[84:87], a[4:7], v[72:75]
  v_cmp_eq_u32 vcc, 2, v41
  buffer_load_dwordx4 v18, s[8:11], s96 offen  lds
  v_mfma_f32_16x16x32_bf16 v[96:99], a[84:87], a[12:15], v[96:99]
  ds_read_b128 a[52:55], v9 offset:12288
  v_add_f32_dpp v40, v40, v40 row_half_mirror row_mask:0xf bank_mask:0xf
  v_mfma_f32_16x16x32_bf16 v[96:99], a[80:83], a[8:11], v[96:99]
  v_mfma_f32_16x16x32_bf16 v[120:123], a[80:83], a[16:19], v[120:123]
  ds_read_b128 a[56:59], v8 offset:14336
  v_cndmask_b32_e64 v42, v42, v46, vcc
  v_mfma_f32_16x16x32_bf16 v[120:123], a[84:87], a[20:23], v[120:123]
  v_mfma_f32_16x16x32_bf16 v[144:147], a[84:87], a[28:31], v[144:147]
  ds_read_b128 a[60:63], v9 offset:14336
  v_cmp_eq_u32 vcc, 3, v41
  v_mfma_f32_16x16x32_bf16 v[144:147], a[80:83], a[24:27], v[144:147]
  s_waitcnt lgkmcnt(14)
  v_mul_f32 v40, 0x3a800000, v40
  v_mfma_f32_16x16x32_bf16 v[148:151], a[88:91], a[24:27], v[148:151]
  ds_read_b64_tr_b16 a[128:129], v23 offset:28672
  s_add_u32 m0, s91, 0
  v_mfma_f32_16x16x32_bf16 v[148:151], a[92:95], a[28:31], v[148:151]
  v_cndmask_b32 v42, v42, v47, vcc
  buffer_load_dwordx4 v19, s[8:11], s94 offen  lds
  v_mfma_f32_16x16x32_bf16 v[124:127], a[92:95], a[20:23], v[124:127]
  ds_read_b64_tr_b16 a[130:131], v24 offset:28672
  v_mfma_f32_16x16x32_bf16 v[124:127], a[88:91], a[16:19], v[124:127]
  v_add_f32_dpp v42, v42, v42 quad_perm:[1,0,3,2] row_mask:0xf bank_mask:0xf
  v_mfma_f32_16x16x32_bf16 v[100:103], a[88:91], a[8:11], v[100:103]
  ds_read_b64_tr_b16 a[132:133], v23 offset:43008
  v_mul_f32_e64 v41, v40, v40
  v_mfma_f32_16x16x32_bf16 v[100:103], a[92:95], a[12:15], v[100:103]
  v_mfma_f32_16x16x32_bf16 v[76:79], a[92:95], a[4:7], v[76:79]
  ds_read_b64_tr_b16 a[134:135], v24 offset:43008
  v_add_f32_dpp v42, v42, v42 quad_perm:[2,3,0,1] row_mask:0xf bank_mask:0xf
  v_mfma_f32_16x16x32_bf16 v[76:79], a[88:91], a[0:3], v[76:79]
  s_waitcnt lgkmcnt(14)
  v_mfma_f32_16x16x32_bf16 v[80:83], a[96:99], a[0:3], v[80:83]
  v_cvt_pk_bf16_f32 v40, v40, v40
  s_add_u32 m0, s92, 0
  v_mfma_f32_16x16x32_bf16 v[80:83], a[100:103], a[4:7], v[80:83]
  v_add_f32_dpp v42, v42, v42 row_half_mirror row_mask:0xf bank_mask:0xf
  buffer_load_dwordx4 v19, s[8:11], s95 offen  lds
  v_mfma_f32_16x16x32_bf16 v[104:107], a[100:103], a[12:15], v[104:107]
  v_mfma_f32_16x16x32_bf16 v[104:107], a[96:99], a[8:11], v[104:107]
  v_and_b32 v40, 0xffff0000, v40
  v_mfma_f32_16x16x32_bf16 v[128:131], a[96:99], a[16:19], v[128:131]
  v_mfma_f32_16x16x32_bf16 v[128:131], a[100:103], a[20:23], v[128:131]
  v_mov_b32 v43, v42
  v_mfma_f32_16x16x32_bf16 v[152:155], a[100:103], a[28:31], v[152:155]
  s_nop 0
  v_permlane16_swap_b32 v42, v43
  v_mfma_f32_16x16x32_bf16 v[152:155], a[96:99], a[24:27], v[152:155]
  s_waitcnt lgkmcnt(12)
  v_mfma_f32_16x16x32_bf16 v[156:159], a[104:107], a[24:27], v[156:159]
  v_add_f32 v42, v42, v43
  s_add_u32 m0, s93, 0
  v_mfma_f32_16x16x32_bf16 v[156:159], a[108:111], a[28:31], v[156:159]
  buffer_load_dwordx4 v19, s[8:11], s96 offen  lds
  v_mfma_f32_16x16x32_bf16 v[132:135], a[108:111], a[20:23], v[132:135]
  v_mov_b32 v43, v42
  s_add_u32 s8, s8, 458752
  s_addc_u32 s9, s9, 0
  v_mfma_f32_16x16x32_bf16 v[132:135], a[104:107], a[16:19], v[132:135]
  v_permlane32_swap_b32 v42, v43
  v_mfma_f32_16x16x32_bf16 v[108:111], a[104:107], a[8:11], v[108:111]
  v_mfma_f32_16x16x32_bf16 v[108:111], a[108:111], a[12:15], v[108:111]
  v_add_f32 v42, v42, v43
  v_mfma_f32_16x16x32_bf16 v[84:87], a[108:111], a[4:7], v[84:87]
  v_mfma_f32_16x16x32_bf16 v[84:87], a[104:107], a[0:3], v[84:87]
  s_waitcnt vmcnt(6) lgkmcnt(0)
  s_barrier
  v_mfma_f32_16x16x32_bf16 v[160:163], a[64:67], a[32:35], v[160:163]
  ds_read_b128 a[0:3], v8 offset:34816
  s_add_u32 m0, s84, 0
  v_mfma_f32_16x16x32_bf16 v[160:163], a[68:71], a[36:39], v[160:163]
  buffer_load_dwordx4 v16, s[4:7], s80 offen offset:0  lds
  v_mfma_f32_16x16x32_bf16 v[184:187], a[68:71], a[44:47], v[184:187]
  ds_read_b128 a[4:7], v9 offset:34816
  v_mov_b32 v43, 0x3a800000
  v_mfma_f32_16x16x32_bf16 v[184:187], a[64:67], a[40:43], v[184:187]
  ds_read_b128 a[16:19], v8 offset:38912
  v_mfma_f32_16x16x32_bf16 v[208:211], a[64:67], a[48:51], v[208:211]
  ds_read_b128 a[8:11], v8 offset:36864
  v_fma_f32 v44, v42, v43, -v41
  v_mfma_f32_16x16x32_bf16 v[208:211], a[68:71], a[52:55], v[208:211]
  buffer_load_dwordx4 v16, s[4:7], s80 offen offset:2048  lds
  v_mfma_f32_16x16x32_bf16 v[232:235], a[68:71], a[60:63], v[232:235]
  ds_read_b128 a[12:15], v9 offset:36864
  v_mfma_f32_16x16x32_bf16 v[232:235], a[64:67], a[56:59], v[232:235]
  ds_read_b128 a[20:23], v9 offset:38912
  v_max_f32 v44, 0, v44
  v_mfma_f32_16x16x32_bf16 v[236:239], a[72:75], a[56:59], v[236:239]
  ds_read_b64_tr_b16 a[64:65], v13 offset:0
  v_mfma_f32_16x16x32_bf16 v[236:239], a[76:79], a[60:63], v[236:239]
  v_mfma_f32_16x16x32_bf16 v[212:215], a[76:79], a[52:55], v[212:215]
  ds_read_b64_tr_b16 a[66:67], v13 offset:512
  v_cvt_pk_bf16_f32 v44, v44, v44
  v_mfma_f32_16x16x32_bf16 v[212:215], a[72:75], a[48:51], v[212:215]
  ds_read_b128 a[24:27], v8 offset:40960
  v_mfma_f32_16x16x32_bf16 v[188:191], a[72:75], a[40:43], v[188:191]
  ds_read_b64_tr_b16 a[68:69], v13 offset:14336
  s_add_u32 m0, s85, 0
  v_mfma_f32_16x16x32_bf16 v[188:191], a[76:79], a[44:47], v[188:191]
  v_and_b32 v44, 0xffff0000, v44
  buffer_load_dwordx4 v16, s[4:7], s81 offen offset:0  lds
  v_mfma_f32_16x16x32_bf16 v[164:167], a[76:79], a[36:39], v[164:167]
  ds_read_b64_tr_b16 a[70:71], v13 offset:14848
  v_mfma_f32_16x16x32_bf16 v[164:167], a[72:75], a[32:35], v[164:167]
  ds_read_b128 a[28:31], v9 offset:40960
  v_mfma_f32_16x16x32_bf16 v[168:171], a[80:83], a[32:35], v[168:171]
  ds_read_b64_tr_b16 a[72:73], v14 offset:0
  v_add_f32 v44, 0x3727c5ac, v44
Lg_pad2:
  s_cbranch_execz Lg_ret0
  s_nop 0
  v_mfma_f32_16x16x32_bf16 v[168:171], a[84:87], a[36:39], v[168:171]
  buffer_load_dwordx4 v16, s[4:7], s81 offen offset:2048  lds
  v_mfma_f32_16x16x32_bf16 v[192:195], a[84:87], a[44:47], v[192:195]
  ds_read_b64_tr_b16 a[74:75], v14 offset:512
  v_mfma_f32_16x16x32_bf16 v[192:195], a[80:83], a[40:43], v[192:195]
  v_cvt_pk_bf16_f32 v44, v44, v44
  v_mfma_f32_16x16x32_bf16 v[216:219], a[80:83], a[48:51], v[216:219]
  ds_read_b64_tr_b16 a[76:77], v14 offset:14336
  v_mfma_f32_16x16x32_bf16 v[216:219], a[84:87], a[52:55], v[216:219]
  v_mfma_f32_16x16x32_bf16 v[240:243], a[84:87], a[60:63], v[240:243]
  ds_read_b64_tr_b16 a[78:79], v14 offset:14848
  v_and_b32 v44, 0xffff0000, v44
  v_mfma_f32_16x16x32_bf16 v[240:243], a[80:83], a[56:59], v[240:243]
  v_mfma_f32_16x16x32_bf16 v[244:247], a[88:91], a[56:59], v[244:247]
  ds_read_b64_tr_b16 a[80:81], v13 offset:1024
  s_add_u32 m0, s86, 0
  v_mfma_f32_16x16x32_bf16 v[244:247], a[92:95], a[60:63], v[244:247]
  v_sqrt_f32_e64 v44, v44
  buffer_load_dwordx4 v16, s[4:7], s82 offen offset:0  lds
  v_mfma_f32_16x16x32_bf16 v[220:223], a[92:95], a[52:55], v[220:223]
  ds_read_b64_tr_b16 a[82:83], v13 offset:1536
  v_mfma_f32_16x16x32_bf16 v[220:223], a[88:91], a[48:51], v[220:223]
  v_mfma_f32_16x16x32_bf16 v[196:199], a[88:91], a[40:43], v[196:199]
  ds_read_b64_tr_b16 a[84:85], v13 offset:15360
  v_cvt_pk_bf16_f32 v44, v44, v44
  v_mfma_f32_16x16x32_bf16 v[196:199], a[92:95], a[44:47], v[196:199]
  buffer_load_dwordx4 v16, s[4:7], s82 offen offset:2048  lds
  v_mfma_f32_16x16x32_bf16 v[172:175], a[92:95], a[36:39], v[172:175]
  ds_read_b64_tr_b16 a[86:87], v13 offset:15872
  v_mfma_f32_16x16x32_bf16 v[172:175], a[88:91], a[32:35], v[172:175]
  v_and_b32 v44, 0xffff0000, v44
  v_mfma_f32_16x16x32_bf16 v[176:179], a[96:99], a[32:35], v[176:179]
  ds_read_b64_tr_b16 a[88:89], v14 offset:1024
  v_mfma_f32_16x16x32_bf16 v[176:179], a[100:103], a[36:39], v[176:179]
  v_mfma_f32_16x16x32_bf16 v[200:203], a[100:103], a[44:47], v[200:203]
  ds_read_b64_tr_b16 a[90:91], v14 offset:1536
  v_rcp_f32_e64 v44, v44
  v_mfma_f32_16x16x32_bf16 v[200:203], a[96:99], a[40:43], v[200:203]
  v_mfma_f32_16x16x32_bf16 v[224:227], a[96:99], a[48:51], v[224:227]
  ds_read_b64_tr_b16 a[92:93], v14 offset:15360
  s_add_u32 m0, s87, 0
  v_mfma_f32_16x16x32_bf16 v[224:227], a[100:103], a[52:55], v[224:227]
  v_mul_f32 v45, v44, v40
  buffer_load_dwordx4 v16, s[4:7], s83 offen offset:0  lds
  v_mfma_f32_16x16x32_bf16 v[248:251], a[100:103], a[60:63], v[248:251]
  ds_read_b64_tr_b16 a[94:95], v14 offset:15872
  v_mfma_f32_16x16x32_bf16 v[248:251], a[96:99], a[56:59], v[248:251]
  v_mfma_f32_16x16x32_bf16 v[252:255], a[104:107], a[56:59], v[252:255]
  ds_read_b64_tr_b16 a[96:97], v13 offset:2048
  v_mfma_f32_16x16x32_bf16 v[252:255], a[108:111], a[60:63], v[252:255]
  buffer_load_dwordx4 v16, s[4:7], s83 offen offset:2048  lds
  v_mfma_f32_16x16x32_bf16 v[228:231], a[108:111], a[52:55], v[228:231]
  ds_read_b64_tr_b16 a[98:99], v13 offset:2560
  s_add_u32 s4, s4, 128
  s_addc_u32 s5, s5, 0
  v_mfma_f32_16x16x32_bf16 v[228:231], a[104:107], a[48:51], v[228:231]
  v_mfma_f32_16x16x32_bf16 v[204:207], a[104:107], a[40:43], v[204:207]
  ds_read_b64_tr_b16 a[100:101], v13 offset:16384
  v_mfma_f32_16x16x32_bf16 v[204:207], a[108:111], a[44:47], v[204:207]
  v_mfma_f32_16x16x32_bf16 v[180:183], a[108:111], a[36:39], v[180:183]
  ds_read_b64_tr_b16 a[102:103], v13 offset:16896
  v_mfma_f32_16x16x32_bf16 v[180:183], a[104:107], a[32:35], v[180:183]
  v_mfma_f32_16x16x32_bf16 v[36:39], a[136:139], a[128:131], v[36:39]
  v_mfma_f32_16x16x32_bf16 v[36:39], a[136:139], a[132:135], v[36:39]
  s_waitcnt lgkmcnt(14)
  v_mfma_f32_16x16x32_bf16 v[64:67], a[64:67], a[0:3], v[64:67]
  ds_read_b64_tr_b16 a[104:105], v14 offset:2048
  s_mov_b32 exec_lo, s38
  s_mov_b32 exec_hi, 0
  s_cbranch_execz Lg_ncl
  buffer_store_dwordx2 v[32:33], v31, s[16:19], 0 offen sc1
Lg_ncl:
  s_mov_b64 exec, -1
  v_mfma_f32_16x16x32_bf16 v[64:67], a[68:71], a[4:7], v[64:67]
  v_mfma_f32_16x16x32_bf16 v[88:91], a[68:71], a[12:15], v[88:91]
  ds_read_b64_tr_b16 a[106:107], v14 offset:2560
  v_mfma_f32_16x16x32_bf16 v[88:91], a[64:67], a[8:11], v[88:91]
  v_mfma_f32_16x16x32_bf16 v[112:115], a[64:67], a[16:19], v[112:115]
  ds_read_b64_tr_b16 a[108:109], v14 offset:16384
  s_mov_b64 exec, 31
  buffer_store_dword v32, v29, s[16:19], 0 offen sc1
  s_mov_b64 exec, -1
  v_mfma_f32_16x16x32_bf16 v[112:115], a[68:71], a[20:23], v[112:115]
  v_mfma_f32_16x16x32_bf16 v[136:139], a[68:71], a[28:31], v[136:139]
  ds_read_b64_tr_b16 a[110:111], v14 offset:16896
  v_mfma_f32_16x16x32_bf16 v[136:139], a[64:67], a[24:27], v[136:139]
  s_waitcnt lgkmcnt(14)
  v_mfma_f32_16x16x32_bf16 v[140:143], a[72:75], a[24:27], v[140:143]
  ds_read_b128 a[32:35], v8 offset:43008
  s_mov_b64 exec, 0x101
  buffer_store_dwordx2 v[44:45], v30, s[16:19], 0 offen sc1
  s_mov_b64 exec, -1
  v_mfma_f32_16x16x32_bf16 v[140:143], a[76:79], a[28:31], v[140:143]
  v_mfma_f32_16x16x32_bf16 v[116:119], a[76:79], a[20:23], v[116:119]
  ds_read_b128 a[36:39], v9 offset:43008
  v_mfma_f32_16x16x32_bf16 v[116:119], a[72:75], a[16:19], v[116:119]
  v_mfma_f32_16x16x32_bf16 v[92:95], a[72:75], a[8:11], v[92:95]
  ds_read_b128 a[40:43], v8 offset:45056
  v_mfma_f32_16x16x32_bf16 v[92:95], a[76:79], a[12:15], v[92:95]
  v_mfma_f32_16x16x32_bf16 v[68:71], a[76:79], a[4:7], v[68:71]
  ds_read_b128 a[44:47], v9 offset:45056
  v_mfma_f32_16x16x32_bf16 v[68:71], a[72:75], a[0:3], v[68:71]
  s_waitcnt lgkmcnt(14)
  v_mfma_f32_16x16x32_bf16 v[72:75], a[80:83], a[0:3], v[72:75]
  ds_read_b128 a[48:51], v8 offset:47104
  s_add_u32 m0, s88, 28672
  v_mfma_f32_16x16x32_bf16 v[72:75], a[84:87], a[4:7], v[72:75]
  buffer_load_dwordx4 v18, s[8:11], s94 offen  lds
  v_mfma_f32_16x16x32_bf16 v[96:99], a[84:87], a[12:15], v[96:99]
  ds_read_b128 a[52:55], v9 offset:47104
  v_mfma_f32_16x16x32_bf16 v[96:99], a[80:83], a[8:11], v[96:99]
  v_mfma_f32_16x16x32_bf16 v[120:123], a[80:83], a[16:19], v[120:123]
  ds_read_b128 a[56:59], v8 offset:49152
  s_add_u32 m0, s89, 28672
  v_mfma_f32_16x16x32_bf16 v[120:123], a[84:87], a[20:23], v[120:123]
  buffer_load_dwordx4 v18, s[8:11], s95 offen  lds
  v_mfma_f32_16x16x32_bf16 v[144:147], a[84:87], a[28:31], v[144:147]
  ds_read_b128 a[60:63], v9 offset:49152
  v_mfma_f32_16x16x32_bf16 v[144:147], a[80:83], a[24:27], v[144:147]
  s_waitcnt lgkmcnt(14)
  v_mfma_f32_16x16x32_bf16 v[148:151], a[88:91], a[24:27], v[148:151]
  ds_read_b64_tr_b16 a[128:129], v25 offset:0
  s_add_u32 m0, s90, 28672
  v_mfma_f32_16x16x32_bf16 v[148:151], a[92:95], a[28:31], v[148:151]
  buffer_load_dwordx4 v18, s[8:11], s96 offen  lds
  v_mfma_f32_16x16x32_bf16 v[124:127], a[92:95], a[20:23], v[124:127]
  ds_read_b64_tr_b16 a[130:131], v26 offset:0
  v_mfma_f32_16x16x32_bf16 v[124:127], a[88:91], a[16:19], v[124:127]
  v_mfma_f32_16x16x32_bf16 v[100:103], a[88:91], a[8:11], v[100:103]
  ds_read_b64_tr_b16 a[132:133], v25 offset:14336
  v_mfma_f32_16x16x32_bf16 v[100:103], a[92:95], a[12:15], v[100:103]
  v_mfma_f32_16x16x32_bf16 v[76:79], a[92:95], a[4:7], v[76:79]
  ds_read_b64_tr_b16 a[134:135], v26 offset:14336
  v_mfma_f32_16x16x32_bf16 v[76:79], a[88:91], a[0:3], v[76:79]
  s_waitcnt lgkmcnt(14)
  v_mfma_f32_16x16x32_bf16 v[80:83], a[96:99], a[0:3], v[80:83]
  s_add_u32 m0, s91, 28672
  v_mfma_f32_16x16x32_bf16 v[80:83], a[100:103], a[4:7], v[80:83]
  buffer_load_dwordx4 v19, s[8:11], s94 offen  lds
  v_mfma_f32_16x16x32_bf16 v[104:107], a[100:103], a[12:15], v[104:107]
  v_mfma_f32_16x16x32_bf16 v[104:107], a[96:99], a[8:11], v[104:107]
  v_mfma_f32_16x16x32_bf16 v[128:131], a[96:99], a[16:19], v[128:131]
  s_add_u32 m0, s92, 28672
  v_mfma_f32_16x16x32_bf16 v[128:131], a[100:103], a[20:23], v[128:131]
  buffer_load_dwordx4 v19, s[8:11], s95 offen  lds
  v_mfma_f32_16x16x32_bf16 v[152:155], a[100:103], a[28:31], v[152:155]
  v_mfma_f32_16x16x32_bf16 v[152:155], a[96:99], a[24:27], v[152:155]
  s_waitcnt lgkmcnt(12)
  v_mfma_f32_16x16x32_bf16 v[156:159], a[104:107], a[24:27], v[156:159]
  s_add_u32 m0, s93, 28672
  v_mfma_f32_16x16x32_bf16 v[156:159], a[108:111], a[28:31], v[156:159]
  buffer_load_dwordx4 v19, s[8:11], s96 offen  lds
  v_mfma_f32_16x16x32_bf16 v[132:135], a[108:111], a[20:23], v[132:135]
  s_add_u32 s8, s8, 458752
  s_addc_u32 s9, s9, 0
  s_sub_u32 s8, s8, s65
  s_subb_u32 s9, s9, 0
  s_sub_u32 s65, 7340032, s65
  v_mfma_f32_16x16x32_bf16 v[132:135], a[104:107], a[16:19], v[132:135]
  v_mfma_f32_16x16x32_bf16 v[108:111], a[104:107], a[8:11], v[108:111]
  v_mfma_f32_16x16x32_bf16 v[108:111], a[108:111], a[12:15], v[108:111]
  v_mfma_f32_16x16x32_bf16 v[84:87], a[108:111], a[4:7], v[84:87]
  v_mfma_f32_16x16x32_bf16 v[84:87], a[104:107], a[0:3], v[84:87]
  s_waitcnt vmcnt(8) lgkmcnt(0)
  s_barrier
  v_mfma_f32_16x16x32_bf16 v[160:163], a[64:67], a[32:35], v[160:163]
  ds_read_b128 a[0:3], v8 offset:0
  s_add_u32 m0, s84, 34816
  v_mfma_f32_16x16x32_bf16 v[160:163], a[68:71], a[36:39], v[160:163]
  buffer_load_dwordx4 v16, s[4:7], s80 offen offset:0  lds
  v_mfma_f32_16x16x32_bf16 v[184:187], a[68:71], a[44:47], v[184:187]
  ds_read_b128 a[4:7], v9 offset:0
  v_mfma_f32_16x16x32_bf16 v[184:187], a[64:67], a[40:43], v[184:187]
  ds_read_b128 a[16:19], v8 offset:4096
  v_mfma_f32_16x16x32_bf16 v[208:211], a[64:67], a[48:51], v[208:211]
  ds_read_b128 a[8:11], v8 offset:2048
  v_mfma_f32_16x16x32_bf16 v[208:211], a[68:71], a[52:55], v[208:211]
  buffer_load_dwordx4 v16, s[4:7], s80 offen offset:2048  lds
  v_mfma_f32_16x16x32_bf16 v[232:235], a[68:71], a[60:63], v[232:235]
  ds_read_b128 a[12:15], v9 offset:2048
  v_mfma_f32_16x16x32_bf16 v[232:235], a[64:67], a[56:59], v[232:235]
  ds_read_b128 a[20:23], v9 offset:4096
  v_mfma_f32_16x16x32_bf16 v[236:239], a[72:75], a[56:59], v[236:239]
  ds_read_b64_tr_b16 a[64:65], v10 offset:0
  v_mfma_f32_16x16x32_bf16 v[236:239], a[76:79], a[60:63], v[236:239]
  v_mfma_f32_16x16x32_bf16 v[212:215], a[76:79], a[52:55], v[212:215]
  ds_read_b64_tr_b16 a[66:67], v10 offset:512
  v_mfma_f32_16x16x32_bf16 v[212:215], a[72:75], a[48:51], v[212:215]
  ds_read_b128 a[24:27], v8 offset:6144
  v_mfma_f32_16x16x32_bf16 v[188:191], a[72:75], a[40:43], v[188:191]
  ds_read_b64_tr_b16 a[68:69], v10 offset:14336
  s_add_u32 m0, s85, 34816
  v_mfma_f32_16x16x32_bf16 v[188:191], a[76:79], a[44:47], v[188:191]
  buffer_load_dwordx4 v16, s[4:7], s81 offen offset:0  lds
  v_mfma_f32_16x16x32_bf16 v[164:167], a[76:79], a[36:39], v[164:167]
  ds_read_b64_tr_b16 a[70:71], v10 offset:14848
  v_mfma_f32_16x16x32_bf16 v[164:167], a[72:75], a[32:35], v[164:167]
  ds_read_b128 a[28:31], v9 offset:6144
  v_mfma_f32_16x16x32_bf16 v[168:171], a[80:83], a[32:35], v[168:171]
  ds_read_b64_tr_b16 a[72:73], v11 offset:0
  v_mfma_f32_16x16x32_bf16 v[168:171], a[84:87], a[36:39], v[168:171]
  buffer_load_dwordx4 v16, s[4:7], s81 offen offset:2048  lds
  v_mfma_f32_16x16x32_bf16 v[192:195], a[84:87], a[44:47], v[192:195]
  ds_read_b64_tr_b16 a[74:75], v11 offset:512
  v_mfma_f32_16x16x32_bf16 v[192:195], a[80:83], a[40:43], v[192:195]
  v_mfma_f32_16x16x32_bf16 v[216:219], a[80:83], a[48:51], v[216:219]
  ds_read_b64_tr_b16 a[76:77], v11 offset:14336
  v_mfma_f32_16x16x32_bf16 v[216:219], a[84:87], a[52:55], v[216:219]
  v_mfma_f32_16x16x32_bf16 v[240:243], a[84:87], a[60:63], v[240:243]
  ds_read_b64_tr_b16 a[78:79], v11 offset:14848
  v_mfma_f32_16x16x32_bf16 v[240:243], a[80:83], a[56:59], v[240:243]
  v_mfma_f32_16x16x32_bf16 v[244:247], a[88:91], a[56:59], v[244:247]
  ds_read_b64_tr_b16 a[80:81], v10 offset:1024
  s_add_u32 m0, s86, 34816
  v_mfma_f32_16x16x32_bf16 v[244:247], a[92:95], a[60:63], v[244:247]
  buffer_load_dwordx4 v16, s[4:7], s82 offen offset:0  lds
  v_mfma_f32_16x16x32_bf16 v[220:223], a[92:95], a[52:55], v[220:223]
  ds_read_b64_tr_b16 a[82:83], v10 offset:1536
  v_mfma_f32_16x16x32_bf16 v[220:223], a[88:91], a[48:51], v[220:223]
  v_mfma_f32_16x16x32_bf16 v[196:199], a[88:91], a[40:43], v[196:199]
  ds_read_b64_tr_b16 a[84:85], v10 offset:15360
  v_mfma_f32_16x16x32_bf16 v[196:199], a[92:95], a[44:47], v[196:199]
  buffer_load_dwordx4 v16, s[4:7], s82 offen offset:2048  lds
  v_mfma_f32_16x16x32_bf16 v[172:175], a[92:95], a[36:39], v[172:175]
  ds_read_b64_tr_b16 a[86:87], v10 offset:15872
  v_mfma_f32_16x16x32_bf16 v[172:175], a[88:91], a[32:35], v[172:175]
  v_mfma_f32_16x16x32_bf16 v[176:179], a[96:99], a[32:35], v[176:179]
  ds_read_b64_tr_b16 a[88:89], v11 offset:1024
  v_mfma_f32_16x16x32_bf16 v[176:179], a[100:103], a[36:39], v[176:179]
  v_mfma_f32_16x16x32_bf16 v[200:203], a[100:103], a[44:47], v[200:203]
  ds_read_b64_tr_b16 a[90:91], v11 offset:1536
  v_mfma_f32_16x16x32_bf16 v[200:203], a[96:99], a[40:43], v[200:203]
  v_mfma_f32_16x16x32_bf16 v[224:227], a[96:99], a[48:51], v[224:227]
  ds_read_b64_tr_b16 a[92:93], v11 offset:15360
  s_add_u32 m0, s87, 34816
  v_mfma_f32_16x16x32_bf16 v[224:227], a[100:103], a[52:55], v[224:227]
  buffer_load_dwordx4 v16, s[4:7], s83 offen offset:0  lds
  v_mfma_f32_16x16x32_bf16 v[248:251], a[100:103], a[60:63], v[248:251]
  ds_read_b64_tr_b16 a[94:95], v11 offset:15872
  v_mfma_f32_16x16x32_bf16 v[248:251], a[96:99], a[56:59], v[248:251]
  v_mfma_f32_16x16x32_bf16 v[252:255], a[104:107], a[56:59], v[252:255]
  ds_read_b64_tr_b16 a[96:97], v10 offset:2048
  v_mfma_f32_16x16x32_bf16 v[252:255], a[108:111], a[60:63], v[252:255]
  buffer_load_dwordx4 v16, s[4:7], s83 offen offset:2048  lds
  v_mfma_f32_16x16x32_bf16 v[228:231], a[108:111], a[52:55], v[228:231]
  ds_read_b64_tr_b16 a[98:99], v10 offset:2560
  s_add_u32 s4, s4, 128
  s_addc_u32 s5, s5, 0
  s_sub_u32 s4, s4, s64
  s_subb_u32 s5, s5, 0
  s_sub_u32 s64, 2048, s64
  v_mfma_f32_16x16x32_bf16 v[228:231], a[104:107], a[48:51], v[228:231]
  v_mfma_f32_16x16x32_bf16 v[204:207], a[104:107], a[40:43], v[204:207]
  ds_read_b64_tr_b16 a[100:101], v10 offset:16384
  v_mfma_f32_16x16x32_bf16 v[204:207], a[108:111], a[44:47], v[204:207]
  v_mfma_f32_16x16x32_bf16 v[180:183], a[108:111], a[36:39], v[180:183]
  ds_read_b64_tr_b16 a[102:103], v10 offset:16896
  v_mfma_f32_16x16x32_bf16 v[180:183], a[104:107], a[32:35], v[180:183]
  v_mfma_f32_16x16x32_bf16 v[36:39], a[136:139], a[128:131], v[36:39]
  v_mfma_f32_16x16x32_bf16 v[36:39], a[136:139], a[132:135], v[36:39]
  s_waitcnt lgkmcnt(14)
  v_mfma_f32_16x16x32_bf16 v[64:67], a[64:67], a[0:3], v[64:67]
  ds_read_b64_tr_b16 a[104:105], v11 offset:2048
  s_add_u32 m0, s88, 57344
  v_mfma_f32_16x16x32_bf16 v[64:67], a[68:71], a[4:7], v[64:67]
  buffer_load_dwordx4 v18, s[8:11], s94 offen  lds
  v_mfma_f32_16x16x32_bf16 v[88:91], a[68:71], a[12:15], v[88:91]
  ds_read_b64_tr_b16 a[106:107], v11 offset:2560
  v_mfma_f32_16x16x32_bf16 v[88:91], a[64:67], a[8:11], v[88:91]
  v_mfma_f32_16x16x32_bf16 v[112:115], a[64:67], a[16:19], v[112:115]
  ds_read_b64_tr_b16 a[108:109], v11 offset:16384
  v_mfma_f32_16x16x32_bf16 v[112:115], a[68:71], a[20:23], v[112:115]
  v_mfma_f32_16x16x32_bf16 v[136:139], a[68:71], a[28:31], v[136:139]
  ds_read_b64_tr_b16 a[110:111], v11 offset:16896
  v_mfma_f32_16x16x32_bf16 v[136:139], a[64:67], a[24:27], v[136:139]
  s_waitcnt lgkmcnt(14)
  v_mfma_f32_16x16x32_bf16 v[140:143], a[72:75], a[24:27], v[140:143]
  ds_read_b128 a[32:35], v8 offset:8192
  s_add_u32 m0, s89, 57344
  v_mfma_f32_16x16x32_bf16 v[140:143], a[76:79], a[28:31], v[140:143]
  buffer_load_dwordx4 v18, s[8:11], s95 offen  lds
  v_mfma_f32_16x16x32_bf16 v[116:119], a[76:79], a[20:23], v[116:119]
  ds_read_b128 a[36:39], v9 offset:8192
  v_mfma_f32_16x16x32_bf16 v[116:119], a[72:75], a[16:19], v[116:119]
  v_mfma_f32_16x16x32_bf16 v[92:95], a[72:75], a[8:11], v[92:95]
  ds_read_b128 a[40:43], v8 offset:10240
  v_mfma_f32_16x16x32_bf16 v[92:95], a[76:79], a[12:15], v[92:95]
  v_mfma_f32_16x16x32_bf16 v[68:71], a[76:79], a[4:7], v[68:71]
  ds_read_b128 a[44:47], v9 offset:10240
  v_mfma_f32_16x16x32_bf16 v[68:71], a[72:75], a[0:3], v[68:71]
  s_waitcnt lgkmcnt(14)
  v_mfma_f32_16x16x32_bf16 v[72:75], a[80:83], a[0:3], v[72:75]
  ds_read_b128 a[48:51], v8 offset:12288
  s_add_u32 m0, s90, 57344
  v_mfma_f32_16x16x32_bf16 v[72:75], a[84:87], a[4:7], v[72:75]
  buffer_load_dwordx4 v18, s[8:11], s96 offen  lds
  v_mfma_f32_16x16x32_bf16 v[96:99], a[84:87], a[12:15], v[96:99]
  ds_read_b128 a[52:55], v9 offset:12288
  v_mfma_f32_16x16x32_bf16 v[96:99], a[80:83], a[8:11], v[96:99]
  v_mfma_f32_16x16x32_bf16 v[120:123], a[80:83], a[16:19], v[120:123]
  ds_read_b128 a[56:59], v8 offset:14336
  v_mfma_f32_16x16x32_bf16 v[120:123], a[84:87], a[20:23], v[120:123]
  v_mfma_f32_16x16x32_bf16 v[144:147], a[84:87], a[28:31], v[144:147]
  ds_read_b128 a[60:63], v9 offset:14336
  v_mfma_f32_16x16x32_bf16 v[144:147], a[80:83], a[24:27], v[144:147]
  s_waitcnt lgkmcnt(14)
  v_mfma_f32_16x16x32_bf16 v[148:151], a[88:91], a[24:27], v[148:151]
  ds_read_b64_tr_b16 a[128:129], v23 offset:0
  s_add_u32 m0, s91, 57344
  v_mfma_f32_16x16x32_bf16 v[148:151], a[92:95], a[28:31], v[148:151]
  buffer_load_dwordx4 v19, s[8:11], s94 offen  lds
  v_mfma_f32_16x16x32_bf16 v[124:127], a[92:95], a[20:23], v[124:127]
  ds_read_b64_tr_b16 a[130:131], v24 offset:0
  v_mfma_f32_16x16x32_bf16 v[124:127], a[88:91], a[16:19], v[124:127]
  v_mfma_f32_16x16x32_bf16 v[100:103], a[88:91], a[8:11], v[100:103]
  ds_read_b64_tr_b16 a[132:133], v23 offset:14336
  v_mfma_f32_16x16x32_bf16 v[100:103], a[92:95], a[12:15], v[100:103]
  v_mfma_f32_16x16x32_bf16 v[76:79], a[92:95], a[4:7], v[76:79]
  ds_read_b64_tr_b16 a[134:135], v24 offset:14336
  v_mfma_f32_16x16x32_bf16 v[76:79], a[88:91], a[0:3], v[76:79]
  s_waitcnt lgkmcnt(14)
  v_mfma_f32_16x16x32_bf16 v[80:83], a[96:99], a[0:3], v[80:83]
  s_add_u32 m0, s92, 57344
  v_mfma_f32_16x16x32_bf16 v[80:83], a[100:103], a[4:7], v[80:83]
  buffer_load_dwordx4 v19, s[8:11], s95 offen  lds
  v_mfma_f32_16x16x32_bf16 v[104:107], a[100:103], a[12:15], v[104:107]
  v_mfma_f32_16x16x32_bf16 v[104:107], a[96:99], a[8:11], v[104:107]
  v_mfma_f32_16x16x32_bf16 v[128:131], a[96:99], a[16:19], v[128:131]
  v_mfma_f32_16x16x32_bf16 v[128:131], a[100:103], a[20:23], v[128:131]
  v_mfma_f32_16x16x32_bf16 v[152:155], a[100:103], a[28:31], v[152:155]
  v_mfma_f32_16x16x32_bf16 v[152:155], a[96:99], a[24:27], v[152:155]
  s_waitcnt lgkmcnt(12)
  v_mfma_f32_16x16x32_bf16 v[156:159], a[104:107], a[24:27], v[156:159]
  s_add_u32 m0, s93, 57344
  v_mfma_f32_16x16x32_bf16 v[156:159], a[108:111], a[28:31], v[156:159]
  buffer_load_dwordx4 v19, s[8:11], s96 offen  lds
  v_mfma_f32_16x16x32_bf16 v[132:135], a[108:111], a[20:23], v[132:135]
  s_add_u32 s8, s8, 458752
  s_addc_u32 s9, s9, 0
  v_mfma_f32_16x16x32_bf16 v[132:135], a[104:107], a[16:19], v[132:135]
  v_mfma_f32_16x16x32_bf16 v[108:111], a[104:107], a[8:11], v[108:111]
  v_mfma_f32_16x16x32_bf16 v[108:111], a[108:111], a[12:15], v[108:111]
  v_mfma_f32_16x16x32_bf16 v[84:87], a[108:111], a[4:7], v[84:87]
  v_mfma_f32_16x16x32_bf16 v[84:87], a[104:107], a[0:3], v[84:87]
  s_waitcnt vmcnt(6) lgkmcnt(0)
  s_barrier
  v_mfma_f32_16x16x32_bf16 v[160:163], a[64:67], a[32:35], v[160:163]
  ds_read_b128 a[0:3], v8 offset:34816
  s_add_u32 m0, s84, 0
  v_mfma_f32_16x16x32_bf16 v[160:163], a[68:71], a[36:39], v[160:163]
  buffer_load_dwordx4 v16, s[4:7], s80 offen offset:0  lds
  v_mfma_f32_16x16x32_bf16 v[184:187], a[68:71], a[44:47], v[184:187]
  ds_read_b128 a[4:7], v9 offset:34816
  v_mfma_f32_16x16x32_bf16 v[184:187], a[64:67], a[40:43], v[184:187]
  ds_read_b128 a[16:19], v8 offset:38912
  v_mfma_f32_16x16x32_bf16 v[208:211], a[64:67], a[48:51], v[208:211]
  ds_read_b128 a[8:11], v8 offset:36864
  v_mfma_f32_16x16x32_bf16 v[208:211], a[68:71], a[52:55], v[208:211]
  buffer_load_dwordx4 v16, s[4:7], s80 offen offset:2048  lds
  v_mfma_f32_16x16x32_bf16 v[232:235], a[68:71], a[60:63], v[232:235]
  ds_read_b128 a[12:15], v9 offset:36864
  v_mfma_f32_16x16x32_bf16 v[232:235], a[64:67], a[56:59], v[232:235]
  ds_read_b128 a[20:23], v9 offset:38912
  v_mfma_f32_16x16x32_bf16 v[236:239], a[72:75], a[56:59], v[236:239]
  ds_read_b64_tr_b16 a[64:65], v10 offset:28672
  v_mfma_f32_16x16x32_bf16 v[236:239], a[76:79], a[60:63], v[236:239]
  v_mfma_f32_16x16x32_bf16 v[212:215], a[76:79], a[52:55], v[212:215]
  ds_read_b64_tr_b16 a[66:67], v10 offset:29184
  v_mfma_f32_16x16x32_bf16 v[212:215], a[72:75], a[48:51], v[212:215]
  ds_read_b128 a[24:27], v8 offset:40960
  v_mfma_f32_16x16x32_bf16 v[188:191], a[72:75], a[40:43], v[188:191]
  ds_read_b64_tr_b16 a[68:69], v10 offset:43008
  s_add_u32 m0, s85, 0
  v_mfma_f32_16x16x32_bf16 v[188:191], a[76:79], a[44:47], v[188:191]
  buffer_load_dwordx4 v16, s[4:7], s81 offen offset:0  lds
  v_mfma_f32_16x16x32_bf16 v[164:167], a[76:79], a[36:39], v[164:167]
  ds_read_b64_tr_b16 a[70:71], v10 offset:43520
  v_mfma_f32_16x16x32_bf16 v[164:167], a[72:75], a[32:35], v[164:167]
  ds_read_b128 a[28:31], v9 offset:40960
  v_mfma_f32_16x16x32_bf16 v[168:171], a[80:83], a[32:35], v[168:171]
  ds_read_b64_tr_b16 a[72:73], v11 offset:28672
  v_mfma_f32_16x16x32_bf16 v[168:171], a[84:87], a[36:39], v[168:171]
  buffer_load_dwordx4 v16, s[4:7], s81 offen offset:2048  lds
  v_mfma_f32_16x16x32_bf16 v[192:195], a[84:87], a[44:47], v[192:195]
  ds_read_b64_tr_b16 a[74:75], v11 offset:29184
  v_mfma_f32_16x16x32_bf16 v[192:195], a[80:83], a[40:43], v[192:195]
  v_mfma_f32_16x16x32_bf16 v[216:219], a[80:83], a[48:51], v[216:219]
  ds_read_b64_tr_b16 a[76:77], v11 offset:43008
  v_mfma_f32_16x16x32_bf16 v[216:219], a[84:87], a[52:55], v[216:219]
  v_mfma_f32_16x16x32_bf16 v[240:243], a[84:87], a[60:63], v[240:243]
  ds_read_b64_tr_b16 a[78:79], v11 offset:43520
  v_mfma_f32_16x16x32_bf16 v[240:243], a[80:83], a[56:59], v[240:243]
  v_mfma_f32_16x16x32_bf16 v[244:247], a[88:91], a[56:59], v[244:247]
  ds_read_b64_tr_b16 a[80:81], v10 offset:29696
  s_add_u32 m0, s86, 0
  v_mfma_f32_16x16x32_bf16 v[244:247], a[92:95], a[60:63], v[244:247]
  buffer_load_dwordx4 v16, s[4:7], s82 offen offset:0  lds
  v_mfma_f32_16x16x32_bf16 v[220:223], a[92:95], a[52:55], v[220:223]
  ds_read_b64_tr_b16 a[82:83], v10 offset:30208
  v_mfma_f32_16x16x32_bf16 v[220:223], a[88:91], a[48:51], v[220:223]
  v_mfma_f32_16x16x32_bf16 v[196:199], a[88:91], a[40:43], v[196:199]
  ds_read_b64_tr_b16 a[84:85], v10 offset:44032
  v_mfma_f32_16x16x32_bf16 v[196:199], a[92:95], a[44:47], v[196:199]
  buffer_load_dwordx4 v16, s[4:7], s82 offen offset:2048  lds
  v_mfma_f32_16x16x32_bf16 v[172:175], a[92:95], a[36:39], v[172:175]
  ds_read_b64_tr_b16 a[86:87], v10 offset:44544
  v_mfma_f32_16x16x32_bf16 v[172:175], a[88:91], a[32:35], v[172:175]
  v_mfma_f32_16x16x32_bf16 v[176:179], a[96:99], a[32:35], v[176:179]
  ds_read_b64_tr_b16 a[88:89], v11 offset:29696
  v_mfma_f32_16x16x32_bf16 v[176:179], a[100:103], a[36:39], v[176:179]
  v_mfma_f32_16x16x32_bf16 v[200:203], a[100:103], a[44:47], v[200:203]
  ds_read_b64_tr_b16 a[90:91], v11 offset:30208
  v_mfma_f32_16x16x32_bf16 v[200:203], a[96:99], a[40:43], v[200:203]
  v_mfma_f32_16x16x32_bf16 v[224:227], a[96:99], a[48:51], v[224:227]
  ds_read_b64_tr_b16 a[92:93], v11 offset:44032
  s_add_u32 m0, s87, 0
  v_mfma_f32_16x16x32_bf16 v[224:227], a[100:103], a[52:55], v[224:227]
  buffer_load_dwordx4 v16, s[4:7], s83 offen offset:0  lds
  v_mfma_f32_16x16x32_bf16 v[248:251], a[100:103], a[60:63], v[248:251]
  ds_read_b64_tr_b16 a[94:95], v11 offset:44544
  v_mfma_f32_16x16x32_bf16 v[248:251], a[96:99], a[56:59], v[248:251]
  v_mfma_f32_16x16x32_bf16 v[252:255], a[104:107], a[56:59], v[252:255]
  ds_read_b64_tr_b16 a[96:97], v10 offset:30720
  v_mfma_f32_16x16x32_bf16 v[252:255], a[108:111], a[60:63], v[252:255]
  buffer_load_dwordx4 v16, s[4:7], s83 offen offset:2048  lds
  v_mfma_f32_16x16x32_bf16 v[228:231], a[108:111], a[52:55], v[228:231]
  ds_read_b64_tr_b16 a[98:99], v10 offset:31232
  s_add_u32 s4, s4, 128
  s_addc_u32 s5, s5, 0
  v_mfma_f32_16x16x32_bf16 v[228:231], a[104:107], a[48:51], v[228:231]
  v_mfma_f32_16x16x32_bf16 v[204:207], a[104:107], a[40:43], v[204:207]
  ds_read_b64_tr_b16 a[100:101], v10 offset:45056
  v_mfma_f32_16x16x32_bf16 v[204:207], a[108:111], a[44:47], v[204:207]
  v_mfma_f32_16x16x32_bf16 v[180:183], a[108:111], a[36:39], v[180:183]
  ds_read_b64_tr_b16 a[102:103], v10 offset:45568
  v_mfma_f32_16x16x32_bf16 v[180:183], a[104:107], a[32:35], v[180:183]
  v_mfma_f32_16x16x32_bf16 v[36:39], a[136:139], a[128:131], v[36:39]
  v_mfma_f32_16x16x32_bf16 v[36:39], a[136:139], a[132:135], v[36:39]
  s_waitcnt lgkmcnt(14)
  v_mfma_f32_16x16x32_bf16 v[64:67], a[64:67], a[0:3], v[64:67]
  ds_read_b64_tr_b16 a[104:105], v11 offset:30720
  s_add_u32 m0, s88, 0
  v_mfma_f32_16x16x32_bf16 v[64:67], a[68:71], a[4:7], v[64:67]
  buffer_load_dwordx4 v18, s[8:11], s94 offen  lds
  v_mfma_f32_16x16x32_bf16 v[88:91], a[68:71], a[12:15], v[88:91]
  ds_read_b64_tr_b16 a[106:107], v11 offset:31232
  v_mfma_f32_16x16x32_bf16 v[88:91], a[64:67], a[8:11], v[88:91]
  v_mfma_f32_16x16x32_bf16 v[112:115], a[64:67], a[16:19], v[112:115]
  ds_read_b64_tr_b16 a[108:109], v11 offset:45056
  s_add_u32 m0, s89, 0
  v_mfma_f32_16x16x32_bf16 v[112:115], a[68:71], a[20:23], v[112:115]
  buffer_load_dwordx4 v18, s[8:11], s95 offen  lds
  v_mfma_f32_16x16x32_bf16 v[136:139], a[68:71], a[28:31], v[136:139]
  ds_read_b64_tr_b16 a[110:111], v11 offset:45568
  v_mfma_f32_16x16x32_bf16 v[136:139], a[64:67], a[24:27], v[136:139]
  s_waitcnt lgkmcnt(14)
  v_mfma_f32_16x16x32_bf16 v[140:143], a[72:75], a[24:27], v[140:143]
  ds_read_b128 a[32:35], v8 offset:43008
  v_mfma_f32_16x16x32_bf16 v[140:143], a[76:79], a[28:31], v[140:143]
  v_mfma_f32_16x16x32_bf16 v[116:119], a[76:79], a[20:23], v[116:119]
  ds_read_b128 a[36:39], v9 offset:43008
  v_mfma_f32_16x16x32_bf16 v[116:119], a[72:75], a[16:19], v[116:119]
  v_mfma_f32_16x16x32_bf16 v[92:95], a[72:75], a[8:11], v[92:95]
  ds_read_b128 a[40:43], v8 offset:45056
  s_add_u32 m0, s90, 0
  v_mfma_f32_16x16x32_bf16 v[92:95], a[76:79], a[12:15], v[92:95]
  buffer_load_dwordx4 v18, s[8:11], s96 offen  lds
  v_mfma_f32_16x16x32_bf16 v[68:71], a[76:79], a[4:7], v[68:71]
  ds_read_b128 a[44:47], v9 offset:45056
  v_mfma_f32_16x16x32_bf16 v[68:71], a[72:75], a[0:3], v[68:71]
  s_waitcnt lgkmcnt(14)
  v_mfma_f32_16x16x32_bf16 v[72:75], a[80:83], a[0:3], v[72:75]
  ds_read_b128 a[48:51], v8 offset:47104
  v_mfma_f32_16x16x32_bf16 v[72:75], a[84:87], a[4:7], v[72:75]
  v_mfma_f32_16x16x32_bf16 v[96:99], a[84:87], a[12:15], v[96:99]
  ds_read_b128 a[52:55], v9 offset:47104
  v_mfma_f32_16x16x32_bf16 v[96:99], a[80:83], a[8:11], v[96:99]
  v_mfma_f32_16x16x32_bf16 v[120:123], a[80:83], a[16:19], v[120:123]
  ds_read_b128 a[56:59], v8 offset:49152
  s_add_u32 m0, s91, 0
  v_mfma_f32_16x16x32_bf16 v[120:123], a[84:87], a[20:23], v[120:123]
  buffer_load_dwordx4 v19, s[8:11], s94 offen  lds
  v_mfma_f32_16x16x32_bf16 v[144:147], a[84:87], a[28:31], v[144:147]
  ds_read_b128 a[60:63], v9 offset:49152
  v_mfma_f32_16x16x32_bf16 v[144:147], a[80:83], a[24:27], v[144:147]
  s_waitcnt lgkmcnt(14)
  v_mfma_f32_16x16x32_bf16 v[148:151], a[88:91], a[24:27], v[148:151]
  ds_read_b64_tr_b16 a[128:129], v23 offset:28672
  s_add_u32 m0, s92, 0
  v_mfma_f32_16x16x32_bf16 v[148:151], a[92:95], a[28:31], v[148:151]
  buffer_load_dwordx4 v19, s[8:11], s95 offen  lds
  v_mfma_f32_16x16x32_bf16 v[124:127], a[92:95], a[20:23], v[124:127]
  ds_read_b64_tr_b16 a[130:131], v24 offset:28672
  v_mfma_f32_16x16x32_bf16 v[124:127], a[88:91], a[16:19], v[124:127]
  v_mfma_f32_16x16x32_bf16 v[100:103], a[88:91], a[8:11], v[100:103]
  ds_read_b64_tr_b16 a[132:133], v23 offset:43008
  v_mfma_f32_16x16x32_bf16 v[100:103], a[92:95], a[12:15], v[100:103]
  v_mfma_f32_16x16x32_bf16 v[76:79], a[92:95], a[4:7], v[76:79]
  ds_read_b64_tr_b16 a[134:135], v24 offset:43008
  v_mfma_f32_16x16x32_bf16 v[76:79], a[88:91], a[0:3], v[76:79]
  s_waitcnt lgkmcnt(14)
  v_mfma_f32_16x16x32_bf16 v[80:83], a[96:99], a[0:3], v[80:83]
  s_add_u32 m0, s93, 0
  v_mfma_f32_16x16x32_bf16 v[80:83], a[100:103], a[4:7], v[80:83]
  buffer_load_dwordx4 v19, s[8:11], s96 offen  lds
  v_mfma_f32_16x16x32_bf16 v[104:107], a[100:103], a[12:15], v[104:107]
  s_add_u32 s8, s8, 458752
  s_addc_u32 s9, s9, 0
  v_mfma_f32_16x16x32_bf16 v[104:107], a[96:99], a[8:11], v[104:107]
  v_mfma_f32_16x16x32_bf16 v[128:131], a[96:99], a[16:19], v[128:131]
  v_mfma_f32_16x16x32_bf16 v[128:131], a[100:103], a[20:23], v[128:131]
  v_mfma_f32_16x16x32_bf16 v[152:155], a[100:103], a[28:31], v[152:155]
  v_mfma_f32_16x16x32_bf16 v[152:155], a[96:99], a[24:27], v[152:155]
  s_waitcnt lgkmcnt(12)
  v_mfma_f32_16x16x32_bf16 v[156:159], a[104:107], a[24:27], v[156:159]
  s_bfe_u32 s29, s2, 0x10004
  s_lshl_b32 s39, s20, 1
  s_add_u32 s29, s29, s39
  s_cmp_eq_u32 s29, 0
  s_cbranch_scc0 Lg_na6
  s_lshr_b32 s29, s2, 0
  s_and_b32 s29, s29, 0
  s_lshl_b64 exec, 1, s29
  buffer_atomic_add v35, v34, s[48:51], 0 offen sc1
  s_mov_b64 exec, -1
Lg_na6:
  v_mfma_f32_16x16x32_bf16 v[156:159], a[108:111], a[28:31], v[156:159]
  v_mfma_f32_16x16x32_bf16 v[132:135], a[108:111], a[20:23], v[132:135]
  v_mfma_f32_16x16x32_bf16 v[132:135], a[104:107], a[16:19], v[132:135]
  v_mfma_f32_16x16x32_bf16 v[108:111], a[104:107], a[8:11], v[108:111]
  v_mfma_f32_16x16x32_bf16 v[108:111], a[108:111], a[12:15], v[108:111]
  v_mfma_f32_16x16x32_bf16 v[84:87], a[108:111], a[4:7], v[84:87]
  v_mfma_f32_16x16x32_bf16 v[84:87], a[104:107], a[0:3], v[84:87]
  s_waitcnt vmcnt(6) lgkmcnt(0)
  s_barrier
  v_mfma_f32_16x16x32_bf16 v[160:163], a[64:67], a[32:35], v[160:163]
  ds_read_b128 a[0:3], v8 offset:0
  s_add_u32 m0, s84, 34816
  v_mfma_f32_16x16x32_bf16 v[160:163], a[68:71], a[36:39], v[160:163]
  buffer_load_dwordx4 v16, s[4:7], s80 offen offset:0  lds
  v_mfma_f32_16x16x32_bf16 v[184:187], a[68:71], a[44:47], v[184:187]
  ds_read_b128 a[4:7], v9 offset:0
  v_mfma_f32_16x16x32_bf16 v[184:187], a[64:67], a[40:43], v[184:187]
  ds_read_b128 a[16:19], v8 offset:4096
Lg_pad3:
  s_cbranch_execz Lg_ret0
  s_nop 0
  v_mfma_f32_16x16x32_bf16 v[208:211], a[64:67], a[48:51], v[208:211]
  ds_read_b128 a[8:11], v8 offset:2048
  v_mfma_f32_16x16x32_bf16 v[208:211], a[68:71], a[52:55], v[208:211]
  buffer_load_dwordx4 v16, s[4:7], s80 offen offset:2048  lds
  v_mfma_f32_16x16x32_bf16 v[232:235], a[68:71], a[60:63], v[232:235]
  ds_read_b128 a[12:15], v9 offset:2048
  v_mfma_f32_16x16x32_bf16 v[232:235], a[64:67], a[56:59], v[232:235]
  ds_read_b128 a[20:23], v9 offset:4096
  v_mfma_f32_16x16x32_bf16 v[236:239], a[72:75], a[56:59], v[236:239]
  ds_read_b64_tr_b16 a[64:65], v13 offset:0
  v_mfma_f32_16x16x32_bf16 v[236:239], a[76:79], a[60:63], v[236:239]
  v_mfma_f32_16x16x32_bf16 v[212:215], a[76:79], a[52:55], v[212:215]
  ds_read_b64_tr_b16 a[66:67], v13 offset:512
  v_mfma_f32_16x16x32_bf16 v[212:215], a[72:75], a[48:51], v[212:215]
  ds_read_b128 a[24:27], v8 offset:6144
  v_mfma_f32_16x16x32_bf16 v[188:191], a[72:75], a[40:43], v[188:191]
  ds_read_b64_tr_b16 a[68:69], v13 offset:14336
  s_add_u32 m0, s85, 34816
  v_mfma_f32_16x16x32_bf16 v[188:191], a[76:79], a[44:47], v[188:191]
  buffer_load_dwordx4 v16, s[4:7], s81 offen offset:0  lds
  v_mfma_f32_16x16x32_bf16 v[164:167], a[76:79], a[36:39], v[164:167]
  ds_read_b64_tr_b16 a[70:71], v13 offset:14848
  v_mfma_f32_16x16x32_bf16 v[164:167], a[72:75], a[32:35], v[164:167]
  ds_read_b128 a[28:31], v9 offset:6144
  v_mfma_f32_16x16x32_bf16 v[168:171], a[80:83], a[32:35], v[168:171]
  ds_read_b64_tr_b16 a[72:73], v14 offset:0
  v_mfma_f32_16x16x32_bf16 v[168:171], a[84:87], a[36:39], v[168:171]
  buffer_load_dwordx4 v16, s[4:7], s81 offen offset:2048  lds
  v_mfma_f32_16x16x32_bf16 v[192:195], a[84:87], a[44:47], v[192:195]
  ds_read_b64_tr_b16 a[74:75], v14 offset:512
  v_mfma_f32_16x16x32_bf16 v[192:195], a[80:83], a[40:43], v[192:195]
  v_mfma_f32_16x16x32_bf16 v[216:219], a[80:83], a[48:51], v[216:219]
  ds_read_b64_tr_b16 a[76:77], v14 offset:14336
  v_mfma_f32_16x16x32_bf16 v[216:219], a[84:87], a[52:55], v[216:219]
  v_mfma_f32_16x16x32_bf16 v[240:243], a[84:87], a[60:63], v[240:243]
  ds_read_b64_tr_b16 a[78:79], v14 offset:14848
  v_mfma_f32_16x16x32_bf16 v[240:243], a[80:83], a[56:59], v[240:243]
  v_mfma_f32_16x16x32_bf16 v[244:247], a[88:91], a[56:59], v[244:247]
  ds_read_b64_tr_b16 a[80:81], v13 offset:1024
  s_add_u32 m0, s86, 34816
  v_mfma_f32_16x16x32_bf16 v[244:247], a[92:95], a[60:63], v[244:247]
  buffer_load_dwordx4 v16, s[4:7], s82 offen offset:0  lds
  v_mfma_f32_16x16x32_bf16 v[220:223], a[92:95], a[52:55], v[220:223]
  ds_read_b64_tr_b16 a[82:83], v13 offset:1536
  v_mfma_f32_16x16x32_bf16 v[220:223], a[88:91], a[48:51], v[220:223]
  v_mfma_f32_16x16x32_bf16 v[196:199], a[88:91], a[40:43], v[196:199]
  ds_read_b64_tr_b16 a[84:85], v13 offset:15360
  v_mfma_f32_16x16x32_bf16 v[196:199], a[92:95], a[44:47], v[196:199]
  buffer_load_dwordx4 v16, s[4:7], s82 offen offset:2048  lds
  v_mfma_f32_16x16x32_bf16 v[172:175], a[92:95], a[36:39], v[172:175]
  ds_read_b64_tr_b16 a[86:87], v13 offset:15872
  v_mfma_f32_16x16x32_bf16 v[172:175], a[88:91], a[32:35], v[172:175]
  v_mfma_f32_16x16x32_bf16 v[176:179], a[96:99], a[32:35], v[176:179]
  ds_read_b64_tr_b16 a[88:89], v14 offset:1024
  v_mfma_f32_16x16x32_bf16 v[176:179], a[100:103], a[36:39], v[176:179]
  v_mfma_f32_16x16x32_bf16 v[200:203], a[100:103], a[44:47], v[200:203]
  ds_read_b64_tr_b16 a[90:91], v14 offset:1536
  v_mfma_f32_16x16x32_bf16 v[200:203], a[96:99], a[40:43], v[200:203]
  v_mfma_f32_16x16x32_bf16 v[224:227], a[96:99], a[48:51], v[224:227]
  ds_read_b64_tr_b16 a[92:93], v14 offset:15360
  s_add_u32 m0, s87, 34816
  v_mfma_f32_16x16x32_bf16 v[224:227], a[100:103], a[52:55], v[224:227]
  buffer_load_dwordx4 v16, s[4:7], s83 offen offset:0  lds
  v_mfma_f32_16x16x32_bf16 v[248:251], a[100:103], a[60:63], v[248:251]
  ds_read_b64_tr_b16 a[94:95], v14 offset:15872
  v_mfma_f32_16x16x32_bf16 v[248:251], a[96:99], a[56:59], v[248:251]
  v_mfma_f32_16x16x32_bf16 v[252:255], a[104:107], a[56:59], v[252:255]
  ds_read_b64_tr_b16 a[96:97], v13 offset:2048
  v_mfma_f32_16x16x32_bf16 v[252:255], a[108:111], a[60:63], v[252:255]
  buffer_load_dwordx4 v16, s[4:7], s83 offen offset:2048  lds
  v_mfma_f32_16x16x32_bf16 v[228:231], a[108:111], a[52:55], v[228:231]
  ds_read_b64_tr_b16 a[98:99], v13 offset:2560
  s_add_u32 s4, s4, 128
  s_addc_u32 s5, s5, 0
  v_mfma_f32_16x16x32_bf16 v[228:231], a[104:107], a[48:51], v[228:231]
  v_mfma_f32_16x16x32_bf16 v[204:207], a[104:107], a[40:43], v[204:207]
  ds_read_b64_tr_b16 a[100:101], v13 offset:16384
  v_mfma_f32_16x16x32_bf16 v[204:207], a[108:111], a[44:47], v[204:207]
  v_mfma_f32_16x16x32_bf16 v[180:183], a[108:111], a[36:39], v[180:183]
  ds_read_b64_tr_b16 a[102:103], v13 offset:16896
  v_mfma_f32_16x16x32_bf16 v[180:183], a[104:107], a[32:35], v[180:183]
  v_mfma_f32_16x16x32_bf16 v[36:39], a[136:139], a[128:131], v[36:39]
  v_mfma_f32_16x16x32_bf16 v[36:39], a[136:139], a[132:135], v[36:39]
  s_waitcnt lgkmcnt(14)
  v_mfma_f32_16x16x32_bf16 v[64:67], a[64:67], a[0:3], v[64:67]
  ds_read_b64_tr_b16 a[104:105], v14 offset:2048
  s_add_u32 m0, s88, 28672
  v_mfma_f32_16x16x32_bf16 v[64:67], a[68:71], a[4:7], v[64:67]
  buffer_load_dwordx4 v18, s[8:11], s94 offen  lds
  v_mfma_f32_16x16x32_bf16 v[88:91], a[68:71], a[12:15], v[88:91]
  ds_read_b64_tr_b16 a[106:107], v14 offset:2560
  v_mfma_f32_16x16x32_bf16 v[88:91], a[64:67], a[8:11], v[88:91]
  v_mfma_f32_16x16x32_bf16 v[112:115], a[64:67], a[16:19], v[112:115]
  ds_read_b64_tr_b16 a[108:109], v14 offset:16384
  s_add_u32 m0, s89, 28672
  v_mfma_f32_16x16x32_bf16 v[112:115], a[68:71], a[20:23], v[112:115]
  buffer_load_dwordx4 v18, s[8:11], s95 offen  lds
  v_mfma_f32_16x16x32_bf16 v[136:139], a[68:71], a[28:31], v[136:139]
  ds_read_b64_tr_b16 a[110:111], v14 offset:16896
  v_mfma_f32_16x16x32_bf16 v[136:139], a[64:67], a[24:27], v[136:139]
  s_waitcnt lgkmcnt(14)
  v_mfma_f32_16x16x32_bf16 v[140:143], a[72:75], a[24:27], v[140:143]
  ds_read_b128 a[32:35], v8 offset:8192
  v_mfma_f32_16x16x32_bf16 v[140:143], a[76:79], a[28:31], v[140:143]
  v_mfma_f32_16x16x32_bf16 v[116:119], a[76:79], a[20:23], v[116:119]
  ds_read_b128 a[36:39], v9 offset:8192
  v_mfma_f32_16x16x32_bf16 v[116:119], a[72:75], a[16:19], v[116:119]
  v_mfma_f32_16x16x32_bf16 v[92:95], a[72:75], a[8:11], v[92:95]
  ds_read_b128 a[40:43], v8 offset:10240
  s_add_u32 m0, s90, 28672
  v_mfma_f32_16x16x32_bf16 v[92:95], a[76:79], a[12:15], v[92:95]
  buffer_load_dwordx4 v18, s[8:11], s96 offen  lds
  v_mfma_f32_16x16x32_bf16 v[68:71], a[76:79], a[4:7], v[68:71]
  ds_read_b128 a[44:47], v9 offset:10240
  v_mfma_f32_16x16x32_bf16 v[68:71], a[72:75], a[0:3], v[68:71]
  s_waitcnt lgkmcnt(14)
  v_mfma_f32_16x16x32_bf16 v[72:75], a[80:83], a[0:3], v[72:75]
  ds_read_b128 a[48:51], v8 offset:12288
  s_add_u32 m0, s91, 28672
  v_mfma_f32_16x16x32_bf16 v[72:75], a[84:87], a[4:7], v[72:75]
  buffer_load_dwordx4 v19, s[8:11], s94 offen  lds
  v_mfma_f32_16x16x32_bf16 v[96:99], a[84:87], a[12:15], v[96:99]
  ds_read_b128 a[52:55], v9 offset:12288
  v_mfma_f32_16x16x32_bf16 v[96:99], a[80:83], a[8:11], v[96:99]
  v_mfma_f32_16x16x32_bf16 v[120:123], a[80:83], a[16:19], v[120:123]
  ds_read_b128 a[56:59], v8 offset:14336
  v_mfma_f32_16x16x32_bf16 v[120:123], a[84:87], a[20:23], v[120:123]
  v_mfma_f32_16x16x32_bf16 v[144:147], a[84:87], a[28:31], v[144:147]
  ds_read_b128 a[60:63], v9 offset:14336
  v_mfma_f32_16x16x32_bf16 v[144:147], a[80:83], a[24:27], v[144:147]
  s_waitcnt lgkmcnt(14)
  v_mfma_f32_16x16x32_bf16 v[148:151], a[88:91], a[24:27], v[148:151]
  s_add_u32 m0, s92, 28672
  v_mfma_f32_16x16x32_bf16 v[148:151], a[92:95], a[28:31], v[148:151]
  buffer_load_dwordx4 v19, s[8:11], s95 offen  lds
  v_mfma_f32_16x16x32_bf16 v[124:127], a[92:95], a[20:23], v[124:127]
  v_mfma_f32_16x16x32_bf16 v[124:127], a[88:91], a[16:19], v[124:127]
  v_mfma_f32_16x16x32_bf16 v[100:103], a[88:91], a[8:11], v[100:103]
  s_add_u32 m0, s93, 28672
  v_mfma_f32_16x16x32_bf16 v[100:103], a[92:95], a[12:15], v[100:103]
  buffer_load_dwordx4 v19, s[8:11], s96 offen  lds
  v_mfma_f32_16x16x32_bf16 v[76:79], a[92:95], a[4:7], v[76:79]
  s_add_u32 s8, s8, 458752
  s_addc_u32 s9, s9, 0
  v_mfma_f32_16x16x32_bf16 v[76:79], a[88:91], a[0:3], v[76:79]
  s_waitcnt lgkmcnt(12)
  v_mfma_f32_16x16x32_bf16 v[80:83], a[96:99], a[0:3], v[80:83]
  v_mfma_f32_16x16x32_bf16 v[80:83], a[100:103], a[4:7], v[80:83]
  v_mfma_f32_16x16x32_bf16 v[104:107], a[100:103], a[12:15], v[104:107]
  v_mfma_f32_16x16x32_bf16 v[104:107], a[96:99], a[8:11], v[104:107]
  v_mfma_f32_16x16x32_bf16 v[128:131], a[96:99], a[16:19], v[128:131]
  s_bfe_u32 s29, s2, 0x10004
  s_lshl_b32 s39, s20, 1
  s_add_u32 s29, s29, s39
  s_cmp_eq_u32 s29, 1
  s_cbranch_scc0 Lg_na7
  s_lshr_b32 s29, s2, 0
  s_and_b32 s29, s29, 0
  s_lshl_b64 exec, 1, s29
  buffer_atomic_add v35, v34, s[48:51], 0 offen sc1
  s_mov_b64 exec, -1
Lg_na7:
  v_mfma_f32_16x16x32_bf16 v[128:131], a[100:103], a[20:23], v[128:131]
  v_mfma_f32_16x16x32_bf16 v[152:155], a[100:103], a[28:31], v[152:155]
  v_mfma_f32_16x16x32_bf16 v[152:155], a[96:99], a[24:27], v[152:155]
  s_waitcnt lgkmcnt(8)
  v_mfma_f32_16x16x32_bf16 v[156:159], a[104:107], a[24:27], v[156:159]
  v_mov_b32 v37, 1
  s_mov_b32 exec_lo, s38
  s_mov_b32 exec_hi, 0
  s_cbranch_execz Lg_ncs
  buffer_store_dwordx2 v[36:37], v31, s[16:19], 0 offen sc1
Lg_ncs:
  s_mov_b64 exec, -1
  v_mfma_f32_16x16x32_bf16 v[156:159], a[108:111], a[28:31], v[156:159]
  v_mfma_f32_16x16x32_bf16 v[132:135], a[108:111], a[20:23], v[132:135]
  v_mfma_f32_16x16x32_bf16 v[132:135], a[104:107], a[16:19], v[132:135]
  v_mfma_f32_16x16x32_bf16 v[108:111], a[104:107], a[8:11], v[108:111]
  v_mfma_f32_16x16x32_bf16 v[108:111], a[108:111], a[12:15], v[108:111]
  v_mfma_f32_16x16x32_bf16 v[84:87], a[108:111], a[4:7], v[84:87]
  v_mfma_f32_16x16x32_bf16 v[84:87], a[104:107], a[0:3], v[84:87]
  s_waitcnt vmcnt(6) lgkmcnt(0)
  s_barrier
  v_mfma_f32_16x16x32_bf16 v[160:163], a[64:67], a[32:35], v[160:163]
  ds_read_b128 a[0:3], v8 offset:34816
  s_add_u32 m0, s84, 0
  v_mfma_f32_16x16x32_bf16 v[160:163], a[68:71], a[36:39], v[160:163]
  buffer_load_dwordx4 v16, s[4:7], s80 offen offset:0  lds
  v_mfma_f32_16x16x32_bf16 v[184:187], a[68:71], a[44:47], v[184:187]
  ds_read_b128 a[4:7], v9 offset:34816
  v_mfma_f32_16x16x32_bf16 v[184:187], a[64:67], a[40:43], v[184:187]
  ds_read_b128 a[16:19], v8 offset:38912
  v_mfma_f32_16x16x32_bf16 v[208:211], a[64:67], a[48:51], v[208:211]
  ds_read_b128 a[8:11], v8 offset:36864
  v_mfma_f32_16x16x32_bf16 v[208:211], a[68:71], a[52:55], v[208:211]
  buffer_load_dwordx4 v16, s[4:7], s80 offen offset:2048  lds
  v_mfma_f32_16x16x32_bf16 v[232:235], a[68:71], a[60:63], v[232:235]
  ds_read_b128 a[12:15], v9 offset:36864
  v_mfma_f32_16x16x32_bf16 v[232:235], a[64:67], a[56:59], v[232:235]
  ds_read_b128 a[20:23], v9 offset:38912
  v_mfma_f32_16x16x32_bf16 v[236:239], a[72:75], a[56:59], v[236:239]
  ds_read_b64_tr_b16 a[64:65], v10 offset:0
  v_mfma_f32_16x16x32_bf16 v[236:239], a[76:79], a[60:63], v[236:239]
  v_mfma_f32_16x16x32_bf16 v[212:215], a[76:79], a[52:55], v[212:215]
  ds_read_b64_tr_b16 a[66:67], v10 offset:512
  v_mfma_f32_16x16x32_bf16 v[212:215], a[72:75], a[48:51], v[212:215]
  ds_read_b128 a[24:27], v8 offset:40960
  v_mfma_f32_16x16x32_bf16 v[188:191], a[72:75], a[40:43], v[188:191]
  ds_read_b64_tr_b16 a[68:69], v10 offset:14336
  s_add_u32 m0, s85, 0
  v_mfma_f32_16x16x32_bf16 v[188:191], a[76:79], a[44:47], v[188:191]
  buffer_load_dwordx4 v16, s[4:7], s81 offen offset:0  lds
  v_mfma_f32_16x16x32_bf16 v[164:167], a[76:79], a[36:39], v[164:167]
  ds_read_b64_tr_b16 a[70:71], v10 offset:14848
  v_mfma_f32_16x16x32_bf16 v[164:167], a[72:75], a[32:35], v[164:167]
  ds_read_b128 a[28:31], v9 offset:40960
  v_mfma_f32_16x16x32_bf16 v[168:171], a[80:83], a[32:35], v[168:171]
  ds_read_b64_tr_b16 a[72:73], v11 offset:0
  v_mfma_f32_16x16x32_bf16 v[168:171], a[84:87], a[36:39], v[168:171]
  buffer_load_dwordx4 v16, s[4:7], s81 offen offset:2048  lds
  v_mfma_f32_16x16x32_bf16 v[192:195], a[84:87], a[44:47], v[192:195]
  ds_read_b64_tr_b16 a[74:75], v11 offset:512
  v_mfma_f32_16x16x32_bf16 v[192:195], a[80:83], a[40:43], v[192:195]
  v_mfma_f32_16x16x32_bf16 v[216:219], a[80:83], a[48:51], v[216:219]
  ds_read_b64_tr_b16 a[76:77], v11 offset:14336
  v_mfma_f32_16x16x32_bf16 v[216:219], a[84:87], a[52:55], v[216:219]
  v_mfma_f32_16x16x32_bf16 v[240:243], a[84:87], a[60:63], v[240:243]
  ds_read_b64_tr_b16 a[78:79], v11 offset:14848
  v_mfma_f32_16x16x32_bf16 v[240:243], a[80:83], a[56:59], v[240:243]
  v_mfma_f32_16x16x32_bf16 v[244:247], a[88:91], a[56:59], v[244:247]
  ds_read_b64_tr_b16 a[80:81], v10 offset:1024
  s_add_u32 m0, s86, 0
  v_mfma_f32_16x16x32_bf16 v[244:247], a[92:95], a[60:63], v[244:247]
  buffer_load_dwordx4 v16, s[4:7], s82 offen offset:0  lds
  v_mfma_f32_16x16x32_bf16 v[220:223], a[92:95], a[52:55], v[220:223]
  ds_read_b64_tr_b16 a[82:83], v10 offset:1536
  v_mfma_f32_16x16x32_bf16 v[220:223], a[88:91], a[48:51], v[220:223]
  v_mfma_f32_16x16x32_bf16 v[196:199], a[88:91], a[40:43], v[196:199]
  ds_read_b64_tr_b16 a[84:85], v10 offset:15360
  v_mfma_f32_16x16x32_bf16 v[196:199], a[92:95], a[44:47], v[196:199]
  buffer_load_dwordx4 v16, s[4:7], s82 offen offset:2048  lds
  v_mfma_f32_16x16x32_bf16 v[172:175], a[92:95], a[36:39], v[172:175]
  ds_read_b64_tr_b16 a[86:87], v10 offset:15872
  v_mfma_f32_16x16x32_bf16 v[172:175], a[88:91], a[32:35], v[172:175]
  v_mfma_f32_16x16x32_bf16 v[176:179], a[96:99], a[32:35], v[176:179]
  ds_read_b64_tr_b16 a[88:89], v11 offset:1024
  v_mfma_f32_16x16x32_bf16 v[176:179], a[100:103], a[36:39], v[176:179]
  v_mfma_f32_16x16x32_bf16 v[200:203], a[100:103], a[44:47], v[200:203]
  ds_read_b64_tr_b16 a[90:91], v11 offset:1536
  v_mfma_f32_16x16x32_bf16 v[200:203], a[96:99], a[40:43], v[200:203]
  v_mfma_f32_16x16x32_bf16 v[224:227], a[96:99], a[48:51], v[224:227]
  ds_read_b64_tr_b16 a[92:93], v11 offset:15360
  s_add_u32 m0, s87, 0
  v_mfma_f32_16x16x32_bf16 v[224:227], a[100:103], a[52:55], v[224:227]
  buffer_load_dwordx4 v16, s[4:7], s83 offen offset:0  lds
  v_mfma_f32_16x16x32_bf16 v[248:251], a[100:103], a[60:63], v[248:251]
  ds_read_b64_tr_b16 a[94:95], v11 offset:15872
  v_mfma_f32_16x16x32_bf16 v[248:251], a[96:99], a[56:59], v[248:251]
  v_mfma_f32_16x16x32_bf16 v[252:255], a[104:107], a[56:59], v[252:255]
  ds_read_b64_tr_b16 a[96:97], v10 offset:2048
  v_mfma_f32_16x16x32_bf16 v[252:255], a[108:111], a[60:63], v[252:255]
  buffer_load_dwordx4 v16, s[4:7], s83 offen offset:2048  lds
  v_mfma_f32_16x16x32_bf16 v[228:231], a[108:111], a[52:55], v[228:231]
  ds_read_b64_tr_b16 a[98:99], v10 offset:2560
  s_add_u32 s4, s4, 128
  s_addc_u32 s5, s5, 0
  v_mfma_f32_16x16x32_bf16 v[228:231], a[104:107], a[48:51], v[228:231]
  v_mfma_f32_16x16x32_bf16 v[204:207], a[104:107], a[40:43], v[204:207]
  ds_read_b64_tr_b16 a[100:101], v10 offset:16384
  v_mfma_f32_16x16x32_bf16 v[204:207], a[108:111], a[44:47], v[204:207]
  v_mfma_f32_16x16x32_bf16 v[180:183], a[108:111], a[36:39], v[180:183]
  ds_read_b64_tr_b16 a[102:103], v10 offset:16896
  v_mfma_f32_16x16x32_bf16 v[180:183], a[104:107], a[32:35], v[180:183]
  s_waitcnt lgkmcnt(14)
  v_mfma_f32_16x16x32_bf16 v[64:67], a[64:67], a[0:3], v[64:67]
  ds_read_b64_tr_b16 a[104:105], v11 offset:2048
  s_add_u32 m0, s88, 57344
  v_mfma_f32_16x16x32_bf16 v[64:67], a[68:71], a[4:7], v[64:67]
  buffer_load_dwordx4 v18, s[8:11], s94 offen  lds
  v_mfma_f32_16x16x32_bf16 v[88:91], a[68:71], a[12:15], v[88:91]
  ds_read_b64_tr_b16 a[106:107], v11 offset:2560
  v_mfma_f32_16x16x32_bf16 v[88:91], a[64:67], a[8:11], v[88:91]
  v_mfma_f32_16x16x32_bf16 v[112:115], a[64:67], a[16:19], v[112:115]
  ds_read_b64_tr_b16 a[108:109], v11 offset:16384
  s_add_u32 m0, s89, 57344
  v_mfma_f32_16x16x32_bf16 v[112:115], a[68:71], a[20:23], v[112:115]
  buffer_load_dwordx4 v18, s[8:11], s95 offen  lds
  v_mfma_f32_16x16x32_bf16 v[136:139], a[68:71], a[28:31], v[136:139]
  ds_read_b64_tr_b16 a[110:111], v11 offset:16896
  v_mfma_f32_16x16x32_bf16 v[136:139], a[64:67], a[24:27], v[136:139]
  s_waitcnt lgkmcnt(14)
  v_mfma_f32_16x16x32_bf16 v[140:143], a[72:75], a[24:27], v[140:143]
  ds_read_b128 a[32:35], v8 offset:43008
  v_mfma_f32_16x16x32_bf16 v[140:143], a[76:79], a[28:31], v[140:143]
  v_mfma_f32_16x16x32_bf16 v[116:119], a[76:79], a[20:23], v[116:119]
  ds_read_b128 a[36:39], v9 offset:43008
  v_mfma_f32_16x16x32_bf16 v[116:119], a[72:75], a[16:19], v[116:119]
  v_mfma_f32_16x16x32_bf16 v[92:95], a[72:75], a[8:11], v[92:95]
  ds_read_b128 a[40:43], v8 offset:45056
  s_add_u32 m0, s90, 57344
  v_mfma_f32_16x16x32_bf16 v[92:95], a[76:79], a[12:15], v[92:95]
  buffer_load_dwordx4 v18, s[8:11], s96 offen  lds
  v_mfma_f32_16x16x32_bf16 v[68:71], a[76:79], a[4:7], v[68:71]
  ds_read_b128 a[44:47], v9 offset:45056
  v_mfma_f32_16x16x32_bf16 v[68:71], a[72:75], a[0:3], v[68:71]
  s_waitcnt lgkmcnt(14)
  v_mfma_f32_16x16x32_bf16 v[72:75], a[80:83], a[0:3], v[72:75]
  ds_read_b128 a[48:51], v8 offset:47104
  s_add_u32 m0, s91, 57344
  v_mfma_f32_16x16x32_bf16 v[72:75], a[84:87], a[4:7], v[72:75]
  buffer_load_dwordx4 v19, s[8:11], s94 offen  lds
  v_mfma_f32_16x16x32_bf16 v[96:99], a[84:87], a[12:15], v[96:99]
  ds_read_b128 a[52:55], v9 offset:47104
  v_mfma_f32_16x16x32_bf16 v[96:99], a[80:83], a[8:11], v[96:99]
  v_mfma_f32_16x16x32_bf16 v[120:123], a[80:83], a[16:19], v[120:123]
  ds_read_b128 a[56:59], v8 offset:49152
  v_mfma_f32_16x16x32_bf16 v[120:123], a[84:87], a[20:23], v[120:123]
  v_mfma_f32_16x16x32_bf16 v[144:147], a[84:87], a[28:31], v[144:147]
  ds_read_b128 a[60:63], v9 offset:49152
  v_mfma_f32_16x16x32_bf16 v[144:147], a[80:83], a[24:27], v[144:147]
  s_waitcnt lgkmcnt(14)
  v_mfma_f32_16x16x32_bf16 v[148:151], a[88:91], a[24:27], v[148:151]
  s_add_u32 m0, s92, 57344
  v_mfma_f32_16x16x32_bf16 v[148:151], a[92:95], a[28:31], v[148:151]
  buffer_load_dwordx4 v19, s[8:11], s95 offen  lds
  v_mfma_f32_16x16x32_bf16 v[124:127], a[92:95], a[20:23], v[124:127]
  v_mfma_f32_16x16x32_bf16 v[124:127], a[88:91], a[16:19], v[124:127]
  v_mfma_f32_16x16x32_bf16 v[100:103], a[88:91], a[8:11], v[100:103]
  s_add_u32 m0, s93, 57344
  v_mfma_f32_16x16x32_bf16 v[100:103], a[92:95], a[12:15], v[100:103]
  buffer_load_dwordx4 v19, s[8:11], s96 offen  lds
  v_mfma_f32_16x16x32_bf16 v[76:79], a[92:95], a[4:7], v[76:79]
  s_add_u32 s8, s8, 458752
  s_addc_u32 s9, s9, 0
  v_mfma_f32_16x16x32_bf16 v[76:79], a[88:91], a[0:3], v[76:79]
  s_waitcnt lgkmcnt(12)
  v_mfma_f32_16x16x32_bf16 v[80:83], a[96:99], a[0:3], v[80:83]
  v_mfma_f32_16x16x32_bf16 v[80:83], a[100:103], a[4:7], v[80:83]
  v_mfma_f32_16x16x32_bf16 v[104:107], a[100:103], a[12:15], v[104:107]
  v_mfma_f32_16x16x32_bf16 v[104:107], a[96:99], a[8:11], v[104:107]
  v_mfma_f32_16x16x32_bf16 v[128:131], a[96:99], a[16:19], v[128:131]
  v_mfma_f32_16x16x32_bf16 v[128:131], a[100:103], a[20:23], v[128:131]
  buffer_load_dwordx4 a[208:211], v21, s[60:63], 0 offen offset:0
  v_mfma_f32_16x16x32_bf16 v[152:155], a[100:103], a[28:31], v[152:155]
  v_mfma_f32_16x16x32_bf16 v[152:155], a[96:99], a[24:27], v[152:155]
  s_waitcnt lgkmcnt(8)
  v_mfma_f32_16x16x32_bf16 v[156:159], a[104:107], a[24:27], v[156:159]
  v_mfma_f32_16x16x32_bf16 v[156:159], a[108:111], a[28:31], v[156:159]
  buffer_load_dwordx4 a[212:215], v21, s[60:63], 0 offen offset:64
  v_mfma_f32_16x16x32_bf16 v[132:135], a[108:111], a[20:23], v[132:135]
  v_mfma_f32_16x16x32_bf16 v[132:135], a[104:107], a[16:19], v[132:135]
  v_mfma_f32_16x16x32_bf16 v[108:111], a[104:107], a[8:11], v[108:111]
  v_mfma_f32_16x16x32_bf16 v[108:111], a[108:111], a[12:15], v[108:111]
  v_mfma_f32_16x16x32_bf16 v[84:87], a[108:111], a[4:7], v[84:87]
  v_mfma_f32_16x16x32_bf16 v[84:87], a[104:107], a[0:3], v[84:87]
  s_waitcnt vmcnt(8) lgkmcnt(0)
  s_barrier
  v_mfma_f32_16x16x32_bf16 v[160:163], a[64:67], a[32:35], v[160:163]
  ds_read_b128 a[0:3], v8 offset:0
  s_add_u32 m0, s84, 34816
  v_mfma_f32_16x16x32_bf16 v[160:163], a[68:71], a[36:39], v[160:163]
  buffer_load_dwordx4 v16, s[4:7], s80 offen offset:0  lds
  v_mfma_f32_16x16x32_bf16 v[184:187], a[68:71], a[44:47], v[184:187]
  ds_read_b128 a[4:7], v9 offset:0
  v_mfma_f32_16x16x32_bf16 v[184:187], a[64:67], a[40:43], v[184:187]
  ds_read_b128 a[16:19], v8 offset:4096
  v_mfma_f32_16x16x32_bf16 v[208:211], a[64:67], a[48:51], v[208:211]
  ds_read_b128 a[8:11], v8 offset:2048
  v_mfma_f32_16x16x32_bf16 v[208:211], a[68:71], a[52:55], v[208:211]
  buffer_load_dwordx4 v16, s[4:7], s80 offen offset:2048  lds
  v_mfma_f32_16x16x32_bf16 v[232:235], a[68:71], a[60:63], v[232:235]
  ds_read_b128 a[12:15], v9 offset:2048
  v_mfma_f32_16x16x32_bf16 v[232:235], a[64:67], a[56:59], v[232:235]
  ds_read_b128 a[20:23], v9 offset:4096
  v_mfma_f32_16x16x32_bf16 v[236:239], a[72:75], a[56:59], v[236:239]
  ds_read_b64_tr_b16 a[64:65], v10 offset:28672
  v_mfma_f32_16x16x32_bf16 v[236:239], a[76:79], a[60:63], v[236:239]
  v_mfma_f32_16x16x32_bf16 v[212:215], a[76:79], a[52:55], v[212:215]
  ds_read_b64_tr_b16 a[66:67], v10 offset:29184
  v_mfma_f32_16x16x32_bf16 v[212:215], a[72:75], a[48:51], v[212:215]
  ds_read_b128 a[24:27], v8 offset:6144
  v_mfma_f32_16x16x32_bf16 v[188:191], a[72:75], a[40:43], v[188:191]
  ds_read_b64_tr_b16 a[68:69], v10 offset:43008
  s_add_u32 m0, s85, 34816
  v_mfma_f32_16x16x32_bf16 v[188:191], a[76:79], a[44:47], v[188:191]
  buffer_load_dwordx4 v16, s[4:7], s81 offen offset:0  lds
  v_mfma_f32_16x16x32_bf16 v[164:167], a[76:79], a[36:39], v[164:167]
  ds_read_b64_tr_b16 a[70:71], v10 offset:43520
  v_mfma_f32_16x16x32_bf16 v[164:167], a[72:75], a[32:35], v[164:167]
  ds_read_b128 a[28:31], v9 offset:6144
  v_mfma_f32_16x16x32_bf16 v[168:171], a[80:83], a[32:35], v[168:171]
  ds_read_b64_tr_b16 a[72:73], v11 offset:28672
  v_mfma_f32_16x16x32_bf16 v[168:171], a[84:87], a[36:39], v[168:171]
  buffer_load_dwordx4 v16, s[4:7], s81 offen offset:2048  lds
  v_mfma_f32_16x16x32_bf16 v[192:195], a[84:87], a[44:47], v[192:195]
  ds_read_b64_tr_b16 a[74:75], v11 offset:29184
  v_mfma_f32_16x16x32_bf16 v[192:195], a[80:83], a[40:43], v[192:195]
  v_mfma_f32_16x16x32_bf16 v[216:219], a[80:83], a[48:51], v[216:219]
  ds_read_b64_tr_b16 a[76:77], v11 offset:43008
  v_mfma_f32_16x16x32_bf16 v[216:219], a[84:87], a[52:55], v[216:219]
  v_mfma_f32_16x16x32_bf16 v[240:243], a[84:87], a[60:63], v[240:243]
  ds_read_b64_tr_b16 a[78:79], v11 offset:43520
  v_mfma_f32_16x16x32_bf16 v[240:243], a[80:83], a[56:59], v[240:243]
  v_mfma_f32_16x16x32_bf16 v[244:247], a[88:91], a[56:59], v[244:247]
  ds_read_b64_tr_b16 a[80:81], v10 offset:29696
  s_add_u32 m0, s86, 34816
  v_mfma_f32_16x16x32_bf16 v[244:247], a[92:95], a[60:63], v[244:247]
  buffer_load_dwordx4 v16, s[4:7], s82 offen offset:0  lds
  v_mfma_f32_16x16x32_bf16 v[220:223], a[92:95], a[52:55], v[220:223]
  ds_read_b64_tr_b16 a[82:83], v10 offset:30208
  v_mfma_f32_16x16x32_bf16 v[220:223], a[88:91], a[48:51], v[220:223]
  v_mfma_f32_16x16x32_bf16 v[196:199], a[88:91], a[40:43], v[196:199]
  ds_read_b64_tr_b16 a[84:85], v10 offset:44032
  v_mfma_f32_16x16x32_bf16 v[196:199], a[92:95], a[44:47], v[196:199]
  buffer_load_dwordx4 v16, s[4:7], s82 offen offset:2048  lds
  v_mfma_f32_16x16x32_bf16 v[172:175], a[92:95], a[36:39], v[172:175]
  ds_read_b64_tr_b16 a[86:87], v10 offset:44544
  v_mfma_f32_16x16x32_bf16 v[172:175], a[88:91], a[32:35], v[172:175]
  v_mfma_f32_16x16x32_bf16 v[176:179], a[96:99], a[32:35], v[176:179]
  ds_read_b64_tr_b16 a[88:89], v11 offset:29696
  v_mfma_f32_16x16x32_bf16 v[176:179], a[100:103], a[36:39], v[176:179]
  v_mfma_f32_16x16x32_bf16 v[200:203], a[100:103], a[44:47], v[200:203]
  ds_read_b64_tr_b16 a[90:91], v11 offset:30208
  v_mfma_f32_16x16x32_bf16 v[200:203], a[96:99], a[40:43], v[200:203]
  v_mfma_f32_16x16x32_bf16 v[224:227], a[96:99], a[48:51], v[224:227]
  ds_read_b64_tr_b16 a[92:93], v11 offset:44032
  s_add_u32 m0, s87, 34816
  v_mfma_f32_16x16x32_bf16 v[224:227], a[100:103], a[52:55], v[224:227]
  buffer_load_dwordx4 v16, s[4:7], s83 offen offset:0  lds
  v_mfma_f32_16x16x32_bf16 v[248:251], a[100:103], a[60:63], v[248:251]
  ds_read_b64_tr_b16 a[94:95], v11 offset:44544
  v_mfma_f32_16x16x32_bf16 v[248:251], a[96:99], a[56:59], v[248:251]
  v_mfma_f32_16x16x32_bf16 v[252:255], a[104:107], a[56:59], v[252:255]
  ds_read_b64_tr_b16 a[96:97], v10 offset:30720
  v_mfma_f32_16x16x32_bf16 v[252:255], a[108:111], a[60:63], v[252:255]
  buffer_load_dwordx4 v16, s[4:7], s83 offen offset:2048  lds
  v_mfma_f32_16x16x32_bf16 v[228:231], a[108:111], a[52:55], v[228:231]
  ds_read_b64_tr_b16 a[98:99], v10 offset:31232
  s_add_u32 s4, s4, 128
  s_addc_u32 s5, s5, 0
  v_mfma_f32_16x16x32_bf16 v[228:231], a[104:107], a[48:51], v[228:231]
  v_mfma_f32_16x16x32_bf16 v[204:207], a[104:107], a[40:43], v[204:207]
  ds_read_b64_tr_b16 a[100:101], v10 offset:45056
  v_mfma_f32_16x16x32_bf16 v[204:207], a[108:111], a[44:47], v[204:207]
  v_mfma_f32_16x16x32_bf16 v[180:183], a[108:111], a[36:39], v[180:183]
  ds_read_b64_tr_b16 a[102:103], v10 offset:45568
  v_mfma_f32_16x16x32_bf16 v[180:183], a[104:107], a[32:35], v[180:183]
  s_waitcnt lgkmcnt(14)
  v_mfma_f32_16x16x32_bf16 v[64:67], a[64:67], a[0:3], v[64:67]
  ds_read_b64_tr_b16 a[104:105], v11 offset:30720
  s_add_u32 m0, s88, 0
  v_mfma_f32_16x16x32_bf16 v[64:67], a[68:71], a[4:7], v[64:67]
  buffer_load_dwordx4 v18, s[8:11], s94 offen  lds
  v_mfma_f32_16x16x32_bf16 v[88:91], a[68:71], a[12:15], v[88:91]
  ds_read_b64_tr_b16 a[106:107], v11 offset:31232
  v_mfma_f32_16x16x32_bf16 v[88:91], a[64:67], a[8:11], v[88:91]
  v_mfma_f32_16x16x32_bf16 v[112:115], a[64:67], a[16:19], v[112:115]
  ds_read_b64_tr_b16 a[108:109], v11 offset:45056
  s_add_u32 m0, s89, 0
  v_mfma_f32_16x16x32_bf16 v[112:115], a[68:71], a[20:23], v[112:115]
  buffer_load_dwordx4 v18, s[8:11], s95 offen  lds
  v_mfma_f32_16x16x32_bf16 v[136:139], a[68:71], a[28:31], v[136:139]
  ds_read_b64_tr_b16 a[110:111], v11 offset:45568
  v_mfma_f32_16x16x32_bf16 v[136:139], a[64:67], a[24:27], v[136:139]
  s_waitcnt lgkmcnt(14)
  v_mfma_f32_16x16x32_bf16 v[140:143], a[72:75], a[24:27], v[140:143]
  ds_read_b128 a[32:35], v8 offset:8192
  v_mfma_f32_16x16x32_bf16 v[140:143], a[76:79], a[28:31], v[140:143]
  v_mfma_f32_16x16x32_bf16 v[116:119], a[76:79], a[20:23], v[116:119]
  ds_read_b128 a[36:39], v9 offset:8192
  v_mfma_f32_16x16x32_bf16 v[116:119], a[72:75], a[16:19], v[116:119]
  v_mfma_f32_16x16x32_bf16 v[92:95], a[72:75], a[8:11], v[92:95]
  ds_read_b128 a[40:43], v8 offset:10240
  s_add_u32 m0, s90, 0
  v_mfma_f32_16x16x32_bf16 v[92:95], a[76:79], a[12:15], v[92:95]
  buffer_load_dwordx4 v18, s[8:11], s96 offen  lds
  v_mfma_f32_16x16x32_bf16 v[68:71], a[76:79], a[4:7], v[68:71]
  ds_read_b128 a[44:47], v9 offset:10240
  v_mfma_f32_16x16x32_bf16 v[68:71], a[72:75], a[0:3], v[68:71]
  s_waitcnt lgkmcnt(14)
  v_mfma_f32_16x16x32_bf16 v[72:75], a[80:83], a[0:3], v[72:75]
  ds_read_b128 a[48:51], v8 offset:12288
  s_add_u32 m0, s91, 0
  v_mfma_f32_16x16x32_bf16 v[72:75], a[84:87], a[4:7], v[72:75]
  buffer_load_dwordx4 v19, s[8:11], s94 offen  lds
  v_mfma_f32_16x16x32_bf16 v[96:99], a[84:87], a[12:15], v[96:99]
  ds_read_b128 a[52:55], v9 offset:12288
  v_mfma_f32_16x16x32_bf16 v[96:99], a[80:83], a[8:11], v[96:99]
  v_mfma_f32_16x16x32_bf16 v[120:123], a[80:83], a[16:19], v[120:123]
  ds_read_b128 a[56:59], v8 offset:14336
  v_mfma_f32_16x16x32_bf16 v[120:123], a[84:87], a[20:23], v[120:123]
  v_mfma_f32_16x16x32_bf16 v[144:147], a[84:87], a[28:31], v[144:147]
  ds_read_b128 a[60:63], v9 offset:14336
  v_mfma_f32_16x16x32_bf16 v[144:147], a[80:83], a[24:27], v[144:147]
  s_waitcnt lgkmcnt(14)
  v_mfma_f32_16x16x32_bf16 v[148:151], a[88:91], a[24:27], v[148:151]
  s_add_u32 m0, s92, 0
  v_mfma_f32_16x16x32_bf16 v[148:151], a[92:95], a[28:31], v[148:151]
  buffer_load_dwordx4 v19, s[8:11], s95 offen  lds
  v_mfma_f32_16x16x32_bf16 v[124:127], a[92:95], a[20:23], v[124:127]
  v_mfma_f32_16x16x32_bf16 v[124:127], a[88:91], a[16:19], v[124:127]
  v_mfma_f32_16x16x32_bf16 v[100:103], a[88:91], a[8:11], v[100:103]
  s_add_u32 m0, s93, 0
  v_mfma_f32_16x16x32_bf16 v[100:103], a[92:95], a[12:15], v[100:103]
  buffer_load_dwordx4 v19, s[8:11], s96 offen  lds
  v_mfma_f32_16x16x32_bf16 v[76:79], a[92:95], a[4:7], v[76:79]
  s_add_u32 s8, s8, 458752
  s_addc_u32 s9, s9, 0
  v_mfma_f32_16x16x32_bf16 v[76:79], a[88:91], a[0:3], v[76:79]
  s_waitcnt lgkmcnt(12)
  v_mfma_f32_16x16x32_bf16 v[80:83], a[96:99], a[0:3], v[80:83]
  v_mfma_f32_16x16x32_bf16 v[80:83], a[100:103], a[4:7], v[80:83]
  v_mfma_f32_16x16x32_bf16 v[104:107], a[100:103], a[12:15], v[104:107]
  v_mfma_f32_16x16x32_bf16 v[104:107], a[96:99], a[8:11], v[104:107]
  v_mfma_f32_16x16x32_bf16 v[128:131], a[96:99], a[16:19], v[128:131]
  v_mfma_f32_16x16x32_bf16 v[128:131], a[100:103], a[20:23], v[128:131]
  buffer_load_dwordx4 a[216:219], v21, s[60:63], 0 offen offset:128
  v_mfma_f32_16x16x32_bf16 v[152:155], a[100:103], a[28:31], v[152:155]
  v_mfma_f32_16x16x32_bf16 v[152:155], a[96:99], a[24:27], v[152:155]
  s_waitcnt lgkmcnt(8)
  v_mfma_f32_16x16x32_bf16 v[156:159], a[104:107], a[24:27], v[156:159]
  v_mfma_f32_16x16x32_bf16 v[156:159], a[108:111], a[28:31], v[156:159]
  buffer_load_dwordx4 a[220:223], v21, s[60:63], 0 offen offset:192
  v_mfma_f32_16x16x32_bf16 v[132:135], a[108:111], a[20:23], v[132:135]
  v_mfma_f32_16x16x32_bf16 v[132:135], a[104:107], a[16:19], v[132:135]
  v_mfma_f32_16x16x32_bf16 v[108:111], a[104:107], a[8:11], v[108:111]
  v_mfma_f32_16x16x32_bf16 v[108:111], a[108:111], a[12:15], v[108:111]
  v_mfma_f32_16x16x32_bf16 v[84:87], a[108:111], a[4:7], v[84:87]
  v_mfma_f32_16x16x32_bf16 v[84:87], a[104:107], a[0:3], v[84:87]
  s_waitcnt vmcnt(8) lgkmcnt(0)
  s_barrier
  v_mfma_f32_16x16x32_bf16 v[160:163], a[64:67], a[32:35], v[160:163]
  ds_read_b128 a[0:3], v8 offset:34816
  s_add_u32 m0, s84, 0
  v_mfma_f32_16x16x32_bf16 v[160:163], a[68:71], a[36:39], v[160:163]
  buffer_load_dwordx4 v16, s[4:7], s80 offen offset:0  lds
  v_mfma_f32_16x16x32_bf16 v[184:187], a[68:71], a[44:47], v[184:187]
  ds_read_b128 a[4:7], v9 offset:34816
  v_mfma_f32_16x16x32_bf16 v[184:187], a[64:67], a[40:43], v[184:187]
  ds_read_b128 a[16:19], v8 offset:38912
Lg_pad4:
  s_cbranch_execz Lg_ret0
  s_nop 0
  v_mfma_f32_16x16x32_bf16 v[208:211], a[64:67], a[48:51], v[208:211]
  ds_read_b128 a[8:11], v8 offset:36864
  v_mfma_f32_16x16x32_bf16 v[208:211], a[68:71], a[52:55], v[208:211]
  buffer_load_dwordx4 v16, s[4:7], s80 offen offset:2048  lds
  v_mfma_f32_16x16x32_bf16 v[232:235], a[68:71], a[60:63], v[232:235]
  ds_read_b128 a[12:15], v9 offset:36864
  v_mfma_f32_16x16x32_bf16 v[232:235], a[64:67], a[56:59], v[232:235]
  ds_read_b128 a[20:23], v9 offset:38912
  v_mfma_f32_16x16x32_bf16 v[236:239], a[72:75], a[56:59], v[236:239]
  ds_read_b64_tr_b16 a[64:65], v13 offset:0
  v_mfma_f32_16x16x32_bf16 v[236:239], a[76:79], a[60:63], v[236:239]
  v_mfma_f32_16x16x32_bf16 v[212:215], a[76:79], a[52:55], v[212:215]
  ds_read_b64_tr_b16 a[66:67], v13 offset:512
  v_mfma_f32_16x16x32_bf16 v[212:215], a[72:75], a[48:51], v[212:215]
  ds_read_b128 a[24:27], v8 offset:40960
  v_mfma_f32_16x16x32_bf16 v[188:191], a[72:75], a[40:43], v[188:191]
  ds_read_b64_tr_b16 a[68:69], v13 offset:14336
  s_add_u32 m0, s85, 0
  v_mfma_f32_16x16x32_bf16 v[188:191], a[76:79], a[44:47], v[188:191]
  buffer_load_dwordx4 v16, s[4:7], s81 offen offset:0  lds
  v_mfma_f32_16x16x32_bf16 v[164:167], a[76:79], a[36:39], v[164:167]
  ds_read_b64_tr_b16 a[70:71], v13 offset:14848
  v_mfma_f32_16x16x32_bf16 v[164:167], a[72:75], a[32:35], v[164:167]
  ds_read_b128 a[28:31], v9 offset:40960
  v_mfma_f32_16x16x32_bf16 v[168:171], a[80:83], a[32:35], v[168:171]
  ds_read_b64_tr_b16 a[72:73], v14 offset:0
  v_mfma_f32_16x16x32_bf16 v[168:171], a[84:87], a[36:39], v[168:171]
  buffer_load_dwordx4 v16, s[4:7], s81 offen offset:2048  lds
  v_mfma_f32_16x16x32_bf16 v[192:195], a[84:87], a[44:47], v[192:195]
  ds_read_b64_tr_b16 a[74:75], v14 offset:512
  v_mfma_f32_16x16x32_bf16 v[192:195], a[80:83], a[40:43], v[192:195]
  v_mfma_f32_16x16x32_bf16 v[216:219], a[80:83], a[48:51], v[216:219]
  ds_read_b64_tr_b16 a[76:77], v14 offset:14336
  v_mfma_f32_16x16x32_bf16 v[216:219], a[84:87], a[52:55], v[216:219]
  v_mfma_f32_16x16x32_bf16 v[240:243], a[84:87], a[60:63], v[240:243]
  ds_read_b64_tr_b16 a[78:79], v14 offset:14848
  v_mfma_f32_16x16x32_bf16 v[240:243], a[80:83], a[56:59], v[240:243]
  v_mfma_f32_16x16x32_bf16 v[244:247], a[88:91], a[56:59], v[244:247]
  ds_read_b64_tr_b16 a[80:81], v13 offset:1024
  s_add_u32 m0, s86, 0
  v_mfma_f32_16x16x32_bf16 v[244:247], a[92:95], a[60:63], v[244:247]
  buffer_load_dwordx4 v16, s[4:7], s82 offen offset:0  lds
  v_mfma_f32_16x16x32_bf16 v[220:223], a[92:95], a[52:55], v[220:223]
  ds_read_b64_tr_b16 a[82:83], v13 offset:1536
  v_mfma_f32_16x16x32_bf16 v[220:223], a[88:91], a[48:51], v[220:223]
  v_mfma_f32_16x16x32_bf16 v[196:199], a[88:91], a[40:43], v[196:199]
  ds_read_b64_tr_b16 a[84:85], v13 offset:15360
  v_mfma_f32_16x16x32_bf16 v[196:199], a[92:95], a[44:47], v[196:199]
  buffer_load_dwordx4 v16, s[4:7], s82 offen offset:2048  lds
  v_mfma_f32_16x16x32_bf16 v[172:175], a[92:95], a[36:39], v[172:175]
  ds_read_b64_tr_b16 a[86:87], v13 offset:15872
  v_mfma_f32_16x16x32_bf16 v[172:175], a[88:91], a[32:35], v[172:175]
  v_mfma_f32_16x16x32_bf16 v[176:179], a[96:99], a[32:35], v[176:179]
  ds_read_b64_tr_b16 a[88:89], v14 offset:1024
  v_mfma_f32_16x16x32_bf16 v[176:179], a[100:103], a[36:39], v[176:179]
  v_mfma_f32_16x16x32_bf16 v[200:203], a[100:103], a[44:47], v[200:203]
  ds_read_b64_tr_b16 a[90:91], v14 offset:1536
  v_mfma_f32_16x16x32_bf16 v[200:203], a[96:99], a[40:43], v[200:203]
  v_mfma_f32_16x16x32_bf16 v[224:227], a[96:99], a[48:51], v[224:227]
  ds_read_b64_tr_b16 a[92:93], v14 offset:15360
  s_add_u32 m0, s87, 0
  v_mfma_f32_16x16x32_bf16 v[224:227], a[100:103], a[52:55], v[224:227]
  buffer_load_dwordx4 v16, s[4:7], s83 offen offset:0  lds
  v_mfma_f32_16x16x32_bf16 v[248:251], a[100:103], a[60:63], v[248:251]
  ds_read_b64_tr_b16 a[94:95], v14 offset:15872
  v_mfma_f32_16x16x32_bf16 v[248:251], a[96:99], a[56:59], v[248:251]
  v_mfma_f32_16x16x32_bf16 v[252:255], a[104:107], a[56:59], v[252:255]
  ds_read_b64_tr_b16 a[96:97], v13 offset:2048
  v_mfma_f32_16x16x32_bf16 v[252:255], a[108:111], a[60:63], v[252:255]
  buffer_load_dwordx4 v16, s[4:7], s83 offen offset:2048  lds
  v_mfma_f32_16x16x32_bf16 v[228:231], a[108:111], a[52:55], v[228:231]
  ds_read_b64_tr_b16 a[98:99], v13 offset:2560
  s_add_u32 s4, s4, 128
  s_addc_u32 s5, s5, 0
  v_mfma_f32_16x16x32_bf16 v[228:231], a[104:107], a[48:51], v[228:231]
  v_mfma_f32_16x16x32_bf16 v[204:207], a[104:107], a[40:43], v[204:207]
  ds_read_b64_tr_b16 a[100:101], v13 offset:16384
  v_mfma_f32_16x16x32_bf16 v[204:207], a[108:111], a[44:47], v[204:207]
  v_mfma_f32_16x16x32_bf16 v[180:183], a[108:111], a[36:39], v[180:183]
  ds_read_b64_tr_b16 a[102:103], v13 offset:16896
  v_mfma_f32_16x16x32_bf16 v[180:183], a[104:107], a[32:35], v[180:183]
  s_waitcnt lgkmcnt(14)
  v_mfma_f32_16x16x32_bf16 v[64:67], a[64:67], a[0:3], v[64:67]
  ds_read_b64_tr_b16 a[104:105], v14 offset:2048
  s_add_u32 m0, s88, 28672
  v_mfma_f32_16x16x32_bf16 v[64:67], a[68:71], a[4:7], v[64:67]
  buffer_load_dwordx4 v18, s[8:11], s94 offen  lds
  v_mfma_f32_16x16x32_bf16 v[88:91], a[68:71], a[12:15], v[88:91]
  ds_read_b64_tr_b16 a[106:107], v14 offset:2560
  v_mfma_f32_16x16x32_bf16 v[88:91], a[64:67], a[8:11], v[88:91]
  v_mfma_f32_16x16x32_bf16 v[112:115], a[64:67], a[16:19], v[112:115]
  ds_read_b64_tr_b16 a[108:109], v14 offset:16384
  s_add_u32 m0, s89, 28672
  v_mfma_f32_16x16x32_bf16 v[112:115], a[68:71], a[20:23], v[112:115]
  buffer_load_dwordx4 v18, s[8:11], s95 offen  lds
  v_mfma_f32_16x16x32_bf16 v[136:139], a[68:71], a[28:31], v[136:139]
  ds_read_b64_tr_b16 a[110:111], v14 offset:16896
  v_mfma_f32_16x16x32_bf16 v[136:139], a[64:67], a[24:27], v[136:139]
  s_waitcnt lgkmcnt(14)
  v_mfma_f32_16x16x32_bf16 v[140:143], a[72:75], a[24:27], v[140:143]
  ds_read_b128 a[32:35], v8 offset:43008
  v_mfma_f32_16x16x32_bf16 v[140:143], a[76:79], a[28:31], v[140:143]
  v_mfma_f32_16x16x32_bf16 v[116:119], a[76:79], a[20:23], v[116:119]
  ds_read_b128 a[36:39], v9 offset:43008
  v_mfma_f32_16x16x32_bf16 v[116:119], a[72:75], a[16:19], v[116:119]
  v_mfma_f32_16x16x32_bf16 v[92:95], a[72:75], a[8:11], v[92:95]
  ds_read_b128 a[40:43], v8 offset:45056
  s_add_u32 m0, s90, 28672
  v_mfma_f32_16x16x32_bf16 v[92:95], a[76:79], a[12:15], v[92:95]
  buffer_load_dwordx4 v18, s[8:11], s96 offen  lds
  v_mfma_f32_16x16x32_bf16 v[68:71], a[76:79], a[4:7], v[68:71]
  ds_read_b128 a[44:47], v9 offset:45056
  v_mfma_f32_16x16x32_bf16 v[68:71], a[72:75], a[0:3], v[68:71]
  s_waitcnt lgkmcnt(14)
  v_mfma_f32_16x16x32_bf16 v[72:75], a[80:83], a[0:3], v[72:75]
  ds_read_b128 a[48:51], v8 offset:47104
  s_add_u32 m0, s91, 28672
  v_mfma_f32_16x16x32_bf16 v[72:75], a[84:87], a[4:7], v[72:75]
  buffer_load_dwordx4 v19, s[8:11], s94 offen  lds
  v_mfma_f32_16x16x32_bf16 v[96:99], a[84:87], a[12:15], v[96:99]
  ds_read_b128 a[52:55], v9 offset:47104
  v_mfma_f32_16x16x32_bf16 v[96:99], a[80:83], a[8:11], v[96:99]
  v_mfma_f32_16x16x32_bf16 v[120:123], a[80:83], a[16:19], v[120:123]
  ds_read_b128 a[56:59], v8 offset:49152
  v_mfma_f32_16x16x32_bf16 v[120:123], a[84:87], a[20:23], v[120:123]
  v_mfma_f32_16x16x32_bf16 v[144:147], a[84:87], a[28:31], v[144:147]
  ds_read_b128 a[60:63], v9 offset:49152
  v_mfma_f32_16x16x32_bf16 v[144:147], a[80:83], a[24:27], v[144:147]
  s_waitcnt lgkmcnt(14)
  v_mfma_f32_16x16x32_bf16 v[148:151], a[88:91], a[24:27], v[148:151]
  s_add_u32 m0, s92, 28672
  v_mfma_f32_16x16x32_bf16 v[148:151], a[92:95], a[28:31], v[148:151]
  buffer_load_dwordx4 v19, s[8:11], s95 offen  lds
  v_mfma_f32_16x16x32_bf16 v[124:127], a[92:95], a[20:23], v[124:127]
  v_mfma_f32_16x16x32_bf16 v[124:127], a[88:91], a[16:19], v[124:127]
  v_mfma_f32_16x16x32_bf16 v[100:103], a[88:91], a[8:11], v[100:103]
  s_add_u32 m0, s93, 28672
  v_mfma_f32_16x16x32_bf16 v[100:103], a[92:95], a[12:15], v[100:103]
  buffer_load_dwordx4 v19, s[8:11], s96 offen  lds
  v_mfma_f32_16x16x32_bf16 v[76:79], a[92:95], a[4:7], v[76:79]
  s_add_u32 s8, s8, 458752
  s_addc_u32 s9, s9, 0
  v_mfma_f32_16x16x32_bf16 v[76:79], a[88:91], a[0:3], v[76:79]
  s_waitcnt lgkmcnt(12)
  v_mfma_f32_16x16x32_bf16 v[80:83], a[96:99], a[0:3], v[80:83]
  v_mfma_f32_16x16x32_bf16 v[80:83], a[100:103], a[4:7], v[80:83]
  v_mfma_f32_16x16x32_bf16 v[104:107], a[100:103], a[12:15], v[104:107]
  v_mfma_f32_16x16x32_bf16 v[104:107], a[96:99], a[8:11], v[104:107]
  v_mfma_f32_16x16x32_bf16 v[128:131], a[96:99], a[16:19], v[128:131]
  v_mfma_f32_16x16x32_bf16 v[128:131], a[100:103], a[20:23], v[128:131]
  buffer_load_dwordx4 a[224:227], v21, s[60:63], 0 offen offset:2048
  v_mfma_f32_16x16x32_bf16 v[152:155], a[100:103], a[28:31], v[152:155]
  v_mfma_f32_16x16x32_bf16 v[152:155], a[96:99], a[24:27], v[152:155]
  s_waitcnt lgkmcnt(8)
  v_mfma_f32_16x16x32_bf16 v[156:159], a[104:107], a[24:27], v[156:159]
  v_mfma_f32_16x16x32_bf16 v[156:159], a[108:111], a[28:31], v[156:159]
  buffer_load_dwordx4 a[228:231], v21, s[60:63], 0 offen offset:2112
  v_mfma_f32_16x16x32_bf16 v[132:135], a[108:111], a[20:23], v[132:135]
  v_mfma_f32_16x16x32_bf16 v[132:135], a[104:107], a[16:19], v[132:135]
  v_mfma_f32_16x16x32_bf16 v[108:111], a[104:107], a[8:11], v[108:111]
  v_mfma_f32_16x16x32_bf16 v[108:111], a[108:111], a[12:15], v[108:111]
  v_mfma_f32_16x16x32_bf16 v[84:87], a[108:111], a[4:7], v[84:87]
  v_mfma_f32_16x16x32_bf16 v[84:87], a[104:107], a[0:3], v[84:87]
  s_waitcnt vmcnt(8) lgkmcnt(0)
  s_barrier
  v_mfma_f32_16x16x32_bf16 v[160:163], a[64:67], a[32:35], v[160:163]
  ds_read_b128 a[0:3], v8 offset:0
  v_mfma_f32_16x16x32_bf16 v[160:163], a[68:71], a[36:39], v[160:163]
  buffer_load_dword v33, v34, s[48:51], 0 offen sc1
  v_mfma_f32_16x16x32_bf16 v[184:187], a[68:71], a[44:47], v[184:187]
  ds_read_b128 a[4:7], v9 offset:0
  v_mfma_f32_16x16x32_bf16 v[184:187], a[64:67], a[40:43], v[184:187]
  ds_read_b128 a[16:19], v8 offset:4096
  v_mfma_f32_16x16x32_bf16 v[208:211], a[64:67], a[48:51], v[208:211]
  ds_read_b128 a[8:11], v8 offset:2048
  v_min_u32 v30, 191, v0
  s_add_u32 m0, s84, 34816
  v_mfma_f32_16x16x32_bf16 v[208:211], a[68:71], a[52:55], v[208:211]
  buffer_load_dwordx4 v16, s[4:7], s80 offen offset:0  lds
  v_mfma_f32_16x16x32_bf16 v[232:235], a[68:71], a[60:63], v[232:235]
  ds_read_b128 a[12:15], v9 offset:2048
  v_mfma_f32_16x16x32_bf16 v[232:235], a[64:67], a[56:59], v[232:235]
  ds_read_b128 a[20:23], v9 offset:4096
  v_and_b32 v27, 0xe0, v0
  v_mfma_f32_16x16x32_bf16 v[236:239], a[72:75], a[56:59], v[236:239]
  ds_read_b64_tr_b16 a[64:65], v10 offset:0
  v_mfma_f32_16x16x32_bf16 v[236:239], a[76:79], a[60:63], v[236:239]
  buffer_load_dwordx4 v16, s[4:7], s80 offen offset:2048  lds
  v_mfma_f32_16x16x32_bf16 v[212:215], a[76:79], a[52:55], v[212:215]
  ds_read_b64_tr_b16 a[66:67], v10 offset:512
  v_lshl_add_u32 v27, v4, 1, v27
  v_mfma_f32_16x16x32_bf16 v[212:215], a[72:75], a[48:51], v[212:215]
  ds_read_b128 a[24:27], v8 offset:6144
  v_mfma_f32_16x16x32_bf16 v[188:191], a[72:75], a[40:43], v[188:191]
  ds_read_b64_tr_b16 a[68:69], v10 offset:14336
  v_mfma_f32_16x16x32_bf16 v[188:191], a[76:79], a[44:47], v[188:191]
  v_and_b32_e64 v28, 1, v3
  v_mfma_f32_16x16x32_bf16 v[164:167], a[76:79], a[36:39], v[164:167]
  ds_read_b64_tr_b16 a[70:71], v10 offset:14848
  v_mfma_f32_16x16x32_bf16 v[164:167], a[72:75], a[32:35], v[164:167]
  ds_read_b128 a[28:31], v9 offset:6144
  v_mfma_f32_16x16x32_bf16 v[168:171], a[80:83], a[32:35], v[168:171]
  ds_read_b64_tr_b16 a[72:73], v11 offset:0
  s_add_u32 m0, s85, 34816
  v_mfma_f32_16x16x32_bf16 v[168:171], a[84:87], a[36:39], v[168:171]
  v_add_u32_e64 v27, v27, v28
  buffer_load_dwordx4 v16, s[4:7], s81 offen offset:0  lds
  v_mfma_f32_16x16x32_bf16 v[192:195], a[84:87], a[44:47], v[192:195]
  ds_read_b64_tr_b16 a[74:75], v11 offset:512
  v_mfma_f32_16x16x32_bf16 v[192:195], a[80:83], a[40:43], v[192:195]
  v_mfma_f32_16x16x32_bf16 v[216:219], a[80:83], a[48:51], v[216:219]
  ds_read_b64_tr_b16 a[76:77], v11 offset:14336
  s_lshl_b32 s29, s23, 8
  v_add_lshl_u32 v27, v27, s29, 3
  v_mfma_f32_16x16x32_bf16 v[216:219], a[84:87], a[52:55], v[216:219]
  buffer_load_dwordx4 v16, s[4:7], s81 offen offset:2048  lds
  v_mfma_f32_16x16x32_bf16 v[240:243], a[84:87], a[60:63], v[240:243]
  ds_read_b64_tr_b16 a[78:79], v11 offset:14848
  v_mfma_f32_16x16x32_bf16 v[240:243], a[80:83], a[56:59], v[240:243]
  s_mul_i32 s29, s24, 192
  v_add_lshl_u32 v31, v30, s29, 1
  v_mfma_f32_16x16x32_bf16 v[244:247], a[88:91], a[56:59], v[244:247]
  ds_read_b64_tr_b16 a[80:81], v10 offset:1024
  s_add_u32 m0, s86, 34816
  v_mfma_f32_16x16x32_bf16 v[244:247], a[92:95], a[60:63], v[244:247]
  buffer_load_dwordx4 v16, s[4:7], s82 offen offset:0  lds
  v_mfma_f32_16x16x32_bf16 v[220:223], a[92:95], a[52:55], v[220:223]
  ds_read_b64_tr_b16 a[82:83], v10 offset:1536
  v_and_b32 v28, 127, v0
  v_mfma_f32_16x16x32_bf16 v[220:223], a[88:91], a[48:51], v[220:223]
  v_mfma_f32_16x16x32_bf16 v[196:199], a[88:91], a[40:43], v[196:199]
  ds_read_b64_tr_b16 a[84:85], v10 offset:15360
  v_mfma_f32_16x16x32_bf16 v[196:199], a[92:95], a[44:47], v[196:199]
  v_mfma_f32_16x16x32_bf16 v[172:175], a[92:95], a[36:39], v[172:175]
  ds_read_b64_tr_b16 a[86:87], v10 offset:15872
  s_lshl_b32 s29, s26, 7
  v_add_lshl_u32 v28, v28, s29, 1
  v_mfma_f32_16x16x32_bf16 v[172:175], a[88:91], a[32:35], v[172:175]
  v_mfma_f32_16x16x32_bf16 v[176:179], a[96:99], a[32:35], v[176:179]
  ds_read_b64_tr_b16 a[88:89], v11 offset:1024
  v_mfma_f32_16x16x32_bf16 v[176:179], a[100:103], a[36:39], v[176:179]
  v_lshlrev_b32_e64 v30, 3, v30
  buffer_load_dwordx4 v16, s[4:7], s82 offen offset:2048  lds
  v_mfma_f32_16x16x32_bf16 v[200:203], a[100:103], a[44:47], v[200:203]
  ds_read_b64_tr_b16 a[90:91], v11 offset:1536
  v_mfma_f32_16x16x32_bf16 v[200:203], a[96:99], a[40:43], v[200:203]
  v_mfma_f32_16x16x32_bf16 v[224:227], a[96:99], a[48:51], v[224:227]
  ds_read_b64_tr_b16 a[92:93], v11 offset:15360
  v_lshlrev_b32_e64 v32, 2, v0
  s_add_u32 m0, s87, 34816
  v_mfma_f32_16x16x32_bf16 v[224:227], a[100:103], a[52:55], v[224:227]
  buffer_load_dwordx4 v16, s[4:7], s83 offen offset:0  lds
  v_mfma_f32_16x16x32_bf16 v[248:251], a[100:103], a[60:63], v[248:251]
  ds_read_b64_tr_b16 a[94:95], v11 offset:15872
  v_mfma_f32_16x16x32_bf16 v[248:251], a[96:99], a[56:59], v[248:251]
  v_mfma_f32_16x16x32_bf16 v[252:255], a[104:107], a[56:59], v[252:255]
  ds_read_b64_tr_b16 a[96:97], v10 offset:2048
  v_mfma_f32_16x16x32_bf16 v[252:255], a[108:111], a[60:63], v[252:255]
  buffer_load_dwordx4 v16, s[4:7], s83 offen offset:2048  lds
  v_mfma_f32_16x16x32_bf16 v[228:231], a[108:111], a[52:55], v[228:231]
  ds_read_b64_tr_b16 a[98:99], v10 offset:2560
  s_add_u32 s4, s4, 128
  s_addc_u32 s5, s5, 0
  v_mfma_f32_16x16x32_bf16 v[228:231], a[104:107], a[48:51], v[228:231]
  v_mfma_f32_16x16x32_bf16 v[204:207], a[104:107], a[40:43], v[204:207]
  ds_read_b64_tr_b16 a[100:101], v10 offset:16384
  v_mfma_f32_16x16x32_bf16 v[204:207], a[108:111], a[44:47], v[204:207]
  v_mfma_f32_16x16x32_bf16 v[180:183], a[108:111], a[36:39], v[180:183]
  ds_read_b64_tr_b16 a[102:103], v10 offset:16896
  v_mfma_f32_16x16x32_bf16 v[180:183], a[104:107], a[32:35], v[180:183]
  s_waitcnt lgkmcnt(14)
  v_mfma_f32_16x16x32_bf16 v[64:67], a[64:67], a[0:3], v[64:67]
  ds_read_b64_tr_b16 a[104:105], v11 offset:2048
  s_add_u32 m0, s88, 57344
  v_mfma_f32_16x16x32_bf16 v[64:67], a[68:71], a[4:7], v[64:67]
  buffer_load_dwordx4 v18, s[8:11], s94 offen  lds
  v_mfma_f32_16x16x32_bf16 v[88:91], a[68:71], a[12:15], v[88:91]
  ds_read_b64_tr_b16 a[106:107], v11 offset:2560
  v_mfma_f32_16x16x32_bf16 v[88:91], a[64:67], a[8:11], v[88:91]
  v_mfma_f32_16x16x32_bf16 v[112:115], a[64:67], a[16:19], v[112:115]
  ds_read_b64_tr_b16 a[108:109], v11 offset:16384
  s_add_u32 m0, s89, 57344
  v_mfma_f32_16x16x32_bf16 v[112:115], a[68:71], a[20:23], v[112:115]
  buffer_load_dwordx4 v18, s[8:11], s95 offen  lds
  v_mfma_f32_16x16x32_bf16 v[136:139], a[68:71], a[28:31], v[136:139]
  ds_read_b64_tr_b16 a[110:111], v11 offset:16896
  v_mfma_f32_16x16x32_bf16 v[136:139], a[64:67], a[24:27], v[136:139]
  s_waitcnt lgkmcnt(14)
  v_mfma_f32_16x16x32_bf16 v[140:143], a[72:75], a[24:27], v[140:143]
  ds_read_b128 a[32:35], v8 offset:8192
  v_mfma_f32_16x16x32_bf16 v[140:143], a[76:79], a[28:31], v[140:143]
  v_mfma_f32_16x16x32_bf16 v[116:119], a[76:79], a[20:23], v[116:119]
  ds_read_b128 a[36:39], v9 offset:8192
  v_mfma_f32_16x16x32_bf16 v[116:119], a[72:75], a[16:19], v[116:119]
  v_mfma_f32_16x16x32_bf16 v[92:95], a[72:75], a[8:11], v[92:95]
  ds_read_b128 a[40:43], v8 offset:10240
  s_add_u32 m0, s90, 57344
  v_mfma_f32_16x16x32_bf16 v[92:95], a[76:79], a[12:15], v[92:95]
  buffer_load_dwordx4 v18, s[8:11], s96 offen  lds
  v_mfma_f32_16x16x32_bf16 v[68:71], a[76:79], a[4:7], v[68:71]
  ds_read_b128 a[44:47], v9 offset:10240
  v_mfma_f32_16x16x32_bf16 v[68:71], a[72:75], a[0:3], v[68:71]
  s_waitcnt lgkmcnt(14)
  v_mfma_f32_16x16x32_bf16 v[72:75], a[80:83], a[0:3], v[72:75]
  ds_read_b128 a[48:51], v8 offset:12288
  s_add_u32 m0, s91, 57344
  v_mfma_f32_16x16x32_bf16 v[72:75], a[84:87], a[4:7], v[72:75]
  buffer_load_dwordx4 v19, s[8:11], s94 offen  lds
  v_mfma_f32_16x16x32_bf16 v[96:99], a[84:87], a[12:15], v[96:99]
  ds_read_b128 a[52:55], v9 offset:12288
  v_mfma_f32_16x16x32_bf16 v[96:99], a[80:83], a[8:11], v[96:99]
  v_mfma_f32_16x16x32_bf16 v[120:123], a[80:83], a[16:19], v[120:123]
  ds_read_b128 a[56:59], v8 offset:14336
  v_mfma_f32_16x16x32_bf16 v[120:123], a[84:87], a[20:23], v[120:123]
  v_mfma_f32_16x16x32_bf16 v[144:147], a[84:87], a[28:31], v[144:147]
  ds_read_b128 a[60:63], v9 offset:14336
  v_mfma_f32_16x16x32_bf16 v[144:147], a[80:83], a[24:27], v[144:147]
  s_waitcnt lgkmcnt(14)
  v_mfma_f32_16x16x32_bf16 v[148:151], a[88:91], a[24:27], v[148:151]
  s_add_u32 m0, s92, 57344
  v_mfma_f32_16x16x32_bf16 v[148:151], a[92:95], a[28:31], v[148:151]
  buffer_load_dwordx4 v19, s[8:11], s95 offen  lds
  v_mfma_f32_16x16x32_bf16 v[124:127], a[92:95], a[20:23], v[124:127]
  v_mfma_f32_16x16x32_bf16 v[124:127], a[88:91], a[16:19], v[124:127]
  v_mfma_f32_16x16x32_bf16 v[100:103], a[88:91], a[8:11], v[100:103]
  s_add_u32 m0, s93, 57344
  v_mfma_f32_16x16x32_bf16 v[100:103], a[92:95], a[12:15], v[100:103]
  buffer_load_dwordx4 v19, s[8:11], s96 offen  lds
  v_mfma_f32_16x16x32_bf16 v[76:79], a[92:95], a[4:7], v[76:79]
  s_add_u32 s8, s8, 458752
  s_addc_u32 s9, s9, 0
  v_mfma_f32_16x16x32_bf16 v[76:79], a[88:91], a[0:3], v[76:79]
  s_waitcnt lgkmcnt(12)
  v_mfma_f32_16x16x32_bf16 v[80:83], a[96:99], a[0:3], v[80:83]
  v_mfma_f32_16x16x32_bf16 v[80:83], a[100:103], a[4:7], v[80:83]
  v_mfma_f32_16x16x32_bf16 v[104:107], a[100:103], a[12:15], v[104:107]
  v_mfma_f32_16x16x32_bf16 v[104:107], a[96:99], a[8:11], v[104:107]
  v_mfma_f32_16x16x32_bf16 v[128:131], a[96:99], a[16:19], v[128:131]
  v_mfma_f32_16x16x32_bf16 v[128:131], a[100:103], a[20:23], v[128:131]
  buffer_load_dwordx4 a[232:235], v21, s[60:63], 0 offen offset:2176
  v_mfma_f32_16x16x32_bf16 v[152:155], a[100:103], a[28:31], v[152:155]
  v_mfma_f32_16x16x32_bf16 v[152:155], a[96:99], a[24:27], v[152:155]
  s_waitcnt lgkmcnt(8)
  v_mfma_f32_16x16x32_bf16 v[156:159], a[104:107], a[24:27], v[156:159]
  v_mfma_f32_16x16x32_bf16 v[156:159], a[108:111], a[28:31], v[156:159]
  buffer_load_dwordx4 a[236:239], v21, s[60:63], 0 offen offset:2240
  v_mfma_f32_16x16x32_bf16 v[132:135], a[108:111], a[20:23], v[132:135]
  v_mfma_f32_16x16x32_bf16 v[132:135], a[104:107], a[16:19], v[132:135]
  v_mfma_f32_16x16x32_bf16 v[108:111], a[104:107], a[8:11], v[108:111]
  v_mfma_f32_16x16x32_bf16 v[108:111], a[108:111], a[12:15], v[108:111]
  v_mfma_f32_16x16x32_bf16 v[84:87], a[108:111], a[4:7], v[84:87]
  v_mfma_f32_16x16x32_bf16 v[84:87], a[104:107], a[0:3], v[84:87]
  s_waitcnt vmcnt(8) lgkmcnt(0)
  s_barrier
  v_mfma_f32_16x16x32_bf16 v[160:163], a[64:67], a[32:35], v[160:163]
  ds_read_b128 a[0:3], v8 offset:34816
  v_cmp_gt_u32 vcc, 256, v33
  s_cbranch_vccnz Lg_c0_slow
Lg_c0_back:
  v_mfma_f32_16x16x32_bf16 v[160:163], a[68:71], a[36:39], v[160:163]
  v_mfma_f32_16x16x32_bf16 v[184:187], a[68:71], a[44:47], v[184:187]
  ds_read_b128 a[4:7], v9 offset:34816
  buffer_load_dwordx2 v[40:41], v30, s[16:19], s66 offen sc1
  v_mfma_f32_16x16x32_bf16 v[184:187], a[64:67], a[40:43], v[184:187]
  ds_read_b128 a[16:19], v8 offset:38912
  v_mfma_f32_16x16x32_bf16 v[208:211], a[64:67], a[48:51], v[208:211]
  ds_read_b128 a[8:11], v8 offset:36864
  v_mfma_f32_16x16x32_bf16 v[208:211], a[68:71], a[52:55], v[208:211]
  buffer_load_dwordx2 v[42:43], v30, s[16:19], s66 offen offset:2048 sc1
  v_mfma_f32_16x16x32_bf16 v[232:235], a[68:71], a[60:63], v[232:235]
  ds_read_b128 a[12:15], v9 offset:36864
  v_mfma_f32_16x16x32_bf16 v[232:235], a[64:67], a[56:59], v[232:235]
  ds_read_b128 a[20:23], v9 offset:38912
  v_mfma_f32_16x16x32_bf16 v[236:239], a[72:75], a[56:59], v[236:239]
  ds_read_b64_tr_b16 a[64:65], v10 offset:28672
  buffer_load_dwordx2 v[44:45], v27, s[16:19], 0 offen sc1
  v_mfma_f32_16x16x32_bf16 v[236:239], a[76:79], a[60:63], v[236:239]
  v_mfma_f32_16x16x32_bf16 v[212:215], a[76:79], a[52:55], v[212:215]
  ds_read_b64_tr_b16 a[66:67], v10 offset:29184
  v_mfma_f32_16x16x32_bf16 v[212:215], a[72:75], a[48:51], v[212:215]
  ds_read_b128 a[24:27], v8 offset:40960
  buffer_load_ushort v46, v28, s[52:55], 0 offen
  v_mfma_f32_16x16x32_bf16 v[188:191], a[72:75], a[40:43], v[188:191]
  ds_read_b64_tr_b16 a[68:69], v10 offset:43008
  v_mfma_f32_16x16x32_bf16 v[188:191], a[76:79], a[44:47], v[188:191]
  v_mfma_f32_16x16x32_bf16 v[164:167], a[76:79], a[36:39], v[164:167]
  ds_read_b64_tr_b16 a[70:71], v10 offset:43520
  buffer_load_ushort v36, v31, s[72:75], 0 offen
  v_mfma_f32_16x16x32_bf16 v[164:167], a[72:75], a[32:35], v[164:167]
  ds_read_b128 a[28:31], v9 offset:40960
  v_mfma_f32_16x16x32_bf16 v[168:171], a[80:83], a[32:35], v[168:171]
  ds_read_b64_tr_b16 a[72:73], v11 offset:28672
  s_add_u32 m0, s84, 0
  v_mfma_f32_16x16x32_bf16 v[168:171], a[84:87], a[36:39], v[168:171]
  buffer_load_dwordx4 v16, s[4:7], s80 offen offset:0  lds
  v_mfma_f32_16x16x32_bf16 v[192:195], a[84:87], a[44:47], v[192:195]
  ds_read_b64_tr_b16 a[74:75], v11 offset:29184
  v_mfma_f32_16x16x32_bf16 v[192:195], a[80:83], a[40:43], v[192:195]
  v_mfma_f32_16x16x32_bf16 v[216:219], a[80:83], a[48:51], v[216:219]
  ds_read_b64_tr_b16 a[76:77], v11 offset:43008
  buffer_load_dwordx4 v16, s[4:7], s80 offen offset:2048  lds
  v_mfma_f32_16x16x32_bf16 v[216:219], a[84:87], a[52:55], v[216:219]
  v_mfma_f32_16x16x32_bf16 v[240:243], a[84:87], a[60:63], v[240:243]
  ds_read_b64_tr_b16 a[78:79], v11 offset:43520
  v_mfma_f32_16x16x32_bf16 v[240:243], a[80:83], a[56:59], v[240:243]
  s_add_u32 m0, s85, 0
  v_mfma_f32_16x16x32_bf16 v[244:247], a[88:91], a[56:59], v[244:247]
  ds_read_b64_tr_b16 a[80:81], v10 offset:29696
  buffer_load_dwordx4 v16, s[4:7], s81 offen offset:0  lds
  v_mfma_f32_16x16x32_bf16 v[244:247], a[92:95], a[60:63], v[244:247]
  v_mfma_f32_16x16x32_bf16 v[220:223], a[92:95], a[52:55], v[220:223]
  ds_read_b64_tr_b16 a[82:83], v10 offset:30208
  v_mfma_f32_16x16x32_bf16 v[220:223], a[88:91], a[48:51], v[220:223]
  buffer_load_dwordx4 v16, s[4:7], s81 offen offset:2048  lds
  v_mfma_f32_16x16x32_bf16 v[196:199], a[88:91], a[40:43], v[196:199]
  ds_read_b64_tr_b16 a[84:85], v10 offset:44032
  v_mfma_f32_16x16x32_bf16 v[196:199], a[92:95], a[44:47], v[196:199]
  s_add_u32 m0, s86, 0
  v_mfma_f32_16x16x32_bf16 v[172:175], a[92:95], a[36:39], v[172:175]
  ds_read_b64_tr_b16 a[86:87], v10 offset:44544
  buffer_load_dwordx4 v16, s[4:7], s82 offen offset:0  lds
  v_mfma_f32_16x16x32_bf16 v[172:175], a[88:91], a[32:35], v[172:175]
  v_mfma_f32_16x16x32_bf16 v[176:179], a[96:99], a[32:35], v[176:179]
  ds_read_b64_tr_b16 a[88:89], v11 offset:29696
  v_mfma_f32_16x16x32_bf16 v[176:179], a[100:103], a[36:39], v[176:179]
  buffer_load_dwordx4 v16, s[4:7], s82 offen offset:2048  lds
  v_mfma_f32_16x16x32_bf16 v[200:203], a[100:103], a[44:47], v[200:203]
  ds_read_b64_tr_b16 a[90:91], v11 offset:30208
  v_mfma_f32_16x16x32_bf16 v[200:203], a[96:99], a[40:43], v[200:203]
  s_add_u32 m0, s87, 0
  v_mfma_f32_16x16x32_bf16 v[224:227], a[96:99], a[48:51], v[224:227]
  ds_read_b64_tr_b16 a[92:93], v11 offset:44032
  buffer_load_dwordx4 v16, s[4:7], s83 offen offset:0  lds
  v_mfma_f32_16x16x32_bf16 v[224:227], a[100:103], a[52:55], v[224:227]
  v_mfma_f32_16x16x32_bf16 v[248:251], a[100:103], a[60:63], v[248:251]
  ds_read_b64_tr_b16 a[94:95], v11 offset:44544
  v_mfma_f32_16x16x32_bf16 v[248:251], a[96:99], a[56:59], v[248:251]
  buffer_load_dwordx4 v16, s[4:7], s83 offen offset:2048  lds
  v_mfma_f32_16x16x32_bf16 v[252:255], a[104:107], a[56:59], v[252:255]
  ds_read_b64_tr_b16 a[96:97], v10 offset:30720
  s_add_u32 s4, s4, 128
  s_addc_u32 s5, s5, 0
  v_mfma_f32_16x16x32_bf16 v[252:255], a[108:111], a[60:63], v[252:255]
  v_mfma_f32_16x16x32_bf16 v[228:231], a[108:111], a[52:55], v[228:231]
  ds_read_b64_tr_b16 a[98:99], v10 offset:31232
  v_mfma_f32_16x16x32_bf16 v[228:231], a[104:107], a[48:51], v[228:231]
  v_mfma_f32_16x16x32_bf16 v[204:207], a[104:107], a[40:43], v[204:207]
  ds_read_b64_tr_b16 a[100:101], v10 offset:45056
  v_mfma_f32_16x16x32_bf16 v[204:207], a[108:111], a[44:47], v[204:207]
  v_mfma_f32_16x16x32_bf16 v[180:183], a[108:111], a[36:39], v[180:183]
  ds_read_b64_tr_b16 a[102:103], v10 offset:45568
  v_mfma_f32_16x16x32_bf16 v[180:183], a[104:107], a[32:35], v[180:183]
  s_waitcnt lgkmcnt(14)
  v_mfma_f32_16x16x32_bf16 v[64:67], a[64:67], a[0:3], v[64:67]
  ds_read_b64_tr_b16 a[104:105], v11 offset:30720
  s_add_u32 m0, s88, 0
  v_mfma_f32_16x16x32_bf16 v[64:67], a[68:71], a[4:7], v[64:67]
  buffer_load_dwordx4 v18, s[8:11], s94 offen  lds
  v_mfma_f32_16x16x32_bf16 v[88:91], a[68:71], a[12:15], v[88:91]
  ds_read_b64_tr_b16 a[106:107], v11 offset:31232
  v_mfma_f32_16x16x32_bf16 v[88:91], a[64:67], a[8:11], v[88:91]
  v_mfma_f32_16x16x32_bf16 v[112:115], a[64:67], a[16:19], v[112:115]
  ds_read_b64_tr_b16 a[108:109], v11 offset:45056
  s_add_u32 m0, s89, 0
  v_mfma_f32_16x16x32_bf16 v[112:115], a[68:71], a[20:23], v[112:115]
  buffer_load_dwordx4 v18, s[8:11], s95 offen  lds
  v_mfma_f32_16x16x32_bf16 v[136:139], a[68:71], a[28:31], v[136:139]
  ds_read_b64_tr_b16 a[110:111], v11 offset:45568
  v_mfma_f32_16x16x32_bf16 v[136:139], a[64:67], a[24:27], v[136:139]
  s_waitcnt lgkmcnt(14)
  v_mfma_f32_16x16x32_bf16 v[140:143], a[72:75], a[24:27], v[140:143]
  ds_read_b128 a[32:35], v8 offset:43008
  v_mfma_f32_16x16x32_bf16 v[140:143], a[76:79], a[28:31], v[140:143]
  v_mfma_f32_16x16x32_bf16 v[116:119], a[76:79], a[20:23], v[116:119]
  ds_read_b128 a[36:39], v9 offset:43008
  v_mfma_f32_16x16x32_bf16 v[116:119], a[72:75], a[16:19], v[116:119]
  v_mfma_f32_16x16x32_bf16 v[92:95], a[72:75], a[8:11], v[92:95]
  ds_read_b128 a[40:43], v8 offset:45056
  s_add_u32 m0, s90, 0
  v_mfma_f32_16x16x32_bf16 v[92:95], a[76:79], a[12:15], v[92:95]
  buffer_load_dwordx4 v18, s[8:11], s96 offen  lds
  v_mfma_f32_16x16x32_bf16 v[68:71], a[76:79], a[4:7], v[68:71]
  ds_read_b128 a[44:47], v9 offset:45056
  v_mfma_f32_16x16x32_bf16 v[68:71], a[72:75], a[0:3], v[68:71]
  s_waitcnt lgkmcnt(14)
  v_mfma_f32_16x16x32_bf16 v[72:75], a[80:83], a[0:3], v[72:75]
  ds_read_b128 a[48:51], v8 offset:47104
  s_add_u32 m0, s91, 0
  v_mfma_f32_16x16x32_bf16 v[72:75], a[84:87], a[4:7], v[72:75]
  buffer_load_dwordx4 v19, s[8:11], s94 offen  lds
  v_mfma_f32_16x16x32_bf16 v[96:99], a[84:87], a[12:15], v[96:99]
  ds_read_b128 a[52:55], v9 offset:47104
  v_mfma_f32_16x16x32_bf16 v[96:99], a[80:83], a[8:11], v[96:99]
  v_mfma_f32_16x16x32_bf16 v[120:123], a[80:83], a[16:19], v[120:123]
  ds_read_b128 a[56:59], v8 offset:49152
  v_mfma_f32_16x16x32_bf16 v[120:123], a[84:87], a[20:23], v[120:123]
  v_mfma_f32_16x16x32_bf16 v[144:147], a[84:87], a[28:31], v[144:147]
  ds_read_b128 a[60:63], v9 offset:49152
  v_mfma_f32_16x16x32_bf16 v[144:147], a[80:83], a[24:27], v[144:147]
  s_waitcnt lgkmcnt(14)
  v_mfma_f32_16x16x32_bf16 v[148:151], a[88:91], a[24:27], v[148:151]
  s_add_u32 m0, s92, 0
  v_mfma_f32_16x16x32_bf16 v[148:151], a[92:95], a[28:31], v[148:151]
  buffer_load_dwordx4 v19, s[8:11], s95 offen  lds
  v_mfma_f32_16x16x32_bf16 v[124:127], a[92:95], a[20:23], v[124:127]
  v_mfma_f32_16x16x32_bf16 v[124:127], a[88:91], a[16:19], v[124:127]
  v_mfma_f32_16x16x32_bf16 v[100:103], a[88:91], a[8:11], v[100:103]
  s_add_u32 m0, s93, 0
  v_mfma_f32_16x16x32_bf16 v[100:103], a[92:95], a[12:15], v[100:103]
  buffer_load_dwordx4 v19, s[8:11], s96 offen  lds
  v_mfma_f32_16x16x32_bf16 v[76:79], a[92:95], a[4:7], v[76:79]
  s_add_u32 s8, s8, 458752
  s_addc_u32 s9, s9, 0
  v_mfma_f32_16x16x32_bf16 v[76:79], a[88:91], a[0:3], v[76:79]
  s_waitcnt lgkmcnt(12)
  v_mfma_f32_16x16x32_bf16 v[80:83], a[96:99], a[0:3], v[80:83]
  v_mfma_f32_16x16x32_bf16 v[80:83], a[100:103], a[4:7], v[80:83]
  v_mfma_f32_16x16x32_bf16 v[104:107], a[100:103], a[12:15], v[104:107]
  v_mfma_f32_16x16x32_bf16 v[104:107], a[96:99], a[8:11], v[104:107]
  v_mfma_f32_16x16x32_bf16 v[128:131], a[96:99], a[16:19], v[128:131]
  s_mov_b32 s29, Lg_epi-Lg_base+0
  v_mfma_f32_16x16x32_bf16 v[128:131], a[100:103], a[20:23], v[128:131]
  buffer_load_dword a141, v6, s[76:79], s29 offen
  v_mfma_f32_16x16x32_bf16 v[152:155], a[100:103], a[28:31], v[152:155]
  v_mfma_f32_16x16x32_bf16 v[152:155], a[96:99], a[24:27], v[152:155]
  s_waitcnt lgkmcnt(8)
  v_mfma_f32_16x16x32_bf16 v[156:159], a[104:107], a[24:27], v[156:159]
  s_mov_b32 s29, Lg_epi-Lg_base+8192
  v_mfma_f32_16x16x32_bf16 v[156:159], a[108:111], a[28:31], v[156:159]
  buffer_load_dword a141, v6, s[76:79], s29 offen
  v_mfma_f32_16x16x32_bf16 v[132:135], a[108:111], a[20:23], v[132:135]
  v_mfma_f32_16x16x32_bf16 v[132:135], a[104:107], a[16:19], v[132:135]
  v_mfma_f32_16x16x32_bf16 v[108:111], a[104:107], a[8:11], v[108:111]
  v_mfma_f32_16x16x32_bf16 v[108:111], a[108:111], a[12:15], v[108:111]
Lg_pad5:
  s_cbranch_execz Lg_pad9
  s_nop 0
  v_mfma_f32_16x16x32_bf16 v[84:87], a[108:111], a[4:7], v[84:87]
  v_mfma_f32_16x16x32_bf16 v[84:87], a[104:107], a[0:3], v[84:87]
  s_waitcnt vmcnt(8) lgkmcnt(0)
  s_barrier
  v_mfma_f32_16x16x32_bf16 v[160:163], a[64:67], a[32:35], v[160:163]
  ds_read_b128 a[0:3], v8 offset:0
  s_add_u32 m0, s84, 34816
  v_mfma_f32_16x16x32_bf16 v[160:163], a[68:71], a[36:39], v[160:163]
  v_and_b32 v33, v41, v43
  v_cmp_ne_u32 vcc, 1, v33
  s_cbranch_vccnz Lg_cs_slow
Lg_cs_back:
  buffer_load_dwordx4 v16, s[4:7], s80 offen offset:0  lds
  v_mfma_f32_16x16x32_bf16 v[184:187], a[68:71], a[44:47], v[184:187]
  ds_read_b128 a[4:7], v9 offset:0
  v_mfma_f32_16x16x32_bf16 v[184:187], a[64:67], a[40:43], v[184:187]
  ds_read_b128 a[16:19], v8 offset:4096
  v_add_f32_e64 v40, v40, v42
  v_mfma_f32_16x16x32_bf16 v[208:211], a[64:67], a[48:51], v[208:211]
  ds_read_b128 a[8:11], v8 offset:2048
  v_mfma_f32_16x16x32_bf16 v[208:211], a[68:71], a[52:55], v[208:211]
  v_add_u32 v32, 155648, v32
  buffer_load_dwordx4 v16, s[4:7], s80 offen offset:2048  lds
  v_mfma_f32_16x16x32_bf16 v[232:235], a[68:71], a[60:63], v[232:235]
  ds_read_b128 a[12:15], v9 offset:2048
  v_mfma_f32_16x16x32_bf16 v[232:235], a[64:67], a[56:59], v[232:235]
  ds_read_b128 a[20:23], v9 offset:4096
  v_mul_f32 v42, 0x3eeff558, v44
  v_mfma_f32_16x16x32_bf16 v[236:239], a[72:75], a[56:59], v[236:239]
  ds_read_b64_tr_b16 a[64:65], v13 offset:0
  v_mfma_f32_16x16x32_bf16 v[236:239], a[76:79], a[60:63], v[236:239]
  v_mul_f32 v43, 0x3eeff558, v45
  v_mfma_f32_16x16x32_bf16 v[212:215], a[76:79], a[52:55], v[212:215]
  ds_read_b64_tr_b16 a[66:67], v13 offset:512
  v_mfma_f32_16x16x32_bf16 v[212:215], a[72:75], a[48:51], v[212:215]
  ds_read_b128 a[24:27], v8 offset:6144
  ds_write2st64_b32 v32, v42, v43 offset0:0 offset1:5
  v_mfma_f32_16x16x32_bf16 v[188:191], a[72:75], a[40:43], v[188:191]
  ds_read_b64_tr_b16 a[68:69], v13 offset:14336
  s_add_u32 m0, s85, 34816
  v_mfma_f32_16x16x32_bf16 v[188:191], a[76:79], a[44:47], v[188:191]
  v_lshlrev_b32_e64 v36, 16, v36
  buffer_load_dwordx4 v16, s[4:7], s81 offen offset:0  lds
  v_mfma_f32_16x16x32_bf16 v[164:167], a[76:79], a[36:39], v[164:167]
  ds_read_b64_tr_b16 a[70:71], v13 offset:14848
  v_mfma_f32_16x16x32_bf16 v[164:167], a[72:75], a[32:35], v[164:167]
  ds_read_b128 a[28:31], v9 offset:6144
  v_mul_f32 v36, 0x3eeff558, v36
  v_mfma_f32_16x16x32_bf16 v[168:171], a[80:83], a[32:35], v[168:171]
  ds_read_b64_tr_b16 a[72:73], v14 offset:0
  v_mfma_f32_16x16x32_bf16 v[168:171], a[84:87], a[36:39], v[168:171]
  ds_write2st64_b32 v32, v40, v36 offset0:10 offset1:14
  buffer_load_dwordx4 v16, s[4:7], s81 offen offset:2048  lds
  v_mfma_f32_16x16x32_bf16 v[192:195], a[84:87], a[44:47], v[192:195]
  ds_read_b64_tr_b16 a[74:75], v14 offset:512
  v_mfma_f32_16x16x32_bf16 v[192:195], a[80:83], a[40:43], v[192:195]
  v_lshlrev_b32_e64 v46, 16, v46
  v_mfma_f32_16x16x32_bf16 v[216:219], a[80:83], a[48:51], v[216:219]
  ds_read_b64_tr_b16 a[76:77], v14 offset:14336
  v_mfma_f32_16x16x32_bf16 v[216:219], a[84:87], a[52:55], v[216:219]
  ds_write_b32 v32, v46 offset:4608
  v_mfma_f32_16x16x32_bf16 v[240:243], a[84:87], a[60:63], v[240:243]
  ds_read_b64_tr_b16 a[78:79], v14 offset:14848
  v_mfma_f32_16x16x32_bf16 v[240:243], a[80:83], a[56:59], v[240:243]
  s_lshl_b32 s98, s20, 12
  v_mfma_f32_16x16x32_bf16 v[244:247], a[88:91], a[56:59], v[244:247]
  ds_read_b64_tr_b16 a[80:81], v13 offset:1024
  s_add_u32 m0, s86, 34816
  v_mfma_f32_16x16x32_bf16 v[244:247], a[92:95], a[60:63], v[244:247]
  v_lshrrev_b32 v18, 3, v2
  buffer_load_dwordx4 v16, s[4:7], s82 offen offset:0  lds
  v_mfma_f32_16x16x32_bf16 v[220:223], a[92:95], a[52:55], v[220:223]
  ds_read_b64_tr_b16 a[82:83], v13 offset:1536
  v_mfma_f32_16x16x32_bf16 v[220:223], a[88:91], a[48:51], v[220:223]
  v_and_b32_e64 v19, 7, v2
  v_mfma_f32_16x16x32_bf16 v[196:199], a[88:91], a[40:43], v[196:199]
  ds_read_b64_tr_b16 a[84:85], v13 offset:15360
  v_mfma_f32_16x16x32_bf16 v[196:199], a[92:95], a[44:47], v[196:199]
  v_and_b32_e64 v20, 6, v18
  buffer_load_dwordx4 v16, s[4:7], s82 offen offset:2048  lds
  v_mfma_f32_16x16x32_bf16 v[172:175], a[92:95], a[36:39], v[172:175]
  ds_read_b64_tr_b16 a[86:87], v13 offset:15872
  v_mfma_f32_16x16x32_bf16 v[172:175], a[88:91], a[32:35], v[172:175]
  v_xor_b32_e64 v19, v19, v20
  v_mfma_f32_16x16x32_bf16 v[176:179], a[96:99], a[32:35], v[176:179]
  ds_read_b64_tr_b16 a[88:89], v14 offset:1024
  v_mfma_f32_16x16x32_bf16 v[176:179], a[100:103], a[36:39], v[176:179]
  s_lshl_b32 s29, s20, 4
  v_add_u32 v18, s29, v18
  v_mfma_f32_16x16x32_bf16 v[200:203], a[100:103], a[44:47], v[200:203]
  ds_read_b64_tr_b16 a[90:91], v14 offset:1536
  v_mfma_f32_16x16x32_bf16 v[200:203], a[96:99], a[40:43], v[200:203]
  s_lshl_b32 s29, s26, 8
  v_lshl_add_u32 v18, v18, 11, s29
  v_mfma_f32_16x16x32_bf16 v[224:227], a[96:99], a[48:51], v[224:227]
  ds_read_b64_tr_b16 a[92:93], v14 offset:15360
  s_add_u32 m0, s87, 34816
  v_mfma_f32_16x16x32_bf16 v[224:227], a[100:103], a[52:55], v[224:227]
  v_lshl_add_u32 v19, v19, 4, v18
  buffer_load_dwordx4 v16, s[4:7], s83 offen offset:0  lds
  v_mfma_f32_16x16x32_bf16 v[248:251], a[100:103], a[60:63], v[248:251]
  ds_read_b64_tr_b16 a[94:95], v14 offset:15872
  v_mfma_f32_16x16x32_bf16 v[248:251], a[96:99], a[56:59], v[248:251]
  s_and_b32 s29, s25, 14
  s_lshl_b32 s29, s29, 9
  s_add_u32 s29, s29, 262144
  v_mfma_f32_16x16x32_bf16 v[252:255], a[104:107], a[56:59], v[252:255]
  ds_read_b64_tr_b16 a[96:97], v13 offset:2048
  v_mfma_f32_16x16x32_bf16 v[252:255], a[108:111], a[60:63], v[252:255]
  v_lshl_add_u32 v20, v4, 4, s29
  buffer_load_dwordx4 v16, s[4:7], s83 offen offset:2048  lds
  v_mfma_f32_16x16x32_bf16 v[228:231], a[108:111], a[52:55], v[228:231]
  ds_read_b64_tr_b16 a[98:99], v13 offset:2560
  s_add_u32 s4, s4, 128
  s_addc_u32 s5, s5, 0
  v_mfma_f32_16x16x32_bf16 v[228:231], a[104:107], a[48:51], v[228:231]
  s_and_b32 s29, s2, 3
  s_lshl_b32 s29, s29, 8
  v_add_u32_e64 v20, s29, v20
  v_mfma_f32_16x16x32_bf16 v[204:207], a[104:107], a[40:43], v[204:207]
  ds_read_b64_tr_b16 a[100:101], v13 offset:16384
  v_mfma_f32_16x16x32_bf16 v[204:207], a[108:111], a[44:47], v[204:207]
  v_mfma_f32_16x16x32_bf16 v[180:183], a[108:111], a[36:39], v[180:183]
  ds_read_b64_tr_b16 a[102:103], v13 offset:16896
  v_mfma_f32_16x16x32_bf16 v[180:183], a[104:107], a[32:35], v[180:183]
  s_waitcnt lgkmcnt(14)
  v_mfma_f32_16x16x32_bf16 v[64:67], a[64:67], a[0:3], v[64:67]
  ds_read_b64_tr_b16 a[104:105], v14 offset:2048
  s_and_b32 s92, s2, 1
  s_bfe_u32 s29, s2, 0x10004
  s_xor_b32 s29, s29, s26
  v_mfma_f32_16x16x32_bf16 v[64:67], a[68:71], a[4:7], v[64:67]
  s_and_b32 s88, s29, 1
  s_sub_u32 s89, 0, s88
  s_and_b32 s93, s2, 3
  v_mfma_f32_16x16x32_bf16 v[88:91], a[68:71], a[12:15], v[88:91]
  ds_read_b64_tr_b16 a[106:107], v14 offset:2560
  v_mfma_f32_16x16x32_bf16 v[88:91], a[64:67], a[8:11], v[88:91]
  v_mfma_f32_16x16x32_bf16 v[112:115], a[64:67], a[16:19], v[112:115]
  ds_read_b64_tr_b16 a[108:109], v14 offset:16384
  v_mfma_f32_16x16x32_bf16 v[112:115], a[68:71], a[20:23], v[112:115]
  v_mfma_f32_16x16x32_bf16 v[136:139], a[68:71], a[28:31], v[136:139]
  ds_read_b64_tr_b16 a[110:111], v14 offset:16896
  v_mfma_f32_16x16x32_bf16 v[136:139], a[64:67], a[24:27], v[136:139]
  s_waitcnt lgkmcnt(14)
  v_mfma_f32_16x16x32_bf16 v[140:143], a[72:75], a[24:27], v[140:143]
  ds_read_b128 a[32:35], v8 offset:8192
  s_add_u32 m0, s98, 98304
  s_mul_i32 s68, s88, 393216
  s_mul_i32 s31, s93, 1572864
  s_add_u32 s68, s68, s31
  s_add_u32 s31, s68, 0
  v_mfma_f32_16x16x32_bf16 v[140:143], a[76:79], a[28:31], v[140:143]
  buffer_load_dwordx4 v19, s[44:47], s31 offen offset:0 lds
  v_mfma_f32_16x16x32_bf16 v[116:119], a[76:79], a[20:23], v[116:119]
  ds_read_b128 a[36:39], v9 offset:8192
  v_mfma_f32_16x16x32_bf16 v[116:119], a[72:75], a[16:19], v[116:119]
  v_mfma_f32_16x16x32_bf16 v[92:95], a[72:75], a[8:11], v[92:95]
  ds_read_b128 a[40:43], v8 offset:10240
  v_mfma_f32_16x16x32_bf16 v[92:95], a[76:79], a[12:15], v[92:95]
  v_mfma_f32_16x16x32_bf16 v[68:71], a[76:79], a[4:7], v[68:71]
  ds_read_b128 a[44:47], v9 offset:10240
  v_mfma_f32_16x16x32_bf16 v[68:71], a[72:75], a[0:3], v[68:71]
  s_waitcnt lgkmcnt(14)
  v_mfma_f32_16x16x32_bf16 v[72:75], a[80:83], a[0:3], v[72:75]
  ds_read_b128 a[48:51], v8 offset:12288
  s_add_u32 m0, s98, 99200
  v_mfma_f32_16x16x32_bf16 v[72:75], a[84:87], a[4:7], v[72:75]
  buffer_load_dwordx4 v19, s[44:47], s31 offen offset:128 lds
  v_mfma_f32_16x16x32_bf16 v[96:99], a[84:87], a[12:15], v[96:99]
  ds_read_b128 a[52:55], v9 offset:12288
  v_mfma_f32_16x16x32_bf16 v[96:99], a[80:83], a[8:11], v[96:99]
  v_mfma_f32_16x16x32_bf16 v[120:123], a[80:83], a[16:19], v[120:123]
  ds_read_b128 a[56:59], v8 offset:14336
  v_mfma_f32_16x16x32_bf16 v[120:123], a[84:87], a[20:23], v[120:123]
  v_mfma_f32_16x16x32_bf16 v[144:147], a[84:87], a[28:31], v[144:147]
  ds_read_b128 a[60:63], v9 offset:14336
  v_mfma_f32_16x16x32_bf16 v[144:147], a[80:83], a[24:27], v[144:147]
  s_waitcnt lgkmcnt(14)
  v_mfma_f32_16x16x32_bf16 v[148:151], a[88:91], a[24:27], v[148:151]
  s_add_u32 m0, s98, 100352
  s_add_u32 s31, s68, 16384
  v_mfma_f32_16x16x32_bf16 v[148:151], a[92:95], a[28:31], v[148:151]
  buffer_load_dwordx4 v19, s[44:47], s31 offen offset:0 lds
  v_mfma_f32_16x16x32_bf16 v[124:127], a[92:95], a[20:23], v[124:127]
  v_mfma_f32_16x16x32_bf16 v[124:127], a[88:91], a[16:19], v[124:127]
  v_mfma_f32_16x16x32_bf16 v[100:103], a[88:91], a[8:11], v[100:103]
  v_mfma_f32_16x16x32_bf16 v[100:103], a[92:95], a[12:15], v[100:103]
  v_mfma_f32_16x16x32_bf16 v[76:79], a[92:95], a[4:7], v[76:79]
  v_mfma_f32_16x16x32_bf16 v[76:79], a[88:91], a[0:3], v[76:79]
  s_waitcnt lgkmcnt(12)
  v_mfma_f32_16x16x32_bf16 v[80:83], a[96:99], a[0:3], v[80:83]
  s_add_u32 m0, s98, 101248
  v_mfma_f32_16x16x32_bf16 v[80:83], a[100:103], a[4:7], v[80:83]
  buffer_load_dwordx4 v19, s[44:47], s31 offen offset:128 lds
  v_mfma_f32_16x16x32_bf16 v[104:107], a[100:103], a[12:15], v[104:107]
  v_mfma_f32_16x16x32_bf16 v[104:107], a[96:99], a[8:11], v[104:107]
  v_mfma_f32_16x16x32_bf16 v[128:131], a[96:99], a[16:19], v[128:131]
  v_mfma_f32_16x16x32_bf16 v[128:131], a[100:103], a[20:23], v[128:131]
  v_mfma_f32_16x16x32_bf16 v[152:155], a[100:103], a[28:31], v[152:155]
  v_mfma_f32_16x16x32_bf16 v[152:155], a[96:99], a[24:27], v[152:155]
  s_waitcnt lgkmcnt(8)
  v_mfma_f32_16x16x32_bf16 v[156:159], a[104:107], a[24:27], v[156:159]
  s_mov_b32 s29, Lg_epi-Lg_base+16384
  v_mfma_f32_16x16x32_bf16 v[156:159], a[108:111], a[28:31], v[156:159]
  buffer_load_dword a141, v6, s[76:79], s29 offen
  v_mfma_f32_16x16x32_bf16 v[132:135], a[108:111], a[20:23], v[132:135]
  v_mfma_f32_16x16x32_bf16 v[132:135], a[104:107], a[16:19], v[132:135]
  v_mfma_f32_16x16x32_bf16 v[108:111], a[104:107], a[8:11], v[108:111]
  v_mfma_f32_16x16x32_bf16 v[108:111], a[108:111], a[12:15], v[108:111]
  v_mfma_f32_16x16x32_bf16 v[84:87], a[108:111], a[4:7], v[84:87]
  v_mfma_f32_16x16x32_bf16 v[84:87], a[104:107], a[0:3], v[84:87]
  s_waitcnt vmcnt(5) lgkmcnt(0)
  s_barrier
  v_mfma_f32_16x16x32_bf16 v[160:163], a[64:67], a[32:35], v[160:163]
  ds_read_b128 a[0:3], v8 offset:34816
  s_add_u32 m0, s98, 114688
  s_mul_i32 s69, s89, 393216
  s_mul_i32 s31, s93, 1572864
  s_add_u32 s69, s69, s31
  s_add_u32 s31, s69, 393216
  v_mfma_f32_16x16x32_bf16 v[160:163], a[68:71], a[36:39], v[160:163]
  buffer_load_dwordx4 v19, s[44:47], s31 offen offset:0 lds
  v_mfma_f32_16x16x32_bf16 v[184:187], a[68:71], a[44:47], v[184:187]
  ds_read_b128 a[4:7], v9 offset:34816
  s_and_b32 s29, s25, 1
  s_lshl_b32 s29, s29, 2
  s_add_u32 s29, s29, s20
  v_mfma_f32_16x16x32_bf16 v[184:187], a[64:67], a[40:43], v[184:187]
  ds_read_b128 a[16:19], v8 offset:38912
  v_mfma_f32_16x16x32_bf16 v[208:211], a[64:67], a[48:51], v[208:211]
  ds_read_b128 a[8:11], v8 offset:36864
  s_add_u32 m0, s98, 115584
  v_mfma_f32_16x16x32_bf16 v[208:211], a[68:71], a[52:55], v[208:211]
  buffer_load_dwordx4 v19, s[44:47], s31 offen offset:128 lds
  v_mfma_f32_16x16x32_bf16 v[232:235], a[68:71], a[60:63], v[232:235]
  ds_read_b128 a[12:15], v9 offset:36864
  s_mul_i32 s39, s29, 295936
  v_lshl_add_u32 v16, v2, 4, s39
  v_mfma_f32_16x16x32_bf16 v[232:235], a[64:67], a[56:59], v[232:235]
  ds_read_b128 a[20:23], v9 offset:38912
  v_mfma_f32_16x16x32_bf16 v[236:239], a[72:75], a[56:59], v[236:239]
  ds_read_b64_tr_b16 a[64:65], v10 offset:0
  v_mfma_f32_16x16x32_bf16 v[236:239], a[76:79], a[60:63], v[236:239]
  v_mfma_f32_16x16x32_bf16 v[212:215], a[76:79], a[52:55], v[212:215]
  ds_read_b64_tr_b16 a[66:67], v10 offset:512
  s_xor_b32 s29, s29, 4
  s_mul_i32 s39, s29, 295936
  v_lshl_add_u32 v7, v2, 4, s39
  v_mfma_f32_16x16x32_bf16 v[212:215], a[72:75], a[48:51], v[212:215]
  ds_read_b128 a[24:27], v8 offset:40960
  v_mfma_f32_16x16x32_bf16 v[188:191], a[72:75], a[40:43], v[188:191]
  ds_read_b64_tr_b16 a[68:69], v10 offset:14336
  s_add_u32 m0, s98, 116736
  s_add_u32 s31, s69, 409600
  v_mfma_f32_16x16x32_bf16 v[188:191], a[76:79], a[44:47], v[188:191]
  buffer_load_dwordx4 v19, s[44:47], s31 offen offset:0 lds
  v_mfma_f32_16x16x32_bf16 v[164:167], a[76:79], a[36:39], v[164:167]
  ds_read_b64_tr_b16 a[70:71], v10 offset:14848
  s_lshr_b32 s29, s25, 1
  s_mul_i32 s29, s29, 2367488
  s_add_u32 s29, s29, 8388608
  v_mfma_f32_16x16x32_bf16 v[164:167], a[72:75], a[32:35], v[164:167]
  ds_read_b128 a[28:31], v9 offset:40960
  v_mfma_f32_16x16x32_bf16 v[168:171], a[80:83], a[32:35], v[168:171]
  ds_read_b64_tr_b16 a[72:73], v11 offset:0
  s_add_u32 m0, s98, 117632
  v_mfma_f32_16x16x32_bf16 v[168:171], a[84:87], a[36:39], v[168:171]
  buffer_load_dwordx4 v19, s[44:47], s31 offen offset:128 lds
  v_mfma_f32_16x16x32_bf16 v[192:195], a[84:87], a[44:47], v[192:195]
  ds_read_b64_tr_b16 a[74:75], v11 offset:512
  s_add_u32 s4, s12, s29
  s_addc_u32 s5, s13, 0
  s_mov_b32 s6, 2367488
  v_mfma_f32_16x16x32_bf16 v[192:195], a[80:83], a[40:43], v[192:195]
  v_mfma_f32_16x16x32_bf16 v[216:219], a[80:83], a[48:51], v[216:219]
  ds_read_b64_tr_b16 a[76:77], v11 offset:14336
  v_mfma_f32_16x16x32_bf16 v[216:219], a[84:87], a[52:55], v[216:219]
  v_mfma_f32_16x16x32_bf16 v[240:243], a[84:87], a[60:63], v[240:243]
  ds_read_b64_tr_b16 a[78:79], v11 offset:14848
  v_mfma_f32_16x16x32_bf16 v[240:243], a[80:83], a[56:59], v[240:243]
  s_lshl_b32 s29, s23, 1
  s_add_u32 s29, s29, s21
  s_mul_i32 s29, s29, 1183744
  v_mfma_f32_16x16x32_bf16 v[244:247], a[88:91], a[56:59], v[244:247]
  ds_read_b64_tr_b16 a[80:81], v10 offset:1024
  s_add_u32 m0, s98, 131072
  s_add_u32 s31, s68, 786432
  v_mfma_f32_16x16x32_bf16 v[244:247], a[92:95], a[60:63], v[244:247]
  buffer_load_dwordx4 v19, s[44:47], s31 offen offset:0 lds
  v_mfma_f32_16x16x32_bf16 v[220:223], a[92:95], a[52:55], v[220:223]
  ds_read_b64_tr_b16 a[82:83], v10 offset:1536
  v_mfma_f32_16x16x32_bf16 v[220:223], a[88:91], a[48:51], v[220:223]
  s_add_u32 s29, s29, 8388608
  s_add_u32 s12, s12, s29
  s_addc_u32 s13, s13, 0
  v_mfma_f32_16x16x32_bf16 v[196:199], a[88:91], a[40:43], v[196:199]
  ds_read_b64_tr_b16 a[84:85], v10 offset:15360
  s_add_u32 m0, s98, 131968
  v_mfma_f32_16x16x32_bf16 v[196:199], a[92:95], a[44:47], v[196:199]
  buffer_load_dwordx4 v19, s[44:47], s31 offen offset:128 lds
  v_mfma_f32_16x16x32_bf16 v[172:175], a[92:95], a[36:39], v[172:175]
  ds_read_b64_tr_b16 a[86:87], v10 offset:15872
  v_mfma_f32_16x16x32_bf16 v[172:175], a[88:91], a[32:35], v[172:175]
  s_mov_b32 s14, 1183744
  s_mov_b32 s15, 0x20000
  v_mfma_f32_16x16x32_bf16 v[176:179], a[96:99], a[32:35], v[176:179]
  ds_read_b64_tr_b16 a[88:89], v11 offset:1024
  v_mfma_f32_16x16x32_bf16 v[176:179], a[100:103], a[36:39], v[176:179]
  v_mfma_f32_16x16x32_bf16 v[200:203], a[100:103], a[44:47], v[200:203]
  ds_read_b64_tr_b16 a[90:91], v11 offset:1536
  v_mfma_f32_16x16x32_bf16 v[200:203], a[96:99], a[40:43], v[200:203]
  s_movk_i32 s34, 0x1000
  s_mov_b32 s94, 8192
  v_mfma_f32_16x16x32_bf16 v[224:227], a[96:99], a[48:51], v[224:227]
  ds_read_b64_tr_b16 a[92:93], v11 offset:15360
  s_add_u32 m0, s98, 133120
  s_add_u32 s31, s68, 802816
  v_mfma_f32_16x16x32_bf16 v[224:227], a[100:103], a[52:55], v[224:227]
  buffer_load_dwordx4 v19, s[44:47], s31 offen offset:0 lds
  v_mfma_f32_16x16x32_bf16 v[248:251], a[100:103], a[60:63], v[248:251]
  ds_read_b64_tr_b16 a[94:95], v11 offset:15872
  v_mfma_f32_16x16x32_bf16 v[248:251], a[96:99], a[56:59], v[248:251]
  s_mov_b32 s32, 16384
  s_mov_b32 s28, 24576
  v_mfma_f32_16x16x32_bf16 v[252:255], a[104:107], a[56:59], v[252:255]
  ds_read_b64_tr_b16 a[96:97], v10 offset:2048
  s_add_u32 m0, s98, 134016
  v_mfma_f32_16x16x32_bf16 v[252:255], a[108:111], a[60:63], v[252:255]
  buffer_load_dwordx4 v19, s[44:47], s31 offen offset:128 lds
  v_mfma_f32_16x16x32_bf16 v[228:231], a[108:111], a[52:55], v[228:231]
  ds_read_b64_tr_b16 a[98:99], v10 offset:2560
  v_mfma_f32_16x16x32_bf16 v[228:231], a[104:107], a[48:51], v[228:231]
  v_mfma_f32_16x16x32_bf16 v[204:207], a[104:107], a[40:43], v[204:207]
  ds_read_b64_tr_b16 a[100:101], v10 offset:16384
  v_mfma_f32_16x16x32_bf16 v[204:207], a[108:111], a[44:47], v[204:207]
  v_mfma_f32_16x16x32_bf16 v[180:183], a[108:111], a[36:39], v[180:183]
  ds_read_b64_tr_b16 a[102:103], v10 offset:16896
  v_mfma_f32_16x16x32_bf16 v[180:183], a[104:107], a[32:35], v[180:183]
  s_waitcnt lgkmcnt(14)
  v_mfma_f32_16x16x32_bf16 v[64:67], a[64:67], a[0:3], v[64:67]
  ds_read_b64_tr_b16 a[104:105], v11 offset:2048
  s_add_u32 m0, s98, 0
  s_add_u32 s31, s69, 1179648
  v_mfma_f32_16x16x32_bf16 v[64:67], a[68:71], a[4:7], v[64:67]
  buffer_load_dwordx4 v19, s[44:47], s31 offen offset:0 lds
  v_mfma_f32_16x16x32_bf16 v[88:91], a[68:71], a[12:15], v[88:91]
  ds_read_b64_tr_b16 a[106:107], v11 offset:2560
  v_mfma_f32_16x16x32_bf16 v[88:91], a[64:67], a[8:11], v[88:91]
  v_mfma_f32_16x16x32_bf16 v[112:115], a[64:67], a[16:19], v[112:115]
  ds_read_b64_tr_b16 a[108:109], v11 offset:16384
  s_add_u32 m0, s98, 896
  v_mfma_f32_16x16x32_bf16 v[112:115], a[68:71], a[20:23], v[112:115]
  buffer_load_dwordx4 v19, s[44:47], s31 offen offset:128 lds
  v_mfma_f32_16x16x32_bf16 v[136:139], a[68:71], a[28:31], v[136:139]
  ds_read_b64_tr_b16 a[110:111], v11 offset:16896
  v_mfma_f32_16x16x32_bf16 v[136:139], a[64:67], a[24:27], v[136:139]
  s_waitcnt lgkmcnt(14)
  v_mfma_f32_16x16x32_bf16 v[140:143], a[72:75], a[24:27], v[140:143]
  ds_read_b128 a[32:35], v8 offset:43008
  v_mfma_f32_16x16x32_bf16 v[140:143], a[76:79], a[28:31], v[140:143]
  v_mfma_f32_16x16x32_bf16 v[116:119], a[76:79], a[20:23], v[116:119]
  ds_read_b128 a[36:39], v9 offset:43008
  v_mfma_f32_16x16x32_bf16 v[116:119], a[72:75], a[16:19], v[116:119]
  v_mfma_f32_16x16x32_bf16 v[92:95], a[72:75], a[8:11], v[92:95]
  ds_read_b128 a[40:43], v8 offset:45056
  s_add_u32 m0, s98, 2048
  s_add_u32 s31, s69, 1196032
  v_mfma_f32_16x16x32_bf16 v[92:95], a[76:79], a[12:15], v[92:95]
  buffer_load_dwordx4 v19, s[44:47], s31 offen offset:0 lds
  v_mfma_f32_16x16x32_bf16 v[68:71], a[76:79], a[4:7], v[68:71]
  ds_read_b128 a[44:47], v9 offset:45056
  v_mfma_f32_16x16x32_bf16 v[68:71], a[72:75], a[0:3], v[68:71]
  s_waitcnt lgkmcnt(14)
  v_mfma_f32_16x16x32_bf16 v[72:75], a[80:83], a[0:3], v[72:75]
  ds_read_b128 a[48:51], v8 offset:47104
  s_add_u32 m0, s98, 2944
  v_mfma_f32_16x16x32_bf16 v[72:75], a[84:87], a[4:7], v[72:75]
  buffer_load_dwordx4 v19, s[44:47], s31 offen offset:128 lds
  v_mfma_f32_16x16x32_bf16 v[96:99], a[84:87], a[12:15], v[96:99]
  ds_read_b128 a[52:55], v9 offset:47104
  v_mfma_f32_16x16x32_bf16 v[96:99], a[80:83], a[8:11], v[96:99]
  v_mfma_f32_16x16x32_bf16 v[120:123], a[80:83], a[16:19], v[120:123]
  ds_read_b128 a[56:59], v8 offset:49152
  v_mfma_f32_16x16x32_bf16 v[120:123], a[84:87], a[20:23], v[120:123]
  v_mfma_f32_16x16x32_bf16 v[144:147], a[84:87], a[28:31], v[144:147]
  ds_read_b128 a[60:63], v9 offset:49152
  v_mfma_f32_16x16x32_bf16 v[144:147], a[80:83], a[24:27], v[144:147]
  s_waitcnt lgkmcnt(14)
  v_mfma_f32_16x16x32_bf16 v[148:151], a[88:91], a[24:27], v[148:151]
  s_add_u32 m0, s98, 16384
  s_add_u32 s31, s68, 131072
  v_mfma_f32_16x16x32_bf16 v[148:151], a[92:95], a[28:31], v[148:151]
  buffer_load_dwordx4 v19, s[44:47], s31 offen offset:0 lds
  v_mfma_f32_16x16x32_bf16 v[124:127], a[92:95], a[20:23], v[124:127]
  v_mfma_f32_16x16x32_bf16 v[124:127], a[88:91], a[16:19], v[124:127]
  v_mfma_f32_16x16x32_bf16 v[100:103], a[88:91], a[8:11], v[100:103]
  s_add_u32 m0, s98, 17280
  v_mfma_f32_16x16x32_bf16 v[100:103], a[92:95], a[12:15], v[100:103]
  buffer_load_dwordx4 v19, s[44:47], s31 offen offset:128 lds
  v_mfma_f32_16x16x32_bf16 v[76:79], a[92:95], a[4:7], v[76:79]
  v_mfma_f32_16x16x32_bf16 v[76:79], a[88:91], a[0:3], v[76:79]
  s_waitcnt lgkmcnt(12)
  v_mfma_f32_16x16x32_bf16 v[80:83], a[96:99], a[0:3], v[80:83]
  v_mfma_f32_16x16x32_bf16 v[80:83], a[100:103], a[4:7], v[80:83]
  v_mfma_f32_16x16x32_bf16 v[104:107], a[100:103], a[12:15], v[104:107]
  v_mfma_f32_16x16x32_bf16 v[104:107], a[96:99], a[8:11], v[104:107]
  v_mfma_f32_16x16x32_bf16 v[128:131], a[96:99], a[16:19], v[128:131]
  s_add_u32 m0, s98, 18432
  s_add_u32 s31, s68, 147456
  v_mfma_f32_16x16x32_bf16 v[128:131], a[100:103], a[20:23], v[128:131]
  buffer_load_dwordx4 v19, s[44:47], s31 offen offset:0 lds
  v_mfma_f32_16x16x32_bf16 v[152:155], a[100:103], a[28:31], v[152:155]
  v_mfma_f32_16x16x32_bf16 v[152:155], a[96:99], a[24:27], v[152:155]
  s_waitcnt lgkmcnt(8)
  v_mfma_f32_16x16x32_bf16 v[156:159], a[104:107], a[24:27], v[156:159]
  s_add_u32 m0, s98, 19328
  v_mfma_f32_16x16x32_bf16 v[156:159], a[108:111], a[28:31], v[156:159]
  buffer_load_dwordx4 v19, s[44:47], s31 offen offset:128 lds
  v_mfma_f32_16x16x32_bf16 v[132:135], a[108:111], a[20:23], v[132:135]
  v_mfma_f32_16x16x32_bf16 v[132:135], a[104:107], a[16:19], v[132:135]
  v_mfma_f32_16x16x32_bf16 v[108:111], a[104:107], a[8:11], v[108:111]
  v_mfma_f32_16x16x32_bf16 v[108:111], a[108:111], a[12:15], v[108:111]
  v_mfma_f32_16x16x32_bf16 v[84:87], a[108:111], a[4:7], v[84:87]
  v_mfma_f32_16x16x32_bf16 v[84:87], a[104:107], a[0:3], v[84:87]
  s_waitcnt lgkmcnt(0)
  s_barrier
  v_mfma_f32_16x16x32_bf16 v[160:163], a[64:67], a[32:35], v[160:163]
  s_lshl_b32 s29, s21, 9
  s_add_u32 s29, s29, 155648
  v_lshl_add_u32 v30, v4, 2, s29
  s_add_u32 m0, s98, 32768
  s_add_u32 s31, s69, 524288
  v_mfma_f32_16x16x32_bf16 v[160:163], a[68:71], a[36:39], v[160:163]
  buffer_load_dwordx4 v19, s[44:47], s31 offen offset:0 lds
  v_mfma_f32_16x16x32_bf16 v[184:187], a[68:71], a[44:47], v[184:187]
  s_mov_b32 s64, 0x409d30fc
  s_mov_b32 s65, 0x3eeff558
  v_mfma_f32_16x16x32_bf16 v[184:187], a[64:67], a[40:43], v[184:187]
  v_mfma_f32_16x16x32_bf16 v[208:211], a[64:67], a[48:51], v[208:211]
  s_add_u32 m0, s98, 33664
  v_mfma_f32_16x16x32_bf16 v[208:211], a[68:71], a[52:55], v[208:211]
  ds_read_b32 v40, v30 offset:0
  ds_read_b32 v41, v30 offset:1280
  buffer_load_dwordx4 v19, s[44:47], s31 offen offset:128 lds
  v_mfma_f32_16x16x32_bf16 v[232:235], a[68:71], a[60:63], v[232:235]
  v_mfma_f32_16x16x32_bf16 v[232:235], a[64:67], a[56:59], v[232:235]
  v_mfma_f32_16x16x32_bf16 v[236:239], a[72:75], a[56:59], v[236:239]
  ds_read_b32 v42, v30 offset:64
  ds_read_b32 v43, v30 offset:1344
  v_mfma_f32_16x16x32_bf16 v[236:239], a[76:79], a[60:63], v[236:239]
  v_mfma_f32_16x16x32_bf16 v[212:215], a[76:79], a[52:55], v[212:215]
  v_mfma_f32_16x16x32_bf16 v[212:215], a[72:75], a[48:51], v[212:215]
  ds_read_b32 v44, v30 offset:128
  ds_read_b32 v45, v30 offset:1408
  v_mfma_f32_16x16x32_bf16 v[188:191], a[72:75], a[40:43], v[188:191]
  s_add_u32 m0, s98, 34816
  s_add_u32 s31, s69, 540672
  v_mfma_f32_16x16x32_bf16 v[188:191], a[76:79], a[44:47], v[188:191]
  buffer_load_dwordx4 v19, s[44:47], s31 offen offset:0 lds
  v_mfma_f32_16x16x32_bf16 v[164:167], a[76:79], a[36:39], v[164:167]
  ds_read_b32 v46, v30 offset:192
  ds_read_b32 v47, v30 offset:1472
  v_mfma_f32_16x16x32_bf16 v[164:167], a[72:75], a[32:35], v[164:167]
  v_mfma_f32_16x16x32_bf16 v[168:171], a[80:83], a[32:35], v[168:171]
  ds_read_b32 v48, v30 offset:256
  ds_read_b32 v49, v30 offset:1536
  s_add_u32 m0, s98, 35712
  v_mfma_f32_16x16x32_bf16 v[168:171], a[84:87], a[36:39], v[168:171]
  buffer_load_dwordx4 v19, s[44:47], s31 offen offset:128 lds
  v_mfma_f32_16x16x32_bf16 v[192:195], a[84:87], a[44:47], v[192:195]
  v_mfma_f32_16x16x32_bf16 v[192:195], a[80:83], a[40:43], v[192:195]
  ds_read_b32 v50, v30 offset:320
  ds_read_b32 v51, v30 offset:1600
  v_mfma_f32_16x16x32_bf16 v[216:219], a[80:83], a[48:51], v[216:219]
  v_mfma_f32_16x16x32_bf16 v[216:219], a[84:87], a[52:55], v[216:219]
  v_mfma_f32_16x16x32_bf16 v[240:243], a[84:87], a[60:63], v[240:243]
  ds_read_b32 v52, v30 offset:384
  ds_read_b32 v53, v30 offset:1664
  v_mfma_f32_16x16x32_bf16 v[240:243], a[80:83], a[56:59], v[240:243]
  v_mfma_f32_16x16x32_bf16 v[244:247], a[88:91], a[56:59], v[244:247]
  s_add_u32 m0, s98, 49152
  s_add_u32 s31, s68, 917504
  v_mfma_f32_16x16x32_bf16 v[244:247], a[92:95], a[60:63], v[244:247]
  ds_read_b32 v54, v30 offset:448
  ds_read_b32 v55, v30 offset:1728
  buffer_load_dwordx4 v19, s[44:47], s31 offen offset:0 lds
  v_mfma_f32_16x16x32_bf16 v[220:223], a[92:95], a[52:55], v[220:223]
  v_mfma_f32_16x16x32_bf16 v[220:223], a[88:91], a[48:51], v[220:223]
  v_mfma_f32_16x16x32_bf16 v[196:199], a[88:91], a[40:43], v[196:199]
  s_lshl_b32 s29, s22, 7
  s_add_u32 s29, s29, 158208
  v_lshl_add_u32 v31, v3, 4, s29
  s_add_u32 m0, s98, 50048
  v_mfma_f32_16x16x32_bf16 v[196:199], a[92:95], a[44:47], v[196:199]
  buffer_load_dwordx4 v19, s[44:47], s31 offen offset:128 lds
  v_mfma_f32_16x16x32_bf16 v[172:175], a[92:95], a[36:39], v[172:175]
  ds_read_b128 v[56:59], v31 offset:0
  ds_read_b128 v[8:11], v31 offset:1024
  v_mfma_f32_16x16x32_bf16 v[172:175], a[88:91], a[32:35], v[172:175]
  v_mfma_f32_16x16x32_bf16 v[176:179], a[96:99], a[32:35], v[176:179]
  v_mfma_f32_16x16x32_bf16 v[176:179], a[100:103], a[36:39], v[176:179]
  ds_read_b128 v[60:63], v31 offset:64
  ds_read_b128 v[12:15], v31 offset:1088
  v_mfma_f32_16x16x32_bf16 v[200:203], a[100:103], a[44:47], v[200:203]
  v_mfma_f32_16x16x32_bf16 v[200:203], a[96:99], a[40:43], v[200:203]
  v_mfma_f32_16x16x32_bf16 v[224:227], a[96:99], a[48:51], v[224:227]
  s_mul_i32 s29, s24, 6
  s_add_u32 s29, s29, s22
  s_add_u32 s29, s29, 32
  s_add_u32 m0, s98, 51200
  s_add_u32 s31, s68, 933888
  v_mfma_f32_16x16x32_bf16 v[224:227], a[100:103], a[52:55], v[224:227]
  buffer_load_dwordx4 v19, s[44:47], s31 offen offset:0 lds
  v_mfma_f32_16x16x32_bf16 v[248:251], a[100:103], a[60:63], v[248:251]
  v_mfma_f32_16x16x32_bf16 v[248:251], a[96:99], a[56:59], v[248:251]
  s_lshl_b32 s29, s29, 10
  v_lshl_add_u32 v18, v2, 4, s29
  v_mfma_f32_16x16x32_bf16 v[252:255], a[104:107], a[56:59], v[252:255]
  s_add_u32 m0, s98, 52096
  v_mfma_f32_16x16x32_bf16 v[252:255], a[108:111], a[60:63], v[252:255]
  buffer_load_dwordx4 v19, s[44:47], s31 offen offset:128 lds
  v_mfma_f32_16x16x32_bf16 v[228:231], a[108:111], a[52:55], v[228:231]
  v_mfma_f32_16x16x32_bf16 v[228:231], a[104:107], a[48:51], v[228:231]
  v_mfma_f32_16x16x32_bf16 v[204:207], a[104:107], a[40:43], v[204:207]
  v_mfma_f32_16x16x32_bf16 v[204:207], a[108:111], a[44:47], v[204:207]
  v_mfma_f32_16x16x32_bf16 v[180:183], a[108:111], a[36:39], v[180:183]
  v_mfma_f32_16x16x32_bf16 v[180:183], a[104:107], a[32:35], v[180:183]
Lg_epi:
  s_waitcnt lgkmcnt(0)
  v_pk_fma_f32 v[22:23], v[56:57], v[40:41], v[8:9] op_sel:[0,1,0] op_sel_hi:[1,1,1] neg_lo:[0,1,0] neg_hi:[0,1,0]
  v_pk_fma_f32 v[24:25], v[58:59], v[40:41], v[10:11] op_sel:[0,1,0] op_sel_hi:[1,1,1] neg_lo:[0,1,0] neg_hi:[0,1,0]
  v_pk_fma_f32 v[26:27], v[60:61], v[40:41], v[12:13] op_sel:[0,1,0] op_sel_hi:[1,1,1] neg_lo:[0,1,0] neg_hi:[0,1,0]
  v_pk_fma_f32 v[38:39], v[62:63], v[40:41], v[14:15] op_sel:[0,1,0] op_sel_hi:[1,1,1] neg_lo:[0,1,0] neg_hi:[0,1,0]
  v_pk_fma_f32 v[64:65], v[64:65], v[40:41], v[22:23] op_sel_hi:[1,0,1]
  v_pk_fma_f32 v[66:67], v[66:67], v[40:41], v[24:25] op_sel_hi:[1,0,1]
  v_pk_fma_f32 v[68:69], v[68:69], v[40:41], v[26:27] op_sel_hi:[1,0,1]
  v_pk_fma_f32 v[70:71], v[70:71], v[40:41], v[38:39] op_sel_hi:[1,0,1]
  v_pk_fma_f32 v[22:23], v[64:65], v[64:65], s[64:65] op_sel_hi:[1,1,0]
  v_pk_fma_f32 v[24:25], v[66:67], v[66:67], s[64:65] op_sel_hi:[1,1,0]
  v_pk_fma_f32 v[26:27], v[68:69], v[68:69], s[64:65] op_sel_hi:[1,1,0]
  v_pk_fma_f32 v[38:39], v[70:71], v[70:71], s[64:65] op_sel_hi:[1,1,0]
Lg_pad6:
  s_cbranch_execz Lg_pad10
  s_nop 0
  v_pk_mul_f32 v[22:23], v[22:23], v[64:65] neg_lo:[0,1] neg_hi:[0,1]
  v_pk_mul_f32 v[24:25], v[24:25], v[66:67] neg_lo:[0,1] neg_hi:[0,1]
  v_pk_mul_f32 v[26:27], v[26:27], v[68:69] neg_lo:[0,1] neg_hi:[0,1]
  v_pk_mul_f32 v[38:39], v[38:39], v[70:71] neg_lo:[0,1] neg_hi:[0,1]
  v_exp_f32 v22, v22
  v_exp_f32 v23, v23
  v_exp_f32 v24, v24
  v_exp_f32 v25, v25
  v_exp_f32 v26, v26
  v_exp_f32 v27, v27
  v_exp_f32 v38, v38
  v_exp_f32 v39, v39
  v_pk_fma_f32 v[22:23], v[22:23], s[64:65], s[64:65] op_sel:[0,1,1] op_sel_hi:[1,1,1]
  v_pk_fma_f32 v[24:25], v[24:25], s[64:65], s[64:65] op_sel:[0,1,1] op_sel_hi:[1,1,1]
  v_pk_fma_f32 v[26:27], v[26:27], s[64:65], s[64:65] op_sel:[0,1,1] op_sel_hi:[1,1,1]
  v_pk_fma_f32 v[38:39], v[38:39], s[64:65], s[64:65] op_sel:[0,1,1] op_sel_hi:[1,1,1]
  v_rcp_f32 v22, v22
  v_rcp_f32 v23, v23
  v_rcp_f32 v24, v24
  v_rcp_f32 v25, v25
  v_rcp_f32 v26, v26
  v_rcp_f32 v27, v27
  v_rcp_f32 v38, v38
  v_rcp_f32 v39, v39
  v_pk_mul_f32 v[22:23], v[22:23], v[64:65]
  v_pk_mul_f32 v[24:25], v[24:25], v[66:67]
  v_pk_mul_f32 v[26:27], v[26:27], v[68:69]
  v_pk_mul_f32 v[38:39], v[38:39], v[70:71]
  v_cvt_pk_bf16_f32 v64, v22, v23
  v_cvt_pk_bf16_f32 v65, v24, v25
  v_cvt_pk_bf16_f32 v66, v26, v27
  v_cvt_pk_bf16_f32 v67, v38, v39
  s_mov_b32 s29, 0
  s_nop 0
  buffer_store_dwordx4 v[64:67], v18, s[12:15], s29 offen sc1
  v_pk_fma_f32 v[22:23], v[56:57], v[42:43], v[8:9] op_sel:[0,1,0] op_sel_hi:[1,1,1] neg_lo:[0,1,0] neg_hi:[0,1,0]
  v_pk_fma_f32 v[24:25], v[58:59], v[42:43], v[10:11] op_sel:[0,1,0] op_sel_hi:[1,1,1] neg_lo:[0,1,0] neg_hi:[0,1,0]
  v_pk_fma_f32 v[26:27], v[60:61], v[42:43], v[12:13] op_sel:[0,1,0] op_sel_hi:[1,1,1] neg_lo:[0,1,0] neg_hi:[0,1,0]
  v_pk_fma_f32 v[38:39], v[62:63], v[42:43], v[14:15] op_sel:[0,1,0] op_sel_hi:[1,1,1] neg_lo:[0,1,0] neg_hi:[0,1,0]
  v_pk_fma_f32 v[88:89], v[88:89], v[42:43], v[22:23] op_sel_hi:[1,0,1]
  v_pk_fma_f32 v[90:91], v[90:91], v[42:43], v[24:25] op_sel_hi:[1,0,1]
  v_pk_fma_f32 v[92:93], v[92:93], v[42:43], v[26:27] op_sel_hi:[1,0,1]
  v_pk_fma_f32 v[94:95], v[94:95], v[42:43], v[38:39] op_sel_hi:[1,0,1]
  v_pk_fma_f32 v[22:23], v[88:89], v[88:89], s[64:65] op_sel_hi:[1,1,0]
  v_pk_fma_f32 v[24:25], v[90:91], v[90:91], s[64:65] op_sel_hi:[1,1,0]
  v_pk_fma_f32 v[26:27], v[92:93], v[92:93], s[64:65] op_sel_hi:[1,1,0]
  v_pk_fma_f32 v[38:39], v[94:95], v[94:95], s[64:65] op_sel_hi:[1,1,0]
  v_pk_mul_f32 v[22:23], v[22:23], v[88:89] neg_lo:[0,1] neg_hi:[0,1]
  v_pk_mul_f32 v[24:25], v[24:25], v[90:91] neg_lo:[0,1] neg_hi:[0,1]
  v_pk_mul_f32 v[26:27], v[26:27], v[92:93] neg_lo:[0,1] neg_hi:[0,1]
  v_pk_mul_f32 v[38:39], v[38:39], v[94:95] neg_lo:[0,1] neg_hi:[0,1]
  v_exp_f32 v22, v22
  v_exp_f32 v23, v23
  v_exp_f32 v24, v24
  v_exp_f32 v25, v25
  v_exp_f32 v26, v26
  v_exp_f32 v27, v27
  v_exp_f32 v38, v38
  v_exp_f32 v39, v39
  v_pk_fma_f32 v[22:23], v[22:23], s[64:65], s[64:65] op_sel:[0,1,1] op_sel_hi:[1,1,1]
  v_pk_fma_f32 v[24:25], v[24:25], s[64:65], s[64:65] op_sel:[0,1,1] op_sel_hi:[1,1,1]
  v_pk_fma_f32 v[26:27], v[26:27], s[64:65], s[64:65] op_sel:[0,1,1] op_sel_hi:[1,1,1]
  v_pk_fma_f32 v[38:39], v[38:39], s[64:65], s[64:65] op_sel:[0,1,1] op_sel_hi:[1,1,1]
  v_rcp_f32 v22, v22
  v_rcp_f32 v23, v23
  v_rcp_f32 v24, v24
  v_rcp_f32 v25, v25
  v_rcp_f32 v26, v26
  v_rcp_f32 v27, v27
  v_rcp_f32 v38, v38
  v_rcp_f32 v39, v39
  v_pk_mul_f32 v[22:23], v[22:23], v[88:89]
  v_pk_mul_f32 v[24:25], v[24:25], v[90:91]
  v_pk_mul_f32 v[26:27], v[26:27], v[92:93]
  v_pk_mul_f32 v[38:39], v[38:39], v[94:95]
  v_cvt_pk_bf16_f32 v88, v22, v23
  v_cvt_pk_bf16_f32 v89, v24, v25
  v_cvt_pk_bf16_f32 v90, v26, v27
  v_cvt_pk_bf16_f32 v91, v38, v39
  s_mov_b32 s29, 147968
  buffer_store_dwordx4 v[88:91], v18, s[12:15], s29 offen sc1
  v_pk_fma_f32 v[22:23], v[56:57], v[44:45], v[8:9] op_sel:[0,1,0] op_sel_hi:[1,1,1] neg_lo:[0,1,0] neg_hi:[0,1,0]
  v_pk_fma_f32 v[24:25], v[58:59], v[44:45], v[10:11] op_sel:[0,1,0] op_sel_hi:[1,1,1] neg_lo:[0,1,0] neg_hi:[0,1,0]
  v_pk_fma_f32 v[26:27], v[60:61], v[44:45], v[12:13] op_sel:[0,1,0] op_sel_hi:[1,1,1] neg_lo:[0,1,0] neg_hi:[0,1,0]
  v_pk_fma_f32 v[38:39], v[62:63], v[44:45], v[14:15] op_sel:[0,1,0] op_sel_hi:[1,1,1] neg_lo:[0,1,0] neg_hi:[0,1,0]
  v_pk_fma_f32 v[112:113], v[112:113], v[44:45], v[22:23] op_sel_hi:[1,0,1]
  v_pk_fma_f32 v[114:115], v[114:115], v[44:45], v[24:25] op_sel_hi:[1,0,1]
  v_pk_fma_f32 v[116:117], v[116:117], v[44:45], v[26:27] op_sel_hi:[1,0,1]
  v_pk_fma_f32 v[118:119], v[118:119], v[44:45], v[38:39] op_sel_hi:[1,0,1]
  v_pk_fma_f32 v[22:23], v[112:113], v[112:113], s[64:65] op_sel_hi:[1,1,0]
  v_pk_fma_f32 v[24:25], v[114:115], v[114:115], s[64:65] op_sel_hi:[1,1,0]
  v_pk_fma_f32 v[26:27], v[116:117], v[116:117], s[64:65] op_sel_hi:[1,1,0]
  v_pk_fma_f32 v[38:39], v[118:119], v[118:119], s[64:65] op_sel_hi:[1,1,0]
  v_pk_mul_f32 v[22:23], v[22:23], v[112:113] neg_lo:[0,1] neg_hi:[0,1]
  v_pk_mul_f32 v[24:25], v[24:25], v[114:115] neg_lo:[0,1] neg_hi:[0,1]
  v_pk_mul_f32 v[26:27], v[26:27], v[116:117] neg_lo:[0,1] neg_hi:[0,1]
  v_pk_mul_f32 v[38:39], v[38:39], v[118:119] neg_lo:[0,1] neg_hi:[0,1]
  v_exp_f32 v22, v22
  v_exp_f32 v23, v23
  v_exp_f32 v24, v24
  v_exp_f32 v25, v25
  v_exp_f32 v26, v26
  v_exp_f32 v27, v27
  v_exp_f32 v38, v38
  v_exp_f32 v39, v39
  v_pk_fma_f32 v[22:23], v[22:23], s[64:65], s[64:65] op_sel:[0,1,1] op_sel_hi:[1,1,1]
  v_pk_fma_f32 v[24:25], v[24:25], s[64:65], s[64:65] op_sel:[0,1,1] op_sel_hi:[1,1,1]
  v_pk_fma_f32 v[26:27], v[26:27], s[64:65], s[64:65] op_sel:[0,1,1] op_sel_hi:[1,1,1]
  v_pk_fma_f32 v[38:39], v[38:39], s[64:65], s[64:65] op_sel:[0,1,1] op_sel_hi:[1,1,1]
  v_rcp_f32 v22, v22
  v_rcp_f32 v23, v23
  v_rcp_f32 v24, v24
  v_rcp_f32 v25, v25
  v_rcp_f32 v26, v26
  v_rcp_f32 v27, v27
  v_rcp_f32 v38, v38
  v_rcp_f32 v39, v39
  v_pk_mul_f32 v[22:23], v[22:23], v[112:113]
  v_pk_mul_f32 v[24:25], v[24:25], v[114:115]
  v_pk_mul_f32 v[26:27], v[26:27], v[116:117]
  v_pk_mul_f32 v[38:39], v[38:39], v[118:119]
  v_cvt_pk_bf16_f32 v112, v22, v23
  v_cvt_pk_bf16_f32 v113, v24, v25
  v_cvt_pk_bf16_f32 v114, v26, v27
  v_cvt_pk_bf16_f32 v115, v38, v39
  s_mov_b32 s29, 295936
  buffer_store_dwordx4 v[112:115], v18, s[12:15], s29 offen sc1
  v_pk_fma_f32 v[22:23], v[56:57], v[46:47], v[8:9] op_sel:[0,1,0] op_sel_hi:[1,1,1] neg_lo:[0,1,0] neg_hi:[0,1,0]
  v_pk_fma_f32 v[24:25], v[58:59], v[46:47], v[10:11] op_sel:[0,1,0] op_sel_hi:[1,1,1] neg_lo:[0,1,0] neg_hi:[0,1,0]
  v_pk_fma_f32 v[26:27], v[60:61], v[46:47], v[12:13] op_sel:[0,1,0] op_sel_hi:[1,1,1] neg_lo:[0,1,0] neg_hi:[0,1,0]
  v_pk_fma_f32 v[38:39], v[62:63], v[46:47], v[14:15] op_sel:[0,1,0] op_sel_hi:[1,1,1] neg_lo:[0,1,0] neg_hi:[0,1,0]
  v_pk_fma_f32 v[136:137], v[136:137], v[46:47], v[22:23] op_sel_hi:[1,0,1]
  v_pk_fma_f32 v[138:139], v[138:139], v[46:47], v[24:25] op_sel_hi:[1,0,1]
  v_pk_fma_f32 v[140:141], v[140:141], v[46:47], v[26:27] op_sel_hi:[1,0,1]
  v_pk_fma_f32 v[142:143], v[142:143], v[46:47], v[38:39] op_sel_hi:[1,0,1]
  v_pk_fma_f32 v[22:23], v[136:137], v[136:137], s[64:65] op_sel_hi:[1,1,0]
  v_pk_fma_f32 v[24:25], v[138:139], v[138:139], s[64:65] op_sel_hi:[1,1,0]
  v_pk_fma_f32 v[26:27], v[140:141], v[140:141], s[64:65] op_sel_hi:[1,1,0]
  v_pk_fma_f32 v[38:39], v[142:143], v[142:143], s[64:65] op_sel_hi:[1,1,0]
  v_pk_mul_f32 v[22:23], v[22:23], v[136:137] neg_lo:[0,1] neg_hi:[0,1]
  v_pk_mul_f32 v[24:25], v[24:25], v[138:139] neg_lo:[0,1] neg_hi:[0,1]
  v_pk_mul_f32 v[26:27], v[26:27], v[140:141] neg_lo:[0,1] neg_hi:[0,1]
  v_pk_mul_f32 v[38:39], v[38:39], v[142:143] neg_lo:[0,1] neg_hi:[0,1]
  v_exp_f32 v22, v22
  v_exp_f32 v23, v23
  v_exp_f32 v24, v24
  v_exp_f32 v25, v25
  v_exp_f32 v26, v26
  v_exp_f32 v27, v27
  v_exp_f32 v38, v38
  v_exp_f32 v39, v39
  v_pk_fma_f32 v[22:23], v[22:23], s[64:65], s[64:65] op_sel:[0,1,1] op_sel_hi:[1,1,1]
  v_pk_fma_f32 v[24:25], v[24:25], s[64:65], s[64:65] op_sel:[0,1,1] op_sel_hi:[1,1,1]
  v_pk_fma_f32 v[26:27], v[26:27], s[64:65], s[64:65] op_sel:[0,1,1] op_sel_hi:[1,1,1]
  v_pk_fma_f32 v[38:39], v[38:39], s[64:65], s[64:65] op_sel:[0,1,1] op_sel_hi:[1,1,1]
  v_rcp_f32 v22, v22
  v_rcp_f32 v23, v23
  v_rcp_f32 v24, v24
  v_rcp_f32 v25, v25
  v_rcp_f32 v26, v26
  v_rcp_f32 v27, v27
  v_rcp_f32 v38, v38
  v_rcp_f32 v39, v39
  v_pk_mul_f32 v[22:23], v[22:23], v[136:137]
  v_pk_mul_f32 v[24:25], v[24:25], v[138:139]
  v_pk_mul_f32 v[26:27], v[26:27], v[140:141]
  v_pk_mul_f32 v[38:39], v[38:39], v[142:143]
  v_cvt_pk_bf16_f32 v136, v22, v23
  v_cvt_pk_bf16_f32 v137, v24, v25
  v_cvt_pk_bf16_f32 v138, v26, v27
  v_cvt_pk_bf16_f32 v139, v38, v39
  s_mov_b32 s29, 443904
  buffer_store_dwordx4 v[136:139], v18, s[12:15], s29 offen sc1
  v_pk_fma_f32 v[22:23], v[56:57], v[48:49], v[8:9] op_sel:[0,1,0] op_sel_hi:[1,1,1] neg_lo:[0,1,0] neg_hi:[0,1,0]
  v_pk_fma_f32 v[24:25], v[58:59], v[48:49], v[10:11] op_sel:[0,1,0] op_sel_hi:[1,1,1] neg_lo:[0,1,0] neg_hi:[0,1,0]
  v_pk_fma_f32 v[26:27], v[60:61], v[48:49], v[12:13] op_sel:[0,1,0] op_sel_hi:[1,1,1] neg_lo:[0,1,0] neg_hi:[0,1,0]
  v_pk_fma_f32 v[38:39], v[62:63], v[48:49], v[14:15] op_sel:[0,1,0] op_sel_hi:[1,1,1] neg_lo:[0,1,0] neg_hi:[0,1,0]
  v_pk_fma_f32 v[160:161], v[160:161], v[48:49], v[22:23] op_sel_hi:[1,0,1]
  v_pk_fma_f32 v[162:163], v[162:163], v[48:49], v[24:25] op_sel_hi:[1,0,1]
  v_pk_fma_f32 v[164:165], v[164:165], v[48:49], v[26:27] op_sel_hi:[1,0,1]
  v_pk_fma_f32 v[166:167], v[166:167], v[48:49], v[38:39] op_sel_hi:[1,0,1]
  v_pk_fma_f32 v[22:23], v[160:161], v[160:161], s[64:65] op_sel_hi:[1,1,0]
  v_pk_fma_f32 v[24:25], v[162:163], v[162:163], s[64:65] op_sel_hi:[1,1,0]
  v_pk_fma_f32 v[26:27], v[164:165], v[164:165], s[64:65] op_sel_hi:[1,1,0]
  v_pk_fma_f32 v[38:39], v[166:167], v[166:167], s[64:65] op_sel_hi:[1,1,0]
  v_pk_mul_f32 v[22:23], v[22:23], v[160:161] neg_lo:[0,1] neg_hi:[0,1]
  v_pk_mul_f32 v[24:25], v[24:25], v[162:163] neg_lo:[0,1] neg_hi:[0,1]
  v_pk_mul_f32 v[26:27], v[26:27], v[164:165] neg_lo:[0,1] neg_hi:[0,1]
  v_pk_mul_f32 v[38:39], v[38:39], v[166:167] neg_lo:[0,1] neg_hi:[0,1]
  v_exp_f32 v22, v22
  v_exp_f32 v23, v23
  v_exp_f32 v24, v24
  v_exp_f32 v25, v25
  v_exp_f32 v26, v26
  v_exp_f32 v27, v27
  v_exp_f32 v38, v38
  v_exp_f32 v39, v39
  v_pk_fma_f32 v[22:23], v[22:23], s[64:65], s[64:65] op_sel:[0,1,1] op_sel_hi:[1,1,1]
  v_pk_fma_f32 v[24:25], v[24:25], s[64:65], s[64:65] op_sel:[0,1,1] op_sel_hi:[1,1,1]
  v_pk_fma_f32 v[26:27], v[26:27], s[64:65], s[64:65] op_sel:[0,1,1] op_sel_hi:[1,1,1]
  v_pk_fma_f32 v[38:39], v[38:39], s[64:65], s[64:65] op_sel:[0,1,1] op_sel_hi:[1,1,1]
  v_rcp_f32 v22, v22
  v_rcp_f32 v23, v23
  v_rcp_f32 v24, v24
  v_rcp_f32 v25, v25
  v_rcp_f32 v26, v26
  v_rcp_f32 v27, v27
  v_rcp_f32 v38, v38
  v_rcp_f32 v39, v39
  v_pk_mul_f32 v[22:23], v[22:23], v[160:161]
  v_pk_mul_f32 v[24:25], v[24:25], v[162:163]
  v_pk_mul_f32 v[26:27], v[26:27], v[164:165]
  v_pk_mul_f32 v[38:39], v[38:39], v[166:167]
  v_cvt_pk_bf16_f32 v160, v22, v23
  v_cvt_pk_bf16_f32 v161, v24, v25
  v_cvt_pk_bf16_f32 v162, v26, v27
  v_cvt_pk_bf16_f32 v163, v38, v39
  s_mov_b32 s29, 591872
  buffer_store_dwordx4 v[160:163], v18, s[12:15], s29 offen sc1
  v_pk_fma_f32 v[22:23], v[56:57], v[50:51], v[8:9] op_sel:[0,1,0] op_sel_hi:[1,1,1] neg_lo:[0,1,0] neg_hi:[0,1,0]
  v_pk_fma_f32 v[24:25], v[58:59], v[50:51], v[10:11] op_sel:[0,1,0] op_sel_hi:[1,1,1] neg_lo:[0,1,0] neg_hi:[0,1,0]
  v_pk_fma_f32 v[26:27], v[60:61], v[50:51], v[12:13] op_sel:[0,1,0] op_sel_hi:[1,1,1] neg_lo:[0,1,0] neg_hi:[0,1,0]
  v_pk_fma_f32 v[38:39], v[62:63], v[50:51], v[14:15] op_sel:[0,1,0] op_sel_hi:[1,1,1] neg_lo:[0,1,0] neg_hi:[0,1,0]
  v_pk_fma_f32 v[184:185], v[184:185], v[50:51], v[22:23] op_sel_hi:[1,0,1]
  v_pk_fma_f32 v[186:187], v[186:187], v[50:51], v[24:25] op_sel_hi:[1,0,1]
  v_pk_fma_f32 v[188:189], v[188:189], v[50:51], v[26:27] op_sel_hi:[1,0,1]
  v_pk_fma_f32 v[190:191], v[190:191], v[50:51], v[38:39] op_sel_hi:[1,0,1]
  v_pk_fma_f32 v[22:23], v[184:185], v[184:185], s[64:65] op_sel_hi:[1,1,0]
  v_pk_fma_f32 v[24:25], v[186:187], v[186:187], s[64:65] op_sel_hi:[1,1,0]
  v_pk_fma_f32 v[26:27], v[188:189], v[188:189], s[64:65] op_sel_hi:[1,1,0]
  v_pk_fma_f32 v[38:39], v[190:191], v[190:191], s[64:65] op_sel_hi:[1,1,0]
  v_pk_mul_f32 v[22:23], v[22:23], v[184:185] neg_lo:[0,1] neg_hi:[0,1]
  v_pk_mul_f32 v[24:25], v[24:25], v[186:187] neg_lo:[0,1] neg_hi:[0,1]
  v_pk_mul_f32 v[26:27], v[26:27], v[188:189] neg_lo:[0,1] neg_hi:[0,1]
  v_pk_mul_f32 v[38:39], v[38:39], v[190:191] neg_lo:[0,1] neg_hi:[0,1]
  v_exp_f32 v22, v22
  v_exp_f32 v23, v23
  v_exp_f32 v24, v24
  v_exp_f32 v25, v25
  v_exp_f32 v26, v26
  v_exp_f32 v27, v27
  v_exp_f32 v38, v38
  v_exp_f32 v39, v39
  v_pk_fma_f32 v[22:23], v[22:23], s[64:65], s[64:65] op_sel:[0,1,1] op_sel_hi:[1,1,1]
  v_pk_fma_f32 v[24:25], v[24:25], s[64:65], s[64:65] op_sel:[0,1,1] op_sel_hi:[1,1,1]
  v_pk_fma_f32 v[26:27], v[26:27], s[64:65], s[64:65] op_sel:[0,1,1] op_sel_hi:[1,1,1]
  v_pk_fma_f32 v[38:39], v[38:39], s[64:65], s[64:65] op_sel:[0,1,1] op_sel_hi:[1,1,1]
  v_rcp_f32 v22, v22
  v_rcp_f32 v23, v23
  v_rcp_f32 v24, v24
  v_rcp_f32 v25, v25
  v_rcp_f32 v26, v26
  v_rcp_f32 v27, v27
  v_rcp_f32 v38, v38
  v_rcp_f32 v39, v39
  v_pk_mul_f32 v[22:23], v[22:23], v[184:185]
  v_pk_mul_f32 v[24:25], v[24:25], v[186:187]
  v_pk_mul_f32 v[26:27], v[26:27], v[188:189]
  v_pk_mul_f32 v[38:39], v[38:39], v[190:191]
  v_cvt_pk_bf16_f32 v184, v22, v23
  v_cvt_pk_bf16_f32 v185, v24, v25
  v_cvt_pk_bf16_f32 v186, v26, v27
  v_cvt_pk_bf16_f32 v187, v38, v39
  s_mov_b32 s29, 739840
  buffer_store_dwordx4 v[184:187], v18, s[12:15], s29 offen sc1
  v_pk_fma_f32 v[22:23], v[56:57], v[52:53], v[8:9] op_sel:[0,1,0] op_sel_hi:[1,1,1] neg_lo:[0,1,0] neg_hi:[0,1,0]
  v_pk_fma_f32 v[24:25], v[58:59], v[52:53], v[10:11] op_sel:[0,1,0] op_sel_hi:[1,1,1] neg_lo:[0,1,0] neg_hi:[0,1,0]
  v_pk_fma_f32 v[26:27], v[60:61], v[52:53], v[12:13] op_sel:[0,1,0] op_sel_hi:[1,1,1] neg_lo:[0,1,0] neg_hi:[0,1,0]
  v_pk_fma_f32 v[38:39], v[62:63], v[52:53], v[14:15] op_sel:[0,1,0] op_sel_hi:[1,1,1] neg_lo:[0,1,0] neg_hi:[0,1,0]
  v_pk_fma_f32 v[208:209], v[208:209], v[52:53], v[22:23] op_sel_hi:[1,0,1]
  v_pk_fma_f32 v[210:211], v[210:211], v[52:53], v[24:25] op_sel_hi:[1,0,1]
  v_pk_fma_f32 v[212:213], v[212:213], v[52:53], v[26:27] op_sel_hi:[1,0,1]
  v_pk_fma_f32 v[214:215], v[214:215], v[52:53], v[38:39] op_sel_hi:[1,0,1]
  v_pk_fma_f32 v[22:23], v[208:209], v[208:209], s[64:65] op_sel_hi:[1,1,0]
  v_pk_fma_f32 v[24:25], v[210:211], v[210:211], s[64:65] op_sel_hi:[1,1,0]
  v_pk_fma_f32 v[26:27], v[212:213], v[212:213], s[64:65] op_sel_hi:[1,1,0]
  v_pk_fma_f32 v[38:39], v[214:215], v[214:215], s[64:65] op_sel_hi:[1,1,0]
  v_pk_mul_f32 v[22:23], v[22:23], v[208:209] neg_lo:[0,1] neg_hi:[0,1]
  v_pk_mul_f32 v[24:25], v[24:25], v[210:211] neg_lo:[0,1] neg_hi:[0,1]
  v_pk_mul_f32 v[26:27], v[26:27], v[212:213] neg_lo:[0,1] neg_hi:[0,1]
  v_pk_mul_f32 v[38:39], v[38:39], v[214:215] neg_lo:[0,1] neg_hi:[0,1]
  v_exp_f32 v22, v22
  v_exp_f32 v23, v23
  v_exp_f32 v24, v24
  v_exp_f32 v25, v25
  v_exp_f32 v26, v26
  v_exp_f32 v27, v27
  v_exp_f32 v38, v38
  v_exp_f32 v39, v39
  v_pk_fma_f32 v[22:23], v[22:23], s[64:65], s[64:65] op_sel:[0,1,1] op_sel_hi:[1,1,1]
  v_pk_fma_f32 v[24:25], v[24:25], s[64:65], s[64:65] op_sel:[0,1,1] op_sel_hi:[1,1,1]
  v_pk_fma_f32 v[26:27], v[26:27], s[64:65], s[64:65] op_sel:[0,1,1] op_sel_hi:[1,1,1]
  v_pk_fma_f32 v[38:39], v[38:39], s[64:65], s[64:65] op_sel:[0,1,1] op_sel_hi:[1,1,1]
  v_rcp_f32 v22, v22
  v_rcp_f32 v23, v23
  v_rcp_f32 v24, v24
  v_rcp_f32 v25, v25
  v_rcp_f32 v26, v26
  v_rcp_f32 v27, v27
  v_rcp_f32 v38, v38
  v_rcp_f32 v39, v39
  v_pk_mul_f32 v[22:23], v[22:23], v[208:209]
  v_pk_mul_f32 v[24:25], v[24:25], v[210:211]
  v_pk_mul_f32 v[26:27], v[26:27], v[212:213]
  v_pk_mul_f32 v[38:39], v[38:39], v[214:215]
  v_cvt_pk_bf16_f32 v208, v22, v23
  v_cvt_pk_bf16_f32 v209, v24, v25
  v_cvt_pk_bf16_f32 v210, v26, v27
  v_cvt_pk_bf16_f32 v211, v38, v39
  s_mov_b32 s29, 887808
  buffer_store_dwordx4 v[208:211], v18, s[12:15], s29 offen sc1
  v_pk_fma_f32 v[22:23], v[56:57], v[54:55], v[8:9] op_sel:[0,1,0] op_sel_hi:[1,1,1] neg_lo:[0,1,0] neg_hi:[0,1,0]
  v_pk_fma_f32 v[24:25], v[58:59], v[54:55], v[10:11] op_sel:[0,1,0] op_sel_hi:[1,1,1] neg_lo:[0,1,0] neg_hi:[0,1,0]
  v_pk_fma_f32 v[26:27], v[60:61], v[54:55], v[12:13] op_sel:[0,1,0] op_sel_hi:[1,1,1] neg_lo:[0,1,0] neg_hi:[0,1,0]
  v_pk_fma_f32 v[38:39], v[62:63], v[54:55], v[14:15] op_sel:[0,1,0] op_sel_hi:[1,1,1] neg_lo:[0,1,0] neg_hi:[0,1,0]
  v_pk_fma_f32 v[232:233], v[232:233], v[54:55], v[22:23] op_sel_hi:[1,0,1]
  v_pk_fma_f32 v[234:235], v[234:235], v[54:55], v[24:25] op_sel_hi:[1,0,1]
  v_pk_fma_f32 v[236:237], v[236:237], v[54:55], v[26:27] op_sel_hi:[1,0,1]
  ds_read_b128 v[56:59], v31 offset:256
  ds_read_b128 v[8:11], v31 offset:1280
  v_pk_fma_f32 v[238:239], v[238:239], v[54:55], v[38:39] op_sel_hi:[1,0,1]
  ds_read_b128 v[60:63], v31 offset:320
  ds_read_b128 v[12:15], v31 offset:1344
  v_pk_fma_f32 v[22:23], v[232:233], v[232:233], s[64:65] op_sel_hi:[1,1,0]
  v_pk_fma_f32 v[24:25], v[234:235], v[234:235], s[64:65] op_sel_hi:[1,1,0]
  v_pk_fma_f32 v[26:27], v[236:237], v[236:237], s[64:65] op_sel_hi:[1,1,0]
  v_pk_fma_f32 v[38:39], v[238:239], v[238:239], s[64:65] op_sel_hi:[1,1,0]
  v_pk_mul_f32 v[22:23], v[22:23], v[232:233] neg_lo:[0,1] neg_hi:[0,1]
  v_pk_mul_f32 v[24:25], v[24:25], v[234:235] neg_lo:[0,1] neg_hi:[0,1]
  v_pk_mul_f32 v[26:27], v[26:27], v[236:237] neg_lo:[0,1] neg_hi:[0,1]
  v_pk_mul_f32 v[38:39], v[38:39], v[238:239] neg_lo:[0,1] neg_hi:[0,1]
  v_exp_f32 v22, v22
  v_exp_f32 v23, v23
  v_exp_f32 v24, v24
  v_exp_f32 v25, v25
  v_exp_f32 v26, v26
  v_exp_f32 v27, v27
  v_exp_f32 v38, v38
  v_exp_f32 v39, v39
  v_pk_fma_f32 v[22:23], v[22:23], s[64:65], s[64:65] op_sel:[0,1,1] op_sel_hi:[1,1,1]
  v_pk_fma_f32 v[24:25], v[24:25], s[64:65], s[64:65] op_sel:[0,1,1] op_sel_hi:[1,1,1]
  v_pk_fma_f32 v[26:27], v[26:27], s[64:65], s[64:65] op_sel:[0,1,1] op_sel_hi:[1,1,1]
  v_pk_fma_f32 v[38:39], v[38:39], s[64:65], s[64:65] op_sel:[0,1,1] op_sel_hi:[1,1,1]
  v_rcp_f32 v22, v22
  v_rcp_f32 v23, v23
  v_rcp_f32 v24, v24
  v_rcp_f32 v25, v25
  v_rcp_f32 v26, v26
  v_rcp_f32 v27, v27
  v_rcp_f32 v38, v38
  v_rcp_f32 v39, v39
  v_pk_mul_f32 v[22:23], v[22:23], v[232:233]
  v_pk_mul_f32 v[24:25], v[24:25], v[234:235]
  v_pk_mul_f32 v[26:27], v[26:27], v[236:237]
  v_pk_mul_f32 v[38:39], v[38:39], v[238:239]
  v_cvt_pk_bf16_f32 v232, v22, v23
  v_cvt_pk_bf16_f32 v233, v24, v25
  v_cvt_pk_bf16_f32 v234, v26, v27
  v_cvt_pk_bf16_f32 v235, v38, v39
  s_mov_b32 s29, 1035776
  buffer_store_dwordx4 v[232:235], v18, s[12:15], s29 offen sc1
  s_waitcnt lgkmcnt(0)
  s_nop 0
  v_pk_fma_f32 v[22:23], v[56:57], v[40:41], v[8:9] op_sel:[0,1,0] op_sel_hi:[1,1,1] neg_lo:[0,1,0] neg_hi:[0,1,0]
  v_pk_fma_f32 v[24:25], v[58:59], v[40:41], v[10:11] op_sel:[0,1,0] op_sel_hi:[1,1,1] neg_lo:[0,1,0] neg_hi:[0,1,0]
  v_pk_fma_f32 v[26:27], v[60:61], v[40:41], v[12:13] op_sel:[0,1,0] op_sel_hi:[1,1,1] neg_lo:[0,1,0] neg_hi:[0,1,0]
  v_pk_fma_f32 v[38:39], v[62:63], v[40:41], v[14:15] op_sel:[0,1,0] op_sel_hi:[1,1,1] neg_lo:[0,1,0] neg_hi:[0,1,0]
  v_pk_fma_f32 v[72:73], v[72:73], v[40:41], v[22:23] op_sel_hi:[1,0,1]
  v_pk_fma_f32 v[74:75], v[74:75], v[40:41], v[24:25] op_sel_hi:[1,0,1]
  v_pk_fma_f32 v[76:77], v[76:77], v[40:41], v[26:27] op_sel_hi:[1,0,1]
  v_pk_fma_f32 v[78:79], v[78:79], v[40:41], v[38:39] op_sel_hi:[1,0,1]
  v_pk_fma_f32 v[22:23], v[72:73], v[72:73], s[64:65] op_sel_hi:[1,1,0]
  v_pk_fma_f32 v[24:25], v[74:75], v[74:75], s[64:65] op_sel_hi:[1,1,0]
  v_pk_fma_f32 v[26:27], v[76:77], v[76:77], s[64:65] op_sel_hi:[1,1,0]
  v_pk_fma_f32 v[38:39], v[78:79], v[78:79], s[64:65] op_sel_hi:[1,1,0]
  v_pk_mul_f32 v[22:23], v[22:23], v[72:73] neg_lo:[0,1] neg_hi:[0,1]
  v_pk_mul_f32 v[24:25], v[24:25], v[74:75] neg_lo:[0,1] neg_hi:[0,1]
  v_pk_mul_f32 v[26:27], v[26:27], v[76:77] neg_lo:[0,1] neg_hi:[0,1]
  v_pk_mul_f32 v[38:39], v[38:39], v[78:79] neg_lo:[0,1] neg_hi:[0,1]
  v_exp_f32 v22, v22
  v_exp_f32 v23, v23
  v_exp_f32 v24, v24
  v_exp_f32 v25, v25
  v_exp_f32 v26, v26
  v_exp_f32 v27, v27
  v_exp_f32 v38, v38
  v_exp_f32 v39, v39
  v_pk_fma_f32 v[22:23], v[22:23], s[64:65], s[64:65] op_sel:[0,1,1] op_sel_hi:[1,1,1]
  v_pk_fma_f32 v[24:25], v[24:25], s[64:65], s[64:65] op_sel:[0,1,1] op_sel_hi:[1,1,1]
  v_pk_fma_f32 v[26:27], v[26:27], s[64:65], s[64:65] op_sel:[0,1,1] op_sel_hi:[1,1,1]
  v_pk_fma_f32 v[38:39], v[38:39], s[64:65], s[64:65] op_sel:[0,1,1] op_sel_hi:[1,1,1]
  v_rcp_f32 v22, v22
  v_rcp_f32 v23, v23
  v_rcp_f32 v24, v24
  v_rcp_f32 v25, v25
  v_rcp_f32 v26, v26
  v_rcp_f32 v27, v27
  v_rcp_f32 v38, v38
  v_rcp_f32 v39, v39
  v_pk_mul_f32 v[22:23], v[22:23], v[72:73]
  v_pk_mul_f32 v[24:25], v[24:25], v[74:75]
  v_pk_mul_f32 v[26:27], v[26:27], v[76:77]
  v_pk_mul_f32 v[38:39], v[38:39], v[78:79]
  v_cvt_pk_bf16_f32 v72, v22, v23
  v_cvt_pk_bf16_f32 v73, v24, v25
  v_cvt_pk_bf16_f32 v74, v26, v27
  v_cvt_pk_bf16_f32 v75, v38, v39
  s_mov_b32 s29, 2048
  buffer_store_dwordx4 v[72:75], v18, s[12:15], s29 offen sc1
  v_pk_fma_f32 v[22:23], v[56:57], v[42:43], v[8:9] op_sel:[0,1,0] op_sel_hi:[1,1,1] neg_lo:[0,1,0] neg_hi:[0,1,0]
  v_pk_fma_f32 v[24:25], v[58:59], v[42:43], v[10:11] op_sel:[0,1,0] op_sel_hi:[1,1,1] neg_lo:[0,1,0] neg_hi:[0,1,0]
  v_pk_fma_f32 v[26:27], v[60:61], v[42:43], v[12:13] op_sel:[0,1,0] op_sel_hi:[1,1,1] neg_lo:[0,1,0] neg_hi:[0,1,0]
  v_pk_fma_f32 v[38:39], v[62:63], v[42:43], v[14:15] op_sel:[0,1,0] op_sel_hi:[1,1,1] neg_lo:[0,1,0] neg_hi:[0,1,0]
  v_pk_fma_f32 v[96:97], v[96:97], v[42:43], v[22:23] op_sel_hi:[1,0,1]
  v_pk_fma_f32 v[98:99], v[98:99], v[42:43], v[24:25] op_sel_hi:[1,0,1]
  v_pk_fma_f32 v[100:101], v[100:101], v[42:43], v[26:27] op_sel_hi:[1,0,1]
  v_pk_fma_f32 v[102:103], v[102:103], v[42:43], v[38:39] op_sel_hi:[1,0,1]
  v_pk_fma_f32 v[22:23], v[96:97], v[96:97], s[64:65] op_sel_hi:[1,1,0]
  v_pk_fma_f32 v[24:25], v[98:99], v[98:99], s[64:65] op_sel_hi:[1,1,0]
  v_pk_fma_f32 v[26:27], v[100:101], v[100:101], s[64:65] op_sel_hi:[1,1,0]
  v_pk_fma_f32 v[38:39], v[102:103], v[102:103], s[64:65] op_sel_hi:[1,1,0]
  v_pk_mul_f32 v[22:23], v[22:23], v[96:97] neg_lo:[0,1] neg_hi:[0,1]
  v_pk_mul_f32 v[24:25], v[24:25], v[98:99] neg_lo:[0,1] neg_hi:[0,1]
  v_pk_mul_f32 v[26:27], v[26:27], v[100:101] neg_lo:[0,1] neg_hi:[0,1]
  v_pk_mul_f32 v[38:39], v[38:39], v[102:103] neg_lo:[0,1] neg_hi:[0,1]
  v_exp_f32 v22, v22
  v_exp_f32 v23, v23
  v_exp_f32 v24, v24
  v_exp_f32 v25, v25
  v_exp_f32 v26, v26
  v_exp_f32 v27, v27
  v_exp_f32 v38, v38
  v_exp_f32 v39, v39
  v_pk_fma_f32 v[22:23], v[22:23], s[64:65], s[64:65] op_sel:[0,1,1] op_sel_hi:[1,1,1]
  v_pk_fma_f32 v[24:25], v[24:25], s[64:65], s[64:65] op_sel:[0,1,1] op_sel_hi:[1,1,1]
  v_pk_fma_f32 v[26:27], v[26:27], s[64:65], s[64:65] op_sel:[0,1,1] op_sel_hi:[1,1,1]
  v_pk_fma_f32 v[38:39], v[38:39], s[64:65], s[64:65] op_sel:[0,1,1] op_sel_hi:[1,1,1]
  v_rcp_f32 v22, v22
  v_rcp_f32 v23, v23
  v_rcp_f32 v24, v24
  v_rcp_f32 v25, v25
  v_rcp_f32 v26, v26
  v_rcp_f32 v27, v27
  v_rcp_f32 v38, v38
  v_rcp_f32 v39, v39
  v_pk_mul_f32 v[22:23], v[22:23], v[96:97]
  v_pk_mul_f32 v[24:25], v[24:25], v[98:99]
  v_pk_mul_f32 v[26:27], v[26:27], v[100:101]
  v_pk_mul_f32 v[38:39], v[38:39], v[102:103]
  v_cvt_pk_bf16_f32 v96, v22, v23
  v_cvt_pk_bf16_f32 v97, v24, v25
  v_cvt_pk_bf16_f32 v98, v26, v27
  v_cvt_pk_bf16_f32 v99, v38, v39
  s_mov_b32 s29, 150016
  buffer_store_dwordx4 v[96:99], v18, s[12:15], s29 offen sc1
  v_pk_fma_f32 v[22:23], v[56:57], v[44:45], v[8:9] op_sel:[0,1,0] op_sel_hi:[1,1,1] neg_lo:[0,1,0] neg_hi:[0,1,0]
  v_pk_fma_f32 v[24:25], v[58:59], v[44:45], v[10:11] op_sel:[0,1,0] op_sel_hi:[1,1,1] neg_lo:[0,1,0] neg_hi:[0,1,0]
  v_pk_fma_f32 v[26:27], v[60:61], v[44:45], v[12:13] op_sel:[0,1,0] op_sel_hi:[1,1,1] neg_lo:[0,1,0] neg_hi:[0,1,0]
  v_pk_fma_f32 v[38:39], v[62:63], v[44:45], v[14:15] op_sel:[0,1,0] op_sel_hi:[1,1,1] neg_lo:[0,1,0] neg_hi:[0,1,0]
  v_pk_fma_f32 v[120:121], v[120:121], v[44:45], v[22:23] op_sel_hi:[1,0,1]
  v_pk_fma_f32 v[122:123], v[122:123], v[44:45], v[24:25] op_sel_hi:[1,0,1]
  v_pk_fma_f32 v[124:125], v[124:125], v[44:45], v[26:27] op_sel_hi:[1,0,1]
  v_pk_fma_f32 v[126:127], v[126:127], v[44:45], v[38:39] op_sel_hi:[1,0,1]
  v_pk_fma_f32 v[22:23], v[120:121], v[120:121], s[64:65] op_sel_hi:[1,1,0]
  v_pk_fma_f32 v[24:25], v[122:123], v[122:123], s[64:65] op_sel_hi:[1,1,0]
  v_pk_fma_f32 v[26:27], v[124:125], v[124:125], s[64:65] op_sel_hi:[1,1,0]
  v_pk_fma_f32 v[38:39], v[126:127], v[126:127], s[64:65] op_sel_hi:[1,1,0]
  v_pk_mul_f32 v[22:23], v[22:23], v[120:121] neg_lo:[0,1] neg_hi:[0,1]
  v_pk_mul_f32 v[24:25], v[24:25], v[122:123] neg_lo:[0,1] neg_hi:[0,1]
  v_pk_mul_f32 v[26:27], v[26:27], v[124:125] neg_lo:[0,1] neg_hi:[0,1]
  v_pk_mul_f32 v[38:39], v[38:39], v[126:127] neg_lo:[0,1] neg_hi:[0,1]
  v_exp_f32 v22, v22
  v_exp_f32 v23, v23
  v_exp_f32 v24, v24
  v_exp_f32 v25, v25
  v_exp_f32 v26, v26
  v_exp_f32 v27, v27
  v_exp_f32 v38, v38
  v_exp_f32 v39, v39
  v_pk_fma_f32 v[22:23], v[22:23], s[64:65], s[64:65] op_sel:[0,1,1] op_sel_hi:[1,1,1]
  v_pk_fma_f32 v[24:25], v[24:25], s[64:65], s[64:65] op_sel:[0,1,1] op_sel_hi:[1,1,1]
  v_pk_fma_f32 v[26:27], v[26:27], s[64:65], s[64:65] op_sel:[0,1,1] op_sel_hi:[1,1,1]
  v_pk_fma_f32 v[38:39], v[38:39], s[64:65], s[64:65] op_sel:[0,1,1] op_sel_hi:[1,1,1]
  v_rcp_f32 v22, v22
  v_rcp_f32 v23, v23
  v_rcp_f32 v24, v24
  v_rcp_f32 v25, v25
  v_rcp_f32 v26, v26
  v_rcp_f32 v27, v27
  v_rcp_f32 v38, v38
  v_rcp_f32 v39, v39
  v_pk_mul_f32 v[22:23], v[22:23], v[120:121]
  v_pk_mul_f32 v[24:25], v[24:25], v[122:123]
  v_pk_mul_f32 v[26:27], v[26:27], v[124:125]
  v_pk_mul_f32 v[38:39], v[38:39], v[126:127]
  v_cvt_pk_bf16_f32 v120, v22, v23
  v_cvt_pk_bf16_f32 v121, v24, v25
  v_cvt_pk_bf16_f32 v122, v26, v27
  v_cvt_pk_bf16_f32 v123, v38, v39
  s_mov_b32 s29, 297984
  buffer_store_dwordx4 v[120:123], v18, s[12:15], s29 offen sc1
  v_pk_fma_f32 v[22:23], v[56:57], v[46:47], v[8:9] op_sel:[0,1,0] op_sel_hi:[1,1,1] neg_lo:[0,1,0] neg_hi:[0,1,0]
  v_pk_fma_f32 v[24:25], v[58:59], v[46:47], v[10:11] op_sel:[0,1,0] op_sel_hi:[1,1,1] neg_lo:[0,1,0] neg_hi:[0,1,0]
  v_pk_fma_f32 v[26:27], v[60:61], v[46:47], v[12:13] op_sel:[0,1,0] op_sel_hi:[1,1,1] neg_lo:[0,1,0] neg_hi:[0,1,0]
  s_waitcnt vmcnt(3)
  s_mov_b64 exec, 1
  buffer_store_dword v35, v29, s[16:19], 0 offen sc1
  s_mov_b64 exec, -1
  s_nop 0
  v_pk_fma_f32 v[38:39], v[62:63], v[46:47], v[14:15] op_sel:[0,1,0] op_sel_hi:[1,1,1] neg_lo:[0,1,0] neg_hi:[0,1,0]
  v_pk_fma_f32 v[144:145], v[144:145], v[46:47], v[22:23] op_sel_hi:[1,0,1]
  v_pk_fma_f32 v[146:147], v[146:147], v[46:47], v[24:25] op_sel_hi:[1,0,1]
  v_pk_fma_f32 v[148:149], v[148:149], v[46:47], v[26:27] op_sel_hi:[1,0,1]
  v_pk_fma_f32 v[150:151], v[150:151], v[46:47], v[38:39] op_sel_hi:[1,0,1]
  v_pk_fma_f32 v[22:23], v[144:145], v[144:145], s[64:65] op_sel_hi:[1,1,0]
  v_pk_fma_f32 v[24:25], v[146:147], v[146:147], s[64:65] op_sel_hi:[1,1,0]
  v_pk_fma_f32 v[26:27], v[148:149], v[148:149], s[64:65] op_sel_hi:[1,1,0]
  v_pk_fma_f32 v[38:39], v[150:151], v[150:151], s[64:65] op_sel_hi:[1,1,0]
  v_pk_mul_f32 v[22:23], v[22:23], v[144:145] neg_lo:[0,1] neg_hi:[0,1]
  v_pk_mul_f32 v[24:25], v[24:25], v[146:147] neg_lo:[0,1] neg_hi:[0,1]
  v_pk_mul_f32 v[26:27], v[26:27], v[148:149] neg_lo:[0,1] neg_hi:[0,1]
  v_pk_mul_f32 v[38:39], v[38:39], v[150:151] neg_lo:[0,1] neg_hi:[0,1]
  v_exp_f32 v22, v22
  v_exp_f32 v23, v23
  v_exp_f32 v24, v24
  v_exp_f32 v25, v25
  v_exp_f32 v26, v26
  v_exp_f32 v27, v27
  v_exp_f32 v38, v38
  v_exp_f32 v39, v39
  v_pk_fma_f32 v[22:23], v[22:23], s[64:65], s[64:65] op_sel:[0,1,1] op_sel_hi:[1,1,1]
  v_pk_fma_f32 v[24:25], v[24:25], s[64:65], s[64:65] op_sel:[0,1,1] op_sel_hi:[1,1,1]
  v_pk_fma_f32 v[26:27], v[26:27], s[64:65], s[64:65] op_sel:[0,1,1] op_sel_hi:[1,1,1]
  v_pk_fma_f32 v[38:39], v[38:39], s[64:65], s[64:65] op_sel:[0,1,1] op_sel_hi:[1,1,1]
  v_rcp_f32 v22, v22
  v_rcp_f32 v23, v23
  v_rcp_f32 v24, v24
  v_rcp_f32 v25, v25
  v_rcp_f32 v26, v26
  v_rcp_f32 v27, v27
  v_rcp_f32 v38, v38
  v_rcp_f32 v39, v39
  v_pk_mul_f32 v[22:23], v[22:23], v[144:145]
  v_pk_mul_f32 v[24:25], v[24:25], v[146:147]
  v_pk_mul_f32 v[26:27], v[26:27], v[148:149]
  v_pk_mul_f32 v[38:39], v[38:39], v[150:151]
  v_cvt_pk_bf16_f32 v144, v22, v23
  v_cvt_pk_bf16_f32 v145, v24, v25
  v_cvt_pk_bf16_f32 v146, v26, v27
  v_cvt_pk_bf16_f32 v147, v38, v39
  s_mov_b32 s29, 445952
  buffer_store_dwordx4 v[144:147], v18, s[12:15], s29 offen sc1
  v_pk_fma_f32 v[22:23], v[56:57], v[48:49], v[8:9] op_sel:[0,1,0] op_sel_hi:[1,1,1] neg_lo:[0,1,0] neg_hi:[0,1,0]
  v_pk_fma_f32 v[24:25], v[58:59], v[48:49], v[10:11] op_sel:[0,1,0] op_sel_hi:[1,1,1] neg_lo:[0,1,0] neg_hi:[0,1,0]
  v_pk_fma_f32 v[26:27], v[60:61], v[48:49], v[12:13] op_sel:[0,1,0] op_sel_hi:[1,1,1] neg_lo:[0,1,0] neg_hi:[0,1,0]
  v_pk_fma_f32 v[38:39], v[62:63], v[48:49], v[14:15] op_sel:[0,1,0] op_sel_hi:[1,1,1] neg_lo:[0,1,0] neg_hi:[0,1,0]
  v_pk_fma_f32 v[168:169], v[168:169], v[48:49], v[22:23] op_sel_hi:[1,0,1]
  v_pk_fma_f32 v[170:171], v[170:171], v[48:49], v[24:25] op_sel_hi:[1,0,1]
  v_pk_fma_f32 v[172:173], v[172:173], v[48:49], v[26:27] op_sel_hi:[1,0,1]
  v_pk_fma_f32 v[174:175], v[174:175], v[48:49], v[38:39] op_sel_hi:[1,0,1]
  v_pk_fma_f32 v[22:23], v[168:169], v[168:169], s[64:65] op_sel_hi:[1,1,0]
  v_pk_fma_f32 v[24:25], v[170:171], v[170:171], s[64:65] op_sel_hi:[1,1,0]
  v_pk_fma_f32 v[26:27], v[172:173], v[172:173], s[64:65] op_sel_hi:[1,1,0]
  v_pk_fma_f32 v[38:39], v[174:175], v[174:175], s[64:65] op_sel_hi:[1,1,0]
  v_pk_mul_f32 v[22:23], v[22:23], v[168:169] neg_lo:[0,1] neg_hi:[0,1]
  v_pk_mul_f32 v[24:25], v[24:25], v[170:171] neg_lo:[0,1] neg_hi:[0,1]
  v_pk_mul_f32 v[26:27], v[26:27], v[172:173] neg_lo:[0,1] neg_hi:[0,1]
  v_pk_mul_f32 v[38:39], v[38:39], v[174:175] neg_lo:[0,1] neg_hi:[0,1]
  v_exp_f32 v22, v22
  v_exp_f32 v23, v23
  v_exp_f32 v24, v24
  v_exp_f32 v25, v25
  v_exp_f32 v26, v26
  v_exp_f32 v27, v27
  v_exp_f32 v38, v38
  v_exp_f32 v39, v39
  v_pk_fma_f32 v[22:23], v[22:23], s[64:65], s[64:65] op_sel:[0,1,1] op_sel_hi:[1,1,1]
  v_pk_fma_f32 v[24:25], v[24:25], s[64:65], s[64:65] op_sel:[0,1,1] op_sel_hi:[1,1,1]
  v_pk_fma_f32 v[26:27], v[26:27], s[64:65], s[64:65] op_sel:[0,1,1] op_sel_hi:[1,1,1]
  v_pk_fma_f32 v[38:39], v[38:39], s[64:65], s[64:65] op_sel:[0,1,1] op_sel_hi:[1,1,1]
  v_rcp_f32 v22, v22
  v_rcp_f32 v23, v23
  v_rcp_f32 v24, v24
  v_rcp_f32 v25, v25
  v_rcp_f32 v26, v26
  v_rcp_f32 v27, v27
  v_rcp_f32 v38, v38
  v_rcp_f32 v39, v39
  v_pk_mul_f32 v[22:23], v[22:23], v[168:169]
  v_pk_mul_f32 v[24:25], v[24:25], v[170:171]
  v_pk_mul_f32 v[26:27], v[26:27], v[172:173]
  v_pk_mul_f32 v[38:39], v[38:39], v[174:175]
  v_cvt_pk_bf16_f32 v168, v22, v23
  v_cvt_pk_bf16_f32 v169, v24, v25
  v_cvt_pk_bf16_f32 v170, v26, v27
  v_cvt_pk_bf16_f32 v171, v38, v39
  s_mov_b32 s29, 593920
  buffer_store_dwordx4 v[168:171], v18, s[12:15], s29 offen sc1
  v_pk_fma_f32 v[22:23], v[56:57], v[50:51], v[8:9] op_sel:[0,1,0] op_sel_hi:[1,1,1] neg_lo:[0,1,0] neg_hi:[0,1,0]
  v_pk_fma_f32 v[24:25], v[58:59], v[50:51], v[10:11] op_sel:[0,1,0] op_sel_hi:[1,1,1] neg_lo:[0,1,0] neg_hi:[0,1,0]
  v_pk_fma_f32 v[26:27], v[60:61], v[50:51], v[12:13] op_sel:[0,1,0] op_sel_hi:[1,1,1] neg_lo:[0,1,0] neg_hi:[0,1,0]
  v_pk_fma_f32 v[38:39], v[62:63], v[50:51], v[14:15] op_sel:[0,1,0] op_sel_hi:[1,1,1] neg_lo:[0,1,0] neg_hi:[0,1,0]
  v_pk_fma_f32 v[192:193], v[192:193], v[50:51], v[22:23] op_sel_hi:[1,0,1]
  v_pk_fma_f32 v[194:195], v[194:195], v[50:51], v[24:25] op_sel_hi:[1,0,1]
  v_pk_fma_f32 v[196:197], v[196:197], v[50:51], v[26:27] op_sel_hi:[1,0,1]
  v_pk_fma_f32 v[198:199], v[198:199], v[50:51], v[38:39] op_sel_hi:[1,0,1]
  v_pk_fma_f32 v[22:23], v[192:193], v[192:193], s[64:65] op_sel_hi:[1,1,0]
  v_pk_fma_f32 v[24:25], v[194:195], v[194:195], s[64:65] op_sel_hi:[1,1,0]
  v_pk_fma_f32 v[26:27], v[196:197], v[196:197], s[64:65] op_sel_hi:[1,1,0]
  v_pk_fma_f32 v[38:39], v[198:199], v[198:199], s[64:65] op_sel_hi:[1,1,0]
  v_pk_mul_f32 v[22:23], v[22:23], v[192:193] neg_lo:[0,1] neg_hi:[0,1]
  v_pk_mul_f32 v[24:25], v[24:25], v[194:195] neg_lo:[0,1] neg_hi:[0,1]
  v_pk_mul_f32 v[26:27], v[26:27], v[196:197] neg_lo:[0,1] neg_hi:[0,1]
  v_pk_mul_f32 v[38:39], v[38:39], v[198:199] neg_lo:[0,1] neg_hi:[0,1]
  v_exp_f32 v22, v22
  v_exp_f32 v23, v23
  v_exp_f32 v24, v24
  v_exp_f32 v25, v25
  v_exp_f32 v26, v26
  v_exp_f32 v27, v27
  v_exp_f32 v38, v38
  v_exp_f32 v39, v39
  v_pk_fma_f32 v[22:23], v[22:23], s[64:65], s[64:65] op_sel:[0,1,1] op_sel_hi:[1,1,1]
Lg_pad7:
  s_cbranch_execz Lg_pad11
  s_nop 0
  v_pk_fma_f32 v[24:25], v[24:25], s[64:65], s[64:65] op_sel:[0,1,1] op_sel_hi:[1,1,1]
  v_pk_fma_f32 v[26:27], v[26:27], s[64:65], s[64:65] op_sel:[0,1,1] op_sel_hi:[1,1,1]
  v_pk_fma_f32 v[38:39], v[38:39], s[64:65], s[64:65] op_sel:[0,1,1] op_sel_hi:[1,1,1]
  v_rcp_f32 v22, v22
  v_rcp_f32 v23, v23
  v_rcp_f32 v24, v24
  v_rcp_f32 v25, v25
  v_rcp_f32 v26, v26
  v_rcp_f32 v27, v27
  v_rcp_f32 v38, v38
  v_rcp_f32 v39, v39
  v_pk_mul_f32 v[22:23], v[22:23], v[192:193]
  v_pk_mul_f32 v[24:25], v[24:25], v[194:195]
  v_pk_mul_f32 v[26:27], v[26:27], v[196:197]
  v_pk_mul_f32 v[38:39], v[38:39], v[198:199]
  v_cvt_pk_bf16_f32 v192, v22, v23
  v_cvt_pk_bf16_f32 v193, v24, v25
  v_cvt_pk_bf16_f32 v194, v26, v27
  v_cvt_pk_bf16_f32 v195, v38, v39
  s_mov_b32 s29, 741888
  buffer_store_dwordx4 v[192:195], v18, s[12:15], s29 offen sc1
  v_pk_fma_f32 v[22:23], v[56:57], v[52:53], v[8:9] op_sel:[0,1,0] op_sel_hi:[1,1,1] neg_lo:[0,1,0] neg_hi:[0,1,0]
  v_pk_fma_f32 v[24:25], v[58:59], v[52:53], v[10:11] op_sel:[0,1,0] op_sel_hi:[1,1,1] neg_lo:[0,1,0] neg_hi:[0,1,0]
  v_pk_fma_f32 v[26:27], v[60:61], v[52:53], v[12:13] op_sel:[0,1,0] op_sel_hi:[1,1,1] neg_lo:[0,1,0] neg_hi:[0,1,0]
  v_pk_fma_f32 v[38:39], v[62:63], v[52:53], v[14:15] op_sel:[0,1,0] op_sel_hi:[1,1,1] neg_lo:[0,1,0] neg_hi:[0,1,0]
  v_pk_fma_f32 v[216:217], v[216:217], v[52:53], v[22:23] op_sel_hi:[1,0,1]
  v_pk_fma_f32 v[218:219], v[218:219], v[52:53], v[24:25] op_sel_hi:[1,0,1]
  v_pk_fma_f32 v[220:221], v[220:221], v[52:53], v[26:27] op_sel_hi:[1,0,1]
  v_pk_fma_f32 v[222:223], v[222:223], v[52:53], v[38:39] op_sel_hi:[1,0,1]
  v_pk_fma_f32 v[22:23], v[216:217], v[216:217], s[64:65] op_sel_hi:[1,1,0]
  v_pk_fma_f32 v[24:25], v[218:219], v[218:219], s[64:65] op_sel_hi:[1,1,0]
  v_pk_fma_f32 v[26:27], v[220:221], v[220:221], s[64:65] op_sel_hi:[1,1,0]
  v_pk_fma_f32 v[38:39], v[222:223], v[222:223], s[64:65] op_sel_hi:[1,1,0]
  v_pk_mul_f32 v[22:23], v[22:23], v[216:217] neg_lo:[0,1] neg_hi:[0,1]
  v_pk_mul_f32 v[24:25], v[24:25], v[218:219] neg_lo:[0,1] neg_hi:[0,1]
  v_pk_mul_f32 v[26:27], v[26:27], v[220:221] neg_lo:[0,1] neg_hi:[0,1]
  v_pk_mul_f32 v[38:39], v[38:39], v[222:223] neg_lo:[0,1] neg_hi:[0,1]
  v_exp_f32 v22, v22
  v_exp_f32 v23, v23
  v_exp_f32 v24, v24
  v_exp_f32 v25, v25
  v_exp_f32 v26, v26
  v_exp_f32 v27, v27
  v_exp_f32 v38, v38
  v_exp_f32 v39, v39
  v_pk_fma_f32 v[22:23], v[22:23], s[64:65], s[64:65] op_sel:[0,1,1] op_sel_hi:[1,1,1]
  v_pk_fma_f32 v[24:25], v[24:25], s[64:65], s[64:65] op_sel:[0,1,1] op_sel_hi:[1,1,1]
  v_pk_fma_f32 v[26:27], v[26:27], s[64:65], s[64:65] op_sel:[0,1,1] op_sel_hi:[1,1,1]
  v_pk_fma_f32 v[38:39], v[38:39], s[64:65], s[64:65] op_sel:[0,1,1] op_sel_hi:[1,1,1]
  v_rcp_f32 v22, v22
  v_rcp_f32 v23, v23
  v_rcp_f32 v24, v24
  v_rcp_f32 v25, v25
  v_rcp_f32 v26, v26
  v_rcp_f32 v27, v27
  v_rcp_f32 v38, v38
  v_rcp_f32 v39, v39
  v_pk_mul_f32 v[22:23], v[22:23], v[216:217]
  v_pk_mul_f32 v[24:25], v[24:25], v[218:219]
  v_pk_mul_f32 v[26:27], v[26:27], v[220:221]
  v_pk_mul_f32 v[38:39], v[38:39], v[222:223]
  v_cvt_pk_bf16_f32 v216, v22, v23
  v_cvt_pk_bf16_f32 v217, v24, v25
  v_cvt_pk_bf16_f32 v218, v26, v27
  v_cvt_pk_bf16_f32 v219, v38, v39
  s_mov_b32 s29, 889856
  buffer_store_dwordx4 v[216:219], v18, s[12:15], s29 offen sc1
  v_pk_fma_f32 v[22:23], v[56:57], v[54:55], v[8:9] op_sel:[0,1,0] op_sel_hi:[1,1,1] neg_lo:[0,1,0] neg_hi:[0,1,0]
  v_pk_fma_f32 v[24:25], v[58:59], v[54:55], v[10:11] op_sel:[0,1,0] op_sel_hi:[1,1,1] neg_lo:[0,1,0] neg_hi:[0,1,0]
  v_pk_fma_f32 v[26:27], v[60:61], v[54:55], v[12:13] op_sel:[0,1,0] op_sel_hi:[1,1,1] neg_lo:[0,1,0] neg_hi:[0,1,0]
  v_pk_fma_f32 v[38:39], v[62:63], v[54:55], v[14:15] op_sel:[0,1,0] op_sel_hi:[1,1,1] neg_lo:[0,1,0] neg_hi:[0,1,0]
  v_pk_fma_f32 v[240:241], v[240:241], v[54:55], v[22:23] op_sel_hi:[1,0,1]
  v_pk_fma_f32 v[242:243], v[242:243], v[54:55], v[24:25] op_sel_hi:[1,0,1]
  v_pk_fma_f32 v[244:245], v[244:245], v[54:55], v[26:27] op_sel_hi:[1,0,1]
  ds_read_b128 v[56:59], v31 offset:512
  ds_read_b128 v[8:11], v31 offset:1536
  v_pk_fma_f32 v[246:247], v[246:247], v[54:55], v[38:39] op_sel_hi:[1,0,1]
  ds_read_b128 v[60:63], v31 offset:576
  ds_read_b128 v[12:15], v31 offset:1600
  v_pk_fma_f32 v[22:23], v[240:241], v[240:241], s[64:65] op_sel_hi:[1,1,0]
  v_pk_fma_f32 v[24:25], v[242:243], v[242:243], s[64:65] op_sel_hi:[1,1,0]
  v_pk_fma_f32 v[26:27], v[244:245], v[244:245], s[64:65] op_sel_hi:[1,1,0]
  v_pk_fma_f32 v[38:39], v[246:247], v[246:247], s[64:65] op_sel_hi:[1,1,0]
  v_pk_mul_f32 v[22:23], v[22:23], v[240:241] neg_lo:[0,1] neg_hi:[0,1]
  v_pk_mul_f32 v[24:25], v[24:25], v[242:243] neg_lo:[0,1] neg_hi:[0,1]
  v_pk_mul_f32 v[26:27], v[26:27], v[244:245] neg_lo:[0,1] neg_hi:[0,1]
  v_pk_mul_f32 v[38:39], v[38:39], v[246:247] neg_lo:[0,1] neg_hi:[0,1]
  v_exp_f32 v22, v22
  v_exp_f32 v23, v23
  v_exp_f32 v24, v24
  v_exp_f32 v25, v25
  v_exp_f32 v26, v26
  v_exp_f32 v27, v27
  v_exp_f32 v38, v38
  v_exp_f32 v39, v39
  v_pk_fma_f32 v[22:23], v[22:23], s[64:65], s[64:65] op_sel:[0,1,1] op_sel_hi:[1,1,1]
  v_pk_fma_f32 v[24:25], v[24:25], s[64:65], s[64:65] op_sel:[0,1,1] op_sel_hi:[1,1,1]
  v_pk_fma_f32 v[26:27], v[26:27], s[64:65], s[64:65] op_sel:[0,1,1] op_sel_hi:[1,1,1]
  v_pk_fma_f32 v[38:39], v[38:39], s[64:65], s[64:65] op_sel:[0,1,1] op_sel_hi:[1,1,1]
  v_rcp_f32 v22, v22
  v_rcp_f32 v23, v23
  v_rcp_f32 v24, v24
  v_rcp_f32 v25, v25
  v_rcp_f32 v26, v26
  v_rcp_f32 v27, v27
  v_rcp_f32 v38, v38
  v_rcp_f32 v39, v39
  v_pk_mul_f32 v[22:23], v[22:23], v[240:241]
  v_pk_mul_f32 v[24:25], v[24:25], v[242:243]
  v_pk_mul_f32 v[26:27], v[26:27], v[244:245]
  v_pk_mul_f32 v[38:39], v[38:39], v[246:247]
  v_cvt_pk_bf16_f32 v240, v22, v23
  v_cvt_pk_bf16_f32 v241, v24, v25
  v_cvt_pk_bf16_f32 v242, v26, v27
  v_cvt_pk_bf16_f32 v243, v38, v39
  s_mov_b32 s29, 1037824
  buffer_store_dwordx4 v[240:243], v18, s[12:15], s29 offen sc1
  s_waitcnt lgkmcnt(0)
  v_bfe_u32 v244, v2, 2, 3
  v_and_b32 v245, 3, v2
  v_lshlrev_b32 v246, 11, v5
  v_lshl_add_u32 v246, v244, 7, v246
  v_lshl_add_u32 v246, v245, 3, v246
  v_lshrrev_b32 v244, 1, v244
  v_lshl_add_u32 v232, v244, 5, v246
  v_add_u32 v236, 0x10000, v232
  v_xor_b32 v237, 32, v236
  v_xor_b32 v238, 64, v236
  v_xor_b32 v239, 96, v236
  v_pk_fma_f32 v[22:23], v[56:57], v[40:41], v[8:9] op_sel:[0,1,0] op_sel_hi:[1,1,1] neg_lo:[0,1,0] neg_hi:[0,1,0]
  v_pk_fma_f32 v[24:25], v[58:59], v[40:41], v[10:11] op_sel:[0,1,0] op_sel_hi:[1,1,1] neg_lo:[0,1,0] neg_hi:[0,1,0]
  v_pk_fma_f32 v[26:27], v[60:61], v[40:41], v[12:13] op_sel:[0,1,0] op_sel_hi:[1,1,1] neg_lo:[0,1,0] neg_hi:[0,1,0]
  v_pk_fma_f32 v[38:39], v[62:63], v[40:41], v[14:15] op_sel:[0,1,0] op_sel_hi:[1,1,1] neg_lo:[0,1,0] neg_hi:[0,1,0]
  v_pk_fma_f32 v[80:81], v[80:81], v[40:41], v[22:23] op_sel_hi:[1,0,1]
  v_pk_fma_f32 v[82:83], v[82:83], v[40:41], v[24:25] op_sel_hi:[1,0,1]
  v_pk_fma_f32 v[84:85], v[84:85], v[40:41], v[26:27] op_sel_hi:[1,0,1]
  v_pk_fma_f32 v[86:87], v[86:87], v[40:41], v[38:39] op_sel_hi:[1,0,1]
  v_pk_fma_f32 v[22:23], v[80:81], v[80:81], s[64:65] op_sel_hi:[1,1,0]
  v_pk_fma_f32 v[24:25], v[82:83], v[82:83], s[64:65] op_sel_hi:[1,1,0]
  v_pk_fma_f32 v[26:27], v[84:85], v[84:85], s[64:65] op_sel_hi:[1,1,0]
  v_pk_fma_f32 v[38:39], v[86:87], v[86:87], s[64:65] op_sel_hi:[1,1,0]
  v_pk_mul_f32 v[22:23], v[22:23], v[80:81] neg_lo:[0,1] neg_hi:[0,1]
  v_pk_mul_f32 v[24:25], v[24:25], v[82:83] neg_lo:[0,1] neg_hi:[0,1]
  v_pk_mul_f32 v[26:27], v[26:27], v[84:85] neg_lo:[0,1] neg_hi:[0,1]
  v_pk_mul_f32 v[38:39], v[38:39], v[86:87] neg_lo:[0,1] neg_hi:[0,1]
  v_exp_f32 v22, v22
  v_exp_f32 v23, v23
  v_exp_f32 v24, v24
  v_exp_f32 v25, v25
  v_exp_f32 v26, v26
  buffer_load_dword v33, v20, s[16:19], s94 offen sc1
  v_exp_f32 v27, v27
  v_exp_f32 v38, v38
  v_exp_f32 v39, v39
  v_pk_fma_f32 v[22:23], v[22:23], s[64:65], s[64:65] op_sel:[0,1,1] op_sel_hi:[1,1,1]
  v_pk_fma_f32 v[24:25], v[24:25], s[64:65], s[64:65] op_sel:[0,1,1] op_sel_hi:[1,1,1]
  v_pk_fma_f32 v[26:27], v[26:27], s[64:65], s[64:65] op_sel:[0,1,1] op_sel_hi:[1,1,1]
  v_pk_fma_f32 v[38:39], v[38:39], s[64:65], s[64:65] op_sel:[0,1,1] op_sel_hi:[1,1,1]
  v_rcp_f32 v22, v22
  v_rcp_f32 v23, v23
  v_rcp_f32 v24, v24
  v_rcp_f32 v25, v25
  v_rcp_f32 v26, v26
  v_rcp_f32 v27, v27
  v_rcp_f32 v38, v38
  v_rcp_f32 v39, v39
  v_pk_mul_f32 v[22:23], v[22:23], v[80:81]
  v_pk_mul_f32 v[24:25], v[24:25], v[82:83]
  v_pk_mul_f32 v[26:27], v[26:27], v[84:85]
  v_pk_mul_f32 v[38:39], v[38:39], v[86:87]
  v_cvt_pk_bf16_f32 v80, v22, v23
  v_cvt_pk_bf16_f32 v81, v24, v25
  v_cvt_pk_bf16_f32 v82, v26, v27
  v_cvt_pk_bf16_f32 v83, v38, v39
  s_mov_b32 s29, 4096
  buffer_store_dwordx4 v[80:83], v18, s[12:15], s29 offen sc1
  v_pk_fma_f32 v[22:23], v[56:57], v[42:43], v[8:9] op_sel:[0,1,0] op_sel_hi:[1,1,1] neg_lo:[0,1,0] neg_hi:[0,1,0]
  v_pk_fma_f32 v[24:25], v[58:59], v[42:43], v[10:11] op_sel:[0,1,0] op_sel_hi:[1,1,1] neg_lo:[0,1,0] neg_hi:[0,1,0]
  v_pk_fma_f32 v[26:27], v[60:61], v[42:43], v[12:13] op_sel:[0,1,0] op_sel_hi:[1,1,1] neg_lo:[0,1,0] neg_hi:[0,1,0]
  v_pk_fma_f32 v[38:39], v[62:63], v[42:43], v[14:15] op_sel:[0,1,0] op_sel_hi:[1,1,1] neg_lo:[0,1,0] neg_hi:[0,1,0]
  v_pk_fma_f32 v[104:105], v[104:105], v[42:43], v[22:23] op_sel_hi:[1,0,1]
  v_pk_fma_f32 v[106:107], v[106:107], v[42:43], v[24:25] op_sel_hi:[1,0,1]
  v_pk_fma_f32 v[108:109], v[108:109], v[42:43], v[26:27] op_sel_hi:[1,0,1]
  v_pk_fma_f32 v[110:111], v[110:111], v[42:43], v[38:39] op_sel_hi:[1,0,1]
  v_pk_fma_f32 v[22:23], v[104:105], v[104:105], s[64:65] op_sel_hi:[1,1,0]
  v_pk_fma_f32 v[24:25], v[106:107], v[106:107], s[64:65] op_sel_hi:[1,1,0]
  v_pk_fma_f32 v[26:27], v[108:109], v[108:109], s[64:65] op_sel_hi:[1,1,0]
  v_pk_fma_f32 v[38:39], v[110:111], v[110:111], s[64:65] op_sel_hi:[1,1,0]
  v_pk_mul_f32 v[22:23], v[22:23], v[104:105] neg_lo:[0,1] neg_hi:[0,1]
  v_pk_mul_f32 v[24:25], v[24:25], v[106:107] neg_lo:[0,1] neg_hi:[0,1]
  v_pk_mul_f32 v[26:27], v[26:27], v[108:109] neg_lo:[0,1] neg_hi:[0,1]
  v_pk_mul_f32 v[38:39], v[38:39], v[110:111] neg_lo:[0,1] neg_hi:[0,1]
  v_exp_f32 v22, v22
  v_exp_f32 v23, v23
  v_exp_f32 v24, v24
  v_exp_f32 v25, v25
  v_exp_f32 v26, v26
  v_exp_f32 v27, v27
  v_exp_f32 v38, v38
  v_exp_f32 v39, v39
  v_pk_fma_f32 v[22:23], v[22:23], s[64:65], s[64:65] op_sel:[0,1,1] op_sel_hi:[1,1,1]
  v_pk_fma_f32 v[24:25], v[24:25], s[64:65], s[64:65] op_sel:[0,1,1] op_sel_hi:[1,1,1]
  v_pk_fma_f32 v[26:27], v[26:27], s[64:65], s[64:65] op_sel:[0,1,1] op_sel_hi:[1,1,1]
  v_pk_fma_f32 v[38:39], v[38:39], s[64:65], s[64:65] op_sel:[0,1,1] op_sel_hi:[1,1,1]
  v_rcp_f32 v22, v22
  v_rcp_f32 v23, v23
  v_rcp_f32 v24, v24
  v_rcp_f32 v25, v25
  v_rcp_f32 v26, v26
  v_rcp_f32 v27, v27
  v_rcp_f32 v38, v38
  v_rcp_f32 v39, v39
  v_pk_mul_f32 v[22:23], v[22:23], v[104:105]
  v_pk_mul_f32 v[24:25], v[24:25], v[106:107]
  v_pk_mul_f32 v[26:27], v[26:27], v[108:109]
  v_pk_mul_f32 v[38:39], v[38:39], v[110:111]
  v_cvt_pk_bf16_f32 v104, v22, v23
  v_cvt_pk_bf16_f32 v105, v24, v25
  v_cvt_pk_bf16_f32 v106, v26, v27
  v_cvt_pk_bf16_f32 v107, v38, v39
  s_mov_b32 s29, 152064
  buffer_store_dwordx4 v[104:107], v18, s[12:15], s29 offen sc1
  v_pk_fma_f32 v[22:23], v[56:57], v[44:45], v[8:9] op_sel:[0,1,0] op_sel_hi:[1,1,1] neg_lo:[0,1,0] neg_hi:[0,1,0]
  v_pk_fma_f32 v[24:25], v[58:59], v[44:45], v[10:11] op_sel:[0,1,0] op_sel_hi:[1,1,1] neg_lo:[0,1,0] neg_hi:[0,1,0]
  v_pk_fma_f32 v[26:27], v[60:61], v[44:45], v[12:13] op_sel:[0,1,0] op_sel_hi:[1,1,1] neg_lo:[0,1,0] neg_hi:[0,1,0]
  v_pk_fma_f32 v[38:39], v[62:63], v[44:45], v[14:15] op_sel:[0,1,0] op_sel_hi:[1,1,1] neg_lo:[0,1,0] neg_hi:[0,1,0]
  v_pk_fma_f32 v[128:129], v[128:129], v[44:45], v[22:23] op_sel_hi:[1,0,1]
  v_pk_fma_f32 v[130:131], v[130:131], v[44:45], v[24:25] op_sel_hi:[1,0,1]
  v_pk_fma_f32 v[132:133], v[132:133], v[44:45], v[26:27] op_sel_hi:[1,0,1]
  v_pk_fma_f32 v[134:135], v[134:135], v[44:45], v[38:39] op_sel_hi:[1,0,1]
  v_pk_fma_f32 v[22:23], v[128:129], v[128:129], s[64:65] op_sel_hi:[1,1,0]
  v_pk_fma_f32 v[24:25], v[130:131], v[130:131], s[64:65] op_sel_hi:[1,1,0]
  v_pk_fma_f32 v[26:27], v[132:133], v[132:133], s[64:65] op_sel_hi:[1,1,0]
  v_pk_fma_f32 v[38:39], v[134:135], v[134:135], s[64:65] op_sel_hi:[1,1,0]
  v_pk_mul_f32 v[22:23], v[22:23], v[128:129] neg_lo:[0,1] neg_hi:[0,1]
  v_pk_mul_f32 v[24:25], v[24:25], v[130:131] neg_lo:[0,1] neg_hi:[0,1]
  v_pk_mul_f32 v[26:27], v[26:27], v[132:133] neg_lo:[0,1] neg_hi:[0,1]
  v_pk_mul_f32 v[38:39], v[38:39], v[134:135] neg_lo:[0,1] neg_hi:[0,1]
  v_exp_f32 v22, v22
  v_exp_f32 v23, v23
  v_exp_f32 v24, v24
  v_exp_f32 v25, v25
  v_exp_f32 v26, v26
  v_exp_f32 v27, v27
  v_exp_f32 v38, v38
  v_exp_f32 v39, v39
  v_pk_fma_f32 v[22:23], v[22:23], s[64:65], s[64:65] op_sel:[0,1,1] op_sel_hi:[1,1,1]
  v_pk_fma_f32 v[24:25], v[24:25], s[64:65], s[64:65] op_sel:[0,1,1] op_sel_hi:[1,1,1]
  v_pk_fma_f32 v[26:27], v[26:27], s[64:65], s[64:65] op_sel:[0,1,1] op_sel_hi:[1,1,1]
  v_pk_fma_f32 v[38:39], v[38:39], s[64:65], s[64:65] op_sel:[0,1,1] op_sel_hi:[1,1,1]
  v_rcp_f32 v22, v22
  v_rcp_f32 v23, v23
  v_rcp_f32 v24, v24
  v_rcp_f32 v25, v25
  v_rcp_f32 v26, v26
  v_rcp_f32 v27, v27
  v_rcp_f32 v38, v38
  v_rcp_f32 v39, v39
  v_pk_mul_f32 v[22:23], v[22:23], v[128:129]
  v_pk_mul_f32 v[24:25], v[24:25], v[130:131]
  v_pk_mul_f32 v[26:27], v[26:27], v[132:133]
  v_pk_mul_f32 v[38:39], v[38:39], v[134:135]
  v_cvt_pk_bf16_f32 v128, v22, v23
  v_cvt_pk_bf16_f32 v129, v24, v25
  v_cvt_pk_bf16_f32 v130, v26, v27
  v_cvt_pk_bf16_f32 v131, v38, v39
  s_mov_b32 s29, 300032
  buffer_store_dwordx4 v[128:131], v18, s[12:15], s29 offen sc1
  v_pk_fma_f32 v[22:23], v[56:57], v[46:47], v[8:9] op_sel:[0,1,0] op_sel_hi:[1,1,1] neg_lo:[0,1,0] neg_hi:[0,1,0]
  v_pk_fma_f32 v[24:25], v[58:59], v[46:47], v[10:11] op_sel:[0,1,0] op_sel_hi:[1,1,1] neg_lo:[0,1,0] neg_hi:[0,1,0]
  v_pk_fma_f32 v[26:27], v[60:61], v[46:47], v[12:13] op_sel:[0,1,0] op_sel_hi:[1,1,1] neg_lo:[0,1,0] neg_hi:[0,1,0]
  v_pk_fma_f32 v[38:39], v[62:63], v[46:47], v[14:15] op_sel:[0,1,0] op_sel_hi:[1,1,1] neg_lo:[0,1,0] neg_hi:[0,1,0]
  v_pk_fma_f32 v[152:153], v[152:153], v[46:47], v[22:23] op_sel_hi:[1,0,1]
  s_waitcnt vmcnt(3)
  s_mov_b64 exec, 2
  buffer_store_dword v35, v29, s[16:19], 0 offen sc1
  s_mov_b64 exec, -1
  v_cmp_eq_u32 vcc, 0, v33
  s_cbranch_vccnz Lg_f1_slow
  s_nop 0
Lg_f1_back:
  v_pk_fma_f32 v[154:155], v[154:155], v[46:47], v[24:25] op_sel_hi:[1,0,1]
  v_pk_fma_f32 v[156:157], v[156:157], v[46:47], v[26:27] op_sel_hi:[1,0,1]
  v_pk_fma_f32 v[158:159], v[158:159], v[46:47], v[38:39] op_sel_hi:[1,0,1]
  v_pk_fma_f32 v[22:23], v[152:153], v[152:153], s[64:65] op_sel_hi:[1,1,0]
  v_pk_fma_f32 v[24:25], v[154:155], v[154:155], s[64:65] op_sel_hi:[1,1,0]
  v_pk_fma_f32 v[26:27], v[156:157], v[156:157], s[64:65] op_sel_hi:[1,1,0]
  s_mul_i32 s80, s88, 6144
  s_mul_i32 s30, s93, 24576
  s_add_u32 s80, s80, s30
  s_nop 0
  s_add_u32 s30, s80, 32768
  v_pk_fma_f32 v[38:39], v[158:159], v[158:159], s[64:65] op_sel_hi:[1,1,0]
  buffer_load_dwordx4 a[64:67], v16, s[4:7], s30 offen offset:0 sc1
  v_pk_mul_f32 v[22:23], v[22:23], v[152:153] neg_lo:[0,1] neg_hi:[0,1]
  v_pk_mul_f32 v[24:25], v[24:25], v[154:155] neg_lo:[0,1] neg_hi:[0,1]
  v_pk_mul_f32 v[26:27], v[26:27], v[156:157] neg_lo:[0,1] neg_hi:[0,1]
  v_pk_mul_f32 v[38:39], v[38:39], v[158:159] neg_lo:[0,1] neg_hi:[0,1]
  v_exp_f32 v22, v22
  v_exp_f32 v23, v23
  v_exp_f32 v24, v24
  v_exp_f32 v25, v25
  v_exp_f32 v26, v26
  v_exp_f32 v27, v27
  v_exp_f32 v38, v38
  v_exp_f32 v39, v39
  v_pk_fma_f32 v[22:23], v[22:23], s[64:65], s[64:65] op_sel:[0,1,1] op_sel_hi:[1,1,1]
  v_pk_fma_f32 v[24:25], v[24:25], s[64:65], s[64:65] op_sel:[0,1,1] op_sel_hi:[1,1,1]
  v_pk_fma_f32 v[26:27], v[26:27], s[64:65], s[64:65] op_sel:[0,1,1] op_sel_hi:[1,1,1]
  buffer_load_dwordx4 a[80:83], v16, s[4:7], s30 offen offset:1024 sc1
  v_pk_fma_f32 v[38:39], v[38:39], s[64:65], s[64:65] op_sel:[0,1,1] op_sel_hi:[1,1,1]
  v_rcp_f32 v22, v22
  v_rcp_f32 v23, v23
  v_rcp_f32 v24, v24
  v_rcp_f32 v25, v25
  v_rcp_f32 v26, v26
  v_rcp_f32 v27, v27
  v_rcp_f32 v38, v38
  v_rcp_f32 v39, v39
  v_pk_mul_f32 v[22:23], v[22:23], v[152:153]
  v_pk_mul_f32 v[24:25], v[24:25], v[154:155]
  v_pk_mul_f32 v[26:27], v[26:27], v[156:157]
  v_pk_mul_f32 v[38:39], v[38:39], v[158:159]
  v_cvt_pk_bf16_f32 v152, v22, v23
  v_cvt_pk_bf16_f32 v153, v24, v25
  v_cvt_pk_bf16_f32 v154, v26, v27
  v_cvt_pk_bf16_f32 v155, v38, v39
  s_mov_b32 s29, 448000
  buffer_store_dwordx4 v[152:155], v18, s[12:15], s29 offen sc1
  v_pk_fma_f32 v[22:23], v[56:57], v[48:49], v[8:9] op_sel:[0,1,0] op_sel_hi:[1,1,1] neg_lo:[0,1,0] neg_hi:[0,1,0]
  v_pk_fma_f32 v[24:25], v[58:59], v[48:49], v[10:11] op_sel:[0,1,0] op_sel_hi:[1,1,1] neg_lo:[0,1,0] neg_hi:[0,1,0]
  v_pk_fma_f32 v[26:27], v[60:61], v[48:49], v[12:13] op_sel:[0,1,0] op_sel_hi:[1,1,1] neg_lo:[0,1,0] neg_hi:[0,1,0]
  v_pk_fma_f32 v[38:39], v[62:63], v[48:49], v[14:15] op_sel:[0,1,0] op_sel_hi:[1,1,1] neg_lo:[0,1,0] neg_hi:[0,1,0]
  v_pk_fma_f32 v[176:177], v[176:177], v[48:49], v[22:23] op_sel_hi:[1,0,1]
  v_pk_fma_f32 v[178:179], v[178:179], v[48:49], v[24:25] op_sel_hi:[1,0,1]
  v_pk_fma_f32 v[180:181], v[180:181], v[48:49], v[26:27] op_sel_hi:[1,0,1]
  v_pk_fma_f32 v[182:183], v[182:183], v[48:49], v[38:39] op_sel_hi:[1,0,1]
  v_pk_fma_f32 v[22:23], v[176:177], v[176:177], s[64:65] op_sel_hi:[1,1,0]
  v_pk_fma_f32 v[24:25], v[178:179], v[178:179], s[64:65] op_sel_hi:[1,1,0]
  v_pk_fma_f32 v[26:27], v[180:181], v[180:181], s[64:65] op_sel_hi:[1,1,0]
  v_pk_fma_f32 v[38:39], v[182:183], v[182:183], s[64:65] op_sel_hi:[1,1,0]
  buffer_load_dwordx4 a[72:75], v7, s[4:7], s30 offen offset:0 sc1
  v_pk_mul_f32 v[22:23], v[22:23], v[176:177] neg_lo:[0,1] neg_hi:[0,1]
  v_pk_mul_f32 v[24:25], v[24:25], v[178:179] neg_lo:[0,1] neg_hi:[0,1]
  v_pk_mul_f32 v[26:27], v[26:27], v[180:181] neg_lo:[0,1] neg_hi:[0,1]
  v_pk_mul_f32 v[38:39], v[38:39], v[182:183] neg_lo:[0,1] neg_hi:[0,1]
  v_exp_f32 v22, v22
  v_exp_f32 v23, v23
  v_exp_f32 v24, v24
  v_exp_f32 v25, v25
  v_exp_f32 v26, v26
  v_exp_f32 v27, v27
  v_exp_f32 v38, v38
  v_exp_f32 v39, v39
  v_pk_fma_f32 v[22:23], v[22:23], s[64:65], s[64:65] op_sel:[0,1,1] op_sel_hi:[1,1,1]
  v_pk_fma_f32 v[24:25], v[24:25], s[64:65], s[64:65] op_sel:[0,1,1] op_sel_hi:[1,1,1]
  v_pk_fma_f32 v[26:27], v[26:27], s[64:65], s[64:65] op_sel:[0,1,1] op_sel_hi:[1,1,1]
  buffer_load_dwordx4 a[88:91], v7, s[4:7], s30 offen offset:1024 sc1
  v_pk_fma_f32 v[38:39], v[38:39], s[64:65], s[64:65] op_sel:[0,1,1] op_sel_hi:[1,1,1]
  v_rcp_f32 v22, v22
  v_rcp_f32 v23, v23
  v_rcp_f32 v24, v24
  v_rcp_f32 v25, v25
  v_rcp_f32 v26, v26
  v_rcp_f32 v27, v27
  v_rcp_f32 v38, v38
  v_rcp_f32 v39, v39
  v_pk_mul_f32 v[22:23], v[22:23], v[176:177]
  v_pk_mul_f32 v[24:25], v[24:25], v[178:179]
  v_pk_mul_f32 v[26:27], v[26:27], v[180:181]
  v_pk_mul_f32 v[38:39], v[38:39], v[182:183]
  v_cvt_pk_bf16_f32 v176, v22, v23
  v_cvt_pk_bf16_f32 v177, v24, v25
  v_cvt_pk_bf16_f32 v178, v26, v27
  v_cvt_pk_bf16_f32 v179, v38, v39
  s_mov_b32 s29, 595968
  buffer_store_dwordx4 v[176:179], v18, s[12:15], s29 offen sc1
  v_pk_fma_f32 v[22:23], v[56:57], v[50:51], v[8:9] op_sel:[0,1,0] op_sel_hi:[1,1,1] neg_lo:[0,1,0] neg_hi:[0,1,0]
  v_pk_fma_f32 v[24:25], v[58:59], v[50:51], v[10:11] op_sel:[0,1,0] op_sel_hi:[1,1,1] neg_lo:[0,1,0] neg_hi:[0,1,0]
  v_pk_fma_f32 v[26:27], v[60:61], v[50:51], v[12:13] op_sel:[0,1,0] op_sel_hi:[1,1,1] neg_lo:[0,1,0] neg_hi:[0,1,0]
  v_pk_fma_f32 v[38:39], v[62:63], v[50:51], v[14:15] op_sel:[0,1,0] op_sel_hi:[1,1,1] neg_lo:[0,1,0] neg_hi:[0,1,0]
  v_pk_fma_f32 v[200:201], v[200:201], v[50:51], v[22:23] op_sel_hi:[1,0,1]
  v_pk_fma_f32 v[202:203], v[202:203], v[50:51], v[24:25] op_sel_hi:[1,0,1]
  v_pk_fma_f32 v[204:205], v[204:205], v[50:51], v[26:27] op_sel_hi:[1,0,1]
  v_pk_fma_f32 v[206:207], v[206:207], v[50:51], v[38:39] op_sel_hi:[1,0,1]
  v_pk_fma_f32 v[22:23], v[200:201], v[200:201], s[64:65] op_sel_hi:[1,1,0]
  v_pk_fma_f32 v[24:25], v[202:203], v[202:203], s[64:65] op_sel_hi:[1,1,0]
  v_pk_fma_f32 v[26:27], v[204:205], v[204:205], s[64:65] op_sel_hi:[1,1,0]
  s_add_u32 s30, s80, 180736
  v_pk_fma_f32 v[38:39], v[206:207], v[206:207], s[64:65] op_sel_hi:[1,1,0]
  buffer_load_dwordx4 a[68:71], v16, s[4:7], s30 offen offset:0 sc1
  v_pk_mul_f32 v[22:23], v[22:23], v[200:201] neg_lo:[0,1] neg_hi:[0,1]
  v_pk_mul_f32 v[24:25], v[24:25], v[202:203] neg_lo:[0,1] neg_hi:[0,1]
  v_pk_mul_f32 v[26:27], v[26:27], v[204:205] neg_lo:[0,1] neg_hi:[0,1]
  v_pk_mul_f32 v[38:39], v[38:39], v[206:207] neg_lo:[0,1] neg_hi:[0,1]
  v_exp_f32 v22, v22
  v_exp_f32 v23, v23
  v_exp_f32 v24, v24
  v_exp_f32 v25, v25
  v_exp_f32 v26, v26
  v_exp_f32 v27, v27
  v_exp_f32 v38, v38
  v_exp_f32 v39, v39
  v_pk_fma_f32 v[22:23], v[22:23], s[64:65], s[64:65] op_sel:[0,1,1] op_sel_hi:[1,1,1]
  v_pk_fma_f32 v[24:25], v[24:25], s[64:65], s[64:65] op_sel:[0,1,1] op_sel_hi:[1,1,1]
  v_pk_fma_f32 v[26:27], v[26:27], s[64:65], s[64:65] op_sel:[0,1,1] op_sel_hi:[1,1,1]
  buffer_load_dwordx4 a[84:87], v16, s[4:7], s30 offen offset:1024 sc1
  v_pk_fma_f32 v[38:39], v[38:39], s[64:65], s[64:65] op_sel:[0,1,1] op_sel_hi:[1,1,1]
  v_rcp_f32 v22, v22
  v_rcp_f32 v23, v23
  v_rcp_f32 v24, v24
  v_rcp_f32 v25, v25
  v_rcp_f32 v26, v26
  v_rcp_f32 v27, v27
  v_rcp_f32 v38, v38
  v_rcp_f32 v39, v39
  v_pk_mul_f32 v[22:23], v[22:23], v[200:201]
  v_pk_mul_f32 v[24:25], v[24:25], v[202:203]
  v_pk_mul_f32 v[26:27], v[26:27], v[204:205]
  v_pk_mul_f32 v[38:39], v[38:39], v[206:207]
  v_cvt_pk_bf16_f32 v200, v22, v23
  v_cvt_pk_bf16_f32 v201, v24, v25
  v_cvt_pk_bf16_f32 v202, v26, v27
  v_cvt_pk_bf16_f32 v203, v38, v39
  s_mov_b32 s29, 743936
  buffer_store_dwordx4 v[200:203], v18, s[12:15], s29 offen sc1
  v_pk_fma_f32 v[22:23], v[56:57], v[52:53], v[8:9] op_sel:[0,1,0] op_sel_hi:[1,1,1] neg_lo:[0,1,0] neg_hi:[0,1,0]
  v_pk_fma_f32 v[24:25], v[58:59], v[52:53], v[10:11] op_sel:[0,1,0] op_sel_hi:[1,1,1] neg_lo:[0,1,0] neg_hi:[0,1,0]
  v_pk_fma_f32 v[26:27], v[60:61], v[52:53], v[12:13] op_sel:[0,1,0] op_sel_hi:[1,1,1] neg_lo:[0,1,0] neg_hi:[0,1,0]
  s_mov_b32 s29, 160256
  v_lshl_add_u32 v32, v3, 4, s29
  v_pk_fma_f32 v[38:39], v[62:63], v[52:53], v[14:15] op_sel:[0,1,0] op_sel_hi:[1,1,1] neg_lo:[0,1,0] neg_hi:[0,1,0]
  v_pk_fma_f32 v[224:225], v[224:225], v[52:53], v[22:23] op_sel_hi:[1,0,1]
  v_pk_fma_f32 v[226:227], v[226:227], v[52:53], v[24:25] op_sel_hi:[1,0,1]
  ds_read_b128 v[96:99], v32 offset:0
  v_pk_fma_f32 v[228:229], v[228:229], v[52:53], v[26:27] op_sel_hi:[1,0,1]
  v_pk_fma_f32 v[230:231], v[230:231], v[52:53], v[38:39] op_sel_hi:[1,0,1]
  v_pk_fma_f32 v[22:23], v[224:225], v[224:225], s[64:65] op_sel_hi:[1,1,0]
  ds_read_b128 v[100:103], v32 offset:64
  v_pk_fma_f32 v[24:25], v[226:227], v[226:227], s[64:65] op_sel_hi:[1,1,0]
  v_pk_fma_f32 v[26:27], v[228:229], v[228:229], s[64:65] op_sel_hi:[1,1,0]
  v_pk_fma_f32 v[38:39], v[230:231], v[230:231], s[64:65] op_sel_hi:[1,1,0]
  buffer_load_dwordx4 a[76:79], v7, s[4:7], s30 offen offset:0 sc1
  ds_read_b128 v[104:107], v32 offset:128
  v_pk_mul_f32 v[22:23], v[22:23], v[224:225] neg_lo:[0,1] neg_hi:[0,1]
  v_pk_mul_f32 v[24:25], v[24:25], v[226:227] neg_lo:[0,1] neg_hi:[0,1]
  v_pk_mul_f32 v[26:27], v[26:27], v[228:229] neg_lo:[0,1] neg_hi:[0,1]
  ds_read_b128 v[108:111], v32 offset:192
  v_pk_mul_f32 v[38:39], v[38:39], v[230:231] neg_lo:[0,1] neg_hi:[0,1]
  v_exp_f32 v22, v22
  v_exp_f32 v23, v23
  ds_read_b128 v[112:115], v32 offset:256
  v_exp_f32 v24, v24
  v_exp_f32 v25, v25
  v_exp_f32 v26, v26
  ds_read_b128 v[116:119], v32 offset:320
  v_exp_f32 v27, v27
  v_exp_f32 v38, v38
  v_exp_f32 v39, v39
  ds_read_b128 v[120:123], v32 offset:384
  v_pk_fma_f32 v[22:23], v[22:23], s[64:65], s[64:65] op_sel:[0,1,1] op_sel_hi:[1,1,1]
  v_pk_fma_f32 v[24:25], v[24:25], s[64:65], s[64:65] op_sel:[0,1,1] op_sel_hi:[1,1,1]
  v_pk_fma_f32 v[26:27], v[26:27], s[64:65], s[64:65] op_sel:[0,1,1] op_sel_hi:[1,1,1]
  buffer_load_dwordx4 a[92:95], v7, s[4:7], s30 offen offset:1024 sc1
  ds_read_b128 v[124:127], v32 offset:448
  v_pk_fma_f32 v[38:39], v[38:39], s[64:65], s[64:65] op_sel:[0,1,1] op_sel_hi:[1,1,1]
  v_rcp_f32 v22, v22
  v_rcp_f32 v23, v23
  v_rcp_f32 v24, v24
  v_rcp_f32 v25, v25
  v_rcp_f32 v26, v26
  v_rcp_f32 v27, v27
  v_rcp_f32 v38, v38
  v_rcp_f32 v39, v39
  v_pk_mul_f32 v[22:23], v[22:23], v[224:225]
  v_pk_mul_f32 v[24:25], v[24:25], v[226:227]
  v_pk_mul_f32 v[26:27], v[26:27], v[228:229]
  v_pk_mul_f32 v[38:39], v[38:39], v[230:231]
  v_cvt_pk_bf16_f32 v224, v22, v23
  v_cvt_pk_bf16_f32 v225, v24, v25
  v_cvt_pk_bf16_f32 v226, v26, v27
  v_cvt_pk_bf16_f32 v227, v38, v39
  s_mov_b32 s29, 891904
  buffer_store_dwordx4 v[224:227], v18, s[12:15], s29 offen sc1
  v_pk_fma_f32 v[22:23], v[56:57], v[54:55], v[8:9] op_sel:[0,1,0] op_sel_hi:[1,1,1] neg_lo:[0,1,0] neg_hi:[0,1,0]
  v_pk_fma_f32 v[24:25], v[58:59], v[54:55], v[10:11] op_sel:[0,1,0] op_sel_hi:[1,1,1] neg_lo:[0,1,0] neg_hi:[0,1,0]
  v_pk_fma_f32 v[26:27], v[60:61], v[54:55], v[12:13] op_sel:[0,1,0] op_sel_hi:[1,1,1] neg_lo:[0,1,0] neg_hi:[0,1,0]
  s_barrier
  s_nop 0
  v_pk_fma_f32 v[38:39], v[62:63], v[54:55], v[14:15] op_sel:[0,1,0] op_sel_hi:[1,1,1] neg_lo:[0,1,0] neg_hi:[0,1,0]
  v_pk_fma_f32 v[248:249], v[248:249], v[54:55], v[22:23] op_sel_hi:[1,0,1]
  ds_read_b64_tr_b16 a[0:1], v236 offset:32768
  v_pk_fma_f32 v[250:251], v[250:251], v[54:55], v[24:25] op_sel_hi:[1,0,1]
  v_pk_fma_f32 v[252:253], v[252:253], v[54:55], v[26:27] op_sel_hi:[1,0,1]
  ds_read_b64_tr_b16 a[2:3], v236 offset:36864
  v_pk_fma_f32 v[254:255], v[254:255], v[54:55], v[38:39] op_sel_hi:[1,0,1]
  v_pk_fma_f32 v[22:23], v[248:249], v[248:249], s[64:65] op_sel_hi:[1,1,0]
  ds_read_b64_tr_b16 a[4:5], v236 offset:40960
  v_pk_fma_f32 v[24:25], v[250:251], v[250:251], s[64:65] op_sel_hi:[1,1,0]
  v_pk_fma_f32 v[26:27], v[252:253], v[252:253], s[64:65] op_sel_hi:[1,1,0]
  ds_read_b64_tr_b16 a[6:7], v236 offset:45056
  v_pk_fma_f32 v[38:39], v[254:255], v[254:255], s[64:65] op_sel_hi:[1,1,0]
  v_pk_mul_f32 v[22:23], v[22:23], v[248:249] neg_lo:[0,1] neg_hi:[0,1]
  v_pk_mul_f32 v[24:25], v[24:25], v[250:251] neg_lo:[0,1] neg_hi:[0,1]
  ds_read_b64_tr_b16 a[8:9], v237 offset:32768
  v_pk_mul_f32 v[26:27], v[26:27], v[252:253] neg_lo:[0,1] neg_hi:[0,1]
  v_pk_mul_f32 v[38:39], v[38:39], v[254:255] neg_lo:[0,1] neg_hi:[0,1]
  ds_read_b64_tr_b16 a[10:11], v237 offset:36864
  v_exp_f32 v22, v22
  v_exp_f32 v23, v23
  ds_read_b64_tr_b16 a[12:13], v237 offset:40960
  v_exp_f32 v24, v24
  v_exp_f32 v25, v25
  ds_read_b64_tr_b16 a[14:15], v237 offset:45056
  v_exp_f32 v26, v26
  v_exp_f32 v27, v27
  v_exp_f32 v38, v38
  ds_read_b64_tr_b16 a[16:17], v238 offset:32768
  v_exp_f32 v39, v39
  v_pk_fma_f32 v[22:23], v[22:23], s[64:65], s[64:65] op_sel:[0,1,1] op_sel_hi:[1,1,1]
  ds_read_b64_tr_b16 a[18:19], v238 offset:36864
  v_pk_fma_f32 v[24:25], v[24:25], s[64:65], s[64:65] op_sel:[0,1,1] op_sel_hi:[1,1,1]
  v_pk_fma_f32 v[26:27], v[26:27], s[64:65], s[64:65] op_sel:[0,1,1] op_sel_hi:[1,1,1]
  ds_read_b64_tr_b16 a[20:21], v238 offset:40960
  v_pk_fma_f32 v[38:39], v[38:39], s[64:65], s[64:65] op_sel:[0,1,1] op_sel_hi:[1,1,1]
  v_rcp_f32 v22, v22
  ds_read_b64_tr_b16 a[22:23], v238 offset:45056
  v_rcp_f32 v23, v23
  v_rcp_f32 v24, v24
  v_rcp_f32 v25, v25
  ds_read_b64_tr_b16 a[24:25], v239 offset:32768
  v_rcp_f32 v26, v26
  v_rcp_f32 v27, v27
  ds_read_b64_tr_b16 a[26:27], v239 offset:36864
  v_rcp_f32 v38, v38
  v_rcp_f32 v39, v39
  ds_read_b64_tr_b16 a[28:29], v239 offset:40960
  v_pk_mul_f32 v[22:23], v[22:23], v[248:249]
  v_pk_mul_f32 v[24:25], v[24:25], v[250:251]
  ds_read_b64_tr_b16 a[30:31], v239 offset:45056
  v_pk_mul_f32 v[26:27], v[26:27], v[252:253]
  v_pk_mul_f32 v[38:39], v[38:39], v[254:255]
  v_cvt_pk_bf16_f32 v248, v22, v23
  v_cvt_pk_bf16_f32 v249, v24, v25
  v_cvt_pk_bf16_f32 v250, v26, v27
  v_cvt_pk_bf16_f32 v251, v38, v39
  s_mov_b32 s29, 1039872
  buffer_store_dwordx4 v[248:251], v18, s[12:15], s29 offen sc1
  s_waitcnt vmcnt(2) lgkmcnt(0)
Lg_g2:
  v_mfma_f32_16x16x32_bf16 v[64:67], a[0:3], a[64:67], v[96:99]
  ds_read_b64_tr_b16 a[32:33], v236 offset:33792
  s_mul_i32 s81, s89, 6144
  s_mul_i32 s30, s93, 24576
  s_add_u32 s81, s81, s30
  s_add_u32 s30, s81, 38912
  v_mfma_f32_16x16x32_bf16 v[64:67], a[4:7], a[80:83], v[64:67]
  buffer_load_dwordx4 a[96:99], v16, s[4:7], s30 offen offset:0 sc1
  v_mfma_f32_16x16x32_bf16 v[96:99], a[4:7], a[84:87], v[96:99]
  ds_read_b64_tr_b16 a[34:35], v236 offset:37888
  v_mfma_f32_16x16x32_bf16 v[96:99], a[0:3], a[68:71], v[96:99]
  v_add_u32 v240, 0x10000, v236
  v_mfma_f32_16x16x32_bf16 v[128:131], a[0:3], a[72:75], 0
  ds_read_b64_tr_b16 a[36:37], v236 offset:41984
  v_mfma_f32_16x16x32_bf16 v[128:131], a[4:7], a[88:91], v[128:131]
  buffer_load_dwordx4 a[112:115], v16, s[4:7], s30 offen offset:1024 sc1
  v_mfma_f32_16x16x32_bf16 v[160:163], a[4:7], a[92:95], 0
  ds_read_b64_tr_b16 a[38:39], v236 offset:46080
  v_add_u32 v241, 0x10000, v237
  v_mfma_f32_16x16x32_bf16 v[160:163], a[0:3], a[76:79], v[160:163]
  v_mfma_f32_16x16x32_bf16 v[68:71], a[8:11], a[64:67], v[100:103]
  ds_read_b64_tr_b16 a[40:41], v237 offset:33792
  v_mfma_f32_16x16x32_bf16 v[68:71], a[12:15], a[80:83], v[68:71]
  buffer_load_dwordx4 a[104:107], v7, s[4:7], s30 offen offset:0 sc1
  v_mfma_f32_16x16x32_bf16 v[100:103], a[12:15], a[84:87], v[100:103]
  ds_read_b64_tr_b16 a[42:43], v237 offset:37888
  v_add_u32 v242, 0x10000, v238
  v_mfma_f32_16x16x32_bf16 v[100:103], a[8:11], a[68:71], v[100:103]
  v_mfma_f32_16x16x32_bf16 v[132:135], a[8:11], a[72:75], 0
  ds_read_b64_tr_b16 a[44:45], v237 offset:41984
  v_mfma_f32_16x16x32_bf16 v[132:135], a[12:15], a[88:91], v[132:135]
  v_add_u32 v243, 0x10000, v239
  buffer_load_dwordx4 a[120:123], v7, s[4:7], s30 offen offset:1024 sc1
  v_mfma_f32_16x16x32_bf16 v[164:167], a[12:15], a[92:95], 0
  ds_read_b64_tr_b16 a[46:47], v237 offset:46080
  v_mfma_f32_16x16x32_bf16 v[164:167], a[8:11], a[76:79], v[164:167]
  s_waitcnt lgkmcnt(8)
  v_mfma_f32_16x16x32_bf16 v[72:75], a[16:19], a[64:67], v[104:107]
  ds_read_b64_tr_b16 a[48:49], v238 offset:33792
  s_add_u32 s30, s81, 186880
  v_mfma_f32_16x16x32_bf16 v[72:75], a[20:23], a[80:83], v[72:75]
  v_xor_b32 v233, 32, v232
  buffer_load_dwordx4 a[100:103], v16, s[4:7], s30 offen offset:0 sc1
  v_mfma_f32_16x16x32_bf16 v[104:107], a[20:23], a[84:87], v[104:107]
  ds_read_b64_tr_b16 a[50:51], v238 offset:37888
  v_mfma_f32_16x16x32_bf16 v[104:107], a[16:19], a[68:71], v[104:107]
  v_mfma_f32_16x16x32_bf16 v[136:139], a[16:19], a[72:75], 0
  ds_read_b64_tr_b16 a[52:53], v238 offset:41984
  v_xor_b32_e64 v234, 64, v232
  v_mfma_f32_16x16x32_bf16 v[136:139], a[20:23], a[88:91], v[136:139]
  buffer_load_dwordx4 a[116:119], v16, s[4:7], s30 offen offset:1024 sc1
  v_mfma_f32_16x16x32_bf16 v[168:171], a[20:23], a[92:95], 0
  ds_read_b64_tr_b16 a[54:55], v238 offset:46080
  v_mfma_f32_16x16x32_bf16 v[168:171], a[16:19], a[76:79], v[168:171]
  v_mfma_f32_16x16x32_bf16 v[76:79], a[24:27], a[64:67], v[108:111]
  ds_read_b64_tr_b16 a[56:57], v239 offset:33792
  v_xor_b32 v235, 96, v232
Lg_pad8:
  s_cbranch_execz Lg_pad12
  s_nop 0
  v_mfma_f32_16x16x32_bf16 v[76:79], a[28:31], a[80:83], v[76:79]
  buffer_load_dwordx4 a[108:111], v7, s[4:7], s30 offen offset:0 sc1
  v_mfma_f32_16x16x32_bf16 v[108:111], a[28:31], a[84:87], v[108:111]
  ds_read_b64_tr_b16 a[58:59], v239 offset:37888
  v_mfma_f32_16x16x32_bf16 v[108:111], a[24:27], a[68:71], v[108:111]
  v_mfma_f32_16x16x32_bf16 v[140:143], a[24:27], a[72:75], 0
  ds_read_b64_tr_b16 a[60:61], v239 offset:41984
  v_mfma_f32_16x16x32_bf16 v[140:143], a[28:31], a[88:91], v[140:143]
  buffer_load_dwordx4 a[124:127], v7, s[4:7], s30 offen offset:1024 sc1
  v_mfma_f32_16x16x32_bf16 v[172:175], a[28:31], a[92:95], 0
  ds_read_b64_tr_b16 a[62:63], v239 offset:46080
  v_mfma_f32_16x16x32_bf16 v[172:175], a[24:27], a[76:79], v[172:175]
  s_waitcnt lgkmcnt(8)
  s_barrier
  v_mfma_f32_16x16x32_bf16 v[80:83], a[32:35], a[64:67], v[112:115]
  ds_read_b64_tr_b16 a[0:1], v236 offset:49152
  buffer_load_dword v33, v20, s[16:19], s32 offen sc1
  s_add_u32 s30, s80, 45056
  v_mfma_f32_16x16x32_bf16 v[80:83], a[36:39], a[80:83], v[80:83]
  buffer_load_dwordx4 a[128:131], v16, s[4:7], s30 offen offset:0 sc1
  v_mfma_f32_16x16x32_bf16 v[112:115], a[36:39], a[84:87], v[112:115]
  ds_read_b64_tr_b16 a[2:3], v236 offset:53248
  v_mfma_f32_16x16x32_bf16 v[112:115], a[32:35], a[68:71], v[112:115]
  v_mfma_f32_16x16x32_bf16 v[144:147], a[32:35], a[72:75], 0
  ds_read_b64_tr_b16 a[4:5], v236 offset:57344
  v_mfma_f32_16x16x32_bf16 v[144:147], a[36:39], a[88:91], v[144:147]
  buffer_load_dwordx4 a[144:147], v16, s[4:7], s30 offen offset:1024 sc1
  v_mfma_f32_16x16x32_bf16 v[176:179], a[36:39], a[92:95], 0
  ds_read_b64_tr_b16 a[6:7], v236 offset:61440
  v_mfma_f32_16x16x32_bf16 v[176:179], a[32:35], a[76:79], v[176:179]
  v_mfma_f32_16x16x32_bf16 v[84:87], a[40:43], a[64:67], v[116:119]
  ds_read_b64_tr_b16 a[8:9], v237 offset:49152
  v_mfma_f32_16x16x32_bf16 v[84:87], a[44:47], a[80:83], v[84:87]
  buffer_load_dwordx4 a[136:139], v7, s[4:7], s30 offen offset:0 sc1
  v_mfma_f32_16x16x32_bf16 v[116:119], a[44:47], a[84:87], v[116:119]
  ds_read_b64_tr_b16 a[10:11], v237 offset:53248
  v_mfma_f32_16x16x32_bf16 v[116:119], a[40:43], a[68:71], v[116:119]
  v_mfma_f32_16x16x32_bf16 v[148:151], a[40:43], a[72:75], 0
  ds_read_b64_tr_b16 a[12:13], v237 offset:57344
  v_mfma_f32_16x16x32_bf16 v[148:151], a[44:47], a[88:91], v[148:151]
  v_mfma_f32_16x16x32_bf16 v[180:183], a[44:47], a[92:95], 0
  ds_read_b64_tr_b16 a[14:15], v237 offset:61440
  v_mfma_f32_16x16x32_bf16 v[180:183], a[40:43], a[76:79], v[180:183]
  s_waitcnt lgkmcnt(8)
  v_mfma_f32_16x16x32_bf16 v[88:91], a[48:51], a[64:67], v[120:123]
  ds_read_b64_tr_b16 a[16:17], v238 offset:49152
  v_mfma_f32_16x16x32_bf16 v[88:91], a[52:55], a[80:83], v[88:91]
  buffer_load_dwordx4 a[152:155], v7, s[4:7], s30 offen offset:1024 sc1
  v_mfma_f32_16x16x32_bf16 v[120:123], a[52:55], a[84:87], v[120:123]
  ds_read_b64_tr_b16 a[18:19], v238 offset:53248
  v_mfma_f32_16x16x32_bf16 v[120:123], a[48:51], a[68:71], v[120:123]
  v_mfma_f32_16x16x32_bf16 v[152:155], a[48:51], a[72:75], 0
  ds_read_b64_tr_b16 a[20:21], v238 offset:57344
  s_add_u32 s30, s80, 193024
  v_mfma_f32_16x16x32_bf16 v[152:155], a[52:55], a[88:91], v[152:155]
  buffer_load_dwordx4 a[132:135], v16, s[4:7], s30 offen offset:0 sc1
  v_mfma_f32_16x16x32_bf16 v[184:187], a[52:55], a[92:95], 0
  ds_read_b64_tr_b16 a[22:23], v238 offset:61440
  v_mfma_f32_16x16x32_bf16 v[184:187], a[48:51], a[76:79], v[184:187]
  v_mfma_f32_16x16x32_bf16 v[92:95], a[56:59], a[64:67], v[124:127]
  ds_read_b64_tr_b16 a[24:25], v239 offset:49152
  v_mfma_f32_16x16x32_bf16 v[92:95], a[60:63], a[80:83], v[92:95]
  buffer_load_dwordx4 a[148:151], v16, s[4:7], s30 offen offset:1024 sc1
  v_mfma_f32_16x16x32_bf16 v[124:127], a[60:63], a[84:87], v[124:127]
  ds_read_b64_tr_b16 a[26:27], v239 offset:53248
  v_mfma_f32_16x16x32_bf16 v[124:127], a[56:59], a[68:71], v[124:127]
  v_mfma_f32_16x16x32_bf16 v[156:159], a[56:59], a[72:75], 0
  ds_read_b64_tr_b16 a[28:29], v239 offset:57344
  v_mfma_f32_16x16x32_bf16 v[156:159], a[60:63], a[88:91], v[156:159]
  v_mfma_f32_16x16x32_bf16 v[188:191], a[60:63], a[92:95], 0
  ds_read_b64_tr_b16 a[30:31], v239 offset:61440
  v_mfma_f32_16x16x32_bf16 v[188:191], a[56:59], a[76:79], v[188:191]
  s_waitcnt vmcnt(7) lgkmcnt(8)
  v_mfma_f32_16x16x32_bf16 v[64:67], a[0:3], a[96:99], v[64:67]
  ds_read_b64_tr_b16 a[32:33], v236 offset:50176
  v_mfma_f32_16x16x32_bf16 v[64:67], a[4:7], a[112:115], v[64:67]
  buffer_load_dwordx4 a[140:143], v7, s[4:7], s30 offen offset:0 sc1
  v_mfma_f32_16x16x32_bf16 v[96:99], a[4:7], a[116:119], v[96:99]
  ds_read_b64_tr_b16 a[34:35], v236 offset:54272
  v_mfma_f32_16x16x32_bf16 v[96:99], a[0:3], a[100:103], v[96:99]
  v_mfma_f32_16x16x32_bf16 v[128:131], a[0:3], a[104:107], v[128:131]
  ds_read_b64_tr_b16 a[36:37], v236 offset:58368
  v_mfma_f32_16x16x32_bf16 v[128:131], a[4:7], a[120:123], v[128:131]
  buffer_load_dwordx4 a[156:159], v7, s[4:7], s30 offen offset:1024 sc1
  v_mfma_f32_16x16x32_bf16 v[160:163], a[4:7], a[124:127], v[160:163]
  ds_read_b64_tr_b16 a[38:39], v236 offset:62464
  v_mfma_f32_16x16x32_bf16 v[160:163], a[0:3], a[108:111], v[160:163]
  v_mfma_f32_16x16x32_bf16 v[164:167], a[8:11], a[108:111], v[164:167]
  ds_read_b64_tr_b16 a[40:41], v237 offset:50176
  s_add_u32 s30, s81, 51200
  v_mfma_f32_16x16x32_bf16 v[164:167], a[12:15], a[124:127], v[164:167]
  buffer_load_dwordx4 a[160:163], v16, s[4:7], s30 offen offset:0 sc1
  v_mfma_f32_16x16x32_bf16 v[132:135], a[12:15], a[120:123], v[132:135]
  ds_read_b64_tr_b16 a[42:43], v237 offset:54272
  v_mfma_f32_16x16x32_bf16 v[132:135], a[8:11], a[104:107], v[132:135]
  v_mfma_f32_16x16x32_bf16 v[100:103], a[8:11], a[100:103], v[100:103]
  ds_read_b64_tr_b16 a[44:45], v237 offset:58368
  v_mfma_f32_16x16x32_bf16 v[100:103], a[12:15], a[116:119], v[100:103]
  v_mfma_f32_16x16x32_bf16 v[68:71], a[12:15], a[112:115], v[68:71]
  ds_read_b64_tr_b16 a[46:47], v237 offset:62464
  v_mfma_f32_16x16x32_bf16 v[68:71], a[8:11], a[96:99], v[68:71]
  s_waitcnt lgkmcnt(8)
  v_mfma_f32_16x16x32_bf16 v[72:75], a[16:19], a[96:99], v[72:75]
  ds_read_b64_tr_b16 a[48:49], v238 offset:50176
  v_mfma_f32_16x16x32_bf16 v[72:75], a[20:23], a[112:115], v[72:75]
  buffer_load_dwordx4 a[176:179], v16, s[4:7], s30 offen offset:1024 sc1
  v_mfma_f32_16x16x32_bf16 v[104:107], a[20:23], a[116:119], v[104:107]
  ds_read_b64_tr_b16 a[50:51], v238 offset:54272
  v_mfma_f32_16x16x32_bf16 v[104:107], a[16:19], a[100:103], v[104:107]
  v_mfma_f32_16x16x32_bf16 v[136:139], a[16:19], a[104:107], v[136:139]
  ds_read_b64_tr_b16 a[52:53], v238 offset:58368
  v_mfma_f32_16x16x32_bf16 v[136:139], a[20:23], a[120:123], v[136:139]
  buffer_load_dwordx4 a[168:171], v7, s[4:7], s30 offen offset:0 sc1
  v_mfma_f32_16x16x32_bf16 v[168:171], a[20:23], a[124:127], v[168:171]
  ds_read_b64_tr_b16 a[54:55], v238 offset:62464
  v_mfma_f32_16x16x32_bf16 v[168:171], a[16:19], a[108:111], v[168:171]
  v_mfma_f32_16x16x32_bf16 v[172:175], a[24:27], a[108:111], v[172:175]
  ds_read_b64_tr_b16 a[56:57], v239 offset:50176
  v_mfma_f32_16x16x32_bf16 v[172:175], a[28:31], a[124:127], v[172:175]
  buffer_load_dwordx4 a[184:187], v7, s[4:7], s30 offen offset:1024 sc1
  v_mfma_f32_16x16x32_bf16 v[140:143], a[28:31], a[120:123], v[140:143]
  ds_read_b64_tr_b16 a[58:59], v239 offset:54272
  v_mfma_f32_16x16x32_bf16 v[140:143], a[24:27], a[104:107], v[140:143]
  v_mfma_f32_16x16x32_bf16 v[108:111], a[24:27], a[100:103], v[108:111]
  ds_read_b64_tr_b16 a[60:61], v239 offset:58368
  v_mfma_f32_16x16x32_bf16 v[108:111], a[28:31], a[116:119], v[108:111]
  v_mfma_f32_16x16x32_bf16 v[76:79], a[28:31], a[112:115], v[76:79]
  ds_read_b64_tr_b16 a[62:63], v239 offset:62464
  v_mfma_f32_16x16x32_bf16 v[76:79], a[24:27], a[96:99], v[76:79]
  s_waitcnt vmcnt(12) lgkmcnt(8)
  v_mfma_f32_16x16x32_bf16 v[80:83], a[32:35], a[96:99], v[80:83]
  ds_read_b64_tr_b16 a[0:1], v240 offset:0
  v_cmp_eq_u32 vcc, 0, v33
  s_cbranch_vccnz Lg_g2_slow
Lg_g2_back:
  s_mov_b64 exec, 4
  buffer_store_dword v35, v29, s[16:19], 0 offen sc1
  s_mov_b64 exec, -1
  s_add_u32 s30, s81, 199168
  v_mfma_f32_16x16x32_bf16 v[80:83], a[36:39], a[112:115], v[80:83]
  buffer_load_dwordx4 a[164:167], v16, s[4:7], s30 offen offset:0 sc1
  v_mfma_f32_16x16x32_bf16 v[112:115], a[36:39], a[116:119], v[112:115]
  ds_read_b64_tr_b16 a[2:3], v240 offset:4096
  v_mfma_f32_16x16x32_bf16 v[112:115], a[32:35], a[100:103], v[112:115]
  v_mfma_f32_16x16x32_bf16 v[144:147], a[32:35], a[104:107], v[144:147]
  ds_read_b64_tr_b16 a[4:5], v240 offset:8192
  v_mfma_f32_16x16x32_bf16 v[144:147], a[36:39], a[120:123], v[144:147]
  buffer_load_dwordx4 a[180:183], v16, s[4:7], s30 offen offset:1024 sc1
  v_mfma_f32_16x16x32_bf16 v[176:179], a[36:39], a[124:127], v[176:179]
  ds_read_b64_tr_b16 a[6:7], v240 offset:12288
  v_mfma_f32_16x16x32_bf16 v[176:179], a[32:35], a[108:111], v[176:179]
  v_mfma_f32_16x16x32_bf16 v[180:183], a[40:43], a[108:111], v[180:183]
  ds_read_b64_tr_b16 a[8:9], v241 offset:0
  v_mfma_f32_16x16x32_bf16 v[180:183], a[44:47], a[124:127], v[180:183]
  buffer_load_dwordx4 a[172:175], v7, s[4:7], s30 offen offset:0 sc1
  v_mfma_f32_16x16x32_bf16 v[148:151], a[44:47], a[120:123], v[148:151]
  ds_read_b64_tr_b16 a[10:11], v241 offset:4096
  v_mfma_f32_16x16x32_bf16 v[148:151], a[40:43], a[104:107], v[148:151]
  v_mfma_f32_16x16x32_bf16 v[116:119], a[40:43], a[100:103], v[116:119]
  ds_read_b64_tr_b16 a[12:13], v241 offset:8192
  v_mfma_f32_16x16x32_bf16 v[116:119], a[44:47], a[116:119], v[116:119]
  v_mfma_f32_16x16x32_bf16 v[84:87], a[44:47], a[112:115], v[84:87]
  ds_read_b64_tr_b16 a[14:15], v241 offset:12288
  v_mfma_f32_16x16x32_bf16 v[84:87], a[40:43], a[96:99], v[84:87]
  s_waitcnt lgkmcnt(8)
  v_mfma_f32_16x16x32_bf16 v[88:91], a[48:51], a[96:99], v[88:91]
  ds_read_b64_tr_b16 a[16:17], v242 offset:0
  v_mfma_f32_16x16x32_bf16 v[88:91], a[52:55], a[112:115], v[88:91]
  buffer_load_dwordx4 a[188:191], v7, s[4:7], s30 offen offset:1024 sc1
  v_mfma_f32_16x16x32_bf16 v[120:123], a[52:55], a[116:119], v[120:123]
  ds_read_b64_tr_b16 a[18:19], v242 offset:4096
  v_mfma_f32_16x16x32_bf16 v[120:123], a[48:51], a[100:103], v[120:123]
  v_mfma_f32_16x16x32_bf16 v[152:155], a[48:51], a[104:107], v[152:155]
  ds_read_b64_tr_b16 a[20:21], v242 offset:8192
  s_add_u32 s30, s80, 34816
  v_mfma_f32_16x16x32_bf16 v[152:155], a[52:55], a[120:123], v[152:155]
  buffer_load_dwordx4 a[64:67], v16, s[4:7], s30 offen offset:0 sc1
  v_mfma_f32_16x16x32_bf16 v[184:187], a[52:55], a[124:127], v[184:187]
  ds_read_b64_tr_b16 a[22:23], v242 offset:12288
  v_mfma_f32_16x16x32_bf16 v[184:187], a[48:51], a[108:111], v[184:187]
  v_mfma_f32_16x16x32_bf16 v[188:191], a[56:59], a[108:111], v[188:191]
  ds_read_b64_tr_b16 a[24:25], v243 offset:0
  v_mfma_f32_16x16x32_bf16 v[188:191], a[60:63], a[124:127], v[188:191]
  buffer_load_dwordx4 a[80:83], v16, s[4:7], s30 offen offset:1024 sc1
  v_mfma_f32_16x16x32_bf16 v[156:159], a[60:63], a[120:123], v[156:159]
  ds_read_b64_tr_b16 a[26:27], v243 offset:4096
  v_mfma_f32_16x16x32_bf16 v[156:159], a[56:59], a[104:107], v[156:159]
  v_mfma_f32_16x16x32_bf16 v[124:127], a[56:59], a[100:103], v[124:127]
  ds_read_b64_tr_b16 a[28:29], v243 offset:8192
  v_mfma_f32_16x16x32_bf16 v[124:127], a[60:63], a[116:119], v[124:127]
  v_mfma_f32_16x16x32_bf16 v[92:95], a[60:63], a[112:115], v[92:95]
  ds_read_b64_tr_b16 a[30:31], v243 offset:12288
  v_mfma_f32_16x16x32_bf16 v[92:95], a[56:59], a[96:99], v[92:95]
  s_waitcnt vmcnt(11) lgkmcnt(8)
  v_mfma_f32_16x16x32_bf16 v[64:67], a[0:3], a[128:131], v[64:67]
  ds_read_b64_tr_b16 a[32:33], v240 offset:1024
  v_mfma_f32_16x16x32_bf16 v[64:67], a[4:7], a[144:147], v[64:67]
  buffer_load_dwordx4 a[72:75], v7, s[4:7], s30 offen offset:0 sc1
  v_mfma_f32_16x16x32_bf16 v[96:99], a[4:7], a[148:151], v[96:99]
  ds_read_b64_tr_b16 a[34:35], v240 offset:5120
  v_mfma_f32_16x16x32_bf16 v[96:99], a[0:3], a[132:135], v[96:99]
  v_mfma_f32_16x16x32_bf16 v[128:131], a[0:3], a[136:139], v[128:131]
  ds_read_b64_tr_b16 a[36:37], v240 offset:9216
  v_mfma_f32_16x16x32_bf16 v[128:131], a[4:7], a[152:155], v[128:131]
  buffer_load_dwordx4 a[88:91], v7, s[4:7], s30 offen offset:1024 sc1
  v_mfma_f32_16x16x32_bf16 v[160:163], a[4:7], a[156:159], v[160:163]
  ds_read_b64_tr_b16 a[38:39], v240 offset:13312
  v_mfma_f32_16x16x32_bf16 v[160:163], a[0:3], a[140:143], v[160:163]
  v_mfma_f32_16x16x32_bf16 v[164:167], a[8:11], a[140:143], v[164:167]
  ds_read_b64_tr_b16 a[40:41], v241 offset:1024
  s_add_u32 s30, s80, 182784
  v_mfma_f32_16x16x32_bf16 v[164:167], a[12:15], a[156:159], v[164:167]
  buffer_load_dwordx4 a[68:71], v16, s[4:7], s30 offen offset:0 sc1
  v_mfma_f32_16x16x32_bf16 v[132:135], a[12:15], a[152:155], v[132:135]
  ds_read_b64_tr_b16 a[42:43], v241 offset:5120
  v_mfma_f32_16x16x32_bf16 v[132:135], a[8:11], a[136:139], v[132:135]
  v_mfma_f32_16x16x32_bf16 v[100:103], a[8:11], a[132:135], v[100:103]
  ds_read_b64_tr_b16 a[44:45], v241 offset:9216
  v_mfma_f32_16x16x32_bf16 v[100:103], a[12:15], a[148:151], v[100:103]
  v_mfma_f32_16x16x32_bf16 v[68:71], a[12:15], a[144:147], v[68:71]
  ds_read_b64_tr_b16 a[46:47], v241 offset:13312
  v_mfma_f32_16x16x32_bf16 v[68:71], a[8:11], a[128:131], v[68:71]
  s_waitcnt lgkmcnt(8)
  v_mfma_f32_16x16x32_bf16 v[72:75], a[16:19], a[128:131], v[72:75]
  ds_read_b64_tr_b16 a[48:49], v242 offset:1024
  v_mfma_f32_16x16x32_bf16 v[72:75], a[20:23], a[144:147], v[72:75]
  buffer_load_dwordx4 a[84:87], v16, s[4:7], s30 offen offset:1024 sc1
  v_mfma_f32_16x16x32_bf16 v[104:107], a[20:23], a[148:151], v[104:107]
  ds_read_b64_tr_b16 a[50:51], v242 offset:5120
  v_mfma_f32_16x16x32_bf16 v[104:107], a[16:19], a[132:135], v[104:107]
  v_mfma_f32_16x16x32_bf16 v[136:139], a[16:19], a[136:139], v[136:139]
  ds_read_b64_tr_b16 a[52:53], v242 offset:9216
  v_mfma_f32_16x16x32_bf16 v[136:139], a[20:23], a[152:155], v[136:139]
  buffer_load_dwordx4 a[76:79], v7, s[4:7], s30 offen offset:0 sc1
  v_mfma_f32_16x16x32_bf16 v[168:171], a[20:23], a[156:159], v[168:171]
  ds_read_b64_tr_b16 a[54:55], v242 offset:13312
  v_mfma_f32_16x16x32_bf16 v[168:171], a[16:19], a[140:143], v[168:171]
  v_mfma_f32_16x16x32_bf16 v[172:175], a[24:27], a[140:143], v[172:175]
  ds_read_b64_tr_b16 a[56:57], v243 offset:1024
  v_mfma_f32_16x16x32_bf16 v[172:175], a[28:31], a[156:159], v[172:175]
  buffer_load_dwordx4 a[92:95], v7, s[4:7], s30 offen offset:1024 sc1
  v_mfma_f32_16x16x32_bf16 v[140:143], a[28:31], a[152:155], v[140:143]
  ds_read_b64_tr_b16 a[58:59], v243 offset:5120
  v_mfma_f32_16x16x32_bf16 v[140:143], a[24:27], a[136:139], v[140:143]
  v_mfma_f32_16x16x32_bf16 v[108:111], a[24:27], a[132:135], v[108:111]
  ds_read_b64_tr_b16 a[60:61], v243 offset:9216
  v_mfma_f32_16x16x32_bf16 v[108:111], a[28:31], a[148:151], v[108:111]
  v_mfma_f32_16x16x32_bf16 v[76:79], a[28:31], a[144:147], v[76:79]
  ds_read_b64_tr_b16 a[62:63], v243 offset:13312
  v_mfma_f32_16x16x32_bf16 v[76:79], a[24:27], a[128:131], v[76:79]
  s_waitcnt lgkmcnt(8)
  s_barrier
  v_mfma_f32_16x16x32_bf16 v[80:83], a[32:35], a[128:131], v[80:83]
  ds_read_b64_tr_b16 a[0:1], v232 offset:0
  s_add_u32 s30, s81, 40960
  v_mfma_f32_16x16x32_bf16 v[80:83], a[36:39], a[144:147], v[80:83]
  buffer_load_dwordx4 a[96:99], v16, s[4:7], s30 offen offset:0 sc1
  v_mfma_f32_16x16x32_bf16 v[112:115], a[36:39], a[148:151], v[112:115]
  ds_read_b64_tr_b16 a[2:3], v232 offset:4096
  s_mul_i32 s29, s37, 9216
  s_add_u32 s29, s29, 5242880
  v_lshl_add_u32 v12, v2, 4, s29
  v_mfma_f32_16x16x32_bf16 v[112:115], a[32:35], a[132:135], v[112:115]
  v_mfma_f32_16x16x32_bf16 v[144:147], a[32:35], a[136:139], v[144:147]
  ds_read_b64_tr_b16 a[4:5], v232 offset:8192
  v_mfma_f32_16x16x32_bf16 v[144:147], a[36:39], a[152:155], v[144:147]
  buffer_load_dwordx4 a[112:115], v16, s[4:7], s30 offen offset:1024 sc1
  v_mfma_f32_16x16x32_bf16 v[176:179], a[36:39], a[156:159], v[176:179]
  ds_read_b64_tr_b16 a[6:7], v232 offset:12288
  s_xor_b32 s29, s37, 8
  s_mul_i32 s29, s29, 9216
  v_mfma_f32_16x16x32_bf16 v[176:179], a[32:35], a[140:143], v[176:179]
  v_mfma_f32_16x16x32_bf16 v[180:183], a[40:43], a[140:143], v[180:183]
  ds_read_b64_tr_b16 a[8:9], v233 offset:0
  v_mfma_f32_16x16x32_bf16 v[180:183], a[44:47], a[156:159], v[180:183]
  buffer_load_dwordx4 a[104:107], v7, s[4:7], s30 offen offset:0 sc1
  v_mfma_f32_16x16x32_bf16 v[148:151], a[44:47], a[152:155], v[148:151]
  ds_read_b64_tr_b16 a[10:11], v233 offset:4096
  v_mfma_f32_16x16x32_bf16 v[148:151], a[40:43], a[136:139], v[148:151]
  s_add_u32 s29, s29, 5242880
  v_lshl_add_u32 v13, v2, 4, s29
  v_mfma_f32_16x16x32_bf16 v[116:119], a[40:43], a[132:135], v[116:119]
  ds_read_b64_tr_b16 a[12:13], v233 offset:8192
  v_mfma_f32_16x16x32_bf16 v[116:119], a[44:47], a[148:151], v[116:119]
  v_mfma_f32_16x16x32_bf16 v[84:87], a[44:47], a[144:147], v[84:87]
  ds_read_b64_tr_b16 a[14:15], v233 offset:12288
  v_mfma_f32_16x16x32_bf16 v[84:87], a[40:43], a[128:131], v[84:87]
  s_waitcnt lgkmcnt(8)
  v_mfma_f32_16x16x32_bf16 v[88:91], a[48:51], a[128:131], v[88:91]
  ds_read_b64_tr_b16 a[16:17], v234 offset:0
  s_lshr_b32 s29, s2, 1
  s_lshl_b32 s29, s29, 2
  s_add_u32 s29, s29, s20
  v_mfma_f32_16x16x32_bf16 v[88:91], a[52:55], a[144:147], v[88:91]
  buffer_load_dwordx4 a[120:123], v7, s[4:7], s30 offen offset:1024 sc1
  v_mfma_f32_16x16x32_bf16 v[120:123], a[52:55], a[148:151], v[120:123]
  ds_read_b64_tr_b16 a[18:19], v234 offset:4096
  v_mfma_f32_16x16x32_bf16 v[120:123], a[48:51], a[132:135], v[120:123]
  v_mfma_f32_16x16x32_bf16 v[152:155], a[48:51], a[136:139], v[152:155]
  ds_read_b64_tr_b16 a[20:21], v234 offset:8192
  s_mul_i32 s29, s29, 9216
  v_lshl_add_u32 v18, v2, 4, s29
  s_add_u32 s30, s81, 188928
  v_mfma_f32_16x16x32_bf16 v[152:155], a[52:55], a[152:155], v[152:155]
  buffer_load_dwordx4 a[100:103], v16, s[4:7], s30 offen offset:0 sc1
  v_mfma_f32_16x16x32_bf16 v[184:187], a[52:55], a[156:159], v[184:187]
  ds_read_b64_tr_b16 a[22:23], v234 offset:12288
  v_mfma_f32_16x16x32_bf16 v[184:187], a[48:51], a[140:143], v[184:187]
  v_mfma_f32_16x16x32_bf16 v[188:191], a[56:59], a[140:143], v[188:191]
  ds_read_b64_tr_b16 a[24:25], v235 offset:0
  v_mfma_f32_16x16x32_bf16 v[188:191], a[60:63], a[156:159], v[188:191]
  s_xor_b32 s29, s99, 256
  v_mov_b32_e64 v34, s29
  buffer_load_dwordx4 a[116:119], v16, s[4:7], s30 offen offset:1024 sc1
  v_mfma_f32_16x16x32_bf16 v[156:159], a[60:63], a[152:155], v[156:159]
  ds_read_b64_tr_b16 a[26:27], v235 offset:4096
  v_mfma_f32_16x16x32_bf16 v[156:159], a[56:59], a[136:139], v[156:159]
  v_mfma_f32_16x16x32_bf16 v[124:127], a[56:59], a[132:135], v[124:127]
  ds_read_b64_tr_b16 a[28:29], v235 offset:8192
  v_mfma_f32_16x16x32_bf16 v[124:127], a[60:63], a[148:151], v[124:127]
  v_mfma_f32_16x16x32_bf16 v[92:95], a[60:63], a[144:147], v[92:95]
  ds_read_b64_tr_b16 a[30:31], v235 offset:12288
  v_mfma_f32_16x16x32_bf16 v[92:95], a[56:59], a[128:131], v[92:95]
  s_waitcnt vmcnt(14) lgkmcnt(8)
  v_mfma_f32_16x16x32_bf16 v[64:67], a[0:3], a[160:163], v[64:67]
  ds_read_b64_tr_b16 a[32:33], v232 offset:1024
  v_mfma_f32_16x16x32_bf16 v[64:67], a[4:7], a[176:179], v[64:67]
  buffer_load_dwordx4 a[108:111], v7, s[4:7], s30 offen offset:0 sc1
  v_mfma_f32_16x16x32_bf16 v[96:99], a[4:7], a[180:183], v[96:99]
  ds_read_b64_tr_b16 a[34:35], v232 offset:5120
  v_mfma_f32_16x16x32_bf16 v[96:99], a[0:3], a[164:167], v[96:99]
  v_mfma_f32_16x16x32_bf16 v[128:131], a[0:3], a[168:171], v[128:131]
  ds_read_b64_tr_b16 a[36:37], v232 offset:9216
  v_mfma_f32_16x16x32_bf16 v[128:131], a[4:7], a[184:187], v[128:131]
  buffer_load_dwordx4 a[124:127], v7, s[4:7], s30 offen offset:1024 sc1
  v_mfma_f32_16x16x32_bf16 v[160:163], a[4:7], a[188:191], v[160:163]
  ds_read_b64_tr_b16 a[38:39], v232 offset:13312
  v_mfma_f32_16x16x32_bf16 v[160:163], a[0:3], a[172:175], v[160:163]
  v_mfma_f32_16x16x32_bf16 v[164:167], a[8:11], a[172:175], v[164:167]
  ds_read_b64_tr_b16 a[40:41], v233 offset:1024
  s_add_u32 s30, s80, 47104
  v_mfma_f32_16x16x32_bf16 v[164:167], a[12:15], a[188:191], v[164:167]
  buffer_load_dwordx4 a[128:131], v16, s[4:7], s30 offen offset:0 sc1
  v_mfma_f32_16x16x32_bf16 v[132:135], a[12:15], a[184:187], v[132:135]
  ds_read_b64_tr_b16 a[42:43], v233 offset:5120
  v_mfma_f32_16x16x32_bf16 v[132:135], a[8:11], a[168:171], v[132:135]
  v_mfma_f32_16x16x32_bf16 v[100:103], a[8:11], a[164:167], v[100:103]
  ds_read_b64_tr_b16 a[44:45], v233 offset:9216
  v_mfma_f32_16x16x32_bf16 v[100:103], a[12:15], a[180:183], v[100:103]
  v_mfma_f32_16x16x32_bf16 v[68:71], a[12:15], a[176:179], v[68:71]
  ds_read_b64_tr_b16 a[46:47], v233 offset:13312
  v_mfma_f32_16x16x32_bf16 v[68:71], a[8:11], a[160:163], v[68:71]
  s_waitcnt lgkmcnt(8)
  v_mfma_f32_16x16x32_bf16 v[72:75], a[16:19], a[160:163], v[72:75]
  ds_read_b64_tr_b16 a[48:49], v234 offset:1024
  v_mfma_f32_16x16x32_bf16 v[72:75], a[20:23], a[176:179], v[72:75]
  buffer_load_dwordx4 a[144:147], v16, s[4:7], s30 offen offset:1024 sc1
  v_mfma_f32_16x16x32_bf16 v[104:107], a[20:23], a[180:183], v[104:107]
  ds_read_b64_tr_b16 a[50:51], v234 offset:5120
  v_mfma_f32_16x16x32_bf16 v[104:107], a[16:19], a[164:167], v[104:107]
  v_mfma_f32_16x16x32_bf16 v[136:139], a[16:19], a[168:171], v[136:139]
  ds_read_b64_tr_b16 a[52:53], v234 offset:9216
  v_mfma_f32_16x16x32_bf16 v[136:139], a[20:23], a[184:187], v[136:139]
  buffer_load_dwordx4 a[136:139], v7, s[4:7], s30 offen offset:0 sc1
  v_mfma_f32_16x16x32_bf16 v[168:171], a[20:23], a[188:191], v[168:171]
  ds_read_b64_tr_b16 a[54:55], v234 offset:13312
  v_mfma_f32_16x16x32_bf16 v[168:171], a[16:19], a[172:175], v[168:171]
  v_mfma_f32_16x16x32_bf16 v[172:175], a[24:27], a[172:175], v[172:175]
  ds_read_b64_tr_b16 a[56:57], v235 offset:1024
  v_mfma_f32_16x16x32_bf16 v[172:175], a[28:31], a[188:191], v[172:175]
  buffer_load_dwordx4 a[152:155], v7, s[4:7], s30 offen offset:1024 sc1
  v_mfma_f32_16x16x32_bf16 v[140:143], a[28:31], a[184:187], v[140:143]
  ds_read_b64_tr_b16 a[58:59], v235 offset:5120
  v_mfma_f32_16x16x32_bf16 v[140:143], a[24:27], a[168:171], v[140:143]
  v_mfma_f32_16x16x32_bf16 v[108:111], a[24:27], a[164:167], v[108:111]
  ds_read_b64_tr_b16 a[60:61], v235 offset:9216
  v_mfma_f32_16x16x32_bf16 v[108:111], a[28:31], a[180:183], v[108:111]
  v_mfma_f32_16x16x32_bf16 v[76:79], a[28:31], a[176:179], v[76:79]
  ds_read_b64_tr_b16 a[62:63], v235 offset:13312
  v_mfma_f32_16x16x32_bf16 v[76:79], a[24:27], a[160:163], v[76:79]
  s_waitcnt lgkmcnt(8)
  v_mfma_f32_16x16x32_bf16 v[80:83], a[32:35], a[160:163], v[80:83]
  ds_read_b64_tr_b16 a[0:1], v232 offset:16384
  s_add_u32 s30, s80, 195072
  v_mfma_f32_16x16x32_bf16 v[80:83], a[36:39], a[176:179], v[80:83]
  buffer_load_dwordx4 a[132:135], v16, s[4:7], s30 offen offset:0 sc1
  v_mfma_f32_16x16x32_bf16 v[112:115], a[36:39], a[180:183], v[112:115]
  ds_read_b64_tr_b16 a[2:3], v232 offset:20480
  v_mfma_f32_16x16x32_bf16 v[112:115], a[32:35], a[164:167], v[112:115]
  v_mfma_f32_16x16x32_bf16 v[144:147], a[32:35], a[168:171], v[144:147]
  ds_read_b64_tr_b16 a[4:5], v232 offset:24576
  v_and_b32 v27, 4294966527, v20
  v_mfma_f32_16x16x32_bf16 v[144:147], a[36:39], a[184:187], v[144:147]
  buffer_load_dwordx4 a[148:151], v16, s[4:7], s30 offen offset:1024 sc1
  v_mfma_f32_16x16x32_bf16 v[176:179], a[36:39], a[188:191], v[176:179]
  ds_read_b64_tr_b16 a[6:7], v232 offset:28672
  v_mfma_f32_16x16x32_bf16 v[176:179], a[32:35], a[172:175], v[176:179]
  v_lshl_add_u32 v27, v3, 8, v27
  v_mfma_f32_16x16x32_bf16 v[180:183], a[40:43], a[172:175], v[180:183]
  ds_read_b64_tr_b16 a[8:9], v233 offset:16384
  v_mfma_f32_16x16x32_bf16 v[180:183], a[44:47], a[188:191], v[180:183]
  buffer_load_dwordx4 a[140:143], v7, s[4:7], s30 offen offset:0 sc1
  v_mfma_f32_16x16x32_bf16 v[148:151], a[44:47], a[184:187], v[148:151]
  ds_read_b64_tr_b16 a[10:11], v233 offset:20480
  v_mfma_f32_16x16x32_bf16 v[148:151], a[40:43], a[168:171], v[148:151]
  v_mfma_f32_16x16x32_bf16 v[116:119], a[40:43], a[164:167], v[116:119]
  ds_read_b64_tr_b16 a[12:13], v233 offset:24576
  v_mfma_f32_16x16x32_bf16 v[116:119], a[44:47], a[180:183], v[116:119]
  v_mfma_f32_16x16x32_bf16 v[84:87], a[44:47], a[176:179], v[84:87]
  ds_read_b64_tr_b16 a[14:15], v233 offset:28672
  v_mfma_f32_16x16x32_bf16 v[84:87], a[40:43], a[160:163], v[84:87]
  s_waitcnt lgkmcnt(8)
  v_mfma_f32_16x16x32_bf16 v[88:91], a[48:51], a[160:163], v[88:91]
  ds_read_b64_tr_b16 a[16:17], v234 offset:16384
  v_mfma_f32_16x16x32_bf16 v[88:91], a[52:55], a[176:179], v[88:91]
  buffer_load_dwordx4 a[156:159], v7, s[4:7], s30 offen offset:1024 sc1
  v_mfma_f32_16x16x32_bf16 v[120:123], a[52:55], a[180:183], v[120:123]
  ds_read_b64_tr_b16 a[18:19], v234 offset:20480
  v_mfma_f32_16x16x32_bf16 v[120:123], a[48:51], a[164:167], v[120:123]
  v_mfma_f32_16x16x32_bf16 v[152:155], a[48:51], a[168:171], v[152:155]
  ds_read_b64_tr_b16 a[20:21], v234 offset:24576
  s_add_u32 m0, s98, 65536
  s_add_u32 s31, s69, 1310720
  v_mfma_f32_16x16x32_bf16 v[152:155], a[52:55], a[184:187], v[152:155]
  buffer_load_dwordx4 v19, s[44:47], s31 offen offset:0 lds
  v_mfma_f32_16x16x32_bf16 v[184:187], a[52:55], a[188:191], v[184:187]
  ds_read_b64_tr_b16 a[22:23], v234 offset:28672
  v_mfma_f32_16x16x32_bf16 v[184:187], a[48:51], a[172:175], v[184:187]
  v_mfma_f32_16x16x32_bf16 v[188:191], a[56:59], a[172:175], v[188:191]
  ds_read_b64_tr_b16 a[24:25], v235 offset:16384
  s_add_u32 m0, s98, 66432
  v_mfma_f32_16x16x32_bf16 v[188:191], a[60:63], a[188:191], v[188:191]
  buffer_load_dwordx4 v19, s[44:47], s31 offen offset:128 lds
  v_mfma_f32_16x16x32_bf16 v[156:159], a[60:63], a[184:187], v[156:159]
  ds_read_b64_tr_b16 a[26:27], v235 offset:20480
  v_mfma_f32_16x16x32_bf16 v[156:159], a[56:59], a[168:171], v[156:159]
  v_mfma_f32_16x16x32_bf16 v[124:127], a[56:59], a[164:167], v[124:127]
  ds_read_b64_tr_b16 a[28:29], v235 offset:24576
  v_mfma_f32_16x16x32_bf16 v[124:127], a[60:63], a[180:183], v[124:127]
  v_mfma_f32_16x16x32_bf16 v[92:95], a[60:63], a[176:179], v[92:95]
  ds_read_b64_tr_b16 a[30:31], v235 offset:28672
  v_mfma_f32_16x16x32_bf16 v[92:95], a[56:59], a[160:163], v[92:95]
  s_waitcnt vmcnt(18) lgkmcnt(8)
  v_mfma_f32_16x16x32_bf16 v[64:67], a[0:3], a[64:67], v[64:67]
  ds_read_b64_tr_b16 a[32:33], v232 offset:17408
  s_add_u32 m0, s98, 67584
  s_add_u32 s31, s69, 1327104
  v_mfma_f32_16x16x32_bf16 v[64:67], a[4:7], a[80:83], v[64:67]
  buffer_load_dwordx4 v19, s[44:47], s31 offen offset:0 lds
  v_mfma_f32_16x16x32_bf16 v[96:99], a[4:7], a[84:87], v[96:99]
  ds_read_b64_tr_b16 a[34:35], v232 offset:21504
  v_mfma_f32_16x16x32_bf16 v[96:99], a[0:3], a[68:71], v[96:99]
  v_mfma_f32_16x16x32_bf16 v[128:131], a[0:3], a[72:75], v[128:131]
  ds_read_b64_tr_b16 a[36:37], v232 offset:25600
  s_add_u32 m0, s98, 68480
  v_mfma_f32_16x16x32_bf16 v[128:131], a[4:7], a[88:91], v[128:131]
  buffer_load_dwordx4 v19, s[44:47], s31 offen offset:128 lds
  v_mfma_f32_16x16x32_bf16 v[160:163], a[4:7], a[92:95], v[160:163]
  ds_read_b64_tr_b16 a[38:39], v232 offset:29696
  v_mfma_f32_16x16x32_bf16 v[160:163], a[0:3], a[76:79], v[160:163]
  v_mfma_f32_16x16x32_bf16 v[164:167], a[8:11], a[76:79], v[164:167]
  ds_read_b64_tr_b16 a[40:41], v233 offset:17408
  s_add_u32 m0, s98, 81920
  s_add_u32 s31, s68, 262144
  v_mfma_f32_16x16x32_bf16 v[164:167], a[12:15], a[92:95], v[164:167]
  buffer_load_dwordx4 v19, s[44:47], s31 offen offset:0 lds
  v_mfma_f32_16x16x32_bf16 v[132:135], a[12:15], a[88:91], v[132:135]
  ds_read_b64_tr_b16 a[42:43], v233 offset:21504
  v_mfma_f32_16x16x32_bf16 v[132:135], a[8:11], a[72:75], v[132:135]
  v_mfma_f32_16x16x32_bf16 v[100:103], a[8:11], a[68:71], v[100:103]
  ds_read_b64_tr_b16 a[44:45], v233 offset:25600
  v_mfma_f32_16x16x32_bf16 v[100:103], a[12:15], a[84:87], v[100:103]
  v_mfma_f32_16x16x32_bf16 v[68:71], a[12:15], a[80:83], v[68:71]
  ds_read_b64_tr_b16 a[46:47], v233 offset:29696
  v_mfma_f32_16x16x32_bf16 v[68:71], a[8:11], a[64:67], v[68:71]
  s_waitcnt lgkmcnt(8)
  v_mfma_f32_16x16x32_bf16 v[72:75], a[16:19], a[64:67], v[72:75]
  ds_read_b64_tr_b16 a[48:49], v234 offset:17408
  s_add_u32 m0, s98, 82816
  v_mfma_f32_16x16x32_bf16 v[72:75], a[20:23], a[80:83], v[72:75]
  buffer_load_dwordx4 v19, s[44:47], s31 offen offset:128 lds
  v_mfma_f32_16x16x32_bf16 v[104:107], a[20:23], a[84:87], v[104:107]
  ds_read_b64_tr_b16 a[50:51], v234 offset:21504
  v_mfma_f32_16x16x32_bf16 v[104:107], a[16:19], a[68:71], v[104:107]
  v_mfma_f32_16x16x32_bf16 v[136:139], a[16:19], a[72:75], v[136:139]
  ds_read_b64_tr_b16 a[52:53], v234 offset:25600
  s_add_u32 m0, s98, 83968
  s_add_u32 s31, s68, 278528
  v_mfma_f32_16x16x32_bf16 v[136:139], a[20:23], a[88:91], v[136:139]
  buffer_load_dwordx4 v19, s[44:47], s31 offen offset:0 lds
  v_mfma_f32_16x16x32_bf16 v[168:171], a[20:23], a[92:95], v[168:171]
  ds_read_b64_tr_b16 a[54:55], v234 offset:29696
  v_mfma_f32_16x16x32_bf16 v[168:171], a[16:19], a[76:79], v[168:171]
  v_mfma_f32_16x16x32_bf16 v[172:175], a[24:27], a[76:79], v[172:175]
  ds_read_b64_tr_b16 a[56:57], v235 offset:17408
  s_add_u32 m0, s98, 84864
  v_mfma_f32_16x16x32_bf16 v[172:175], a[28:31], a[92:95], v[172:175]
  buffer_load_dwordx4 v19, s[44:47], s31 offen offset:128 lds
  v_mfma_f32_16x16x32_bf16 v[140:143], a[28:31], a[88:91], v[140:143]
  ds_read_b64_tr_b16 a[58:59], v235 offset:21504
  v_mfma_f32_16x16x32_bf16 v[140:143], a[24:27], a[72:75], v[140:143]
  v_mfma_f32_16x16x32_bf16 v[108:111], a[24:27], a[68:71], v[108:111]
  ds_read_b64_tr_b16 a[60:61], v235 offset:25600
  v_mfma_f32_16x16x32_bf16 v[108:111], a[28:31], a[84:87], v[108:111]
  v_mfma_f32_16x16x32_bf16 v[76:79], a[28:31], a[80:83], v[76:79]
  ds_read_b64_tr_b16 a[62:63], v235 offset:29696
  v_mfma_f32_16x16x32_bf16 v[76:79], a[24:27], a[64:67], v[76:79]
  s_waitcnt lgkmcnt(8)
  s_barrier
  v_mfma_f32_16x16x32_bf16 v[80:83], a[32:35], a[64:67], v[80:83]
  ds_read_b64_tr_b16 a[0:1], v232 offset:32768
  buffer_load_dword v33, v20, s[16:19], s28 offen sc1
  s_add_u32 s30, s81, 53248
  v_mfma_f32_16x16x32_bf16 v[80:83], a[36:39], a[80:83], v[80:83]
  buffer_load_dwordx4 a[160:163], v16, s[4:7], s30 offen offset:0 sc1
  v_mfma_f32_16x16x32_bf16 v[112:115], a[36:39], a[84:87], v[112:115]
  ds_read_b64_tr_b16 a[2:3], v232 offset:36864
  v_mfma_f32_16x16x32_bf16 v[112:115], a[32:35], a[68:71], v[112:115]
  v_mfma_f32_16x16x32_bf16 v[144:147], a[32:35], a[72:75], v[144:147]
  ds_read_b64_tr_b16 a[4:5], v232 offset:40960
  v_mfma_f32_16x16x32_bf16 v[144:147], a[36:39], a[88:91], v[144:147]
  buffer_load_dwordx4 a[176:179], v16, s[4:7], s30 offen offset:1024 sc1
  v_mfma_f32_16x16x32_bf16 v[176:179], a[36:39], a[92:95], v[176:179]
  ds_read_b64_tr_b16 a[6:7], v232 offset:45056
  v_mfma_f32_16x16x32_bf16 v[176:179], a[32:35], a[76:79], v[176:179]
  v_mfma_f32_16x16x32_bf16 v[180:183], a[40:43], a[76:79], v[180:183]
Lg_pad9:
  s_cbranch_execz Lg_ret1
  s_nop 0
  ds_read_b64_tr_b16 a[8:9], v233 offset:32768
  v_mfma_f32_16x16x32_bf16 v[180:183], a[44:47], a[92:95], v[180:183]
  buffer_load_dwordx4 a[168:171], v7, s[4:7], s30 offen offset:0 sc1
  v_mfma_f32_16x16x32_bf16 v[148:151], a[44:47], a[88:91], v[148:151]
  ds_read_b64_tr_b16 a[10:11], v233 offset:36864
  v_mfma_f32_16x16x32_bf16 v[148:151], a[40:43], a[72:75], v[148:151]
  v_mfma_f32_16x16x32_bf16 v[116:119], a[40:43], a[68:71], v[116:119]
  ds_read_b64_tr_b16 a[12:13], v233 offset:40960
  v_mfma_f32_16x16x32_bf16 v[116:119], a[44:47], a[84:87], v[116:119]
  v_mfma_f32_16x16x32_bf16 v[84:87], a[44:47], a[80:83], v[84:87]
  ds_read_b64_tr_b16 a[14:15], v233 offset:45056
  v_mfma_f32_16x16x32_bf16 v[84:87], a[40:43], a[64:67], v[84:87]
  s_waitcnt lgkmcnt(8)
  v_mfma_f32_16x16x32_bf16 v[88:91], a[48:51], a[64:67], v[88:91]
  ds_read_b64_tr_b16 a[16:17], v234 offset:32768
  v_mfma_f32_16x16x32_bf16 v[88:91], a[52:55], a[80:83], v[88:91]
  buffer_load_dwordx4 a[184:187], v7, s[4:7], s30 offen offset:1024 sc1
  v_mfma_f32_16x16x32_bf16 v[120:123], a[52:55], a[84:87], v[120:123]
  ds_read_b64_tr_b16 a[18:19], v234 offset:36864
  v_mfma_f32_16x16x32_bf16 v[120:123], a[48:51], a[68:71], v[120:123]
  v_mfma_f32_16x16x32_bf16 v[152:155], a[48:51], a[72:75], v[152:155]
  ds_read_b64_tr_b16 a[20:21], v234 offset:40960
  s_add_u32 s30, s81, 201216
  v_mfma_f32_16x16x32_bf16 v[152:155], a[52:55], a[88:91], v[152:155]
  buffer_load_dwordx4 a[164:167], v16, s[4:7], s30 offen offset:0 sc1
  v_mfma_f32_16x16x32_bf16 v[184:187], a[52:55], a[92:95], v[184:187]
  ds_read_b64_tr_b16 a[22:23], v234 offset:45056
  v_mfma_f32_16x16x32_bf16 v[184:187], a[48:51], a[76:79], v[184:187]
  v_mfma_f32_16x16x32_bf16 v[188:191], a[56:59], a[76:79], v[188:191]
  ds_read_b64_tr_b16 a[24:25], v235 offset:32768
  v_mfma_f32_16x16x32_bf16 v[188:191], a[60:63], a[92:95], v[188:191]
  buffer_load_dwordx4 a[180:183], v16, s[4:7], s30 offen offset:1024 sc1
  v_mfma_f32_16x16x32_bf16 v[156:159], a[60:63], a[88:91], v[156:159]
  ds_read_b64_tr_b16 a[26:27], v235 offset:36864
  v_mfma_f32_16x16x32_bf16 v[156:159], a[56:59], a[72:75], v[156:159]
  v_mfma_f32_16x16x32_bf16 v[124:127], a[56:59], a[68:71], v[124:127]
  ds_read_b64_tr_b16 a[28:29], v235 offset:40960
  v_mfma_f32_16x16x32_bf16 v[124:127], a[60:63], a[84:87], v[124:127]
  v_mfma_f32_16x16x32_bf16 v[92:95], a[60:63], a[80:83], v[92:95]
  ds_read_b64_tr_b16 a[30:31], v235 offset:45056
  v_mfma_f32_16x16x32_bf16 v[92:95], a[56:59], a[64:67], v[92:95]
  s_waitcnt vmcnt(23) lgkmcnt(8)
  v_mfma_f32_16x16x32_bf16 v[64:67], a[0:3], a[96:99], v[64:67]
  ds_read_b64_tr_b16 a[32:33], v232 offset:33792
  v_mfma_f32_16x16x32_bf16 v[64:67], a[4:7], a[112:115], v[64:67]
  buffer_load_dwordx4 a[172:175], v7, s[4:7], s30 offen offset:0 sc1
  v_mfma_f32_16x16x32_bf16 v[96:99], a[4:7], a[116:119], v[96:99]
  ds_read_b64_tr_b16 a[34:35], v232 offset:37888
  v_mfma_f32_16x16x32_bf16 v[96:99], a[0:3], a[100:103], v[96:99]
  v_mfma_f32_16x16x32_bf16 v[128:131], a[0:3], a[104:107], v[128:131]
  ds_read_b64_tr_b16 a[36:37], v232 offset:41984
  v_mfma_f32_16x16x32_bf16 v[128:131], a[4:7], a[120:123], v[128:131]
  buffer_load_dwordx4 a[188:191], v7, s[4:7], s30 offen offset:1024 sc1
  v_mfma_f32_16x16x32_bf16 v[160:163], a[4:7], a[124:127], v[160:163]
  ds_read_b64_tr_b16 a[38:39], v232 offset:46080
  v_mfma_f32_16x16x32_bf16 v[160:163], a[0:3], a[108:111], v[160:163]
  v_mfma_f32_16x16x32_bf16 v[164:167], a[8:11], a[108:111], v[164:167]
  ds_read_b64_tr_b16 a[40:41], v233 offset:33792
  s_add_u32 m0, s98, 98304
  s_add_u32 s31, s69, 655360
  v_mfma_f32_16x16x32_bf16 v[164:167], a[12:15], a[124:127], v[164:167]
  buffer_load_dwordx4 v19, s[44:47], s31 offen offset:0 lds
  v_mfma_f32_16x16x32_bf16 v[132:135], a[12:15], a[120:123], v[132:135]
  ds_read_b64_tr_b16 a[42:43], v233 offset:37888
  v_mfma_f32_16x16x32_bf16 v[132:135], a[8:11], a[104:107], v[132:135]
  v_mfma_f32_16x16x32_bf16 v[100:103], a[8:11], a[100:103], v[100:103]
  ds_read_b64_tr_b16 a[44:45], v233 offset:41984
  v_mfma_f32_16x16x32_bf16 v[100:103], a[12:15], a[116:119], v[100:103]
  v_mfma_f32_16x16x32_bf16 v[68:71], a[12:15], a[112:115], v[68:71]
  ds_read_b64_tr_b16 a[46:47], v233 offset:46080
  v_mfma_f32_16x16x32_bf16 v[68:71], a[8:11], a[96:99], v[68:71]
  s_waitcnt lgkmcnt(8)
  v_mfma_f32_16x16x32_bf16 v[72:75], a[16:19], a[96:99], v[72:75]
  ds_read_b64_tr_b16 a[48:49], v234 offset:33792
  s_add_u32 m0, s98, 99200
  v_mfma_f32_16x16x32_bf16 v[72:75], a[20:23], a[112:115], v[72:75]
  buffer_load_dwordx4 v19, s[44:47], s31 offen offset:128 lds
  v_mfma_f32_16x16x32_bf16 v[104:107], a[20:23], a[116:119], v[104:107]
  ds_read_b64_tr_b16 a[50:51], v234 offset:37888
  v_mfma_f32_16x16x32_bf16 v[104:107], a[16:19], a[100:103], v[104:107]
  v_mfma_f32_16x16x32_bf16 v[136:139], a[16:19], a[104:107], v[136:139]
  ds_read_b64_tr_b16 a[52:53], v234 offset:41984
  s_add_u32 m0, s98, 100352
  s_add_u32 s31, s69, 671744
  v_mfma_f32_16x16x32_bf16 v[136:139], a[20:23], a[120:123], v[136:139]
  buffer_load_dwordx4 v19, s[44:47], s31 offen offset:0 lds
  v_mfma_f32_16x16x32_bf16 v[168:171], a[20:23], a[124:127], v[168:171]
  ds_read_b64_tr_b16 a[54:55], v234 offset:46080
  v_mfma_f32_16x16x32_bf16 v[168:171], a[16:19], a[108:111], v[168:171]
  v_mfma_f32_16x16x32_bf16 v[172:175], a[24:27], a[108:111], v[172:175]
  ds_read_b64_tr_b16 a[56:57], v235 offset:33792
  s_add_u32 m0, s98, 101248
  v_mfma_f32_16x16x32_bf16 v[172:175], a[28:31], a[124:127], v[172:175]
  buffer_load_dwordx4 v19, s[44:47], s31 offen offset:128 lds
  v_mfma_f32_16x16x32_bf16 v[140:143], a[28:31], a[120:123], v[140:143]
  ds_read_b64_tr_b16 a[58:59], v235 offset:37888
  v_mfma_f32_16x16x32_bf16 v[140:143], a[24:27], a[104:107], v[140:143]
  v_mfma_f32_16x16x32_bf16 v[108:111], a[24:27], a[100:103], v[108:111]
  ds_read_b64_tr_b16 a[60:61], v235 offset:41984
  v_mfma_f32_16x16x32_bf16 v[108:111], a[28:31], a[116:119], v[108:111]
  v_mfma_f32_16x16x32_bf16 v[76:79], a[28:31], a[112:115], v[76:79]
  ds_read_b64_tr_b16 a[62:63], v235 offset:46080
  v_mfma_f32_16x16x32_bf16 v[76:79], a[24:27], a[96:99], v[76:79]
  s_waitcnt vmcnt(12) lgkmcnt(8)
  v_mfma_f32_16x16x32_bf16 v[80:83], a[32:35], a[96:99], v[80:83]
  ds_read_b64_tr_b16 a[0:1], v232 offset:49152
  v_cmp_eq_u32 vcc, 0, v33
  s_cbranch_vccnz Lg_g3_slow
Lg_g3_back:
  s_add_u32 s30, s80, 36864
  v_mfma_f32_16x16x32_bf16 v[80:83], a[36:39], a[112:115], v[80:83]
  buffer_load_dwordx4 a[64:67], v16, s[4:7], s30 offen offset:0 sc1
  v_mfma_f32_16x16x32_bf16 v[112:115], a[36:39], a[116:119], v[112:115]
  ds_read_b64_tr_b16 a[2:3], v232 offset:53248
  v_and_b32_e64 v22, 1, v4
  v_mfma_f32_16x16x32_bf16 v[112:115], a[32:35], a[100:103], v[112:115]
  v_mfma_f32_16x16x32_bf16 v[144:147], a[32:35], a[104:107], v[144:147]
  ds_read_b64_tr_b16 a[4:5], v232 offset:57344
  v_lshlrev_b32_e64 v22, 4, v22
  v_mfma_f32_16x16x32_bf16 v[144:147], a[36:39], a[120:123], v[144:147]
  buffer_load_dwordx4 a[80:83], v16, s[4:7], s30 offen offset:1024 sc1
  v_mfma_f32_16x16x32_bf16 v[176:179], a[36:39], a[124:127], v[176:179]
  ds_read_b64_tr_b16 a[6:7], v232 offset:61440
  v_mov_b32 v23, 0x3f80
  v_mfma_f32_16x16x32_bf16 v[176:179], a[32:35], a[108:111], v[176:179]
  v_mfma_f32_16x16x32_bf16 v[180:183], a[40:43], a[108:111], v[180:183]
  ds_read_b64_tr_b16 a[8:9], v233 offset:49152
  v_lshlrev_b32_e64 v22, v22, v23
  v_mfma_f32_16x16x32_bf16 v[180:183], a[44:47], a[124:127], v[180:183]
  buffer_load_dwordx4 a[72:75], v7, s[4:7], s30 offen offset:0 sc1
  v_mfma_f32_16x16x32_bf16 v[148:151], a[44:47], a[120:123], v[148:151]
  ds_read_b64_tr_b16 a[10:11], v233 offset:53248
  v_lshrrev_b32_e64 v23, 1, v4
  v_mfma_f32_16x16x32_bf16 v[148:151], a[40:43], a[104:107], v[148:151]
  v_mfma_f32_16x16x32_bf16 v[116:119], a[40:43], a[100:103], v[116:119]
  ds_read_b64_tr_b16 a[12:13], v233 offset:57344
  v_lshlrev_b32_e64 v24, 1, v3
  v_mfma_f32_16x16x32_bf16 v[116:119], a[44:47], a[116:119], v[116:119]
  v_mfma_f32_16x16x32_bf16 v[84:87], a[44:47], a[112:115], v[84:87]
  ds_read_b64_tr_b16 a[14:15], v233 offset:61440
  v_sub_u32 v23, v23, v24
  v_mfma_f32_16x16x32_bf16 v[84:87], a[40:43], a[96:99], v[84:87]
  s_waitcnt lgkmcnt(8)
  v_mfma_f32_16x16x32_bf16 v[88:91], a[48:51], a[96:99], v[88:91]
  ds_read_b64_tr_b16 a[16:17], v234 offset:49152
  v_cmp_eq_u32_e64 vcc, 0, v23
  v_mfma_f32_16x16x32_bf16 v[88:91], a[52:55], a[112:115], v[88:91]
  buffer_load_dwordx4 a[88:91], v7, s[4:7], s30 offen offset:1024 sc1
  v_mfma_f32_16x16x32_bf16 v[120:123], a[52:55], a[116:119], v[120:123]
  ds_read_b64_tr_b16 a[18:19], v234 offset:53248
  v_mov_b32_e64 v192, 0
  v_mfma_f32_16x16x32_bf16 v[120:123], a[48:51], a[100:103], v[120:123]
  v_mfma_f32_16x16x32_bf16 v[152:155], a[48:51], a[104:107], v[152:155]
  ds_read_b64_tr_b16 a[20:21], v234 offset:57344
  v_cndmask_b32_e64 v194, 0, v22, vcc
  s_add_u32 s30, s80, 184832
  v_mfma_f32_16x16x32_bf16 v[152:155], a[52:55], a[120:123], v[152:155]
  buffer_load_dwordx4 a[68:71], v16, s[4:7], s30 offen offset:0 sc1
  v_mfma_f32_16x16x32_bf16 v[184:187], a[52:55], a[124:127], v[184:187]
  ds_read_b64_tr_b16 a[22:23], v234 offset:61440
  v_cmp_eq_u32_e64 vcc, 1, v23
  v_mfma_f32_16x16x32_bf16 v[184:187], a[48:51], a[108:111], v[184:187]
  v_mfma_f32_16x16x32_bf16 v[188:191], a[56:59], a[108:111], v[188:191]
  ds_read_b64_tr_b16 a[24:25], v235 offset:49152
  v_mov_b32_e64 v193, 0
  v_mfma_f32_16x16x32_bf16 v[188:191], a[60:63], a[124:127], v[188:191]
  buffer_load_dwordx4 a[84:87], v16, s[4:7], s30 offen offset:1024 sc1
  v_mfma_f32_16x16x32_bf16 v[156:159], a[60:63], a[120:123], v[156:159]
  ds_read_b64_tr_b16 a[26:27], v235 offset:53248
  v_cndmask_b32_e64 v195, 0, v22, vcc
  v_mfma_f32_16x16x32_bf16 v[156:159], a[56:59], a[104:107], v[156:159]
  v_mfma_f32_16x16x32_bf16 v[124:127], a[56:59], a[100:103], v[124:127]
  ds_read_b64_tr_b16 a[28:29], v235 offset:57344
  v_mov_b32_e64 v196, 0
  v_mfma_f32_16x16x32_bf16 v[124:127], a[60:63], a[116:119], v[124:127]
  v_mfma_f32_16x16x32_bf16 v[92:95], a[60:63], a[112:115], v[92:95]
  ds_read_b64_tr_b16 a[30:31], v235 offset:61440
  v_mov_b32 v197, 0
  v_mfma_f32_16x16x32_bf16 v[92:95], a[56:59], a[96:99], v[92:95]
  s_waitcnt lgkmcnt(8)
  v_mfma_f32_16x16x32_bf16 v[64:67], a[0:3], a[128:131], v[64:67]
  ds_read_b64_tr_b16 a[32:33], v232 offset:50176
  v_mfma_f32_16x16x32_bf16 v[64:67], a[4:7], a[144:147], v[64:67]
  buffer_load_dwordx4 a[76:79], v7, s[4:7], s30 offen offset:0 sc1
  v_mfma_f32_16x16x32_bf16 v[96:99], a[4:7], a[148:151], v[96:99]
  ds_read_b64_tr_b16 a[34:35], v232 offset:54272
  v_mfma_f32_16x16x32_bf16 v[96:99], a[0:3], a[132:135], v[96:99]
  v_mfma_f32_16x16x32_bf16 v[128:131], a[0:3], a[136:139], v[128:131]
  ds_read_b64_tr_b16 a[36:37], v232 offset:58368
  v_mfma_f32_16x16x32_bf16 v[128:131], a[4:7], a[152:155], v[128:131]
  buffer_load_dwordx4 a[92:95], v7, s[4:7], s30 offen offset:1024 sc1
  v_mfma_f32_16x16x32_bf16 v[160:163], a[4:7], a[156:159], v[160:163]
  ds_read_b64_tr_b16 a[38:39], v232 offset:62464
  v_mfma_f32_16x16x32_bf16 v[160:163], a[0:3], a[140:143], v[160:163]
  v_mfma_f32_16x16x32_bf16 v[164:167], a[8:11], a[140:143], v[164:167]
  ds_read_b64_tr_b16 a[40:41], v233 offset:50176
  s_add_u32 m0, s98, 114688
  s_add_u32 s31, s68, 1048576
  v_mfma_f32_16x16x32_bf16 v[164:167], a[12:15], a[156:159], v[164:167]
  buffer_load_dwordx4 v19, s[44:47], s31 offen offset:0 lds
  v_mfma_f32_16x16x32_bf16 v[132:135], a[12:15], a[152:155], v[132:135]
  ds_read_b64_tr_b16 a[42:43], v233 offset:54272
  v_mfma_f32_16x16x32_bf16 v[132:135], a[8:11], a[136:139], v[132:135]
  v_mfma_f32_16x16x32_bf16 v[100:103], a[8:11], a[132:135], v[100:103]
  ds_read_b64_tr_b16 a[44:45], v233 offset:58368
  v_mfma_f32_16x16x32_bf16 v[100:103], a[12:15], a[148:151], v[100:103]
  v_mfma_f32_16x16x32_bf16 v[68:71], a[12:15], a[144:147], v[68:71]
  ds_read_b64_tr_b16 a[46:47], v233 offset:62464
  v_mfma_f32_16x16x32_bf16 v[68:71], a[8:11], a[128:131], v[68:71]
  s_waitcnt lgkmcnt(8)
  v_mfma_f32_16x16x32_bf16 v[72:75], a[16:19], a[128:131], v[72:75]
  ds_read_b64_tr_b16 a[48:49], v234 offset:50176
  s_add_u32 m0, s98, 115584
  v_mfma_f32_16x16x32_bf16 v[72:75], a[20:23], a[144:147], v[72:75]
  buffer_load_dwordx4 v19, s[44:47], s31 offen offset:128 lds
  v_mfma_f32_16x16x32_bf16 v[104:107], a[20:23], a[148:151], v[104:107]
  ds_read_b64_tr_b16 a[50:51], v234 offset:54272
  v_mfma_f32_16x16x32_bf16 v[104:107], a[16:19], a[132:135], v[104:107]
  v_mfma_f32_16x16x32_bf16 v[136:139], a[16:19], a[136:139], v[136:139]
  ds_read_b64_tr_b16 a[52:53], v234 offset:58368
  s_add_u32 m0, s98, 116736
  s_add_u32 s31, s68, 1064960
  v_mfma_f32_16x16x32_bf16 v[136:139], a[20:23], a[152:155], v[136:139]
  buffer_load_dwordx4 v19, s[44:47], s31 offen offset:0 lds
  v_mfma_f32_16x16x32_bf16 v[168:171], a[20:23], a[156:159], v[168:171]
  ds_read_b64_tr_b16 a[54:55], v234 offset:62464
  v_mfma_f32_16x16x32_bf16 v[168:171], a[16:19], a[140:143], v[168:171]
  v_mfma_f32_16x16x32_bf16 v[172:175], a[24:27], a[140:143], v[172:175]
  ds_read_b64_tr_b16 a[56:57], v235 offset:50176
  s_add_u32 m0, s98, 117632
  v_mfma_f32_16x16x32_bf16 v[172:175], a[28:31], a[156:159], v[172:175]
  buffer_load_dwordx4 v19, s[44:47], s31 offen offset:128 lds
  v_mfma_f32_16x16x32_bf16 v[140:143], a[28:31], a[152:155], v[140:143]
  ds_read_b64_tr_b16 a[58:59], v235 offset:54272
  v_mfma_f32_16x16x32_bf16 v[140:143], a[24:27], a[136:139], v[140:143]
  v_mfma_f32_16x16x32_bf16 v[108:111], a[24:27], a[132:135], v[108:111]
  ds_read_b64_tr_b16 a[60:61], v235 offset:58368
  v_mfma_f32_16x16x32_bf16 v[108:111], a[28:31], a[148:151], v[108:111]
  v_mfma_f32_16x16x32_bf16 v[76:79], a[28:31], a[144:147], v[76:79]
  ds_read_b64_tr_b16 a[62:63], v235 offset:62464
  v_mfma_f32_16x16x32_bf16 v[76:79], a[24:27], a[128:131], v[76:79]
  s_waitcnt lgkmcnt(8)
  s_barrier
  v_mfma_f32_16x16x32_bf16 v[80:83], a[32:35], a[128:131], v[80:83]
  ds_read_b64_tr_b16 a[0:1], v236 offset:0
  s_add_u32 s30, s81, 43008
  v_mfma_f32_16x16x32_bf16 v[80:83], a[36:39], a[144:147], v[80:83]
  buffer_load_dwordx4 a[96:99], v16, s[4:7], s30 offen offset:0 sc1
  v_mfma_f32_16x16x32_bf16 v[112:115], a[36:39], a[148:151], v[112:115]
  ds_read_b64_tr_b16 a[2:3], v236 offset:4096
  v_sub_u32 v23, v23, v24
  v_mfma_f32_16x16x32_bf16 v[112:115], a[32:35], a[132:135], v[112:115]
  v_cmp_eq_i32_e64 vcc, 0, v23
  v_mfma_f32_16x16x32_bf16 v[144:147], a[32:35], a[136:139], v[144:147]
  ds_read_b64_tr_b16 a[4:5], v236 offset:8192
  v_mfma_f32_16x16x32_bf16 v[144:147], a[36:39], a[152:155], v[144:147]
  v_cndmask_b32_e64 v200, 0, v22, vcc
  buffer_load_dwordx4 a[112:115], v16, s[4:7], s30 offen offset:1024 sc1
  v_mfma_f32_16x16x32_bf16 v[176:179], a[36:39], a[156:159], v[176:179]
  ds_read_b64_tr_b16 a[6:7], v236 offset:12288
  v_mfma_f32_16x16x32_bf16 v[176:179], a[32:35], a[140:143], v[176:179]
  v_cmp_eq_i32_e64 vcc, 1, v23
  v_mfma_f32_16x16x32_bf16 v[180:183], a[40:43], a[140:143], v[180:183]
  ds_read_b64_tr_b16 a[8:9], v237 offset:0
  v_mfma_f32_16x16x32_bf16 v[180:183], a[44:47], a[156:159], v[180:183]
  v_cndmask_b32_e64 v201, 0, v22, vcc
  buffer_load_dwordx4 a[104:107], v7, s[4:7], s30 offen offset:0 sc1
  v_mfma_f32_16x16x32_bf16 v[148:151], a[44:47], a[152:155], v[148:151]
  ds_read_b64_tr_b16 a[10:11], v237 offset:4096
  v_cmp_eq_i32_e64 vcc, 2, v23
  v_mfma_f32_16x16x32_bf16 v[148:151], a[40:43], a[136:139], v[148:151]
  v_mfma_f32_16x16x32_bf16 v[116:119], a[40:43], a[132:135], v[116:119]
  ds_read_b64_tr_b16 a[12:13], v237 offset:8192
  v_cndmask_b32_e64 v202, 0, v22, vcc
  v_mfma_f32_16x16x32_bf16 v[116:119], a[44:47], a[148:151], v[116:119]
  v_mfma_f32_16x16x32_bf16 v[84:87], a[44:47], a[144:147], v[84:87]
  ds_read_b64_tr_b16 a[14:15], v237 offset:12288
  v_cmp_eq_i32 vcc, 3, v23
  v_mfma_f32_16x16x32_bf16 v[84:87], a[40:43], a[128:131], v[84:87]
  s_waitcnt lgkmcnt(8)
  v_mfma_f32_16x16x32_bf16 v[88:91], a[48:51], a[128:131], v[88:91]
  ds_read_b64_tr_b16 a[16:17], v238 offset:0
  v_cndmask_b32 v203, 0, v22, vcc
  v_mfma_f32_16x16x32_bf16 v[88:91], a[52:55], a[144:147], v[88:91]
  v_cmp_eq_i32 vcc, -8, v23
  buffer_load_dwordx4 a[120:123], v7, s[4:7], s30 offen offset:1024 sc1
  v_mfma_f32_16x16x32_bf16 v[120:123], a[52:55], a[148:151], v[120:123]
  ds_read_b64_tr_b16 a[18:19], v238 offset:4096
  v_mfma_f32_16x16x32_bf16 v[120:123], a[48:51], a[132:135], v[120:123]
  v_cndmask_b32_e64 v204, 0, v22, vcc
  v_mfma_f32_16x16x32_bf16 v[152:155], a[48:51], a[136:139], v[152:155]
  ds_read_b64_tr_b16 a[20:21], v238 offset:8192
  s_add_u32 s30, s81, 190976
  v_mfma_f32_16x16x32_bf16 v[152:155], a[52:55], a[152:155], v[152:155]
  v_cmp_eq_i32_e64 vcc, -7, v23
  buffer_load_dwordx4 a[100:103], v16, s[4:7], s30 offen offset:0 sc1
  v_mfma_f32_16x16x32_bf16 v[184:187], a[52:55], a[156:159], v[184:187]
  ds_read_b64_tr_b16 a[22:23], v238 offset:12288
  v_mfma_f32_16x16x32_bf16 v[184:187], a[48:51], a[140:143], v[184:187]
  v_cndmask_b32 v205, 0, v22, vcc
  v_mfma_f32_16x16x32_bf16 v[188:191], a[56:59], a[140:143], v[188:191]
  ds_read_b64_tr_b16 a[24:25], v239 offset:0
  v_cmp_eq_i32 vcc, -6, v23
  v_mfma_f32_16x16x32_bf16 v[188:191], a[60:63], a[156:159], v[188:191]
  buffer_load_dwordx4 a[116:119], v16, s[4:7], s30 offen offset:1024 sc1
  v_mfma_f32_16x16x32_bf16 v[156:159], a[60:63], a[152:155], v[156:159]
  ds_read_b64_tr_b16 a[26:27], v239 offset:4096
  v_cndmask_b32_e64 v206, 0, v22, vcc
  v_mfma_f32_16x16x32_bf16 v[156:159], a[56:59], a[136:139], v[156:159]
  v_mfma_f32_16x16x32_bf16 v[124:127], a[56:59], a[132:135], v[124:127]
  ds_read_b64_tr_b16 a[28:29], v239 offset:8192
  v_cmp_eq_i32_e64 vcc, -5, v23
  v_mfma_f32_16x16x32_bf16 v[124:127], a[60:63], a[148:151], v[124:127]
  v_mfma_f32_16x16x32_bf16 v[92:95], a[60:63], a[144:147], v[92:95]
  ds_read_b64_tr_b16 a[30:31], v239 offset:12288
  v_cndmask_b32 v207, 0, v22, vcc
  v_mfma_f32_16x16x32_bf16 v[92:95], a[56:59], a[128:131], v[92:95]
  s_waitcnt vmcnt(22) lgkmcnt(8)
  v_mfma_f32_16x16x32_bf16 v[64:67], a[0:3], a[160:163], v[64:67]
  ds_read_b64_tr_b16 a[32:33], v236 offset:1024
  v_mfma_f32_16x16x32_bf16 v[64:67], a[4:7], a[176:179], v[64:67]
  buffer_load_dwordx4 a[108:111], v7, s[4:7], s30 offen offset:0 sc1
  v_mfma_f32_16x16x32_bf16 v[96:99], a[4:7], a[180:183], v[96:99]
  ds_read_b64_tr_b16 a[34:35], v236 offset:5120
  v_mfma_f32_16x16x32_bf16 v[96:99], a[0:3], a[164:167], v[96:99]
  v_mfma_f32_16x16x32_bf16 v[128:131], a[0:3], a[168:171], v[128:131]
  ds_read_b64_tr_b16 a[36:37], v236 offset:9216
  v_mfma_f32_16x16x32_bf16 v[128:131], a[4:7], a[184:187], v[128:131]
  buffer_load_dwordx4 a[124:127], v7, s[4:7], s30 offen offset:1024 sc1
  v_mfma_f32_16x16x32_bf16 v[160:163], a[4:7], a[188:191], v[160:163]
  ds_read_b64_tr_b16 a[38:39], v236 offset:13312
  v_mfma_f32_16x16x32_bf16 v[160:163], a[0:3], a[172:175], v[160:163]
  v_mfma_f32_16x16x32_bf16 v[164:167], a[8:11], a[172:175], v[164:167]
  ds_read_b64_tr_b16 a[40:41], v237 offset:1024
  s_add_u32 s30, s80, 49152
  v_mfma_f32_16x16x32_bf16 v[164:167], a[12:15], a[188:191], v[164:167]
  buffer_load_dwordx4 a[128:131], v16, s[4:7], s30 offen offset:0 sc1
  v_mfma_f32_16x16x32_bf16 v[132:135], a[12:15], a[184:187], v[132:135]
  ds_read_b64_tr_b16 a[42:43], v237 offset:5120
  v_mfma_f32_16x16x32_bf16 v[132:135], a[8:11], a[168:171], v[132:135]
  v_mfma_f32_16x16x32_bf16 v[100:103], a[8:11], a[164:167], v[100:103]
  ds_read_b64_tr_b16 a[44:45], v237 offset:9216
  v_mfma_f32_16x16x32_bf16 v[100:103], a[12:15], a[180:183], v[100:103]
  buffer_load_dwordx4 a[144:147], v16, s[4:7], s30 offen offset:1024 sc1
  v_mfma_f32_16x16x32_bf16 v[68:71], a[12:15], a[176:179], v[68:71]
  ds_read_b64_tr_b16 a[46:47], v237 offset:13312
  v_mfma_f32_16x16x32_bf16 v[68:71], a[8:11], a[160:163], v[68:71]
  s_waitcnt lgkmcnt(8)
  v_mfma_f32_16x16x32_bf16 v[72:75], a[16:19], a[160:163], v[72:75]
  ds_read_b64_tr_b16 a[48:49], v238 offset:1024
  v_mfma_f32_16x16x32_bf16 v[72:75], a[20:23], a[176:179], v[72:75]
  buffer_load_dwordx4 a[136:139], v7, s[4:7], s30 offen offset:0 sc1
  v_mfma_f32_16x16x32_bf16 v[104:107], a[20:23], a[180:183], v[104:107]
  ds_read_b64_tr_b16 a[50:51], v238 offset:5120
  v_mfma_f32_16x16x32_bf16 v[104:107], a[16:19], a[164:167], v[104:107]
  v_mfma_f32_16x16x32_bf16 v[136:139], a[16:19], a[168:171], v[136:139]
  ds_read_b64_tr_b16 a[52:53], v238 offset:9216
  v_mfma_f32_16x16x32_bf16 v[136:139], a[20:23], a[184:187], v[136:139]
  buffer_load_dwordx4 a[152:155], v7, s[4:7], s30 offen offset:1024 sc1
  v_mfma_f32_16x16x32_bf16 v[168:171], a[20:23], a[188:191], v[168:171]
  ds_read_b64_tr_b16 a[54:55], v238 offset:13312
  v_mfma_f32_16x16x32_bf16 v[168:171], a[16:19], a[172:175], v[168:171]
  v_mfma_f32_16x16x32_bf16 v[172:175], a[24:27], a[172:175], v[172:175]
  ds_read_b64_tr_b16 a[56:57], v239 offset:1024
  s_add_u32 s30, s80, 197120
  v_mfma_f32_16x16x32_bf16 v[172:175], a[28:31], a[188:191], v[172:175]
  buffer_load_dwordx4 a[132:135], v16, s[4:7], s30 offen offset:0 sc1
  v_mfma_f32_16x16x32_bf16 v[140:143], a[28:31], a[184:187], v[140:143]
  ds_read_b64_tr_b16 a[58:59], v239 offset:5120
  v_mfma_f32_16x16x32_bf16 v[140:143], a[24:27], a[168:171], v[140:143]
  v_mfma_f32_16x16x32_bf16 v[108:111], a[24:27], a[164:167], v[108:111]
  ds_read_b64_tr_b16 a[60:61], v239 offset:9216
  v_mfma_f32_16x16x32_bf16 v[108:111], a[28:31], a[180:183], v[108:111]
  v_mfma_f32_16x16x32_bf16 v[76:79], a[28:31], a[176:179], v[76:79]
  ds_read_b64_tr_b16 a[62:63], v239 offset:13312
  v_mfma_f32_16x16x32_bf16 v[76:79], a[24:27], a[160:163], v[76:79]
  s_waitcnt lgkmcnt(8)
  v_mfma_f32_16x16x32_bf16 v[80:83], a[32:35], a[160:163], v[80:83]
  ds_read_b64_tr_b16 a[0:1], v236 offset:16384
  v_mfma_f32_16x16x32_bf16 v[80:83], a[36:39], a[176:179], v[80:83]
  buffer_load_dwordx4 a[148:151], v16, s[4:7], s30 offen offset:1024 sc1
  v_mfma_f32_16x16x32_bf16 v[112:115], a[36:39], a[180:183], v[112:115]
  ds_read_b64_tr_b16 a[2:3], v236 offset:20480
  v_mfma_f32_16x16x32_bf16 v[112:115], a[32:35], a[164:167], v[112:115]
  v_mfma_f32_16x16x32_bf16 v[144:147], a[32:35], a[168:171], v[144:147]
  ds_read_b64_tr_b16 a[4:5], v236 offset:24576
  v_mfma_f32_16x16x32_bf16 v[144:147], a[36:39], a[184:187], v[144:147]
  buffer_load_dwordx4 a[140:143], v7, s[4:7], s30 offen offset:0 sc1
  v_mfma_f32_16x16x32_bf16 v[176:179], a[36:39], a[188:191], v[176:179]
  ds_read_b64_tr_b16 a[6:7], v236 offset:28672
  v_mfma_f32_16x16x32_bf16 v[176:179], a[32:35], a[172:175], v[176:179]
  v_mfma_f32_16x16x32_bf16 v[180:183], a[40:43], a[172:175], v[180:183]
  ds_read_b64_tr_b16 a[8:9], v237 offset:16384
  v_mfma_f32_16x16x32_bf16 v[180:183], a[44:47], a[188:191], v[180:183]
  buffer_load_dwordx4 a[156:159], v7, s[4:7], s30 offen offset:1024 sc1
  v_mfma_f32_16x16x32_bf16 v[148:151], a[44:47], a[184:187], v[148:151]
  ds_read_b64_tr_b16 a[10:11], v237 offset:20480
  v_mfma_f32_16x16x32_bf16 v[148:151], a[40:43], a[168:171], v[148:151]
  v_mfma_f32_16x16x32_bf16 v[116:119], a[40:43], a[164:167], v[116:119]
  ds_read_b64_tr_b16 a[12:13], v237 offset:24576
  s_add_u32 m0, s98, 131072
  s_add_u32 s31, s69, 1441792
  v_mfma_f32_16x16x32_bf16 v[116:119], a[44:47], a[180:183], v[116:119]
  buffer_load_dwordx4 v19, s[44:47], s31 offen offset:0 lds
  v_mfma_f32_16x16x32_bf16 v[84:87], a[44:47], a[176:179], v[84:87]
  ds_read_b64_tr_b16 a[14:15], v237 offset:28672
  v_mfma_f32_16x16x32_bf16 v[84:87], a[40:43], a[160:163], v[84:87]
  s_waitcnt lgkmcnt(8)
  v_mfma_f32_16x16x32_bf16 v[88:91], a[48:51], a[160:163], v[88:91]
  ds_read_b64_tr_b16 a[16:17], v238 offset:16384
  s_add_u32 m0, s98, 131968
  v_mfma_f32_16x16x32_bf16 v[88:91], a[52:55], a[176:179], v[88:91]
  buffer_load_dwordx4 v19, s[44:47], s31 offen offset:128 lds
  v_mfma_f32_16x16x32_bf16 v[120:123], a[52:55], a[180:183], v[120:123]
  ds_read_b64_tr_b16 a[18:19], v238 offset:20480
  v_mfma_f32_16x16x32_bf16 v[120:123], a[48:51], a[164:167], v[120:123]
  v_mfma_f32_16x16x32_bf16 v[152:155], a[48:51], a[168:171], v[152:155]
  ds_read_b64_tr_b16 a[20:21], v238 offset:24576
  s_add_u32 m0, s98, 133120
  s_add_u32 s31, s69, 1458176
  v_mfma_f32_16x16x32_bf16 v[152:155], a[52:55], a[184:187], v[152:155]
  buffer_load_dwordx4 v19, s[44:47], s31 offen offset:0 lds
  v_mfma_f32_16x16x32_bf16 v[184:187], a[52:55], a[188:191], v[184:187]
  ds_read_b64_tr_b16 a[22:23], v238 offset:28672
  v_mfma_f32_16x16x32_bf16 v[184:187], a[48:51], a[172:175], v[184:187]
  v_mfma_f32_16x16x32_bf16 v[188:191], a[56:59], a[172:175], v[188:191]
  ds_read_b64_tr_b16 a[24:25], v239 offset:16384
  s_add_u32 m0, s98, 134016
  v_mfma_f32_16x16x32_bf16 v[188:191], a[60:63], a[188:191], v[188:191]
  buffer_load_dwordx4 v19, s[44:47], s31 offen offset:128 lds
  v_mfma_f32_16x16x32_bf16 v[156:159], a[60:63], a[184:187], v[156:159]
  ds_read_b64_tr_b16 a[26:27], v239 offset:20480
  v_mfma_f32_16x16x32_bf16 v[156:159], a[56:59], a[168:171], v[156:159]
  v_mfma_f32_16x16x32_bf16 v[124:127], a[56:59], a[164:167], v[124:127]
  ds_read_b64_tr_b16 a[28:29], v239 offset:24576
  v_mfma_f32_16x16x32_bf16 v[124:127], a[60:63], a[180:183], v[124:127]
  v_mfma_f32_16x16x32_bf16 v[92:95], a[60:63], a[176:179], v[92:95]
  ds_read_b64_tr_b16 a[30:31], v239 offset:28672
  v_mfma_f32_16x16x32_bf16 v[92:95], a[56:59], a[160:163], v[92:95]
  s_waitcnt vmcnt(24) lgkmcnt(8)
  v_mfma_f32_16x16x32_bf16 v[64:67], a[0:3], a[64:67], v[64:67]
  ds_read_b64_tr_b16 a[32:33], v236 offset:17408
  s_add_u32 m0, s98, 0
  s_mul_i32 s68, s88, 131072
  s_mul_i32 s31, s93, 524288
  s_add_u32 s68, s68, s31
  s_add_u32 s31, s68, 0
  v_mfma_f32_16x16x32_bf16 v[64:67], a[4:7], a[80:83], v[64:67]
  buffer_load_dwordx4 v19, s[40:43], s31 offen offset:0 lds
  v_mfma_f32_16x16x32_bf16 v[96:99], a[4:7], a[84:87], v[96:99]
  ds_read_b64_tr_b16 a[34:35], v236 offset:21504
  v_mfma_f32_16x16x32_bf16 v[96:99], a[0:3], a[68:71], v[96:99]
  v_mfma_f32_16x16x32_bf16 v[128:131], a[0:3], a[72:75], v[128:131]
  ds_read_b64_tr_b16 a[36:37], v236 offset:25600
  s_add_u32 m0, s98, 896
  v_mfma_f32_16x16x32_bf16 v[128:131], a[4:7], a[88:91], v[128:131]
  buffer_load_dwordx4 v19, s[40:43], s31 offen offset:128 lds
  v_mfma_f32_16x16x32_bf16 v[160:163], a[4:7], a[92:95], v[160:163]
  ds_read_b64_tr_b16 a[38:39], v236 offset:29696
  v_mfma_f32_16x16x32_bf16 v[160:163], a[0:3], a[76:79], v[160:163]
  v_mfma_f32_16x16x32_bf16 v[164:167], a[8:11], a[76:79], v[164:167]
  ds_read_b64_tr_b16 a[40:41], v237 offset:17408
  s_add_u32 m0, s98, 2048
  s_add_u32 s31, s68, 16384
  v_mfma_f32_16x16x32_bf16 v[164:167], a[12:15], a[92:95], v[164:167]
  buffer_load_dwordx4 v19, s[40:43], s31 offen offset:0 lds
  v_mfma_f32_16x16x32_bf16 v[132:135], a[12:15], a[88:91], v[132:135]
  ds_read_b64_tr_b16 a[42:43], v237 offset:21504
  v_mfma_f32_16x16x32_bf16 v[132:135], a[8:11], a[72:75], v[132:135]
  v_mfma_f32_16x16x32_bf16 v[100:103], a[8:11], a[68:71], v[100:103]
  ds_read_b64_tr_b16 a[44:45], v237 offset:25600
  s_add_u32 m0, s98, 2944
  v_mfma_f32_16x16x32_bf16 v[100:103], a[12:15], a[84:87], v[100:103]
  buffer_load_dwordx4 v19, s[40:43], s31 offen offset:128 lds
  v_mfma_f32_16x16x32_bf16 v[68:71], a[12:15], a[80:83], v[68:71]
  ds_read_b64_tr_b16 a[46:47], v237 offset:29696
  v_mfma_f32_16x16x32_bf16 v[68:71], a[8:11], a[64:67], v[68:71]
  s_waitcnt lgkmcnt(8)
  v_mfma_f32_16x16x32_bf16 v[72:75], a[16:19], a[64:67], v[72:75]
  ds_read_b64_tr_b16 a[48:49], v238 offset:17408
  s_add_u32 s30, s81, 55296
  v_mfma_f32_16x16x32_bf16 v[72:75], a[20:23], a[80:83], v[72:75]
  buffer_load_dwordx4 a[160:163], v16, s[4:7], s30 offen offset:0 sc1
  v_mfma_f32_16x16x32_bf16 v[104:107], a[20:23], a[84:87], v[104:107]
  ds_read_b64_tr_b16 a[50:51], v238 offset:21504
  v_mfma_f32_16x16x32_bf16 v[104:107], a[16:19], a[68:71], v[104:107]
  v_mfma_f32_16x16x32_bf16 v[136:139], a[16:19], a[72:75], v[136:139]
  ds_read_b64_tr_b16 a[52:53], v238 offset:25600
  v_mfma_f32_16x16x32_bf16 v[136:139], a[20:23], a[88:91], v[136:139]
  buffer_load_dwordx4 a[176:179], v16, s[4:7], s30 offen offset:1024 sc1
  v_mfma_f32_16x16x32_bf16 v[168:171], a[20:23], a[92:95], v[168:171]
  ds_read_b64_tr_b16 a[54:55], v238 offset:29696
  v_mfma_f32_16x16x32_bf16 v[168:171], a[16:19], a[76:79], v[168:171]
  v_mfma_f32_16x16x32_bf16 v[172:175], a[24:27], a[76:79], v[172:175]
  ds_read_b64_tr_b16 a[56:57], v239 offset:17408
  v_mfma_f32_16x16x32_bf16 v[172:175], a[28:31], a[92:95], v[172:175]
  buffer_load_dwordx4 a[168:171], v7, s[4:7], s30 offen offset:0 sc1
  v_mfma_f32_16x16x32_bf16 v[140:143], a[28:31], a[88:91], v[140:143]
  ds_read_b64_tr_b16 a[58:59], v239 offset:21504
  v_mfma_f32_16x16x32_bf16 v[140:143], a[24:27], a[72:75], v[140:143]
  v_mfma_f32_16x16x32_bf16 v[108:111], a[24:27], a[68:71], v[108:111]
  ds_read_b64_tr_b16 a[60:61], v239 offset:25600
  v_mfma_f32_16x16x32_bf16 v[108:111], a[28:31], a[84:87], v[108:111]
  v_mfma_f32_16x16x32_bf16 v[76:79], a[28:31], a[80:83], v[76:79]
  ds_read_b64_tr_b16 a[62:63], v239 offset:29696
  v_mfma_f32_16x16x32_bf16 v[76:79], a[24:27], a[64:67], v[76:79]
  s_waitcnt vmcnt(27) lgkmcnt(8)
  s_barrier
  v_mfma_f32_16x16x32_bf16 v[80:83], a[32:35], a[64:67], v[80:83]
  ds_read_b64_tr_b16 a[0:1], v236 offset:32768
  buffer_load_dword v33, v27, s[16:19], 0 offen sc1
  v_mfma_f32_16x16x32_bf16 v[80:83], a[36:39], a[80:83], v[80:83]
  buffer_load_dwordx4 a[184:187], v7, s[4:7], s30 offen offset:1024 sc1
  v_mfma_f32_16x16x32_bf16 v[112:115], a[36:39], a[84:87], v[112:115]
  ds_read_b64_tr_b16 a[2:3], v236 offset:36864
  v_mfma_f32_16x16x32_bf16 v[112:115], a[32:35], a[68:71], v[112:115]
  v_mfma_f32_16x16x32_bf16 v[144:147], a[32:35], a[72:75], v[144:147]
  ds_read_b64_tr_b16 a[4:5], v236 offset:40960
  s_add_u32 s30, s81, 203264
  v_mfma_f32_16x16x32_bf16 v[144:147], a[36:39], a[88:91], v[144:147]
  buffer_load_dwordx4 a[164:167], v16, s[4:7], s30 offen offset:0 sc1
  v_mfma_f32_16x16x32_bf16 v[176:179], a[36:39], a[92:95], v[176:179]
  ds_read_b64_tr_b16 a[6:7], v236 offset:45056
  v_mfma_f32_16x16x32_bf16 v[176:179], a[32:35], a[76:79], v[176:179]
  v_mfma_f32_16x16x32_bf16 v[180:183], a[40:43], a[76:79], v[180:183]
  ds_read_b64_tr_b16 a[8:9], v237 offset:32768
  v_mfma_f32_16x16x32_bf16 v[180:183], a[44:47], a[92:95], v[180:183]
  buffer_load_dwordx4 a[180:183], v16, s[4:7], s30 offen offset:1024 sc1
Lg_pad10:
  s_cbranch_execz Lg_ret1
  s_nop 0
  v_mfma_f32_16x16x32_bf16 v[148:151], a[44:47], a[88:91], v[148:151]
  ds_read_b64_tr_b16 a[10:11], v237 offset:36864
  v_mfma_f32_16x16x32_bf16 v[148:151], a[40:43], a[72:75], v[148:151]
  v_mfma_f32_16x16x32_bf16 v[116:119], a[40:43], a[68:71], v[116:119]
  ds_read_b64_tr_b16 a[12:13], v237 offset:40960
  v_mfma_f32_16x16x32_bf16 v[116:119], a[44:47], a[84:87], v[116:119]
  buffer_load_dwordx4 a[172:175], v7, s[4:7], s30 offen offset:0 sc1
  v_mfma_f32_16x16x32_bf16 v[84:87], a[44:47], a[80:83], v[84:87]
  ds_read_b64_tr_b16 a[14:15], v237 offset:45056
  v_mfma_f32_16x16x32_bf16 v[84:87], a[40:43], a[64:67], v[84:87]
  s_waitcnt lgkmcnt(8)
  v_mfma_f32_16x16x32_bf16 v[88:91], a[48:51], a[64:67], v[88:91]
  ds_read_b64_tr_b16 a[16:17], v238 offset:32768
  v_mfma_f32_16x16x32_bf16 v[88:91], a[52:55], a[80:83], v[88:91]
  buffer_load_dwordx4 a[188:191], v7, s[4:7], s30 offen offset:1024 sc1
  v_mfma_f32_16x16x32_bf16 v[120:123], a[52:55], a[84:87], v[120:123]
  ds_read_b64_tr_b16 a[18:19], v238 offset:36864
  v_mfma_f32_16x16x32_bf16 v[120:123], a[48:51], a[68:71], v[120:123]
  v_mfma_f32_16x16x32_bf16 v[152:155], a[48:51], a[72:75], v[152:155]
  ds_read_b64_tr_b16 a[20:21], v238 offset:40960
  s_add_u32 m0, s98, 16384
  s_mul_i32 s69, s89, 131072
  s_mul_i32 s31, s93, 524288
  s_add_u32 s69, s69, s31
  s_add_u32 s31, s69, 131072
  v_mfma_f32_16x16x32_bf16 v[152:155], a[52:55], a[88:91], v[152:155]
  buffer_load_dwordx4 v19, s[40:43], s31 offen offset:0 lds
  v_mfma_f32_16x16x32_bf16 v[184:187], a[52:55], a[92:95], v[184:187]
  ds_read_b64_tr_b16 a[22:23], v238 offset:45056
  v_mfma_f32_16x16x32_bf16 v[184:187], a[48:51], a[76:79], v[184:187]
  v_mfma_f32_16x16x32_bf16 v[188:191], a[56:59], a[76:79], v[188:191]
  ds_read_b64_tr_b16 a[24:25], v239 offset:32768
  s_add_u32 m0, s98, 17280
  v_mfma_f32_16x16x32_bf16 v[188:191], a[60:63], a[92:95], v[188:191]
  buffer_load_dwordx4 v19, s[40:43], s31 offen offset:128 lds
  v_mfma_f32_16x16x32_bf16 v[156:159], a[60:63], a[88:91], v[156:159]
  ds_read_b64_tr_b16 a[26:27], v239 offset:36864
  v_mfma_f32_16x16x32_bf16 v[156:159], a[56:59], a[72:75], v[156:159]
  v_mfma_f32_16x16x32_bf16 v[124:127], a[56:59], a[68:71], v[124:127]
  ds_read_b64_tr_b16 a[28:29], v239 offset:40960
  v_mfma_f32_16x16x32_bf16 v[124:127], a[60:63], a[84:87], v[124:127]
  v_mfma_f32_16x16x32_bf16 v[92:95], a[60:63], a[80:83], v[92:95]
  ds_read_b64_tr_b16 a[30:31], v239 offset:45056
  v_mfma_f32_16x16x32_bf16 v[92:95], a[56:59], a[64:67], v[92:95]
  s_waitcnt vmcnt(27) lgkmcnt(8)
  v_mfma_f32_16x16x32_bf16 v[64:67], a[0:3], a[96:99], v[64:67]
  ds_read_b64_tr_b16 a[32:33], v236 offset:33792
  s_add_u32 m0, s98, 18432
  s_add_u32 s31, s69, 147456
  v_mfma_f32_16x16x32_bf16 v[64:67], a[4:7], a[112:115], v[64:67]
  buffer_load_dwordx4 v19, s[40:43], s31 offen offset:0 lds
  v_mfma_f32_16x16x32_bf16 v[96:99], a[4:7], a[116:119], v[96:99]
  ds_read_b64_tr_b16 a[34:35], v236 offset:37888
  v_mfma_f32_16x16x32_bf16 v[96:99], a[0:3], a[100:103], v[96:99]
  v_mfma_f32_16x16x32_bf16 v[128:131], a[0:3], a[104:107], v[128:131]
  ds_read_b64_tr_b16 a[36:37], v236 offset:41984
  s_add_u32 m0, s98, 19328
  v_mfma_f32_16x16x32_bf16 v[128:131], a[4:7], a[120:123], v[128:131]
  buffer_load_dwordx4 v19, s[40:43], s31 offen offset:128 lds
  v_mfma_f32_16x16x32_bf16 v[160:163], a[4:7], a[124:127], v[160:163]
  ds_read_b64_tr_b16 a[38:39], v236 offset:46080
  v_mfma_f32_16x16x32_bf16 v[160:163], a[0:3], a[108:111], v[160:163]
  v_mfma_f32_16x16x32_bf16 v[164:167], a[8:11], a[108:111], v[164:167]
  ds_read_b64_tr_b16 a[40:41], v237 offset:33792
  s_add_u32 m0, s98, 32768
  s_mul_i32 s68, s88, 131072
  s_mul_i32 s31, s92, 524288
  s_add_u32 s68, s68, s31
  s_add_u32 s31, s68, 262144
  v_mfma_f32_16x16x32_bf16 v[164:167], a[12:15], a[124:127], v[164:167]
  buffer_load_dwordx4 v19, s[40:43], s31 offen offset:0 lds
  v_mfma_f32_16x16x32_bf16 v[132:135], a[12:15], a[120:123], v[132:135]
  ds_read_b64_tr_b16 a[42:43], v237 offset:37888
  v_mfma_f32_16x16x32_bf16 v[132:135], a[8:11], a[104:107], v[132:135]
  v_mfma_f32_16x16x32_bf16 v[100:103], a[8:11], a[100:103], v[100:103]
  ds_read_b64_tr_b16 a[44:45], v237 offset:41984
  s_add_u32 m0, s98, 33664
  v_mfma_f32_16x16x32_bf16 v[100:103], a[12:15], a[116:119], v[100:103]
  buffer_load_dwordx4 v19, s[40:43], s31 offen offset:128 lds
  v_mfma_f32_16x16x32_bf16 v[68:71], a[12:15], a[112:115], v[68:71]
  ds_read_b64_tr_b16 a[46:47], v237 offset:46080
  v_mfma_f32_16x16x32_bf16 v[68:71], a[8:11], a[96:99], v[68:71]
  s_waitcnt lgkmcnt(8)
  v_mfma_f32_16x16x32_bf16 v[72:75], a[16:19], a[96:99], v[72:75]
  ds_read_b64_tr_b16 a[48:49], v238 offset:33792
  s_add_u32 m0, s98, 34816
  s_add_u32 s31, s68, 278528
  v_mfma_f32_16x16x32_bf16 v[72:75], a[20:23], a[112:115], v[72:75]
  buffer_load_dwordx4 v19, s[40:43], s31 offen offset:0 lds
  v_mfma_f32_16x16x32_bf16 v[104:107], a[20:23], a[116:119], v[104:107]
  ds_read_b64_tr_b16 a[50:51], v238 offset:37888
  v_mfma_f32_16x16x32_bf16 v[104:107], a[16:19], a[100:103], v[104:107]
  v_mfma_f32_16x16x32_bf16 v[136:139], a[16:19], a[104:107], v[136:139]
  ds_read_b64_tr_b16 a[52:53], v238 offset:41984
  s_add_u32 m0, s98, 35712
  v_mfma_f32_16x16x32_bf16 v[136:139], a[20:23], a[120:123], v[136:139]
  buffer_load_dwordx4 v19, s[40:43], s31 offen offset:128 lds
  v_mfma_f32_16x16x32_bf16 v[168:171], a[20:23], a[124:127], v[168:171]
  ds_read_b64_tr_b16 a[54:55], v238 offset:46080
  v_mfma_f32_16x16x32_bf16 v[168:171], a[16:19], a[108:111], v[168:171]
  v_mfma_f32_16x16x32_bf16 v[172:175], a[24:27], a[108:111], v[172:175]
  ds_read_b64_tr_b16 a[56:57], v239 offset:33792
  s_add_u32 m0, s98, 49152
  s_mul_i32 s69, s89, 131072
  s_mul_i32 s31, s92, 524288
  s_add_u32 s69, s69, s31
  s_add_u32 s31, s69, 393216
  v_mfma_f32_16x16x32_bf16 v[172:175], a[28:31], a[124:127], v[172:175]
  buffer_load_dwordx4 v19, s[40:43], s31 offen offset:0 lds
  v_mfma_f32_16x16x32_bf16 v[140:143], a[28:31], a[120:123], v[140:143]
  ds_read_b64_tr_b16 a[58:59], v239 offset:37888
  v_mfma_f32_16x16x32_bf16 v[140:143], a[24:27], a[104:107], v[140:143]
  v_mfma_f32_16x16x32_bf16 v[108:111], a[24:27], a[100:103], v[108:111]
  ds_read_b64_tr_b16 a[60:61], v239 offset:41984
  v_mfma_f32_16x16x32_bf16 v[108:111], a[28:31], a[116:119], v[108:111]
  v_mfma_f32_16x16x32_bf16 v[76:79], a[28:31], a[112:115], v[76:79]
  ds_read_b64_tr_b16 a[62:63], v239 offset:46080
  v_mfma_f32_16x16x32_bf16 v[76:79], a[24:27], a[96:99], v[76:79]
  v_mfma_f32_16x16x32_bf16 v[64:67], v[200:203], a[208:211], v[64:67]
  v_mfma_f32_16x16x32_bf16 v[96:99], v[200:203], a[224:227], v[96:99]
  v_mfma_f32_16x16x32_bf16 v[68:71], v[204:207], a[208:211], v[68:71]
  v_mfma_f32_16x16x32_bf16 v[100:103], v[204:207], a[224:227], v[100:103]
  v_mfma_f32_16x16x32_bf16 v[72:75], v[200:203], a[212:215], v[72:75]
  v_mfma_f32_16x16x32_bf16 v[104:107], v[200:203], a[228:231], v[104:107]
  v_mfma_f32_16x16x32_bf16 v[76:79], v[204:207], a[212:215], v[76:79]
  v_mfma_f32_16x16x32_bf16 v[108:111], v[204:207], a[228:231], v[108:111]
  v_mfma_f32_16x16x32_bf16 v[80:83], v[200:203], a[216:219], v[80:83]
  v_mfma_f32_16x16x32_bf16 v[112:115], v[200:203], a[232:235], v[112:115]
  v_mfma_f32_16x16x32_bf16 v[84:87], v[204:207], a[216:219], v[84:87]
  v_mfma_f32_16x16x32_bf16 v[116:119], v[204:207], a[232:235], v[116:119]
  v_mfma_f32_16x16x32_bf16 v[88:91], v[200:203], a[220:223], v[88:91]
  v_mfma_f32_16x16x32_bf16 v[120:123], v[200:203], a[236:239], v[120:123]
  v_mfma_f32_16x16x32_bf16 v[92:95], v[204:207], a[220:223], v[92:95]
  v_mfma_f32_16x16x32_bf16 v[124:127], v[204:207], a[236:239], v[124:127]
  s_waitcnt vmcnt(14) lgkmcnt(8)
  v_mfma_f32_16x16x32_bf16 v[80:83], a[32:35], a[96:99], v[80:83]
  ds_read_b64_tr_b16 a[0:1], v236 offset:49152
  v_cmp_eq_u32 vcc, 0, v33
  s_cbranch_vccnz Lg_g0_slow
Lg_g0_back:
  s_mul_i32 s80, s88, 2048
  s_mul_i32 s30, s93, 8192
  s_add_u32 s80, s80, s30
  s_add_u32 s30, s80, 0
  v_mfma_f32_16x16x32_bf16 v[80:83], a[36:39], a[112:115], v[80:83]
  buffer_load_dwordx4 a[64:67], v16, s[4:7], s30 offen offset:0 sc1
  v_mfma_f32_16x16x32_bf16 v[112:115], a[36:39], a[116:119], v[112:115]
  ds_read_b64_tr_b16 a[2:3], v236 offset:53248
  v_mfma_f32_16x16x32_bf16 v[112:115], a[32:35], a[100:103], v[112:115]
  v_mfma_f32_16x16x32_bf16 v[144:147], a[32:35], a[104:107], v[144:147]
  ds_read_b64_tr_b16 a[4:5], v236 offset:57344
  v_mfma_f32_16x16x32_bf16 v[144:147], a[36:39], a[120:123], v[144:147]
  buffer_load_dwordx4 a[80:83], v16, s[4:7], s30 offen offset:1024 sc1
  v_mfma_f32_16x16x32_bf16 v[176:179], a[36:39], a[124:127], v[176:179]
  ds_read_b64_tr_b16 a[6:7], v236 offset:61440
  v_mfma_f32_16x16x32_bf16 v[176:179], a[32:35], a[108:111], v[176:179]
  v_mfma_f32_16x16x32_bf16 v[180:183], a[40:43], a[108:111], v[180:183]
  ds_read_b64_tr_b16 a[8:9], v237 offset:49152
  v_mfma_f32_16x16x32_bf16 v[180:183], a[44:47], a[124:127], v[180:183]
  buffer_load_dwordx4 a[72:75], v7, s[4:7], s30 offen offset:0 sc1
  v_mfma_f32_16x16x32_bf16 v[148:151], a[44:47], a[120:123], v[148:151]
  ds_read_b64_tr_b16 a[10:11], v237 offset:53248
  v_mfma_f32_16x16x32_bf16 v[148:151], a[40:43], a[104:107], v[148:151]
  v_mfma_f32_16x16x32_bf16 v[116:119], a[40:43], a[100:103], v[116:119]
  ds_read_b64_tr_b16 a[12:13], v237 offset:57344
  v_mfma_f32_16x16x32_bf16 v[116:119], a[44:47], a[116:119], v[116:119]
  buffer_load_dwordx4 a[88:91], v7, s[4:7], s30 offen offset:1024 sc1
  v_mfma_f32_16x16x32_bf16 v[84:87], a[44:47], a[112:115], v[84:87]
  ds_read_b64_tr_b16 a[14:15], v237 offset:61440
  v_mfma_f32_16x16x32_bf16 v[84:87], a[40:43], a[96:99], v[84:87]
  s_waitcnt lgkmcnt(8)
  v_mfma_f32_16x16x32_bf16 v[88:91], a[48:51], a[96:99], v[88:91]
  ds_read_b64_tr_b16 a[16:17], v238 offset:49152
  s_add_u32 s30, s80, 147968
  v_mfma_f32_16x16x32_bf16 v[88:91], a[52:55], a[112:115], v[88:91]
  buffer_load_dwordx4 a[68:71], v16, s[4:7], s30 offen offset:0 sc1
  v_mfma_f32_16x16x32_bf16 v[120:123], a[52:55], a[116:119], v[120:123]
  ds_read_b64_tr_b16 a[18:19], v238 offset:53248
  v_mfma_f32_16x16x32_bf16 v[120:123], a[48:51], a[100:103], v[120:123]
  v_mfma_f32_16x16x32_bf16 v[152:155], a[48:51], a[104:107], v[152:155]
  ds_read_b64_tr_b16 a[20:21], v238 offset:57344
  v_mfma_f32_16x16x32_bf16 v[152:155], a[52:55], a[120:123], v[152:155]
  buffer_load_dwordx4 a[84:87], v16, s[4:7], s30 offen offset:1024 sc1
  v_mfma_f32_16x16x32_bf16 v[184:187], a[52:55], a[124:127], v[184:187]
  ds_read_b64_tr_b16 a[22:23], v238 offset:61440
  v_mfma_f32_16x16x32_bf16 v[184:187], a[48:51], a[108:111], v[184:187]
  v_mfma_f32_16x16x32_bf16 v[188:191], a[56:59], a[108:111], v[188:191]
  ds_read_b64_tr_b16 a[24:25], v239 offset:49152
  v_mfma_f32_16x16x32_bf16 v[188:191], a[60:63], a[124:127], v[188:191]
  buffer_load_dwordx4 a[76:79], v7, s[4:7], s30 offen offset:0 sc1
  v_mfma_f32_16x16x32_bf16 v[156:159], a[60:63], a[120:123], v[156:159]
  ds_read_b64_tr_b16 a[26:27], v239 offset:53248
  v_mfma_f32_16x16x32_bf16 v[156:159], a[56:59], a[104:107], v[156:159]
  v_mfma_f32_16x16x32_bf16 v[124:127], a[56:59], a[100:103], v[124:127]
  ds_read_b64_tr_b16 a[28:29], v239 offset:57344
  v_mfma_f32_16x16x32_bf16 v[124:127], a[60:63], a[116:119], v[124:127]
  v_mfma_f32_16x16x32_bf16 v[92:95], a[60:63], a[112:115], v[92:95]
  ds_read_b64_tr_b16 a[30:31], v239 offset:61440
  v_mfma_f32_16x16x32_bf16 v[92:95], a[56:59], a[96:99], v[92:95]
  s_waitcnt lgkmcnt(8)
  v_mfma_f32_16x16x32_bf16 v[64:67], a[0:3], a[128:131], v[64:67]
  ds_read_b64_tr_b16 a[32:33], v236 offset:50176
  v_mfma_f32_16x16x32_bf16 v[64:67], a[4:7], a[144:147], v[64:67]
  buffer_load_dwordx4 a[92:95], v7, s[4:7], s30 offen offset:1024 sc1
  v_mfma_f32_16x16x32_bf16 v[96:99], a[4:7], a[148:151], v[96:99]
  ds_read_b64_tr_b16 a[34:35], v236 offset:54272
  v_mfma_f32_16x16x32_bf16 v[96:99], a[0:3], a[132:135], v[96:99]
  v_mfma_f32_16x16x32_bf16 v[128:131], a[0:3], a[136:139], v[128:131]
  ds_read_b64_tr_b16 a[36:37], v236 offset:58368
  s_mul_i32 s81, s89, 2048
  s_mul_i32 s30, s93, 8192
  s_add_u32 s81, s81, s30
  s_add_u32 s30, s81, 2048
  v_mfma_f32_16x16x32_bf16 v[128:131], a[4:7], a[152:155], v[128:131]
  buffer_load_dwordx4 a[96:99], v16, s[4:7], s30 offen offset:0 sc1
  v_mfma_f32_16x16x32_bf16 v[160:163], a[4:7], a[156:159], v[160:163]
  ds_read_b64_tr_b16 a[38:39], v236 offset:62464
  v_mfma_f32_16x16x32_bf16 v[160:163], a[0:3], a[140:143], v[160:163]
  v_mfma_f32_16x16x32_bf16 v[164:167], a[8:11], a[140:143], v[164:167]
  ds_read_b64_tr_b16 a[40:41], v237 offset:50176
  v_mfma_f32_16x16x32_bf16 v[164:167], a[12:15], a[156:159], v[164:167]
  buffer_load_dwordx4 a[112:115], v16, s[4:7], s30 offen offset:1024 sc1
  v_mfma_f32_16x16x32_bf16 v[132:135], a[12:15], a[152:155], v[132:135]
  ds_read_b64_tr_b16 a[42:43], v237 offset:54272
  v_mfma_f32_16x16x32_bf16 v[132:135], a[8:11], a[136:139], v[132:135]
  v_mfma_f32_16x16x32_bf16 v[100:103], a[8:11], a[132:135], v[100:103]
  ds_read_b64_tr_b16 a[44:45], v237 offset:58368
  v_mfma_f32_16x16x32_bf16 v[100:103], a[12:15], a[148:151], v[100:103]
  buffer_load_dwordx4 a[104:107], v7, s[4:7], s30 offen offset:0 sc1
  v_mfma_f32_16x16x32_bf16 v[68:71], a[12:15], a[144:147], v[68:71]
  ds_read_b64_tr_b16 a[46:47], v237 offset:62464
  v_mfma_f32_16x16x32_bf16 v[68:71], a[8:11], a[128:131], v[68:71]
  s_waitcnt lgkmcnt(8)
  v_mfma_f32_16x16x32_bf16 v[72:75], a[16:19], a[128:131], v[72:75]
  ds_read_b64_tr_b16 a[48:49], v238 offset:50176
  v_mfma_f32_16x16x32_bf16 v[72:75], a[20:23], a[144:147], v[72:75]
  buffer_load_dwordx4 a[120:123], v7, s[4:7], s30 offen offset:1024 sc1
  v_mfma_f32_16x16x32_bf16 v[104:107], a[20:23], a[148:151], v[104:107]
  ds_read_b64_tr_b16 a[50:51], v238 offset:54272
  v_mfma_f32_16x16x32_bf16 v[104:107], a[16:19], a[132:135], v[104:107]
  v_mfma_f32_16x16x32_bf16 v[136:139], a[16:19], a[136:139], v[136:139]
  ds_read_b64_tr_b16 a[52:53], v238 offset:58368
  s_add_u32 s30, s81, 150016
  v_mfma_f32_16x16x32_bf16 v[136:139], a[20:23], a[152:155], v[136:139]
  buffer_load_dwordx4 a[100:103], v16, s[4:7], s30 offen offset:0 sc1
  v_mfma_f32_16x16x32_bf16 v[168:171], a[20:23], a[156:159], v[168:171]
  ds_read_b64_tr_b16 a[54:55], v238 offset:62464
  v_mfma_f32_16x16x32_bf16 v[168:171], a[16:19], a[140:143], v[168:171]
  v_mfma_f32_16x16x32_bf16 v[172:175], a[24:27], a[140:143], v[172:175]
  ds_read_b64_tr_b16 a[56:57], v239 offset:50176
  v_mfma_f32_16x16x32_bf16 v[172:175], a[28:31], a[156:159], v[172:175]
  buffer_load_dwordx4 a[116:119], v16, s[4:7], s30 offen offset:1024 sc1
  v_mfma_f32_16x16x32_bf16 v[140:143], a[28:31], a[152:155], v[140:143]
  ds_read_b64_tr_b16 a[58:59], v239 offset:54272
  v_mfma_f32_16x16x32_bf16 v[140:143], a[24:27], a[136:139], v[140:143]
  v_mfma_f32_16x16x32_bf16 v[108:111], a[24:27], a[132:135], v[108:111]
  ds_read_b64_tr_b16 a[60:61], v239 offset:58368
  v_mfma_f32_16x16x32_bf16 v[108:111], a[28:31], a[148:151], v[108:111]
  v_mfma_f32_16x16x32_bf16 v[76:79], a[28:31], a[144:147], v[76:79]
  ds_read_b64_tr_b16 a[62:63], v239 offset:62464
  v_mfma_f32_16x16x32_bf16 v[76:79], a[24:27], a[128:131], v[76:79]
  s_waitcnt lgkmcnt(8)
  s_barrier
  v_mfma_f32_16x16x32_bf16 v[80:83], a[32:35], a[128:131], v[80:83]
  ds_read_b64_tr_b16 a[0:1], v240 offset:0
  v_mfma_f32_16x16x32_bf16 v[80:83], a[36:39], a[144:147], v[80:83]
  buffer_load_dwordx4 a[108:111], v7, s[4:7], s30 offen offset:0 sc1
  v_mfma_f32_16x16x32_bf16 v[112:115], a[36:39], a[148:151], v[112:115]
  ds_read_b64_tr_b16 a[2:3], v240 offset:4096
  v_mfma_f32_16x16x32_bf16 v[112:115], a[32:35], a[132:135], v[112:115]
  v_mfma_f32_16x16x32_bf16 v[144:147], a[32:35], a[136:139], v[144:147]
  ds_read_b64_tr_b16 a[4:5], v240 offset:8192
  v_mfma_f32_16x16x32_bf16 v[144:147], a[36:39], a[152:155], v[144:147]
  buffer_load_dwordx4 a[124:127], v7, s[4:7], s30 offen offset:1024 sc1
  v_mfma_f32_16x16x32_bf16 v[176:179], a[36:39], a[156:159], v[176:179]
  ds_read_b64_tr_b16 a[6:7], v240 offset:12288
  v_mfma_f32_16x16x32_bf16 v[176:179], a[32:35], a[140:143], v[176:179]
  v_mfma_f32_16x16x32_bf16 v[180:183], a[40:43], a[140:143], v[180:183]
  ds_read_b64_tr_b16 a[8:9], v241 offset:0
  s_add_u32 m0, s98, 50048
  v_mfma_f32_16x16x32_bf16 v[180:183], a[44:47], a[156:159], v[180:183]
  buffer_load_dwordx4 v19, s[40:43], s31 offen offset:128 lds
  v_mfma_f32_16x16x32_bf16 v[148:151], a[44:47], a[152:155], v[148:151]
  ds_read_b64_tr_b16 a[10:11], v241 offset:4096
  v_mfma_f32_16x16x32_bf16 v[148:151], a[40:43], a[136:139], v[148:151]
  v_mfma_f32_16x16x32_bf16 v[116:119], a[40:43], a[132:135], v[116:119]
  ds_read_b64_tr_b16 a[12:13], v241 offset:8192
  s_add_u32 m0, s98, 51200
  s_add_u32 s31, s69, 409600
  v_mfma_f32_16x16x32_bf16 v[116:119], a[44:47], a[148:151], v[116:119]
  buffer_load_dwordx4 v19, s[40:43], s31 offen offset:0 lds
  v_mfma_f32_16x16x32_bf16 v[84:87], a[44:47], a[144:147], v[84:87]
  ds_read_b64_tr_b16 a[14:15], v241 offset:12288
  v_mfma_f32_16x16x32_bf16 v[84:87], a[40:43], a[128:131], v[84:87]
  s_waitcnt lgkmcnt(8)
  v_mfma_f32_16x16x32_bf16 v[88:91], a[48:51], a[128:131], v[88:91]
  ds_read_b64_tr_b16 a[16:17], v242 offset:0
  s_add_u32 m0, s98, 52096
  v_mfma_f32_16x16x32_bf16 v[88:91], a[52:55], a[144:147], v[88:91]
  buffer_load_dwordx4 v19, s[40:43], s31 offen offset:128 lds
  v_mfma_f32_16x16x32_bf16 v[120:123], a[52:55], a[148:151], v[120:123]
  ds_read_b64_tr_b16 a[18:19], v242 offset:4096
  v_mfma_f32_16x16x32_bf16 v[120:123], a[48:51], a[132:135], v[120:123]
  v_mfma_f32_16x16x32_bf16 v[152:155], a[48:51], a[136:139], v[152:155]
  ds_read_b64_tr_b16 a[20:21], v242 offset:8192
  s_add_u32 m0, s98, 65536
  s_add_u32 s31, s68, 1310720
  v_mfma_f32_16x16x32_bf16 v[152:155], a[52:55], a[152:155], v[152:155]
  buffer_load_dwordx4 v19, s[40:43], s31 offen offset:0 lds
  v_mfma_f32_16x16x32_bf16 v[184:187], a[52:55], a[156:159], v[184:187]
  ds_read_b64_tr_b16 a[22:23], v242 offset:12288
  v_mfma_f32_16x16x32_bf16 v[184:187], a[48:51], a[140:143], v[184:187]
  v_mfma_f32_16x16x32_bf16 v[188:191], a[56:59], a[140:143], v[188:191]
  ds_read_b64_tr_b16 a[24:25], v243 offset:0
  s_add_u32 m0, s98, 66432
  v_mfma_f32_16x16x32_bf16 v[188:191], a[60:63], a[156:159], v[188:191]
  buffer_load_dwordx4 v19, s[40:43], s31 offen offset:128 lds
  v_mfma_f32_16x16x32_bf16 v[156:159], a[60:63], a[152:155], v[156:159]
  ds_read_b64_tr_b16 a[26:27], v243 offset:4096
  v_mfma_f32_16x16x32_bf16 v[156:159], a[56:59], a[136:139], v[156:159]
  v_mfma_f32_16x16x32_bf16 v[124:127], a[56:59], a[132:135], v[124:127]
  ds_read_b64_tr_b16 a[28:29], v243 offset:8192
  v_mfma_f32_16x16x32_bf16 v[124:127], a[60:63], a[148:151], v[124:127]
  v_mfma_f32_16x16x32_bf16 v[92:95], a[60:63], a[144:147], v[92:95]
  ds_read_b64_tr_b16 a[30:31], v243 offset:12288
  v_mfma_f32_16x16x32_bf16 v[92:95], a[56:59], a[128:131], v[92:95]
  s_waitcnt vmcnt(30) lgkmcnt(8)
  v_mfma_f32_16x16x32_bf16 v[64:67], a[0:3], a[160:163], v[64:67]
  ds_read_b64_tr_b16 a[32:33], v240 offset:1024
  s_mul_i32 s80, s88, 2048
  s_mul_i32 s30, s92, 8192
  s_add_u32 s80, s80, s30
  s_add_u32 s30, s80, 4096
  v_mfma_f32_16x16x32_bf16 v[64:67], a[4:7], a[176:179], v[64:67]
  buffer_load_dwordx4 a[128:131], v16, s[4:7], s30 offen offset:0 sc1
  v_mfma_f32_16x16x32_bf16 v[96:99], a[4:7], a[180:183], v[96:99]
  ds_read_b64_tr_b16 a[34:35], v240 offset:5120
  v_mfma_f32_16x16x32_bf16 v[96:99], a[0:3], a[164:167], v[96:99]
  v_mfma_f32_16x16x32_bf16 v[128:131], a[0:3], a[168:171], v[128:131]
  ds_read_b64_tr_b16 a[36:37], v240 offset:9216
  v_mfma_f32_16x16x32_bf16 v[128:131], a[4:7], a[184:187], v[128:131]
  buffer_load_dwordx4 a[136:139], v16, s[4:7], s30 offen offset:1024 sc1
  v_mfma_f32_16x16x32_bf16 v[160:163], a[4:7], a[188:191], v[160:163]
  ds_read_b64_tr_b16 a[38:39], v240 offset:13312
  v_mfma_f32_16x16x32_bf16 v[160:163], a[0:3], a[172:175], v[160:163]
  v_mfma_f32_16x16x32_bf16 v[164:167], a[8:11], a[172:175], v[164:167]
  ds_read_b64_tr_b16 a[40:41], v241 offset:1024
  s_add_u32 s30, s80, 152064
  v_mfma_f32_16x16x32_bf16 v[164:167], a[12:15], a[188:191], v[164:167]
  buffer_load_dwordx4 a[132:135], v16, s[4:7], s30 offen offset:0 sc1
  v_mfma_f32_16x16x32_bf16 v[132:135], a[12:15], a[184:187], v[132:135]
  ds_read_b64_tr_b16 a[42:43], v241 offset:5120
  v_mfma_f32_16x16x32_bf16 v[132:135], a[8:11], a[168:171], v[132:135]
  v_mfma_f32_16x16x32_bf16 v[100:103], a[8:11], a[164:167], v[100:103]
  ds_read_b64_tr_b16 a[44:45], v241 offset:9216
  v_mfma_f32_16x16x32_bf16 v[100:103], a[12:15], a[180:183], v[100:103]
  buffer_load_dwordx4 a[140:143], v16, s[4:7], s30 offen offset:1024 sc1
  v_mfma_f32_16x16x32_bf16 v[68:71], a[12:15], a[176:179], v[68:71]
  ds_read_b64_tr_b16 a[46:47], v241 offset:13312
  v_mfma_f32_16x16x32_bf16 v[68:71], a[8:11], a[160:163], v[68:71]
  s_waitcnt lgkmcnt(8)
  v_mfma_f32_16x16x32_bf16 v[72:75], a[16:19], a[160:163], v[72:75]
  ds_read_b64_tr_b16 a[48:49], v242 offset:1024
  s_add_u32 m0, s98, 67584
  s_add_u32 s31, s68, 1327104
  v_mfma_f32_16x16x32_bf16 v[72:75], a[20:23], a[176:179], v[72:75]
  buffer_load_dwordx4 v19, s[40:43], s31 offen offset:0 lds
  v_mfma_f32_16x16x32_bf16 v[104:107], a[20:23], a[180:183], v[104:107]
  ds_read_b64_tr_b16 a[50:51], v242 offset:5120
  v_mfma_f32_16x16x32_bf16 v[104:107], a[16:19], a[164:167], v[104:107]
  v_mfma_f32_16x16x32_bf16 v[136:139], a[16:19], a[168:171], v[136:139]
  ds_read_b64_tr_b16 a[52:53], v242 offset:9216
  s_add_u32 m0, s98, 68480
  v_mfma_f32_16x16x32_bf16 v[136:139], a[20:23], a[184:187], v[136:139]
  buffer_load_dwordx4 v19, s[40:43], s31 offen offset:128 lds
  v_mfma_f32_16x16x32_bf16 v[168:171], a[20:23], a[188:191], v[168:171]
  ds_read_b64_tr_b16 a[54:55], v242 offset:13312
  v_mfma_f32_16x16x32_bf16 v[168:171], a[16:19], a[172:175], v[168:171]
  v_mfma_f32_16x16x32_bf16 v[172:175], a[24:27], a[172:175], v[172:175]
  ds_read_b64_tr_b16 a[56:57], v243 offset:1024
  s_mul_i32 s81, s89, 2048
  s_mul_i32 s30, s92, 8192
  s_add_u32 s81, s81, s30
  s_add_u32 s30, s81, 6144
  v_mfma_f32_16x16x32_bf16 v[172:175], a[28:31], a[188:191], v[172:175]
  buffer_load_dwordx4 a[144:147], v16, s[4:7], s30 offen offset:0 sc1
  v_mfma_f32_16x16x32_bf16 v[140:143], a[28:31], a[184:187], v[140:143]
  ds_read_b64_tr_b16 a[58:59], v243 offset:5120
  v_mfma_f32_16x16x32_bf16 v[140:143], a[24:27], a[168:171], v[140:143]
  v_mfma_f32_16x16x32_bf16 v[108:111], a[24:27], a[164:167], v[108:111]
  ds_read_b64_tr_b16 a[60:61], v243 offset:9216
  v_mfma_f32_16x16x32_bf16 v[108:111], a[28:31], a[180:183], v[108:111]
  v_mfma_f32_16x16x32_bf16 v[76:79], a[28:31], a[176:179], v[76:79]
  ds_read_b64_tr_b16 a[62:63], v243 offset:13312
  v_mfma_f32_16x16x32_bf16 v[76:79], a[24:27], a[160:163], v[76:79]
  s_waitcnt lgkmcnt(8)
  v_mfma_f32_16x16x32_bf16 v[80:83], a[32:35], a[160:163], v[80:83]
  ds_read_b64_tr_b16 a[0:1], v232 offset:0
  v_mfma_f32_16x16x32_bf16 v[80:83], a[36:39], a[176:179], v[80:83]
  buffer_load_dwordx4 a[152:155], v16, s[4:7], s30 offen offset:1024 sc1
  v_mfma_f32_16x16x32_bf16 v[112:115], a[36:39], a[180:183], v[112:115]
  ds_read_b64_tr_b16 a[2:3], v232 offset:4096
  v_mfma_f32_16x16x32_bf16 v[112:115], a[32:35], a[164:167], v[112:115]
  v_mfma_f32_16x16x32_bf16 v[144:147], a[32:35], a[168:171], v[144:147]
  ds_read_b64_tr_b16 a[4:5], v232 offset:8192
  s_add_u32 s30, s81, 154112
  v_mfma_f32_16x16x32_bf16 v[144:147], a[36:39], a[184:187], v[144:147]
  buffer_load_dwordx4 a[148:151], v16, s[4:7], s30 offen offset:0 sc1
  v_mfma_f32_16x16x32_bf16 v[176:179], a[36:39], a[188:191], v[176:179]
  ds_read_b64_tr_b16 a[6:7], v232 offset:12288
  v_mfma_f32_16x16x32_bf16 v[176:179], a[32:35], a[172:175], v[176:179]
  v_mfma_f32_16x16x32_bf16 v[180:183], a[40:43], a[172:175], v[180:183]
  ds_read_b64_tr_b16 a[8:9], v233 offset:0
  v_mfma_f32_16x16x32_bf16 v[180:183], a[44:47], a[188:191], v[180:183]
  buffer_load_dwordx4 a[156:159], v16, s[4:7], s30 offen offset:1024 sc1
  v_mfma_f32_16x16x32_bf16 v[148:151], a[44:47], a[184:187], v[148:151]
  ds_read_b64_tr_b16 a[10:11], v233 offset:4096
  v_mfma_f32_16x16x32_bf16 v[148:151], a[40:43], a[168:171], v[148:151]
  v_mfma_f32_16x16x32_bf16 v[116:119], a[40:43], a[164:167], v[116:119]
  ds_read_b64_tr_b16 a[12:13], v233 offset:8192
  s_add_u32 m0, s98, 81920
  s_add_u32 s31, s69, 1441792
  v_mfma_f32_16x16x32_bf16 v[116:119], a[44:47], a[180:183], v[116:119]
  buffer_load_dwordx4 v19, s[40:43], s31 offen offset:0 lds
  v_mfma_f32_16x16x32_bf16 v[84:87], a[44:47], a[176:179], v[84:87]
  ds_read_b64_tr_b16 a[14:15], v233 offset:12288
  v_mfma_f32_16x16x32_bf16 v[84:87], a[40:43], a[160:163], v[84:87]
  s_waitcnt lgkmcnt(8)
  v_mfma_f32_16x16x32_bf16 v[88:91], a[48:51], a[160:163], v[88:91]
  ds_read_b64_tr_b16 a[16:17], v234 offset:0
  s_add_u32 m0, s98, 82816
  v_mfma_f32_16x16x32_bf16 v[88:91], a[52:55], a[176:179], v[88:91]
  buffer_load_dwordx4 v19, s[40:43], s31 offen offset:128 lds
  v_mfma_f32_16x16x32_bf16 v[120:123], a[52:55], a[180:183], v[120:123]
  ds_read_b64_tr_b16 a[18:19], v234 offset:4096
  v_mfma_f32_16x16x32_bf16 v[120:123], a[48:51], a[164:167], v[120:123]
  v_mfma_f32_16x16x32_bf16 v[152:155], a[48:51], a[168:171], v[152:155]
  ds_read_b64_tr_b16 a[20:21], v234 offset:8192
  s_add_u32 m0, s98, 83968
  s_add_u32 s31, s69, 1458176
  v_mfma_f32_16x16x32_bf16 v[152:155], a[52:55], a[184:187], v[152:155]
  buffer_load_dwordx4 v19, s[40:43], s31 offen offset:0 lds
  v_mfma_f32_16x16x32_bf16 v[184:187], a[52:55], a[188:191], v[184:187]
  ds_read_b64_tr_b16 a[22:23], v234 offset:12288
  v_mfma_f32_16x16x32_bf16 v[184:187], a[48:51], a[172:175], v[184:187]
  v_mfma_f32_16x16x32_bf16 v[188:191], a[56:59], a[172:175], v[188:191]
  ds_read_b64_tr_b16 a[24:25], v235 offset:0
  s_add_u32 m0, s98, 84864
  v_mfma_f32_16x16x32_bf16 v[188:191], a[60:63], a[188:191], v[188:191]
  buffer_load_dwordx4 v19, s[40:43], s31 offen offset:128 lds
  v_mfma_f32_16x16x32_bf16 v[156:159], a[60:63], a[184:187], v[156:159]
  ds_read_b64_tr_b16 a[26:27], v235 offset:4096
  v_mfma_f32_16x16x32_bf16 v[156:159], a[56:59], a[168:171], v[156:159]
  v_mfma_f32_16x16x32_bf16 v[124:127], a[56:59], a[164:167], v[124:127]
  ds_read_b64_tr_b16 a[28:29], v235 offset:8192
  v_mfma_f32_16x16x32_bf16 v[124:127], a[60:63], a[180:183], v[124:127]
  v_mfma_f32_16x16x32_bf16 v[92:95], a[60:63], a[176:179], v[92:95]
  ds_read_b64_tr_b16 a[30:31], v235 offset:12288
  v_mfma_f32_16x16x32_bf16 v[92:95], a[56:59], a[160:163], v[92:95]
  s_waitcnt vmcnt(27) lgkmcnt(8)
  v_mfma_f32_16x16x32_bf16 v[64:67], a[0:3], a[64:67], v[64:67]
  ds_read_b64_tr_b16 a[32:33], v232 offset:1024
  s_add_u32 s30, s80, 20480
  v_mfma_f32_16x16x32_bf16 v[64:67], a[4:7], a[80:83], v[64:67]
  buffer_load_dwordx4 a[160:163], v16, s[4:7], s30 offen offset:0 sc1
  v_mfma_f32_16x16x32_bf16 v[96:99], a[4:7], a[84:87], v[96:99]
  ds_read_b64_tr_b16 a[34:35], v232 offset:5120
  v_mfma_f32_16x16x32_bf16 v[96:99], a[0:3], a[68:71], v[96:99]
  v_mfma_f32_16x16x32_bf16 v[128:131], a[0:3], a[72:75], v[128:131]
  ds_read_b64_tr_b16 a[36:37], v232 offset:9216
  v_mfma_f32_16x16x32_bf16 v[128:131], a[4:7], a[88:91], v[128:131]
  buffer_load_dwordx4 a[168:171], v16, s[4:7], s30 offen offset:1024 sc1
  v_mfma_f32_16x16x32_bf16 v[160:163], a[4:7], a[92:95], v[160:163]
  ds_read_b64_tr_b16 a[38:39], v232 offset:13312
  v_mfma_f32_16x16x32_bf16 v[160:163], a[0:3], a[76:79], v[160:163]
  v_mfma_f32_16x16x32_bf16 v[164:167], a[8:11], a[76:79], v[164:167]
  ds_read_b64_tr_b16 a[40:41], v233 offset:1024
  s_add_u32 s30, s80, 168448
  v_mfma_f32_16x16x32_bf16 v[164:167], a[12:15], a[92:95], v[164:167]
  buffer_load_dwordx4 a[164:167], v16, s[4:7], s30 offen offset:0 sc1
  v_mfma_f32_16x16x32_bf16 v[132:135], a[12:15], a[88:91], v[132:135]
  ds_read_b64_tr_b16 a[42:43], v233 offset:5120
  v_mfma_f32_16x16x32_bf16 v[132:135], a[8:11], a[72:75], v[132:135]
  v_mfma_f32_16x16x32_bf16 v[100:103], a[8:11], a[68:71], v[100:103]
  ds_read_b64_tr_b16 a[44:45], v233 offset:9216
  v_mfma_f32_16x16x32_bf16 v[100:103], a[12:15], a[84:87], v[100:103]
  buffer_load_dwordx4 a[172:175], v16, s[4:7], s30 offen offset:1024 sc1
  v_mfma_f32_16x16x32_bf16 v[68:71], a[12:15], a[80:83], v[68:71]
  ds_read_b64_tr_b16 a[46:47], v233 offset:13312
  v_mfma_f32_16x16x32_bf16 v[68:71], a[8:11], a[64:67], v[68:71]
  s_waitcnt lgkmcnt(8)
  v_mfma_f32_16x16x32_bf16 v[72:75], a[16:19], a[64:67], v[72:75]
  ds_read_b64_tr_b16 a[48:49], v234 offset:1024
  s_add_u32 m0, s98, 98304
  s_add_u32 s31, s68, 6291456
  v_mfma_f32_16x16x32_bf16 v[72:75], a[20:23], a[80:83], v[72:75]
  buffer_load_dwordx4 v19, s[44:47], s31 offen offset:0 lds
  v_mfma_f32_16x16x32_bf16 v[104:107], a[20:23], a[84:87], v[104:107]
  ds_read_b64_tr_b16 a[50:51], v234 offset:5120
  v_mfma_f32_16x16x32_bf16 v[104:107], a[16:19], a[68:71], v[104:107]
  v_mfma_f32_16x16x32_bf16 v[136:139], a[16:19], a[72:75], v[136:139]
  ds_read_b64_tr_b16 a[52:53], v234 offset:9216
  s_add_u32 m0, s98, 99200
  v_mfma_f32_16x16x32_bf16 v[136:139], a[20:23], a[88:91], v[136:139]
  buffer_load_dwordx4 v19, s[44:47], s31 offen offset:128 lds
  v_mfma_f32_16x16x32_bf16 v[168:171], a[20:23], a[92:95], v[168:171]
  ds_read_b64_tr_b16 a[54:55], v234 offset:13312
  v_mfma_f32_16x16x32_bf16 v[168:171], a[16:19], a[76:79], v[168:171]
  v_mfma_f32_16x16x32_bf16 v[172:175], a[24:27], a[76:79], v[172:175]
  ds_read_b64_tr_b16 a[56:57], v235 offset:1024
  s_add_u32 m0, s98, 100352
  s_add_u32 s31, s68, 6307840
  v_mfma_f32_16x16x32_bf16 v[172:175], a[28:31], a[92:95], v[172:175]
  buffer_load_dwordx4 v19, s[44:47], s31 offen offset:0 lds
  v_mfma_f32_16x16x32_bf16 v[140:143], a[28:31], a[88:91], v[140:143]
  ds_read_b64_tr_b16 a[58:59], v235 offset:5120
  v_mfma_f32_16x16x32_bf16 v[140:143], a[24:27], a[72:75], v[140:143]
  v_mfma_f32_16x16x32_bf16 v[108:111], a[24:27], a[68:71], v[108:111]
  ds_read_b64_tr_b16 a[60:61], v235 offset:9216
  v_mfma_f32_16x16x32_bf16 v[108:111], a[28:31], a[84:87], v[108:111]
  v_mfma_f32_16x16x32_bf16 v[76:79], a[28:31], a[80:83], v[76:79]
  ds_read_b64_tr_b16 a[62:63], v235 offset:13312
  v_mfma_f32_16x16x32_bf16 v[76:79], a[24:27], a[64:67], v[76:79]
  s_waitcnt lgkmcnt(8)
  s_barrier
  v_mfma_f32_16x16x32_bf16 v[80:83], a[32:35], a[64:67], v[80:83]
Lg_pad11:
  s_cbranch_execz Lg_ret1
  s_nop 0
  ds_read_b64_tr_b16 a[0:1], v232 offset:16384
  s_add_u32 m0, s98, 101248
  v_mfma_f32_16x16x32_bf16 v[80:83], a[36:39], a[80:83], v[80:83]
  buffer_load_dwordx4 v19, s[44:47], s31 offen offset:128 lds
  v_mfma_f32_16x16x32_bf16 v[112:115], a[36:39], a[84:87], v[112:115]
  ds_read_b64_tr_b16 a[2:3], v232 offset:20480
  v_mfma_f32_16x16x32_bf16 v[112:115], a[32:35], a[68:71], v[112:115]
  v_mfma_f32_16x16x32_bf16 v[144:147], a[32:35], a[72:75], v[144:147]
  ds_read_b64_tr_b16 a[4:5], v232 offset:24576
  s_add_u32 s30, s81, 22528
  v_mfma_f32_16x16x32_bf16 v[144:147], a[36:39], a[88:91], v[144:147]
  buffer_load_dwordx4 a[176:179], v16, s[4:7], s30 offen offset:0 sc1
  v_mfma_f32_16x16x32_bf16 v[176:179], a[36:39], a[92:95], v[176:179]
  ds_read_b64_tr_b16 a[6:7], v232 offset:28672
  v_mfma_f32_16x16x32_bf16 v[176:179], a[32:35], a[76:79], v[176:179]
  v_mfma_f32_16x16x32_bf16 v[180:183], a[40:43], a[76:79], v[180:183]
  ds_read_b64_tr_b16 a[8:9], v233 offset:16384
  v_mfma_f32_16x16x32_bf16 v[180:183], a[44:47], a[92:95], v[180:183]
  buffer_load_dwordx4 a[184:187], v16, s[4:7], s30 offen offset:1024 sc1
  v_mfma_f32_16x16x32_bf16 v[148:151], a[44:47], a[88:91], v[148:151]
  ds_read_b64_tr_b16 a[10:11], v233 offset:20480
  v_mfma_f32_16x16x32_bf16 v[148:151], a[40:43], a[72:75], v[148:151]
  v_mfma_f32_16x16x32_bf16 v[116:119], a[40:43], a[68:71], v[116:119]
  ds_read_b64_tr_b16 a[12:13], v233 offset:24576
  s_add_u32 s30, s81, 170496
  v_mfma_f32_16x16x32_bf16 v[116:119], a[44:47], a[84:87], v[116:119]
  buffer_load_dwordx4 a[180:183], v16, s[4:7], s30 offen offset:0 sc1
  v_mfma_f32_16x16x32_bf16 v[84:87], a[44:47], a[80:83], v[84:87]
  ds_read_b64_tr_b16 a[14:15], v233 offset:28672
  v_mfma_f32_16x16x32_bf16 v[84:87], a[40:43], a[64:67], v[84:87]
  s_waitcnt lgkmcnt(8)
  v_mfma_f32_16x16x32_bf16 v[88:91], a[48:51], a[64:67], v[88:91]
  ds_read_b64_tr_b16 a[16:17], v234 offset:16384
  v_mfma_f32_16x16x32_bf16 v[88:91], a[52:55], a[80:83], v[88:91]
  buffer_load_dwordx4 a[188:191], v16, s[4:7], s30 offen offset:1024 sc1
  v_mfma_f32_16x16x32_bf16 v[120:123], a[52:55], a[84:87], v[120:123]
  ds_read_b64_tr_b16 a[18:19], v234 offset:20480
  v_mfma_f32_16x16x32_bf16 v[120:123], a[48:51], a[68:71], v[120:123]
  v_mfma_f32_16x16x32_bf16 v[152:155], a[48:51], a[72:75], v[152:155]
  ds_read_b64_tr_b16 a[20:21], v234 offset:24576
  s_add_u32 m0, s98, 114688
  s_add_u32 s31, s69, 6422528
  v_mfma_f32_16x16x32_bf16 v[152:155], a[52:55], a[88:91], v[152:155]
  buffer_load_dwordx4 v19, s[44:47], s31 offen offset:0 lds
  v_mfma_f32_16x16x32_bf16 v[184:187], a[52:55], a[92:95], v[184:187]
  ds_read_b64_tr_b16 a[22:23], v234 offset:28672
  v_mfma_f32_16x16x32_bf16 v[184:187], a[48:51], a[76:79], v[184:187]
  v_mfma_f32_16x16x32_bf16 v[188:191], a[56:59], a[76:79], v[188:191]
  ds_read_b64_tr_b16 a[24:25], v235 offset:16384
  s_add_u32 m0, s98, 115584
  v_mfma_f32_16x16x32_bf16 v[188:191], a[60:63], a[92:95], v[188:191]
  buffer_load_dwordx4 v19, s[44:47], s31 offen offset:128 lds
  v_mfma_f32_16x16x32_bf16 v[156:159], a[60:63], a[88:91], v[156:159]
  ds_read_b64_tr_b16 a[26:27], v235 offset:20480
  v_mfma_f32_16x16x32_bf16 v[156:159], a[56:59], a[72:75], v[156:159]
  v_mfma_f32_16x16x32_bf16 v[124:127], a[56:59], a[68:71], v[124:127]
  ds_read_b64_tr_b16 a[28:29], v235 offset:24576
  v_mfma_f32_16x16x32_bf16 v[124:127], a[60:63], a[84:87], v[124:127]
  v_mfma_f32_16x16x32_bf16 v[92:95], a[60:63], a[80:83], v[92:95]
  ds_read_b64_tr_b16 a[30:31], v235 offset:28672
  v_mfma_f32_16x16x32_bf16 v[92:95], a[56:59], a[64:67], v[92:95]
  s_waitcnt vmcnt(33) lgkmcnt(8)
  v_mfma_f32_16x16x32_bf16 v[64:67], a[0:3], a[96:99], v[64:67]
  ds_read_b64_tr_b16 a[32:33], v232 offset:17408
  s_add_u32 s30, s80, 131072
  v_mfma_f32_16x16x32_bf16 v[64:67], a[4:7], a[112:115], v[64:67]
  buffer_load_dwordx4 a[64:67], v16, s[4:7], s30 offen offset:0 sc1
  v_mfma_f32_16x16x32_bf16 v[96:99], a[4:7], a[116:119], v[96:99]
  ds_read_b64_tr_b16 a[34:35], v232 offset:21504
  v_mfma_f32_16x16x32_bf16 v[96:99], a[0:3], a[100:103], v[96:99]
  v_mfma_f32_16x16x32_bf16 v[128:131], a[0:3], a[104:107], v[128:131]
  ds_read_b64_tr_b16 a[36:37], v232 offset:25600
  v_mfma_f32_16x16x32_bf16 v[128:131], a[4:7], a[120:123], v[128:131]
  buffer_load_dwordx4 a[72:75], v16, s[4:7], s30 offen offset:1024 sc1
  v_mfma_f32_16x16x32_bf16 v[160:163], a[4:7], a[124:127], v[160:163]
  ds_read_b64_tr_b16 a[38:39], v232 offset:29696
  v_mfma_f32_16x16x32_bf16 v[160:163], a[0:3], a[108:111], v[160:163]
  v_mfma_f32_16x16x32_bf16 v[164:167], a[8:11], a[108:111], v[164:167]
  ds_read_b64_tr_b16 a[40:41], v233 offset:17408
  s_add_u32 s30, s80, 279040
  v_mfma_f32_16x16x32_bf16 v[164:167], a[12:15], a[124:127], v[164:167]
  buffer_load_dwordx4 a[68:71], v16, s[4:7], s30 offen offset:0 sc1
  v_mfma_f32_16x16x32_bf16 v[132:135], a[12:15], a[120:123], v[132:135]
  ds_read_b64_tr_b16 a[42:43], v233 offset:21504
  v_mfma_f32_16x16x32_bf16 v[132:135], a[8:11], a[104:107], v[132:135]
  v_mfma_f32_16x16x32_bf16 v[100:103], a[8:11], a[100:103], v[100:103]
  ds_read_b64_tr_b16 a[44:45], v233 offset:25600
  v_mfma_f32_16x16x32_bf16 v[100:103], a[12:15], a[116:119], v[100:103]
  buffer_load_dwordx4 a[76:79], v16, s[4:7], s30 offen offset:1024 sc1
  v_mfma_f32_16x16x32_bf16 v[68:71], a[12:15], a[112:115], v[68:71]
  ds_read_b64_tr_b16 a[46:47], v233 offset:29696
  v_mfma_f32_16x16x32_bf16 v[68:71], a[8:11], a[96:99], v[68:71]
  s_waitcnt lgkmcnt(8)
  v_mfma_f32_16x16x32_bf16 v[72:75], a[16:19], a[96:99], v[72:75]
  ds_read_b64_tr_b16 a[48:49], v234 offset:17408
  s_add_u32 m0, s98, 116736
  s_add_u32 s31, s69, 6438912
  v_mfma_f32_16x16x32_bf16 v[72:75], a[20:23], a[112:115], v[72:75]
  buffer_load_dwordx4 v19, s[44:47], s31 offen offset:0 lds
  v_mfma_f32_16x16x32_bf16 v[104:107], a[20:23], a[116:119], v[104:107]
  ds_read_b64_tr_b16 a[50:51], v234 offset:21504
  v_mfma_f32_16x16x32_bf16 v[104:107], a[16:19], a[100:103], v[104:107]
  v_mfma_f32_16x16x32_bf16 v[136:139], a[16:19], a[104:107], v[136:139]
  ds_read_b64_tr_b16 a[52:53], v234 offset:25600
  s_add_u32 m0, s98, 117632
  v_mfma_f32_16x16x32_bf16 v[136:139], a[20:23], a[120:123], v[136:139]
  buffer_load_dwordx4 v19, s[44:47], s31 offen offset:128 lds
  v_mfma_f32_16x16x32_bf16 v[168:171], a[20:23], a[124:127], v[168:171]
  ds_read_b64_tr_b16 a[54:55], v234 offset:29696
  v_mfma_f32_16x16x32_bf16 v[168:171], a[16:19], a[108:111], v[168:171]
  v_mfma_f32_16x16x32_bf16 v[172:175], a[24:27], a[108:111], v[172:175]
  ds_read_b64_tr_b16 a[56:57], v235 offset:17408
  s_add_u32 m0, s98, 131072
  s_add_u32 s31, s68, 6553600
  v_mfma_f32_16x16x32_bf16 v[172:175], a[28:31], a[124:127], v[172:175]
  buffer_load_dwordx4 v19, s[44:47], s31 offen offset:0 lds
  v_mfma_f32_16x16x32_bf16 v[140:143], a[28:31], a[120:123], v[140:143]
  ds_read_b64_tr_b16 a[58:59], v235 offset:21504
  v_mfma_f32_16x16x32_bf16 v[140:143], a[24:27], a[104:107], v[140:143]
  v_mfma_f32_16x16x32_bf16 v[108:111], a[24:27], a[100:103], v[108:111]
  ds_read_b64_tr_b16 a[60:61], v235 offset:25600
  v_mfma_f32_16x16x32_bf16 v[108:111], a[28:31], a[116:119], v[108:111]
  v_mfma_f32_16x16x32_bf16 v[76:79], a[28:31], a[112:115], v[76:79]
  ds_read_b64_tr_b16 a[62:63], v235 offset:29696
  v_mfma_f32_16x16x32_bf16 v[76:79], a[24:27], a[96:99], v[76:79]
  s_waitcnt lgkmcnt(8)
  v_mfma_f32_16x16x32_bf16 v[80:83], a[32:35], a[96:99], v[80:83]
  ds_read_b64_tr_b16 a[0:1], v232 offset:32768
  v_cvt_pk_bf16_f32 v128, v128, v129
  v_mfma_f32_16x16x32_bf16 v[80:83], a[36:39], a[112:115], v[80:83]
  v_cvt_pk_bf16_f32 v129, v130, v131
  v_mfma_f32_16x16x32_bf16 v[112:115], a[36:39], a[116:119], v[112:115]
  ds_read_b64_tr_b16 a[2:3], v232 offset:36864
  v_cvt_pk_bf16_f32 v130, v132, v133
  v_mfma_f32_16x16x32_bf16 v[112:115], a[32:35], a[100:103], v[112:115]
  v_cvt_pk_bf16_f32 v131, v134, v135
  v_mfma_f32_16x16x32_bf16 v[144:147], a[32:35], a[104:107], v[144:147]
  ds_read_b64_tr_b16 a[4:5], v232 offset:40960
  buffer_store_dwordx4 v[128:131], v12, s[56:59], 0 offen offset:0 sc1
  v_mfma_f32_16x16x32_bf16 v[144:147], a[36:39], a[120:123], v[144:147]
  v_cvt_pk_bf16_f32 v160, v160, v161
  v_mfma_f32_16x16x32_bf16 v[176:179], a[36:39], a[124:127], v[176:179]
  ds_read_b64_tr_b16 a[6:7], v232 offset:45056
  v_cvt_pk_bf16_f32 v161, v162, v163
  v_mfma_f32_16x16x32_bf16 v[176:179], a[32:35], a[108:111], v[176:179]
  v_cvt_pk_bf16_f32 v162, v164, v165
  v_mfma_f32_16x16x32_bf16 v[180:183], a[40:43], a[108:111], v[180:183]
  ds_read_b64_tr_b16 a[8:9], v233 offset:32768
  v_cvt_pk_bf16_f32 v163, v166, v167
  v_mfma_f32_16x16x32_bf16 v[180:183], a[44:47], a[124:127], v[180:183]
  buffer_store_dwordx4 v[160:163], v12, s[56:59], s34 offen offset:0 sc1
  v_mfma_f32_16x16x32_bf16 v[148:151], a[44:47], a[120:123], v[148:151]
  ds_read_b64_tr_b16 a[10:11], v233 offset:36864
  v_cvt_pk_bf16_f32 v136, v136, v137
  v_mfma_f32_16x16x32_bf16 v[148:151], a[40:43], a[104:107], v[148:151]
  v_cvt_pk_bf16_f32 v137, v138, v139
  v_mfma_f32_16x16x32_bf16 v[116:119], a[40:43], a[100:103], v[116:119]
  ds_read_b64_tr_b16 a[12:13], v233 offset:40960
  v_cvt_pk_bf16_f32 v138, v140, v141
  v_mfma_f32_16x16x32_bf16 v[116:119], a[44:47], a[116:119], v[116:119]
  v_cvt_pk_bf16_f32 v139, v142, v143
  v_mfma_f32_16x16x32_bf16 v[84:87], a[44:47], a[112:115], v[84:87]
  ds_read_b64_tr_b16 a[14:15], v233 offset:45056
  buffer_store_dwordx4 v[136:139], v12, s[56:59], 0 offen offset:1024 sc1
  v_mfma_f32_16x16x32_bf16 v[84:87], a[40:43], a[96:99], v[84:87]
  v_cvt_pk_bf16_f32 v168, v168, v169
  s_waitcnt lgkmcnt(8)
  v_mfma_f32_16x16x32_bf16 v[88:91], a[48:51], a[96:99], v[88:91]
  ds_read_b64_tr_b16 a[16:17], v234 offset:32768
  v_cvt_pk_bf16_f32 v169, v170, v171
  v_mfma_f32_16x16x32_bf16 v[88:91], a[52:55], a[112:115], v[88:91]
  v_cvt_pk_bf16_f32 v170, v172, v173
  v_mfma_f32_16x16x32_bf16 v[120:123], a[52:55], a[116:119], v[120:123]
  ds_read_b64_tr_b16 a[18:19], v234 offset:36864
  v_cvt_pk_bf16_f32 v171, v174, v175
  v_mfma_f32_16x16x32_bf16 v[120:123], a[48:51], a[100:103], v[120:123]
  buffer_store_dwordx4 v[168:171], v12, s[56:59], s34 offen offset:1024 sc1
  v_mfma_f32_16x16x32_bf16 v[152:155], a[48:51], a[104:107], v[152:155]
  ds_read_b64_tr_b16 a[20:21], v234 offset:40960
  v_cvt_pk_bf16_f32 v144, v144, v145
  v_mfma_f32_16x16x32_bf16 v[152:155], a[52:55], a[120:123], v[152:155]
  v_cvt_pk_bf16_f32 v145, v146, v147
  v_mfma_f32_16x16x32_bf16 v[184:187], a[52:55], a[124:127], v[184:187]
  ds_read_b64_tr_b16 a[22:23], v234 offset:45056
  v_cvt_pk_bf16_f32 v146, v148, v149
  v_mfma_f32_16x16x32_bf16 v[184:187], a[48:51], a[108:111], v[184:187]
  v_cvt_pk_bf16_f32 v147, v150, v151
  v_mfma_f32_16x16x32_bf16 v[188:191], a[56:59], a[108:111], v[188:191]
  ds_read_b64_tr_b16 a[24:25], v235 offset:32768
  buffer_store_dwordx4 v[144:147], v12, s[56:59], 0 offen offset:2048 sc1
  v_mfma_f32_16x16x32_bf16 v[188:191], a[60:63], a[124:127], v[188:191]
  v_mfma_f32_16x16x32_bf16 v[156:159], a[60:63], a[120:123], v[156:159]
  ds_read_b64_tr_b16 a[26:27], v235 offset:36864
  v_cvt_pk_bf16_f32 v176, v176, v177
  v_mfma_f32_16x16x32_bf16 v[156:159], a[56:59], a[104:107], v[156:159]
  v_cvt_pk_bf16_f32 v177, v178, v179
  v_mfma_f32_16x16x32_bf16 v[124:127], a[56:59], a[100:103], v[124:127]
  ds_read_b64_tr_b16 a[28:29], v235 offset:40960
  v_cvt_pk_bf16_f32 v178, v180, v181
  v_mfma_f32_16x16x32_bf16 v[124:127], a[60:63], a[116:119], v[124:127]
  v_cvt_pk_bf16_f32 v179, v182, v183
  v_mfma_f32_16x16x32_bf16 v[92:95], a[60:63], a[112:115], v[92:95]
  ds_read_b64_tr_b16 a[30:31], v235 offset:45056
  buffer_store_dwordx4 v[176:179], v12, s[56:59], s34 offen offset:2048 sc1
  v_mfma_f32_16x16x32_bf16 v[92:95], a[56:59], a[96:99], v[92:95]
  s_waitcnt vmcnt(37) lgkmcnt(8)
  v_mfma_f32_16x16x32_bf16 v[64:67], a[0:3], a[128:131], v[64:67]
  ds_read_b64_tr_b16 a[32:33], v232 offset:33792
  v_mfma_f32_16x16x32_bf16 v[64:67], a[4:7], a[136:139], v[64:67]
  ds_read_b64_tr_b16 a[34:35], v232 offset:37888
  v_mfma_f32_16x16x32_bf16 v[96:99], a[4:7], a[140:143], v[96:99]
  ds_read_b64_tr_b16 a[36:37], v232 offset:41984
  v_mfma_f32_16x16x32_bf16 v[96:99], a[0:3], a[132:135], v[96:99]
  ds_read_b64_tr_b16 a[38:39], v232 offset:46080
  v_mfma_f32_16x16x32_bf16 v[100:103], a[8:11], a[132:135], v[100:103]
  ds_read_b64_tr_b16 a[40:41], v233 offset:33792
  v_cvt_pk_bf16_f32 v152, v152, v153
  v_mfma_f32_16x16x32_bf16 v[100:103], a[12:15], a[140:143], v[100:103]
  ds_read_b64_tr_b16 a[42:43], v233 offset:37888
  v_cvt_pk_bf16_f32 v153, v154, v155
  v_mfma_f32_16x16x32_bf16 v[68:71], a[12:15], a[136:139], v[68:71]
  ds_read_b64_tr_b16 a[44:45], v233 offset:41984
  v_cvt_pk_bf16_f32 v154, v156, v157
  v_mfma_f32_16x16x32_bf16 v[68:71], a[8:11], a[128:131], v[68:71]
  ds_read_b64_tr_b16 a[46:47], v233 offset:46080
  v_cvt_pk_bf16_f32 v155, v158, v159
  s_waitcnt lgkmcnt(8)
  v_mfma_f32_16x16x32_bf16 v[72:75], a[16:19], a[128:131], v[72:75]
  ds_read_b64_tr_b16 a[48:49], v234 offset:33792
  buffer_store_dwordx4 v[152:155], v12, s[56:59], 0 offen offset:3072 sc1
  v_mfma_f32_16x16x32_bf16 v[72:75], a[20:23], a[136:139], v[72:75]
  ds_read_b64_tr_b16 a[50:51], v234 offset:37888
  v_mfma_f32_16x16x32_bf16 v[104:107], a[20:23], a[140:143], v[104:107]
  ds_read_b64_tr_b16 a[52:53], v234 offset:41984
  v_cvt_pk_bf16_f32 v184, v184, v185
  v_mfma_f32_16x16x32_bf16 v[104:107], a[16:19], a[132:135], v[104:107]
  ds_read_b64_tr_b16 a[54:55], v234 offset:46080
  v_cvt_pk_bf16_f32 v185, v186, v187
  v_mfma_f32_16x16x32_bf16 v[108:111], a[24:27], a[132:135], v[108:111]
  ds_read_b64_tr_b16 a[56:57], v235 offset:33792
  v_cvt_pk_bf16_f32 v186, v188, v189
  v_mfma_f32_16x16x32_bf16 v[108:111], a[28:31], a[140:143], v[108:111]
  ds_read_b64_tr_b16 a[58:59], v235 offset:37888
  v_cvt_pk_bf16_f32 v187, v190, v191
  v_mfma_f32_16x16x32_bf16 v[76:79], a[28:31], a[136:139], v[76:79]
  ds_read_b64_tr_b16 a[60:61], v235 offset:41984
  buffer_store_dwordx4 v[184:187], v12, s[56:59], s34 offen offset:3072 sc1
  v_mfma_f32_16x16x32_bf16 v[76:79], a[24:27], a[128:131], v[76:79]
  ds_read_b64_tr_b16 a[62:63], v235 offset:46080
  s_waitcnt vmcnt(37) lgkmcnt(8)
  s_barrier
  v_mfma_f32_16x16x32_bf16 v[80:83], a[32:35], a[128:131], v[80:83]
  ds_read_b64_tr_b16 a[0:1], v232 offset:49152
  v_mfma_f32_16x16x32_bf16 v[80:83], a[36:39], a[136:139], v[80:83]
  ds_read_b64_tr_b16 a[2:3], v232 offset:53248
  v_mfma_f32_16x16x32_bf16 v[112:115], a[36:39], a[140:143], v[112:115]
  ds_read_b64_tr_b16 a[4:5], v232 offset:57344
  v_mfma_f32_16x16x32_bf16 v[112:115], a[32:35], a[132:135], v[112:115]
  ds_read_b64_tr_b16 a[6:7], v232 offset:61440
  v_mfma_f32_16x16x32_bf16 v[116:119], a[40:43], a[132:135], v[116:119]
  ds_read_b64_tr_b16 a[8:9], v233 offset:49152
  v_mfma_f32_16x16x32_bf16 v[116:119], a[44:47], a[140:143], v[116:119]
  ds_read_b64_tr_b16 a[10:11], v233 offset:53248
  v_mfma_f32_16x16x32_bf16 v[84:87], a[44:47], a[136:139], v[84:87]
  ds_read_b64_tr_b16 a[12:13], v233 offset:57344
  v_mfma_f32_16x16x32_bf16 v[84:87], a[40:43], a[128:131], v[84:87]
  ds_read_b64_tr_b16 a[14:15], v233 offset:61440
  s_waitcnt lgkmcnt(8)
  v_mfma_f32_16x16x32_bf16 v[88:91], a[48:51], a[128:131], v[88:91]
  ds_read_b64_tr_b16 a[16:17], v234 offset:49152
  v_mfma_f32_16x16x32_bf16 v[88:91], a[52:55], a[136:139], v[88:91]
  ds_read_b64_tr_b16 a[18:19], v234 offset:53248
  v_mfma_f32_16x16x32_bf16 v[120:123], a[52:55], a[140:143], v[120:123]
  ds_read_b64_tr_b16 a[20:21], v234 offset:57344
  v_mfma_f32_16x16x32_bf16 v[120:123], a[48:51], a[132:135], v[120:123]
  ds_read_b64_tr_b16 a[22:23], v234 offset:61440
  v_mfma_f32_16x16x32_bf16 v[124:127], a[56:59], a[132:135], v[124:127]
  ds_read_b64_tr_b16 a[24:25], v235 offset:49152
  v_mfma_f32_16x16x32_bf16 v[124:127], a[60:63], a[140:143], v[124:127]
  ds_read_b64_tr_b16 a[26:27], v235 offset:53248
  v_mfma_f32_16x16x32_bf16 v[92:95], a[60:63], a[136:139], v[92:95]
  ds_read_b64_tr_b16 a[28:29], v235 offset:57344
  v_mfma_f32_16x16x32_bf16 v[92:95], a[56:59], a[128:131], v[92:95]
  ds_read_b64_tr_b16 a[30:31], v235 offset:61440
  s_waitcnt vmcnt(33) lgkmcnt(8)
  v_mfma_f32_16x16x32_bf16 v[64:67], a[0:3], a[144:147], v[64:67]
  ds_read_b64_tr_b16 a[32:33], v232 offset:50176
  s_add_u32 m0, s98, 131968
  v_mfma_f32_16x16x32_bf16 v[64:67], a[4:7], a[152:155], v[64:67]
  ds_read_b64_tr_b16 a[34:35], v232 offset:54272
  buffer_load_dwordx4 v19, s[44:47], s31 offen offset:128 lds
  v_mfma_f32_16x16x32_bf16 v[96:99], a[4:7], a[156:159], v[96:99]
  ds_read_b64_tr_b16 a[36:37], v232 offset:58368
  v_mfma_f32_16x16x32_bf16 v[96:99], a[0:3], a[148:151], v[96:99]
  ds_read_b64_tr_b16 a[38:39], v232 offset:62464
  v_mfma_f32_16x16x32_bf16 v[100:103], a[8:11], a[148:151], v[100:103]
  ds_read_b64_tr_b16 a[40:41], v233 offset:50176
  s_add_u32 m0, s98, 133120
  s_add_u32 s31, s68, 6569984
  v_mfma_f32_16x16x32_bf16 v[100:103], a[12:15], a[156:159], v[100:103]
  ds_read_b64_tr_b16 a[42:43], v233 offset:54272
  buffer_load_dwordx4 v19, s[44:47], s31 offen offset:0 lds
  v_mfma_f32_16x16x32_bf16 v[68:71], a[12:15], a[152:155], v[68:71]
  ds_read_b64_tr_b16 a[44:45], v233 offset:58368
  v_mfma_f32_16x16x32_bf16 v[68:71], a[8:11], a[144:147], v[68:71]
  ds_read_b64_tr_b16 a[46:47], v233 offset:62464
  s_waitcnt lgkmcnt(8)
  v_mfma_f32_16x16x32_bf16 v[72:75], a[16:19], a[144:147], v[72:75]
  ds_read_b64_tr_b16 a[48:49], v234 offset:50176
  s_add_u32 m0, s98, 134016
  v_mfma_f32_16x16x32_bf16 v[72:75], a[20:23], a[152:155], v[72:75]
  ds_read_b64_tr_b16 a[50:51], v234 offset:54272
  buffer_load_dwordx4 v19, s[44:47], s31 offen offset:128 lds
  v_mfma_f32_16x16x32_bf16 v[104:107], a[20:23], a[156:159], v[104:107]
  ds_read_b64_tr_b16 a[52:53], v234 offset:58368
  v_mfma_f32_16x16x32_bf16 v[104:107], a[16:19], a[148:151], v[104:107]
  ds_read_b64_tr_b16 a[54:55], v234 offset:62464
  v_mfma_f32_16x16x32_bf16 v[108:111], a[24:27], a[148:151], v[108:111]
  ds_read_b64_tr_b16 a[56:57], v235 offset:50176
  v_mfma_f32_16x16x32_bf16 v[108:111], a[28:31], a[156:159], v[108:111]
  ds_read_b64_tr_b16 a[58:59], v235 offset:54272
  v_mfma_f32_16x16x32_bf16 v[76:79], a[28:31], a[152:155], v[76:79]
  ds_read_b64_tr_b16 a[60:61], v235 offset:58368
  v_mfma_f32_16x16x32_bf16 v[76:79], a[24:27], a[144:147], v[76:79]
  ds_read_b64_tr_b16 a[62:63], v235 offset:62464
  s_waitcnt lgkmcnt(8)
  v_mfma_f32_16x16x32_bf16 v[80:83], a[32:35], a[144:147], v[80:83]
  ds_read_b64_tr_b16 a[0:1], v236 offset:0
  s_add_u32 s30, s81, 133120
  v_mfma_f32_16x16x32_bf16 v[80:83], a[36:39], a[152:155], v[80:83]
  ds_read_b64_tr_b16 a[2:3], v236 offset:4096
  buffer_load_dwordx4 a[80:83], v16, s[4:7], s30 offen offset:0 sc1
  v_mfma_f32_16x16x32_bf16 v[112:115], a[36:39], a[156:159], v[112:115]
  ds_read_b64_tr_b16 a[4:5], v236 offset:8192
  v_mfma_f32_16x16x32_bf16 v[112:115], a[32:35], a[148:151], v[112:115]
  ds_read_b64_tr_b16 a[6:7], v236 offset:12288
  v_mfma_f32_16x16x32_bf16 v[116:119], a[40:43], a[148:151], v[116:119]
  ds_read_b64_tr_b16 a[8:9], v237 offset:0
  v_mfma_f32_16x16x32_bf16 v[116:119], a[44:47], a[156:159], v[116:119]
  ds_read_b64_tr_b16 a[10:11], v237 offset:4096
  buffer_load_dwordx4 a[88:91], v16, s[4:7], s30 offen offset:1024 sc1
  v_mfma_f32_16x16x32_bf16 v[84:87], a[44:47], a[152:155], v[84:87]
  ds_read_b64_tr_b16 a[12:13], v237 offset:8192
  v_mfma_f32_16x16x32_bf16 v[84:87], a[40:43], a[144:147], v[84:87]
  ds_read_b64_tr_b16 a[14:15], v237 offset:12288
  s_waitcnt lgkmcnt(8)
  v_mfma_f32_16x16x32_bf16 v[88:91], a[48:51], a[144:147], v[88:91]
  ds_read_b64_tr_b16 a[16:17], v238 offset:0
  s_add_u32 s30, s81, 281088
  v_mfma_f32_16x16x32_bf16 v[88:91], a[52:55], a[152:155], v[88:91]
  ds_read_b64_tr_b16 a[18:19], v238 offset:4096
  buffer_load_dwordx4 a[84:87], v16, s[4:7], s30 offen offset:0 sc1
  v_mfma_f32_16x16x32_bf16 v[120:123], a[52:55], a[156:159], v[120:123]
  ds_read_b64_tr_b16 a[20:21], v238 offset:8192
  v_mfma_f32_16x16x32_bf16 v[120:123], a[48:51], a[148:151], v[120:123]
  ds_read_b64_tr_b16 a[22:23], v238 offset:12288
  v_mfma_f32_16x16x32_bf16 v[124:127], a[56:59], a[148:151], v[124:127]
  ds_read_b64_tr_b16 a[24:25], v239 offset:0
  v_mfma_f32_16x16x32_bf16 v[124:127], a[60:63], a[156:159], v[124:127]
  ds_read_b64_tr_b16 a[26:27], v239 offset:4096
  v_mfma_f32_16x16x32_bf16 v[92:95], a[60:63], a[152:155], v[92:95]
  ds_read_b64_tr_b16 a[28:29], v239 offset:8192
  v_mfma_f32_16x16x32_bf16 v[92:95], a[56:59], a[144:147], v[92:95]
  ds_read_b64_tr_b16 a[30:31], v239 offset:12288
  s_waitcnt vmcnt(6) lgkmcnt(8)
  v_mfma_f32_16x16x32_bf16 v[64:67], a[0:3], a[160:163], v[64:67]
  ds_read_b64_tr_b16 a[32:33], v236 offset:1024
  s_mov_b64 exec, 16
  buffer_store_dword v35, v29, s[16:19], 0 offen sc1
  s_mov_b64 exec, -1
  v_mfma_f32_16x16x32_bf16 v[64:67], a[4:7], a[168:171], v[64:67]
  ds_read_b64_tr_b16 a[34:35], v236 offset:5120
  buffer_load_dwordx4 a[92:95], v16, s[4:7], s30 offen offset:1024 sc1
  v_mfma_f32_16x16x32_bf16 v[96:99], a[4:7], a[172:175], v[96:99]
  ds_read_b64_tr_b16 a[36:37], v236 offset:9216
  v_mfma_f32_16x16x32_bf16 v[96:99], a[0:3], a[164:167], v[96:99]
  ds_read_b64_tr_b16 a[38:39], v236 offset:13312
  v_mfma_f32_16x16x32_bf16 v[100:103], a[8:11], a[164:167], v[100:103]
  ds_read_b64_tr_b16 a[40:41], v237 offset:1024
  s_add_u32 s30, s80, 135168
  v_mfma_f32_16x16x32_bf16 v[100:103], a[12:15], a[172:175], v[100:103]
  ds_read_b64_tr_b16 a[42:43], v237 offset:5120
  buffer_load_dwordx4 a[96:99], v16, s[4:7], s30 offen offset:0 sc1
  v_mfma_f32_16x16x32_bf16 v[68:71], a[12:15], a[168:171], v[68:71]
  ds_read_b64_tr_b16 a[44:45], v237 offset:9216
  v_mfma_f32_16x16x32_bf16 v[68:71], a[8:11], a[160:163], v[68:71]
  ds_read_b64_tr_b16 a[46:47], v237 offset:13312
  s_waitcnt lgkmcnt(8)
  v_mfma_f32_16x16x32_bf16 v[72:75], a[16:19], a[160:163], v[72:75]
  ds_read_b64_tr_b16 a[48:49], v238 offset:1024
  v_mfma_f32_16x16x32_bf16 v[72:75], a[20:23], a[168:171], v[72:75]
  ds_read_b64_tr_b16 a[50:51], v238 offset:5120
  buffer_load_dwordx4 a[104:107], v16, s[4:7], s30 offen offset:1024 sc1
  v_mfma_f32_16x16x32_bf16 v[104:107], a[20:23], a[172:175], v[104:107]
  ds_read_b64_tr_b16 a[52:53], v238 offset:9216
  v_mfma_f32_16x16x32_bf16 v[104:107], a[16:19], a[164:167], v[104:107]
  ds_read_b64_tr_b16 a[54:55], v238 offset:13312
  v_mfma_f32_16x16x32_bf16 v[108:111], a[24:27], a[164:167], v[108:111]
  ds_read_b64_tr_b16 a[56:57], v239 offset:1024
  v_mfma_f32_16x16x32_bf16 v[108:111], a[28:31], a[172:175], v[108:111]
  ds_read_b64_tr_b16 a[58:59], v239 offset:5120
  v_mfma_f32_16x16x32_bf16 v[76:79], a[28:31], a[168:171], v[76:79]
  ds_read_b64_tr_b16 a[60:61], v239 offset:9216
  v_mfma_f32_16x16x32_bf16 v[76:79], a[24:27], a[160:163], v[76:79]
  ds_read_b64_tr_b16 a[62:63], v239 offset:13312
  s_waitcnt lgkmcnt(8)
  s_barrier
  v_mfma_f32_16x16x32_bf16 v[80:83], a[32:35], a[160:163], v[80:83]
  ds_read_b64_tr_b16 a[0:1], v236 offset:16384
  s_add_u32 s30, s80, 283136
  v_mfma_f32_16x16x32_bf16 v[80:83], a[36:39], a[168:171], v[80:83]
  ds_read_b64_tr_b16 a[2:3], v236 offset:20480
  buffer_load_dwordx4 a[100:103], v16, s[4:7], s30 offen offset:0 sc1
  v_mfma_f32_16x16x32_bf16 v[112:115], a[36:39], a[172:175], v[112:115]
  ds_read_b64_tr_b16 a[4:5], v236 offset:24576
  v_mfma_f32_16x16x32_bf16 v[112:115], a[32:35], a[164:167], v[112:115]
  ds_read_b64_tr_b16 a[6:7], v236 offset:28672
  v_mfma_f32_16x16x32_bf16 v[116:119], a[40:43], a[164:167], v[116:119]
  ds_read_b64_tr_b16 a[8:9], v237 offset:16384
  v_mfma_f32_16x16x32_bf16 v[116:119], a[44:47], a[172:175], v[116:119]
  ds_read_b64_tr_b16 a[10:11], v237 offset:20480
  buffer_load_dwordx4 a[108:111], v16, s[4:7], s30 offen offset:1024 sc1
  v_mfma_f32_16x16x32_bf16 v[84:87], a[44:47], a[168:171], v[84:87]
  ds_read_b64_tr_b16 a[12:13], v237 offset:24576
  v_mfma_f32_16x16x32_bf16 v[84:87], a[40:43], a[160:163], v[84:87]
  ds_read_b64_tr_b16 a[14:15], v237 offset:28672
  s_waitcnt lgkmcnt(8)
  v_mfma_f32_16x16x32_bf16 v[88:91], a[48:51], a[160:163], v[88:91]
  ds_read_b64_tr_b16 a[16:17], v238 offset:16384
  s_add_u32 m0, s98, 0
  s_add_u32 s31, s69, 6684672
  v_mfma_f32_16x16x32_bf16 v[88:91], a[52:55], a[168:171], v[88:91]
  ds_read_b64_tr_b16 a[18:19], v238 offset:20480
  buffer_load_dwordx4 v19, s[44:47], s31 offen offset:0 lds
  v_mfma_f32_16x16x32_bf16 v[120:123], a[52:55], a[172:175], v[120:123]
  ds_read_b64_tr_b16 a[20:21], v238 offset:24576
  v_mfma_f32_16x16x32_bf16 v[120:123], a[48:51], a[164:167], v[120:123]
  ds_read_b64_tr_b16 a[22:23], v238 offset:28672
  v_mfma_f32_16x16x32_bf16 v[124:127], a[56:59], a[164:167], v[124:127]
  ds_read_b64_tr_b16 a[24:25], v239 offset:16384
  v_mfma_f32_16x16x32_bf16 v[124:127], a[60:63], a[172:175], v[124:127]
  ds_read_b64_tr_b16 a[26:27], v239 offset:20480
  v_mfma_f32_16x16x32_bf16 v[92:95], a[60:63], a[168:171], v[92:95]
  ds_read_b64_tr_b16 a[28:29], v239 offset:24576
  v_mfma_f32_16x16x32_bf16 v[92:95], a[56:59], a[160:163], v[92:95]
  ds_read_b64_tr_b16 a[30:31], v239 offset:28672
  s_waitcnt lgkmcnt(8)
  v_mfma_f32_16x16x32_bf16 v[64:67], a[0:3], a[176:179], v[64:67]
  ds_read_b64_tr_b16 a[32:33], v236 offset:17408
  s_add_u32 m0, s98, 896
  v_mfma_f32_16x16x32_bf16 v[64:67], a[4:7], a[184:187], v[64:67]
  ds_read_b64_tr_b16 a[34:35], v236 offset:21504
  buffer_load_dwordx4 v19, s[44:47], s31 offen offset:128 lds
  v_mfma_f32_16x16x32_bf16 v[96:99], a[4:7], a[188:191], v[96:99]
  ds_read_b64_tr_b16 a[36:37], v236 offset:25600
  v_mfma_f32_16x16x32_bf16 v[96:99], a[0:3], a[180:183], v[96:99]
  ds_read_b64_tr_b16 a[38:39], v236 offset:29696
  v_mfma_f32_16x16x32_bf16 v[100:103], a[8:11], a[180:183], v[100:103]
  ds_read_b64_tr_b16 a[40:41], v237 offset:17408
  s_add_u32 m0, s98, 2048
  s_add_u32 s31, s69, 6701056
  v_mfma_f32_16x16x32_bf16 v[100:103], a[12:15], a[188:191], v[100:103]
  ds_read_b64_tr_b16 a[42:43], v237 offset:21504
  buffer_load_dwordx4 v19, s[44:47], s31 offen offset:0 lds
  v_mfma_f32_16x16x32_bf16 v[68:71], a[12:15], a[184:187], v[68:71]
  ds_read_b64_tr_b16 a[44:45], v237 offset:25600
  v_mfma_f32_16x16x32_bf16 v[68:71], a[8:11], a[176:179], v[68:71]
  ds_read_b64_tr_b16 a[46:47], v237 offset:29696
  s_waitcnt lgkmcnt(8)
  v_mfma_f32_16x16x32_bf16 v[72:75], a[16:19], a[176:179], v[72:75]
  ds_read_b64_tr_b16 a[48:49], v238 offset:17408
  s_add_u32 m0, s98, 2944
  v_mfma_f32_16x16x32_bf16 v[72:75], a[20:23], a[184:187], v[72:75]
  ds_read_b64_tr_b16 a[50:51], v238 offset:21504
  buffer_load_dwordx4 v19, s[44:47], s31 offen offset:128 lds
  v_mfma_f32_16x16x32_bf16 v[104:107], a[20:23], a[188:191], v[104:107]
  ds_read_b64_tr_b16 a[52:53], v238 offset:25600
  v_mfma_f32_16x16x32_bf16 v[104:107], a[16:19], a[180:183], v[104:107]
  ds_read_b64_tr_b16 a[54:55], v238 offset:29696
  v_mfma_f32_16x16x32_bf16 v[108:111], a[24:27], a[180:183], v[108:111]
  ds_read_b64_tr_b16 a[56:57], v239 offset:17408
  v_mfma_f32_16x16x32_bf16 v[108:111], a[28:31], a[188:191], v[108:111]
  ds_read_b64_tr_b16 a[58:59], v239 offset:21504
  v_mfma_f32_16x16x32_bf16 v[76:79], a[28:31], a[184:187], v[76:79]
  ds_read_b64_tr_b16 a[60:61], v239 offset:25600
  v_mfma_f32_16x16x32_bf16 v[76:79], a[24:27], a[176:179], v[76:79]
  ds_read_b64_tr_b16 a[62:63], v239 offset:29696
  s_waitcnt lgkmcnt(8)
  v_mfma_f32_16x16x32_bf16 v[80:83], a[32:35], a[176:179], v[80:83]
  ds_read_b64_tr_b16 a[0:1], v236 offset:32768
  s_add_u32 s30, s81, 137216
  v_mfma_f32_16x16x32_bf16 v[80:83], a[36:39], a[184:187], v[80:83]
  ds_read_b64_tr_b16 a[2:3], v236 offset:36864
  buffer_load_dwordx4 a[112:115], v16, s[4:7], s30 offen offset:0 sc1
  v_mfma_f32_16x16x32_bf16 v[112:115], a[36:39], a[188:191], v[112:115]
  ds_read_b64_tr_b16 a[4:5], v236 offset:40960
  v_mfma_f32_16x16x32_bf16 v[112:115], a[32:35], a[180:183], v[112:115]
  ds_read_b64_tr_b16 a[6:7], v236 offset:45056
  v_mfma_f32_16x16x32_bf16 v[116:119], a[40:43], a[180:183], v[116:119]
  ds_read_b64_tr_b16 a[8:9], v237 offset:32768
  v_mfma_f32_16x16x32_bf16 v[116:119], a[44:47], a[188:191], v[116:119]
  ds_read_b64_tr_b16 a[10:11], v237 offset:36864
  buffer_load_dwordx4 a[120:123], v16, s[4:7], s30 offen offset:1024 sc1
  v_mfma_f32_16x16x32_bf16 v[84:87], a[44:47], a[184:187], v[84:87]
  ds_read_b64_tr_b16 a[12:13], v237 offset:40960
  v_mfma_f32_16x16x32_bf16 v[84:87], a[40:43], a[176:179], v[84:87]
  ds_read_b64_tr_b16 a[14:15], v237 offset:45056
  s_waitcnt lgkmcnt(8)
  v_mfma_f32_16x16x32_bf16 v[88:91], a[48:51], a[176:179], v[88:91]
  ds_read_b64_tr_b16 a[16:17], v238 offset:32768
  s_add_u32 s30, s81, 285184
  v_mfma_f32_16x16x32_bf16 v[88:91], a[52:55], a[184:187], v[88:91]
  ds_read_b64_tr_b16 a[18:19], v238 offset:36864
  buffer_load_dwordx4 a[116:119], v16, s[4:7], s30 offen offset:0 sc1
  v_mfma_f32_16x16x32_bf16 v[120:123], a[52:55], a[188:191], v[120:123]
  ds_read_b64_tr_b16 a[20:21], v238 offset:40960
  v_mfma_f32_16x16x32_bf16 v[120:123], a[48:51], a[180:183], v[120:123]
  ds_read_b64_tr_b16 a[22:23], v238 offset:45056
  v_mfma_f32_16x16x32_bf16 v[124:127], a[56:59], a[180:183], v[124:127]
  ds_read_b64_tr_b16 a[24:25], v239 offset:32768
  v_mfma_f32_16x16x32_bf16 v[124:127], a[60:63], a[188:191], v[124:127]
  ds_read_b64_tr_b16 a[26:27], v239 offset:36864
  v_mfma_f32_16x16x32_bf16 v[92:95], a[60:63], a[184:187], v[92:95]
  ds_read_b64_tr_b16 a[28:29], v239 offset:40960
Lg_pad12:
  s_cbranch_execz Lg_ret1
  s_nop 0
  v_mfma_f32_16x16x32_bf16 v[92:95], a[56:59], a[176:179], v[92:95]
  ds_read_b64_tr_b16 a[30:31], v239 offset:45056
  s_waitcnt lgkmcnt(8)
  v_mfma_f32_16x16x32_bf16 v[64:67], a[0:3], a[64:67], v[64:67]
  ds_read_b64_tr_b16 a[32:33], v236 offset:33792
  buffer_load_dword v33, v34, s[16:19], 0 offen sc1
  v_mfma_f32_16x16x32_bf16 v[64:67], a[4:7], a[72:75], v[64:67]
  ds_read_b64_tr_b16 a[34:35], v236 offset:37888
  buffer_load_dwordx4 a[124:127], v16, s[4:7], s30 offen offset:1024 sc1
  v_mfma_f32_16x16x32_bf16 v[96:99], a[4:7], a[76:79], v[96:99]
  ds_read_b64_tr_b16 a[36:37], v236 offset:41984
  v_mfma_f32_16x16x32_bf16 v[96:99], a[0:3], a[68:71], v[96:99]
  ds_read_b64_tr_b16 a[38:39], v236 offset:46080
  v_mfma_f32_16x16x32_bf16 v[100:103], a[8:11], a[68:71], v[100:103]
  ds_read_b64_tr_b16 a[40:41], v237 offset:33792
  v_mfma_f32_16x16x32_bf16 v[100:103], a[12:15], a[76:79], v[100:103]
  ds_read_b64_tr_b16 a[42:43], v237 offset:37888
  v_mfma_f32_16x16x32_bf16 v[68:71], a[12:15], a[72:75], v[68:71]
  ds_read_b64_tr_b16 a[44:45], v237 offset:41984
  v_mfma_f32_16x16x32_bf16 v[68:71], a[8:11], a[64:67], v[68:71]
  ds_read_b64_tr_b16 a[46:47], v237 offset:46080
  s_waitcnt lgkmcnt(8)
  v_mfma_f32_16x16x32_bf16 v[72:75], a[16:19], a[64:67], v[72:75]
  ds_read_b64_tr_b16 a[48:49], v238 offset:33792
  v_mfma_f32_16x16x32_bf16 v[72:75], a[20:23], a[72:75], v[72:75]
  ds_read_b64_tr_b16 a[50:51], v238 offset:37888
  v_mfma_f32_16x16x32_bf16 v[104:107], a[20:23], a[76:79], v[104:107]
  ds_read_b64_tr_b16 a[52:53], v238 offset:41984
  v_mfma_f32_16x16x32_bf16 v[104:107], a[16:19], a[68:71], v[104:107]
  ds_read_b64_tr_b16 a[54:55], v238 offset:46080
  v_mfma_f32_16x16x32_bf16 v[108:111], a[24:27], a[68:71], v[108:111]
  ds_read_b64_tr_b16 a[56:57], v239 offset:33792
  v_mfma_f32_16x16x32_bf16 v[108:111], a[28:31], a[76:79], v[108:111]
  ds_read_b64_tr_b16 a[58:59], v239 offset:37888
  v_mfma_f32_16x16x32_bf16 v[76:79], a[28:31], a[72:75], v[76:79]
  ds_read_b64_tr_b16 a[60:61], v239 offset:41984
  v_mfma_f32_16x16x32_bf16 v[76:79], a[24:27], a[64:67], v[76:79]
  ds_read_b64_tr_b16 a[62:63], v239 offset:46080
  s_waitcnt vmcnt(18) lgkmcnt(8)
  s_barrier
  v_mfma_f32_16x16x32_bf16 v[80:83], a[32:35], a[64:67], v[80:83]
  ds_read_b64_tr_b16 a[0:1], v236 offset:49152
  v_mfma_f32_16x16x32_bf16 v[80:83], a[36:39], a[72:75], v[80:83]
  ds_read_b64_tr_b16 a[2:3], v236 offset:53248
  v_mfma_f32_16x16x32_bf16 v[112:115], a[36:39], a[76:79], v[112:115]
  ds_read_b64_tr_b16 a[4:5], v236 offset:57344
  v_mfma_f32_16x16x32_bf16 v[112:115], a[32:35], a[68:71], v[112:115]
  ds_read_b64_tr_b16 a[6:7], v236 offset:61440
  v_mfma_f32_16x16x32_bf16 v[116:119], a[40:43], a[68:71], v[116:119]
  ds_read_b64_tr_b16 a[8:9], v237 offset:49152
  v_mfma_f32_16x16x32_bf16 v[116:119], a[44:47], a[76:79], v[116:119]
  ds_read_b64_tr_b16 a[10:11], v237 offset:53248
  v_mfma_f32_16x16x32_bf16 v[84:87], a[44:47], a[72:75], v[84:87]
  ds_read_b64_tr_b16 a[12:13], v237 offset:57344
  v_mfma_f32_16x16x32_bf16 v[84:87], a[40:43], a[64:67], v[84:87]
  ds_read_b64_tr_b16 a[14:15], v237 offset:61440
  s_waitcnt lgkmcnt(8)
  v_mfma_f32_16x16x32_bf16 v[88:91], a[48:51], a[64:67], v[88:91]
  ds_read_b64_tr_b16 a[16:17], v238 offset:49152
  v_mfma_f32_16x16x32_bf16 v[88:91], a[52:55], a[72:75], v[88:91]
  ds_read_b64_tr_b16 a[18:19], v238 offset:53248
  v_mfma_f32_16x16x32_bf16 v[120:123], a[52:55], a[76:79], v[120:123]
  ds_read_b64_tr_b16 a[20:21], v238 offset:57344
  v_mfma_f32_16x16x32_bf16 v[120:123], a[48:51], a[68:71], v[120:123]
  ds_read_b64_tr_b16 a[22:23], v238 offset:61440
  v_mfma_f32_16x16x32_bf16 v[124:127], a[56:59], a[68:71], v[124:127]
  ds_read_b64_tr_b16 a[24:25], v239 offset:49152
  v_mfma_f32_16x16x32_bf16 v[124:127], a[60:63], a[76:79], v[124:127]
  ds_read_b64_tr_b16 a[26:27], v239 offset:53248
  v_mfma_f32_16x16x32_bf16 v[92:95], a[60:63], a[72:75], v[92:95]
  ds_read_b64_tr_b16 a[28:29], v239 offset:57344
  v_mfma_f32_16x16x32_bf16 v[92:95], a[56:59], a[64:67], v[92:95]
  ds_read_b64_tr_b16 a[30:31], v239 offset:61440
  s_waitcnt vmcnt(13) lgkmcnt(8)
  v_mfma_f32_16x16x32_bf16 v[64:67], a[0:3], a[80:83], v[64:67]
  ds_read_b64_tr_b16 a[32:33], v236 offset:50176
  v_mfma_f32_16x16x32_bf16 v[64:67], a[4:7], a[88:91], v[64:67]
  ds_read_b64_tr_b16 a[34:35], v236 offset:54272
  v_mfma_f32_16x16x32_bf16 v[96:99], a[4:7], a[92:95], v[96:99]
  ds_read_b64_tr_b16 a[36:37], v236 offset:58368
  v_mfma_f32_16x16x32_bf16 v[96:99], a[0:3], a[84:87], v[96:99]
  ds_read_b64_tr_b16 a[38:39], v236 offset:62464
  v_mfma_f32_16x16x32_bf16 v[100:103], a[8:11], a[84:87], v[100:103]
  ds_read_b64_tr_b16 a[40:41], v237 offset:50176
  v_mfma_f32_16x16x32_bf16 v[100:103], a[12:15], a[92:95], v[100:103]
  ds_read_b64_tr_b16 a[42:43], v237 offset:54272
  v_mfma_f32_16x16x32_bf16 v[68:71], a[12:15], a[88:91], v[68:71]
  ds_read_b64_tr_b16 a[44:45], v237 offset:58368
  v_mfma_f32_16x16x32_bf16 v[68:71], a[8:11], a[80:83], v[68:71]
  ds_read_b64_tr_b16 a[46:47], v237 offset:62464
  s_waitcnt lgkmcnt(8)
  v_mfma_f32_16x16x32_bf16 v[72:75], a[16:19], a[80:83], v[72:75]
  ds_read_b64_tr_b16 a[48:49], v238 offset:50176
  v_mfma_f32_16x16x32_bf16 v[72:75], a[20:23], a[88:91], v[72:75]
  ds_read_b64_tr_b16 a[50:51], v238 offset:54272
  v_mfma_f32_16x16x32_bf16 v[104:107], a[20:23], a[92:95], v[104:107]
  ds_read_b64_tr_b16 a[52:53], v238 offset:58368
  v_mfma_f32_16x16x32_bf16 v[104:107], a[16:19], a[84:87], v[104:107]
  ds_read_b64_tr_b16 a[54:55], v238 offset:62464
  v_mfma_f32_16x16x32_bf16 v[108:111], a[24:27], a[84:87], v[108:111]
  ds_read_b64_tr_b16 a[56:57], v239 offset:50176
  v_mfma_f32_16x16x32_bf16 v[108:111], a[28:31], a[92:95], v[108:111]
  ds_read_b64_tr_b16 a[58:59], v239 offset:54272
  v_mfma_f32_16x16x32_bf16 v[76:79], a[28:31], a[88:91], v[76:79]
  ds_read_b64_tr_b16 a[60:61], v239 offset:58368
  v_mfma_f32_16x16x32_bf16 v[76:79], a[24:27], a[80:83], v[76:79]
  ds_read_b64_tr_b16 a[62:63], v239 offset:62464
  s_waitcnt vmcnt(1) lgkmcnt(8)
  v_mfma_f32_16x16x32_bf16 v[80:83], a[32:35], a[80:83], v[80:83]
  ds_read_b64_tr_b16 a[0:1], v240 offset:0
  v_cmp_eq_u32 vcc, 0, v33
  s_nop 1
  s_cmp_eq_u64 vcc, 0
  s_cselect_b32 s58, 16777216, 0
  s_mov_b32 s64, s58
  v_mfma_f32_16x16x32_bf16 v[80:83], a[36:39], a[88:91], v[80:83]
  ds_read_b64_tr_b16 a[2:3], v240 offset:4096
  buffer_load_dwordx4 v[128:131], v13, s[56:59], 0 offen offset:0 sc1
  v_mfma_f32_16x16x32_bf16 v[112:115], a[36:39], a[92:95], v[112:115]
  ds_read_b64_tr_b16 a[4:5], v240 offset:8192
  v_mfma_f32_16x16x32_bf16 v[112:115], a[32:35], a[84:87], v[112:115]
  ds_read_b64_tr_b16 a[6:7], v240 offset:12288
  v_mfma_f32_16x16x32_bf16 v[116:119], a[40:43], a[84:87], v[116:119]
  ds_read_b64_tr_b16 a[8:9], v241 offset:0
  v_mfma_f32_16x16x32_bf16 v[116:119], a[44:47], a[92:95], v[116:119]
  ds_read_b64_tr_b16 a[10:11], v241 offset:4096
  buffer_load_dwordx4 v[144:147], v13, s[56:59], s34 offen offset:0 sc1
  v_mfma_f32_16x16x32_bf16 v[84:87], a[44:47], a[88:91], v[84:87]
  ds_read_b64_tr_b16 a[12:13], v241 offset:8192
  v_mfma_f32_16x16x32_bf16 v[84:87], a[40:43], a[80:83], v[84:87]
  ds_read_b64_tr_b16 a[14:15], v241 offset:12288
  s_waitcnt lgkmcnt(8)
  v_mfma_f32_16x16x32_bf16 v[88:91], a[48:51], a[80:83], v[88:91]
  ds_read_b64_tr_b16 a[16:17], v242 offset:0
  v_mfma_f32_16x16x32_bf16 v[88:91], a[52:55], a[88:91], v[88:91]
  ds_read_b64_tr_b16 a[18:19], v242 offset:4096
  buffer_load_dwordx4 v[132:135], v13, s[56:59], 0 offen offset:1024 sc1
  v_mfma_f32_16x16x32_bf16 v[120:123], a[52:55], a[92:95], v[120:123]
  ds_read_b64_tr_b16 a[20:21], v242 offset:8192
  v_mfma_f32_16x16x32_bf16 v[120:123], a[48:51], a[84:87], v[120:123]
  ds_read_b64_tr_b16 a[22:23], v242 offset:12288
  v_mfma_f32_16x16x32_bf16 v[124:127], a[56:59], a[84:87], v[124:127]
  ds_read_b64_tr_b16 a[24:25], v243 offset:0
  v_mfma_f32_16x16x32_bf16 v[124:127], a[60:63], a[92:95], v[124:127]
  ds_read_b64_tr_b16 a[26:27], v243 offset:4096
  buffer_load_dwordx4 v[148:151], v13, s[56:59], s34 offen offset:1024 sc1
  v_mfma_f32_16x16x32_bf16 v[92:95], a[60:63], a[88:91], v[92:95]
  ds_read_b64_tr_b16 a[28:29], v243 offset:8192
  v_mfma_f32_16x16x32_bf16 v[92:95], a[56:59], a[80:83], v[92:95]
  ds_read_b64_tr_b16 a[30:31], v243 offset:12288
  s_waitcnt lgkmcnt(8)
  v_mfma_f32_16x16x32_bf16 v[64:67], a[0:3], a[96:99], v[64:67]
  ds_read_b64_tr_b16 a[32:33], v240 offset:1024
  v_mfma_f32_16x16x32_bf16 v[64:67], a[4:7], a[104:107], v[64:67]
  ds_read_b64_tr_b16 a[34:35], v240 offset:5120
  buffer_load_dwordx4 v[136:139], v13, s[56:59], 0 offen offset:2048 sc1
  v_mfma_f32_16x16x32_bf16 v[96:99], a[4:7], a[108:111], v[96:99]
  ds_read_b64_tr_b16 a[36:37], v240 offset:9216
  v_mfma_f32_16x16x32_bf16 v[96:99], a[0:3], a[100:103], v[96:99]
  ds_read_b64_tr_b16 a[38:39], v240 offset:13312
  v_mfma_f32_16x16x32_bf16 v[100:103], a[8:11], a[100:103], v[100:103]
  ds_read_b64_tr_b16 a[40:41], v241 offset:1024
  v_mfma_f32_16x16x32_bf16 v[100:103], a[12:15], a[108:111], v[100:103]
  ds_read_b64_tr_b16 a[42:43], v241 offset:5120
  buffer_load_dwordx4 v[152:155], v13, s[56:59], s34 offen offset:2048 sc1
  v_mfma_f32_16x16x32_bf16 v[68:71], a[12:15], a[104:107], v[68:71]
  ds_read_b64_tr_b16 a[44:45], v241 offset:9216
  v_mfma_f32_16x16x32_bf16 v[68:71], a[8:11], a[96:99], v[68:71]
  ds_read_b64_tr_b16 a[46:47], v241 offset:13312
  s_waitcnt lgkmcnt(8)
  v_mfma_f32_16x16x32_bf16 v[72:75], a[16:19], a[96:99], v[72:75]
  ds_read_b64_tr_b16 a[48:49], v242 offset:1024
  v_mfma_f32_16x16x32_bf16 v[72:75], a[20:23], a[104:107], v[72:75]
  ds_read_b64_tr_b16 a[50:51], v242 offset:5120
  buffer_load_dwordx4 v[140:143], v13, s[56:59], 0 offen offset:3072 sc1
  v_mfma_f32_16x16x32_bf16 v[104:107], a[20:23], a[108:111], v[104:107]
  ds_read_b64_tr_b16 a[52:53], v242 offset:9216
  v_mfma_f32_16x16x32_bf16 v[104:107], a[16:19], a[100:103], v[104:107]
  ds_read_b64_tr_b16 a[54:55], v242 offset:13312
  v_mfma_f32_16x16x32_bf16 v[108:111], a[24:27], a[100:103], v[108:111]
  ds_read_b64_tr_b16 a[56:57], v243 offset:1024
  v_mfma_f32_16x16x32_bf16 v[108:111], a[28:31], a[108:111], v[108:111]
  ds_read_b64_tr_b16 a[58:59], v243 offset:5120
  buffer_load_dwordx4 v[156:159], v13, s[56:59], s34 offen offset:3072 sc1
  v_mfma_f32_16x16x32_bf16 v[76:79], a[28:31], a[104:107], v[76:79]
  ds_read_b64_tr_b16 a[60:61], v243 offset:9216
  v_mfma_f32_16x16x32_bf16 v[76:79], a[24:27], a[96:99], v[76:79]
  ds_read_b64_tr_b16 a[62:63], v243 offset:13312
  s_waitcnt lgkmcnt(8)
  s_barrier
  v_mfma_f32_16x16x32_bf16 v[80:83], a[32:35], a[96:99], v[80:83]
  ds_read_b64_tr_b16 a[0:1], v232 offset:0
  v_mfma_f32_16x16x32_bf16 v[80:83], a[36:39], a[104:107], v[80:83]
  ds_read_b64_tr_b16 a[2:3], v232 offset:4096
  v_mfma_f32_16x16x32_bf16 v[112:115], a[36:39], a[108:111], v[112:115]
  ds_read_b64_tr_b16 a[4:5], v233 offset:0
  v_mfma_f32_16x16x32_bf16 v[112:115], a[32:35], a[100:103], v[112:115]
  ds_read_b64_tr_b16 a[6:7], v233 offset:4096
  v_mfma_f32_16x16x32_bf16 v[116:119], a[40:43], a[100:103], v[116:119]
  ds_read_b64_tr_b16 a[8:9], v234 offset:0
  v_mfma_f32_16x16x32_bf16 v[116:119], a[44:47], a[108:111], v[116:119]
  ds_read_b64_tr_b16 a[10:11], v234 offset:4096
  v_mfma_f32_16x16x32_bf16 v[84:87], a[44:47], a[104:107], v[84:87]
  ds_read_b64_tr_b16 a[12:13], v235 offset:0
  v_mfma_f32_16x16x32_bf16 v[84:87], a[40:43], a[96:99], v[84:87]
  ds_read_b64_tr_b16 a[14:15], v235 offset:4096
  s_waitcnt lgkmcnt(8)
  v_mfma_f32_16x16x32_bf16 v[88:91], a[48:51], a[96:99], v[88:91]
  ds_read_b64_tr_b16 a[16:17], v232 offset:1024
  v_mfma_f32_16x16x32_bf16 v[88:91], a[52:55], a[104:107], v[88:91]
  ds_read_b64_tr_b16 a[18:19], v232 offset:5120
  v_mfma_f32_16x16x32_bf16 v[120:123], a[52:55], a[108:111], v[120:123]
  ds_read_b64_tr_b16 a[20:21], v233 offset:1024
  v_mfma_f32_16x16x32_bf16 v[120:123], a[48:51], a[100:103], v[120:123]
  ds_read_b64_tr_b16 a[22:23], v233 offset:5120
  v_mfma_f32_16x16x32_bf16 v[124:127], a[56:59], a[100:103], v[124:127]
  ds_read_b64_tr_b16 a[24:25], v234 offset:1024
  v_mfma_f32_16x16x32_bf16 v[124:127], a[60:63], a[108:111], v[124:127]
  ds_read_b64_tr_b16 a[26:27], v234 offset:5120
  v_mfma_f32_16x16x32_bf16 v[92:95], a[60:63], a[104:107], v[92:95]
  ds_read_b64_tr_b16 a[28:29], v235 offset:1024
  v_mfma_f32_16x16x32_bf16 v[92:95], a[56:59], a[96:99], v[92:95]
  ds_read_b64_tr_b16 a[30:31], v235 offset:5120
  s_waitcnt vmcnt(8) lgkmcnt(8)
  v_mfma_f32_16x16x32_bf16 v[64:67], a[0:3], a[112:115], v[64:67]
  ds_read_b64_tr_b16 a[32:33], v232 offset:8192
  v_mfma_f32_16x16x32_bf16 v[96:99], a[0:3], a[116:119], v[96:99]
  ds_read_b64_tr_b16 a[34:35], v232 offset:12288
  v_mfma_f32_16x16x32_bf16 v[100:103], a[4:7], a[116:119], v[100:103]
  ds_read_b64_tr_b16 a[36:37], v233 offset:8192
  v_mfma_f32_16x16x32_bf16 v[68:71], a[4:7], a[112:115], v[68:71]
  ds_read_b64_tr_b16 a[38:39], v233 offset:12288
  v_mfma_f32_16x16x32_bf16 v[72:75], a[8:11], a[112:115], v[72:75]
  ds_read_b64_tr_b16 a[40:41], v234 offset:8192
  v_mfma_f32_16x16x32_bf16 v[104:107], a[8:11], a[116:119], v[104:107]
  ds_read_b64_tr_b16 a[42:43], v234 offset:12288
  v_mfma_f32_16x16x32_bf16 v[108:111], a[12:15], a[116:119], v[108:111]
  ds_read_b64_tr_b16 a[44:45], v235 offset:8192
  v_mfma_f32_16x16x32_bf16 v[76:79], a[12:15], a[112:115], v[76:79]
  ds_read_b64_tr_b16 a[46:47], v235 offset:12288
  s_waitcnt lgkmcnt(8)
  v_mfma_f32_16x16x32_bf16 v[80:83], a[16:19], a[112:115], v[80:83]
  ds_read_b64_tr_b16 a[48:49], v232 offset:9216
  v_mfma_f32_16x16x32_bf16 v[112:115], a[16:19], a[116:119], v[112:115]
  ds_read_b64_tr_b16 a[50:51], v232 offset:13312
  v_mfma_f32_16x16x32_bf16 v[116:119], a[20:23], a[116:119], v[116:119]
  ds_read_b64_tr_b16 a[52:53], v233 offset:9216
  v_mfma_f32_16x16x32_bf16 v[84:87], a[20:23], a[112:115], v[84:87]
  ds_read_b64_tr_b16 a[54:55], v233 offset:13312
  v_mfma_f32_16x16x32_bf16 v[88:91], a[24:27], a[112:115], v[88:91]
  ds_read_b64_tr_b16 a[56:57], v234 offset:9216
  v_mfma_f32_16x16x32_bf16 v[120:123], a[24:27], a[116:119], v[120:123]
  ds_read_b64_tr_b16 a[58:59], v234 offset:13312
  v_mfma_f32_16x16x32_bf16 v[124:127], a[28:31], a[116:119], v[124:127]
  ds_read_b64_tr_b16 a[60:61], v235 offset:9216
  v_mfma_f32_16x16x32_bf16 v[92:95], a[28:31], a[112:115], v[92:95]
  ds_read_b64_tr_b16 a[62:63], v235 offset:13312
  s_cmp_eq_u32 s64, 0
  s_cbranch_scc1 Lg_x_slow
Lg_xdone:
  s_waitcnt lgkmcnt(8)
  s_nop 0
  v_mfma_f32_16x16x32_bf16 v[64:67], a[32:35], a[120:123], v[64:67]
  v_mfma_f32_16x16x32_bf16 v[96:99], a[32:35], a[124:127], v[96:99]
  v_mfma_f32_16x16x32_bf16 v[100:103], a[36:39], a[124:127], v[100:103]
  v_mfma_f32_16x16x32_bf16 v[68:71], a[36:39], a[120:123], v[68:71]
  s_waitcnt vmcnt(6)
  s_nop 0
  v_mfma_f32_16x16x32_bf16 v[64:67], v[194:197], v[128:131], v[64:67]
  v_mfma_f32_16x16x32_bf16 v[96:99], v[194:197], v[144:147], v[96:99]
  v_mfma_f32_16x16x32_bf16 v[100:103], v[192:195], v[144:147], v[100:103]
  v_mfma_f32_16x16x32_bf16 v[68:71], v[192:195], v[128:131], v[68:71]
  s_waitcnt lgkmcnt(0)
  s_nop 0
  v_mfma_f32_16x16x32_bf16 v[72:75], a[40:43], a[120:123], v[72:75]
  v_mfma_f32_16x16x32_bf16 v[104:107], a[40:43], a[124:127], v[104:107]
  v_mfma_f32_16x16x32_bf16 v[108:111], a[44:47], a[124:127], v[108:111]
  s_nop 0
  s_nop 0
  v_cvt_pk_bf16_f32 v160, v64, v65
  v_cvt_pk_bf16_f32 v161, v66, v67
  v_mfma_f32_16x16x32_bf16 v[76:79], a[44:47], a[120:123], v[76:79]
  s_waitcnt vmcnt(4)
  s_nop 0
  v_cvt_pk_bf16_f32 v176, v96, v97
  v_cvt_pk_bf16_f32 v177, v98, v99
  v_mfma_f32_16x16x32_bf16 v[72:75], v[194:197], v[132:135], v[72:75]
  v_cvt_pk_bf16_f32 v178, v100, v101
  v_mfma_f32_16x16x32_bf16 v[104:107], v[194:197], v[148:151], v[104:107]
  v_cvt_pk_bf16_f32 v179, v102, v103
  buffer_store_dwordx4 v[176:179], v18, s[56:59], s34 offen offset:0 sc1
  v_mfma_f32_16x16x32_bf16 v[108:111], v[192:195], v[148:151], v[108:111]
  v_cvt_pk_bf16_f32 v162, v68, v69
  v_cvt_pk_bf16_f32 v163, v70, v71
  v_mfma_f32_16x16x32_bf16 v[76:79], v[192:195], v[132:135], v[76:79]
  buffer_store_dwordx4 v[160:163], v18, s[56:59], 0 offen offset:0 sc1
  v_mfma_f32_16x16x32_bf16 v[80:83], a[48:51], a[120:123], v[80:83]
  v_mfma_f32_16x16x32_bf16 v[112:115], a[48:51], a[124:127], v[112:115]
  v_mfma_f32_16x16x32_bf16 v[116:119], a[52:55], a[124:127], v[116:119]
  v_cvt_pk_bf16_f32 v164, v72, v73
  v_cvt_pk_bf16_f32 v165, v74, v75
  v_mfma_f32_16x16x32_bf16 v[84:87], a[52:55], a[120:123], v[84:87]
  s_waitcnt vmcnt(4)
  s_nop 0
  v_cvt_pk_bf16_f32 v180, v104, v105
  v_cvt_pk_bf16_f32 v181, v106, v107
  v_mfma_f32_16x16x32_bf16 v[80:83], v[194:197], v[136:139], v[80:83]
  v_cvt_pk_bf16_f32 v182, v108, v109
  v_mfma_f32_16x16x32_bf16 v[112:115], v[194:197], v[152:155], v[112:115]
  v_cvt_pk_bf16_f32 v183, v110, v111
  buffer_store_dwordx4 v[180:183], v18, s[56:59], s34 offen offset:1024 sc1
  v_mfma_f32_16x16x32_bf16 v[116:119], v[192:195], v[152:155], v[116:119]
  v_cvt_pk_bf16_f32 v166, v76, v77
  v_cvt_pk_bf16_f32 v167, v78, v79
  v_mfma_f32_16x16x32_bf16 v[84:87], v[192:195], v[136:139], v[84:87]
  buffer_store_dwordx4 v[164:167], v18, s[56:59], 0 offen offset:1024 sc1
  v_mfma_f32_16x16x32_bf16 v[88:91], a[56:59], a[120:123], v[88:91]
  v_mfma_f32_16x16x32_bf16 v[120:123], a[56:59], a[124:127], v[120:123]
  v_mfma_f32_16x16x32_bf16 v[124:127], a[60:63], a[124:127], v[124:127]
  v_cvt_pk_bf16_f32 v168, v80, v81
  v_cvt_pk_bf16_f32 v169, v82, v83
  v_mfma_f32_16x16x32_bf16 v[92:95], a[60:63], a[120:123], v[92:95]
  s_waitcnt vmcnt(4)
  s_nop 0
  v_cvt_pk_bf16_f32 v184, v112, v113
  v_cvt_pk_bf16_f32 v185, v114, v115
  v_mfma_f32_16x16x32_bf16 v[88:91], v[194:197], v[140:143], v[88:91]
  v_cvt_pk_bf16_f32 v186, v116, v117
  v_mfma_f32_16x16x32_bf16 v[120:123], v[194:197], v[156:159], v[120:123]
  v_cvt_pk_bf16_f32 v187, v118, v119
  buffer_store_dwordx4 v[184:187], v18, s[56:59], s34 offen offset:2048 sc1
  v_mfma_f32_16x16x32_bf16 v[124:127], v[192:195], v[156:159], v[124:127]
  v_cvt_pk_bf16_f32 v170, v84, v85
  v_cvt_pk_bf16_f32 v171, v86, v87
  v_mfma_f32_16x16x32_bf16 v[92:95], v[192:195], v[140:143], v[92:95]
  buffer_store_dwordx4 v[168:171], v18, s[56:59], 0 offen offset:2048 sc1
  v_cvt_pk_bf16_f32 v172, v88, v89
  v_cvt_pk_bf16_f32 v173, v90, v91
  v_cvt_pk_bf16_f32 v188, v120, v121
  v_cvt_pk_bf16_f32 v189, v122, v123
  v_cvt_pk_bf16_f32 v190, v124, v125
  v_cvt_pk_bf16_f32 v191, v126, v127
  buffer_store_dwordx4 v[188:191], v18, s[56:59], s34 offen offset:3072 sc1
  v_cvt_pk_bf16_f32 v174, v92, v93
  v_cvt_pk_bf16_f32 v175, v94, v95
  buffer_store_dwordx4 v[172:175], v18, s[56:59], 0 offen offset:3072 sc1
  s_waitcnt vmcnt(0)
  s_mov_b64 exec, 8
  buffer_store_dword v35, v29, s[16:19], 0 offen sc1
  s_mov_b64 exec, -1
Lg_fin:
  s_endpgm
.p2align 6
Lg_ws:
  s_branch Lg_ret2
  s_nop 7
Lg_x_slow:
  s_mov_b32 s39, 65536
  s_mov_b32 s58, 16777216
Lg_x_spin:
  buffer_load_dword v33, v34, s[16:19], 0 offen sc1
  s_waitcnt vmcnt(0)
  v_cmp_eq_u32 vcc, 0, v33
  s_cbranch_vccz Lg_x_ok
  s_sleep 1
  s_sub_u32 s39, s39, 1
  s_cmp_lg_u32 s39, 0
  s_cbranch_scc1 Lg_x_spin
Lg_x_ok:
  buffer_load_dwordx4 v[128:131], v13, s[56:59], 0 offen offset:0 sc1
  buffer_load_dwordx4 v[144:147], v13, s[56:59], s34 offen offset:0 sc1
  buffer_load_dwordx4 v[132:135], v13, s[56:59], 0 offen offset:1024 sc1
  buffer_load_dwordx4 v[148:151], v13, s[56:59], s34 offen offset:1024 sc1
  buffer_load_dwordx4 v[136:139], v13, s[56:59], 0 offen offset:2048 sc1
  buffer_load_dwordx4 v[152:155], v13, s[56:59], s34 offen offset:2048 sc1
  buffer_load_dwordx4 v[140:143], v13, s[56:59], 0 offen offset:3072 sc1
  buffer_load_dwordx4 v[156:159], v13, s[56:59], s34 offen offset:3072 sc1
  s_branch Lg_xdone
  s_nop 7
Lg_c0_slow:
  s_mov_b32 s39, 65536
Lg_c0_spin:
  s_sleep 8
  buffer_load_dword v33, v34, s[48:51], 0 offen sc1
  s_waitcnt vmcnt(0)
  v_cmp_gt_u32 vcc, 256, v33
  s_cbranch_vccz Lg_c0_back
  s_sub_u32 s39, s39, 1
  s_cmp_lg_u32 s39, 0
  s_cbranch_scc1 Lg_c0_spin
  s_branch Lg_c0_back
  s_nop 7
Lg_cs_slow:
  s_mov_b32 s39, 65536
Lg_cs_spin:
  s_sleep 8
  buffer_load_dwordx2 v[40:41], v30, s[16:19], s66 offen sc1
  buffer_load_dwordx2 v[42:43], v30, s[16:19], s66 offen offset:2048 sc1
  s_waitcnt vmcnt(0)
  v_and_b32 v33, v41, v43
  v_cmp_ne_u32 vcc, 1, v33
  s_cbranch_vccz Lg_cs_back
  s_sub_u32 s39, s39, 1
  s_cmp_lg_u32 s39, 0
  s_cbranch_scc1 Lg_cs_spin
  s_branch Lg_cs_back
  s_nop 7
Lg_f1_slow:
  s_mov_b32 s39, 65536
Lg_f1_spin:
  s_sleep 8
  buffer_load_dword v33, v20, s[16:19], s94 offen sc1
  s_waitcnt vmcnt(0)
  v_cmp_eq_u32 vcc, 0, v33
  s_cbranch_vccz Lg_f1_back
  s_sub_u32 s39, s39, 1
  s_cmp_lg_u32 s39, 0
  s_cbranch_scc1 Lg_f1_spin
  s_branch Lg_f1_back
  s_nop 7
Lg_g2_slow:
  s_mov_b32 s39, 65536
Lg_g2_spin:
  s_sleep 8
  buffer_load_dword v33, v20, s[16:19], s32 offen sc1
  s_waitcnt vmcnt(0)
  v_cmp_eq_u32 vcc, 0, v33
  s_cbranch_vccz Lg_g2_back
  s_sub_u32 s39, s39, 1
  s_cmp_lg_u32 s39, 0
  s_cbranch_scc1 Lg_g2_spin
  s_branch Lg_g2_back
  s_nop 7
Lg_g3_slow:
  s_mov_b32 s39, 65536
Lg_g3_spin:
  s_sleep 8
  buffer_load_dword v33, v20, s[16:19], s28 offen sc1
  s_waitcnt vmcnt(0)
  v_cmp_eq_u32 vcc, 0, v33
  s_cbranch_vccz Lg_g3_back
  s_sub_u32 s39, s39, 1
  s_cmp_lg_u32 s39, 0
  s_cbranch_scc1 Lg_g3_spin
  s_branch Lg_g3_back
  s_nop 7
Lg_g0_slow:
  s_mov_b32 s39, 65536
Lg_g0_spin:
  s_sleep 8
  buffer_load_dword v33, v27, s[16:19], 0 offen sc1
  s_waitcnt vmcnt(0)
  v_cmp_eq_u32 vcc, 0, v33
  s_cbranch_vccz Lg_g0_back
  s_sub_u32 s39, s39, 1
  s_cmp_lg_u32 s39, 0
  s_cbranch_scc1 Lg_g0_spin
  s_branch Lg_g0_back
Lg_end:
.section .rodata,"a"
.p2align 6
.amdhsa_kernel parallel_sum__sliding_local_dilated__dense_activation_gelu__prompt_kernel
  .amdhsa_next_free_vgpr 512
  .amdhsa_next_free_sgpr 102
  .amdhsa_accum_offset 256
  .amdhsa_group_segment_fixed_size 0
  .amdhsa_kernarg_size 88
  .amdhsa_user_sgpr_count 2
  .amdhsa_user_sgpr_kernarg_segment_ptr 1
  .amdhsa_system_sgpr_workgroup_id_x 1
  .amdhsa_float_denorm_mode_32 3
.end_amdhsa_kernel
```
